```python
import torch

def _softmax(x, axis=-1):
    return torch.softmax(x, dim=axis)

def _gelu(x):
    return torch.nn.functional.gelu(x, approximate='tanh')

def _silu(x):
    return torch.nn.functional.silu(x)

def _sigmoid(x):
    return torch.sigmoid(x)

def _layernorm(x, axis=-1, eps=1e-05):
    m = x.mean(dim=axis, keepdim=True)
    v = x.var(dim=axis, keepdim=True, unbiased=False)
    return (x - m) / torch.sqrt(v + eps)

def _scatter_add(tgt, idx, src, axis=0):
    return tgt.clone().index_add_(axis, idx, src)

def _segment_sum(src, seg, n):
    out = torch.zeros((n,) + src.shape[1:], dtype=src.dtype)
    return out.index_add_(0, seg, src)

def _pad(x, pw):
    flat = tuple((v for pair in reversed(pw) for v in pair))
    return torch.nn.functional.pad(x, flat)
kernel_name = 'adaLN_cond__compressed_kv_cla__dense_activation_relu__decode'

def setup_inputs():

    _w = lambda a: (lambda t: t.to(torch.bfloat16) if t.is_floating_point() else t)(torch.as_tensor(a))

    def _A_setup():
        B, H, Sq, Sk, D, M = (8, 32, 1, 4096, 128, 512)
        Dc = 4 * D
        return {'x': _w((lambda *s: torch.randn(*s, dtype=torch.bfloat16) * 0.05)(B, Sq, M)), 'c_kv': _w((lambda *s: torch.randn(*s, dtype=torch.bfloat16) * 1.6)(B, Sk, Dc)), 'w_q': _w((lambda *s: torch.randn(*s, dtype=torch.bfloat16) * 1.6)(M, H, D) * M ** (-0.5)), 'w_uk': _w((lambda *s: torch.randn(*s, dtype=torch.bfloat16) * 1.6)(Dc, H, D) * Dc ** (-0.5)), 'w_uv': _w((lambda *s: torch.randn(*s, dtype=torch.bfloat16) * 1.6)(Dc, H, D) * Dc ** (-0.5)), 'w_o': _w((lambda *s: torch.randn(*s, dtype=torch.bfloat16) * 1.6)(H, D, M) * (H * D) ** (-0.5))}
    _A_in = _A_setup()

    def _B_setup():
        B, S, D, Dff = (8, 1, 512, 1792)
        return {'x': _w((lambda *s: torch.randn(*s, dtype=torch.bfloat16) * 0.05)(B, S, D)), 'w1': _w((lambda *s: torch.randn(*s, dtype=torch.bfloat16) * 0.05)(D, Dff)), 'w2': _w((lambda *s: torch.randn(*s, dtype=torch.bfloat16) * 0.05)(Dff, D))}
    _B_in = _B_setup()
    return {'A_x': _A_in['x'], 'A_c_kv': _A_in['c_kv'], 'A_w_q': _A_in['w_q'], 'A_w_uk': _A_in['w_uk'], 'A_w_uv': _A_in['w_uv'], 'A_w_o': _A_in['w_o'], 'B_x': _B_in['x'], 'B_w1': _B_in['w1'], 'B_w2': _B_in['w2'], 'c': _w((lambda *s: torch.randn(*s, dtype=torch.bfloat16) * 0.2)(8, 512) * 8.0), 'w_mod': _w((lambda *s: torch.randn(*s, dtype=torch.bfloat16) * 0.2)(512, 6 * 512) * 512 ** (-0.5) * 8.0)}

def reference(A_x, A_c_kv, A_w_q, A_w_uk, A_w_uv, A_w_o, B_x, B_w1, B_w2, c, w_mod):

    def _A_ref(x, c_kv, w_q, w_uk, w_uv, w_o):
        B, Sq, M = (x.shape[0], x.shape[1], x.shape[2])
        Sk = c_kv.shape[1]
        H, D = (w_q.shape[1], w_q.shape[2])
        q = torch.einsum('bqm,mhd->bhqd', x, w_q)
        k = torch.einsum('bkc,chd->bhkd', c_kv, w_uk)
        v = torch.einsum('bkc,chd->bhkd', c_kv, w_uv)
        scores = torch.einsum('bhqd,bhkd->bhqk', q, k) * D ** (-0.5)
        off = Sk - Sq
        qi = torch.arange(Sq)[:, None]
        kj = torch.arange(Sk)[None, :]
        cmask = kj <= qi + off
        scores = torch.where(cmask[None, None], scores, -1000000000.0)
        p = _softmax(scores, axis=-1)
        ctx = torch.einsum('bhqk,bhkd->bhqd', p, v)
        return torch.einsum('bhqd,hdm->bqm', ctx, w_o)

    def _B_ref(x, w1, w2):
        h = torch.einsum('bsd,df->bsf', x, w1)
        zero = torch.zeros_like(h)
        h = torch.maximum(h, zero)
        return torch.einsum('bsf,fd->bsd', h, w2)
    x = A_x
    mod = (_silu(c) @ w_mod).reshape(c.shape[0], 6, 1, -1)
    sa, ca, ga, sb, cb, gb = (mod[:, 0].clone(), mod[:, 1].clone(), mod[:, 2].clone(), mod[:, 3].clone(), mod[:, 4].clone(), mod[:, 5].clone())
    h = _layernorm(x, axis=-1) * (1 + ca) + sa
    x = x + ga * _A_ref(h, A_c_kv, A_w_q, A_w_uk, A_w_uv, A_w_o)
    h = _layernorm(x, axis=-1) * (1 + cb) + sb
    x = x + gb * _B_ref(h, B_w1, B_w2)
    return x
```

```asm
; @launch grid=(256,1,1) block=(768,1,1) lds=163840
.amdgcn_target "amdgcn-amd-amdhsa--gfx950"
.text
.globl adaLN_cond__compressed_kv_cla__dense_activation_relu__decode_kernel
.p2align 8
.type adaLN_cond__compressed_kv_cla__dense_activation_relu__decode_kernel,@function
adaLN_cond__compressed_kv_cla__dense_activation_relu__decode_kernel:

    s_cmp_ge_u32 s2, 256
    s_cbranch_scc1 L_exit
    s_load_dwordx16 s[4:19], s[0:1], 0
    s_load_dwordx8 s[20:27], s[0:1], 64
    s_load_dwordx4 s[28:31], s[0:1], 96
    v_lshrrev_b32 v2, 6, v0
    v_and_b32 v1, 63, v0
    v_readfirstlane_b32 s32, v2
    s_and_b32 s36, s2, 7
    s_lshr_b32 s37, s2, 3
    s_and_b32 s34, s37, 7
    s_lshr_b32 s35, s37, 3
    s_lshl_b32 s35, s35, 3
    s_add_u32 s35, s35, s36
    s_and_b32 s33, s32, 3
    s_mov_b32 s3, 0x400000
    v_mov_b32 v0, 156256

    s_getpc_b64 s[52:53]
L_pc:
    s_mul_i32 s38, s37, 12
    s_add_u32 s38, s38, s32
    s_lshl_b32 s38, s38, 7
    s_cmp_ge_u32 s38, L_codeend-L_pc
    s_cbranch_scc1 L_nopf
    v_mov_b32 v2, s38
    s_mov_b64 exec, 1
    global_load_dword v167, v2, s[52:53]
    s_mov_b64 exec, -1
L_nopf:

    s_lshl_b32 s54, s34, 5
    s_add_u32 s54, s54, s35
    s_lshl_b32 s54, s54, 10
    s_lshl_b32 s55, s36, 2
    s_add_u32 s55, s55, s37
    s_waitcnt lgkmcnt(0)

    s_mov_b32 s40, s30
    s_mov_b32 s41, s31
    s_mov_b32 s42, 16777216
    s_mov_b32 s43, 0x20000

    s_cmp_ge_u32 s32, 8
    s_cbranch_scc1 L_C
    s_cmp_ge_u32 s32, 4
    s_cbranch_scc1 L_B

L_A:

    v_mov_b32 v8, -1
    v_mov_b32 v9, -1
    v_mov_b32 v10, -1
    v_mov_b32 v11, -1
    v_lshlrev_b32 v2, 4, v1
    s_cmp_lg_u32 s33, 0
    s_cbranch_scc1 L_A_i1
    v_cmp_lt_u32 vcc, 4, v1
    v_mul_u32_u24 v3, 1008, v1
    s_nop 0
    v_cndmask_b32 v4, 0, v8, vcc
    v_add_u32 v3, v3, v0
    v_mov_b32 v5, v4
    v_mov_b32 v6, v4
    v_mov_b32 v7, v4
    v_add_u32 v12, v2, v0
    s_mov_b64 exec, 0xff
    ds_write_b128 v3, v[4:7]
    s_mov_b32 exec_lo, -1
    ds_write_b128 v12, v[8:11] offset:7072
    s_mov_b64 exec, -1
L_A_i1:
    s_cmp_lg_u32 s33, 1
    s_cbranch_scc1 L_A_i2
    s_cmp_ge_u32 s2, 32
    s_cbranch_scc1 L_A_i2
    s_lshl_b32 s38, s55, 13
    s_add_u32 s38, s38, 65536
    s_add_u32 s39, s38, 4096

    buffer_store_dwordx4 v[8:11], v2, s[40:43], s38 offen offset:0 sc1
    buffer_store_dwordx4 v[8:11], v2, s[40:43], s38 offen offset:1024 sc1
    buffer_store_dwordx4 v[8:11], v2, s[40:43], s38 offen offset:2048 sc1
    buffer_store_dwordx4 v[8:11], v2, s[40:43], s38 offen offset:3072 sc1
    buffer_store_dwordx4 v[8:11], v2, s[40:43], s39 offen offset:0 sc1
    buffer_store_dwordx4 v[8:11], v2, s[40:43], s39 offen offset:1024 sc1
    buffer_store_dwordx4 v[8:11], v2, s[40:43], s39 offen offset:2048 sc1
    buffer_store_dwordx4 v[8:11], v2, s[40:43], s39 offen offset:3072 sc1

    s_lshl_b32 s38, s55, 8
    s_mov_b64 exec, 0xffff
    buffer_store_dwordx4 v[8:11], v2, s[40:43], s38 offen sc1
    s_lshl_b32 s38, s55, 3
    v_mov_b32 v3, s38
    s_mov_b64 exec, 1
    s_waitcnt vmcnt(0)
    global_store_dword v3, v8, s[28:29] sc1
    s_mov_b64 exec, -1
L_A_i2:

    s_mov_b32 s44, s6
    s_mov_b32 s45, s7
    s_mov_b32 s46, 33554432
    s_mov_b32 s47, 0x20000

    v_lshrrev_b32 v4, 3, v1
    v_bfe_u32 v5, v4, 1, 1
    v_lshlrev_b32 v5, 2, v5
    v_bfe_u32 v6, v4, 2, 1
    v_or_b32 v5, v5, v6
    v_and_b32 v6, 7, v1
    v_xor_b32 v5, v5, v6
    v_lshlrev_b32 v5, 4, v5
    v_lshl_add_u32 v2, v4, 10, v5
    v_xor_b32 v3, 32, v2
    s_lshl_b32 s48, s54, 7
    s_lshl_b32 s38, s33, 15
    s_add_u32 s48, s48, s38
    s_lshl_b32 s49, s33, 12
    s_waitcnt lgkmcnt(0)
    s_barrier

L_w1:
    s_sleep 1
    ds_read_b32 v8, v0 offset:12
    s_sub_u32 s3, s3, 1
    s_cbranch_scc1 L_end
    s_waitcnt lgkmcnt(0)
    v_cmp_gt_u32 vcc, 4, v8
    s_cbranch_vccnz L_w1

    s_mov_b32 s50, 0
L_A_dma:
    s_cmp_lg_u32 s50, 5
    s_cbranch_scc1 L_A_dma1

L_w2:
    ds_read_b32 v8, v0 offset:8
    s_sub_u32 s3, s3, 1
    s_cbranch_scc1 L_end
    s_waitcnt lgkmcnt(0)
    v_cmp_gt_u32 vcc, 4, v8
    s_cbranch_vccnz L_w2
L_A_dma1:
    s_add_u32 m0, s49, 0
    s_add_u32 s38, s48, 0
    buffer_load_dwordx4 v2, s[44:47], s38 offen nt lds
    s_waitcnt vmcnt(3)
    s_add_u32 m0, s49, 1024
    s_add_u32 s38, s48, 8192
    buffer_load_dwordx4 v3, s[44:47], s38 offen nt lds
    s_waitcnt vmcnt(3)
    s_add_u32 m0, s49, 2048
    s_add_u32 s38, s48, 16384
    buffer_load_dwordx4 v2, s[44:47], s38 offen nt lds
    s_waitcnt vmcnt(3)
    s_add_u32 m0, s49, 3072
    s_add_u32 s38, s48, 24576
    buffer_load_dwordx4 v3, s[44:47], s38 offen nt lds
    s_waitcnt vmcnt(3)

    s_add_u32 s49, s49, 16384
    s_add_u32 s48, s48, 128
    s_add_u32 s50, s50, 1
    s_cmp_lt_u32 s50, 8
    s_cbranch_scc1 L_A_dma

    v_mov_b32 v8, 1
    s_mov_b64 exec, 1
    ds_add_u32 v0, v8 offset:1012
    s_mov_b64 exec, -1

    v_and_b32 v9, 31, v1
    v_lshrrev_b32 v10, 5, v1
    v_bfe_u32 v4, v9, 1, 1
    v_lshlrev_b32 v4, 2, v4
    v_bfe_u32 v5, v9, 2, 2
    v_or_b32 v4, v4, v5
    v_xor_b32 v4, v4, v10
    v_lshlrev_b32 v4, 4, v4
    v_lshl_add_u32 v4, v9, 7, v4
    s_lshl_b32 s38, s33, 12
    v_add_u32 v4, s38, v4
    v_xor_b32 v5, 32, v4
    v_xor_b32 v6, 64, v4
    v_xor_b32 v7, 0x60, v4
    v_mul_u32_u24 v8, 1008, v9
    v_lshl_add_u32 v8, v10, 4, v8
    v_add_u32 v8, 131072, v8
    v_lshlrev_b32 v11, 10, v9
    v_lshl_add_u32 v11, v10, 4, v11
    s_lshl_b32 s38, s34, 15
    s_add_u32 s38, s38, 65536

L_w3:
    ds_read_b32 v16, v0 offset:1008
    s_sub_u32 s3, s3, 1
    s_cbranch_scc1 L_end
    s_waitcnt lgkmcnt(0)
    v_cmp_gt_u32 vcc, 4, v16
    s_cbranch_vccnz L_w3
    buffer_load_dwordx4 v[12:15], v11, s[40:43], s38 offen offset:992 sc1
    ds_read_b128 v[32:35], v4 offset:0
    ds_read_b128 v[48:51], v8 offset:0
    ds_read_b128 v[36:39], v5 offset:0
    ds_read_b128 v[52:55], v8 offset:32
    ds_read_b128 v[40:43], v6 offset:0
    ds_read_b128 v[56:59], v8 offset:64
    ds_read_b128 v[44:47], v7 offset:0
    ds_read_b128 v[60:63], v8 offset:96
    s_waitcnt lgkmcnt(6)
    v_mfma_f32_32x32x16_bf16 v[16:31], v[32:35], v[48:51], 0
    ds_read_b128 v[32:35], v4 offset:16384
    ds_read_b128 v[48:51], v8 offset:128
    s_waitcnt lgkmcnt(6)
    v_mfma_f32_32x32x16_bf16 v[16:31], v[36:39], v[52:55], v[16:31]
    ds_read_b128 v[36:39], v5 offset:16384
    ds_read_b128 v[52:55], v8 offset:160
    s_waitcnt lgkmcnt(6)
    v_mfma_f32_32x32x16_bf16 v[16:31], v[40:43], v[56:59], v[16:31]
    ds_read_b128 v[40:43], v6 offset:16384
    ds_read_b128 v[56:59], v8 offset:192
    s_waitcnt lgkmcnt(6)
    v_mfma_f32_32x32x16_bf16 v[16:31], v[44:47], v[60:63], v[16:31]
    ds_read_b128 v[44:47], v7 offset:16384
    ds_read_b128 v[60:63], v8 offset:224
    s_waitcnt lgkmcnt(6)
    v_mfma_f32_32x32x16_bf16 v[16:31], v[32:35], v[48:51], v[16:31]
    ds_read_b128 v[32:35], v4 offset:32768
    ds_read_b128 v[48:51], v8 offset:256
    s_waitcnt lgkmcnt(6)
    v_mfma_f32_32x32x16_bf16 v[16:31], v[36:39], v[52:55], v[16:31]
    ds_read_b128 v[36:39], v5 offset:32768
    ds_read_b128 v[52:55], v8 offset:288
    s_waitcnt lgkmcnt(6)
    v_mfma_f32_32x32x16_bf16 v[16:31], v[40:43], v[56:59], v[16:31]
    ds_read_b128 v[40:43], v6 offset:32768
    ds_read_b128 v[56:59], v8 offset:320
    s_waitcnt lgkmcnt(6)
    v_mfma_f32_32x32x16_bf16 v[16:31], v[44:47], v[60:63], v[16:31]
    ds_read_b128 v[44:47], v7 offset:32768
    ds_read_b128 v[60:63], v8 offset:352
    s_waitcnt lgkmcnt(6)
    v_mfma_f32_32x32x16_bf16 v[16:31], v[32:35], v[48:51], v[16:31]
    ds_read_b128 v[32:35], v4 offset:49152
    ds_read_b128 v[48:51], v8 offset:384
    s_waitcnt lgkmcnt(6)
    v_mfma_f32_32x32x16_bf16 v[16:31], v[36:39], v[52:55], v[16:31]
    ds_read_b128 v[36:39], v5 offset:49152
    ds_read_b128 v[52:55], v8 offset:416
    s_waitcnt lgkmcnt(6)
    v_mfma_f32_32x32x16_bf16 v[16:31], v[40:43], v[56:59], v[16:31]
    ds_read_b128 v[40:43], v6 offset:49152
    ds_read_b128 v[56:59], v8 offset:448
    s_waitcnt lgkmcnt(6)
    v_mfma_f32_32x32x16_bf16 v[16:31], v[44:47], v[60:63], v[16:31]
    ds_read_b128 v[44:47], v7 offset:49152
    ds_read_b128 v[60:63], v8 offset:480
    s_waitcnt lgkmcnt(6)
    v_mfma_f32_32x32x16_bf16 v[16:31], v[32:35], v[48:51], v[16:31]
    v_add_u32 v4, 0x10000, v4
    v_add_u32 v5, 0x10000, v5
    v_add_u32 v6, 0x10000, v6
    v_add_u32 v7, 0x10000, v7
    ds_read_b128 v[32:35], v4 offset:0
    ds_read_b128 v[48:51], v8 offset:512
    s_waitcnt lgkmcnt(6)
    v_mfma_f32_32x32x16_bf16 v[16:31], v[36:39], v[52:55], v[16:31]
    ds_read_b128 v[36:39], v5 offset:0
    ds_read_b128 v[52:55], v8 offset:544
    s_waitcnt lgkmcnt(6)
    v_mfma_f32_32x32x16_bf16 v[16:31], v[40:43], v[56:59], v[16:31]
    ds_read_b128 v[40:43], v6 offset:0
    ds_read_b128 v[56:59], v8 offset:576
    s_waitcnt lgkmcnt(6)
    v_mfma_f32_32x32x16_bf16 v[16:31], v[44:47], v[60:63], v[16:31]
    ds_read_b128 v[44:47], v7 offset:0
    ds_read_b128 v[60:63], v8 offset:608
    s_waitcnt lgkmcnt(6)
    v_mfma_f32_32x32x16_bf16 v[16:31], v[32:35], v[48:51], v[16:31]
    ds_read_b128 v[32:35], v4 offset:16384
    ds_read_b128 v[48:51], v8 offset:640
    s_waitcnt lgkmcnt(6)
    v_mfma_f32_32x32x16_bf16 v[16:31], v[36:39], v[52:55], v[16:31]
    ds_read_b128 v[36:39], v5 offset:16384
    ds_read_b128 v[52:55], v8 offset:672
    s_waitcnt lgkmcnt(6)
    v_mfma_f32_32x32x16_bf16 v[16:31], v[40:43], v[56:59], v[16:31]
    ds_read_b128 v[40:43], v6 offset:16384
    ds_read_b128 v[56:59], v8 offset:704
    s_waitcnt lgkmcnt(6)
    v_mfma_f32_32x32x16_bf16 v[16:31], v[44:47], v[60:63], v[16:31]
    ds_read_b128 v[44:47], v7 offset:16384
    ds_read_b128 v[60:63], v8 offset:736
    s_waitcnt lgkmcnt(6)
    v_mfma_f32_32x32x16_bf16 v[16:31], v[32:35], v[48:51], v[16:31]
    ds_read_b128 v[32:35], v4 offset:32768
    ds_read_b128 v[48:51], v8 offset:768
    s_waitcnt lgkmcnt(6)
    v_mfma_f32_32x32x16_bf16 v[16:31], v[36:39], v[52:55], v[16:31]
    ds_read_b128 v[36:39], v5 offset:32768
    ds_read_b128 v[52:55], v8 offset:800
    s_waitcnt lgkmcnt(6)
    v_mfma_f32_32x32x16_bf16 v[16:31], v[40:43], v[56:59], v[16:31]
    ds_read_b128 v[40:43], v6 offset:32768
    ds_read_b128 v[56:59], v8 offset:832
    s_waitcnt lgkmcnt(6)
    v_mfma_f32_32x32x16_bf16 v[16:31], v[44:47], v[60:63], v[16:31]
    ds_read_b128 v[44:47], v7 offset:32768
    ds_read_b128 v[60:63], v8 offset:864
    s_waitcnt lgkmcnt(6)
    v_mfma_f32_32x32x16_bf16 v[16:31], v[32:35], v[48:51], v[16:31]
    s_waitcnt vmcnt(0)
    ds_read_b128 v[32:35], v4 offset:49152
    ds_read_b128 v[48:51], v8 offset:896
    s_waitcnt lgkmcnt(6)
    v_mfma_f32_32x32x16_bf16 v[16:31], v[36:39], v[52:55], v[16:31]
    ds_read_b128 v[36:39], v5 offset:49152
    ds_read_b128 v[52:55], v8 offset:928
    s_waitcnt lgkmcnt(6)
    v_mfma_f32_32x32x16_bf16 v[16:31], v[40:43], v[56:59], v[16:31]
    ds_read_b128 v[40:43], v6 offset:49152
    ds_read_b128 v[56:59], v8 offset:960
    s_waitcnt lgkmcnt(6)
    v_mfma_f32_32x32x16_bf16 v[16:31], v[44:47], v[60:63], v[16:31]
    ds_read_b128 v[44:47], v7 offset:49152
    s_waitcnt lgkmcnt(5)
    v_mfma_f32_32x32x16_bf16 v[16:31], v[32:35], v[48:51], v[16:31]
    s_waitcnt lgkmcnt(3)
    v_mfma_f32_32x32x16_bf16 v[16:31], v[36:39], v[52:55], v[16:31]
    s_waitcnt lgkmcnt(1)
    v_mfma_f32_32x32x16_bf16 v[16:31], v[40:43], v[56:59], v[16:31]
    s_waitcnt lgkmcnt(0)
    v_mfma_f32_32x32x16_bf16 v[16:31], v[44:47], v[12:15], v[16:31]

    v_bfe_u32 v32, v1, 2, 2
    v_lshl_add_u32 v33, v10, 2, v32
    v_lshrrev_b32 v32, 1, v32
    v_lshl_or_b32 v32, v32, 2, v10
    v_bfe_u32 v34, v1, 4, 1
    v_bfe_u32 v35, v1, 1, 1
    v_lshl_or_b32 v34, v34, 1, v35
    v_xor_b32 v32, v32, v34
    v_lshlrev_b32 v32, 4, v32
    v_lshl_add_u32 v32, v33, 7, v32
    v_and_b32 v33, 1, v1
    v_lshl_add_u32 v32, v33, 3, v32
    s_mul_i32 s38, s33, 36864
    v_add_u32 v4, s38, v32
    v_xor_b32 v5, 1056, v4
    v_xor_b32 v6, 64, v4
    v_xor_b32 v7, 1120, v4
    v_lshl_add_u32 v11, v9, 4, v0
    s_lshl_b32 s38, s33, 2
    v_add_u32 v12, s38, v11

    v_max3_f32 v13, v16, v17, v18
    v_max3_f32 v13, v13, v19, v20
    v_max3_f32 v13, v13, v21, v22
    v_max3_f32 v13, v13, v23, v24
    v_max3_f32 v13, v13, v25, v26
    v_max3_f32 v13, v13, v27, v28
    v_max3_f32 v13, v13, v29, v30
    v_max_f32 v13, v13, v31
    v_mov_b32 v14, v13
    s_nop 1
    v_permlane32_swap_b32 v13, v14
    v_max_f32 v13, v13, v14
    ds_write_b32 v12, v13 offset:7072
L_A_mx:
    ds_read_b128 v[32:35], v11 offset:7072
    s_sub_u32 s3, s3, 1
    s_cbranch_scc1 L_end
    s_waitcnt lgkmcnt(0)
    v_max3_u32 v36, v32, v33, v34
    v_max_u32 v36, v36, v35
    v_cmp_eq_u32 vcc, -1, v36
    s_cbranch_vccnz L_A_mx
    v_max3_f32 v13, v32, v33, v34
    v_max_f32 v13, v13, v35
    ds_read_b64_tr_b16 v[32:33], v4 offset:0
    ds_read_b64_tr_b16 v[34:35], v5 offset:0
    ds_read_b64_tr_b16 v[36:37], v6 offset:0
    ds_read_b64_tr_b16 v[38:39], v7 offset:0
    ds_read_b64_tr_b16 v[40:41], v4 offset:16384
    ds_read_b64_tr_b16 v[42:43], v5 offset:16384
    ds_read_b64_tr_b16 v[44:45], v6 offset:16384
    ds_read_b64_tr_b16 v[46:47], v7 offset:16384
    v_sub_f32 v16, v16, v13
    v_sub_f32 v17, v17, v13
    v_sub_f32 v18, v18, v13
    v_sub_f32 v19, v19, v13
    v_sub_f32 v20, v20, v13
    v_sub_f32 v21, v21, v13
    v_sub_f32 v22, v22, v13
    v_sub_f32 v23, v23, v13
    v_sub_f32 v24, v24, v13
    v_sub_f32 v25, v25, v13
    v_sub_f32 v26, v26, v13
    v_sub_f32 v27, v27, v13
    v_sub_f32 v28, v28, v13
    v_sub_f32 v29, v29, v13
    v_sub_f32 v30, v30, v13
    v_sub_f32 v31, v31, v13
    v_exp_f32 v16, v16
    v_exp_f32 v17, v17
    v_exp_f32 v18, v18
    v_exp_f32 v19, v19
    v_exp_f32 v20, v20
    v_exp_f32 v21, v21
    v_exp_f32 v22, v22
    v_exp_f32 v23, v23
    v_exp_f32 v24, v24
    v_exp_f32 v25, v25
    v_exp_f32 v26, v26
    v_exp_f32 v27, v27
    v_exp_f32 v28, v28
    v_exp_f32 v29, v29
    v_exp_f32 v30, v30
    v_exp_f32 v31, v31
    v_cvt_pk_bf16_f32 v128, v16, v17
    v_cvt_pk_bf16_f32 v129, v18, v19
    v_cvt_pk_bf16_f32 v130, v20, v21
    v_cvt_pk_bf16_f32 v131, v22, v23
    v_cvt_pk_bf16_f32 v132, v24, v25
    v_cvt_pk_bf16_f32 v133, v26, v27
    v_cvt_pk_bf16_f32 v134, v28, v29
    v_cvt_pk_bf16_f32 v135, v30, v31
    v_lshlrev_b32 v8, 4, v1
    s_lshl_b32 s38, s33, 11
    s_add_u32 s38, s38, 131072
    v_add_u32 v8, s38, v8
    ds_write_b128 v8, v[128:131]
    ds_write_b128 v8, v[132:135] offset:1024
    v_add_f32 v16, v16, v24
    v_add_f32 v17, v17, v25
    v_add_f32 v18, v18, v26
    v_add_f32 v19, v19, v27
    v_add_f32 v20, v20, v28
    v_add_f32 v21, v21, v29
    v_add_f32 v22, v22, v30
    v_add_f32 v23, v23, v31
    v_add_f32 v16, v16, v20
    v_add_f32 v17, v17, v21
    v_add_f32 v18, v18, v22
    v_add_f32 v19, v19, v23
    v_add_f32 v16, v16, v18
    v_add_f32 v17, v17, v19
    v_add_f32 v16, v16, v17
    v_mov_b32 v14, v16
    s_nop 1
    v_permlane32_swap_b32 v16, v14
    v_add_f32 v16, v16, v14
    v_add_u32 v12, -16992, v12
    ds_write_b32 v12, v16
    v_mov_b32 v14, 1
    s_mov_b64 exec, 1
    ds_add_u32 v0, v14 offset:1016
    s_mov_b64 exec, -1
    ds_read_b64_tr_b16 v[48:49], v4 offset:2048
    ds_read_b64_tr_b16 v[50:51], v5 offset:2048
    s_waitcnt lgkmcnt(2)
    v_mfma_f32_32x32x16_bf16 v[64:79], v[128:131], v[32:35], 0
    ds_read_b64_tr_b16 v[52:53], v6 offset:2048
    ds_read_b64_tr_b16 v[54:55], v7 offset:2048
    s_waitcnt lgkmcnt(4)
    v_mfma_f32_32x32x16_bf16 v[80:95], v[128:131], v[36:39], 0
    ds_read_b64_tr_b16 v[56:57], v4 offset:18432
    ds_read_b64_tr_b16 v[58:59], v5 offset:18432
    s_waitcnt lgkmcnt(6)
    v_mfma_f32_32x32x16_bf16 v[96:111], v[128:131], v[40:43], 0
    ds_read_b64_tr_b16 v[60:61], v6 offset:18432
    ds_read_b64_tr_b16 v[62:63], v7 offset:18432
    s_waitcnt lgkmcnt(8)
    v_mfma_f32_32x32x16_bf16 v[112:127], v[128:131], v[44:47], 0
L_w4:
    ds_read_b32 v14, v0 offset:1016
    s_sub_u32 s3, s3, 1
    s_cbranch_scc1 L_end
    s_waitcnt lgkmcnt(0)
    v_cmp_gt_u32 vcc, 4, v14
    s_cbranch_vccnz L_w4
    v_xor_b32 v15, 2048, v8
    ds_read_b128 v[136:139], v15
    ds_read_b128 v[140:143], v15 offset:1024
    v_xor_b32 v15, 4096, v8
    ds_read_b128 v[144:147], v15
    ds_read_b128 v[148:151], v15 offset:1024
    v_xor_b32 v15, 6144, v8
    ds_read_b128 v[152:155], v15
    ds_read_b128 v[156:159], v15 offset:1024
    v_add_u32 v11, -16992, v11
    ds_read_b128 v[16:19], v11
    v_xor_b32 v4, 4096, v4
    v_xor_b32 v5, 4096, v5
    v_xor_b32 v6, 4096, v6
    v_xor_b32 v7, 4096, v7
    ds_read_b64_tr_b16 v[32:33], v4 offset:0
    ds_read_b64_tr_b16 v[34:35], v5 offset:0
    v_mfma_f32_32x32x16_bf16 v[64:79], v[132:135], v[48:51], v[64:79]
    ds_read_b64_tr_b16 v[36:37], v6 offset:0
    ds_read_b64_tr_b16 v[38:39], v7 offset:0
    v_mfma_f32_32x32x16_bf16 v[80:95], v[132:135], v[52:55], v[80:95]
    ds_read_b64_tr_b16 v[40:41], v4 offset:16384
    ds_read_b64_tr_b16 v[42:43], v5 offset:16384
    v_mfma_f32_32x32x16_bf16 v[96:111], v[132:135], v[56:59], v[96:111]
    ds_read_b64_tr_b16 v[44:45], v6 offset:16384
    ds_read_b64_tr_b16 v[46:47], v7 offset:16384
    v_mfma_f32_32x32x16_bf16 v[112:127], v[132:135], v[60:63], v[112:127]
    ds_read_b64_tr_b16 v[48:49], v4 offset:2048
    ds_read_b64_tr_b16 v[50:51], v5 offset:2048
    s_waitcnt lgkmcnt(8)
    v_mfma_f32_32x32x16_bf16 v[64:79], v[136:139], v[32:35], v[64:79]
    ds_read_b64_tr_b16 v[52:53], v6 offset:2048
    ds_read_b64_tr_b16 v[54:55], v7 offset:2048
    s_waitcnt lgkmcnt(8)
    v_mfma_f32_32x32x16_bf16 v[80:95], v[136:139], v[36:39], v[80:95]
    ds_read_b64_tr_b16 v[56:57], v4 offset:18432
    ds_read_b64_tr_b16 v[58:59], v5 offset:18432
    s_waitcnt lgkmcnt(8)
    v_mfma_f32_32x32x16_bf16 v[96:111], v[136:139], v[40:43], v[96:111]
    ds_read_b64_tr_b16 v[60:61], v6 offset:18432
    ds_read_b64_tr_b16 v[62:63], v7 offset:18432
    s_waitcnt lgkmcnt(8)
    v_mfma_f32_32x32x16_bf16 v[112:127], v[136:139], v[44:47], v[112:127]
    v_xor_b32 v4, 12288, v4
    v_xor_b32 v5, 12288, v5
    v_xor_b32 v6, 12288, v6
    v_xor_b32 v7, 12288, v7
    ds_read_b64_tr_b16 v[32:33], v4 offset:0
    ds_read_b64_tr_b16 v[34:35], v5 offset:0
    s_waitcnt lgkmcnt(8)
    v_mfma_f32_32x32x16_bf16 v[64:79], v[140:143], v[48:51], v[64:79]
    ds_read_b64_tr_b16 v[36:37], v6 offset:0
    ds_read_b64_tr_b16 v[38:39], v7 offset:0
    s_waitcnt lgkmcnt(8)
    v_mfma_f32_32x32x16_bf16 v[80:95], v[140:143], v[52:55], v[80:95]
    ds_read_b64_tr_b16 v[40:41], v4 offset:16384
    ds_read_b64_tr_b16 v[42:43], v5 offset:16384
    s_waitcnt lgkmcnt(8)
    v_mfma_f32_32x32x16_bf16 v[96:111], v[140:143], v[56:59], v[96:111]
    ds_read_b64_tr_b16 v[44:45], v6 offset:16384
    ds_read_b64_tr_b16 v[46:47], v7 offset:16384
    s_waitcnt lgkmcnt(8)
    v_mfma_f32_32x32x16_bf16 v[112:127], v[140:143], v[60:63], v[112:127]
    ds_read_b64_tr_b16 v[48:49], v4 offset:2048
    ds_read_b64_tr_b16 v[50:51], v5 offset:2048
    s_waitcnt lgkmcnt(8)
    v_mfma_f32_32x32x16_bf16 v[64:79], v[144:147], v[32:35], v[64:79]
    ds_read_b64_tr_b16 v[52:53], v6 offset:2048
    ds_read_b64_tr_b16 v[54:55], v7 offset:2048
    s_waitcnt lgkmcnt(8)
    v_mfma_f32_32x32x16_bf16 v[80:95], v[144:147], v[36:39], v[80:95]
    ds_read_b64_tr_b16 v[56:57], v4 offset:18432
    ds_read_b64_tr_b16 v[58:59], v5 offset:18432
    s_waitcnt lgkmcnt(8)
    v_mfma_f32_32x32x16_bf16 v[96:111], v[144:147], v[40:43], v[96:111]
    ds_read_b64_tr_b16 v[60:61], v6 offset:18432
    ds_read_b64_tr_b16 v[62:63], v7 offset:18432
    s_waitcnt lgkmcnt(8)
    v_mfma_f32_32x32x16_bf16 v[112:127], v[144:147], v[44:47], v[112:127]
    v_xor_b32 v4, 4096, v4
    v_xor_b32 v5, 4096, v5
    v_xor_b32 v6, 4096, v6
    v_xor_b32 v7, 4096, v7
    ds_read_b64_tr_b16 v[32:33], v4 offset:0
    ds_read_b64_tr_b16 v[34:35], v5 offset:0
    s_waitcnt lgkmcnt(8)
    v_mfma_f32_32x32x16_bf16 v[64:79], v[148:151], v[48:51], v[64:79]
    ds_read_b64_tr_b16 v[36:37], v6 offset:0
    ds_read_b64_tr_b16 v[38:39], v7 offset:0
    s_waitcnt lgkmcnt(8)
    v_mfma_f32_32x32x16_bf16 v[80:95], v[148:151], v[52:55], v[80:95]
    ds_read_b64_tr_b16 v[40:41], v4 offset:16384
    ds_read_b64_tr_b16 v[42:43], v5 offset:16384
    s_waitcnt lgkmcnt(8)
    v_mfma_f32_32x32x16_bf16 v[96:111], v[148:151], v[56:59], v[96:111]
    ds_read_b64_tr_b16 v[44:45], v6 offset:16384
    ds_read_b64_tr_b16 v[46:47], v7 offset:16384
    s_waitcnt lgkmcnt(8)
    v_mfma_f32_32x32x16_bf16 v[112:127], v[148:151], v[60:63], v[112:127]
    ds_read_b64_tr_b16 v[48:49], v4 offset:2048
    ds_read_b64_tr_b16 v[50:51], v5 offset:2048
    s_waitcnt lgkmcnt(8)
    v_mfma_f32_32x32x16_bf16 v[64:79], v[152:155], v[32:35], v[64:79]
    ds_read_b64_tr_b16 v[52:53], v6 offset:2048
    ds_read_b64_tr_b16 v[54:55], v7 offset:2048
    s_waitcnt lgkmcnt(8)
    v_mfma_f32_32x32x16_bf16 v[80:95], v[152:155], v[36:39], v[80:95]
    ds_read_b64_tr_b16 v[56:57], v4 offset:18432
    ds_read_b64_tr_b16 v[58:59], v5 offset:18432
    s_waitcnt lgkmcnt(8)
    v_mfma_f32_32x32x16_bf16 v[96:111], v[152:155], v[40:43], v[96:111]
    ds_read_b64_tr_b16 v[60:61], v6 offset:18432
    ds_read_b64_tr_b16 v[62:63], v7 offset:18432
    s_waitcnt lgkmcnt(8)
    v_mfma_f32_32x32x16_bf16 v[112:127], v[152:155], v[44:47], v[112:127]
    s_waitcnt lgkmcnt(6)
    v_mfma_f32_32x32x16_bf16 v[64:79], v[156:159], v[48:51], v[64:79]
    s_waitcnt lgkmcnt(4)
    v_mfma_f32_32x32x16_bf16 v[80:95], v[156:159], v[52:55], v[80:95]
    s_waitcnt lgkmcnt(2)
    v_mfma_f32_32x32x16_bf16 v[96:111], v[156:159], v[56:59], v[96:111]
    s_waitcnt lgkmcnt(0)
    v_mfma_f32_32x32x16_bf16 v[112:127], v[156:159], v[60:63], v[112:127]
    v_mov_b32 v14, 1
    s_mov_b64 exec, 1
    ds_add_u32 v0, v14 offset:1020
    s_mov_b64 exec, -1

    v_add_f32 v16, v16, v17
    v_add_f32 v18, v18, v19
    v_add_f32 v14, v16, v18
    v_bfe_u32 v2, v1, 4, 1
    v_lshl_add_u32 v2, v10, 2, v2
    v_lshlrev_b32 v2, 15, v2
    v_and_b32 v3, 15, v1
    v_lshl_add_u32 v2, v3, 4, v2
    s_lshl_b32 s48, s34, 20
    s_lshl_b32 s38, s35, 10
    s_add_u32 s48, s48, s38
    s_lshl_b32 s38, s33, 8
    s_add_u32 s48, s48, s38
    s_add_u32 s48, s48, 2097152

    v_cvt_pk_bf16_f32 v128, v64, v80
    v_cvt_pk_bf16_f32 v129, v65, v81
    v_cvt_pk_bf16_f32 v130, v96, v112
    v_cvt_pk_bf16_f32 v131, v97, v113
    s_add_u32 s38, s48, 0
    v_permlane16_swap_b32 v128, v129
    v_permlane16_swap_b32 v130, v131
    buffer_store_dwordx4 v[128:131], v2, s[40:43], s38 offen sc1
    v_cvt_pk_bf16_f32 v132, v66, v82
    v_cvt_pk_bf16_f32 v133, v67, v83
    v_cvt_pk_bf16_f32 v134, v98, v114
    v_cvt_pk_bf16_f32 v135, v99, v115
    s_add_u32 s38, s48, 65536
    v_permlane16_swap_b32 v132, v133
    v_permlane16_swap_b32 v134, v135
    buffer_store_dwordx4 v[132:135], v2, s[40:43], s38 offen sc1
    v_cvt_pk_bf16_f32 v136, v68, v84
    v_cvt_pk_bf16_f32 v137, v69, v85
    v_cvt_pk_bf16_f32 v138, v100, v116
    v_cvt_pk_bf16_f32 v139, v101, v117
    s_add_u32 s38, s48, 262144
    v_permlane16_swap_b32 v136, v137
    v_permlane16_swap_b32 v138, v139
    buffer_store_dwordx4 v[136:139], v2, s[40:43], s38 offen sc1
    v_cvt_pk_bf16_f32 v140, v70, v86
    v_cvt_pk_bf16_f32 v141, v71, v87
    v_cvt_pk_bf16_f32 v142, v102, v118
    v_cvt_pk_bf16_f32 v143, v103, v119
    s_add_u32 s38, s48, 327680
    v_permlane16_swap_b32 v140, v141
    v_permlane16_swap_b32 v142, v143
    buffer_store_dwordx4 v[140:143], v2, s[40:43], s38 offen sc1
    v_cvt_pk_bf16_f32 v144, v72, v88
    v_cvt_pk_bf16_f32 v145, v73, v89
    v_cvt_pk_bf16_f32 v146, v104, v120
    v_cvt_pk_bf16_f32 v147, v105, v121
    s_add_u32 s38, s48, 524288
    v_permlane16_swap_b32 v144, v145
    v_permlane16_swap_b32 v146, v147
    buffer_store_dwordx4 v[144:147], v2, s[40:43], s38 offen sc1
    v_cvt_pk_bf16_f32 v148, v74, v90
    v_cvt_pk_bf16_f32 v149, v75, v91
    v_cvt_pk_bf16_f32 v150, v106, v122
    v_cvt_pk_bf16_f32 v151, v107, v123
    s_add_u32 s38, s48, 589824
    v_permlane16_swap_b32 v148, v149
    v_permlane16_swap_b32 v150, v151
    buffer_store_dwordx4 v[148:151], v2, s[40:43], s38 offen sc1
    v_cvt_pk_bf16_f32 v152, v76, v92
    v_cvt_pk_bf16_f32 v153, v77, v93
    v_cvt_pk_bf16_f32 v154, v108, v124
    v_cvt_pk_bf16_f32 v155, v109, v125
    s_add_u32 s38, s48, 786432
    v_permlane16_swap_b32 v152, v153
    v_permlane16_swap_b32 v154, v155
    buffer_store_dwordx4 v[152:155], v2, s[40:43], s38 offen sc1
    v_cvt_pk_bf16_f32 v156, v78, v94
    v_cvt_pk_bf16_f32 v157, v79, v95
    v_cvt_pk_bf16_f32 v158, v110, v126
    v_cvt_pk_bf16_f32 v159, v111, v127
    s_add_u32 s38, s48, 851968
    v_permlane16_swap_b32 v156, v157
    v_permlane16_swap_b32 v158, v159
    buffer_store_dwordx4 v[156:159], v2, s[40:43], s38 offen sc1

    v_mov_b32 v12, v13
    v_mov_b32 v13, v14
    v_lshlrev_b32 v4, 3, v9
    s_lshl_b32 s38, s33, 8
    s_add_u32 s49, s54, s38
    s_add_u32 s49, s49, 327680
    v_lshlrev_b32 v5, 10, v9
    s_lshl_b32 s50, s34, 15
    s_add_u32 s50, s50, s38
    s_lshl_b32 s39, s35, 3
    s_add_u32 s50, s50, s39
    s_add_u32 s50, s50, 327680
    v_lshrrev_b32 v6, 4, v1
    v_lshlrev_b32 v7, 13, v6
    v_lshl_add_u32 v7, v3, 4, v7
    s_lshl_b32 s51, s54, 5
    s_add_u32 s51, s51, s38
    s_add_u32 s51, s51, 2097152
    s_add_u32 s52, s51, 4096

    v_and_b32 v16, 1, v1
    v_lshlrev_b32 v16, 4, v16
    s_mov_b32 s38, 0xffff
    v_lshlrev_b32 v16, v16, s38
    v_bfe_u32 v17, v1, 1, 2
    v_cmp_eq_u32 vcc, 0, v17
    s_nop 1
    v_cndmask_b32 v20, 0, v16, vcc
    v_cmp_eq_u32 vcc, 1, v17
    s_nop 1
    v_cndmask_b32 v21, 0, v16, vcc
    v_cmp_eq_u32 vcc, 2, v17
    s_nop 1
    v_cndmask_b32 v22, 0, v16, vcc
    v_cmp_eq_u32 vcc, 3, v17
    s_nop 1
    v_cndmask_b32 v23, 0, v16, vcc

    s_lshl_b32 s38, s33, 8
    s_add_u32 s38, s38, 139776
    v_lshl_add_u32 v24, v1, 2, s38
    v_bfe_u32 v16, v1, 3, 1
    v_lshlrev_b32 v16, 7, v16
    v_lshl_add_u32 v16, v6, 5, v16
    v_add_u32 v25, s38, v16
    v_bfe_u32 v16, v1, 4, 1
    v_lshlrev_b32 v16, 4, v16
    v_lshl_add_u32 v16, v3, 5, v16
    v_lshl_add_u32 v16, v10, 3, v16
    s_lshr_b32 s38, s34, 1
    s_lshl_b32 s38, s38, 7
    s_and_b32 s39, s34, 1
    s_lshl_b32 s39, s39, 4
    s_or_b32 s38, s38, s39
    v_xor_b32 v16, s38, v16
    s_lshl_b32 s38, s33, 10
    s_add_u32 s38, s38, 140800
    v_add_u32 v26, s38, v16
    s_lshl_b32 s38, s33, 2
    v_add_u32 v27, s38, v0
    s_waitcnt vmcnt(0)
    s_mov_b32 exec_hi, 0
    buffer_store_dwordx2 v[12:13], v4, s[40:43], s49 offen sc1
    s_mov_b64 exec, -1

    s_mov_b32 s44, s22
    s_mov_b32 s45, s23
    s_mov_b32 s46, 8192
    s_mov_b32 s47, 0x20000
    s_cmp_lt_u32 s35, 28
    s_cbranch_scc1 L_A_st
    v_and_b32 v16, 7, v1
    v_lshlrev_b32 v16, 10, v16
    v_bfe_u32 v17, v1, 3, 1
    v_lshl_add_u32 v16, v17, 7, v16
    v_lshrrev_b32 v17, 4, v1
    v_lshl_add_u32 v16, v17, 4, v16
    s_lshl_b32 s38, s33, 8
    buffer_load_dwordx4 v[128:131], v16, s[44:47], s38 offen
    buffer_load_dwordx4 v[132:135], v16, s[44:47], s38 offen offset:64
L_A_st:
    buffer_load_dwordx2 v[12:13], v5, s[40:43], s50 offen sc1
    s_sub_u32 s3, s3, 1
    s_cbranch_scc1 L_end
    s_waitcnt vmcnt(0)
    v_cmp_eq_u32 vcc, -1, v13
    s_cbranch_vccnz L_A_st
    buffer_load_dwordx4 v[32:35], v7, s[40:43], s51 offen offset:0 sc1
    buffer_load_dwordx4 v[36:39], v7, s[40:43], s51 offen offset:1024 sc1
    buffer_load_dwordx4 v[40:43], v7, s[40:43], s51 offen offset:2048 sc1
    buffer_load_dwordx4 v[44:47], v7, s[40:43], s51 offen offset:3072 sc1
    buffer_load_dwordx4 v[48:51], v7, s[40:43], s52 offen offset:0 sc1
    buffer_load_dwordx4 v[52:55], v7, s[40:43], s52 offen offset:1024 sc1
    buffer_load_dwordx4 v[56:59], v7, s[40:43], s52 offen offset:2048 sc1
    buffer_load_dwordx4 v[60:63], v7, s[40:43], s52 offen offset:3072 sc1
    v_mov_b32 v14, v12
    s_nop 1
    v_max_f32_dpp v14, v14, v14 quad_perm:[1,0,3,2] row_mask:0xf bank_mask:0xf
    s_nop 1
    v_max_f32_dpp v14, v14, v14 quad_perm:[2,3,0,1] row_mask:0xf bank_mask:0xf
    s_nop 1
    v_max_f32_dpp v14, v14, v14 row_half_mirror row_mask:0xf bank_mask:0xf
    s_nop 1
    v_max_f32_dpp v14, v14, v14 row_mirror row_mask:0xf bank_mask:0xf
    v_mov_b32 v15, v14
    s_nop 1
    v_permlane16_swap_b32 v14, v15
    v_max_f32 v14, v14, v15
    v_sub_f32 v12, v12, v14
    v_exp_f32 v12, v12
    s_nop 0
    v_mul_f32 v14, v12, v13
    s_nop 1
    v_add_f32_dpp v14, v14, v14 quad_perm:[1,0,3,2] row_mask:0xf bank_mask:0xf
    s_nop 1
    v_add_f32_dpp v14, v14, v14 quad_perm:[2,3,0,1] row_mask:0xf bank_mask:0xf
    s_nop 1
    v_add_f32_dpp v14, v14, v14 row_half_mirror row_mask:0xf bank_mask:0xf
    s_nop 1
    v_add_f32_dpp v14, v14, v14 row_mirror row_mask:0xf bank_mask:0xf
    v_mov_b32 v15, v14
    s_nop 1
    v_permlane16_swap_b32 v14, v15
    v_add_f32 v14, v14, v15
    v_rcp_f32 v14, v14
    v_cmp_gt_u32 vcc, 32, v1
    v_mul_f32 v12, v12, v14
    v_cvt_pk_bf16_f32 v13, v12, v12
    v_and_b32 v14, 0xffff0000, v13
    v_sub_f32 v12, v12, v14
    v_cvt_pk_bf16_f32 v12, v12, v12
    v_cndmask_b32 v12, v12, v13, vcc
    ds_write_b32 v24, v12
    ds_read_b128 v[12:15], v25
    ds_read_b128 v[16:19], v25 offset:16
    s_waitcnt lgkmcnt(0)
    v_and_b32 v64, v12, v20
    v_and_b32 v65, v12, v21
    v_and_b32 v66, v12, v22
    v_and_b32 v67, v12, v23
    v_and_b32 v68, v13, v20
    v_and_b32 v69, v13, v21
    v_and_b32 v70, v13, v22
    v_and_b32 v71, v13, v23
    v_and_b32 v72, v14, v20
    v_and_b32 v73, v14, v21
    v_and_b32 v74, v14, v22
    v_and_b32 v75, v14, v23
    v_and_b32 v76, v15, v20
    v_and_b32 v77, v15, v21
    v_and_b32 v78, v15, v22
    v_and_b32 v79, v15, v23
    v_and_b32 v80, v16, v20
    v_and_b32 v81, v16, v21
    v_and_b32 v82, v16, v22
    v_and_b32 v83, v16, v23
    v_and_b32 v84, v17, v20
    v_and_b32 v85, v17, v21
    v_and_b32 v86, v17, v22
    v_and_b32 v87, v17, v23
    v_and_b32 v88, v18, v20
    v_and_b32 v89, v18, v21
    v_and_b32 v90, v18, v22
    v_and_b32 v91, v18, v23
    v_and_b32 v92, v19, v20
    v_and_b32 v93, v19, v21
    v_and_b32 v94, v19, v22
    v_and_b32 v95, v19, v23
    s_waitcnt vmcnt(7)
    v_mfma_f32_16x16x32_bf16 v[28:31], v[64:67], v[32:35], 0
    s_waitcnt vmcnt(6)
    v_mfma_f32_16x16x32_bf16 v[28:31], v[68:71], v[36:39], v[28:31]
    s_waitcnt vmcnt(5)
    v_mfma_f32_16x16x32_bf16 v[28:31], v[72:75], v[40:43], v[28:31]
    s_waitcnt vmcnt(4)
    v_mfma_f32_16x16x32_bf16 v[28:31], v[76:79], v[44:47], v[28:31]
    s_waitcnt vmcnt(3)
    v_mfma_f32_16x16x32_bf16 v[28:31], v[80:83], v[48:51], v[28:31]
    s_waitcnt vmcnt(2)
    v_mfma_f32_16x16x32_bf16 v[28:31], v[84:87], v[52:55], v[28:31]
    s_waitcnt vmcnt(1)
    v_mfma_f32_16x16x32_bf16 v[28:31], v[88:91], v[56:59], v[28:31]
    s_waitcnt vmcnt(0)
    v_mfma_f32_16x16x32_bf16 v[28:31], v[92:95], v[60:63], v[28:31]
    v_mov_b32 v16, 1
    s_nop 6
    v_permlane32_swap_b32 v28, v30
    v_permlane32_swap_b32 v29, v31
    v_add_f32 v28, v28, v30
    v_add_f32 v29, v29, v31
    v_cvt_pk_bf16_f32 v12, v28, 0
    v_cvt_pk_bf16_f32 v13, v29, 0
    v_cvt_pk_bf16_f32 v14, 0, v28
    v_cvt_pk_bf16_f32 v15, 0, v29
    ds_write2_b64 v26, v[12:13], v[14:15] offset0:0 offset1:64
    ds_write_b32 v27, v16 offset:2016

    s_mov_b32 s38, 0x3f803f80
    v_and_b32 v20, s38, v20
    v_and_b32 v21, s38, v21
    v_and_b32 v22, s38, v22
    v_and_b32 v23, s38, v23
    v_bfe_u32 v12, v1, 2, 2
    v_lshl_add_u32 v13, v6, 3, v12
    v_lshrrev_b32 v14, 1, v12
    v_and_b32 v15, 1, v6
    v_lshl_or_b32 v14, v15, 1, v14
    v_lshlrev_b32 v14, 5, v14
    v_lshl_add_u32 v14, v13, 7, v14
    v_and_b32 v16, 3, v1
    v_lshl_add_u32 v14, v16, 3, v14
    s_lshl_b32 s38, s33, 14
    v_add_u32 v24, s38, v14
    v_xor_b32 v25, 32, v24
    v_xor_b32 v26, 64, v24
    v_xor_b32 v27, 0x60, v24
    v_lshl_or_b32 v14, v15, 2, v12
    v_lshlrev_b32 v14, 5, v14
    v_lshl_add_u32 v14, v13, 10, v14
    v_lshl_add_u32 v14, v16, 3, v14
    s_lshl_b32 s38, s33, 8
    s_add_u32 s38, s38, 65536
    v_add_u32 v2, s38, v14

    s_cmp_lt_u32 s35, 28
    s_cbranch_scc1 L_A_w1
    s_mov_b32 s38, 0xbfb8aa3b
    v_lshlrev_b32 v12, 16, v128
    v_and_b32 v13, 0xffff0000, v128
    v_mul_f32 v14, s38, v12
    v_mul_f32 v15, s38, v13
    v_exp_f32 v14, v14
    v_exp_f32 v15, v15
    v_add_f32 v14, 1.0, v14
    v_add_f32 v15, 1.0, v15
    v_rcp_f32 v14, v14
    v_rcp_f32 v15, v15
    v_mul_f32 v12, v12, v14
    v_mul_f32 v13, v13, v15
    v_cvt_pk_bf16_f32 v128, v12, v13
    v_lshlrev_b32 v12, 16, v129
    v_and_b32 v13, 0xffff0000, v129
    v_mul_f32 v14, s38, v12
    v_mul_f32 v15, s38, v13
    v_exp_f32 v14, v14
    v_exp_f32 v15, v15
    v_add_f32 v14, 1.0, v14
    v_add_f32 v15, 1.0, v15
    v_rcp_f32 v14, v14
    v_rcp_f32 v15, v15
    v_mul_f32 v12, v12, v14
    v_mul_f32 v13, v13, v15
    v_cvt_pk_bf16_f32 v129, v12, v13
    v_lshlrev_b32 v12, 16, v130
    v_and_b32 v13, 0xffff0000, v130
    v_mul_f32 v14, s38, v12
    v_mul_f32 v15, s38, v13
    v_exp_f32 v14, v14
    v_exp_f32 v15, v15
    v_add_f32 v14, 1.0, v14
    v_add_f32 v15, 1.0, v15
    v_rcp_f32 v14, v14
    v_rcp_f32 v15, v15
    v_mul_f32 v12, v12, v14
    v_mul_f32 v13, v13, v15
    v_cvt_pk_bf16_f32 v130, v12, v13
    v_lshlrev_b32 v12, 16, v131
    v_and_b32 v13, 0xffff0000, v131
    v_mul_f32 v14, s38, v12
    v_mul_f32 v15, s38, v13
    v_exp_f32 v14, v14
    v_exp_f32 v15, v15
    v_add_f32 v14, 1.0, v14
    v_add_f32 v15, 1.0, v15
    v_rcp_f32 v14, v14
    v_rcp_f32 v15, v15
    v_mul_f32 v12, v12, v14
    v_mul_f32 v13, v13, v15
    v_cvt_pk_bf16_f32 v131, v12, v13
    v_lshlrev_b32 v12, 16, v132
    v_and_b32 v13, 0xffff0000, v132
    v_mul_f32 v14, s38, v12
    v_mul_f32 v15, s38, v13
    v_exp_f32 v14, v14
    v_exp_f32 v15, v15
    v_add_f32 v14, 1.0, v14
    v_add_f32 v15, 1.0, v15
    v_rcp_f32 v14, v14
    v_rcp_f32 v15, v15
    v_mul_f32 v12, v12, v14
    v_mul_f32 v13, v13, v15
    v_cvt_pk_bf16_f32 v132, v12, v13
    v_lshlrev_b32 v12, 16, v133
    v_and_b32 v13, 0xffff0000, v133
    v_mul_f32 v14, s38, v12
    v_mul_f32 v15, s38, v13
    v_exp_f32 v14, v14
    v_exp_f32 v15, v15
    v_add_f32 v14, 1.0, v14
    v_add_f32 v15, 1.0, v15
    v_rcp_f32 v14, v14
    v_rcp_f32 v15, v15
    v_mul_f32 v12, v12, v14
    v_mul_f32 v13, v13, v15
    v_cvt_pk_bf16_f32 v133, v12, v13
    v_lshlrev_b32 v12, 16, v134
    v_and_b32 v13, 0xffff0000, v134
    v_mul_f32 v14, s38, v12
    v_mul_f32 v15, s38, v13
    v_exp_f32 v14, v14
    v_exp_f32 v15, v15
    v_add_f32 v14, 1.0, v14
    v_add_f32 v15, 1.0, v15
    v_rcp_f32 v14, v14
    v_rcp_f32 v15, v15
    v_mul_f32 v12, v12, v14
    v_mul_f32 v13, v13, v15
    v_cvt_pk_bf16_f32 v134, v12, v13
    v_lshlrev_b32 v12, 16, v135
    v_and_b32 v13, 0xffff0000, v135
    v_mul_f32 v14, s38, v12
    v_mul_f32 v15, s38, v13
    v_exp_f32 v14, v14
    v_exp_f32 v15, v15
    v_add_f32 v14, 1.0, v14
    v_add_f32 v15, 1.0, v15
    v_rcp_f32 v14, v14
    v_rcp_f32 v15, v15
    v_mul_f32 v12, v12, v14
    v_mul_f32 v13, v13, v15
    v_cvt_pk_bf16_f32 v135, v12, v13
    v_mov_b32_dpp v136, v128 row_ror:8 row_mask:0xf bank_mask:0xf
    v_mov_b32_dpp v137, v129 row_ror:8 row_mask:0xf bank_mask:0xf
    v_mov_b32_dpp v138, v130 row_ror:8 row_mask:0xf bank_mask:0xf
    v_mov_b32_dpp v139, v131 row_ror:8 row_mask:0xf bank_mask:0xf
    v_mov_b32_dpp v140, v132 row_ror:8 row_mask:0xf bank_mask:0xf
    v_mov_b32_dpp v141, v133 row_ror:8 row_mask:0xf bank_mask:0xf
    v_mov_b32_dpp v142, v134 row_ror:8 row_mask:0xf bank_mask:0xf
    v_mov_b32_dpp v143, v135 row_ror:8 row_mask:0xf bank_mask:0xf
L_A_w1:
L_w5:
    s_sleep 1
    ds_read_b32 v12, v0 offset:3032
    s_sub_u32 s3, s3, 1
    s_cbranch_scc1 L_end
    s_waitcnt lgkmcnt(0)
    v_cmp_gt_u32 vcc, 8, v12
    s_cbranch_vccnz L_w5
    ds_read_b64_tr_b16 v[64:65], v24 offset:0
    ds_read_b64_tr_b16 v[66:67], v24 offset:512
    ds_read_b64_tr_b16 v[68:69], v25 offset:0
    ds_read_b64_tr_b16 v[70:71], v25 offset:512
    ds_read_b64_tr_b16 v[72:73], v26 offset:0
    ds_read_b64_tr_b16 v[74:75], v26 offset:512
    ds_read_b64_tr_b16 v[76:77], v27 offset:0
    ds_read_b64_tr_b16 v[78:79], v27 offset:512
    s_waitcnt lgkmcnt(0)
    ds_read_b64_tr_b16 v[80:81], v24 offset:4096
    ds_read_b64_tr_b16 v[82:83], v24 offset:4608
    ds_read_b64_tr_b16 v[84:85], v25 offset:4096
    ds_read_b64_tr_b16 v[86:87], v25 offset:4608
    ds_read_b64_tr_b16 v[88:89], v26 offset:4096
    ds_read_b64_tr_b16 v[90:91], v26 offset:4608
    ds_read_b64_tr_b16 v[92:93], v27 offset:4096
    ds_read_b64_tr_b16 v[94:95], v27 offset:4608
    s_waitcnt lgkmcnt(0)
    ds_read_b64_tr_b16 v[96:97], v24 offset:8192
    ds_read_b64_tr_b16 v[98:99], v24 offset:8704
    ds_read_b64_tr_b16 v[100:101], v25 offset:8192
    ds_read_b64_tr_b16 v[102:103], v25 offset:8704
    ds_read_b64_tr_b16 v[104:105], v26 offset:8192
    ds_read_b64_tr_b16 v[106:107], v26 offset:8704
    ds_read_b64_tr_b16 v[108:109], v27 offset:8192
    ds_read_b64_tr_b16 v[110:111], v27 offset:8704
    s_waitcnt lgkmcnt(0)
    ds_read_b64_tr_b16 v[112:113], v24 offset:12288
    ds_read_b64_tr_b16 v[114:115], v24 offset:12800
    ds_read_b64_tr_b16 v[116:117], v25 offset:12288
    ds_read_b64_tr_b16 v[118:119], v25 offset:12800
    ds_read_b64_tr_b16 v[120:121], v26 offset:12288
    ds_read_b64_tr_b16 v[122:123], v26 offset:12800
    ds_read_b64_tr_b16 v[124:125], v27 offset:12288
    ds_read_b64_tr_b16 v[126:127], v27 offset:12800
    s_waitcnt lgkmcnt(0)
    s_cmp_lt_u32 s35, 28
    s_cbranch_scc1 L_A_F
    v_mfma_f32_16x16x32_bf16 v[32:35], v[64:67], v[128:131], 0
    v_mfma_f32_16x16x32_bf16 v[36:39], v[68:71], v[128:131], 0
    v_mfma_f32_16x16x32_bf16 v[40:43], v[72:75], v[128:131], 0
    v_mfma_f32_16x16x32_bf16 v[44:47], v[76:79], v[128:131], 0
    v_mfma_f32_16x16x32_bf16 v[32:35], v[80:83], v[132:135], v[32:35]
    v_mfma_f32_16x16x32_bf16 v[36:39], v[84:87], v[132:135], v[36:39]
    v_mfma_f32_16x16x32_bf16 v[40:43], v[88:91], v[132:135], v[40:43]
    v_mfma_f32_16x16x32_bf16 v[44:47], v[92:95], v[132:135], v[44:47]
    v_mfma_f32_16x16x32_bf16 v[32:35], v[96:99], v[136:139], v[32:35]
    v_mfma_f32_16x16x32_bf16 v[36:39], v[100:103], v[136:139], v[36:39]
    v_mfma_f32_16x16x32_bf16 v[40:43], v[104:107], v[136:139], v[40:43]
    v_mfma_f32_16x16x32_bf16 v[44:47], v[108:111], v[136:139], v[44:47]
    v_mfma_f32_16x16x32_bf16 v[32:35], v[112:115], v[140:143], v[32:35]
    v_mfma_f32_16x16x32_bf16 v[36:39], v[116:119], v[140:143], v[36:39]
    v_mfma_f32_16x16x32_bf16 v[40:43], v[120:123], v[140:143], v[40:43]
    v_mfma_f32_16x16x32_bf16 v[44:47], v[124:127], v[140:143], v[44:47]
    s_lshl_b32 s38, s33, 12
    s_add_u32 s38, s38, 65536
    v_lshl_add_u32 v12, v1, 4, s38
    s_nop 1
    ds_write_b128 v12, v[32:35] offset:0
    ds_write_b128 v12, v[36:39] offset:1024
    ds_write_b128 v12, v[40:43] offset:2048
    ds_write_b128 v12, v[44:47] offset:3072
    v_mov_b32 v13, 1
    s_mov_b64 exec, 1
    ds_add_u32 v0, v13 offset:4032
    s_mov_b64 exec, -1
    s_sub_u32 s38, s35, 28
    s_cmp_lg_u32 s38, s33
    s_cbranch_scc1 L_end
    v_and_b32 v12, 0x37, v1
    v_lshlrev_b32 v12, 4, v12
    v_bfe_u32 v13, v1, 3, 1
    v_lshl_add_u32 v12, v13, 11, v12
    v_add_u32 v12, 65536, v12
    v_and_b32 v14, 7, v1
    v_lshlrev_b32 v14, 10, v14
    v_lshl_add_u32 v14, v13, 6, v14
    v_lshl_add_u32 v14, v6, 4, v14
    s_lshl_b32 s38, s33, 13
    s_lshl_b32 s39, s34, 7
    s_add_u32 s38, s38, s39
    s_add_u32 s38, s38, 8192
L_w6:
    ds_read_b32 v13, v0 offset:4032
    s_sub_u32 s3, s3, 1
    s_cbranch_scc1 L_end
    s_waitcnt lgkmcnt(0)
    v_cmp_gt_u32 vcc, 4, v13
    s_cbranch_vccnz L_w6
    ds_read_b128 v[32:35], v12 offset:0
    ds_read_b128 v[36:39], v12 offset:1024
    ds_read_b128 v[40:43], v12 offset:4096
    ds_read_b128 v[44:47], v12 offset:5120
    ds_read_b128 v[48:51], v12 offset:8192
    ds_read_b128 v[52:55], v12 offset:9216
    ds_read_b128 v[56:59], v12 offset:12288
    ds_read_b128 v[60:63], v12 offset:13312
    s_waitcnt lgkmcnt(0)
    v_add_f32 v32, v32, v40
    v_add_f32 v48, v48, v56
    v_add_f32 v33, v33, v41
    v_add_f32 v49, v49, v57
    v_add_f32 v34, v34, v42
    v_add_f32 v50, v50, v58
    v_add_f32 v35, v35, v43
    v_add_f32 v51, v51, v59
    v_add_f32 v36, v36, v44
    v_add_f32 v52, v52, v60
    v_add_f32 v37, v37, v45
    v_add_f32 v53, v53, v61
    v_add_f32 v38, v38, v46
    v_add_f32 v54, v54, v62
    v_add_f32 v39, v39, v47
    v_add_f32 v55, v55, v63
    v_add_f32 v32, v32, v48
    v_add_f32 v33, v33, v49
    v_add_f32 v34, v34, v50
    v_add_f32 v35, v35, v51
    v_add_f32 v36, v36, v52
    v_add_f32 v37, v37, v53
    v_add_f32 v38, v38, v54
    v_add_f32 v39, v39, v55
    v_cvt_pk_bf16_f32 v32, v32, v33
    v_cvt_pk_bf16_f32 v33, v34, v35
    v_cvt_pk_bf16_f32 v34, v36, v37
    v_cvt_pk_bf16_f32 v35, v38, v39
    buffer_store_dwordx4 v[32:35], v14, s[40:43], s38 offen sc1
L_A_F:
    s_mov_b32 s44, s4
    s_mov_b32 s45, s5
    s_mov_b32 s46, 8192
    s_mov_b32 s47, 0x20000

    v_and_b32 v12, 1, v6
    v_lshlrev_b32 v13, 3, v12
    v_lshl_add_u32 v13, v3, 4, v13
    s_lshl_b32 s38, s34, 10
    s_lshl_b32 s39, s33, 8
    s_add_u32 s48, s38, s39
    buffer_load_dwordx2 v[128:129], v13, s[44:47], s48 offen
    v_and_b32 v14, 12, v3
    v_lshlrev_b32 v14, 4, v14
    v_and_b32 v15, 1, v3
    v_lshl_add_u32 v14, v15, 5, v14
    v_lshl_add_u32 v14, v12, 4, v14
    v_bfe_u32 v15, v3, 1, 1
    v_lshl_add_u32 v14, v15, 3, v14
    s_add_u32 s49, s48, 8192
    s_add_u32 s50, s49, 8192
    s_add_u32 s51, s49, 16384
    s_add_u32 s52, s49, 24576
L_A_md:
    buffer_load_dwordx2 v[130:131], v14, s[40:43], s49 offen sc1
    buffer_load_dwordx2 v[132:133], v14, s[40:43], s50 offen sc1
    buffer_load_dwordx2 v[134:135], v14, s[40:43], s51 offen sc1
    buffer_load_dwordx2 v[136:137], v14, s[40:43], s52 offen sc1
    s_sub_u32 s3, s3, 1
    s_cbranch_scc1 L_end
    s_waitcnt vmcnt(0)
    v_max3_u32 v15, v130, v131, v132
    v_max3_u32 v15, v15, v133, v134
    v_max3_u32 v15, v15, v135, v136
    v_max_u32 v15, v15, v137
    v_cmp_eq_u32 vcc, -1, v15
    s_cbranch_vccnz L_A_md
    v_lshlrev_b32 v140, 16, v128
    v_and_b32 v141, 0xffff0000, v128
    v_lshlrev_b32 v142, 16, v129
    v_and_b32 v143, 0xffff0000, v129
    v_lshlrev_b32 v144, 16, v130
    v_and_b32 v145, 0xffff0000, v130
    v_lshlrev_b32 v146, 16, v131
    v_and_b32 v147, 0xffff0000, v131
    v_lshlrev_b32 v148, 16, v132
    v_and_b32 v149, 0xffff0000, v132
    v_lshlrev_b32 v150, 16, v133
    v_and_b32 v151, 0xffff0000, v133
    v_lshlrev_b32 v152, 16, v134
    v_and_b32 v153, 0xffff0000, v134
    v_lshlrev_b32 v154, 16, v135
    v_and_b32 v155, 0xffff0000, v135
    v_lshlrev_b32 v156, 16, v136
    v_and_b32 v157, 0xffff0000, v136
    v_lshlrev_b32 v158, 16, v137
    v_and_b32 v159, 0xffff0000, v137
    v_add_f32 v152, 1.0, v152
    v_add_f32 v153, 1.0, v153
    v_add_f32 v154, 1.0, v154
    v_add_f32 v155, 1.0, v155

    s_lshl_b32 s51, s34, 15
    s_add_u32 s51, s51, s39
    s_add_u32 s53, s51, 851968
    s_add_u32 s51, s51, 589824
    s_add_u32 s52, s51, 4096
    s_add_u32 s38, s39, 146944
    v_add_u32 v24, s38, v13
    v_lshl_add_u32 v25, v6, 4, s38
    v_mul_u32_u24 v26, 1008, v10
    s_lshl_b32 s38, s33, 2
    v_add3_u32 v26, v26, v0, s38
    s_add_u32 s38, s39, 147968
    v_lshl_add_u32 v27, v6, 4, s38
    v_and_b32 v12, 3, v1
    v_lshlrev_b32 v12, 8, v12
    v_bfe_u32 v15, v1, 3, 1
    v_lshl_add_u32 v12, v15, 7, v12
    v_bfe_u32 v15, v1, 2, 1
    v_lshl_add_u32 v12, v15, 4, v12
    v_lshl_add_u32 v12, v6, 5, v12
    v_add_u32 v4, 147968, v12
    v_lshlrev_b32 v5, 4, v3

L_w7:
    ds_read_b32 v12, v0 offset:3028
    s_sub_u32 s3, s3, 1
    s_cbranch_scc1 L_end
    s_waitcnt lgkmcnt(0)
    v_cmp_gt_u32 vcc, 4, v12
    s_cbranch_vccnz L_w7
L_A_h4:
    buffer_load_dwordx4 v[32:35], v7, s[40:43], s51 offen offset:0 sc1
    buffer_load_dwordx4 v[36:39], v7, s[40:43], s51 offen offset:1024 sc1
    buffer_load_dwordx4 v[40:43], v7, s[40:43], s51 offen offset:2048 sc1
    buffer_load_dwordx4 v[44:47], v7, s[40:43], s51 offen offset:3072 sc1
    buffer_load_dwordx4 v[48:51], v7, s[40:43], s52 offen offset:0 sc1
    buffer_load_dwordx4 v[52:55], v7, s[40:43], s52 offen offset:1024 sc1
    buffer_load_dwordx4 v[56:59], v7, s[40:43], s52 offen offset:2048 sc1
    buffer_load_dwordx4 v[60:63], v7, s[40:43], s52 offen offset:3072 sc1
    s_sub_u32 s3, s3, 1
    s_cbranch_scc1 L_end
    s_waitcnt vmcnt(7)
    v_mfma_f32_16x16x32_bf16 v[28:31], v[20:23], v[32:35], 0
    v_max3_u32 v12, v32, v33, v34
    v_max_u32 v12, v12, v35
    s_waitcnt vmcnt(6)
    v_mfma_f32_16x16x32_bf16 v[28:31], v[20:23], v[36:39], v[28:31]
    v_max3_u32 v12, v12, v36, v37
    v_max3_u32 v12, v12, v38, v39
    s_waitcnt vmcnt(5)
    v_mfma_f32_16x16x32_bf16 v[28:31], v[20:23], v[40:43], v[28:31]
    v_max3_u32 v12, v12, v40, v41
    v_max3_u32 v12, v12, v42, v43
    s_waitcnt vmcnt(4)
    v_mfma_f32_16x16x32_bf16 v[28:31], v[20:23], v[44:47], v[28:31]
    v_max3_u32 v12, v12, v44, v45
    v_max3_u32 v12, v12, v46, v47
    s_waitcnt vmcnt(3)
    v_mfma_f32_16x16x32_bf16 v[28:31], v[20:23], v[48:51], v[28:31]
    v_max3_u32 v12, v12, v48, v49
    v_max3_u32 v12, v12, v50, v51
    s_waitcnt vmcnt(2)
    v_mfma_f32_16x16x32_bf16 v[28:31], v[20:23], v[52:55], v[28:31]
    v_max3_u32 v12, v12, v52, v53
    v_max3_u32 v12, v12, v54, v55
    s_waitcnt vmcnt(1)
    v_mfma_f32_16x16x32_bf16 v[28:31], v[20:23], v[56:59], v[28:31]
    v_max3_u32 v12, v12, v56, v57
    v_max3_u32 v12, v12, v58, v59
    s_waitcnt vmcnt(0)
    v_mfma_f32_16x16x32_bf16 v[28:31], v[20:23], v[60:63], v[28:31]
    v_max3_u32 v12, v12, v60, v61
    v_max3_u32 v12, v12, v62, v63
    v_cmp_eq_u32 vcc, -1, v12
    s_cbranch_vccnz L_A_h4
    s_nop 3
    v_fma_f32 v28, v28, v144, v140
    v_fma_f32 v29, v29, v145, v141
    v_fma_f32 v30, v30, v146, v142
    v_fma_f32 v31, v31, v147, v143
    s_cmp_ge_u32 s35, 28
    s_cbranch_scc1 L_A_fin

    v_add_f32 v12, v28, v29
    v_mul_f32 v13, v28, v28
    v_add_f32 v14, v30, v31
    v_fmac_f32 v13, v29, v29
    v_cmp_gt_u32 vcc, 32, v1
    v_fmac_f32 v13, v30, v30
    v_add_f32 v12, v12, v14
    v_fmac_f32 v13, v31, v31
    v_cndmask_b32 v12, v13, v12, vcc
    s_nop 1
    v_add_f32_dpp v12, v12, v12 quad_perm:[1,0,3,2] row_mask:0xf bank_mask:0xf
    s_nop 1
    v_add_f32_dpp v12, v12, v12 quad_perm:[2,3,0,1] row_mask:0xf bank_mask:0xf
    s_nop 1
    v_add_f32_dpp v12, v12, v12 row_half_mirror row_mask:0xf bank_mask:0xf
    s_nop 1
    v_add_f32_dpp v12, v12, v12 row_mirror row_mask:0xf bank_mask:0xf
    v_mov_b32 v13, v12
    s_nop 1
    v_permlane16_swap_b32 v12, v13
    v_add_f32 v12, v12, v13
    ds_write_b32 v26, v12 offset:5040
L_A_ln:
    ds_read_b128 v[12:15], v0 offset:5040
    ds_read_b128 v[16:19], v0 offset:6048
    s_sub_u32 s3, s3, 1
    s_cbranch_scc1 L_end
    s_waitcnt lgkmcnt(0)
    v_max3_u32 v32, v12, v13, v14
    v_max3_u32 v32, v32, v15, v16
    v_max3_u32 v32, v32, v17, v18
    v_max_u32 v32, v32, v19
    v_cmp_eq_u32 vcc, -1, v32
    s_cbranch_vccnz L_A_ln
    v_add_f32 v12, v12, v13
    v_add_f32 v16, v16, v17
    v_add_f32 v14, v14, v15
    v_add_f32 v18, v18, v19
    s_mov_b32 s38, 0x3b000000
    v_add_f32 v12, v12, v14
    v_add_f32 v16, v16, v18
    v_mul_f32 v12, s38, v12
    v_mul_f32 v16, s38, v16
    v_fma_f32 v16, -v12, v12, v16
    v_max_f32 v16, 0, v16
    v_add_f32 v16, 0x3727c5ac, v16
    v_rsq_f32 v16, v16
    v_sub_f32 v28, v28, v12
    v_sub_f32 v29, v29, v12
    v_sub_f32 v30, v30, v12
    v_sub_f32 v31, v31, v12
    v_mul_f32 v152, v152, v16
    v_mul_f32 v153, v153, v16
    v_mul_f32 v154, v154, v16
    v_mul_f32 v155, v155, v16
    v_fma_f32 v28, v28, v152, v148
    v_fma_f32 v29, v29, v153, v149
    v_fma_f32 v30, v30, v154, v150
    v_fma_f32 v31, v31, v155, v151
    v_cvt_pk_bf16_f32 v28, v28, v29
    v_cvt_pk_bf16_f32 v29, v30, v31
    ds_write_b64 v24, v[28:29]
    ds_read_b128 v[128:131], v25 offset:0
    ds_read_b128 v[132:135], v25 offset:64
    ds_read_b128 v[136:139], v25 offset:128
    ds_read_b128 v[140:143], v25 offset:192
    v_xor_b32 v13, 32, v2
    v_xor_b32 v14, 64, v2
    v_xor_b32 v15, 96, v2
    v_xor_b32 v16, 128, v2
    v_xor_b32 v17, 160, v2
    v_xor_b32 v18, 192, v2
    v_xor_b32 v19, 224, v2
    s_waitcnt lgkmcnt(3)
    v_mfma_f32_16x16x32_bf16 v[32:35], v[64:67], v[128:131], 0
    v_mfma_f32_16x16x32_bf16 v[36:39], v[68:71], v[128:131], 0
    v_mfma_f32_16x16x32_bf16 v[40:43], v[72:75], v[128:131], 0
    v_mfma_f32_16x16x32_bf16 v[44:47], v[76:79], v[128:131], 0
    s_waitcnt lgkmcnt(2)
    v_mfma_f32_16x16x32_bf16 v[32:35], v[80:83], v[132:135], v[32:35]
    v_mfma_f32_16x16x32_bf16 v[36:39], v[84:87], v[132:135], v[36:39]
    v_mfma_f32_16x16x32_bf16 v[40:43], v[88:91], v[132:135], v[40:43]
    v_mfma_f32_16x16x32_bf16 v[44:47], v[92:95], v[132:135], v[44:47]
    s_waitcnt lgkmcnt(1)
    v_mfma_f32_16x16x32_bf16 v[32:35], v[96:99], v[136:139], v[32:35]
    v_mfma_f32_16x16x32_bf16 v[36:39], v[100:103], v[136:139], v[36:39]
    v_mfma_f32_16x16x32_bf16 v[40:43], v[104:107], v[136:139], v[40:43]
    v_mfma_f32_16x16x32_bf16 v[44:47], v[108:111], v[136:139], v[44:47]
    s_waitcnt lgkmcnt(0)
    v_mfma_f32_16x16x32_bf16 v[32:35], v[112:115], v[140:143], v[32:35]
    v_mfma_f32_16x16x32_bf16 v[36:39], v[116:119], v[140:143], v[36:39]
    v_mfma_f32_16x16x32_bf16 v[40:43], v[120:123], v[140:143], v[40:43]
    v_mfma_f32_16x16x32_bf16 v[44:47], v[124:127], v[140:143], v[44:47]
    ds_read_b64_tr_b16 v[64:65], v2 offset:0
    ds_read_b64_tr_b16 v[66:67], v2 offset:4096
    ds_read_b64_tr_b16 v[68:69], v13 offset:0
    ds_read_b64_tr_b16 v[70:71], v13 offset:4096
    ds_read_b64_tr_b16 v[72:73], v14 offset:0
    ds_read_b64_tr_b16 v[74:75], v14 offset:4096
    ds_read_b64_tr_b16 v[76:77], v15 offset:0
    ds_read_b64_tr_b16 v[78:79], v15 offset:4096
    s_mov_b32 s38, 0x00010001
    s_mov_b32 s39, 0x00010001
    s_mov_b64 exec, s[38:39]
    ds_write_b128 v27, v[32:35] offset:0
    ds_write_b128 v27, v[36:39] offset:64
    ds_write_b128 v27, v[40:43] offset:128
    ds_write_b128 v27, v[44:47] offset:192
    s_mov_b64 exec, -1
    v_mov_b32 v12, 1
    s_mov_b64 exec, 1
    ds_add_u32 v0, v12 offset:4032
    s_mov_b64 exec, -1
    s_waitcnt lgkmcnt(6)
    ds_read_b64_tr_b16 v[80:81], v16 offset:0
    ds_read_b64_tr_b16 v[82:83], v16 offset:4096
    ds_read_b64_tr_b16 v[84:85], v17 offset:0
    ds_read_b64_tr_b16 v[86:87], v17 offset:4096
    ds_read_b64_tr_b16 v[88:89], v18 offset:0
    ds_read_b64_tr_b16 v[90:91], v18 offset:4096
    ds_read_b64_tr_b16 v[92:93], v19 offset:0
    ds_read_b64_tr_b16 v[94:95], v19 offset:4096
    s_waitcnt lgkmcnt(4)
    ds_read_b64_tr_b16 v[96:97], v2 offset:32768
    ds_read_b64_tr_b16 v[98:99], v2 offset:36864
    ds_read_b64_tr_b16 v[100:101], v13 offset:32768
    ds_read_b64_tr_b16 v[102:103], v13 offset:36864
    ds_read_b64_tr_b16 v[104:105], v14 offset:32768
    ds_read_b64_tr_b16 v[106:107], v14 offset:36864
    ds_read_b64_tr_b16 v[108:109], v15 offset:32768
    ds_read_b64_tr_b16 v[110:111], v15 offset:36864
    s_waitcnt lgkmcnt(4)
    ds_read_b64_tr_b16 v[112:113], v16 offset:32768
    ds_read_b64_tr_b16 v[114:115], v16 offset:36864
    ds_read_b64_tr_b16 v[116:117], v17 offset:32768
    ds_read_b64_tr_b16 v[118:119], v17 offset:36864
    ds_read_b64_tr_b16 v[120:121], v18 offset:32768
    ds_read_b64_tr_b16 v[122:123], v18 offset:36864
    ds_read_b64_tr_b16 v[124:125], v19 offset:32768
    ds_read_b64_tr_b16 v[126:127], v19 offset:36864
L_w8:
    ds_read_b32 v12, v0 offset:4032
    s_sub_u32 s3, s3, 1
    s_cbranch_scc1 L_end
    s_waitcnt lgkmcnt(0)
    v_cmp_gt_u32 vcc, 4, v12
    s_cbranch_vccnz L_w8
    ds_read_b128 v[28:31], v4
    s_waitcnt lgkmcnt(0)
    v_add_f32_dpp v28, v28, v28 quad_perm:[1,0,3,2] row_mask:0xf bank_mask:0xf
    v_add_f32_dpp v29, v29, v29 quad_perm:[1,0,3,2] row_mask:0xf bank_mask:0xf
    v_add_f32_dpp v30, v30, v30 quad_perm:[1,0,3,2] row_mask:0xf bank_mask:0xf
    v_add_f32_dpp v31, v31, v31 quad_perm:[1,0,3,2] row_mask:0xf bank_mask:0xf
    v_add_f32_dpp v28, v28, v28 quad_perm:[2,3,0,1] row_mask:0xf bank_mask:0xf
    v_add_f32_dpp v29, v29, v29 quad_perm:[2,3,0,1] row_mask:0xf bank_mask:0xf
    v_add_f32_dpp v30, v30, v30 quad_perm:[2,3,0,1] row_mask:0xf bank_mask:0xf
    v_add_f32_dpp v31, v31, v31 quad_perm:[2,3,0,1] row_mask:0xf bank_mask:0xf
    v_max_f32 v28, 0, v28
    v_max_f32 v29, 0, v29
    v_max_f32 v30, 0, v30
    v_max_f32 v31, 0, v31
    v_cvt_pk_bf16_f32 v28, v28, v29
    v_cvt_pk_bf16_f32 v29, v30, v31
    s_nop 0
    v_mov_b32_dpp v128, v28 row_newbcast:0 row_mask:0xf bank_mask:0xf
    v_mov_b32_dpp v129, v29 row_newbcast:0 row_mask:0xf bank_mask:0xf
    v_mov_b32_dpp v130, v28 row_newbcast:4 row_mask:0xf bank_mask:0xf
    v_mov_b32_dpp v131, v29 row_newbcast:4 row_mask:0xf bank_mask:0xf
    v_mov_b32_dpp v132, v28 row_newbcast:8 row_mask:0xf bank_mask:0xf
    v_mov_b32_dpp v133, v29 row_newbcast:8 row_mask:0xf bank_mask:0xf
    v_mov_b32_dpp v134, v28 row_newbcast:12 row_mask:0xf bank_mask:0xf
    v_mov_b32_dpp v135, v29 row_newbcast:12 row_mask:0xf bank_mask:0xf
    v_mfma_f32_16x16x32_bf16 v[32:35], v[128:131], v[64:67], 0
    v_mfma_f32_16x16x32_bf16 v[36:39], v[128:131], v[68:71], 0
    v_mfma_f32_16x16x32_bf16 v[40:43], v[128:131], v[72:75], 0
    v_mfma_f32_16x16x32_bf16 v[44:47], v[128:131], v[76:79], 0
    v_mfma_f32_16x16x32_bf16 v[48:51], v[128:131], v[80:83], 0
    v_mfma_f32_16x16x32_bf16 v[52:55], v[128:131], v[84:87], 0
    v_mfma_f32_16x16x32_bf16 v[56:59], v[128:131], v[88:91], 0
    v_mfma_f32_16x16x32_bf16 v[60:63], v[128:131], v[92:95], 0
    v_mfma_f32_16x16x32_bf16 v[32:35], v[132:135], v[96:99], v[32:35]
    v_mfma_f32_16x16x32_bf16 v[36:39], v[132:135], v[100:103], v[36:39]
    v_mfma_f32_16x16x32_bf16 v[40:43], v[132:135], v[104:107], v[40:43]
    v_mfma_f32_16x16x32_bf16 v[44:47], v[132:135], v[108:111], v[44:47]
    v_mfma_f32_16x16x32_bf16 v[48:51], v[132:135], v[112:115], v[48:51]
    v_mfma_f32_16x16x32_bf16 v[52:55], v[132:135], v[116:119], v[52:55]
    v_mfma_f32_16x16x32_bf16 v[56:59], v[132:135], v[120:123], v[56:59]
    v_mfma_f32_16x16x32_bf16 v[60:63], v[132:135], v[124:127], v[60:63]
    s_lshl_b32 s38, s35, 10
    s_add_u32 s38, s38, s53
    v_cvt_pk_bf16_f32 v28, v32, v36
    s_nop 0
    v_cvt_pk_bf16_f32 v29, v40, v44
    s_nop 0
    v_cvt_pk_bf16_f32 v30, v48, v52
    s_nop 0
    v_cvt_pk_bf16_f32 v31, v56, v60
    s_mov_b64 exec, 0xffff
    buffer_store_dwordx4 v[28:31], v5, s[40:43], s38 offen sc1
    s_branch L_end
L_A_fin:
    s_mov_b32 s44, s26
    s_mov_b32 s45, s27
    s_mov_b32 s46, 8192
    s_mov_b32 s47, 0x20000

    v_and_b32 v12, 7, v1
    v_lshlrev_b32 v13, 1, v12
    v_lshrrev_b32 v14, 1, v6
    v_add_u32 v13, v13, v14
    v_and_b32 v14, 1, v6
    v_lshl_add_u32 v13, v14, 4, v13
    v_lshlrev_b32 v13, 2, v13
    ds_bpermute_b32 v140, v13, v28
    ds_bpermute_b32 v144, v13, v156
    ds_bpermute_b32 v141, v13, v29
    ds_bpermute_b32 v145, v13, v157
    ds_bpermute_b32 v142, v13, v30
    ds_bpermute_b32 v146, v13, v158
    ds_bpermute_b32 v143, v13, v31
    ds_bpermute_b32 v147, v13, v159

    v_lshlrev_b32 v4, 5, v12
    v_lshl_add_u32 v4, v6, 3, v4
    v_mul_u32_u24 v7, 7168, v6
    v_lshl_add_u32 v7, v3, 4, v7
    s_add_u32 s52, s53, 4096
    s_waitcnt lgkmcnt(0)
L_A_h5:
    buffer_load_dwordx4 v[32:35], v7, s[40:43], s53 offen offset:0 sc1
    buffer_load_dwordx4 v[36:39], v7, s[40:43], s53 offen offset:1024 sc1
    buffer_load_dwordx4 v[40:43], v7, s[40:43], s53 offen offset:2048 sc1
    buffer_load_dwordx4 v[44:47], v7, s[40:43], s53 offen offset:3072 sc1
    buffer_load_dwordx4 v[48:51], v7, s[40:43], s52 offen offset:0 sc1
    buffer_load_dwordx4 v[52:55], v7, s[40:43], s52 offen offset:1024 sc1
    buffer_load_dwordx4 v[56:59], v7, s[40:43], s52 offen offset:2048 sc1
    s_sub_u32 s3, s3, 1
    s_cbranch_scc1 L_end
    s_waitcnt vmcnt(6)
    v_mfma_f32_16x16x32_bf16 v[28:31], v[32:35], v[20:23], 0
    v_max3_u32 v12, v32, v33, v34
    v_max_u32 v12, v12, v35
    s_waitcnt vmcnt(5)
    v_mfma_f32_16x16x32_bf16 v[28:31], v[36:39], v[20:23], v[28:31]
    v_max3_u32 v12, v12, v36, v37
    v_max3_u32 v12, v12, v38, v39
    s_waitcnt vmcnt(4)
    v_mfma_f32_16x16x32_bf16 v[28:31], v[40:43], v[20:23], v[28:31]
    v_max3_u32 v12, v12, v40, v41
    v_max3_u32 v12, v12, v42, v43
    s_waitcnt vmcnt(3)
    v_mfma_f32_16x16x32_bf16 v[28:31], v[44:47], v[20:23], v[28:31]
    v_max3_u32 v12, v12, v44, v45
    v_max3_u32 v12, v12, v46, v47
    s_waitcnt vmcnt(2)
    v_mfma_f32_16x16x32_bf16 v[28:31], v[48:51], v[20:23], v[28:31]
    v_max3_u32 v12, v12, v48, v49
    v_max3_u32 v12, v12, v50, v51
    s_waitcnt vmcnt(1)
    v_mfma_f32_16x16x32_bf16 v[28:31], v[52:55], v[20:23], v[28:31]
    v_max3_u32 v12, v12, v52, v53
    v_max3_u32 v12, v12, v54, v55
    s_waitcnt vmcnt(0)
    v_mfma_f32_16x16x32_bf16 v[28:31], v[56:59], v[20:23], v[28:31]
    v_max3_u32 v12, v12, v56, v57
    v_max3_u32 v12, v12, v58, v59
    v_cmp_eq_u32 vcc, -1, v12
    s_cbranch_vccnz L_A_h5
    s_nop 3
    v_fma_f32 v28, v28, v144, v140
    v_fma_f32 v29, v29, v145, v141
    v_fma_f32 v30, v30, v146, v142
    v_fma_f32 v31, v31, v147, v143
    v_cvt_pk_bf16_f32 v28, v28, v29
    v_cvt_pk_bf16_f32 v29, v30, v31
    s_mov_b32 s38, 0x00ff00ff
    s_mov_b32 s39, 0x00ff00ff
    s_mov_b64 exec, s[38:39]
    buffer_store_dwordx2 v[28:29], v4, s[44:47], s48 offen
    s_branch L_end
L_B:
    s_mov_b32 s44, s8
    s_mov_b32 s45, s9
    s_mov_b32 s46, 4194304
    s_mov_b32 s47, 0x20000

    v_lshrrev_b32 v4, 4, v1
    v_and_b32 v5, 15, v1
    v_lshlrev_b32 v2, 18, v4
    v_lshl_add_u32 v2, v5, 4, v2
    s_lshl_b32 s48, s33, 20
    s_lshl_b32 s38, s35, 8
    s_add_u32 s48, s48, s38
    s_and_b32 s49, s34, 3
    s_barrier

    s_xor_b32 s38, s49, 0
    s_lshl_b32 s38, s38, 16
    s_add_u32 s38, s38, s48
    buffer_load_dwordx4 v[40:43], v2, s[44:47], s38 offen nt
    s_add_u32 s38, s38, 8192
    buffer_load_dwordx4 v[44:47], v2, s[44:47], s38 offen nt
    s_add_u32 s38, s38, 8192
    buffer_load_dwordx4 v[48:51], v2, s[44:47], s38 offen nt
    s_add_u32 s38, s38, 8192
    buffer_load_dwordx4 v[52:55], v2, s[44:47], s38 offen nt
    s_add_u32 s38, s38, 8192
    buffer_load_dwordx4 v[56:59], v2, s[44:47], s38 offen nt
    s_add_u32 s38, s38, 8192
    buffer_load_dwordx4 v[60:63], v2, s[44:47], s38 offen nt
    s_add_u32 s38, s38, 8192
    buffer_load_dwordx4 v[64:67], v2, s[44:47], s38 offen nt
    s_add_u32 s38, s38, 8192
    buffer_load_dwordx4 v[68:71], v2, s[44:47], s38 offen nt
    s_xor_b32 s38, s49, 1
    s_lshl_b32 s38, s38, 16
    s_add_u32 s38, s38, s48
    buffer_load_dwordx4 v[72:75], v2, s[44:47], s38 offen nt
    s_add_u32 s38, s38, 8192
    buffer_load_dwordx4 v[76:79], v2, s[44:47], s38 offen nt
    s_add_u32 s38, s38, 8192
    buffer_load_dwordx4 v[80:83], v2, s[44:47], s38 offen nt
    s_add_u32 s38, s38, 8192
    buffer_load_dwordx4 v[84:87], v2, s[44:47], s38 offen nt
    s_add_u32 s38, s38, 8192
    buffer_load_dwordx4 v[88:91], v2, s[44:47], s38 offen nt
    s_add_u32 s38, s38, 8192
    buffer_load_dwordx4 v[92:95], v2, s[44:47], s38 offen nt
    s_add_u32 s38, s38, 8192
    buffer_load_dwordx4 v[96:99], v2, s[44:47], s38 offen nt
    s_add_u32 s38, s38, 8192
    buffer_load_dwordx4 v[100:103], v2, s[44:47], s38 offen nt
    s_xor_b32 s38, s49, 2
    s_lshl_b32 s38, s38, 16
    s_add_u32 s38, s38, s48
    buffer_load_dwordx4 v[104:107], v2, s[44:47], s38 offen nt
    s_add_u32 s38, s38, 8192
    buffer_load_dwordx4 v[108:111], v2, s[44:47], s38 offen nt
    s_add_u32 s38, s38, 8192
    buffer_load_dwordx4 v[112:115], v2, s[44:47], s38 offen nt
    s_add_u32 s38, s38, 8192
    buffer_load_dwordx4 v[116:119], v2, s[44:47], s38 offen nt
    s_add_u32 s38, s38, 8192
    buffer_load_dwordx4 v[120:123], v2, s[44:47], s38 offen nt
    s_add_u32 s38, s38, 8192
    buffer_load_dwordx4 v[124:127], v2, s[44:47], s38 offen nt
    s_add_u32 s38, s38, 8192
    buffer_load_dwordx4 v[128:131], v2, s[44:47], s38 offen nt
    s_add_u32 s38, s38, 8192
    buffer_load_dwordx4 v[132:135], v2, s[44:47], s38 offen nt
    s_xor_b32 s38, s49, 3
    s_lshl_b32 s38, s38, 16
    s_add_u32 s38, s38, s48
    buffer_load_dwordx4 v[136:139], v2, s[44:47], s38 offen nt
    s_add_u32 s38, s38, 8192
    buffer_load_dwordx4 v[140:143], v2, s[44:47], s38 offen nt
    s_add_u32 s38, s38, 8192
    buffer_load_dwordx4 v[144:147], v2, s[44:47], s38 offen nt
    s_add_u32 s38, s38, 8192
    buffer_load_dwordx4 v[148:151], v2, s[44:47], s38 offen nt
    s_add_u32 s38, s38, 8192
    buffer_load_dwordx4 v[152:155], v2, s[44:47], s38 offen nt
    s_add_u32 s38, s38, 8192
    buffer_load_dwordx4 v[156:159], v2, s[44:47], s38 offen nt
    s_add_u32 s38, s38, 8192
    buffer_load_dwordx4 v[160:163], v2, s[44:47], s38 offen nt
    s_add_u32 s38, s38, 8192
    buffer_load_dwordx4 v[164:167], v2, s[44:47], s38 offen nt
    v_mov_b32 v6, 1
    s_mov_b64 exec, 1
    ds_add_u32 v0, v6 offset:12
    s_mov_b64 exec, -1

    v_and_b32 v6, 31, v1
    v_lshlrev_b32 v6, 3, v6
    v_lshrrev_b32 v5, 1, v5
    v_lshlrev_b32 v5, 4, v5
    v_lshl_add_u32 v7, v4, 9, v5
    s_lshl_b32 s38, s33, 11
    s_xor_b32 s50, s49, 0
    s_lshl_b32 s50, s50, 7
    s_add_u32 s50, s50, s38
    s_xor_b32 s51, s49, 1
    s_lshl_b32 s51, s51, 7
    s_add_u32 s51, s51, s38
    s_xor_b32 s52, s49, 2
    s_lshl_b32 s52, s52, 7
    s_add_u32 s52, s52, s38
    s_xor_b32 s53, s49, 3
    s_lshl_b32 s53, s53, 7
    s_add_u32 s53, s53, s38

    v_and_b32 v4, 1, v1
    v_cmp_eq_u32 vcc, 1, v4
    v_mov_b32 v2, 0x0c0c0100
    v_mov_b32 v4, 0x01000c0c
    v_cndmask_b32 v2, v2, v4, vcc
    v_mov_b32 v3, 0x0c0c0302
    v_mov_b32 v4, 0x03020c0c
    v_cndmask_b32 v3, v3, v4, vcc
L_B_fl:
    global_load_dword v4, v6, s[28:29] sc1
    s_sub_u32 s3, s3, 1
    s_cbranch_scc1 L_end
    s_waitcnt vmcnt(0)
    v_cmp_eq_u32 vcc, 0, v4
    s_cbranch_vccnz L_B_fl
    buffer_load_dwordx4 v[8:11], v7, s[40:43], s50 offen sc1
    buffer_load_dwordx4 v[12:15], v7, s[40:43], s51 offen sc1
    buffer_load_dwordx4 v[16:19], v7, s[40:43], s52 offen sc1
    buffer_load_dwordx4 v[20:23], v7, s[40:43], s53 offen sc1
    v_swap_b32 v41, v44
    v_swap_b32 v42, v48
    v_swap_b32 v43, v52
    v_swap_b32 v46, v49
    v_swap_b32 v47, v53
    v_swap_b32 v51, v54
    v_swap_b32 v57, v60
    v_swap_b32 v58, v64
    v_swap_b32 v59, v68
    v_swap_b32 v62, v65
    v_swap_b32 v63, v69
    v_swap_b32 v67, v70
    v_swap_b32 v73, v76
    v_swap_b32 v74, v80
    v_swap_b32 v75, v84
    v_swap_b32 v78, v81
    v_swap_b32 v79, v85
    v_swap_b32 v83, v86
    v_swap_b32 v89, v92
    v_swap_b32 v90, v96
    v_swap_b32 v91, v100
    v_swap_b32 v94, v97
    v_swap_b32 v95, v101
    v_swap_b32 v99, v102
    v_swap_b32 v105, v108
    v_swap_b32 v106, v112
    v_swap_b32 v107, v116
    v_swap_b32 v110, v113
    v_swap_b32 v111, v117
    v_swap_b32 v115, v118
    v_swap_b32 v121, v124
    v_swap_b32 v122, v128
    v_swap_b32 v123, v132
    v_swap_b32 v126, v129
    v_swap_b32 v127, v133
    v_swap_b32 v131, v134
    v_swap_b32 v137, v140
    v_swap_b32 v138, v144
    v_swap_b32 v139, v148
    v_swap_b32 v142, v145
    v_swap_b32 v143, v149
    v_swap_b32 v147, v150
    v_swap_b32 v153, v156
    v_swap_b32 v154, v160
    v_swap_b32 v155, v164
    v_swap_b32 v158, v161
    v_swap_b32 v159, v165
    v_swap_b32 v163, v166
    s_branch L_B_h1
L_B_h0:
    buffer_load_dwordx4 v[8:11], v7, s[40:43], s50 offen sc1
    buffer_load_dwordx4 v[12:15], v7, s[40:43], s51 offen sc1
    buffer_load_dwordx4 v[16:19], v7, s[40:43], s52 offen sc1
    buffer_load_dwordx4 v[20:23], v7, s[40:43], s53 offen sc1
    s_sub_u32 s3, s3, 1
    s_cbranch_scc1 L_end
L_B_h1:
    s_waitcnt vmcnt(0)
    v_max3_u32 v24, v8, v9, v10
    v_max3_u32 v24, v24, v11, v12
    v_max3_u32 v24, v24, v13, v14
    v_max3_u32 v24, v24, v15, v16
    v_max3_u32 v24, v24, v17, v18
    v_max3_u32 v24, v24, v19, v20
    v_max3_u32 v24, v24, v21, v22
    v_max_u32 v24, v24, v23
    v_cmp_eq_u32 vcc, -1, v24
    s_cbranch_vccnz L_B_h0
    v_perm_b32 v4, v8, v8, v2
    v_perm_b32 v5, v8, v8, v3
    v_perm_b32 v6, v9, v9, v2
    v_perm_b32 v7, v9, v9, v3
    s_nop 1
    v_mfma_f32_16x16x32_bf16 v[24:27], v[40:43], v[4:7], 0
    v_perm_b32 v40, v10, v10, v2
    v_perm_b32 v41, v10, v10, v3
    v_mfma_f32_16x16x32_bf16 v[28:31], v[44:47], v[4:7], 0
    v_perm_b32 v42, v11, v11, v2
    v_perm_b32 v43, v11, v11, v3
    v_mfma_f32_16x16x32_bf16 v[32:35], v[48:51], v[4:7], 0
    v_mfma_f32_16x16x32_bf16 v[36:39], v[52:55], v[4:7], 0
    v_mfma_f32_16x16x32_bf16 v[24:27], v[56:59], v[40:43], v[24:27]
    v_perm_b32 v56, v12, v12, v2
    v_perm_b32 v57, v12, v12, v3
    v_mfma_f32_16x16x32_bf16 v[28:31], v[60:63], v[40:43], v[28:31]
    v_perm_b32 v58, v13, v13, v2
    v_perm_b32 v59, v13, v13, v3
    v_mfma_f32_16x16x32_bf16 v[32:35], v[64:67], v[40:43], v[32:35]
    v_mfma_f32_16x16x32_bf16 v[36:39], v[68:71], v[40:43], v[36:39]
    v_mfma_f32_16x16x32_bf16 v[24:27], v[72:75], v[56:59], v[24:27]
    v_perm_b32 v72, v14, v14, v2
    v_perm_b32 v73, v14, v14, v3
    v_mfma_f32_16x16x32_bf16 v[28:31], v[76:79], v[56:59], v[28:31]
    v_perm_b32 v74, v15, v15, v2
    v_perm_b32 v75, v15, v15, v3
    v_mfma_f32_16x16x32_bf16 v[32:35], v[80:83], v[56:59], v[32:35]
    v_mfma_f32_16x16x32_bf16 v[36:39], v[84:87], v[56:59], v[36:39]
    v_mfma_f32_16x16x32_bf16 v[24:27], v[88:91], v[72:75], v[24:27]
    v_perm_b32 v88, v16, v16, v2
    v_perm_b32 v89, v16, v16, v3
    v_mfma_f32_16x16x32_bf16 v[28:31], v[92:95], v[72:75], v[28:31]
    v_perm_b32 v90, v17, v17, v2
    v_perm_b32 v91, v17, v17, v3
    v_mfma_f32_16x16x32_bf16 v[32:35], v[96:99], v[72:75], v[32:35]
    v_mfma_f32_16x16x32_bf16 v[36:39], v[100:103], v[72:75], v[36:39]
    v_mfma_f32_16x16x32_bf16 v[24:27], v[104:107], v[88:91], v[24:27]
    v_perm_b32 v104, v18, v18, v2
    v_perm_b32 v105, v18, v18, v3
    v_mfma_f32_16x16x32_bf16 v[28:31], v[108:111], v[88:91], v[28:31]
    v_perm_b32 v106, v19, v19, v2
    v_perm_b32 v107, v19, v19, v3
    v_mfma_f32_16x16x32_bf16 v[32:35], v[112:115], v[88:91], v[32:35]
    v_mfma_f32_16x16x32_bf16 v[36:39], v[116:119], v[88:91], v[36:39]
    v_mfma_f32_16x16x32_bf16 v[24:27], v[120:123], v[104:107], v[24:27]
    v_perm_b32 v120, v20, v20, v2
    v_perm_b32 v121, v20, v20, v3
    v_mfma_f32_16x16x32_bf16 v[28:31], v[124:127], v[104:107], v[28:31]
    v_perm_b32 v122, v21, v21, v2
    v_perm_b32 v123, v21, v21, v3
    v_mfma_f32_16x16x32_bf16 v[32:35], v[128:131], v[104:107], v[32:35]
    v_mfma_f32_16x16x32_bf16 v[36:39], v[132:135], v[104:107], v[36:39]
    v_mfma_f32_16x16x32_bf16 v[24:27], v[136:139], v[120:123], v[24:27]
    v_perm_b32 v136, v22, v22, v2
    v_perm_b32 v137, v22, v22, v3
    v_mfma_f32_16x16x32_bf16 v[28:31], v[140:143], v[120:123], v[28:31]
    v_perm_b32 v138, v23, v23, v2
    v_perm_b32 v139, v23, v23, v3
    v_mfma_f32_16x16x32_bf16 v[32:35], v[144:147], v[120:123], v[32:35]
    v_mfma_f32_16x16x32_bf16 v[36:39], v[148:151], v[120:123], v[36:39]
    v_mfma_f32_16x16x32_bf16 v[24:27], v[152:155], v[136:139], v[24:27]
    v_mfma_f32_16x16x32_bf16 v[28:31], v[156:159], v[136:139], v[28:31]
    v_mfma_f32_16x16x32_bf16 v[32:35], v[160:163], v[136:139], v[32:35]
    v_mfma_f32_16x16x32_bf16 v[36:39], v[164:167], v[136:139], v[36:39]
    s_lshl_b32 s38, s33, 12
    s_add_u32 s38, s38, 131072
    v_lshl_add_u32 v4, v1, 4, s38
    s_nop 1
    ds_write_b128 v4, v[24:27] offset:0
    ds_write_b128 v4, v[28:31] offset:1024
    ds_write_b128 v4, v[32:35] offset:2048
    ds_write_b128 v4, v[36:39] offset:3072
    v_mov_b32 v5, 1
    s_mov_b64 exec, 1
    ds_add_u32 v0, v5 offset:4
    s_mov_b64 exec, -1

    v_lshlrev_b32 v2, 4, v1
    s_lshl_b32 s50, s34, 15
    s_lshl_b32 s38, s33, 13
    s_add_u32 s50, s50, s38
    s_add_u32 s50, s50, 65536
    s_add_u32 s51, s50, 4096
    s_mul_i32 s38, s33, 8064
    s_add_u32 s38, s38, 131072
    v_add_u32 v3, s38, v2
L_w9:
    ds_read_b32 v5, v0 offset:3036
    s_sub_u32 s3, s3, 1
    s_cbranch_scc1 L_end
    s_waitcnt lgkmcnt(0)
    v_cmp_gt_u32 vcc, 1, v5
    s_cbranch_vccnz L_w9
L_B_q:
    buffer_load_dwordx4 v[40:43], v2, s[40:43], s50 offen offset:0 sc1
    buffer_load_dwordx4 v[44:47], v2, s[40:43], s50 offen offset:1024 sc1
    buffer_load_dwordx4 v[48:51], v2, s[40:43], s50 offen offset:2048 sc1
    buffer_load_dwordx4 v[52:55], v2, s[40:43], s50 offen offset:3072 sc1
    buffer_load_dwordx4 v[56:59], v2, s[40:43], s51 offen offset:0 sc1
    buffer_load_dwordx4 v[60:63], v2, s[40:43], s51 offen offset:1024 sc1
    buffer_load_dwordx4 v[64:67], v2, s[40:43], s51 offen offset:2048 sc1
    buffer_load_dwordx4 v[68:71], v2, s[40:43], s51 offen offset:3072 sc1
    s_sub_u32 s3, s3, 1
    s_cbranch_scc1 L_end
    s_waitcnt vmcnt(0)
    v_max3_u32 v5, v40, v41, v42
    v_max3_u32 v5, v5, v43, v44
    v_max3_u32 v5, v5, v45, v46
    v_max3_u32 v5, v5, v47, v48
    v_max3_u32 v5, v5, v49, v50
    v_max3_u32 v5, v5, v51, v52
    v_max3_u32 v5, v5, v53, v54
    v_max3_u32 v5, v5, v55, v56
    v_max3_u32 v5, v5, v57, v58
    v_max3_u32 v5, v5, v59, v60
    v_max3_u32 v5, v5, v61, v62
    v_max3_u32 v5, v5, v63, v64
    v_max3_u32 v5, v5, v65, v66
    v_max3_u32 v5, v5, v67, v68
    v_max3_u32 v5, v5, v69, v70
    v_max_u32 v5, v5, v71
    v_cmp_eq_u32 vcc, -1, v5
    s_cbranch_vccnz L_B_q
    s_mov_b32 s38, -1
    s_mov_b32 s39, 0x3fffffff
    s_mov_b64 exec, s[38:39]
    ds_write_b128 v3, v[40:43] offset:0
    ds_write_b128 v3, v[44:47] offset:1008
    ds_write_b128 v3, v[48:51] offset:2016
    ds_write_b128 v3, v[52:55] offset:3024
    ds_write_b128 v3, v[56:59] offset:4032
    ds_write_b128 v3, v[60:63] offset:5040
    ds_write_b128 v3, v[64:67] offset:6048
    ds_write_b128 v3, v[68:71] offset:7056
    s_mov_b64 exec, -1
    v_mov_b32 v5, 1
    s_mov_b64 exec, 1
    ds_add_u32 v0, v5 offset:1008
    s_mov_b64 exec, -1
    s_mov_b32 s44, s12
    s_mov_b32 s45, s13
    s_mov_b32 s46, 4194304
    s_mov_b32 s47, 0x20000

    v_lshrrev_b32 v4, 4, v1
    v_and_b32 v5, 15, v1
    v_lshlrev_b32 v2, 13, v4
    v_lshl_add_u32 v2, v5, 4, v2
L_w10:
    s_sleep 1
    ds_read_b32 v6, v0 offset:1012
    s_sub_u32 s3, s3, 1
    s_cbranch_scc1 L_end
    s_waitcnt lgkmcnt(0)
    v_cmp_gt_u32 vcc, 4, v6
    s_cbranch_vccnz L_w10
    s_xor_b32 s38, s34, 0
    s_and_b32 s39, s38, 1
    s_lshl_b32 s39, s39, 19
    s_lshr_b32 s38, s38, 1
    s_lshl_b32 s38, s38, 15
    s_add_u32 s38, s38, s39
    s_add_u32 s38, s38, s48
    s_add_u32 s39, s38, 0
    buffer_load_dwordx4 v[40:43], v2, s[44:47], s39 offen nt
    s_add_u32 s39, s38, 262144
    buffer_load_dwordx4 v[44:47], v2, s[44:47], s39 offen nt
    s_add_u32 s39, s38, 131072
    buffer_load_dwordx4 v[48:51], v2, s[44:47], s39 offen nt
    s_add_u32 s39, s38, 393216
    buffer_load_dwordx4 v[52:55], v2, s[44:47], s39 offen nt
    s_waitcnt vmcnt(3)
    s_xor_b32 s38, s34, 1
    s_and_b32 s39, s38, 1
    s_lshl_b32 s39, s39, 19
    s_lshr_b32 s38, s38, 1
    s_lshl_b32 s38, s38, 15
    s_add_u32 s38, s38, s39
    s_add_u32 s38, s38, s48
    s_add_u32 s39, s38, 0
    buffer_load_dwordx4 v[56:59], v2, s[44:47], s39 offen nt
    s_waitcnt vmcnt(3)
    s_add_u32 s39, s38, 262144
    buffer_load_dwordx4 v[60:63], v2, s[44:47], s39 offen nt
    s_waitcnt vmcnt(3)
    s_add_u32 s39, s38, 131072
    buffer_load_dwordx4 v[64:67], v2, s[44:47], s39 offen nt
    s_waitcnt vmcnt(3)
    s_add_u32 s39, s38, 393216
    buffer_load_dwordx4 v[68:71], v2, s[44:47], s39 offen nt
    s_waitcnt vmcnt(3)
    v_swap_b32 v41, v44
    v_swap_b32 v42, v48
    v_swap_b32 v43, v52
    v_swap_b32 v46, v49
    v_swap_b32 v47, v53
    v_swap_b32 v51, v54
    s_xor_b32 s38, s34, 2
    s_and_b32 s39, s38, 1
    s_lshl_b32 s39, s39, 19
    s_lshr_b32 s38, s38, 1
    s_lshl_b32 s38, s38, 15
    s_add_u32 s38, s38, s39
    s_add_u32 s38, s38, s48
    s_add_u32 s39, s38, 0
    buffer_load_dwordx4 v[72:75], v2, s[44:47], s39 offen nt
    s_waitcnt vmcnt(3)
    s_add_u32 s39, s38, 262144
    buffer_load_dwordx4 v[76:79], v2, s[44:47], s39 offen nt
    s_waitcnt vmcnt(3)
    s_add_u32 s39, s38, 131072
    buffer_load_dwordx4 v[80:83], v2, s[44:47], s39 offen nt
    s_waitcnt vmcnt(3)
    s_add_u32 s39, s38, 393216
    buffer_load_dwordx4 v[84:87], v2, s[44:47], s39 offen nt
    s_waitcnt vmcnt(3)
    v_swap_b32 v57, v60
    v_swap_b32 v58, v64
    v_swap_b32 v59, v68
    v_swap_b32 v62, v65
    v_swap_b32 v63, v69
    v_swap_b32 v67, v70
    s_xor_b32 s38, s34, 3
    s_and_b32 s39, s38, 1
    s_lshl_b32 s39, s39, 19
    s_lshr_b32 s38, s38, 1
    s_lshl_b32 s38, s38, 15
    s_add_u32 s38, s38, s39
    s_add_u32 s38, s38, s48
    s_add_u32 s39, s38, 0
    buffer_load_dwordx4 v[88:91], v2, s[44:47], s39 offen nt
    s_waitcnt vmcnt(3)
    s_add_u32 s39, s38, 262144
    buffer_load_dwordx4 v[92:95], v2, s[44:47], s39 offen nt
    s_waitcnt vmcnt(3)
    s_add_u32 s39, s38, 131072
    buffer_load_dwordx4 v[96:99], v2, s[44:47], s39 offen nt
    s_waitcnt vmcnt(3)
    s_add_u32 s39, s38, 393216
    buffer_load_dwordx4 v[100:103], v2, s[44:47], s39 offen nt
    s_waitcnt vmcnt(3)
    v_swap_b32 v73, v76
    v_swap_b32 v74, v80
    v_swap_b32 v75, v84
    v_swap_b32 v78, v81
    v_swap_b32 v79, v85
    v_swap_b32 v83, v86
    s_xor_b32 s38, s34, 4
    s_and_b32 s39, s38, 1
    s_lshl_b32 s39, s39, 19
    s_lshr_b32 s38, s38, 1
    s_lshl_b32 s38, s38, 15
    s_add_u32 s38, s38, s39
    s_add_u32 s38, s38, s48
    s_add_u32 s39, s38, 0
    buffer_load_dwordx4 v[104:107], v2, s[44:47], s39 offen nt
    s_waitcnt vmcnt(3)
    s_add_u32 s39, s38, 262144
    buffer_load_dwordx4 v[108:111], v2, s[44:47], s39 offen nt
    s_waitcnt vmcnt(3)
    s_add_u32 s39, s38, 131072
    buffer_load_dwordx4 v[112:115], v2, s[44:47], s39 offen nt
    s_waitcnt vmcnt(3)
    s_add_u32 s39, s38, 393216
    buffer_load_dwordx4 v[116:119], v2, s[44:47], s39 offen nt
    s_waitcnt vmcnt(3)
    v_swap_b32 v89, v92
    v_swap_b32 v90, v96
    v_swap_b32 v91, v100
    v_swap_b32 v94, v97
    v_swap_b32 v95, v101
    v_swap_b32 v99, v102
    s_xor_b32 s38, s34, 5
    s_and_b32 s39, s38, 1
    s_lshl_b32 s39, s39, 19
    s_lshr_b32 s38, s38, 1
    s_lshl_b32 s38, s38, 15
    s_add_u32 s38, s38, s39
    s_add_u32 s38, s38, s48
    s_add_u32 s39, s38, 0
    buffer_load_dwordx4 v[120:123], v2, s[44:47], s39 offen nt
    s_waitcnt vmcnt(3)
    s_add_u32 s39, s38, 262144
    buffer_load_dwordx4 v[124:127], v2, s[44:47], s39 offen nt
    s_waitcnt vmcnt(3)
    s_add_u32 s39, s38, 131072
    buffer_load_dwordx4 v[128:131], v2, s[44:47], s39 offen nt
    s_waitcnt vmcnt(3)
    s_add_u32 s39, s38, 393216
    buffer_load_dwordx4 v[132:135], v2, s[44:47], s39 offen nt
    s_waitcnt vmcnt(3)
    v_swap_b32 v105, v108
    v_swap_b32 v106, v112
    v_swap_b32 v107, v116
    v_swap_b32 v110, v113
    v_swap_b32 v111, v117
    v_swap_b32 v115, v118
    s_xor_b32 s38, s34, 6
    s_and_b32 s39, s38, 1
    s_lshl_b32 s39, s39, 19
    s_lshr_b32 s38, s38, 1
    s_lshl_b32 s38, s38, 15
    s_add_u32 s38, s38, s39
    s_add_u32 s38, s38, s48
    s_add_u32 s39, s38, 0
    buffer_load_dwordx4 v[136:139], v2, s[44:47], s39 offen nt
    s_waitcnt vmcnt(3)
    s_add_u32 s39, s38, 262144
    buffer_load_dwordx4 v[140:143], v2, s[44:47], s39 offen nt
    s_waitcnt vmcnt(3)
    s_add_u32 s39, s38, 131072
    buffer_load_dwordx4 v[144:147], v2, s[44:47], s39 offen nt
    s_waitcnt vmcnt(3)
    s_add_u32 s39, s38, 393216
    buffer_load_dwordx4 v[148:151], v2, s[44:47], s39 offen nt
    s_waitcnt vmcnt(3)
    v_swap_b32 v121, v124
    v_swap_b32 v122, v128
    v_swap_b32 v123, v132
    v_swap_b32 v126, v129
    v_swap_b32 v127, v133
    v_swap_b32 v131, v134
    s_xor_b32 s38, s34, 7
    s_and_b32 s39, s38, 1
    s_lshl_b32 s39, s39, 19
    s_lshr_b32 s38, s38, 1
    s_lshl_b32 s38, s38, 15
    s_add_u32 s38, s38, s39
    s_add_u32 s38, s38, s48
    s_add_u32 s39, s38, 0
    buffer_load_dwordx4 v[152:155], v2, s[44:47], s39 offen nt
    s_waitcnt vmcnt(3)
    s_add_u32 s39, s38, 262144
    buffer_load_dwordx4 v[156:159], v2, s[44:47], s39 offen nt
    s_waitcnt vmcnt(3)
    s_add_u32 s39, s38, 131072
    buffer_load_dwordx4 v[160:163], v2, s[44:47], s39 offen nt
    s_waitcnt vmcnt(3)
    s_add_u32 s39, s38, 393216
    buffer_load_dwordx4 v[164:167], v2, s[44:47], s39 offen nt
    s_waitcnt vmcnt(3)
    v_swap_b32 v137, v140
    v_swap_b32 v138, v144
    v_swap_b32 v139, v148
    v_swap_b32 v142, v145
    v_swap_b32 v143, v149
    v_swap_b32 v147, v150

    s_sub_u32 s56, s32, 4
    s_cmp_lt_u32 s35, 28
    s_cselect_b32 s48, s18, s24
    s_cselect_b32 s49, s19, s25
    s_movk_i32 s57, 6144
    s_cselect_b32 s57, 3584, s57
    s_mul_i32 s50, s57, 512
    s_mov_b32 s51, 0x20000
    s_lshl_b32 s58, s35, 7
    s_sub_u32 s38, s35, 26
    s_lshl_b32 s38, s38, 10
    s_lshl_b32 s39, s34, 7
    s_add_u32 s38, s38, s39
    s_cmp_lt_u32 s35, 28
    s_cselect_b32 s58, s58, s38
    v_lshrrev_b32 v4, 3, v1
    v_mul_lo_u32 v5, v4, s57
    v_bfe_u32 v4, v4, 1, 1
    s_and_b32 s38, s56, 1
    s_lshl_b32 s38, s38, 1
    v_or_b32 v4, s38, v4
    v_lshlrev_b32 v4, 1, v4
    v_and_b32 v6, 7, v1
    v_xor_b32 v4, v4, v6
    v_lshl_add_u32 v4, v4, 4, v5
    s_lshl_b32 s38, s56, 5
    v_lshlrev_b32 v5, 4, v1
    v_xor_b32 v5, s38, v5
    s_lshl_b32 s57, s57, 3

L_w11:
    s_sleep 1
    ds_read_b32 v6, v0 offset:1020
    s_sub_u32 s3, s3, 1
    s_cbranch_scc1 L_end
    s_waitcnt lgkmcnt(0)
    v_cmp_gt_u32 vcc, 4, v6
    s_cbranch_vccnz L_w11
    s_mov_b32 s59, 0
L_B_f1:
    s_xor_b32 s38, s59, s34
    s_lshl_b32 s38, s38, 3
    s_add_u32 s38, s38, s56
    s_lshl_b32 m0, s38, 10
    s_mul_i32 s38, s38, s57
    s_add_u32 s38, s38, s58
    buffer_load_dwordx4 v4, s[48:51], s38 offen nt lds
    s_waitcnt vmcnt(3)
    s_add_u32 s59, s59, 1
    s_cmp_lt_u32 s59, 8
    s_cbranch_scc1 L_B_f1
    s_cmp_ge_u32 s35, 28
    s_cbranch_scc1 L_B_f3
    s_mov_b32 s48, s20
    s_mov_b32 s49, s21
    s_and_b32 s38, s56, 3
    s_lshr_b32 s39, s56, 2
    s_lshl_b32 s39, s39, 3
    s_add_u32 s56, s38, s39
    s_lshl_b32 s58, s35, 16
    s_mov_b32 s59, 0
L_B_f2:
    s_xor_b32 s38, s59, s34
    s_and_b32 s39, s38, 1
    s_lshl_b32 s39, s39, 2
    s_lshr_b32 s38, s38, 1
    s_lshl_b32 s38, s38, 4
    s_add_u32 s38, s38, s39
    s_add_u32 s38, s38, s56
    s_lshl_b32 s38, s38, 10
    s_add_u32 m0, s38, 65536
    s_add_u32 s38, s38, s58
    buffer_load_dwordx4 v5, s[48:51], s38 offen nt lds
    s_waitcnt vmcnt(3)
    s_add_u32 s59, s59, 1
    s_cmp_lt_u32 s59, 8
    s_cbranch_scc1 L_B_f2
L_B_f3:

    v_swap_b32 v153, v156
    v_swap_b32 v154, v160
    v_swap_b32 v155, v164
    v_swap_b32 v158, v161
    v_swap_b32 v159, v165
    v_swap_b32 v163, v166

    v_and_b32 v2, 1, v1
    v_lshlrev_b32 v2, 9, v2
    v_lshrrev_b32 v4, 4, v1
    v_lshl_add_u32 v2, v4, 5, v2
    s_lshl_b32 s38, s33, 10
    s_add_u32 s38, s38, 140800
    v_add_u32 v2, s38, v2
    s_lshl_b32 s38, s33, 9
    s_add_u32 s38, s38, 144896
    v_lshl_add_u32 v3, v1, 5, s38
    s_lshl_b32 s38, s33, 2
    v_add_u32 v5, s38, v0
    s_waitcnt vmcnt(0)
    v_mov_b32 v6, 1
    s_mov_b64 exec, 1
    ds_add_u32 v0, v6 offset:3032
    s_mov_b64 exec, -1
L_w12:
    ds_read_b32 v6, v5 offset:2016
    s_sub_u32 s3, s3, 1
    s_cbranch_scc1 L_end
    s_waitcnt lgkmcnt(0)
    v_cmp_gt_u32 vcc, 1, v6
    s_cbranch_vccnz L_w12
    ds_read_b128 v[4:7], v2 offset:0
    ds_read_b128 v[8:11], v2 offset:16
    ds_read_b128 v[12:15], v2 offset:128
    ds_read_b128 v[16:19], v2 offset:144
    ds_read_b128 v[20:23], v2 offset:256
    s_waitcnt lgkmcnt(4)
    v_mfma_f32_16x16x32_bf16 v[24:27], v[4:7], v[40:43], 0
    v_mfma_f32_16x16x32_bf16 v[28:31], v[4:7], v[44:47], 0
    v_mfma_f32_16x16x32_bf16 v[32:35], v[4:7], v[48:51], 0
    v_mfma_f32_16x16x32_bf16 v[36:39], v[4:7], v[52:55], 0
    ds_read_b128 v[40:43], v2 offset:272
    ds_read_b128 v[44:47], v2 offset:384
    ds_read_b128 v[48:51], v2 offset:400
    s_waitcnt lgkmcnt(6)
    v_mfma_f32_16x16x32_bf16 v[24:27], v[8:11], v[56:59], v[24:27]
    v_mfma_f32_16x16x32_bf16 v[28:31], v[8:11], v[60:63], v[28:31]
    v_mfma_f32_16x16x32_bf16 v[32:35], v[8:11], v[64:67], v[32:35]
    v_mfma_f32_16x16x32_bf16 v[36:39], v[8:11], v[68:71], v[36:39]
    s_waitcnt lgkmcnt(5)
    v_mfma_f32_16x16x32_bf16 v[24:27], v[12:15], v[72:75], v[24:27]
    v_mfma_f32_16x16x32_bf16 v[28:31], v[12:15], v[76:79], v[28:31]
    v_mfma_f32_16x16x32_bf16 v[32:35], v[12:15], v[80:83], v[32:35]
    v_mfma_f32_16x16x32_bf16 v[36:39], v[12:15], v[84:87], v[36:39]
    s_waitcnt lgkmcnt(4)
    v_mfma_f32_16x16x32_bf16 v[24:27], v[16:19], v[88:91], v[24:27]
    v_mfma_f32_16x16x32_bf16 v[28:31], v[16:19], v[92:95], v[28:31]
    v_mfma_f32_16x16x32_bf16 v[32:35], v[16:19], v[96:99], v[32:35]
    v_mfma_f32_16x16x32_bf16 v[36:39], v[16:19], v[100:103], v[36:39]
    s_waitcnt lgkmcnt(3)
    v_mfma_f32_16x16x32_bf16 v[24:27], v[20:23], v[104:107], v[24:27]
    v_mfma_f32_16x16x32_bf16 v[28:31], v[20:23], v[108:111], v[28:31]
    v_mfma_f32_16x16x32_bf16 v[32:35], v[20:23], v[112:115], v[32:35]
    v_mfma_f32_16x16x32_bf16 v[36:39], v[20:23], v[116:119], v[36:39]
    s_waitcnt lgkmcnt(2)
    v_mfma_f32_16x16x32_bf16 v[24:27], v[40:43], v[120:123], v[24:27]
    v_mfma_f32_16x16x32_bf16 v[28:31], v[40:43], v[124:127], v[28:31]
    v_mfma_f32_16x16x32_bf16 v[32:35], v[40:43], v[128:131], v[32:35]
    v_mfma_f32_16x16x32_bf16 v[36:39], v[40:43], v[132:135], v[36:39]
    s_waitcnt lgkmcnt(1)
    v_mfma_f32_16x16x32_bf16 v[24:27], v[44:47], v[136:139], v[24:27]
    v_mfma_f32_16x16x32_bf16 v[28:31], v[44:47], v[140:143], v[28:31]
    v_mfma_f32_16x16x32_bf16 v[32:35], v[44:47], v[144:147], v[32:35]
    v_mfma_f32_16x16x32_bf16 v[36:39], v[44:47], v[148:151], v[36:39]
    s_waitcnt lgkmcnt(0)
    v_mfma_f32_16x16x32_bf16 v[24:27], v[48:51], v[152:155], v[24:27]
    v_mfma_f32_16x16x32_bf16 v[28:31], v[48:51], v[156:159], v[28:31]
    v_mfma_f32_16x16x32_bf16 v[32:35], v[48:51], v[160:163], v[32:35]
    v_mfma_f32_16x16x32_bf16 v[36:39], v[48:51], v[164:167], v[36:39]
    s_mov_b64 exec, 0xffff
    s_nop 4
    ds_write2_b64 v3, v[24:25], v[28:29] offset0:0 offset1:1
    s_nop 0
    ds_write2_b64 v3, v[32:33], v[36:37] offset0:2 offset1:3
    s_mov_b64 exec, -1
    v_mov_b32 v6, 1
    s_mov_b64 exec, 1
    ds_add_u32 v0, v6 offset:3024
    s_mov_b64 exec, -1
    s_branch L_end
L_C:
    s_cmp_lt_u32 s2, 32
    s_cbranch_scc1 L_C_s1
    s_barrier
    s_branch L_C_s1d
L_C_s1:
    s_mov_b32 s44, s22
    s_mov_b32 s45, s23
    s_mov_b32 s46, 8192
    s_mov_b32 s47, 0x20000
    v_and_b32 v2, 7, v1
    v_lshlrev_b32 v2, 10, v2
    v_bfe_u32 v3, v1, 3, 1
    v_lshl_add_u32 v2, v3, 7, v2
    v_lshrrev_b32 v3, 4, v1
    v_lshl_add_u32 v2, v3, 4, v2
    s_lshl_b32 s38, s33, 8
    buffer_load_dwordx4 v[8:11], v2, s[44:47], s38 offen
    buffer_load_dwordx4 v[12:15], v2, s[44:47], s38 offen offset:64
    s_mov_b32 s44, s4
    s_mov_b32 s45, s5
    s_mov_b32 s46, 8192
    s_mov_b32 s47, 0x20000
    s_mov_b32 s48, s24
    s_mov_b32 s49, s25
    s_mov_b32 s50, 3145728
    s_mov_b32 s51, 0x20000
    v_mov_b32 v24, 0x3f803f80
    v_mov_b32 v25, 0x3f803f80
    v_mov_b32 v26, 0x3f803f80
    v_mov_b32 v27, 0x3f803f80
    v_mov_b32 v28, 0x3f803f80
    v_mov_b32 v29, 0x3f803f80
    v_mov_b32 v30, 0x3f803f80
    v_mov_b32 v31, 0x3f803f80
    v_mov_b32 v32, 0x3f803f80
    v_mov_b32 v33, 0x3f803f80
    v_mov_b32 v34, 0x3f803f80
    v_mov_b32 v35, 0x3f803f80
    v_mov_b32 v36, 0x3f803f80
    v_mov_b32 v37, 0x3f803f80
    v_mov_b32 v38, 0x3f803f80
    v_mov_b32 v39, 0x3f803f80

    v_and_b32 v2, 15, v1
    v_lshlrev_b32 v2, 10, v2
    v_lshrrev_b32 v3, 4, v1
    v_lshl_add_u32 v4, v3, 4, v2
    v_lshl_add_u32 v5, v3, 3, v2
    s_lshl_b32 s39, s55, 5
    s_mov_b32 s56, 0x00ff00ff
    s_mov_b32 s57, 0x00ff00ff
    s_mov_b64 exec, s[56:57]
    buffer_load_dwordx4 v[24:27], v4, s[44:47], s38 offen offset:0
    buffer_load_dwordx4 v[28:31], v4, s[44:47], s38 offen offset:64
    buffer_load_dwordx4 v[32:35], v4, s[44:47], s38 offen offset:128
    buffer_load_dwordx4 v[36:39], v4, s[44:47], s38 offen offset:192
    buffer_load_dwordx2 v[6:7], v5, s[44:47], s39 offen
    s_mov_b64 exec, -1
    v_lshrrev_b32 v2, 2, v1
    v_mul_u32_u24 v4, 6144, v2
    v_lshrrev_b32 v2, 5, v1
    v_bfe_u32 v5, v1, 1, 1
    v_xor_b32 v2, v2, v5
    v_lshl_add_u32 v4, v2, 10, v4
    v_and_b32 v2, 1, v1
    v_lshl_add_u32 v4, v2, 4, v4
    s_mul_i32 s58, s33, 786432
    s_add_u32 s58, s58, s39
    s_lshl_b32 s59, s33, 13
    s_add_u32 s59, s59, 98304
    s_lshl_b32 s60, s37, 1
    s_xor_b32 s38, s60, 0
    s_lshl_b32 s39, s38, 10
    s_add_u32 m0, s39, s59
    s_mul_i32 s38, s38, 98304
    s_add_u32 s38, s38, s58
    buffer_load_dwordx4 v4, s[48:51], s38 offen nt lds
    s_xor_b32 s38, s60, 1
    s_lshl_b32 s39, s38, 10
    s_add_u32 m0, s39, s59
    s_mul_i32 s38, s38, 98304
    s_add_u32 s38, s38, s58
    buffer_load_dwordx4 v4, s[48:51], s38 offen nt lds
    s_xor_b32 s38, s60, 2
    s_lshl_b32 s39, s38, 10
    s_add_u32 m0, s39, s59
    s_mul_i32 s38, s38, 98304
    s_add_u32 s38, s38, s58
    buffer_load_dwordx4 v4, s[48:51], s38 offen nt lds
    s_xor_b32 s38, s60, 3
    s_lshl_b32 s39, s38, 10
    s_add_u32 m0, s39, s59
    s_mul_i32 s38, s38, 98304
    s_add_u32 s38, s38, s58
    buffer_load_dwordx4 v4, s[48:51], s38 offen nt lds
    s_xor_b32 s38, s60, 4
    s_lshl_b32 s39, s38, 10
    s_add_u32 m0, s39, s59
    s_mul_i32 s38, s38, 98304
    s_add_u32 s38, s38, s58
    buffer_load_dwordx4 v4, s[48:51], s38 offen nt lds
    s_xor_b32 s38, s60, 5
    s_lshl_b32 s39, s38, 10
    s_add_u32 m0, s39, s59
    s_mul_i32 s38, s38, 98304
    s_add_u32 s38, s38, s58
    buffer_load_dwordx4 v4, s[48:51], s38 offen nt lds
    s_xor_b32 s38, s60, 6
    s_lshl_b32 s39, s38, 10
    s_add_u32 m0, s39, s59
    s_mul_i32 s38, s38, 98304
    s_add_u32 s38, s38, s58
    buffer_load_dwordx4 v4, s[48:51], s38 offen nt lds
    s_xor_b32 s38, s60, 7
    s_lshl_b32 s39, s38, 10
    s_add_u32 m0, s39, s59
    s_mul_i32 s38, s38, 98304
    s_add_u32 s38, s38, s58
    buffer_load_dwordx4 v4, s[48:51], s38 offen nt lds
    s_barrier
    v_bfe_u32 v2, v1, 2, 2
    v_lshl_add_u32 v2, v3, 3, v2
    v_lshlrev_b32 v2, 6, v2
    v_and_b32 v4, 1, v3
    v_lshl_add_u32 v2, v4, 5, v2
    v_and_b32 v4, 3, v1
    v_lshl_add_u32 v2, v4, 3, v2
    v_add_u32 v2, s59, v2
    v_xor_b32 v3, 32, v2
    s_waitcnt vmcnt(13)
    s_mov_b32 s38, 0xbfb8aa3b
    v_lshlrev_b32 v40, 16, v8
    v_and_b32 v41, 0xffff0000, v8
    v_mul_f32 v42, s38, v40
    v_mul_f32 v43, s38, v41
    v_exp_f32 v42, v42
    v_exp_f32 v43, v43
    v_add_f32 v42, 1.0, v42
    v_add_f32 v43, 1.0, v43
    v_rcp_f32 v42, v42
    v_rcp_f32 v43, v43
    v_mul_f32 v40, v40, v42
    v_mul_f32 v41, v41, v43
    v_cvt_pk_bf16_f32 v8, v40, v41
    v_lshlrev_b32 v40, 16, v9
    v_and_b32 v41, 0xffff0000, v9
    v_mul_f32 v42, s38, v40
    v_mul_f32 v43, s38, v41
    v_exp_f32 v42, v42
    v_exp_f32 v43, v43
    v_add_f32 v42, 1.0, v42
    v_add_f32 v43, 1.0, v43
    v_rcp_f32 v42, v42
    v_rcp_f32 v43, v43
    v_mul_f32 v40, v40, v42
    v_mul_f32 v41, v41, v43
    v_cvt_pk_bf16_f32 v9, v40, v41
    v_lshlrev_b32 v40, 16, v10
    v_and_b32 v41, 0xffff0000, v10
    v_mul_f32 v42, s38, v40
    v_mul_f32 v43, s38, v41
    v_exp_f32 v42, v42
    v_exp_f32 v43, v43
    v_add_f32 v42, 1.0, v42
    v_add_f32 v43, 1.0, v43
    v_rcp_f32 v42, v42
    v_rcp_f32 v43, v43
    v_mul_f32 v40, v40, v42
    v_mul_f32 v41, v41, v43
    v_cvt_pk_bf16_f32 v10, v40, v41
    v_lshlrev_b32 v40, 16, v11
    v_and_b32 v41, 0xffff0000, v11
    v_mul_f32 v42, s38, v40
    v_mul_f32 v43, s38, v41
    v_exp_f32 v42, v42
    v_exp_f32 v43, v43
    v_add_f32 v42, 1.0, v42
    v_add_f32 v43, 1.0, v43
    v_rcp_f32 v42, v42
    v_rcp_f32 v43, v43
    v_mul_f32 v40, v40, v42
    v_mul_f32 v41, v41, v43
    v_cvt_pk_bf16_f32 v11, v40, v41
    v_lshlrev_b32 v40, 16, v12
    v_and_b32 v41, 0xffff0000, v12
    v_mul_f32 v42, s38, v40
    v_mul_f32 v43, s38, v41
    v_exp_f32 v42, v42
    v_exp_f32 v43, v43
    v_add_f32 v42, 1.0, v42
    v_add_f32 v43, 1.0, v43
    v_rcp_f32 v42, v42
    v_rcp_f32 v43, v43
    v_mul_f32 v40, v40, v42
    v_mul_f32 v41, v41, v43
    v_cvt_pk_bf16_f32 v12, v40, v41
    v_lshlrev_b32 v40, 16, v13
    v_and_b32 v41, 0xffff0000, v13
    v_mul_f32 v42, s38, v40
    v_mul_f32 v43, s38, v41
    v_exp_f32 v42, v42
    v_exp_f32 v43, v43
    v_add_f32 v42, 1.0, v42
    v_add_f32 v43, 1.0, v43
    v_rcp_f32 v42, v42
    v_rcp_f32 v43, v43
    v_mul_f32 v40, v40, v42
    v_mul_f32 v41, v41, v43
    v_cvt_pk_bf16_f32 v13, v40, v41
    v_lshlrev_b32 v40, 16, v14
    v_and_b32 v41, 0xffff0000, v14
    v_mul_f32 v42, s38, v40
    v_mul_f32 v43, s38, v41
    v_exp_f32 v42, v42
    v_exp_f32 v43, v43
    v_add_f32 v42, 1.0, v42
    v_add_f32 v43, 1.0, v43
    v_rcp_f32 v42, v42
    v_rcp_f32 v43, v43
    v_mul_f32 v40, v40, v42
    v_mul_f32 v41, v41, v43
    v_cvt_pk_bf16_f32 v14, v40, v41
    v_lshlrev_b32 v40, 16, v15
    v_and_b32 v41, 0xffff0000, v15
    v_mul_f32 v42, s38, v40
    v_mul_f32 v43, s38, v41
    v_exp_f32 v42, v42
    v_exp_f32 v43, v43
    v_add_f32 v42, 1.0, v42
    v_add_f32 v43, 1.0, v43
    v_rcp_f32 v42, v42
    v_rcp_f32 v43, v43
    v_mul_f32 v40, v40, v42
    v_mul_f32 v41, v41, v43
    v_cvt_pk_bf16_f32 v15, v40, v41
    v_mov_b32_dpp v16, v8 row_ror:8 row_mask:0xf bank_mask:0xf
    v_mov_b32_dpp v17, v9 row_ror:8 row_mask:0xf bank_mask:0xf
    v_mov_b32_dpp v18, v10 row_ror:8 row_mask:0xf bank_mask:0xf
    v_mov_b32_dpp v19, v11 row_ror:8 row_mask:0xf bank_mask:0xf
    v_mov_b32_dpp v20, v12 row_ror:8 row_mask:0xf bank_mask:0xf
    v_mov_b32_dpp v21, v13 row_ror:8 row_mask:0xf bank_mask:0xf
    v_mov_b32_dpp v22, v14 row_ror:8 row_mask:0xf bank_mask:0xf
    v_mov_b32_dpp v23, v15 row_ror:8 row_mask:0xf bank_mask:0xf
    s_waitcnt vmcnt(8)
    v_mfma_f32_16x16x32_bf16 v[88:91], v[24:27], v[24:27], 0
    v_mfma_f32_16x16x32_bf16 v[88:91], v[28:31], v[28:31], v[88:91]
    v_mfma_f32_16x16x32_bf16 v[88:91], v[32:35], v[32:35], v[88:91]
    v_mfma_f32_16x16x32_bf16 v[88:91], v[36:39], v[36:39], v[88:91]
    s_mul_i32 s38, s33, 3072
    s_add_u32 s38, s38, 131072
    v_lshl_add_u32 v4, v1, 4, s38
    s_waitcnt vmcnt(0)
    ds_read_b64_tr_b16 v[48:49], v2 offset:0
    ds_read_b64_tr_b16 v[50:51], v2 offset:256
    ds_read_b64_tr_b16 v[52:53], v3 offset:0
    ds_read_b64_tr_b16 v[54:55], v3 offset:256
    ds_read_b64_tr_b16 v[56:57], v2 offset:2048
    ds_read_b64_tr_b16 v[58:59], v2 offset:2304
    ds_read_b64_tr_b16 v[60:61], v3 offset:2048
    ds_read_b64_tr_b16 v[62:63], v3 offset:2304
    ds_read_b64_tr_b16 v[64:65], v2 offset:4096
    ds_read_b64_tr_b16 v[66:67], v2 offset:4352
    ds_read_b64_tr_b16 v[68:69], v3 offset:4096
    ds_read_b64_tr_b16 v[70:71], v3 offset:4352
    s_waitcnt lgkmcnt(8)
    ds_read_b64_tr_b16 v[72:73], v2 offset:6144
    ds_read_b64_tr_b16 v[74:75], v2 offset:6400
    ds_read_b64_tr_b16 v[76:77], v3 offset:6144
    ds_read_b64_tr_b16 v[78:79], v3 offset:6400
    s_waitcnt lgkmcnt(12)
    v_mfma_f32_16x16x32_bf16 v[80:83], v[48:51], v[8:11], 0
    v_mfma_f32_16x16x32_bf16 v[84:87], v[52:55], v[8:11], 0
    s_waitcnt lgkmcnt(8)
    v_mfma_f32_16x16x32_bf16 v[80:83], v[56:59], v[12:15], v[80:83]
    v_mfma_f32_16x16x32_bf16 v[84:87], v[60:63], v[12:15], v[84:87]
    s_waitcnt lgkmcnt(4)
    v_mfma_f32_16x16x32_bf16 v[80:83], v[64:67], v[16:19], v[80:83]
    v_mfma_f32_16x16x32_bf16 v[84:87], v[68:71], v[16:19], v[84:87]
    s_waitcnt lgkmcnt(0)
    v_mfma_f32_16x16x32_bf16 v[80:83], v[72:75], v[20:23], v[80:83]
    v_mfma_f32_16x16x32_bf16 v[84:87], v[76:79], v[20:23], v[84:87]
    ds_write_b128 v4, v[88:91] offset:2048
    s_nop 5
    ds_write_b128 v4, v[80:83] offset:0
    ds_write_b128 v4, v[84:87] offset:1024
    v_mov_b32 v5, 1
    s_mov_b64 exec, 1
    ds_add_u32 v0, v5 offset:0
    s_mov_b64 exec, -1
    s_cmp_lg_u32 s33, 0
    s_cbranch_scc1 L_C_s1d
    v_and_b32 v2, 7, v1
    v_lshrrev_b32 v3, 2, v2
    v_lshl_add_u32 v3, v3, 4, v2
    v_lshlrev_b32 v3, 4, v3
    v_and_b32 v5, 3, v1
    v_lshl_add_u32 v3, v5, 2, v3
    v_add_u32 v3, 133120, v3
    v_lshlrev_b32 v2, 4, v2
    v_add_u32 v8, 133632, v2
    v_lshrrev_b32 v9, 5, v1
    v_lshl_add_u32 v2, v9, 7, v2
    v_bfe_u32 v9, v1, 4, 1
    v_lshl_add_u32 v2, v9, 3, v2
    v_lshlrev_b32 v12, 16, v6
    v_and_b32 v13, 0xffff0000, v6
    v_lshlrev_b32 v14, 16, v7
    v_and_b32 v15, 0xffff0000, v7
    s_lshl_b32 s39, s55, 8
L_w13:
    ds_read_b32 v5, v0 offset:0
    s_sub_u32 s3, s3, 1
    s_cbranch_scc1 L_end
    s_waitcnt lgkmcnt(0)
    v_cmp_gt_u32 vcc, 4, v5
    s_cbranch_vccnz L_w13
    ds_read_b32 v16, v8 offset:0
    ds_read_b32 v20, v3 offset:0
    ds_read_b32 v17, v8 offset:3072
    ds_read_b32 v21, v3 offset:3072
    ds_read_b32 v18, v8 offset:6144
    ds_read_b32 v22, v3 offset:6144
    ds_read_b32 v19, v8 offset:9216
    ds_read_b32 v23, v3 offset:9216
    ds_read_b128 v[48:51], v4 offset:3072
    ds_read_b128 v[52:55], v4 offset:4096
    ds_read_b128 v[56:59], v4 offset:6144
    ds_read_b128 v[60:63], v4 offset:7168
    ds_read_b128 v[64:67], v4 offset:9216
    ds_read_b128 v[68:71], v4 offset:10240
    s_mov_b32 s38, 0x3b000000
    s_waitcnt lgkmcnt(6)
    v_add_f32 v16, v16, v17
    v_add_f32 v20, v20, v21
    v_add_f32 v18, v18, v19
    v_add_f32 v22, v22, v23
    v_add_f32 v16, v16, v18
    v_add_f32 v20, v20, v22
    v_mul_f32 v16, s38, v16
    v_mul_f32 v20, s38, v20
    v_fma_f32 v20, -v16, v16, v20
    v_max_f32 v20, 0, v20
    v_add_f32 v20, 0x3727c5ac, v20
    v_rsq_f32 v20, v20
    v_sub_f32 v12, v12, v16
    v_sub_f32 v13, v13, v16
    v_sub_f32 v14, v14, v16
    v_sub_f32 v15, v15, v16
    v_mul_f32 v12, v12, v20
    v_mul_f32 v13, v13, v20
    v_mul_f32 v14, v14, v20
    v_mul_f32 v15, v15, v20
    s_waitcnt lgkmcnt(0)
    v_add_f32 v80, v80, v48
    v_add_f32 v56, v56, v64
    v_add_f32 v81, v81, v49
    v_add_f32 v57, v57, v65
    v_add_f32 v82, v82, v50
    v_add_f32 v58, v58, v66
    v_add_f32 v83, v83, v51
    v_add_f32 v59, v59, v67
    v_add_f32 v84, v84, v52
    v_add_f32 v60, v60, v68
    v_add_f32 v85, v85, v53
    v_add_f32 v61, v61, v69
    v_add_f32 v86, v86, v54
    v_add_f32 v62, v62, v70
    v_add_f32 v87, v87, v55
    v_add_f32 v63, v63, v71
    v_add_f32 v80, v80, v56
    v_add_f32 v81, v81, v57
    v_add_f32 v82, v82, v58
    v_add_f32 v83, v83, v59
    v_add_f32 v84, v84, v60
    v_add_f32 v85, v85, v61
    v_add_f32 v86, v86, v62
    v_add_f32 v87, v87, v63
    v_add_f32 v80, v80, v12
    v_add_f32 v81, v81, v13
    v_add_f32 v82, v82, v14
    v_add_f32 v83, v83, v15
    v_fmac_f32 v80, v84, v12
    v_fmac_f32 v81, v85, v13
    v_fmac_f32 v82, v86, v14
    v_fmac_f32 v83, v87, v15
    v_cvt_pk_bf16_f32 v80, v80, v81
    v_cvt_pk_bf16_f32 v81, v82, v83
    s_mov_b64 exec, s[56:57]
    buffer_store_dwordx2 v[80:81], v2, s[40:43], s39 offen sc1
    s_mov_b64 exec, -1
L_C_s1d:
    s_cmp_eq_u32 s33, 1
    s_cbranch_scc1 L_C_s3
    v_mov_b32 v5, 1
    s_mov_b64 exec, 1
    ds_add_u32 v0, v5 offset:8
    s_mov_b64 exec, -1
    s_branch L_C_t
L_C_s3:
    s_mov_b32 s44, s10
    s_mov_b32 s45, s11
    s_mov_b32 s46, 4194304
    s_mov_b32 s47, 0x20000

    v_lshrrev_b32 v3, 4, v1
    v_and_b32 v2, 15, v1
    v_xor_b32 v4, v2, v3
    v_lshlrev_b32 v4, 4, v4
    v_lshl_add_u32 v4, v3, 13, v4
    v_xor_b32 v5, 64, v4
    v_xor_b32 v6, 0x80, v4
    v_xor_b32 v7, 0xc0, v4
    s_lshl_b32 s48, s34, 19
    s_lshl_b32 s38, s35, 8
    s_add_u32 s48, s48, s38
    s_mov_b32 m0, 81920
    s_add_u32 s38, s48, 0
    buffer_load_dwordx4 v4, s[44:47], s38 offen nt lds
    s_mov_b32 m0, 82944
    s_add_u32 s38, s48, 131072
    buffer_load_dwordx4 v5, s[44:47], s38 offen nt lds
    s_mov_b32 m0, 83968
    s_add_u32 s38, s48, 262144
    buffer_load_dwordx4 v6, s[44:47], s38 offen nt lds
    s_mov_b32 m0, 84992
    s_add_u32 s38, s48, 393216
    buffer_load_dwordx4 v7, s[44:47], s38 offen nt lds
    s_mov_b32 m0, 86016
    s_add_u32 s38, s48, 32768
    buffer_load_dwordx4 v4, s[44:47], s38 offen nt lds
    s_mov_b32 m0, 87040
    s_add_u32 s38, s48, 163840
    buffer_load_dwordx4 v5, s[44:47], s38 offen nt lds
    s_mov_b32 m0, 88064
    s_add_u32 s38, s48, 294912
    buffer_load_dwordx4 v6, s[44:47], s38 offen nt lds
    s_mov_b32 m0, 89088
    s_add_u32 s38, s48, 425984
    buffer_load_dwordx4 v7, s[44:47], s38 offen nt lds
    s_mov_b32 m0, 90112
    s_add_u32 s38, s48, 65536
    buffer_load_dwordx4 v4, s[44:47], s38 offen nt lds
    s_mov_b32 m0, 91136
    s_add_u32 s38, s48, 196608
    buffer_load_dwordx4 v5, s[44:47], s38 offen nt lds
    s_mov_b32 m0, 92160
    s_add_u32 s38, s48, 327680
    buffer_load_dwordx4 v6, s[44:47], s38 offen nt lds
    s_mov_b32 m0, 93184
    s_add_u32 s38, s48, 458752
    buffer_load_dwordx4 v7, s[44:47], s38 offen nt lds
    s_mov_b32 m0, 94208
    s_add_u32 s38, s48, 98304
    buffer_load_dwordx4 v4, s[44:47], s38 offen nt lds
    s_mov_b32 m0, 95232
    s_add_u32 s38, s48, 229376
    buffer_load_dwordx4 v5, s[44:47], s38 offen nt lds
    s_mov_b32 m0, 96256
    s_add_u32 s38, s48, 360448
    buffer_load_dwordx4 v6, s[44:47], s38 offen nt lds
    s_mov_b32 m0, 97280
    s_add_u32 s38, s48, 491520
    buffer_load_dwordx4 v7, s[44:47], s38 offen nt lds

    v_mov_b32 v8, -1
    v_mov_b32 v9, -1
    v_mov_b32 v10, -1
    v_mov_b32 v11, -1
    v_lshlrev_b32 v12, 4, v1
    s_add_u32 s38, s54, 327680
    buffer_store_dwordx4 v[8:11], v12, s[40:43], s38 offen sc1
    s_add_u32 s38, s54, 589824
    buffer_store_dwordx4 v[8:11], v12, s[40:43], s38 offen sc1
    s_add_u32 s38, s54, 851968
    buffer_store_dwordx4 v[8:11], v12, s[40:43], s38 offen sc1
    s_cmp_lt_u32 s35, 28
    s_cbranch_scc1 L_C_nm
    v_lshrrev_b32 v13, 3, v1
    v_lshlrev_b32 v13, 10, v13
    v_and_b32 v14, 7, v1
    v_lshl_add_u32 v13, v14, 4, v13
    s_sub_u32 s38, s35, 28
    s_lshl_b32 s38, s38, 13
    s_lshl_b32 s39, s34, 7
    s_add_u32 s38, s38, s39
    s_add_u32 s38, s38, 8192
    buffer_store_dwordx4 v[8:11], v13, s[40:43], s38 offen sc1
L_C_nm:
    v_lshlrev_b32 v4, 2, v3
    v_xor_b32 v4, v4, v2
    v_lshlrev_b32 v4, 4, v4
    v_lshl_add_u32 v4, v2, 8, v4
    v_add_u32 v4, 81920, v4
    v_xor_b32 v5, 16, v4
    v_xor_b32 v6, 32, v4
    v_xor_b32 v7, 48, v4
    v_add_u32 v12, 131072, v12
    v_and_b32 v13, 1, v1
    v_lshlrev_b32 v14, 4, v13
    v_lshl_add_u32 v15, v3, 5, v14
    v_lshrrev_b32 v2, 1, v2
    v_lshl_add_u32 v15, v2, 15, v15
    s_mov_b32 s38, 0xffff
    v_lshlrev_b32 v14, v14, s38
    v_cmp_eq_u32 s[56:57], 1, v13
    s_lshl_b32 s49, s35, 10
    s_lshl_b32 s38, s34, 7
    s_add_u32 s49, s49, s38
    s_add_u32 s49, s49, 65536
    s_mov_b32 s50, 0x3e0293ee
    s_waitcnt vmcnt(0)
    ds_read_b128 v[104:107], v4 offset:0
    ds_read_b128 v[108:111], v5 offset:0
    ds_read_b128 v[112:115], v6 offset:0
    ds_read_b128 v[116:119], v7 offset:0
    s_waitcnt lgkmcnt(0)
    ds_read_b128 v[120:123], v4 offset:4096
    ds_read_b128 v[124:127], v5 offset:4096
    ds_read_b128 v[128:131], v6 offset:4096
    ds_read_b128 v[132:135], v7 offset:4096
    s_waitcnt lgkmcnt(0)
    ds_read_b128 v[136:139], v4 offset:8192
    ds_read_b128 v[140:143], v5 offset:8192
    ds_read_b128 v[144:147], v6 offset:8192
    ds_read_b128 v[148:151], v7 offset:8192
    s_waitcnt lgkmcnt(0)
    ds_read_b128 v[152:155], v4 offset:12288
    ds_read_b128 v[156:159], v5 offset:12288
    ds_read_b128 v[160:163], v6 offset:12288
    ds_read_b128 v[164:167], v7 offset:12288
    s_waitcnt lgkmcnt(0)
    v_mov_b32 v5, 1
    s_mov_b64 exec, 1
    ds_add_u32 v0, v5 offset:8
    s_mov_b64 exec, -1
L_w14:
    ds_read_b32 v5, v0 offset:4
    s_sub_u32 s3, s3, 1
    s_cbranch_scc1 L_end
    s_waitcnt lgkmcnt(0)
    v_cmp_gt_u32 vcc, 4, v5
    s_cbranch_vccnz L_w14
    ds_read_b128 v[40:43], v12 offset:0
    ds_read_b128 v[44:47], v12 offset:4096
    ds_read_b128 v[48:51], v12 offset:8192
    ds_read_b128 v[52:55], v12 offset:12288
    ds_read_b128 v[56:59], v12 offset:1024
    ds_read_b128 v[60:63], v12 offset:5120
    ds_read_b128 v[64:67], v12 offset:9216
    ds_read_b128 v[68:71], v12 offset:13312
    ds_read_b128 v[72:75], v12 offset:2048
    ds_read_b128 v[76:79], v12 offset:6144
    ds_read_b128 v[80:83], v12 offset:10240
    ds_read_b128 v[84:87], v12 offset:14336
    s_waitcnt lgkmcnt(8)
    ds_read_b128 v[88:91], v12 offset:3072
    ds_read_b128 v[92:95], v12 offset:7168
    ds_read_b128 v[96:99], v12 offset:11264
    ds_read_b128 v[100:103], v12 offset:15360
    s_waitcnt lgkmcnt(12)
    v_add_f32 v40, v40, v44
    v_add_f32 v48, v48, v52
    v_add_f32 v41, v41, v45
    v_add_f32 v49, v49, v53
    v_add_f32 v42, v42, v46
    v_add_f32 v50, v50, v54
    v_add_f32 v43, v43, v47
    v_add_f32 v51, v51, v55
    v_add_f32 v40, v40, v48
    v_add_f32 v41, v41, v49
    v_add_f32 v42, v42, v50
    v_add_f32 v43, v43, v51
    v_cvt_pk_bf16_f32 v40, v40, v40
    v_cvt_pk_bf16_f32 v41, v41, v41
    v_cvt_pk_bf16_f32 v42, v42, v42
    v_cvt_pk_bf16_f32 v43, v43, v43
    v_and_b32 v16, v40, v14
    v_and_b32 v20, v41, v14
    v_and_b32 v24, v42, v14
    v_and_b32 v28, v43, v14
    s_waitcnt lgkmcnt(8)
    v_add_f32 v56, v56, v60
    v_add_f32 v64, v64, v68
    v_add_f32 v57, v57, v61
    v_add_f32 v65, v65, v69
    v_add_f32 v58, v58, v62
    v_add_f32 v66, v66, v70
    v_add_f32 v59, v59, v63
    v_add_f32 v67, v67, v71
    v_add_f32 v56, v56, v64
    v_add_f32 v57, v57, v65
    v_add_f32 v58, v58, v66
    v_add_f32 v59, v59, v67
    v_cvt_pk_bf16_f32 v56, v56, v56
    v_cvt_pk_bf16_f32 v57, v57, v57
    v_cvt_pk_bf16_f32 v58, v58, v58
    v_cvt_pk_bf16_f32 v59, v59, v59
    v_and_b32 v17, v56, v14
    v_and_b32 v21, v57, v14
    v_and_b32 v25, v58, v14
    v_and_b32 v29, v59, v14
    s_waitcnt lgkmcnt(4)
    v_add_f32 v72, v72, v76
    v_add_f32 v80, v80, v84
    v_add_f32 v73, v73, v77
    v_add_f32 v81, v81, v85
    v_add_f32 v74, v74, v78
    v_add_f32 v82, v82, v86
    v_add_f32 v75, v75, v79
    v_add_f32 v83, v83, v87
    v_add_f32 v72, v72, v80
    v_add_f32 v73, v73, v81
    v_add_f32 v74, v74, v82
    v_add_f32 v75, v75, v83
    v_cvt_pk_bf16_f32 v72, v72, v72
    v_cvt_pk_bf16_f32 v73, v73, v73
    v_cvt_pk_bf16_f32 v74, v74, v74
    v_cvt_pk_bf16_f32 v75, v75, v75
    v_and_b32 v18, v72, v14
    v_and_b32 v22, v73, v14
    v_and_b32 v26, v74, v14
    v_and_b32 v30, v75, v14
    s_waitcnt lgkmcnt(0)
    v_add_f32 v88, v88, v92
    v_add_f32 v96, v96, v100
    v_add_f32 v89, v89, v93
    v_add_f32 v97, v97, v101
    v_add_f32 v90, v90, v94
    v_add_f32 v98, v98, v102
    v_add_f32 v91, v91, v95
    v_add_f32 v99, v99, v103
    v_add_f32 v88, v88, v96
    v_add_f32 v89, v89, v97
    v_add_f32 v90, v90, v98
    v_add_f32 v91, v91, v99
    v_cvt_pk_bf16_f32 v88, v88, v88
    v_cvt_pk_bf16_f32 v89, v89, v89
    v_cvt_pk_bf16_f32 v90, v90, v90
    v_cvt_pk_bf16_f32 v91, v91, v91
    v_and_b32 v19, v88, v14
    v_and_b32 v23, v89, v14
    v_and_b32 v27, v90, v14
    v_and_b32 v31, v91, v14
    v_mfma_f32_16x16x32_bf16 v[40:43], v[104:107], v[16:19], 0
    v_mfma_f32_16x16x32_bf16 v[44:47], v[120:123], v[16:19], 0
    v_mfma_f32_16x16x32_bf16 v[48:51], v[136:139], v[16:19], 0
    v_mfma_f32_16x16x32_bf16 v[52:55], v[152:155], v[16:19], 0
    v_mfma_f32_16x16x32_bf16 v[40:43], v[108:111], v[20:23], v[40:43]
    v_mfma_f32_16x16x32_bf16 v[44:47], v[124:127], v[20:23], v[44:47]
    v_mfma_f32_16x16x32_bf16 v[48:51], v[140:143], v[20:23], v[48:51]
    v_mfma_f32_16x16x32_bf16 v[52:55], v[156:159], v[20:23], v[52:55]
    v_mfma_f32_16x16x32_bf16 v[40:43], v[112:115], v[24:27], v[40:43]
    v_mfma_f32_16x16x32_bf16 v[44:47], v[128:131], v[24:27], v[44:47]
    v_mfma_f32_16x16x32_bf16 v[48:51], v[144:147], v[24:27], v[48:51]
    v_mfma_f32_16x16x32_bf16 v[52:55], v[160:163], v[24:27], v[52:55]
    v_mfma_f32_16x16x32_bf16 v[40:43], v[116:119], v[28:31], v[40:43]
    v_mfma_f32_16x16x32_bf16 v[44:47], v[132:135], v[28:31], v[44:47]
    v_mfma_f32_16x16x32_bf16 v[48:51], v[148:151], v[28:31], v[48:51]
    v_mfma_f32_16x16x32_bf16 v[52:55], v[164:167], v[28:31], v[52:55]
    s_nop 4
    v_add_f32_dpp v40, v40, v40 quad_perm:[1,0,3,2] row_mask:0xf bank_mask:0xf
    v_add_f32_dpp v41, v41, v41 quad_perm:[1,0,3,2] row_mask:0xf bank_mask:0xf
    v_add_f32_dpp v42, v42, v42 quad_perm:[1,0,3,2] row_mask:0xf bank_mask:0xf
    v_add_f32_dpp v43, v43, v43 quad_perm:[1,0,3,2] row_mask:0xf bank_mask:0xf
    v_add_f32_dpp v44, v44, v44 quad_perm:[1,0,3,2] row_mask:0xf bank_mask:0xf
    v_add_f32_dpp v45, v45, v45 quad_perm:[1,0,3,2] row_mask:0xf bank_mask:0xf
    v_add_f32_dpp v46, v46, v46 quad_perm:[1,0,3,2] row_mask:0xf bank_mask:0xf
    v_add_f32_dpp v47, v47, v47 quad_perm:[1,0,3,2] row_mask:0xf bank_mask:0xf
    v_add_f32_dpp v48, v48, v48 quad_perm:[1,0,3,2] row_mask:0xf bank_mask:0xf
    v_add_f32_dpp v49, v49, v49 quad_perm:[1,0,3,2] row_mask:0xf bank_mask:0xf
    v_add_f32_dpp v50, v50, v50 quad_perm:[1,0,3,2] row_mask:0xf bank_mask:0xf
    v_add_f32_dpp v51, v51, v51 quad_perm:[1,0,3,2] row_mask:0xf bank_mask:0xf
    v_add_f32_dpp v52, v52, v52 quad_perm:[1,0,3,2] row_mask:0xf bank_mask:0xf
    v_add_f32_dpp v53, v53, v53 quad_perm:[1,0,3,2] row_mask:0xf bank_mask:0xf
    v_add_f32_dpp v54, v54, v54 quad_perm:[1,0,3,2] row_mask:0xf bank_mask:0xf
    v_add_f32_dpp v55, v55, v55 quad_perm:[1,0,3,2] row_mask:0xf bank_mask:0xf
    v_cndmask_b32 v40, v40, v48, s[56:57]
    v_cndmask_b32 v41, v41, v49, s[56:57]
    v_cndmask_b32 v42, v42, v50, s[56:57]
    v_cndmask_b32 v43, v43, v51, s[56:57]
    v_cndmask_b32 v44, v44, v52, s[56:57]
    v_cndmask_b32 v45, v45, v53, s[56:57]
    v_cndmask_b32 v46, v46, v54, s[56:57]
    v_cndmask_b32 v47, v47, v55, s[56:57]
    v_mul_f32 v40, s50, v40
    v_mul_f32 v41, s50, v41
    v_mul_f32 v42, s50, v42
    v_mul_f32 v43, s50, v43
    v_mul_f32 v44, s50, v44
    v_mul_f32 v45, s50, v45
    v_mul_f32 v46, s50, v46
    v_mul_f32 v47, s50, v47
    v_cvt_pk_bf16_f32 v40, v40, v41
    v_cvt_pk_bf16_f32 v41, v42, v43
    v_cvt_pk_bf16_f32 v42, v44, v45
    v_cvt_pk_bf16_f32 v43, v46, v47
    buffer_store_dwordx4 v[40:43], v15, s[40:43], s49 offen sc1
    s_waitcnt vmcnt(0)
    v_mov_b32 v5, 1
    s_mov_b64 exec, 1
    ds_add_u32 v0, v5 offset:3036
    s_mov_b64 exec, -1
L_C_t:
    s_mov_b32 s44, s14
    s_mov_b32 s45, s15
    s_mov_b32 s46, 4194304
    s_mov_b32 s47, 0x20000

    v_lshrrev_b32 v4, 4, v1
    v_and_b32 v5, 15, v1
    v_lshlrev_b32 v2, 15, v4
    v_lshl_add_u32 v2, v5, 4, v2
    s_lshl_b32 s48, s35, 17
    s_lshl_b32 s38, s33, 8
    s_add_u32 s48, s48, s38
L_w15:
    s_sleep 1
    ds_read_b32 v6, v0 offset:1012
    s_sub_u32 s3, s3, 1
    s_cbranch_scc1 L_end
    s_waitcnt lgkmcnt(0)
    v_cmp_gt_u32 vcc, 4, v6
    s_cbranch_vccnz L_w15
    s_xor_b32 s38, s34, 0
    s_lshl_b32 s38, s38, 12
    s_add_u32 s38, s38, s48
    buffer_load_dwordx4 v[40:43], v2, s[44:47], s38 offen offset:0 nt
    buffer_load_dwordx4 v[44:47], v2, s[44:47], s38 offen offset:1024 nt
    buffer_load_dwordx4 v[48:51], v2, s[44:47], s38 offen offset:2048 nt
    buffer_load_dwordx4 v[52:55], v2, s[44:47], s38 offen offset:3072 nt
    s_waitcnt vmcnt(3)
    s_xor_b32 s38, s34, 1
    s_lshl_b32 s38, s38, 12
    s_add_u32 s38, s38, s48
    buffer_load_dwordx4 v[56:59], v2, s[44:47], s38 offen offset:0 nt
    s_waitcnt vmcnt(3)
    buffer_load_dwordx4 v[60:63], v2, s[44:47], s38 offen offset:1024 nt
    s_waitcnt vmcnt(3)
    buffer_load_dwordx4 v[64:67], v2, s[44:47], s38 offen offset:2048 nt
    s_waitcnt vmcnt(3)
    buffer_load_dwordx4 v[68:71], v2, s[44:47], s38 offen offset:3072 nt
    s_waitcnt vmcnt(3)
    v_swap_b32 v41, v44
    v_swap_b32 v42, v48
    v_swap_b32 v43, v52
    v_swap_b32 v46, v49
    v_swap_b32 v47, v53
    v_swap_b32 v51, v54
    s_xor_b32 s38, s34, 2
    s_lshl_b32 s38, s38, 12
    s_add_u32 s38, s38, s48
    buffer_load_dwordx4 v[72:75], v2, s[44:47], s38 offen offset:0 nt
    s_waitcnt vmcnt(3)
    buffer_load_dwordx4 v[76:79], v2, s[44:47], s38 offen offset:1024 nt
    s_waitcnt vmcnt(3)
    buffer_load_dwordx4 v[80:83], v2, s[44:47], s38 offen offset:2048 nt
    s_waitcnt vmcnt(3)
    buffer_load_dwordx4 v[84:87], v2, s[44:47], s38 offen offset:3072 nt
    s_waitcnt vmcnt(3)
    v_swap_b32 v57, v60
    v_swap_b32 v58, v64
    v_swap_b32 v59, v68
    v_swap_b32 v62, v65
    v_swap_b32 v63, v69
    v_swap_b32 v67, v70
    s_xor_b32 s38, s34, 3
    s_lshl_b32 s38, s38, 12
    s_add_u32 s38, s38, s48
    buffer_load_dwordx4 v[88:91], v2, s[44:47], s38 offen offset:0 nt
    s_waitcnt vmcnt(3)
    buffer_load_dwordx4 v[92:95], v2, s[44:47], s38 offen offset:1024 nt
    s_waitcnt vmcnt(3)
    buffer_load_dwordx4 v[96:99], v2, s[44:47], s38 offen offset:2048 nt
    s_waitcnt vmcnt(3)
    buffer_load_dwordx4 v[100:103], v2, s[44:47], s38 offen offset:3072 nt
    s_waitcnt vmcnt(3)
    v_swap_b32 v73, v76
    v_swap_b32 v74, v80
    v_swap_b32 v75, v84
    v_swap_b32 v78, v81
    v_swap_b32 v79, v85
    v_swap_b32 v83, v86
    s_xor_b32 s38, s34, 4
    s_lshl_b32 s38, s38, 12
    s_add_u32 s38, s38, s48
    buffer_load_dwordx4 v[104:107], v2, s[44:47], s38 offen offset:0 nt
    s_waitcnt vmcnt(3)
    buffer_load_dwordx4 v[108:111], v2, s[44:47], s38 offen offset:1024 nt
    s_waitcnt vmcnt(3)
    buffer_load_dwordx4 v[112:115], v2, s[44:47], s38 offen offset:2048 nt
    s_waitcnt vmcnt(3)
    buffer_load_dwordx4 v[116:119], v2, s[44:47], s38 offen offset:3072 nt
    s_waitcnt vmcnt(3)
    v_swap_b32 v89, v92
    v_swap_b32 v90, v96
    v_swap_b32 v91, v100
    v_swap_b32 v94, v97
    v_swap_b32 v95, v101
    v_swap_b32 v99, v102
    s_xor_b32 s38, s34, 5
    s_lshl_b32 s38, s38, 12
    s_add_u32 s38, s38, s48
    buffer_load_dwordx4 v[120:123], v2, s[44:47], s38 offen offset:0 nt
    s_waitcnt vmcnt(3)
    buffer_load_dwordx4 v[124:127], v2, s[44:47], s38 offen offset:1024 nt
    s_waitcnt vmcnt(3)
    buffer_load_dwordx4 v[128:131], v2, s[44:47], s38 offen offset:2048 nt
    s_waitcnt vmcnt(3)
    buffer_load_dwordx4 v[132:135], v2, s[44:47], s38 offen offset:3072 nt
    s_waitcnt vmcnt(3)
    v_swap_b32 v105, v108
    v_swap_b32 v106, v112
    v_swap_b32 v107, v116
    v_swap_b32 v110, v113
    v_swap_b32 v111, v117
    v_swap_b32 v115, v118
    s_xor_b32 s38, s34, 6
    s_lshl_b32 s38, s38, 12
    s_add_u32 s38, s38, s48
    buffer_load_dwordx4 v[136:139], v2, s[44:47], s38 offen offset:0 nt
    s_waitcnt vmcnt(3)
    buffer_load_dwordx4 v[140:143], v2, s[44:47], s38 offen offset:1024 nt
    s_waitcnt vmcnt(3)
    buffer_load_dwordx4 v[144:147], v2, s[44:47], s38 offen offset:2048 nt
    s_waitcnt vmcnt(3)
    buffer_load_dwordx4 v[148:151], v2, s[44:47], s38 offen offset:3072 nt
    s_waitcnt vmcnt(3)
    v_swap_b32 v121, v124
    v_swap_b32 v122, v128
    v_swap_b32 v123, v132
    v_swap_b32 v126, v129
    v_swap_b32 v127, v133
    v_swap_b32 v131, v134
    s_xor_b32 s38, s34, 7
    s_lshl_b32 s38, s38, 12
    s_add_u32 s38, s38, s48
    buffer_load_dwordx4 v[152:155], v2, s[44:47], s38 offen offset:0 nt
    s_waitcnt vmcnt(3)
    buffer_load_dwordx4 v[156:159], v2, s[44:47], s38 offen offset:1024 nt
    s_waitcnt vmcnt(3)
    buffer_load_dwordx4 v[160:163], v2, s[44:47], s38 offen offset:2048 nt
    s_waitcnt vmcnt(3)
    buffer_load_dwordx4 v[164:167], v2, s[44:47], s38 offen offset:3072 nt
    s_waitcnt vmcnt(3)
    v_swap_b32 v137, v140
    v_swap_b32 v138, v144
    v_swap_b32 v139, v148
    v_swap_b32 v142, v145
    v_swap_b32 v143, v149
    v_swap_b32 v147, v150

    s_sub_u32 s56, s32, 4
    s_cmp_lt_u32 s35, 28
    s_cselect_b32 s48, s18, s24
    s_cselect_b32 s49, s19, s25
    s_movk_i32 s57, 6144
    s_cselect_b32 s57, 3584, s57
    s_mul_i32 s50, s57, 512
    s_mov_b32 s51, 0x20000
    s_lshl_b32 s58, s35, 7
    s_sub_u32 s38, s35, 26
    s_lshl_b32 s38, s38, 10
    s_lshl_b32 s39, s34, 7
    s_add_u32 s38, s38, s39
    s_cmp_lt_u32 s35, 28
    s_cselect_b32 s58, s58, s38
    v_lshrrev_b32 v4, 3, v1
    v_mul_lo_u32 v5, v4, s57
    v_bfe_u32 v4, v4, 1, 1
    s_and_b32 s38, s56, 1
    s_lshl_b32 s38, s38, 1
    v_or_b32 v4, s38, v4
    v_lshlrev_b32 v4, 1, v4
    v_and_b32 v6, 7, v1
    v_xor_b32 v4, v4, v6
    v_lshl_add_u32 v4, v4, 4, v5
    s_lshl_b32 s38, s56, 5
    v_lshlrev_b32 v5, 4, v1
    v_xor_b32 v5, s38, v5
    s_lshl_b32 s57, s57, 3

L_w16:
    s_sleep 1
    ds_read_b32 v6, v0 offset:1020
    s_sub_u32 s3, s3, 1
    s_cbranch_scc1 L_end
    s_waitcnt lgkmcnt(0)
    v_cmp_gt_u32 vcc, 4, v6
    s_cbranch_vccnz L_w16
    s_mov_b32 s59, 0
L_C_f1:
    s_xor_b32 s38, s59, s34
    s_lshl_b32 s38, s38, 3
    s_add_u32 s38, s38, s56
    s_lshl_b32 m0, s38, 10
    s_mul_i32 s38, s38, s57
    s_add_u32 s38, s38, s58
    buffer_load_dwordx4 v4, s[48:51], s38 offen nt lds
    s_waitcnt vmcnt(3)
    s_add_u32 s59, s59, 1
    s_cmp_lt_u32 s59, 8
    s_cbranch_scc1 L_C_f1
    s_cmp_ge_u32 s35, 28
    s_cbranch_scc1 L_C_f3
    s_mov_b32 s48, s20
    s_mov_b32 s49, s21
    s_and_b32 s38, s56, 3
    s_lshr_b32 s39, s56, 2
    s_lshl_b32 s39, s39, 3
    s_add_u32 s56, s38, s39
    s_lshl_b32 s58, s35, 16
    s_mov_b32 s59, 0
L_C_f2:
    s_xor_b32 s38, s59, s34
    s_and_b32 s39, s38, 1
    s_lshl_b32 s39, s39, 2
    s_lshr_b32 s38, s38, 1
    s_lshl_b32 s38, s38, 4
    s_add_u32 s38, s38, s39
    s_add_u32 s38, s38, s56
    s_lshl_b32 s38, s38, 10
    s_add_u32 m0, s38, 65536
    s_add_u32 s38, s38, s58
    buffer_load_dwordx4 v5, s[48:51], s38 offen nt lds
    s_waitcnt vmcnt(3)
    s_add_u32 s59, s59, 1
    s_cmp_lt_u32 s59, 8
    s_cbranch_scc1 L_C_f2
L_C_f3:

    v_swap_b32 v153, v156
    v_swap_b32 v154, v160
    v_swap_b32 v155, v164
    v_swap_b32 v158, v161
    v_swap_b32 v159, v165
    v_swap_b32 v163, v166

    v_and_b32 v2, 7, v1
    v_xor_b32 v2, s34, v2
    v_lshlrev_b32 v2, 4, v2
    v_lshrrev_b32 v4, 4, v1
    v_lshl_add_u32 v2, v4, 7, v2
    v_bfe_u32 v4, v1, 3, 1
    v_lshl_add_u32 v2, v4, 10, v2
    v_add_u32 v2, 144896, v2
    v_and_b32 v3, 1, v1
    v_lshlrev_b32 v3, 4, v3
    s_mov_b32 s38, 0xffff
    v_lshlrev_b32 v3, v3, s38
    v_lshlrev_b32 v4, 4, v1
    s_lshl_b32 s38, s33, 8
    s_add_u32 s48, s54, s38
    s_add_u32 s48, s48, 589824
    s_waitcnt vmcnt(0)
    v_mov_b32 v6, 1
    s_mov_b64 exec, 1
    ds_add_u32 v0, v6 offset:3032
    s_mov_b64 exec, -1
L_w17:
    ds_read_b32 v6, v0 offset:3024
    s_sub_u32 s3, s3, 1
    s_cbranch_scc1 L_end
    s_waitcnt lgkmcnt(0)
    v_cmp_gt_u32 vcc, 4, v6
    s_cbranch_vccnz L_w17
    ds_read_b128 v[8:11], v2
    ds_read_b128 v[12:15], v2 offset:512
    s_waitcnt lgkmcnt(0)
    v_add_f32 v8, v8, v12
    v_add_f32 v9, v9, v13
    v_add_f32 v10, v10, v14
    v_add_f32 v11, v11, v15
    v_add_f32_dpp v8, v8, v8 row_ror:8 row_mask:0xf bank_mask:0xf
    v_add_f32_dpp v9, v9, v9 row_ror:8 row_mask:0xf bank_mask:0xf
    v_add_f32_dpp v10, v10, v10 row_ror:8 row_mask:0xf bank_mask:0xf
    v_add_f32_dpp v11, v11, v11 row_ror:8 row_mask:0xf bank_mask:0xf
    v_cvt_pk_bf16_f32 v8, v8, v8
    v_cvt_pk_bf16_f32 v9, v9, v9
    v_cvt_pk_bf16_f32 v10, v10, v10
    v_cvt_pk_bf16_f32 v11, v11, v11
    v_and_b32_dpp v16, v8, v3 row_newbcast:0 row_mask:0xf bank_mask:0xf
    v_and_b32_dpp v17, v9, v3 row_newbcast:0 row_mask:0xf bank_mask:0xf
    v_and_b32_dpp v18, v10, v3 row_newbcast:0 row_mask:0xf bank_mask:0xf
    v_and_b32_dpp v19, v11, v3 row_newbcast:0 row_mask:0xf bank_mask:0xf
    s_nop 1
    v_mfma_f32_16x16x32_bf16 v[24:27], v[16:19], v[40:43], 0
    v_and_b32_dpp v20, v8, v3 row_newbcast:1 row_mask:0xf bank_mask:0xf
    v_and_b32_dpp v21, v9, v3 row_newbcast:1 row_mask:0xf bank_mask:0xf
    v_mfma_f32_16x16x32_bf16 v[28:31], v[16:19], v[44:47], 0
    v_and_b32_dpp v22, v10, v3 row_newbcast:1 row_mask:0xf bank_mask:0xf
    v_and_b32_dpp v23, v11, v3 row_newbcast:1 row_mask:0xf bank_mask:0xf
    v_mfma_f32_16x16x32_bf16 v[32:35], v[16:19], v[48:51], 0
    v_mfma_f32_16x16x32_bf16 v[36:39], v[16:19], v[52:55], 0
    v_mfma_f32_16x16x32_bf16 v[24:27], v[20:23], v[56:59], v[24:27]
    v_and_b32_dpp v16, v8, v3 row_newbcast:2 row_mask:0xf bank_mask:0xf
    v_and_b32_dpp v17, v9, v3 row_newbcast:2 row_mask:0xf bank_mask:0xf
    v_mfma_f32_16x16x32_bf16 v[28:31], v[20:23], v[60:63], v[28:31]
    v_and_b32_dpp v18, v10, v3 row_newbcast:2 row_mask:0xf bank_mask:0xf
    v_and_b32_dpp v19, v11, v3 row_newbcast:2 row_mask:0xf bank_mask:0xf
    v_mfma_f32_16x16x32_bf16 v[32:35], v[20:23], v[64:67], v[32:35]
    v_mfma_f32_16x16x32_bf16 v[36:39], v[20:23], v[68:71], v[36:39]
    v_mfma_f32_16x16x32_bf16 v[24:27], v[16:19], v[72:75], v[24:27]
    v_and_b32_dpp v20, v8, v3 row_newbcast:3 row_mask:0xf bank_mask:0xf
    v_and_b32_dpp v21, v9, v3 row_newbcast:3 row_mask:0xf bank_mask:0xf
    v_mfma_f32_16x16x32_bf16 v[28:31], v[16:19], v[76:79], v[28:31]
    v_and_b32_dpp v22, v10, v3 row_newbcast:3 row_mask:0xf bank_mask:0xf
    v_and_b32_dpp v23, v11, v3 row_newbcast:3 row_mask:0xf bank_mask:0xf
    v_mfma_f32_16x16x32_bf16 v[32:35], v[16:19], v[80:83], v[32:35]
    v_mfma_f32_16x16x32_bf16 v[36:39], v[16:19], v[84:87], v[36:39]
    v_mfma_f32_16x16x32_bf16 v[24:27], v[20:23], v[88:91], v[24:27]
    v_and_b32_dpp v16, v8, v3 row_newbcast:4 row_mask:0xf bank_mask:0xf
    v_and_b32_dpp v17, v9, v3 row_newbcast:4 row_mask:0xf bank_mask:0xf
    v_mfma_f32_16x16x32_bf16 v[28:31], v[20:23], v[92:95], v[28:31]
    v_and_b32_dpp v18, v10, v3 row_newbcast:4 row_mask:0xf bank_mask:0xf
    v_and_b32_dpp v19, v11, v3 row_newbcast:4 row_mask:0xf bank_mask:0xf
    v_mfma_f32_16x16x32_bf16 v[32:35], v[20:23], v[96:99], v[32:35]
    v_mfma_f32_16x16x32_bf16 v[36:39], v[20:23], v[100:103], v[36:39]
    v_mfma_f32_16x16x32_bf16 v[24:27], v[16:19], v[104:107], v[24:27]
    v_and_b32_dpp v20, v8, v3 row_newbcast:5 row_mask:0xf bank_mask:0xf
    v_and_b32_dpp v21, v9, v3 row_newbcast:5 row_mask:0xf bank_mask:0xf
    v_mfma_f32_16x16x32_bf16 v[28:31], v[16:19], v[108:111], v[28:31]
    v_and_b32_dpp v22, v10, v3 row_newbcast:5 row_mask:0xf bank_mask:0xf
    v_and_b32_dpp v23, v11, v3 row_newbcast:5 row_mask:0xf bank_mask:0xf
    v_mfma_f32_16x16x32_bf16 v[32:35], v[16:19], v[112:115], v[32:35]
    v_mfma_f32_16x16x32_bf16 v[36:39], v[16:19], v[116:119], v[36:39]
    v_mfma_f32_16x16x32_bf16 v[24:27], v[20:23], v[120:123], v[24:27]
    v_and_b32_dpp v16, v8, v3 row_newbcast:6 row_mask:0xf bank_mask:0xf
    v_and_b32_dpp v17, v9, v3 row_newbcast:6 row_mask:0xf bank_mask:0xf
    v_mfma_f32_16x16x32_bf16 v[28:31], v[20:23], v[124:127], v[28:31]
    v_and_b32_dpp v18, v10, v3 row_newbcast:6 row_mask:0xf bank_mask:0xf
    v_and_b32_dpp v19, v11, v3 row_newbcast:6 row_mask:0xf bank_mask:0xf
    v_mfma_f32_16x16x32_bf16 v[32:35], v[20:23], v[128:131], v[32:35]
    v_mfma_f32_16x16x32_bf16 v[36:39], v[20:23], v[132:135], v[36:39]
    v_mfma_f32_16x16x32_bf16 v[24:27], v[16:19], v[136:139], v[24:27]
    v_and_b32_dpp v20, v8, v3 row_newbcast:7 row_mask:0xf bank_mask:0xf
    v_and_b32_dpp v21, v9, v3 row_newbcast:7 row_mask:0xf bank_mask:0xf
    v_mfma_f32_16x16x32_bf16 v[28:31], v[16:19], v[140:143], v[28:31]
    v_and_b32_dpp v22, v10, v3 row_newbcast:7 row_mask:0xf bank_mask:0xf
    v_and_b32_dpp v23, v11, v3 row_newbcast:7 row_mask:0xf bank_mask:0xf
    v_mfma_f32_16x16x32_bf16 v[32:35], v[16:19], v[144:147], v[32:35]
    v_mfma_f32_16x16x32_bf16 v[36:39], v[16:19], v[148:151], v[36:39]
    v_mfma_f32_16x16x32_bf16 v[24:27], v[20:23], v[152:155], v[24:27]
    v_mfma_f32_16x16x32_bf16 v[28:31], v[20:23], v[156:159], v[28:31]
    v_mfma_f32_16x16x32_bf16 v[32:35], v[20:23], v[160:163], v[32:35]
    v_mfma_f32_16x16x32_bf16 v[36:39], v[20:23], v[164:167], v[36:39]
    s_nop 4
    v_cvt_pk_bf16_f32 v8, v24, v25
    v_cvt_pk_bf16_f32 v9, v28, v29
    v_cvt_pk_bf16_f32 v10, v32, v33
    v_cvt_pk_bf16_f32 v11, v36, v37
    s_mov_b64 exec, 0xffff
    buffer_store_dwordx4 v[8:11], v4, s[40:43], s48 offen sc1
    s_mov_b64 exec, -1
    s_waitcnt vmcnt(0)
    v_mov_b32 v6, 1
    s_mov_b64 exec, 1
    ds_add_u32 v0, v6 offset:3028
    s_mov_b64 exec, -1
L_end:
L_exit:
    s_endpgm
L_codeend:
.section .rodata,"a"
.p2align 6
.amdhsa_kernel adaLN_cond__compressed_kv_cla__dense_activation_relu__decode_kernel
.amdhsa_next_free_vgpr 168
.amdhsa_next_free_sgpr 102
.amdhsa_accum_offset 168
.amdhsa_group_segment_fixed_size 0
.amdhsa_kernarg_size 112
.amdhsa_user_sgpr_count 2
.amdhsa_user_sgpr_kernarg_segment_ptr 1
.amdhsa_system_sgpr_workgroup_id_x 1
.amdhsa_float_denorm_mode_32 3
.end_amdhsa_kernel
.text
```

```asm
; @launch grid=(256,1,1) block=(768,1,1) lds=163840
.amdgcn_target "amdgcn-amd-amdhsa--gfx950"
.text
.globl adaLN_cond__compressed_kv_cla__dense_activation_relu__decode_kernel
.p2align 8
.type adaLN_cond__compressed_kv_cla__dense_activation_relu__decode_kernel,@function
adaLN_cond__compressed_kv_cla__dense_activation_relu__decode_kernel:

    s_cmpk_ge_u32 s2, 256
    s_cbranch_scc1 L_exit
    s_load_dwordx16 s[4:19], s[0:1], 0
    s_load_dwordx8 s[20:27], s[0:1], 64
    s_load_dwordx4 s[28:31], s[0:1], 96
    v_lshrrev_b32 v2, 6, v0
    v_and_b32 v1, 63, v0
    v_readfirstlane_b32 s32, v2
    s_lshr_b32 s37, s2, 3
    s_getpc_b64 s[52:53]
L_pc:
    s_mul_i32 s38, s37, 12
    s_add_u32 s38, s38, s32
    s_lshl_b32 s38, s38, 7
    s_min_u32 s38, s38, L_codeend-L_pc-4
    v_mov_b32 v2, s38
    global_load_dword v167, v2, s[52:53]
    s_and_b32 s36, s2, 7
    s_and_b32 s34, s37, 7
    s_lshr_b32 s37, s37, 3
    s_lshl3_add_u32 s35, s37, s36
    s_and_b32 s33, s32, 3
    s_cmp_lt_u32 s32, 4
    s_cbranch_scc1 L_pA
    s_cmp_lt_u32 s32, 8
    s_cbranch_scc1 L_pB
    s_cmp_eq_u32 s34, 4
    s_cbranch_scc1 L_Cs
    s_branch L_Co
L_pB:
    s_cmp_lt_u32 s34, 4
    s_cbranch_scc1 L_Bc
    s_branch L_Be
L_pA:
    s_cmp_lg_u32 s32, 0
    s_cbranch_scc1 L_A
    s_cmp_lt_u32 s34, 4
    s_cbranch_scc1 L_pT
    s_cmp_lg_u32 s34, 4
    s_cbranch_scc1 L_A
    v_lshlrev_b32 v2, 7, v1
    s_waitcnt lgkmcnt(0)
    global_load_dword v166, v2, s[22:23]
    global_load_dword v166, v2, s[4:5]
    s_branch L_A
L_pT:
    v_and_b32 v3, 1, v1
    v_lshrrev_b32 v2, 1, v1
    s_lshl2_add_u32 s38, s37, s34
    v_lshl_add_u32 v2, s38, 5, v2
    v_mul_u32_u24 v2, 6, v2
    v_add_u32 v2, v2, v3
    s_lshl_b32 s39, s36, 7
    v_lshl_add_u32 v2, v2, 10, s39
    s_waitcnt lgkmcnt(0)
    global_load_dword v166, v2, s[24:25]

L_A:
    v_mov_b32 v8, -1
    v_mov_b32 v9, -1
    v_mov_b32 v10, -1
    v_mov_b32 v11, -1
    v_lshlrev_b32 v14, 4, v1
    s_waitcnt lgkmcnt(0)
    s_mov_b32 s40, s30
    s_mov_b32 s41, s31
    s_mov_b32 s42, 16777216
    s_mov_b32 s43, 0x20000

    s_mov_b32 s3, 0x400000
    v_mov_b32 v0, 156256
    s_lshl_b32 s54, s34, 5
    s_add_u32 s54, s54, s35
    s_lshl_b32 s54, s54, 10
    s_and_b32 s96, s36, 3
    s_and_b32 s39, s34, 4
    s_add_u32 s96, s96, s39

    s_xor_b32 s38, s2, 40
    s_or_b32 s38, s38, s33
    s_cbranch_scc1 L_A_nx
    s_movk_i32 s39, 4096
    buffer_store_dwordx4 v[8:11], v14, s[40:43], 0 offen offset:0 sc1
    buffer_store_dwordx4 v[8:11], v14, s[40:43], 0 offen offset:1024 sc1
    buffer_store_dwordx4 v[8:11], v14, s[40:43], 0 offen offset:2048 sc1
    buffer_store_dwordx4 v[8:11], v14, s[40:43], 0 offen offset:3072 sc1
    buffer_store_dwordx4 v[8:11], v14, s[40:43], s39 offen offset:0 sc1
    buffer_store_dwordx4 v[8:11], v14, s[40:43], s39 offen offset:1024 sc1
    buffer_store_dwordx4 v[8:11], v14, s[40:43], s39 offen offset:2048 sc1
    buffer_store_dwordx4 v[8:11], v14, s[40:43], s39 offen offset:3072 sc1
L_A_nx:
    s_xor_b32 s38, s34, 4
    s_xor_b32 s39, s33, 1
    s_or_b32 s38, s38, s39
    s_cbranch_scc1 L_A_nc
    s_lshl_b32 s55, s36, 2
    s_add_u32 s55, s55, s37
    s_lshl_b32 s38, s55, 13
    s_add_u32 s38, s38, 65536
    s_add_u32 s39, s38, 4096
    buffer_store_dwordx4 v[8:11], v14, s[40:43], s38 offen offset:0 sc1
    buffer_store_dwordx4 v[8:11], v14, s[40:43], s38 offen offset:1024 sc1
    buffer_store_dwordx4 v[8:11], v14, s[40:43], s38 offen offset:2048 sc1
    buffer_store_dwordx4 v[8:11], v14, s[40:43], s38 offen offset:3072 sc1
    buffer_store_dwordx4 v[8:11], v14, s[40:43], s39 offen offset:0 sc1
    buffer_store_dwordx4 v[8:11], v14, s[40:43], s39 offen offset:1024 sc1
    buffer_store_dwordx4 v[8:11], v14, s[40:43], s39 offen offset:2048 sc1
    buffer_store_dwordx4 v[8:11], v14, s[40:43], s39 offen offset:3072 sc1
L_A_nc:
    s_cmp_lg_u32 s33, 3
    s_cbranch_scc1 L_noinit
    v_mul_u32_u24 v13, 1008, v1
    v_mov_b32 v4, 0
    v_add_u32 v13, v13, v0
    v_mov_b32 v5, v4
    v_mov_b32 v6, v4
    v_mov_b32 v7, v4
    v_add_u32 v12, v14, v0
    s_mov_b64 exec, 0xff
    ds_write_b128 v13, v[4:7]
    s_mov_b32 exec_lo, -1
    ds_write_b128 v12, v[8:11] offset:7072
    s_mov_b64 exec, -1
L_noinit:
    s_mov_b32 s44, s6
    s_mov_b32 s45, s7
    s_mov_b32 s46, 33554432
    s_mov_b32 s47, 0x20000

    s_and_b32 s97, s36, 4
    s_and_b32 s39, s34, 3
    s_add_u32 s97, s97, s39
    s_lshl_b32 s97, s97, 2
    s_add_u32 s97, s97, s37
    s_lshl_b32 s61, s96, 5
    s_add_u32 s61, s61, s97
    s_lshl_b32 s61, s61, 10
    v_lshrrev_b32 v4, 3, v1
    v_bfe_u32 v5, v4, 1, 1
    v_lshlrev_b32 v5, 2, v5
    v_bfe_u32 v6, v4, 2, 1
    v_or_b32 v5, v5, v6
    v_and_b32 v6, 7, v1
    v_xor_b32 v5, v5, v6
    v_lshlrev_b32 v5, 4, v5
    v_lshl_add_u32 v2, v4, 10, v5
    v_xor_b32 v3, 32, v2
    s_lshl_b32 s48, s61, 7
    s_lshl_b32 s38, s33, 15
    s_add_u32 s48, s48, s38
    s_lshl_b32 s49, s33, 12
    s_mov_b32 s50, 0
    s_cmp_lt_u32 s34, 5
    s_cselect_b32 s52, 8, 8
    s_waitcnt lgkmcnt(0)
    s_barrier
    s_cmp_lt_u32 s34, 5
    s_cbranch_scc1 L_A_hold
    s_xor_b32 s38, s2, 40
    s_or_b32 s38, s38, s33
    s_cbranch_scc1 L_A_nx2
    s_mov_b64 exec, 1
    s_waitcnt vmcnt(0)
    global_store_dword v14, v8, s[28:29] sc1
    s_mov_b64 exec, -1
L_A_nx2:
L_A_go:
L_A_dma:
    s_cmp_lg_u32 s50, 6
    s_cbranch_scc1 L_A_dma1
L_w1:
    ds_read_b32 v8, v0 offset:8
    s_sub_u32 s3, s3, 1
    s_cbranch_scc1 L_end
    s_waitcnt lgkmcnt(0)
    v_cmp_gt_u32 vcc, 4, v8
    s_cbranch_vccnz L_w1
L_A_dma1:
    s_add_u32 m0, s49, 0
    s_add_u32 s38, s48, 0
    buffer_load_dwordx4 v2, s[44:47], s38 offen nt lds
    s_waitcnt vmcnt(7)
    s_add_u32 m0, s49, 1024
    s_add_u32 s38, s48, 8192
    buffer_load_dwordx4 v3, s[44:47], s38 offen nt lds
    s_waitcnt vmcnt(7)
    s_add_u32 m0, s49, 2048
    s_add_u32 s38, s48, 16384
    buffer_load_dwordx4 v2, s[44:47], s38 offen nt lds
    s_waitcnt vmcnt(7)
    s_add_u32 m0, s49, 3072
    s_add_u32 s38, s48, 24576
    buffer_load_dwordx4 v3, s[44:47], s38 offen nt lds
    s_waitcnt vmcnt(7)
    s_add_u32 s49, s49, 16384
    s_add_u32 s48, s48, 128
    s_add_u32 s50, s50, 1
L_A_dma3:
    s_cmp_lt_u32 s50, 8
    s_cbranch_scc1 L_A_dma
    s_branch L_A_iss
L_A_hold:
    s_xor_b32 s38, s34, 4
    s_xor_b32 s39, s33, 1
    s_or_b32 s38, s38, s39
    s_cbranch_scc1 L_A_hold1
L_w2:
    s_sleep 1
    ds_read_b32 v8, v0 offset:2020
    s_sub_u32 s3, s3, 1
    s_cbranch_scc1 L_end
    s_waitcnt lgkmcnt(0)
    v_cmp_gt_u32 vcc, 4, v8
    s_cbranch_vccnz L_w2
    v_mov_b32 v4, 0
L_fl3:
    global_load_dword v5, v4, s[28:29] offset:0 sc1
    s_sub_u32 s3, s3, 1
    s_cbranch_scc1 L_end
    s_waitcnt vmcnt(0)
    v_cmp_eq_u32 vcc, 0, v5
    s_cbranch_vccnz L_fl3
    v_mov_b32 v8, 1
    s_mov_b64 exec, 1
    ds_add_u32 v0, v8 offset:4040
    s_mov_b64 exec, -1
L_A_hold1:
    s_cmp_ge_u32 s34, 4
    s_cbranch_scc1 L_A_hold2
L_w4:
    s_sleep 1
    ds_read_b32 v8, v0 offset:12
    s_sub_u32 s3, s3, 1
    s_cbranch_scc1 L_end
    s_waitcnt lgkmcnt(0)
    v_cmp_gt_u32 vcc, 4, v8
    s_cbranch_vccnz L_w4
    s_add_u32 s51, s50, 2
L_A_slb:
    s_add_u32 m0, s49, 0
    s_add_u32 s38, s48, 0
    buffer_load_dwordx4 v2, s[44:47], s38 offen nt lds
    s_waitcnt vmcnt(3)
    s_add_u32 m0, s49, 1024
    s_add_u32 s38, s48, 8192
    buffer_load_dwordx4 v3, s[44:47], s38 offen nt lds
    s_waitcnt vmcnt(3)
    s_add_u32 m0, s49, 2048
    s_add_u32 s38, s48, 16384
    buffer_load_dwordx4 v2, s[44:47], s38 offen nt lds
    s_waitcnt vmcnt(3)
    s_add_u32 m0, s49, 3072
    s_add_u32 s38, s48, 24576
    buffer_load_dwordx4 v3, s[44:47], s38 offen nt lds
    s_waitcnt vmcnt(3)
    s_add_u32 s49, s49, 16384
    s_add_u32 s48, s48, 128
    s_add_u32 s50, s50, 1
    s_cmp_lt_u32 s50, s51
    s_cbranch_scc1 L_A_slb
L_w5:
    s_sleep 1
    ds_read_b32 v8, v0 offset:2028
    s_sub_u32 s3, s3, 1
    s_cbranch_scc1 L_end
    s_waitcnt lgkmcnt(0)
    v_cmp_gt_u32 vcc, 2, v8
    s_cbranch_vccnz L_w5
    s_branch L_A_go
L_A_hold2:
L_w6:
    s_sleep 1
    ds_read_b32 v8, v0 offset:12
    s_sub_u32 s3, s3, 1
    s_cbranch_scc1 L_end
    s_waitcnt lgkmcnt(0)
    v_cmp_gt_u32 vcc, 4, v8
    s_cbranch_vccnz L_w6
    s_branch L_A_go
L_A_iss:

    v_and_b32 v9, 31, v1
    v_lshrrev_b32 v10, 5, v1
    v_bfe_u32 v4, v9, 1, 1
    v_lshlrev_b32 v4, 2, v4
    v_bfe_u32 v5, v9, 2, 2
    v_or_b32 v4, v4, v5
    v_xor_b32 v4, v4, v10
    v_lshlrev_b32 v4, 4, v4
    v_lshl_add_u32 v4, v9, 7, v4
    s_lshl_b32 s38, s33, 12
    v_add_u32 v4, s38, v4
    v_xor_b32 v5, 32, v4
    v_xor_b32 v6, 64, v4
    v_xor_b32 v7, 0x60, v4
    v_mul_u32_u24 v8, 1008, v9
    v_lshl_add_u32 v8, v10, 4, v8
    v_add_u32 v8, 131072, v8
    v_lshlrev_b32 v11, 10, v9
    v_lshl_add_u32 v11, v10, 4, v11
    s_lshl_b32 s38, s96, 15
    s_add_u32 s38, s38, 65536

L_w7:
    ds_read_b32 v16, v0 offset:1008
    s_sub_u32 s3, s3, 1
    s_cbranch_scc1 L_end
    s_waitcnt lgkmcnt(0)
    v_cmp_gt_u32 vcc, 4, v16
    s_cbranch_vccnz L_w7
    buffer_load_dwordx4 v[12:15], v11, s[40:43], s38 offen offset:992 sc1
    v_mov_b32 v16, 1
    s_mov_b64 exec, 1
    ds_add_u32 v0, v16 offset:7060
    s_mov_b64 exec, -1
    ds_read_b128 v[32:35], v4 offset:0
    ds_read_b128 v[48:51], v8 offset:0
    ds_read_b128 v[36:39], v5 offset:0
    ds_read_b128 v[52:55], v8 offset:32
    ds_read_b128 v[40:43], v6 offset:0
    ds_read_b128 v[56:59], v8 offset:64
    ds_read_b128 v[44:47], v7 offset:0
    ds_read_b128 v[60:63], v8 offset:96
    s_waitcnt lgkmcnt(6)
    v_mfma_f32_32x32x16_bf16 v[16:31], v[32:35], v[48:51], 0
    ds_read_b128 v[32:35], v4 offset:16384
    ds_read_b128 v[48:51], v8 offset:128
    s_waitcnt lgkmcnt(6)
    v_mfma_f32_32x32x16_bf16 v[16:31], v[36:39], v[52:55], v[16:31]
    ds_read_b128 v[36:39], v5 offset:16384
    ds_read_b128 v[52:55], v8 offset:160
    s_waitcnt lgkmcnt(6)
    v_mfma_f32_32x32x16_bf16 v[16:31], v[40:43], v[56:59], v[16:31]
    ds_read_b128 v[40:43], v6 offset:16384
    ds_read_b128 v[56:59], v8 offset:192
    s_waitcnt lgkmcnt(6)
    v_mfma_f32_32x32x16_bf16 v[16:31], v[44:47], v[60:63], v[16:31]
    ds_read_b128 v[44:47], v7 offset:16384
    ds_read_b128 v[60:63], v8 offset:224
    s_waitcnt lgkmcnt(6)
    v_mfma_f32_32x32x16_bf16 v[16:31], v[32:35], v[48:51], v[16:31]
    ds_read_b128 v[32:35], v4 offset:32768
    ds_read_b128 v[48:51], v8 offset:256
    s_waitcnt lgkmcnt(6)
    v_mfma_f32_32x32x16_bf16 v[16:31], v[36:39], v[52:55], v[16:31]
    ds_read_b128 v[36:39], v5 offset:32768
    ds_read_b128 v[52:55], v8 offset:288
    s_waitcnt lgkmcnt(6)
    v_mfma_f32_32x32x16_bf16 v[16:31], v[40:43], v[56:59], v[16:31]
    ds_read_b128 v[40:43], v6 offset:32768
    ds_read_b128 v[56:59], v8 offset:320
    s_waitcnt lgkmcnt(6)
    v_mfma_f32_32x32x16_bf16 v[16:31], v[44:47], v[60:63], v[16:31]
    ds_read_b128 v[44:47], v7 offset:32768
    ds_read_b128 v[60:63], v8 offset:352
    s_waitcnt lgkmcnt(6)
    v_mfma_f32_32x32x16_bf16 v[16:31], v[32:35], v[48:51], v[16:31]
    ds_read_b128 v[32:35], v4 offset:49152
    ds_read_b128 v[48:51], v8 offset:384
    s_waitcnt lgkmcnt(6)
    v_mfma_f32_32x32x16_bf16 v[16:31], v[36:39], v[52:55], v[16:31]
    ds_read_b128 v[36:39], v5 offset:49152
    ds_read_b128 v[52:55], v8 offset:416
    s_waitcnt lgkmcnt(6)
    v_mfma_f32_32x32x16_bf16 v[16:31], v[40:43], v[56:59], v[16:31]
    ds_read_b128 v[40:43], v6 offset:49152
    ds_read_b128 v[56:59], v8 offset:448
    s_waitcnt lgkmcnt(6)
    v_mfma_f32_32x32x16_bf16 v[16:31], v[44:47], v[60:63], v[16:31]
    ds_read_b128 v[44:47], v7 offset:49152
    ds_read_b128 v[60:63], v8 offset:480
    s_waitcnt lgkmcnt(6)
    v_mfma_f32_32x32x16_bf16 v[16:31], v[32:35], v[48:51], v[16:31]
    v_add_u32 v4, 0x10000, v4
    v_add_u32 v5, 0x10000, v5
    v_add_u32 v6, 0x10000, v6
    v_add_u32 v7, 0x10000, v7
    ds_read_b128 v[32:35], v4 offset:0
    ds_read_b128 v[48:51], v8 offset:512
    s_waitcnt lgkmcnt(6)
    v_mfma_f32_32x32x16_bf16 v[16:31], v[36:39], v[52:55], v[16:31]
    ds_read_b128 v[36:39], v5 offset:0
    ds_read_b128 v[52:55], v8 offset:544
    s_waitcnt lgkmcnt(6)
    v_mfma_f32_32x32x16_bf16 v[16:31], v[40:43], v[56:59], v[16:31]
    ds_read_b128 v[40:43], v6 offset:0
    ds_read_b128 v[56:59], v8 offset:576
    s_waitcnt lgkmcnt(6)
    v_mfma_f32_32x32x16_bf16 v[16:31], v[44:47], v[60:63], v[16:31]
    ds_read_b128 v[44:47], v7 offset:0
    ds_read_b128 v[60:63], v8 offset:608
    s_waitcnt lgkmcnt(6)
    v_mfma_f32_32x32x16_bf16 v[16:31], v[32:35], v[48:51], v[16:31]
    ds_read_b128 v[32:35], v4 offset:16384
    ds_read_b128 v[48:51], v8 offset:640
    s_waitcnt lgkmcnt(6)
    v_mfma_f32_32x32x16_bf16 v[16:31], v[36:39], v[52:55], v[16:31]
    ds_read_b128 v[36:39], v5 offset:16384
    ds_read_b128 v[52:55], v8 offset:672
    s_waitcnt lgkmcnt(6)
    v_mfma_f32_32x32x16_bf16 v[16:31], v[40:43], v[56:59], v[16:31]
    ds_read_b128 v[40:43], v6 offset:16384
    ds_read_b128 v[56:59], v8 offset:704
    s_waitcnt lgkmcnt(6)
    v_mfma_f32_32x32x16_bf16 v[16:31], v[44:47], v[60:63], v[16:31]
    ds_read_b128 v[44:47], v7 offset:16384
    ds_read_b128 v[60:63], v8 offset:736
    s_waitcnt lgkmcnt(6)
    v_mfma_f32_32x32x16_bf16 v[16:31], v[32:35], v[48:51], v[16:31]
    s_waitcnt vmcnt(5)
    ds_read_b128 v[32:35], v4 offset:32768
    ds_read_b128 v[48:51], v8 offset:768
    s_waitcnt lgkmcnt(6)
    v_mfma_f32_32x32x16_bf16 v[16:31], v[36:39], v[52:55], v[16:31]
    ds_read_b128 v[36:39], v5 offset:32768
    ds_read_b128 v[52:55], v8 offset:800
    s_waitcnt lgkmcnt(6)
    v_mfma_f32_32x32x16_bf16 v[16:31], v[40:43], v[56:59], v[16:31]
    ds_read_b128 v[40:43], v6 offset:32768
    ds_read_b128 v[56:59], v8 offset:832
    s_waitcnt lgkmcnt(6)
    v_mfma_f32_32x32x16_bf16 v[16:31], v[44:47], v[60:63], v[16:31]
    ds_read_b128 v[44:47], v7 offset:32768
    ds_read_b128 v[60:63], v8 offset:864
    s_waitcnt lgkmcnt(6)
    v_mfma_f32_32x32x16_bf16 v[16:31], v[32:35], v[48:51], v[16:31]
    s_waitcnt vmcnt(0)
    ds_read_b128 v[32:35], v4 offset:49152
    ds_read_b128 v[48:51], v8 offset:896
    s_waitcnt lgkmcnt(6)
    v_mfma_f32_32x32x16_bf16 v[16:31], v[36:39], v[52:55], v[16:31]
    ds_read_b128 v[36:39], v5 offset:49152
    ds_read_b128 v[52:55], v8 offset:928
    s_waitcnt lgkmcnt(6)
    v_mfma_f32_32x32x16_bf16 v[16:31], v[40:43], v[56:59], v[16:31]
    ds_read_b128 v[40:43], v6 offset:49152
    ds_read_b128 v[56:59], v8 offset:960
    s_waitcnt lgkmcnt(6)
    v_mfma_f32_32x32x16_bf16 v[16:31], v[44:47], v[60:63], v[16:31]
    ds_read_b128 v[44:47], v7 offset:49152
    s_waitcnt lgkmcnt(5)
    v_mfma_f32_32x32x16_bf16 v[16:31], v[32:35], v[48:51], v[16:31]
    s_waitcnt lgkmcnt(3)
    v_mfma_f32_32x32x16_bf16 v[16:31], v[36:39], v[52:55], v[16:31]
    s_waitcnt lgkmcnt(1)
    v_mfma_f32_32x32x16_bf16 v[16:31], v[40:43], v[56:59], v[16:31]
    s_waitcnt lgkmcnt(0)
    v_mfma_f32_32x32x16_bf16 v[16:31], v[44:47], v[12:15], v[16:31]

    v_bfe_u32 v32, v1, 2, 2
    v_lshl_add_u32 v33, v10, 2, v32
    v_lshrrev_b32 v32, 1, v32
    v_lshl_or_b32 v32, v32, 2, v10
    v_bfe_u32 v34, v1, 4, 1
    v_bfe_u32 v35, v1, 1, 1
    v_lshl_or_b32 v34, v34, 1, v35
    v_xor_b32 v32, v32, v34
    v_lshlrev_b32 v32, 4, v32
    v_lshl_add_u32 v32, v33, 7, v32
    v_and_b32 v33, 1, v1
    v_lshl_add_u32 v32, v33, 3, v32
    s_mul_i32 s38, s33, 36864
    v_add_u32 v4, s38, v32
    v_xor_b32 v5, 1056, v4
    v_xor_b32 v6, 64, v4
    v_xor_b32 v7, 1120, v4
    v_lshl_add_u32 v11, v9, 4, v0
    s_lshl_b32 s38, s33, 2
    v_add_u32 v12, s38, v11

    v_max3_f32 v13, v16, v17, v18
    v_max3_f32 v13, v13, v19, v20
    v_max3_f32 v13, v13, v21, v22
    v_max3_f32 v13, v13, v23, v24
    v_max3_f32 v13, v13, v25, v26
    v_max3_f32 v13, v13, v27, v28
    v_max3_f32 v13, v13, v29, v30
    v_max_f32 v13, v13, v31
    v_mov_b32 v14, v13
    s_nop 1
    v_permlane32_swap_b32 v13, v14
    v_max_f32 v13, v13, v14
    ds_write_b32 v12, v13 offset:7072
L_A_mx:
    ds_read_b128 v[32:35], v11 offset:7072
    s_sub_u32 s3, s3, 1
    s_cbranch_scc1 L_end
    s_waitcnt lgkmcnt(0)
    v_max3_u32 v36, v32, v33, v34
    v_max_u32 v36, v36, v35
    v_cmp_eq_u32 vcc, -1, v36
    s_cbranch_vccnz L_A_mx
    v_max3_f32 v13, v32, v33, v34
    v_max_f32 v13, v13, v35
    s_mov_b32 s39, 0x3e0293ee
    v_mul_f32 v13, s39, v13
    ds_read_b64_tr_b16 v[32:33], v4 offset:0
    ds_read_b64_tr_b16 v[34:35], v5 offset:0
    ds_read_b64_tr_b16 v[36:37], v6 offset:0
    ds_read_b64_tr_b16 v[38:39], v7 offset:0
    ds_read_b64_tr_b16 v[40:41], v4 offset:16384
    ds_read_b64_tr_b16 v[42:43], v5 offset:16384
    ds_read_b64_tr_b16 v[44:45], v6 offset:16384
    ds_read_b64_tr_b16 v[46:47], v7 offset:16384
    v_fma_f32 v16, v16, s39, -v13
    v_fma_f32 v17, v17, s39, -v13
    v_fma_f32 v18, v18, s39, -v13
    v_fma_f32 v19, v19, s39, -v13
    v_fma_f32 v20, v20, s39, -v13
    v_fma_f32 v21, v21, s39, -v13
    v_fma_f32 v22, v22, s39, -v13
    v_fma_f32 v23, v23, s39, -v13
    v_fma_f32 v24, v24, s39, -v13
    v_fma_f32 v25, v25, s39, -v13
    v_fma_f32 v26, v26, s39, -v13
    v_fma_f32 v27, v27, s39, -v13
    v_fma_f32 v28, v28, s39, -v13
    v_fma_f32 v29, v29, s39, -v13
    v_fma_f32 v30, v30, s39, -v13
    v_fma_f32 v31, v31, s39, -v13
    v_exp_f32 v16, v16
    v_exp_f32 v17, v17
    v_exp_f32 v18, v18
    v_exp_f32 v19, v19
    v_exp_f32 v20, v20
    v_exp_f32 v21, v21
    v_exp_f32 v22, v22
    v_exp_f32 v23, v23
    v_exp_f32 v24, v24
    v_exp_f32 v25, v25
    v_exp_f32 v26, v26
    v_exp_f32 v27, v27
    v_exp_f32 v28, v28
    v_exp_f32 v29, v29
    v_exp_f32 v30, v30
    v_exp_f32 v31, v31
    v_cvt_pk_bf16_f32 v128, v16, v17
    v_cvt_pk_bf16_f32 v129, v18, v19
    v_cvt_pk_bf16_f32 v130, v20, v21
    v_cvt_pk_bf16_f32 v131, v22, v23
    v_cvt_pk_bf16_f32 v132, v24, v25
    v_cvt_pk_bf16_f32 v133, v26, v27
    v_cvt_pk_bf16_f32 v134, v28, v29
    v_cvt_pk_bf16_f32 v135, v30, v31
    v_lshlrev_b32 v8, 4, v1
    s_lshl_b32 s38, s33, 11
    s_add_u32 s38, s38, 131072
    v_add_u32 v8, s38, v8
    ds_write_b128 v8, v[128:131]
    ds_write_b128 v8, v[132:135] offset:1024
    v_add_f32 v16, v16, v24
    v_add_f32 v17, v17, v25
    v_add_f32 v18, v18, v26
    v_add_f32 v19, v19, v27
    v_add_f32 v20, v20, v28
    v_add_f32 v21, v21, v29
    v_add_f32 v22, v22, v30
    v_add_f32 v23, v23, v31
    v_add_f32 v16, v16, v20
    v_add_f32 v17, v17, v21
    v_add_f32 v18, v18, v22
    v_add_f32 v19, v19, v23
    v_add_f32 v16, v16, v18
    v_add_f32 v17, v17, v19
    v_add_f32 v16, v16, v17
    v_mov_b32 v14, v16
    s_nop 1
    v_permlane32_swap_b32 v16, v14
    v_add_f32 v16, v16, v14
    v_add_u32 v12, -16992, v12
    ds_write_b32 v12, v16
    v_mov_b32 v14, 1
    s_mov_b64 exec, 1
    ds_add_u32 v0, v14 offset:1016
    s_mov_b64 exec, -1
    ds_read_b64_tr_b16 v[48:49], v4 offset:2048
    ds_read_b64_tr_b16 v[50:51], v5 offset:2048
    s_waitcnt lgkmcnt(2)
    v_mfma_f32_32x32x16_bf16 v[64:79], v[128:131], v[32:35], 0
    ds_read_b64_tr_b16 v[52:53], v6 offset:2048
    ds_read_b64_tr_b16 v[54:55], v7 offset:2048
    s_waitcnt lgkmcnt(4)
    v_mfma_f32_32x32x16_bf16 v[80:95], v[128:131], v[36:39], 0
    ds_read_b64_tr_b16 v[56:57], v4 offset:18432
    ds_read_b64_tr_b16 v[58:59], v5 offset:18432
    s_waitcnt lgkmcnt(6)
    v_mfma_f32_32x32x16_bf16 v[96:111], v[128:131], v[40:43], 0
    ds_read_b64_tr_b16 v[60:61], v6 offset:18432
    ds_read_b64_tr_b16 v[62:63], v7 offset:18432
    s_waitcnt lgkmcnt(8)
    v_mfma_f32_32x32x16_bf16 v[112:127], v[128:131], v[44:47], 0
L_w8:
    ds_read_b32 v14, v0 offset:1016
    s_sub_u32 s3, s3, 1
    s_cbranch_scc1 L_end
    s_waitcnt lgkmcnt(0)
    v_cmp_gt_u32 vcc, 4, v14
    s_cbranch_vccnz L_w8
    v_xor_b32 v15, 2048, v8
    ds_read_b128 v[136:139], v15
    ds_read_b128 v[140:143], v15 offset:1024
    v_xor_b32 v15, 4096, v8
    ds_read_b128 v[144:147], v15
    ds_read_b128 v[148:151], v15 offset:1024
    v_xor_b32 v15, 6144, v8
    ds_read_b128 v[152:155], v15
    ds_read_b128 v[156:159], v15 offset:1024
    v_add_u32 v11, -16992, v11
    ds_read_b128 v[16:19], v11
    v_xor_b32 v4, 4096, v4
    v_xor_b32 v5, 4096, v5
    v_xor_b32 v6, 4096, v6
    v_xor_b32 v7, 4096, v7
    ds_read_b64_tr_b16 v[32:33], v4 offset:0
    ds_read_b64_tr_b16 v[34:35], v5 offset:0
    v_mfma_f32_32x32x16_bf16 v[64:79], v[132:135], v[48:51], v[64:79]
    ds_read_b64_tr_b16 v[36:37], v6 offset:0
    ds_read_b64_tr_b16 v[38:39], v7 offset:0
    v_mfma_f32_32x32x16_bf16 v[80:95], v[132:135], v[52:55], v[80:95]
    ds_read_b64_tr_b16 v[40:41], v4 offset:16384
    ds_read_b64_tr_b16 v[42:43], v5 offset:16384
    v_mfma_f32_32x32x16_bf16 v[96:111], v[132:135], v[56:59], v[96:111]
    ds_read_b64_tr_b16 v[44:45], v6 offset:16384
    ds_read_b64_tr_b16 v[46:47], v7 offset:16384
    v_mfma_f32_32x32x16_bf16 v[112:127], v[132:135], v[60:63], v[112:127]
    ds_read_b64_tr_b16 v[48:49], v4 offset:2048
    ds_read_b64_tr_b16 v[50:51], v5 offset:2048
    s_waitcnt lgkmcnt(8)
    v_mfma_f32_32x32x16_bf16 v[64:79], v[136:139], v[32:35], v[64:79]
    ds_read_b64_tr_b16 v[52:53], v6 offset:2048
    ds_read_b64_tr_b16 v[54:55], v7 offset:2048
    s_waitcnt lgkmcnt(8)
    v_mfma_f32_32x32x16_bf16 v[80:95], v[136:139], v[36:39], v[80:95]
    ds_read_b64_tr_b16 v[56:57], v4 offset:18432
    ds_read_b64_tr_b16 v[58:59], v5 offset:18432
    s_waitcnt lgkmcnt(8)
    v_mfma_f32_32x32x16_bf16 v[96:111], v[136:139], v[40:43], v[96:111]
    ds_read_b64_tr_b16 v[60:61], v6 offset:18432
    ds_read_b64_tr_b16 v[62:63], v7 offset:18432
    s_waitcnt lgkmcnt(8)
    v_mfma_f32_32x32x16_bf16 v[112:127], v[136:139], v[44:47], v[112:127]
    v_xor_b32 v4, 12288, v4
    v_xor_b32 v5, 12288, v5
    v_xor_b32 v6, 12288, v6
    v_xor_b32 v7, 12288, v7
    ds_read_b64_tr_b16 v[32:33], v4 offset:0
    ds_read_b64_tr_b16 v[34:35], v5 offset:0
    s_waitcnt lgkmcnt(8)
    v_mfma_f32_32x32x16_bf16 v[64:79], v[140:143], v[48:51], v[64:79]
    ds_read_b64_tr_b16 v[36:37], v6 offset:0
    ds_read_b64_tr_b16 v[38:39], v7 offset:0
    s_waitcnt lgkmcnt(8)
    v_mfma_f32_32x32x16_bf16 v[80:95], v[140:143], v[52:55], v[80:95]
    ds_read_b64_tr_b16 v[40:41], v4 offset:16384
    ds_read_b64_tr_b16 v[42:43], v5 offset:16384
    s_waitcnt lgkmcnt(8)
    v_mfma_f32_32x32x16_bf16 v[96:111], v[140:143], v[56:59], v[96:111]
    ds_read_b64_tr_b16 v[44:45], v6 offset:16384
    ds_read_b64_tr_b16 v[46:47], v7 offset:16384
    s_waitcnt lgkmcnt(8)
    v_mfma_f32_32x32x16_bf16 v[112:127], v[140:143], v[60:63], v[112:127]
    ds_read_b64_tr_b16 v[48:49], v4 offset:2048
    ds_read_b64_tr_b16 v[50:51], v5 offset:2048
    s_waitcnt lgkmcnt(8)
    v_mfma_f32_32x32x16_bf16 v[64:79], v[144:147], v[32:35], v[64:79]
    ds_read_b64_tr_b16 v[52:53], v6 offset:2048
    ds_read_b64_tr_b16 v[54:55], v7 offset:2048
    s_waitcnt lgkmcnt(8)
    v_mfma_f32_32x32x16_bf16 v[80:95], v[144:147], v[36:39], v[80:95]
    ds_read_b64_tr_b16 v[56:57], v4 offset:18432
    ds_read_b64_tr_b16 v[58:59], v5 offset:18432
    s_waitcnt lgkmcnt(8)
    v_mfma_f32_32x32x16_bf16 v[96:111], v[144:147], v[40:43], v[96:111]
    ds_read_b64_tr_b16 v[60:61], v6 offset:18432
    ds_read_b64_tr_b16 v[62:63], v7 offset:18432
    s_waitcnt lgkmcnt(8)
    v_mfma_f32_32x32x16_bf16 v[112:127], v[144:147], v[44:47], v[112:127]
    v_xor_b32 v4, 4096, v4
    v_xor_b32 v5, 4096, v5
    v_xor_b32 v6, 4096, v6
    v_xor_b32 v7, 4096, v7
    ds_read_b64_tr_b16 v[32:33], v4 offset:0
    ds_read_b64_tr_b16 v[34:35], v5 offset:0
    s_waitcnt lgkmcnt(8)
    v_mfma_f32_32x32x16_bf16 v[64:79], v[148:151], v[48:51], v[64:79]
    ds_read_b64_tr_b16 v[36:37], v6 offset:0
    ds_read_b64_tr_b16 v[38:39], v7 offset:0
    s_waitcnt lgkmcnt(8)
    v_mfma_f32_32x32x16_bf16 v[80:95], v[148:151], v[52:55], v[80:95]
    ds_read_b64_tr_b16 v[40:41], v4 offset:16384
    ds_read_b64_tr_b16 v[42:43], v5 offset:16384
    s_waitcnt lgkmcnt(8)
    v_mfma_f32_32x32x16_bf16 v[96:111], v[148:151], v[56:59], v[96:111]
    ds_read_b64_tr_b16 v[44:45], v6 offset:16384
    ds_read_b64_tr_b16 v[46:47], v7 offset:16384
    s_waitcnt lgkmcnt(8)
    v_mfma_f32_32x32x16_bf16 v[112:127], v[148:151], v[60:63], v[112:127]
    ds_read_b64_tr_b16 v[48:49], v4 offset:2048
    ds_read_b64_tr_b16 v[50:51], v5 offset:2048
    s_waitcnt lgkmcnt(8)
    v_mfma_f32_32x32x16_bf16 v[64:79], v[152:155], v[32:35], v[64:79]
    ds_read_b64_tr_b16 v[52:53], v6 offset:2048
    ds_read_b64_tr_b16 v[54:55], v7 offset:2048
    s_waitcnt lgkmcnt(8)
    v_mfma_f32_32x32x16_bf16 v[80:95], v[152:155], v[36:39], v[80:95]
    ds_read_b64_tr_b16 v[56:57], v4 offset:18432
    ds_read_b64_tr_b16 v[58:59], v5 offset:18432
    s_waitcnt lgkmcnt(8)
    v_mfma_f32_32x32x16_bf16 v[96:111], v[152:155], v[40:43], v[96:111]
    ds_read_b64_tr_b16 v[60:61], v6 offset:18432
    ds_read_b64_tr_b16 v[62:63], v7 offset:18432
    s_waitcnt lgkmcnt(8)
    v_mfma_f32_32x32x16_bf16 v[112:127], v[152:155], v[44:47], v[112:127]
    s_waitcnt lgkmcnt(6)
    v_mfma_f32_32x32x16_bf16 v[64:79], v[156:159], v[48:51], v[64:79]
    s_waitcnt lgkmcnt(4)
    v_mfma_f32_32x32x16_bf16 v[80:95], v[156:159], v[52:55], v[80:95]
    s_waitcnt lgkmcnt(2)
    v_mfma_f32_32x32x16_bf16 v[96:111], v[156:159], v[56:59], v[96:111]
    s_waitcnt lgkmcnt(0)
    v_mfma_f32_32x32x16_bf16 v[112:127], v[156:159], v[60:63], v[112:127]

    v_add_f32 v16, v16, v17
    v_add_f32 v18, v18, v19
    v_add_f32 v14, v16, v18
    v_bfe_u32 v2, v1, 4, 1
    v_lshl_add_u32 v2, v10, 2, v2
    v_lshlrev_b32 v2, 15, v2
    v_and_b32 v3, 15, v1
    v_lshl_add_u32 v2, v3, 4, v2
    s_lshl_b32 s48, s96, 20
    s_lshl_b32 s38, s97, 10
    s_add_u32 s48, s48, s38
    s_lshl_b32 s38, s33, 8
    s_add_u32 s48, s48, s38
    s_add_u32 s48, s48, 2097152

    v_cvt_pk_bf16_f32 v128, v64, v80
    v_cvt_pk_bf16_f32 v129, v65, v81
    v_cvt_pk_bf16_f32 v130, v96, v112
    v_cvt_pk_bf16_f32 v131, v97, v113
    s_add_u32 s38, s48, 0
    v_permlane16_swap_b32 v128, v129
    v_permlane16_swap_b32 v130, v131
    buffer_store_dwordx4 v[128:131], v2, s[40:43], s38 offen sc1
    v_cvt_pk_bf16_f32 v132, v66, v82
    v_cvt_pk_bf16_f32 v133, v67, v83
    v_cvt_pk_bf16_f32 v134, v98, v114
    v_cvt_pk_bf16_f32 v135, v99, v115
    s_add_u32 s38, s48, 65536
    v_permlane16_swap_b32 v132, v133
    v_permlane16_swap_b32 v134, v135
    buffer_store_dwordx4 v[132:135], v2, s[40:43], s38 offen sc1
    v_cvt_pk_bf16_f32 v136, v68, v84
    v_cvt_pk_bf16_f32 v137, v69, v85
    v_cvt_pk_bf16_f32 v138, v100, v116
    v_cvt_pk_bf16_f32 v139, v101, v117
    s_add_u32 s38, s48, 262144
    v_permlane16_swap_b32 v136, v137
    v_permlane16_swap_b32 v138, v139
    buffer_store_dwordx4 v[136:139], v2, s[40:43], s38 offen sc1
    v_cvt_pk_bf16_f32 v140, v70, v86
    v_cvt_pk_bf16_f32 v141, v71, v87
    v_cvt_pk_bf16_f32 v142, v102, v118
    v_cvt_pk_bf16_f32 v143, v103, v119
    s_add_u32 s38, s48, 327680
    v_permlane16_swap_b32 v140, v141
    v_permlane16_swap_b32 v142, v143
    buffer_store_dwordx4 v[140:143], v2, s[40:43], s38 offen sc1
    v_cvt_pk_bf16_f32 v144, v72, v88
    v_cvt_pk_bf16_f32 v145, v73, v89
    v_cvt_pk_bf16_f32 v146, v104, v120
    v_cvt_pk_bf16_f32 v147, v105, v121
    s_add_u32 s38, s48, 524288
    v_permlane16_swap_b32 v144, v145
    v_permlane16_swap_b32 v146, v147
    buffer_store_dwordx4 v[144:147], v2, s[40:43], s38 offen sc1
    v_cvt_pk_bf16_f32 v148, v74, v90
    v_cvt_pk_bf16_f32 v149, v75, v91
    v_cvt_pk_bf16_f32 v150, v106, v122
    v_cvt_pk_bf16_f32 v151, v107, v123
    s_add_u32 s38, s48, 589824
    v_permlane16_swap_b32 v148, v149
    v_permlane16_swap_b32 v150, v151
    buffer_store_dwordx4 v[148:151], v2, s[40:43], s38 offen sc1
    v_cvt_pk_bf16_f32 v152, v76, v92
    v_cvt_pk_bf16_f32 v153, v77, v93
    v_cvt_pk_bf16_f32 v154, v108, v124
    v_cvt_pk_bf16_f32 v155, v109, v125
    s_add_u32 s38, s48, 786432
    v_permlane16_swap_b32 v152, v153
    v_permlane16_swap_b32 v154, v155
    buffer_store_dwordx4 v[152:155], v2, s[40:43], s38 offen sc1
    v_cvt_pk_bf16_f32 v156, v78, v94
    v_cvt_pk_bf16_f32 v157, v79, v95
    v_cvt_pk_bf16_f32 v158, v110, v126
    v_cvt_pk_bf16_f32 v159, v111, v127
    s_add_u32 s38, s48, 851968
    v_permlane16_swap_b32 v156, v157
    v_permlane16_swap_b32 v158, v159
    buffer_store_dwordx4 v[156:159], v2, s[40:43], s38 offen sc1

    v_mov_b32 v12, v13
    v_mov_b32 v13, v14
    v_lshlrev_b32 v4, 3, v9
    s_lshl_b32 s38, s33, 8
    s_add_u32 s49, s61, s38
    s_add_u32 s49, s49, 327680
    v_lshrrev_b32 v6, 4, v1
    v_lshlrev_b32 v7, 13, v6
    v_lshl_add_u32 v7, v3, 4, v7

    v_and_b32 v16, 1, v1
    v_lshlrev_b32 v16, 4, v16
    s_mov_b32 s38, 0xffff
    v_lshlrev_b32 v16, v16, s38
    v_bfe_u32 v17, v1, 1, 2
    v_cmp_eq_u32 vcc, 0, v17
    s_nop 1
    v_cndmask_b32 v20, 0, v16, vcc
    v_cmp_eq_u32 vcc, 1, v17
    s_nop 1
    v_cndmask_b32 v21, 0, v16, vcc
    v_cmp_eq_u32 vcc, 2, v17
    s_nop 1
    v_cndmask_b32 v22, 0, v16, vcc
    v_cmp_eq_u32 vcc, 3, v17
    s_nop 1
    v_cndmask_b32 v23, 0, v16, vcc

    s_waitcnt vmcnt(0)
    s_mov_b32 exec_hi, 0
    buffer_store_dwordx2 v[12:13], v4, s[40:43], s49 offen sc1
    s_mov_b64 exec, -1

    v_mov_b32 v16, 1
    s_mov_b64 exec, 1
    ds_add_u32 v0, v16 offset:7068
    s_mov_b64 exec, -1
    v_mov_b32 v16, 1
    s_mov_b64 exec, 1
    ds_add_u32 v0, v16 offset:1012
    s_mov_b64 exec, -1

    v_bfe_u32 v12, v1, 2, 2
    v_lshl_add_u32 v13, v6, 3, v12
    v_lshrrev_b32 v14, 1, v12
    v_and_b32 v15, 1, v6
    v_lshl_or_b32 v14, v15, 1, v14
    v_lshlrev_b32 v14, 5, v14
    v_lshl_add_u32 v14, v13, 7, v14
    v_and_b32 v16, 3, v1
    v_lshl_add_u32 v14, v16, 3, v14
    s_lshl_b32 s38, s33, 14
    v_add_u32 v160, s38, v14
    v_xor_b32 v161, 32, v160
    v_xor_b32 v162, 64, v160
    v_xor_b32 v163, 0x60, v160
    v_lshl_or_b32 v14, v15, 2, v12
    v_lshlrev_b32 v14, 5, v14
    v_lshl_add_u32 v14, v13, 8, v14
    v_lshl_add_u32 v14, v16, 3, v14
    s_add_u32 s38, s38, 65536
    v_add_u32 v2, s38, v14

    s_cmp_lt_u32 s34, 4
    s_cbranch_scc1 L_A_fw
L_A_st:
    v_lshlrev_b32 v5, 10, v9
    s_and_b32 s38, s34, 3
    s_lshl_b32 s38, s38, 8
    s_add_u32 s39, s33, 4
    s_lshl_b32 s50, s39, 15
    s_add_u32 s50, s50, s38
    s_lshl_b32 s51, s35, 3
    s_add_u32 s50, s50, s51
    s_add_u32 s50, s50, 327680
    s_lshl_b32 s51, s39, 5
    s_add_u32 s51, s51, s35
    s_lshl_b32 s51, s51, 15
    s_add_u32 s51, s51, s38
    s_add_u32 s51, s51, 2097152
    s_lshl_b32 s38, s33, 8
    s_add_u32 s38, s38, 139776
    v_lshl_add_u32 v24, v1, 2, s38
    v_bfe_u32 v16, v1, 3, 1
    v_lshlrev_b32 v16, 7, v16
    v_lshl_add_u32 v16, v6, 5, v16
    v_add_u32 v25, s38, v16
    v_bfe_u32 v16, v1, 4, 1
    v_lshlrev_b32 v16, 4, v16
    v_lshl_add_u32 v16, v3, 5, v16
    v_lshl_add_u32 v16, v10, 3, v16
    s_mul_i32 s38, s33, 1056
    s_add_u32 s38, s38, 145536
    v_add_u32 v26, s38, v16
    s_mov_b32 s53, 0
L_w9:
    s_sleep 1
    ds_read_b32 v12, v0 offset:6060
    s_sub_u32 s3, s3, 1
    s_cbranch_scc1 L_end
    s_waitcnt lgkmcnt(0)
    v_cmp_gt_u32 vcc, 5, v12
    s_cbranch_vccnz L_w9
L_A_st1:
    buffer_load_dwordx2 v[12:13], v5, s[40:43], s50 offen sc1
    s_sub_u32 s3, s3, 1
    s_cbranch_scc1 L_end
L_A_st4:
    s_add_u32 s52, s51, 4096
    s_waitcnt vmcnt(0)
    v_cmp_eq_u32 vcc, -1, v13
    s_cbranch_vccz L_A_st3
    s_mov_b64 exec, vcc
    s_branch L_A_st1
L_A_st3:
    s_mov_b64 exec, -1
    buffer_load_dwordx4 v[32:35], v7, s[40:43], s51 offen offset:0 sc1
    buffer_load_dwordx4 v[36:39], v7, s[40:43], s51 offen offset:1024 sc1
    buffer_load_dwordx4 v[40:43], v7, s[40:43], s51 offen offset:2048 sc1
    buffer_load_dwordx4 v[44:47], v7, s[40:43], s51 offen offset:3072 sc1
    buffer_load_dwordx4 v[48:51], v7, s[40:43], s52 offen offset:0 sc1
    buffer_load_dwordx4 v[52:55], v7, s[40:43], s52 offen offset:1024 sc1
    buffer_load_dwordx4 v[56:59], v7, s[40:43], s52 offen offset:2048 sc1
    buffer_load_dwordx4 v[60:63], v7, s[40:43], s52 offen offset:3072 sc1
    s_sub_u32 s50, s50, 131072
    s_max_i32 s38, s50, 327680
    buffer_load_dwordx2 v[96:97], v5, s[40:43], s38 offen sc1
    v_mov_b32 v14, v12
    s_nop 1
    v_max_f32_dpp v14, v14, v14 quad_perm:[1,0,3,2] row_mask:0xf bank_mask:0xf
    s_nop 1
    v_max_f32_dpp v14, v14, v14 quad_perm:[2,3,0,1] row_mask:0xf bank_mask:0xf
    s_nop 1
    v_max_f32_dpp v14, v14, v14 row_half_mirror row_mask:0xf bank_mask:0xf
    s_nop 1
    v_max_f32_dpp v14, v14, v14 row_mirror row_mask:0xf bank_mask:0xf
    v_mov_b32 v15, v14
    s_nop 1
    v_permlane16_swap_b32 v14, v15
    v_max_f32 v14, v14, v15
    v_sub_f32 v12, v12, v14
    v_exp_f32 v12, v12
    s_nop 0
    v_mul_f32 v14, v12, v13
    s_nop 1
    v_add_f32_dpp v14, v14, v14 quad_perm:[1,0,3,2] row_mask:0xf bank_mask:0xf
    s_nop 1
    v_add_f32_dpp v14, v14, v14 quad_perm:[2,3,0,1] row_mask:0xf bank_mask:0xf
    s_nop 1
    v_add_f32_dpp v14, v14, v14 row_half_mirror row_mask:0xf bank_mask:0xf
    s_nop 1
    v_add_f32_dpp v14, v14, v14 row_mirror row_mask:0xf bank_mask:0xf
    v_mov_b32 v15, v14
    s_nop 1
    v_permlane16_swap_b32 v14, v15
    v_add_f32 v14, v14, v15
    v_rcp_f32 v14, v14
    v_cmp_gt_u32 vcc, 32, v1
    v_mul_f32 v12, v12, v14
    v_cvt_pk_bf16_f32 v13, v12, v12
    v_and_b32 v14, 0xffff0000, v13
    v_sub_f32 v12, v12, v14
    v_cvt_pk_bf16_f32 v12, v12, v12
    v_cndmask_b32 v12, v12, v13, vcc
    ds_write_b32 v24, v12
    ds_read_b128 v[12:15], v25
    ds_read_b128 v[16:19], v25 offset:16
    s_waitcnt lgkmcnt(0)
    v_and_b32 v64, v12, v20
    v_and_b32 v65, v12, v21
    v_and_b32 v66, v12, v22
    v_and_b32 v67, v12, v23
    v_and_b32 v68, v13, v20
    v_and_b32 v69, v13, v21
    v_and_b32 v70, v13, v22
    v_and_b32 v71, v13, v23
    v_and_b32 v72, v14, v20
    v_and_b32 v73, v14, v21
    v_and_b32 v74, v14, v22
    v_and_b32 v75, v14, v23
    v_and_b32 v76, v15, v20
    v_and_b32 v77, v15, v21
    v_and_b32 v78, v15, v22
    v_and_b32 v79, v15, v23
    v_and_b32 v80, v16, v20
    v_and_b32 v81, v16, v21
    v_and_b32 v82, v16, v22
    v_and_b32 v83, v16, v23
    v_and_b32 v84, v17, v20
    v_and_b32 v85, v17, v21
    v_and_b32 v86, v17, v22
    v_and_b32 v87, v17, v23
    v_and_b32 v88, v18, v20
    v_and_b32 v89, v18, v21
    v_and_b32 v90, v18, v22
    v_and_b32 v91, v18, v23
    v_and_b32 v92, v19, v20
    v_and_b32 v93, v19, v21
    v_and_b32 v94, v19, v22
    v_and_b32 v95, v19, v23
    s_waitcnt vmcnt(8)
    v_mfma_f32_16x16x32_bf16 v[28:31], v[64:67], v[32:35], 0
    s_waitcnt vmcnt(7)
    v_mfma_f32_16x16x32_bf16 v[28:31], v[68:71], v[36:39], v[28:31]
    s_waitcnt vmcnt(6)
    v_mfma_f32_16x16x32_bf16 v[28:31], v[72:75], v[40:43], v[28:31]
    s_waitcnt vmcnt(5)
    v_mfma_f32_16x16x32_bf16 v[28:31], v[76:79], v[44:47], v[28:31]
    s_waitcnt vmcnt(4)
    v_mfma_f32_16x16x32_bf16 v[28:31], v[80:83], v[48:51], v[28:31]
    s_waitcnt vmcnt(3)
    v_mfma_f32_16x16x32_bf16 v[28:31], v[84:87], v[52:55], v[28:31]
    s_waitcnt vmcnt(2)
    v_mfma_f32_16x16x32_bf16 v[28:31], v[88:91], v[56:59], v[28:31]
    s_waitcnt vmcnt(1)
    v_mfma_f32_16x16x32_bf16 v[28:31], v[92:95], v[60:63], v[28:31]
    s_sub_u32 s51, s51, 4194304
    v_mov_b32 v16, 1
    s_add_u32 s53, s53, 1
    s_nop 4
    v_permlane32_swap_b32 v28, v30
    v_permlane32_swap_b32 v29, v31
    v_add_f32 v28, v28, v30
    v_add_f32 v29, v29, v31
    v_cvt_pk_bf16_f32 v12, v28, 0
    v_cvt_pk_bf16_f32 v13, v29, 0
    v_cvt_pk_bf16_f32 v14, 0, v28
    v_cvt_pk_bf16_f32 v15, 0, v29
    ds_write2_b64 v26, v[12:13], v[14:15] offset0:0 offset1:66
    s_mov_b64 exec, 1
    ds_add_u32 v0, v16 offset:6048
    s_mov_b64 exec, -1
    v_subrev_u32 v26, 4224, v26
    s_cmp_eq_u32 s53, 1
    s_cbranch_scc0 L_A_st2
    s_waitcnt lgkmcnt(0) vmcnt(0)
    v_mov_b32 v12, v96
    v_mov_b32 v13, v97
    s_branch L_A_st4
L_A_st2:
    s_cmp_lg_u32 s35, s33
    s_cbranch_scc1 L_end
    s_branch L_A_F
L_A_fw:
    s_cmp_ge_u32 s35, 28
    s_cbranch_scc1 L_end
L_w10:
    s_sleep 1
    ds_read_b32 v12, v0 offset:7056
    s_sub_u32 s3, s3, 1
    s_cbranch_scc1 L_end
    s_waitcnt lgkmcnt(0)
    v_cmp_gt_u32 vcc, 4, v12
    s_cbranch_vccnz L_w10
    ds_read_b64_tr_b16 v[96:97], v160 offset:0
    ds_read_b64_tr_b16 v[98:99], v160 offset:512
    ds_read_b64_tr_b16 v[100:101], v161 offset:0
    ds_read_b64_tr_b16 v[102:103], v161 offset:512
    ds_read_b64_tr_b16 v[104:105], v162 offset:0
    ds_read_b64_tr_b16 v[106:107], v162 offset:512
    ds_read_b64_tr_b16 v[108:109], v163 offset:0
    ds_read_b64_tr_b16 v[110:111], v163 offset:512
    s_waitcnt lgkmcnt(6)
    ds_read_b64_tr_b16 v[112:113], v160 offset:4096
    ds_read_b64_tr_b16 v[114:115], v160 offset:4608
    ds_read_b64_tr_b16 v[116:117], v161 offset:4096
    ds_read_b64_tr_b16 v[118:119], v161 offset:4608
    ds_read_b64_tr_b16 v[120:121], v162 offset:4096
    ds_read_b64_tr_b16 v[122:123], v162 offset:4608
    ds_read_b64_tr_b16 v[124:125], v163 offset:4096
    ds_read_b64_tr_b16 v[126:127], v163 offset:4608
    s_waitcnt lgkmcnt(0)
L_A_F:
    s_mov_b32 s44, s4
    s_mov_b32 s45, s5
    s_mov_b32 s46, 8192
    s_mov_b32 s47, 0x20000

    v_bfe_u32 v17, v1, 3, 1
    v_cmp_eq_u32 vcc, v17, v10
    v_mov_b32 v12, 0x3f803f80
    s_nop 0
    v_cndmask_b32 v12, 0, v12, vcc
    v_and_b32 v20, v12, v20
    v_and_b32 v21, v12, v21
    v_and_b32 v22, v12, v22
    v_and_b32 v23, v12, v23
    v_and_b32 v12, 1, v6
    v_lshlrev_b32 v13, 3, v12
    v_lshl_add_u32 v13, v3, 4, v13
    v_lshl_add_u32 v16, v10, 12, v13
    s_and_b32 s62, s34, 3
    s_lshl_b32 s38, s62, 10
    s_lshl_b32 s39, s33, 8
    s_add_u32 s48, s38, s39
    buffer_load_dwordx2 v[128:129], v16, s[44:47], s48 offen
L_A_md:
    s_add_u32 s49, s48, 1376256
    buffer_load_dwordx2 v[32:33], v16, s[40:43], s49 offen sc1
    s_add_u32 s49, s49, 8192
    buffer_load_dwordx2 v[34:35], v16, s[40:43], s49 offen sc1
    s_add_u32 s49, s49, 8192
    buffer_load_dwordx2 v[36:37], v16, s[40:43], s49 offen sc1
    s_add_u32 s49, s49, 8192
    buffer_load_dwordx2 v[38:39], v16, s[40:43], s49 offen sc1
    s_add_u32 s49, s49, 8192
    buffer_load_dwordx2 v[40:41], v16, s[40:43], s49 offen sc1
    s_add_u32 s49, s49, 8192
    buffer_load_dwordx2 v[42:43], v16, s[40:43], s49 offen sc1
    s_add_u32 s49, s49, 8192
    buffer_load_dwordx2 v[44:45], v16, s[40:43], s49 offen sc1
    s_add_u32 s49, s49, 8192
    buffer_load_dwordx2 v[46:47], v16, s[40:43], s49 offen sc1
    s_add_u32 s49, s49, 8192
    buffer_load_dwordx2 v[48:49], v16, s[40:43], s49 offen sc1
    s_add_u32 s49, s49, 8192
    buffer_load_dwordx2 v[50:51], v16, s[40:43], s49 offen sc1
    s_add_u32 s49, s49, 8192
    buffer_load_dwordx2 v[52:53], v16, s[40:43], s49 offen sc1
    s_add_u32 s49, s49, 8192
    buffer_load_dwordx2 v[54:55], v16, s[40:43], s49 offen sc1
    s_add_u32 s49, s49, 8192
    buffer_load_dwordx2 v[56:57], v16, s[40:43], s49 offen sc1
    s_add_u32 s49, s49, 8192
    buffer_load_dwordx2 v[58:59], v16, s[40:43], s49 offen sc1
    s_add_u32 s49, s49, 8192
    buffer_load_dwordx2 v[60:61], v16, s[40:43], s49 offen sc1
    s_add_u32 s49, s49, 8192
    buffer_load_dwordx2 v[62:63], v16, s[40:43], s49 offen sc1
    s_sub_u32 s3, s3, 1
    s_cbranch_scc1 L_end
    s_waitcnt vmcnt(0)
    v_max3_u32 v15, v32, v33, v34
    v_max3_u32 v15, v15, v35, v36
    v_max3_u32 v15, v15, v37, v38
    v_max3_u32 v15, v15, v39, v40
    v_max3_u32 v15, v15, v41, v42
    v_max3_u32 v15, v15, v43, v44
    v_max3_u32 v15, v15, v45, v46
    v_max3_u32 v15, v15, v47, v48
    v_max3_u32 v15, v15, v49, v50
    v_max3_u32 v15, v15, v51, v52
    v_max3_u32 v15, v15, v53, v54
    v_max3_u32 v15, v15, v55, v56
    v_max3_u32 v15, v15, v57, v58
    v_max3_u32 v15, v15, v59, v60
    v_max3_u32 v15, v15, v61, v62
    v_max_u32 v15, v15, v63
    v_cmp_eq_u32 vcc, -1, v15
    s_cbranch_vccz L_A_md1
    s_sleep 4
    s_branch L_A_md
L_A_md1:
    v_lshlrev_b32 v140, 16, v128
    v_and_b32 v141, 0xffff0000, v128
    v_lshlrev_b32 v142, 16, v129
    v_and_b32 v143, 0xffff0000, v129
    v_lshlrev_b32 v144, 16, v32
    v_and_b32 v145, 0xffff0000, v32
    v_lshlrev_b32 v146, 16, v33
    v_and_b32 v147, 0xffff0000, v33
    v_lshlrev_b32 v14, 16, v34
    v_and_b32 v15, 0xffff0000, v34
    v_pk_add_f32 v[144:145], v[144:145], v[14:15]
    v_lshlrev_b32 v14, 16, v35
    v_and_b32 v15, 0xffff0000, v35
    v_pk_add_f32 v[146:147], v[146:147], v[14:15]
    v_lshlrev_b32 v14, 16, v36
    v_and_b32 v15, 0xffff0000, v36
    v_pk_add_f32 v[144:145], v[144:145], v[14:15]
    v_lshlrev_b32 v14, 16, v37
    v_and_b32 v15, 0xffff0000, v37
    v_pk_add_f32 v[146:147], v[146:147], v[14:15]
    v_lshlrev_b32 v14, 16, v38
    v_and_b32 v15, 0xffff0000, v38
    v_pk_add_f32 v[144:145], v[144:145], v[14:15]
    v_lshlrev_b32 v14, 16, v39
    v_and_b32 v15, 0xffff0000, v39
    v_pk_add_f32 v[146:147], v[146:147], v[14:15]
    v_lshlrev_b32 v148, 16, v40
    v_and_b32 v149, 0xffff0000, v40
    v_lshlrev_b32 v150, 16, v41
    v_and_b32 v151, 0xffff0000, v41
    v_lshlrev_b32 v14, 16, v42
    v_and_b32 v15, 0xffff0000, v42
    v_pk_add_f32 v[148:149], v[148:149], v[14:15]
    v_lshlrev_b32 v14, 16, v43
    v_and_b32 v15, 0xffff0000, v43
    v_pk_add_f32 v[150:151], v[150:151], v[14:15]
    v_lshlrev_b32 v14, 16, v44
    v_and_b32 v15, 0xffff0000, v44
    v_pk_add_f32 v[148:149], v[148:149], v[14:15]
    v_lshlrev_b32 v14, 16, v45
    v_and_b32 v15, 0xffff0000, v45
    v_pk_add_f32 v[150:151], v[150:151], v[14:15]
    v_lshlrev_b32 v14, 16, v46
    v_and_b32 v15, 0xffff0000, v46
    v_pk_add_f32 v[148:149], v[148:149], v[14:15]
    v_lshlrev_b32 v14, 16, v47
    v_and_b32 v15, 0xffff0000, v47
    v_pk_add_f32 v[150:151], v[150:151], v[14:15]
    v_lshlrev_b32 v152, 16, v48
    v_and_b32 v153, 0xffff0000, v48
    v_lshlrev_b32 v154, 16, v49
    v_and_b32 v155, 0xffff0000, v49
    v_lshlrev_b32 v14, 16, v50
    v_and_b32 v15, 0xffff0000, v50
    v_pk_add_f32 v[152:153], v[152:153], v[14:15]
    v_lshlrev_b32 v14, 16, v51
    v_and_b32 v15, 0xffff0000, v51
    v_pk_add_f32 v[154:155], v[154:155], v[14:15]
    v_lshlrev_b32 v14, 16, v52
    v_and_b32 v15, 0xffff0000, v52
    v_pk_add_f32 v[152:153], v[152:153], v[14:15]
    v_lshlrev_b32 v14, 16, v53
    v_and_b32 v15, 0xffff0000, v53
    v_pk_add_f32 v[154:155], v[154:155], v[14:15]
    v_lshlrev_b32 v14, 16, v54
    v_and_b32 v15, 0xffff0000, v54
    v_pk_add_f32 v[152:153], v[152:153], v[14:15]
    v_lshlrev_b32 v14, 16, v55
    v_and_b32 v15, 0xffff0000, v55
    v_pk_add_f32 v[154:155], v[154:155], v[14:15]
    v_lshlrev_b32 v156, 16, v56
    v_and_b32 v157, 0xffff0000, v56
    v_lshlrev_b32 v158, 16, v57
    v_and_b32 v159, 0xffff0000, v57
    v_lshlrev_b32 v14, 16, v58
    v_and_b32 v15, 0xffff0000, v58
    v_pk_add_f32 v[156:157], v[156:157], v[14:15]
    v_lshlrev_b32 v14, 16, v59
    v_and_b32 v15, 0xffff0000, v59
    v_pk_add_f32 v[158:159], v[158:159], v[14:15]
    v_lshlrev_b32 v14, 16, v60
    v_and_b32 v15, 0xffff0000, v60
    v_pk_add_f32 v[156:157], v[156:157], v[14:15]
    v_lshlrev_b32 v14, 16, v61
    v_and_b32 v15, 0xffff0000, v61
    v_pk_add_f32 v[158:159], v[158:159], v[14:15]
    v_lshlrev_b32 v14, 16, v62
    v_and_b32 v15, 0xffff0000, v62
    v_pk_add_f32 v[156:157], v[156:157], v[14:15]
    v_lshlrev_b32 v14, 16, v63
    v_and_b32 v15, 0xffff0000, v63
    v_pk_add_f32 v[158:159], v[158:159], v[14:15]
    v_add_f32 v152, 1.0, v152
    v_add_f32 v153, 1.0, v153
    v_add_f32 v154, 1.0, v154
    v_add_f32 v155, 1.0, v155

    s_lshl_b32 s53, s62, 15
    s_add_u32 s53, s53, s39
    s_add_u32 s56, s53, 851968
    s_add_u32 s53, s53, 589824
    s_and_b32 s38, s35, 24
    s_lshl_b32 s38, s38, 9
    s_add_u32 s56, s56, s38
    s_xor_b32 s57, s56, 4096
    s_xor_b32 s58, s56, 8192
    s_xor_b32 s59, s56, 12288
    v_lshlrev_b32 v5, 17, v10
    v_lshl_add_u32 v5, v3, 4, v5
    v_lshl_add_u32 v7, v12, 14, v5
    s_add_u32 s38, s39, 141312
    v_lshl_add_u32 v24, v10, 10, v13
    v_add_u32 v24, s38, v24
    v_lshlrev_b32 v15, 10, v17
    v_lshl_add_u32 v16, v6, 4, v15
    v_add_u32 v25, s38, v16
    s_add_u32 s38, s39, 143360
    v_add_u32 v27, s38, v16
    s_lshl_b32 s38, s33, 2
    s_add_u32 s38, s38, 145408
    v_lshl_add_u32 v26, v6, 4, s38
    v_lshlrev_b32 v8, 5, v10
    v_add_u32 v8, 145408, v8
    v_bfe_u32 v16, v1, 2, 1
    v_lshl_add_u32 v15, v16, 9, v15
    v_mul_u32_u24 v16, 3, v16
    v_xor_b32 v16, v16, v1
    v_bfe_u32 v18, v16, 1, 1
    v_lshl_add_u32 v15, v18, 7, v15
    v_and_b32 v18, 1, v16
    v_lshl_add_u32 v15, v18, 4, v15
    v_lshl_add_u32 v15, v6, 5, v15
    v_add_u32 v4, 143360, v15
    s_lshl_b32 s60, s33, 15
    s_add_u32 s60, s60, 618496
    v_lshlrev_b32 v13, 7, v9
    s_mov_b32 exec_hi, 0
L_A_hint1:
    buffer_load_dword v12, v13, s[40:43], s60 offen sc1
    s_sub_u32 s3, s3, 1
    s_cbranch_scc1 L_end
    s_waitcnt vmcnt(0)
    v_cmp_eq_u32 vcc, -1, v12
    s_mov_b64 exec, vcc
    s_cbranch_vccnz L_A_hint1
    s_mov_b64 exec, -1
    buffer_load_dwordx4 v[32:35], v7, s[40:43], s56 offen offset:0 sc1
    buffer_load_dwordx4 v[36:39], v7, s[40:43], s56 offen offset:1024 sc1
    buffer_load_dwordx4 v[40:43], v7, s[40:43], s56 offen offset:2048 sc1
    buffer_load_dwordx4 v[44:47], v7, s[40:43], s56 offen offset:3072 sc1
    buffer_load_dwordx4 v[48:51], v7, s[40:43], s57 offen offset:0 sc1
    buffer_load_dwordx4 v[52:55], v7, s[40:43], s57 offen offset:1024 sc1
    buffer_load_dwordx4 v[56:59], v7, s[40:43], s57 offen offset:2048 sc1
    buffer_load_dwordx4 v[60:63], v7, s[40:43], s57 offen offset:3072 sc1
    buffer_load_dwordx4 v[64:67], v7, s[40:43], s58 offen offset:0 sc1
    buffer_load_dwordx4 v[68:71], v7, s[40:43], s58 offen offset:1024 sc1
    buffer_load_dwordx4 v[72:75], v7, s[40:43], s58 offen offset:2048 sc1
    buffer_load_dwordx4 v[76:79], v7, s[40:43], s58 offen offset:3072 sc1
    buffer_load_dwordx4 v[80:83], v7, s[40:43], s59 offen offset:0 sc1
    buffer_load_dwordx4 v[84:87], v7, s[40:43], s59 offen offset:1024 sc1
    buffer_load_dwordx4 v[88:91], v7, s[40:43], s59 offen offset:2048 sc1
    buffer_load_dwordx4 v[92:95], v7, s[40:43], s59 offen offset:3072 sc1
    s_waitcnt vmcnt(12)
L_h4_c0:
    v_max3_u32 v12, v32, v33, v34
    v_max3_u32 v12, v12, v35, v36
    v_max3_u32 v12, v12, v37, v38
    v_max3_u32 v12, v12, v39, v40
    v_max3_u32 v12, v12, v41, v42
    v_max3_u32 v12, v12, v43, v44
    v_max3_u32 v12, v12, v45, v46
    v_max_u32 v12, v12, v47
    v_cmp_eq_u32 vcc, -1, v12
    s_cbranch_vccnz L_h4_r0
    v_mfma_f32_16x16x32_bf16 v[28:31], v[20:23], v[32:35], 0
    v_mfma_f32_16x16x32_bf16 v[28:31], v[20:23], v[36:39], v[28:31]
    v_mfma_f32_16x16x32_bf16 v[28:31], v[20:23], v[40:43], v[28:31]
    v_mfma_f32_16x16x32_bf16 v[28:31], v[20:23], v[44:47], v[28:31]
    s_waitcnt vmcnt(8)
L_h4_c1:
    v_max3_u32 v12, v48, v49, v50
    v_max3_u32 v12, v12, v51, v52
    v_max3_u32 v12, v12, v53, v54
    v_max3_u32 v12, v12, v55, v56
    v_max3_u32 v12, v12, v57, v58
    v_max3_u32 v12, v12, v59, v60
    v_max3_u32 v12, v12, v61, v62
    v_max_u32 v12, v12, v63
    v_cmp_eq_u32 vcc, -1, v12
    s_cbranch_vccnz L_h4_r1
    v_mfma_f32_16x16x32_bf16 v[28:31], v[20:23], v[48:51], v[28:31]
    v_mfma_f32_16x16x32_bf16 v[28:31], v[20:23], v[52:55], v[28:31]
    v_mfma_f32_16x16x32_bf16 v[28:31], v[20:23], v[56:59], v[28:31]
    v_mfma_f32_16x16x32_bf16 v[28:31], v[20:23], v[60:63], v[28:31]
    s_waitcnt vmcnt(4)
L_h4_c2:
    v_max3_u32 v12, v64, v65, v66
    v_max3_u32 v12, v12, v67, v68
    v_max3_u32 v12, v12, v69, v70
    v_max3_u32 v12, v12, v71, v72
    v_max3_u32 v12, v12, v73, v74
    v_max3_u32 v12, v12, v75, v76
    v_max3_u32 v12, v12, v77, v78
    v_max_u32 v12, v12, v79
    v_cmp_eq_u32 vcc, -1, v12
    s_cbranch_vccnz L_h4_r2
    v_mfma_f32_16x16x32_bf16 v[28:31], v[20:23], v[64:67], v[28:31]
    v_mfma_f32_16x16x32_bf16 v[28:31], v[20:23], v[68:71], v[28:31]
    v_mfma_f32_16x16x32_bf16 v[28:31], v[20:23], v[72:75], v[28:31]
    v_mfma_f32_16x16x32_bf16 v[28:31], v[20:23], v[76:79], v[28:31]
    s_waitcnt vmcnt(0)
L_h4_c3:
    v_max3_u32 v12, v80, v81, v82
    v_max3_u32 v12, v12, v83, v84
    v_max3_u32 v12, v12, v85, v86
    v_max3_u32 v12, v12, v87, v88
    v_max3_u32 v12, v12, v89, v90
    v_max3_u32 v12, v12, v91, v92
    v_max3_u32 v12, v12, v93, v94
    v_max_u32 v12, v12, v95
    v_cmp_eq_u32 vcc, -1, v12
    s_cbranch_vccnz L_h4_r3
    v_mfma_f32_16x16x32_bf16 v[28:31], v[20:23], v[80:83], v[28:31]
    v_mfma_f32_16x16x32_bf16 v[28:31], v[20:23], v[84:87], v[28:31]
    v_mfma_f32_16x16x32_bf16 v[28:31], v[20:23], v[88:91], v[28:31]
    v_mfma_f32_16x16x32_bf16 v[28:31], v[20:23], v[92:95], v[28:31]
    s_nop 7
    v_fma_f32 v28, v28, v144, v140
    v_fma_f32 v29, v29, v145, v141
    v_fma_f32 v30, v30, v146, v142
    v_fma_f32 v31, v31, v147, v143
    s_cmp_ge_u32 s34, 4
    s_cbranch_scc1 L_A_fin
    ds_read_b64_tr_b16 v[64:65], v160 offset:8192
    ds_read_b64_tr_b16 v[66:67], v160 offset:8704
    ds_read_b64_tr_b16 v[68:69], v161 offset:8192
    ds_read_b64_tr_b16 v[70:71], v161 offset:8704
    ds_read_b64_tr_b16 v[72:73], v162 offset:8192
    ds_read_b64_tr_b16 v[74:75], v162 offset:8704
    ds_read_b64_tr_b16 v[76:77], v163 offset:8192
    ds_read_b64_tr_b16 v[78:79], v163 offset:8704

    v_add_f32 v12, v28, v29
    v_mul_f32 v13, v28, v28
    v_add_f32 v14, v30, v31
    v_fmac_f32 v13, v29, v29
    v_add_f32 v12, v12, v14
    v_fmac_f32 v13, v30, v30
    v_fmac_f32 v13, v31, v31
    s_nop 1
    v_permlane16_swap_b32 v12, v13
    v_add_f32 v12, v12, v13
    s_nop 1
    v_add_f32_dpp v12, v12, v12 quad_perm:[1,0,3,2] row_mask:0xf bank_mask:0xf
    s_nop 1
    v_add_f32_dpp v12, v12, v12 quad_perm:[2,3,0,1] row_mask:0xf bank_mask:0xf
    s_nop 1
    v_add_f32_dpp v12, v12, v12 row_half_mirror row_mask:0xf bank_mask:0xf
    s_nop 1
    v_add_f32_dpp v12, v12, v12 row_mirror row_mask:0xf bank_mask:0xf
    ds_write_b32 v26, v12
    ds_read_b64_tr_b16 v[80:81], v160 offset:12288
    ds_read_b64_tr_b16 v[82:83], v160 offset:12800
    ds_read_b64_tr_b16 v[84:85], v161 offset:12288
    ds_read_b64_tr_b16 v[86:87], v161 offset:12800
    ds_read_b64_tr_b16 v[88:89], v162 offset:12288
    ds_read_b64_tr_b16 v[90:91], v162 offset:12800
    ds_read_b64_tr_b16 v[92:93], v163 offset:12288
    ds_read_b64_tr_b16 v[94:95], v163 offset:12800
L_A_ln:
    ds_read_b128 v[12:15], v8
    ds_read_b128 v[16:19], v8 offset:16
    s_sub_u32 s3, s3, 1
    s_cbranch_scc1 L_end
    s_waitcnt lgkmcnt(0)
    v_max3_u32 v32, v12, v13, v14
    v_max3_u32 v32, v32, v15, v16
    v_max3_u32 v32, v32, v17, v18
    v_max_u32 v32, v32, v19
    v_cmp_eq_u32 vcc, -1, v32
    s_cbranch_vccnz L_A_ln
    v_add_f32 v12, v12, v13
    v_add_f32 v16, v16, v17
    v_add_f32 v14, v14, v15
    v_add_f32 v18, v18, v19
    s_mov_b32 s38, 0x3b000000
    v_add_f32 v12, v12, v14
    v_add_f32 v16, v16, v18
    v_mul_f32 v12, s38, v12
    v_mul_f32 v16, s38, v16
    v_fma_f32 v16, -v12, v12, v16
    v_max_f32 v16, 0, v16
    v_add_f32 v16, 0x3727c5ac, v16
    v_rsq_f32 v16, v16
    v_sub_f32 v28, v28, v12
    v_sub_f32 v29, v29, v12
    v_sub_f32 v30, v30, v12
    v_sub_f32 v31, v31, v12
    v_mul_f32 v152, v152, v16
    v_mul_f32 v153, v153, v16
    v_mul_f32 v154, v154, v16
    v_mul_f32 v155, v155, v16
    v_fma_f32 v28, v28, v152, v148
    v_fma_f32 v29, v29, v153, v149
    v_fma_f32 v30, v30, v154, v150
    v_fma_f32 v31, v31, v155, v151
    v_cvt_pk_bf16_f32 v28, v28, v29
    v_cvt_pk_bf16_f32 v29, v30, v31
    ds_write_b64 v24, v[28:29]
    ds_read_b128 v[128:131], v25 offset:0
    ds_read_b128 v[132:135], v25 offset:64
    ds_read_b128 v[136:139], v25 offset:128
    ds_read_b128 v[140:143], v25 offset:192
    v_xor_b32 v13, 32, v2
    v_xor_b32 v14, 64, v2
    v_xor_b32 v15, 96, v2
    v_xor_b32 v16, 128, v2
    v_xor_b32 v17, 160, v2
    v_xor_b32 v18, 192, v2
    v_xor_b32 v19, 224, v2
    s_waitcnt lgkmcnt(3)
    v_mfma_f32_16x16x32_bf16 v[32:35], v[96:99], v[128:131], 0
    v_mfma_f32_16x16x32_bf16 v[36:39], v[100:103], v[128:131], 0
    v_mfma_f32_16x16x32_bf16 v[40:43], v[104:107], v[128:131], 0
    v_mfma_f32_16x16x32_bf16 v[44:47], v[108:111], v[128:131], 0
    s_waitcnt lgkmcnt(2)
    v_mfma_f32_16x16x32_bf16 v[32:35], v[112:115], v[132:135], v[32:35]
    v_mfma_f32_16x16x32_bf16 v[36:39], v[116:119], v[132:135], v[36:39]
    v_mfma_f32_16x16x32_bf16 v[40:43], v[120:123], v[132:135], v[40:43]
    v_mfma_f32_16x16x32_bf16 v[44:47], v[124:127], v[132:135], v[44:47]
    s_waitcnt lgkmcnt(1)
    v_mfma_f32_16x16x32_bf16 v[32:35], v[64:67], v[136:139], v[32:35]
    v_mfma_f32_16x16x32_bf16 v[36:39], v[68:71], v[136:139], v[36:39]
    v_mfma_f32_16x16x32_bf16 v[40:43], v[72:75], v[136:139], v[40:43]
    v_mfma_f32_16x16x32_bf16 v[44:47], v[76:79], v[136:139], v[44:47]
    s_waitcnt lgkmcnt(0)
    v_mfma_f32_16x16x32_bf16 v[32:35], v[80:83], v[140:143], v[32:35]
    v_mfma_f32_16x16x32_bf16 v[36:39], v[84:87], v[140:143], v[36:39]
    v_mfma_f32_16x16x32_bf16 v[40:43], v[88:91], v[140:143], v[40:43]
    v_mfma_f32_16x16x32_bf16 v[44:47], v[92:95], v[140:143], v[44:47]
    ds_read_b64_tr_b16 v[96:97], v2 offset:0
    ds_read_b64_tr_b16 v[98:99], v2 offset:1024
    ds_read_b64_tr_b16 v[100:101], v13 offset:0
    ds_read_b64_tr_b16 v[102:103], v13 offset:1024
    ds_read_b64_tr_b16 v[104:105], v14 offset:0
    ds_read_b64_tr_b16 v[106:107], v14 offset:1024
    ds_read_b64_tr_b16 v[108:109], v15 offset:0
    ds_read_b64_tr_b16 v[110:111], v15 offset:1024
    s_mov_b32 exec_lo, 0x01010101
    s_mov_b32 exec_hi, 0x01010101
    ds_write_b128 v27, v[32:35] offset:0
    ds_write_b128 v27, v[36:39] offset:64
    ds_write_b128 v27, v[40:43] offset:128
    ds_write_b128 v27, v[44:47] offset:192
    s_mov_b64 exec, -1
    v_mov_b32 v12, 1
    s_mov_b64 exec, 1
    ds_add_u32 v0, v12 offset:4032
    s_mov_b64 exec, -1
    s_waitcnt lgkmcnt(6)
    ds_read_b64_tr_b16 v[112:113], v16 offset:0
    ds_read_b64_tr_b16 v[114:115], v16 offset:1024
    ds_read_b64_tr_b16 v[116:117], v17 offset:0
    ds_read_b64_tr_b16 v[118:119], v17 offset:1024
    ds_read_b64_tr_b16 v[120:121], v18 offset:0
    ds_read_b64_tr_b16 v[122:123], v18 offset:1024
    ds_read_b64_tr_b16 v[124:125], v19 offset:0
    ds_read_b64_tr_b16 v[126:127], v19 offset:1024
    s_waitcnt lgkmcnt(4)
    ds_read_b64_tr_b16 v[64:65], v2 offset:8192
    ds_read_b64_tr_b16 v[66:67], v2 offset:9216
    ds_read_b64_tr_b16 v[68:69], v13 offset:8192
    ds_read_b64_tr_b16 v[70:71], v13 offset:9216
    ds_read_b64_tr_b16 v[72:73], v14 offset:8192
    ds_read_b64_tr_b16 v[74:75], v14 offset:9216
    ds_read_b64_tr_b16 v[76:77], v15 offset:8192
    ds_read_b64_tr_b16 v[78:79], v15 offset:9216
    s_waitcnt lgkmcnt(4)
    ds_read_b64_tr_b16 v[80:81], v16 offset:8192
    ds_read_b64_tr_b16 v[82:83], v16 offset:9216
    ds_read_b64_tr_b16 v[84:85], v17 offset:8192
    ds_read_b64_tr_b16 v[86:87], v17 offset:9216
    ds_read_b64_tr_b16 v[88:89], v18 offset:8192
    ds_read_b64_tr_b16 v[90:91], v18 offset:9216
    ds_read_b64_tr_b16 v[92:93], v19 offset:8192
    ds_read_b64_tr_b16 v[94:95], v19 offset:9216
L_w11:
    ds_read_b32 v12, v0 offset:4032
    s_sub_u32 s3, s3, 1
    s_cbranch_scc1 L_end
    s_waitcnt lgkmcnt(0)
    v_cmp_gt_u32 vcc, 4, v12
    s_cbranch_vccnz L_w11
    ds_read_b128 v[28:31], v4
    ds_read_b128 v[12:15], v4 offset:256
    s_waitcnt lgkmcnt(0)
    v_add_f32 v28, v28, v12
    v_add_f32 v29, v29, v13
    v_add_f32 v30, v30, v14
    v_add_f32 v31, v31, v15
    v_add_f32_dpp v28, v28, v28 row_half_mirror row_mask:0xf bank_mask:0xf
    v_add_f32_dpp v29, v29, v29 row_half_mirror row_mask:0xf bank_mask:0xf
    v_add_f32_dpp v30, v30, v30 row_half_mirror row_mask:0xf bank_mask:0xf
    v_add_f32_dpp v31, v31, v31 row_half_mirror row_mask:0xf bank_mask:0xf
    v_max_f32 v28, 0, v28
    v_max_f32 v29, 0, v29
    v_max_f32 v30, 0, v30
    v_max_f32 v31, 0, v31
    v_cvt_pk_bf16_f32 v28, v28, v29
    v_cvt_pk_bf16_f32 v29, v30, v31
    s_nop 0
    v_mov_b32_dpp v128, v28 row_newbcast:0 row_mask:0xf bank_mask:0x3
    v_mov_b32_dpp v129, v29 row_newbcast:0 row_mask:0xf bank_mask:0x3
    v_mov_b32_dpp v130, v28 row_newbcast:1 row_mask:0xf bank_mask:0x3
    v_mov_b32_dpp v131, v29 row_newbcast:1 row_mask:0xf bank_mask:0x3
    v_mov_b32_dpp v128, v28 row_newbcast:8 row_mask:0xf bank_mask:0xc
    v_mov_b32_dpp v129, v29 row_newbcast:8 row_mask:0xf bank_mask:0xc
    v_mov_b32_dpp v130, v28 row_newbcast:9 row_mask:0xf bank_mask:0xc
    v_mov_b32_dpp v131, v29 row_newbcast:9 row_mask:0xf bank_mask:0xc
    s_nop 1
    v_mfma_f32_16x16x32_bf16 v[32:35], v[128:131], v[96:99], 0
    v_mov_b32_dpp v132, v28 row_newbcast:2 row_mask:0xf bank_mask:0x3
    v_mov_b32_dpp v133, v29 row_newbcast:2 row_mask:0xf bank_mask:0x3
    v_mov_b32_dpp v134, v28 row_newbcast:3 row_mask:0xf bank_mask:0x3
    v_mov_b32_dpp v135, v29 row_newbcast:3 row_mask:0xf bank_mask:0x3
    v_mfma_f32_16x16x32_bf16 v[36:39], v[128:131], v[100:103], 0
    v_mfma_f32_16x16x32_bf16 v[40:43], v[128:131], v[104:107], 0
    v_mov_b32_dpp v132, v28 row_newbcast:10 row_mask:0xf bank_mask:0xc
    v_mov_b32_dpp v133, v29 row_newbcast:10 row_mask:0xf bank_mask:0xc
    v_mov_b32_dpp v134, v28 row_newbcast:11 row_mask:0xf bank_mask:0xc
    v_mov_b32_dpp v135, v29 row_newbcast:11 row_mask:0xf bank_mask:0xc
    v_mfma_f32_16x16x32_bf16 v[44:47], v[128:131], v[108:111], 0
    v_mfma_f32_16x16x32_bf16 v[48:51], v[128:131], v[112:115], 0
    v_mfma_f32_16x16x32_bf16 v[52:55], v[128:131], v[116:119], 0
    v_mfma_f32_16x16x32_bf16 v[56:59], v[128:131], v[120:123], 0
    v_mfma_f32_16x16x32_bf16 v[60:63], v[128:131], v[124:127], 0
    v_mfma_f32_16x16x32_bf16 v[32:35], v[132:135], v[64:67], v[32:35]
    v_mfma_f32_16x16x32_bf16 v[36:39], v[132:135], v[68:71], v[36:39]
    v_mfma_f32_16x16x32_bf16 v[40:43], v[132:135], v[72:75], v[40:43]
    v_mfma_f32_16x16x32_bf16 v[44:47], v[132:135], v[76:79], v[44:47]
    v_mfma_f32_16x16x32_bf16 v[48:51], v[132:135], v[80:83], v[48:51]
    v_mfma_f32_16x16x32_bf16 v[52:55], v[132:135], v[84:87], v[52:55]
    v_mfma_f32_16x16x32_bf16 v[56:59], v[132:135], v[88:91], v[56:59]
    v_mfma_f32_16x16x32_bf16 v[60:63], v[132:135], v[92:95], v[60:63]
    s_lshl_b32 s38, s35, 10
    s_add_u32 s38, s38, s53
    v_cvt_pk_bf16_f32 v28, v32, v36
    s_nop 0
    v_cvt_pk_bf16_f32 v29, v40, v44
    s_nop 0
    v_cvt_pk_bf16_f32 v30, v48, v52
    s_nop 0
    v_cvt_pk_bf16_f32 v31, v56, v60
    s_mov_b32 exec_lo, 0xffff
    s_mov_b32 exec_hi, 0xffff
    buffer_store_dwordx4 v[28:31], v5, s[40:43], s38 offen sc1
    s_branch L_end
L_A_fin:
    s_mov_b32 s44, s26
    s_mov_b32 s45, s27
    s_mov_b32 s46, 8192
    s_mov_b32 s47, 0x20000

    v_and_b32 v12, 7, v1
    v_lshlrev_b32 v13, 1, v12
    v_lshrrev_b32 v14, 1, v6
    v_add_u32 v13, v13, v14
    v_and_b32 v14, 1, v6
    v_lshl_add_u32 v13, v14, 4, v13
    v_lshl_add_u32 v13, v17, 5, v13
    v_lshlrev_b32 v13, 2, v13
    ds_bpermute_b32 v140, v13, v28
    ds_bpermute_b32 v144, v13, v156
    ds_bpermute_b32 v141, v13, v29
    ds_bpermute_b32 v145, v13, v157
    ds_bpermute_b32 v142, v13, v30
    ds_bpermute_b32 v146, v13, v158
    ds_bpermute_b32 v143, v13, v31
    ds_bpermute_b32 v147, v13, v159

    v_lshlrev_b32 v4, 5, v12
    v_lshl_add_u32 v4, v6, 3, v4
    v_lshl_add_u32 v4, v17, 12, v4
    v_mul_u32_u24 v7, 14336, v14
    v_add_u32 v7, v7, v5
    s_mov_b32 s56, s53
    s_add_u32 s57, s53, 4096
    s_add_u32 s58, s53, 8192
    s_add_u32 s59, s53, 12288
    s_waitcnt lgkmcnt(0)
    buffer_load_dwordx4 v[32:35], v7, s[40:43], s56 offen offset:0 sc1
    buffer_load_dwordx4 v[36:39], v7, s[40:43], s56 offen offset:1024 sc1
    buffer_load_dwordx4 v[40:43], v7, s[40:43], s56 offen offset:2048 sc1
    buffer_load_dwordx4 v[44:47], v7, s[40:43], s56 offen offset:3072 sc1
    buffer_load_dwordx4 v[48:51], v7, s[40:43], s57 offen offset:0 sc1
    buffer_load_dwordx4 v[52:55], v7, s[40:43], s57 offen offset:1024 sc1
    buffer_load_dwordx4 v[56:59], v7, s[40:43], s57 offen offset:2048 sc1
    buffer_load_dwordx4 v[60:63], v7, s[40:43], s57 offen offset:3072 sc1
    buffer_load_dwordx4 v[64:67], v7, s[40:43], s58 offen offset:0 sc1
    buffer_load_dwordx4 v[68:71], v7, s[40:43], s58 offen offset:1024 sc1
    buffer_load_dwordx4 v[72:75], v7, s[40:43], s58 offen offset:2048 sc1
    buffer_load_dwordx4 v[76:79], v7, s[40:43], s58 offen offset:3072 sc1
    buffer_load_dwordx4 v[80:83], v7, s[40:43], s59 offen offset:0 sc1
    buffer_load_dwordx4 v[84:87], v7, s[40:43], s59 offen offset:1024 sc1
    s_waitcnt vmcnt(10)
L_h5_c0:
    v_max3_u32 v12, v32, v33, v34
    v_max3_u32 v12, v12, v35, v36
    v_max3_u32 v12, v12, v37, v38
    v_max3_u32 v12, v12, v39, v40
    v_max3_u32 v12, v12, v41, v42
    v_max3_u32 v12, v12, v43, v44
    v_max3_u32 v12, v12, v45, v46
    v_max_u32 v12, v12, v47
    v_cmp_eq_u32 vcc, -1, v12
    s_cbranch_vccnz L_h5_r0
    v_mfma_f32_16x16x32_bf16 v[28:31], v[32:35], v[20:23], 0
    v_mfma_f32_16x16x32_bf16 v[28:31], v[36:39], v[20:23], v[28:31]
    v_mfma_f32_16x16x32_bf16 v[28:31], v[40:43], v[20:23], v[28:31]
    v_mfma_f32_16x16x32_bf16 v[28:31], v[44:47], v[20:23], v[28:31]
    s_waitcnt vmcnt(6)
L_h5_c1:
    v_max3_u32 v12, v48, v49, v50
    v_max3_u32 v12, v12, v51, v52
    v_max3_u32 v12, v12, v53, v54
    v_max3_u32 v12, v12, v55, v56
    v_max3_u32 v12, v12, v57, v58
    v_max3_u32 v12, v12, v59, v60
    v_max3_u32 v12, v12, v61, v62
    v_max_u32 v12, v12, v63
    v_cmp_eq_u32 vcc, -1, v12
    s_cbranch_vccnz L_h5_r1
    v_mfma_f32_16x16x32_bf16 v[28:31], v[48:51], v[20:23], v[28:31]
    v_mfma_f32_16x16x32_bf16 v[28:31], v[52:55], v[20:23], v[28:31]
    v_mfma_f32_16x16x32_bf16 v[28:31], v[56:59], v[20:23], v[28:31]
    v_mfma_f32_16x16x32_bf16 v[28:31], v[60:63], v[20:23], v[28:31]
    s_waitcnt vmcnt(2)
L_h5_c2:
    v_max3_u32 v12, v64, v65, v66
    v_max3_u32 v12, v12, v67, v68
    v_max3_u32 v12, v12, v69, v70
    v_max3_u32 v12, v12, v71, v72
    v_max3_u32 v12, v12, v73, v74
    v_max3_u32 v12, v12, v75, v76
    v_max3_u32 v12, v12, v77, v78
    v_max_u32 v12, v12, v79
    v_cmp_eq_u32 vcc, -1, v12
    s_cbranch_vccnz L_h5_r2
    v_mfma_f32_16x16x32_bf16 v[28:31], v[64:67], v[20:23], v[28:31]
    v_mfma_f32_16x16x32_bf16 v[28:31], v[68:71], v[20:23], v[28:31]
    v_mfma_f32_16x16x32_bf16 v[28:31], v[72:75], v[20:23], v[28:31]
    v_mfma_f32_16x16x32_bf16 v[28:31], v[76:79], v[20:23], v[28:31]
    s_waitcnt vmcnt(0)
L_h5_c3:
    v_max3_u32 v12, v80, v81, v82
    v_max3_u32 v12, v12, v83, v84
    v_max3_u32 v12, v12, v85, v86
    v_max_u32 v12, v12, v87
    v_cmp_eq_u32 vcc, -1, v12
    s_cbranch_vccnz L_h5_r3
    v_mfma_f32_16x16x32_bf16 v[28:31], v[80:83], v[20:23], v[28:31]
    v_mfma_f32_16x16x32_bf16 v[28:31], v[84:87], v[20:23], v[28:31]
    s_nop 7
    v_fma_f32 v28, v28, v144, v140
    v_fma_f32 v29, v29, v145, v141
    v_fma_f32 v30, v30, v146, v142
    v_fma_f32 v31, v31, v147, v143
    v_cvt_pk_bf16_f32 v28, v28, v29
    v_cvt_pk_bf16_f32 v29, v30, v31
    buffer_store_dwordx2 v[28:29], v4, s[44:47], s48 offen
    s_branch L_end
L_h4_r0:
    buffer_load_dwordx4 v[32:35], v7, s[40:43], s56 offen offset:0 sc1
    buffer_load_dwordx4 v[36:39], v7, s[40:43], s56 offen offset:1024 sc1
    buffer_load_dwordx4 v[40:43], v7, s[40:43], s56 offen offset:2048 sc1
    buffer_load_dwordx4 v[44:47], v7, s[40:43], s56 offen offset:3072 sc1
    buffer_load_dwordx4 v[48:51], v7, s[40:43], s57 offen offset:0 sc1
    buffer_load_dwordx4 v[52:55], v7, s[40:43], s57 offen offset:1024 sc1
    buffer_load_dwordx4 v[56:59], v7, s[40:43], s57 offen offset:2048 sc1
    buffer_load_dwordx4 v[60:63], v7, s[40:43], s57 offen offset:3072 sc1
    buffer_load_dwordx4 v[64:67], v7, s[40:43], s58 offen offset:0 sc1
    buffer_load_dwordx4 v[68:71], v7, s[40:43], s58 offen offset:1024 sc1
    buffer_load_dwordx4 v[72:75], v7, s[40:43], s58 offen offset:2048 sc1
    buffer_load_dwordx4 v[76:79], v7, s[40:43], s58 offen offset:3072 sc1
    buffer_load_dwordx4 v[80:83], v7, s[40:43], s59 offen offset:0 sc1
    buffer_load_dwordx4 v[84:87], v7, s[40:43], s59 offen offset:1024 sc1
    buffer_load_dwordx4 v[88:91], v7, s[40:43], s59 offen offset:2048 sc1
    buffer_load_dwordx4 v[92:95], v7, s[40:43], s59 offen offset:3072 sc1
    s_sub_u32 s3, s3, 1
    s_cbranch_scc1 L_end
    s_waitcnt vmcnt(12)
    s_branch L_h4_c0
L_h4_r1:
    buffer_load_dwordx4 v[48:51], v7, s[40:43], s57 offen offset:0 sc1
    buffer_load_dwordx4 v[52:55], v7, s[40:43], s57 offen offset:1024 sc1
    buffer_load_dwordx4 v[56:59], v7, s[40:43], s57 offen offset:2048 sc1
    buffer_load_dwordx4 v[60:63], v7, s[40:43], s57 offen offset:3072 sc1
    buffer_load_dwordx4 v[64:67], v7, s[40:43], s58 offen offset:0 sc1
    buffer_load_dwordx4 v[68:71], v7, s[40:43], s58 offen offset:1024 sc1
    buffer_load_dwordx4 v[72:75], v7, s[40:43], s58 offen offset:2048 sc1
    buffer_load_dwordx4 v[76:79], v7, s[40:43], s58 offen offset:3072 sc1
    buffer_load_dwordx4 v[80:83], v7, s[40:43], s59 offen offset:0 sc1
    buffer_load_dwordx4 v[84:87], v7, s[40:43], s59 offen offset:1024 sc1
    buffer_load_dwordx4 v[88:91], v7, s[40:43], s59 offen offset:2048 sc1
    buffer_load_dwordx4 v[92:95], v7, s[40:43], s59 offen offset:3072 sc1
    s_sub_u32 s3, s3, 1
    s_cbranch_scc1 L_end
    s_waitcnt vmcnt(8)
    s_branch L_h4_c1
L_h4_r2:
    buffer_load_dwordx4 v[64:67], v7, s[40:43], s58 offen offset:0 sc1
    buffer_load_dwordx4 v[68:71], v7, s[40:43], s58 offen offset:1024 sc1
    buffer_load_dwordx4 v[72:75], v7, s[40:43], s58 offen offset:2048 sc1
    buffer_load_dwordx4 v[76:79], v7, s[40:43], s58 offen offset:3072 sc1
    buffer_load_dwordx4 v[80:83], v7, s[40:43], s59 offen offset:0 sc1
    buffer_load_dwordx4 v[84:87], v7, s[40:43], s59 offen offset:1024 sc1
    buffer_load_dwordx4 v[88:91], v7, s[40:43], s59 offen offset:2048 sc1
    buffer_load_dwordx4 v[92:95], v7, s[40:43], s59 offen offset:3072 sc1
    s_sub_u32 s3, s3, 1
    s_cbranch_scc1 L_end
    s_waitcnt vmcnt(4)
    s_branch L_h4_c2
L_h4_r3:
    buffer_load_dwordx4 v[80:83], v7, s[40:43], s59 offen offset:0 sc1
    buffer_load_dwordx4 v[84:87], v7, s[40:43], s59 offen offset:1024 sc1
    buffer_load_dwordx4 v[88:91], v7, s[40:43], s59 offen offset:2048 sc1
    buffer_load_dwordx4 v[92:95], v7, s[40:43], s59 offen offset:3072 sc1
    s_sub_u32 s3, s3, 1
    s_cbranch_scc1 L_end
    s_waitcnt vmcnt(0)
    s_branch L_h4_c3
L_h5_r0:
    buffer_load_dwordx4 v[32:35], v7, s[40:43], s56 offen offset:0 sc1
    buffer_load_dwordx4 v[36:39], v7, s[40:43], s56 offen offset:1024 sc1
    buffer_load_dwordx4 v[40:43], v7, s[40:43], s56 offen offset:2048 sc1
    buffer_load_dwordx4 v[44:47], v7, s[40:43], s56 offen offset:3072 sc1
    buffer_load_dwordx4 v[48:51], v7, s[40:43], s57 offen offset:0 sc1
    buffer_load_dwordx4 v[52:55], v7, s[40:43], s57 offen offset:1024 sc1
    buffer_load_dwordx4 v[56:59], v7, s[40:43], s57 offen offset:2048 sc1
    buffer_load_dwordx4 v[60:63], v7, s[40:43], s57 offen offset:3072 sc1
    buffer_load_dwordx4 v[64:67], v7, s[40:43], s58 offen offset:0 sc1
    buffer_load_dwordx4 v[68:71], v7, s[40:43], s58 offen offset:1024 sc1
    buffer_load_dwordx4 v[72:75], v7, s[40:43], s58 offen offset:2048 sc1
    buffer_load_dwordx4 v[76:79], v7, s[40:43], s58 offen offset:3072 sc1
    buffer_load_dwordx4 v[80:83], v7, s[40:43], s59 offen offset:0 sc1
    buffer_load_dwordx4 v[84:87], v7, s[40:43], s59 offen offset:1024 sc1
    s_sub_u32 s3, s3, 1
    s_cbranch_scc1 L_end
    s_waitcnt vmcnt(10)
    s_branch L_h5_c0
L_h5_r1:
    buffer_load_dwordx4 v[48:51], v7, s[40:43], s57 offen offset:0 sc1
    buffer_load_dwordx4 v[52:55], v7, s[40:43], s57 offen offset:1024 sc1
    buffer_load_dwordx4 v[56:59], v7, s[40:43], s57 offen offset:2048 sc1
    buffer_load_dwordx4 v[60:63], v7, s[40:43], s57 offen offset:3072 sc1
    buffer_load_dwordx4 v[64:67], v7, s[40:43], s58 offen offset:0 sc1
    buffer_load_dwordx4 v[68:71], v7, s[40:43], s58 offen offset:1024 sc1
    buffer_load_dwordx4 v[72:75], v7, s[40:43], s58 offen offset:2048 sc1
    buffer_load_dwordx4 v[76:79], v7, s[40:43], s58 offen offset:3072 sc1
    buffer_load_dwordx4 v[80:83], v7, s[40:43], s59 offen offset:0 sc1
    buffer_load_dwordx4 v[84:87], v7, s[40:43], s59 offen offset:1024 sc1
    s_sub_u32 s3, s3, 1
    s_cbranch_scc1 L_end
    s_waitcnt vmcnt(6)
    s_branch L_h5_c1
L_h5_r2:
    buffer_load_dwordx4 v[64:67], v7, s[40:43], s58 offen offset:0 sc1
    buffer_load_dwordx4 v[68:71], v7, s[40:43], s58 offen offset:1024 sc1
    buffer_load_dwordx4 v[72:75], v7, s[40:43], s58 offen offset:2048 sc1
    buffer_load_dwordx4 v[76:79], v7, s[40:43], s58 offen offset:3072 sc1
    buffer_load_dwordx4 v[80:83], v7, s[40:43], s59 offen offset:0 sc1
    buffer_load_dwordx4 v[84:87], v7, s[40:43], s59 offen offset:1024 sc1
    s_sub_u32 s3, s3, 1
    s_cbranch_scc1 L_end
    s_waitcnt vmcnt(2)
    s_branch L_h5_c2
L_h5_r3:
    buffer_load_dwordx4 v[80:83], v7, s[40:43], s59 offen offset:0 sc1
    buffer_load_dwordx4 v[84:87], v7, s[40:43], s59 offen offset:1024 sc1
    s_sub_u32 s3, s3, 1
    s_cbranch_scc1 L_end
    s_waitcnt vmcnt(0)
    s_branch L_h5_c3
L_Bc:

    s_lshl_b32 s48, s33, 20
    s_lshl_b32 s38, s35, 8
    s_add_u32 s48, s48, s38
    s_and_b32 s49, s34, 3
    v_lshrrev_b32 v4, 4, v1
    v_and_b32 v5, 15, v1
    v_lshlrev_b32 v2, 18, v4
    v_lshl_add_u32 v2, v5, 4, v2
    s_waitcnt lgkmcnt(0)
    s_mov_b32 s44, s8
    s_mov_b32 s45, s9
    s_mov_b32 s46, 4194304
    s_mov_b32 s47, 0x20000
    s_xor_b32 s38, s49, 0
    s_lshl_b32 s38, s38, 16
    s_add_u32 s38, s38, s48
    buffer_load_dwordx4 v[40:43], v2, s[44:47], s38 offen
    s_add_u32 s38, s38, 8192
    buffer_load_dwordx4 v[44:47], v2, s[44:47], s38 offen
    s_add_u32 s38, s38, 8192
    buffer_load_dwordx4 v[48:51], v2, s[44:47], s38 offen
    s_add_u32 s38, s38, 8192
    buffer_load_dwordx4 v[52:55], v2, s[44:47], s38 offen
    s_add_u32 s38, s38, 8192
    buffer_load_dwordx4 v[56:59], v2, s[44:47], s38 offen
    s_add_u32 s38, s38, 8192
    buffer_load_dwordx4 v[60:63], v2, s[44:47], s38 offen
    s_add_u32 s38, s38, 8192
    buffer_load_dwordx4 v[64:67], v2, s[44:47], s38 offen
    s_add_u32 s38, s38, 8192
    buffer_load_dwordx4 v[68:71], v2, s[44:47], s38 offen
    s_mov_b32 s40, s30
    s_mov_b32 s41, s31
    s_mov_b32 s42, 16777216
    s_mov_b32 s43, 0x20000

    s_mov_b32 s3, 0x400000
    v_mov_b32 v0, 156256
    s_lshl_b32 s54, s34, 5
    s_add_u32 s54, s54, s35
    s_lshl_b32 s54, s54, 10
    s_and_b32 s96, s36, 3
    s_and_b32 s39, s34, 4
    s_add_u32 s96, s96, s39

    s_barrier
    s_xor_b32 s38, s49, 1
    s_lshl_b32 s38, s38, 16
    s_add_u32 s38, s38, s48
    buffer_load_dwordx4 v[72:75], v2, s[44:47], s38 offen
    s_add_u32 s38, s38, 8192
    buffer_load_dwordx4 v[76:79], v2, s[44:47], s38 offen
    s_add_u32 s38, s38, 8192
    buffer_load_dwordx4 v[80:83], v2, s[44:47], s38 offen
    s_add_u32 s38, s38, 8192
    buffer_load_dwordx4 v[84:87], v2, s[44:47], s38 offen
    s_add_u32 s38, s38, 8192
    buffer_load_dwordx4 v[88:91], v2, s[44:47], s38 offen
    s_add_u32 s38, s38, 8192
    buffer_load_dwordx4 v[92:95], v2, s[44:47], s38 offen
    s_add_u32 s38, s38, 8192
    buffer_load_dwordx4 v[96:99], v2, s[44:47], s38 offen
    s_add_u32 s38, s38, 8192
    buffer_load_dwordx4 v[100:103], v2, s[44:47], s38 offen
    s_xor_b32 s38, s49, 2
    s_lshl_b32 s38, s38, 16
    s_add_u32 s38, s38, s48
    buffer_load_dwordx4 v[104:107], v2, s[44:47], s38 offen
    s_add_u32 s38, s38, 8192
    buffer_load_dwordx4 v[108:111], v2, s[44:47], s38 offen
    s_add_u32 s38, s38, 8192
    buffer_load_dwordx4 v[112:115], v2, s[44:47], s38 offen
    s_add_u32 s38, s38, 8192
    buffer_load_dwordx4 v[116:119], v2, s[44:47], s38 offen
    s_add_u32 s38, s38, 8192
    buffer_load_dwordx4 v[120:123], v2, s[44:47], s38 offen
    s_add_u32 s38, s38, 8192
    buffer_load_dwordx4 v[124:127], v2, s[44:47], s38 offen
    s_add_u32 s38, s38, 8192
    buffer_load_dwordx4 v[128:131], v2, s[44:47], s38 offen
    s_add_u32 s38, s38, 8192
    buffer_load_dwordx4 v[132:135], v2, s[44:47], s38 offen
    s_xor_b32 s38, s49, 3
    s_lshl_b32 s38, s38, 16
    s_add_u32 s38, s38, s48
    buffer_load_dwordx4 v[136:139], v2, s[44:47], s38 offen
    s_add_u32 s38, s38, 8192
    buffer_load_dwordx4 v[140:143], v2, s[44:47], s38 offen
    s_add_u32 s38, s38, 8192
    buffer_load_dwordx4 v[144:147], v2, s[44:47], s38 offen
    s_add_u32 s38, s38, 8192
    buffer_load_dwordx4 v[148:151], v2, s[44:47], s38 offen
    s_add_u32 s38, s38, 8192
    buffer_load_dwordx4 v[152:155], v2, s[44:47], s38 offen
    s_add_u32 s38, s38, 8192
    buffer_load_dwordx4 v[156:159], v2, s[44:47], s38 offen
    s_add_u32 s38, s38, 8192
    buffer_load_dwordx4 v[160:163], v2, s[44:47], s38 offen
    s_add_u32 s38, s38, 8192
    buffer_load_dwordx4 v[164:167], v2, s[44:47], s38 offen
    v_mov_b32 v6, 1
    s_mov_b64 exec, 1
    ds_add_u32 v0, v6 offset:2020
    s_mov_b64 exec, -1

    v_lshrrev_b32 v5, 1, v5
    v_lshlrev_b32 v5, 4, v5
    v_lshl_add_u32 v7, v4, 9, v5
    s_lshl_b32 s38, s33, 11
    s_xor_b32 s50, s49, 0
    s_lshl_b32 s50, s50, 7
    s_add_u32 s50, s50, s38
    s_xor_b32 s51, s49, 1
    s_lshl_b32 s51, s51, 7
    s_add_u32 s51, s51, s38
    s_xor_b32 s52, s49, 2
    s_lshl_b32 s52, s52, 7
    s_add_u32 s52, s52, s38
    s_xor_b32 s53, s49, 3
    s_lshl_b32 s53, s53, 7
    s_add_u32 s53, s53, s38

    v_and_b32 v4, 1, v1
    v_cmp_eq_u32 vcc, 1, v4
    v_mov_b32 v2, 0x0c0c0100
    v_mov_b32 v4, 0x01000c0c
    v_cndmask_b32 v2, v2, v4, vcc
    v_mov_b32 v3, 0x0c0c0302
    v_mov_b32 v4, 0x03020c0c
    v_cndmask_b32 v3, v3, v4, vcc

    v_mov_b32 v6, 0
L_fl12:
    global_load_dword v4, v6, s[28:29] offset:0 sc1
    s_sub_u32 s3, s3, 1
    s_cbranch_scc1 L_end
    s_waitcnt vmcnt(0)
    v_cmp_eq_u32 vcc, 0, v4
    s_cbranch_vccnz L_fl12
    buffer_load_dwordx4 v[8:11], v7, s[40:43], s50 offen sc1
    buffer_load_dwordx4 v[12:15], v7, s[40:43], s51 offen sc1
    buffer_load_dwordx4 v[16:19], v7, s[40:43], s52 offen sc1
    buffer_load_dwordx4 v[20:23], v7, s[40:43], s53 offen sc1
    v_swap_b32 v41, v44
    v_swap_b32 v42, v48
    v_swap_b32 v43, v52
    v_swap_b32 v46, v49
    v_swap_b32 v47, v53
    v_swap_b32 v51, v54
    v_swap_b32 v57, v60
    v_swap_b32 v58, v64
    v_swap_b32 v59, v68
    v_swap_b32 v62, v65
    v_swap_b32 v63, v69
    v_swap_b32 v67, v70
    v_swap_b32 v73, v76
    v_swap_b32 v74, v80
    v_swap_b32 v75, v84
    v_swap_b32 v78, v81
    v_swap_b32 v79, v85
    v_swap_b32 v83, v86
    v_swap_b32 v89, v92
    v_swap_b32 v90, v96
    v_swap_b32 v91, v100
    v_swap_b32 v94, v97
    v_swap_b32 v95, v101
    v_swap_b32 v99, v102
    v_swap_b32 v105, v108
    v_swap_b32 v106, v112
    v_swap_b32 v107, v116
    v_swap_b32 v110, v113
    v_swap_b32 v111, v117
    v_swap_b32 v115, v118
    v_swap_b32 v121, v124
    v_swap_b32 v122, v128
    v_swap_b32 v123, v132
    v_swap_b32 v126, v129
    v_swap_b32 v127, v133
    v_swap_b32 v131, v134
    v_swap_b32 v137, v140
    v_swap_b32 v138, v144
    v_swap_b32 v139, v148
    v_swap_b32 v142, v145
    v_swap_b32 v143, v149
    v_swap_b32 v147, v150
    v_swap_b32 v153, v156
    v_swap_b32 v154, v160
    v_swap_b32 v155, v164
    v_swap_b32 v158, v161
    v_swap_b32 v159, v165
    v_swap_b32 v163, v166
    s_branch L_B_h1
L_B_h0:
    buffer_load_dwordx4 v[8:11], v7, s[40:43], s50 offen sc1
    buffer_load_dwordx4 v[12:15], v7, s[40:43], s51 offen sc1
    buffer_load_dwordx4 v[16:19], v7, s[40:43], s52 offen sc1
    buffer_load_dwordx4 v[20:23], v7, s[40:43], s53 offen sc1
    s_sub_u32 s3, s3, 1
    s_cbranch_scc1 L_end
L_B_h1:
    s_waitcnt vmcnt(0)
    v_max3_u32 v24, v8, v9, v10
    v_max3_u32 v24, v24, v11, v12
    v_max3_u32 v24, v24, v13, v14
    v_max3_u32 v24, v24, v15, v16
    v_max3_u32 v24, v24, v17, v18
    v_max3_u32 v24, v24, v19, v20
    v_max3_u32 v24, v24, v21, v22
    v_max_u32 v24, v24, v23
    v_cmp_eq_u32 vcc, -1, v24
    s_cbranch_vccnz L_B_h0
    v_mov_b32 v24, 1
    s_mov_b64 exec, 1
    ds_add_u32 v0, v24 offset:12
    s_mov_b64 exec, -1
    v_perm_b32 v4, v8, v8, v2
    v_perm_b32 v5, v8, v8, v3
    v_perm_b32 v6, v9, v9, v2
    v_perm_b32 v7, v9, v9, v3
    s_nop 1
    v_mfma_f32_16x16x32_bf16 v[24:27], v[40:43], v[4:7], 0
    v_perm_b32 v40, v10, v10, v2
    v_perm_b32 v41, v10, v10, v3
    v_mfma_f32_16x16x32_bf16 v[28:31], v[44:47], v[4:7], 0
    v_perm_b32 v42, v11, v11, v2
    v_perm_b32 v43, v11, v11, v3
    v_mfma_f32_16x16x32_bf16 v[32:35], v[48:51], v[4:7], 0
    v_mfma_f32_16x16x32_bf16 v[36:39], v[52:55], v[4:7], 0
    v_mfma_f32_16x16x32_bf16 v[24:27], v[56:59], v[40:43], v[24:27]
    v_perm_b32 v56, v12, v12, v2
    v_perm_b32 v57, v12, v12, v3
    v_mfma_f32_16x16x32_bf16 v[28:31], v[60:63], v[40:43], v[28:31]
    v_perm_b32 v58, v13, v13, v2
    v_perm_b32 v59, v13, v13, v3
    v_mfma_f32_16x16x32_bf16 v[32:35], v[64:67], v[40:43], v[32:35]
    v_mfma_f32_16x16x32_bf16 v[36:39], v[68:71], v[40:43], v[36:39]
    v_mfma_f32_16x16x32_bf16 v[24:27], v[72:75], v[56:59], v[24:27]
    v_perm_b32 v72, v14, v14, v2
    v_perm_b32 v73, v14, v14, v3
    v_mfma_f32_16x16x32_bf16 v[28:31], v[76:79], v[56:59], v[28:31]
    v_perm_b32 v74, v15, v15, v2
    v_perm_b32 v75, v15, v15, v3
    v_mfma_f32_16x16x32_bf16 v[32:35], v[80:83], v[56:59], v[32:35]
    v_mfma_f32_16x16x32_bf16 v[36:39], v[84:87], v[56:59], v[36:39]
    v_mfma_f32_16x16x32_bf16 v[24:27], v[88:91], v[72:75], v[24:27]
    v_perm_b32 v88, v16, v16, v2
    v_perm_b32 v89, v16, v16, v3
    v_mfma_f32_16x16x32_bf16 v[28:31], v[92:95], v[72:75], v[28:31]
    v_perm_b32 v90, v17, v17, v2
    v_perm_b32 v91, v17, v17, v3
    v_mfma_f32_16x16x32_bf16 v[32:35], v[96:99], v[72:75], v[32:35]
    v_mfma_f32_16x16x32_bf16 v[36:39], v[100:103], v[72:75], v[36:39]
    v_mfma_f32_16x16x32_bf16 v[24:27], v[104:107], v[88:91], v[24:27]
    v_perm_b32 v104, v18, v18, v2
    v_perm_b32 v105, v18, v18, v3
    v_mfma_f32_16x16x32_bf16 v[28:31], v[108:111], v[88:91], v[28:31]
    v_perm_b32 v106, v19, v19, v2
    v_perm_b32 v107, v19, v19, v3
    v_mfma_f32_16x16x32_bf16 v[32:35], v[112:115], v[88:91], v[32:35]
    v_mfma_f32_16x16x32_bf16 v[36:39], v[116:119], v[88:91], v[36:39]
    v_mfma_f32_16x16x32_bf16 v[24:27], v[120:123], v[104:107], v[24:27]
    v_perm_b32 v120, v20, v20, v2
    v_perm_b32 v121, v20, v20, v3
    v_mfma_f32_16x16x32_bf16 v[28:31], v[124:127], v[104:107], v[28:31]
    v_perm_b32 v122, v21, v21, v2
    v_perm_b32 v123, v21, v21, v3
    v_mfma_f32_16x16x32_bf16 v[32:35], v[128:131], v[104:107], v[32:35]
    v_mfma_f32_16x16x32_bf16 v[36:39], v[132:135], v[104:107], v[36:39]
    v_mfma_f32_16x16x32_bf16 v[24:27], v[136:139], v[120:123], v[24:27]
    v_perm_b32 v136, v22, v22, v2
    v_perm_b32 v137, v22, v22, v3
    v_mfma_f32_16x16x32_bf16 v[28:31], v[140:143], v[120:123], v[28:31]
    v_perm_b32 v138, v23, v23, v2
    v_perm_b32 v139, v23, v23, v3
    v_mfma_f32_16x16x32_bf16 v[32:35], v[144:147], v[120:123], v[32:35]
    v_mfma_f32_16x16x32_bf16 v[36:39], v[148:151], v[120:123], v[36:39]
    v_mfma_f32_16x16x32_bf16 v[24:27], v[152:155], v[136:139], v[24:27]
    v_mfma_f32_16x16x32_bf16 v[28:31], v[156:159], v[136:139], v[28:31]
    v_mfma_f32_16x16x32_bf16 v[32:35], v[160:163], v[136:139], v[32:35]
    v_mfma_f32_16x16x32_bf16 v[36:39], v[164:167], v[136:139], v[36:39]
    s_lshl_b32 s38, s33, 12
    s_add_u32 s38, s38, 131072
    v_lshl_add_u32 v4, v1, 4, s38
    s_nop 1
    ds_write_b128 v4, v[24:27] offset:0
    ds_write_b128 v4, v[28:31] offset:1024
    ds_write_b128 v4, v[32:35] offset:2048
    ds_write_b128 v4, v[36:39] offset:3072
    v_mov_b32 v5, 1
    s_mov_b64 exec, 1
    ds_add_u32 v0, v5 offset:4
    s_mov_b64 exec, -1
L_w13:
    ds_read_b32 v5, v0 offset:3036
    s_sub_u32 s3, s3, 1
    s_cbranch_scc1 L_end
    s_waitcnt lgkmcnt(0)
    v_cmp_gt_u32 vcc, 2, v5
    s_cbranch_vccnz L_w13
    s_branch L_B_qa
L_Be:
    s_lshl_b32 s48, s33, 20
    s_lshl_b32 s38, s35, 8
    s_add_u32 s48, s48, s38
    s_waitcnt lgkmcnt(0)
    s_cmp_eq_u32 s34, 4
    s_cbranch_scc1 L_Bs
    s_cmp_lt_u32 s34, 5
    s_cbranch_scc1 L_B_nt
    s_cmp_eq_u32 s2, 40
    s_cbranch_scc1 L_B_nt
    s_mul_i32 s38, s32, 3
    s_add_u32 s38, s38, s34
    s_sub_u32 s38, s38, 17
    s_cmp_ge_u32 s38, 16
    s_cbranch_scc1 L_B_nt
    v_lshrrev_b32 v2, 1, v1
    v_and_b32 v3, 1, v1
    v_lshl_add_u32 v2, v2, 6, v3
    s_lshl_b32 s38, s38, 10
    s_add_u32 s38, s38, s35
    s_lshl_b32 s38, s38, 8
    v_lshl_add_u32 v2, v2, 7, s38
    global_load_dword v166, v2, s[10:11]
L_B_nt:
    s_mov_b32 s40, s30
    s_mov_b32 s41, s31
    s_mov_b32 s42, 16777216
    s_mov_b32 s43, 0x20000

    s_mov_b32 s3, 0x400000
    v_mov_b32 v0, 156256
    s_lshl_b32 s54, s34, 5
    s_add_u32 s54, s54, s35
    s_lshl_b32 s54, s54, 10
    s_and_b32 s96, s36, 3
    s_and_b32 s39, s34, 4
    s_add_u32 s96, s96, s39

    s_barrier
    s_branch L_B_e1
L_Bs:
    s_mov_b32 s44, s24
    s_mov_b32 s45, s25
    s_mov_b32 s46, 3145728
    s_mov_b32 s47, 0x20000
    s_lshl_b32 s55, s36, 2
    s_add_u32 s55, s55, s37
    s_mov_b32 s40, s30
    s_mov_b32 s41, s31
    s_mov_b32 s42, 16777216
    s_mov_b32 s43, 0x20000

    s_mov_b32 s3, 0x400000
    v_mov_b32 v0, 156256
    s_lshl_b32 s54, s34, 5
    s_add_u32 s54, s54, s35
    s_lshl_b32 s54, s54, 10
    s_and_b32 s96, s36, 3
    s_and_b32 s39, s34, 4
    s_add_u32 s96, s96, s39

    v_lshrrev_b32 v2, 2, v1
    v_mul_u32_u24 v4, 6144, v2
    v_lshrrev_b32 v2, 5, v1
    v_bfe_u32 v5, v1, 1, 1
    v_xor_b32 v2, v2, v5
    v_lshl_add_u32 v4, v2, 10, v4
    v_and_b32 v2, 1, v1
    v_lshl_add_u32 v4, v2, 4, v4
    s_mul_i32 s58, s33, 786432
    s_lshl_b32 s39, s55, 5
    s_add_u32 s58, s58, s39
    s_lshl_b32 s59, s33, 13
    s_add_u32 m0, s59, 98304
    s_lshl_b32 s38, s33, 2
    v_add_u32 v5, s38, v0
    s_barrier
    buffer_load_dwordx4 v4, s[44:47], s58 offen lds
    s_add_u32 m0, m0, 1024
    s_add_u32 s58, s58, 98304
    buffer_load_dwordx4 v4, s[44:47], s58 offen lds
    s_add_u32 m0, m0, 1024
    s_add_u32 s58, s58, 98304
    buffer_load_dwordx4 v4, s[44:47], s58 offen lds
    s_add_u32 m0, m0, 1024
    s_add_u32 s58, s58, 98304
    buffer_load_dwordx4 v4, s[44:47], s58 offen lds
    s_add_u32 m0, m0, 1024
    s_add_u32 s58, s58, 98304
    buffer_load_dwordx4 v4, s[44:47], s58 offen lds
    s_add_u32 m0, m0, 1024
    s_add_u32 s58, s58, 98304
    buffer_load_dwordx4 v4, s[44:47], s58 offen lds
    s_add_u32 m0, m0, 1024
    s_add_u32 s58, s58, 98304
    buffer_load_dwordx4 v4, s[44:47], s58 offen lds
    s_add_u32 m0, m0, 1024
    s_add_u32 s58, s58, 98304
    buffer_load_dwordx4 v4, s[44:47], s58 offen lds
    s_add_u32 m0, m0, 1024
    s_add_u32 s58, s58, 98304
    v_mov_b32 v6, 1
    s_waitcnt vmcnt(0)
    ds_write_b32 v5, v6 offset:5040
    v_mov_b32 v6, 1
    s_mov_b64 exec, 1
    ds_add_u32 v0, v6 offset:2020
    s_mov_b64 exec, -1
L_B_e1:
    v_mov_b32 v6, 0
L_fl14:
    s_sleep 4
    global_load_dword v4, v6, s[28:29] offset:128 sc1
    s_sub_u32 s3, s3, 1
    s_cbranch_scc1 L_end
    s_waitcnt vmcnt(0)
    v_cmp_eq_u32 vcc, 0, v4
    s_cbranch_vccnz L_fl14
L_B_qa:
    v_lshlrev_b32 v2, 4, v1
    s_lshl_b32 s50, s96, 15
    s_lshl_b32 s38, s33, 13
    s_add_u32 s50, s50, s38
    s_add_u32 s50, s50, 65536
    s_add_u32 s51, s50, 4096
    s_mul_i32 s38, s33, 8064
    s_add_u32 s38, s38, 131072
    v_add_u32 v3, s38, v2

    s_setprio 2
    buffer_load_dwordx4 v[40:43], v2, s[40:43], s50 offen offset:0 sc1
    buffer_load_dwordx4 v[44:47], v2, s[40:43], s50 offen offset:1024 sc1
    buffer_load_dwordx4 v[48:51], v2, s[40:43], s50 offen offset:2048 sc1
    buffer_load_dwordx4 v[52:55], v2, s[40:43], s50 offen offset:3072 sc1
    buffer_load_dwordx4 v[56:59], v2, s[40:43], s51 offen offset:0 sc1
    buffer_load_dwordx4 v[60:63], v2, s[40:43], s51 offen offset:1024 sc1
    buffer_load_dwordx4 v[64:67], v2, s[40:43], s51 offen offset:2048 sc1
    buffer_load_dwordx4 v[68:71], v2, s[40:43], s51 offen offset:3072 sc1
    s_mov_b32 s56, -1
    s_mov_b32 s57, 0x3fffffff
    s_waitcnt vmcnt(7)
L_B_qc0:
    v_max3_u32 v5, v40, v41, v42
    v_max_u32 v5, v5, v43
    v_cmp_eq_u32 vcc, -1, v5
    s_cbranch_vccnz L_B_qr0
    s_mov_b64 exec, s[56:57]
    ds_write_b128 v3, v[40:43] offset:0
    s_mov_b64 exec, -1
    s_waitcnt vmcnt(6)
L_B_qc1:
    v_max3_u32 v5, v44, v45, v46
    v_max_u32 v5, v5, v47
    v_cmp_eq_u32 vcc, -1, v5
    s_cbranch_vccnz L_B_qr1
    s_mov_b64 exec, s[56:57]
    ds_write_b128 v3, v[44:47] offset:1008
    s_mov_b64 exec, -1
    s_waitcnt vmcnt(5)
L_B_qc2:
    v_max3_u32 v5, v48, v49, v50
    v_max_u32 v5, v5, v51
    v_cmp_eq_u32 vcc, -1, v5
    s_cbranch_vccnz L_B_qr2
    s_mov_b64 exec, s[56:57]
    ds_write_b128 v3, v[48:51] offset:2016
    s_mov_b64 exec, -1
    s_waitcnt vmcnt(4)
L_B_qc3:
    v_max3_u32 v5, v52, v53, v54
    v_max_u32 v5, v5, v55
    v_cmp_eq_u32 vcc, -1, v5
    s_cbranch_vccnz L_B_qr3
    s_mov_b64 exec, s[56:57]
    ds_write_b128 v3, v[52:55] offset:3024
    s_mov_b64 exec, -1
    s_waitcnt vmcnt(3)
L_B_qc4:
    v_max3_u32 v5, v56, v57, v58
    v_max_u32 v5, v5, v59
    v_cmp_eq_u32 vcc, -1, v5
    s_cbranch_vccnz L_B_qr4
    s_mov_b64 exec, s[56:57]
    ds_write_b128 v3, v[56:59] offset:4032
    s_mov_b64 exec, -1
    s_waitcnt vmcnt(2)
L_B_qc5:
    v_max3_u32 v5, v60, v61, v62
    v_max_u32 v5, v5, v63
    v_cmp_eq_u32 vcc, -1, v5
    s_cbranch_vccnz L_B_qr5
    s_mov_b64 exec, s[56:57]
    ds_write_b128 v3, v[60:63] offset:5040
    s_mov_b64 exec, -1
    s_waitcnt vmcnt(1)
L_B_qc6:
    v_max3_u32 v5, v64, v65, v66
    v_max_u32 v5, v5, v67
    v_cmp_eq_u32 vcc, -1, v5
    s_cbranch_vccnz L_B_qr6
    s_mov_b64 exec, s[56:57]
    ds_write_b128 v3, v[64:67] offset:6048
    s_mov_b64 exec, -1
    s_waitcnt vmcnt(0)
L_B_qc7:
    v_max3_u32 v5, v68, v69, v70
    v_max_u32 v5, v5, v71
    v_cmp_eq_u32 vcc, -1, v5
    s_cbranch_vccnz L_B_qr7
    s_mov_b64 exec, s[56:57]
    ds_write_b128 v3, v[68:71] offset:7056
    s_mov_b64 exec, -1
    s_branch L_B_qd
L_B_qr0:
    buffer_load_dwordx4 v[40:43], v2, s[40:43], s50 offen offset:0 sc1
    buffer_load_dwordx4 v[44:47], v2, s[40:43], s50 offen offset:1024 sc1
    buffer_load_dwordx4 v[48:51], v2, s[40:43], s50 offen offset:2048 sc1
    buffer_load_dwordx4 v[52:55], v2, s[40:43], s50 offen offset:3072 sc1
    buffer_load_dwordx4 v[56:59], v2, s[40:43], s51 offen offset:0 sc1
    buffer_load_dwordx4 v[60:63], v2, s[40:43], s51 offen offset:1024 sc1
    buffer_load_dwordx4 v[64:67], v2, s[40:43], s51 offen offset:2048 sc1
    buffer_load_dwordx4 v[68:71], v2, s[40:43], s51 offen offset:3072 sc1
    s_sub_u32 s3, s3, 1
    s_cbranch_scc1 L_end
    s_waitcnt vmcnt(0)
    s_branch L_B_qc0
L_B_qr1:
    buffer_load_dwordx4 v[44:47], v2, s[40:43], s50 offen offset:1024 sc1
    buffer_load_dwordx4 v[48:51], v2, s[40:43], s50 offen offset:2048 sc1
    buffer_load_dwordx4 v[52:55], v2, s[40:43], s50 offen offset:3072 sc1
    buffer_load_dwordx4 v[56:59], v2, s[40:43], s51 offen offset:0 sc1
    buffer_load_dwordx4 v[60:63], v2, s[40:43], s51 offen offset:1024 sc1
    buffer_load_dwordx4 v[64:67], v2, s[40:43], s51 offen offset:2048 sc1
    buffer_load_dwordx4 v[68:71], v2, s[40:43], s51 offen offset:3072 sc1
    s_sub_u32 s3, s3, 1
    s_cbranch_scc1 L_end
    s_waitcnt vmcnt(0)
    s_branch L_B_qc1
L_B_qr2:
    buffer_load_dwordx4 v[48:51], v2, s[40:43], s50 offen offset:2048 sc1
    buffer_load_dwordx4 v[52:55], v2, s[40:43], s50 offen offset:3072 sc1
    buffer_load_dwordx4 v[56:59], v2, s[40:43], s51 offen offset:0 sc1
    buffer_load_dwordx4 v[60:63], v2, s[40:43], s51 offen offset:1024 sc1
    buffer_load_dwordx4 v[64:67], v2, s[40:43], s51 offen offset:2048 sc1
    buffer_load_dwordx4 v[68:71], v2, s[40:43], s51 offen offset:3072 sc1
    s_sub_u32 s3, s3, 1
    s_cbranch_scc1 L_end
    s_waitcnt vmcnt(0)
    s_branch L_B_qc2
L_B_qr3:
    buffer_load_dwordx4 v[52:55], v2, s[40:43], s50 offen offset:3072 sc1
    buffer_load_dwordx4 v[56:59], v2, s[40:43], s51 offen offset:0 sc1
    buffer_load_dwordx4 v[60:63], v2, s[40:43], s51 offen offset:1024 sc1
    buffer_load_dwordx4 v[64:67], v2, s[40:43], s51 offen offset:2048 sc1
    buffer_load_dwordx4 v[68:71], v2, s[40:43], s51 offen offset:3072 sc1
    s_sub_u32 s3, s3, 1
    s_cbranch_scc1 L_end
    s_waitcnt vmcnt(0)
    s_branch L_B_qc3
L_B_qr4:
    buffer_load_dwordx4 v[56:59], v2, s[40:43], s51 offen offset:0 sc1
    buffer_load_dwordx4 v[60:63], v2, s[40:43], s51 offen offset:1024 sc1
    buffer_load_dwordx4 v[64:67], v2, s[40:43], s51 offen offset:2048 sc1
    buffer_load_dwordx4 v[68:71], v2, s[40:43], s51 offen offset:3072 sc1
    s_sub_u32 s3, s3, 1
    s_cbranch_scc1 L_end
    s_waitcnt vmcnt(0)
    s_branch L_B_qc4
L_B_qr5:
    buffer_load_dwordx4 v[60:63], v2, s[40:43], s51 offen offset:1024 sc1
    buffer_load_dwordx4 v[64:67], v2, s[40:43], s51 offen offset:2048 sc1
    buffer_load_dwordx4 v[68:71], v2, s[40:43], s51 offen offset:3072 sc1
    s_sub_u32 s3, s3, 1
    s_cbranch_scc1 L_end
    s_waitcnt vmcnt(0)
    s_branch L_B_qc5
L_B_qr6:
    buffer_load_dwordx4 v[64:67], v2, s[40:43], s51 offen offset:2048 sc1
    buffer_load_dwordx4 v[68:71], v2, s[40:43], s51 offen offset:3072 sc1
    s_sub_u32 s3, s3, 1
    s_cbranch_scc1 L_end
    s_waitcnt vmcnt(0)
    s_branch L_B_qc6
L_B_qr7:
    buffer_load_dwordx4 v[68:71], v2, s[40:43], s51 offen offset:3072 sc1
    s_sub_u32 s3, s3, 1
    s_cbranch_scc1 L_end
    s_waitcnt vmcnt(0)
    s_branch L_B_qc7
L_B_qd:
    s_setprio 0
    v_mov_b32 v5, 1
    s_mov_b64 exec, 1
    ds_add_u32 v0, v5 offset:1008
    s_mov_b64 exec, -1
    s_cmp_lt_u32 s34, 4
    s_cbranch_scc1 L_end

    s_cmp_lt_u32 s33, 2
    s_cbranch_scc1 L_B_uv
    s_cmp_eq_u32 s33, 3
    s_cbranch_scc1 L_end
    s_mov_b32 s44, s22
    s_mov_b32 s45, s23
    s_mov_b32 s46, 8192
    s_mov_b32 s47, 0x20000

    v_lshrrev_b32 v4, 4, v1
    v_and_b32 v5, 15, v1
    v_lshrrev_b32 v2, 1, v5
    v_lshlrev_b32 v2, 10, v2
    v_lshl_add_u32 v2, v4, 6, v2
    s_and_b32 s62, s34, 3
    s_lshl_b32 s38, s62, 8
    buffer_load_dwordx4 v[8:11], v2, s[44:47], s38 offen offset:0
    buffer_load_dwordx4 v[12:15], v2, s[44:47], s38 offen offset:16
    buffer_load_dwordx4 v[16:19], v2, s[44:47], s38 offen offset:32
    buffer_load_dwordx4 v[20:23], v2, s[44:47], s38 offen offset:48
    s_mov_b32 s44, s24
    s_mov_b32 s45, s25
    s_mov_b32 s46, 3145728
    s_mov_b32 s47, 0x20000

    v_mul_u32_u24 v2, 196608, v4
    v_lshl_add_u32 v2, v5, 3, v2
    v_lshlrev_b32 v4, 11, v4
    v_lshl_add_u32 v4, v5, 3, v4
    v_and_b32 v3, 1, v1
    v_lshlrev_b32 v3, 4, v3
    s_mov_b32 s38, 0xffff
    v_lshlrev_b32 v3, v3, s38
    s_mul_i32 s48, s62, 786432
    s_lshl_b32 s38, s35, 7
    s_add_u32 s48, s48, s38
    s_add_u32 s48, s48, 2048
    s_lshl2_add_u32 s49, s37, s62
    s_lshl_b32 s49, s49, 13
    s_lshl_b32 s38, s36, 7
    s_add_u32 s49, s49, s38
    s_add_u32 s49, s49, 1376256
    s_mov_b32 s38, 0xbfb8aa3b
    s_waitcnt vmcnt(0)
    v_lshlrev_b32 v24, 16, v8
    v_and_b32 v25, 0xffff0000, v8
    v_mul_f32 v26, s38, v24
    v_mul_f32 v27, s38, v25
    v_exp_f32 v26, v26
    v_exp_f32 v27, v27
    v_add_f32 v26, 1.0, v26
    v_add_f32 v27, 1.0, v27
    v_rcp_f32 v26, v26
    v_rcp_f32 v27, v27
    v_mul_f32 v24, v24, v26
    v_mul_f32 v25, v25, v27
    v_cvt_pk_bf16_f32 v24, v24, v24
    v_cvt_pk_bf16_f32 v25, v25, v25
    v_and_b32 v40, v24, v3
    v_and_b32 v41, v25, v3
    v_lshlrev_b32 v24, 16, v9
    v_and_b32 v25, 0xffff0000, v9
    v_mul_f32 v26, s38, v24
    v_mul_f32 v27, s38, v25
    v_exp_f32 v26, v26
    v_exp_f32 v27, v27
    v_add_f32 v26, 1.0, v26
    v_add_f32 v27, 1.0, v27
    v_rcp_f32 v26, v26
    v_rcp_f32 v27, v27
    v_mul_f32 v24, v24, v26
    v_mul_f32 v25, v25, v27
    v_cvt_pk_bf16_f32 v24, v24, v24
    v_cvt_pk_bf16_f32 v25, v25, v25
    v_and_b32 v42, v24, v3
    v_and_b32 v43, v25, v3
    v_lshlrev_b32 v24, 16, v10
    v_and_b32 v25, 0xffff0000, v10
    v_mul_f32 v26, s38, v24
    v_mul_f32 v27, s38, v25
    v_exp_f32 v26, v26
    v_exp_f32 v27, v27
    v_add_f32 v26, 1.0, v26
    v_add_f32 v27, 1.0, v27
    v_rcp_f32 v26, v26
    v_rcp_f32 v27, v27
    v_mul_f32 v24, v24, v26
    v_mul_f32 v25, v25, v27
    v_cvt_pk_bf16_f32 v24, v24, v24
    v_cvt_pk_bf16_f32 v25, v25, v25
    v_and_b32 v44, v24, v3
    v_and_b32 v45, v25, v3
    v_lshlrev_b32 v24, 16, v11
    v_and_b32 v25, 0xffff0000, v11
    v_mul_f32 v26, s38, v24
    v_mul_f32 v27, s38, v25
    v_exp_f32 v26, v26
    v_exp_f32 v27, v27
    v_add_f32 v26, 1.0, v26
    v_add_f32 v27, 1.0, v27
    v_rcp_f32 v26, v26
    v_rcp_f32 v27, v27
    v_mul_f32 v24, v24, v26
    v_mul_f32 v25, v25, v27
    v_cvt_pk_bf16_f32 v24, v24, v24
    v_cvt_pk_bf16_f32 v25, v25, v25
    v_and_b32 v46, v24, v3
    v_and_b32 v47, v25, v3
    v_lshlrev_b32 v24, 16, v12
    v_and_b32 v25, 0xffff0000, v12
    v_mul_f32 v26, s38, v24
    v_mul_f32 v27, s38, v25
    v_exp_f32 v26, v26
    v_exp_f32 v27, v27
    v_add_f32 v26, 1.0, v26
    v_add_f32 v27, 1.0, v27
    v_rcp_f32 v26, v26
    v_rcp_f32 v27, v27
    v_mul_f32 v24, v24, v26
    v_mul_f32 v25, v25, v27
    v_cvt_pk_bf16_f32 v24, v24, v24
    v_cvt_pk_bf16_f32 v25, v25, v25
    v_and_b32 v48, v24, v3
    v_and_b32 v49, v25, v3
    v_lshlrev_b32 v24, 16, v13
    v_and_b32 v25, 0xffff0000, v13
    v_mul_f32 v26, s38, v24
    v_mul_f32 v27, s38, v25
    v_exp_f32 v26, v26
    v_exp_f32 v27, v27
    v_add_f32 v26, 1.0, v26
    v_add_f32 v27, 1.0, v27
    v_rcp_f32 v26, v26
    v_rcp_f32 v27, v27
    v_mul_f32 v24, v24, v26
    v_mul_f32 v25, v25, v27
    v_cvt_pk_bf16_f32 v24, v24, v24
    v_cvt_pk_bf16_f32 v25, v25, v25
    v_and_b32 v50, v24, v3
    v_and_b32 v51, v25, v3
    v_lshlrev_b32 v24, 16, v14
    v_and_b32 v25, 0xffff0000, v14
    v_mul_f32 v26, s38, v24
    v_mul_f32 v27, s38, v25
    v_exp_f32 v26, v26
    v_exp_f32 v27, v27
    v_add_f32 v26, 1.0, v26
    v_add_f32 v27, 1.0, v27
    v_rcp_f32 v26, v26
    v_rcp_f32 v27, v27
    v_mul_f32 v24, v24, v26
    v_mul_f32 v25, v25, v27
    v_cvt_pk_bf16_f32 v24, v24, v24
    v_cvt_pk_bf16_f32 v25, v25, v25
    v_and_b32 v52, v24, v3
    v_and_b32 v53, v25, v3
    v_lshlrev_b32 v24, 16, v15
    v_and_b32 v25, 0xffff0000, v15
    v_mul_f32 v26, s38, v24
    v_mul_f32 v27, s38, v25
    v_exp_f32 v26, v26
    v_exp_f32 v27, v27
    v_add_f32 v26, 1.0, v26
    v_add_f32 v27, 1.0, v27
    v_rcp_f32 v26, v26
    v_rcp_f32 v27, v27
    v_mul_f32 v24, v24, v26
    v_mul_f32 v25, v25, v27
    v_cvt_pk_bf16_f32 v24, v24, v24
    v_cvt_pk_bf16_f32 v25, v25, v25
    v_and_b32 v54, v24, v3
    v_and_b32 v55, v25, v3
    v_lshlrev_b32 v24, 16, v16
    v_and_b32 v25, 0xffff0000, v16
    v_mul_f32 v26, s38, v24
    v_mul_f32 v27, s38, v25
    v_exp_f32 v26, v26
    v_exp_f32 v27, v27
    v_add_f32 v26, 1.0, v26
    v_add_f32 v27, 1.0, v27
    v_rcp_f32 v26, v26
    v_rcp_f32 v27, v27
    v_mul_f32 v24, v24, v26
    v_mul_f32 v25, v25, v27
    v_cvt_pk_bf16_f32 v24, v24, v24
    v_cvt_pk_bf16_f32 v25, v25, v25
    v_and_b32 v56, v24, v3
    v_and_b32 v57, v25, v3
    v_lshlrev_b32 v24, 16, v17
    v_and_b32 v25, 0xffff0000, v17
    v_mul_f32 v26, s38, v24
    v_mul_f32 v27, s38, v25
    v_exp_f32 v26, v26
    v_exp_f32 v27, v27
    v_add_f32 v26, 1.0, v26
    v_add_f32 v27, 1.0, v27
    v_rcp_f32 v26, v26
    v_rcp_f32 v27, v27
    v_mul_f32 v24, v24, v26
    v_mul_f32 v25, v25, v27
    v_cvt_pk_bf16_f32 v24, v24, v24
    v_cvt_pk_bf16_f32 v25, v25, v25
    v_and_b32 v58, v24, v3
    v_and_b32 v59, v25, v3
    v_lshlrev_b32 v24, 16, v18
    v_and_b32 v25, 0xffff0000, v18
    v_mul_f32 v26, s38, v24
    v_mul_f32 v27, s38, v25
    v_exp_f32 v26, v26
    v_exp_f32 v27, v27
    v_add_f32 v26, 1.0, v26
    v_add_f32 v27, 1.0, v27
    v_rcp_f32 v26, v26
    v_rcp_f32 v27, v27
    v_mul_f32 v24, v24, v26
    v_mul_f32 v25, v25, v27
    v_cvt_pk_bf16_f32 v24, v24, v24
    v_cvt_pk_bf16_f32 v25, v25, v25
    v_and_b32 v60, v24, v3
    v_and_b32 v61, v25, v3
    v_lshlrev_b32 v24, 16, v19
    v_and_b32 v25, 0xffff0000, v19
    v_mul_f32 v26, s38, v24
    v_mul_f32 v27, s38, v25
    v_exp_f32 v26, v26
    v_exp_f32 v27, v27
    v_add_f32 v26, 1.0, v26
    v_add_f32 v27, 1.0, v27
    v_rcp_f32 v26, v26
    v_rcp_f32 v27, v27
    v_mul_f32 v24, v24, v26
    v_mul_f32 v25, v25, v27
    v_cvt_pk_bf16_f32 v24, v24, v24
    v_cvt_pk_bf16_f32 v25, v25, v25
    v_and_b32 v62, v24, v3
    v_and_b32 v63, v25, v3
    v_lshlrev_b32 v24, 16, v20
    v_and_b32 v25, 0xffff0000, v20
    v_mul_f32 v26, s38, v24
    v_mul_f32 v27, s38, v25
    v_exp_f32 v26, v26
    v_exp_f32 v27, v27
    v_add_f32 v26, 1.0, v26
    v_add_f32 v27, 1.0, v27
    v_rcp_f32 v26, v26
    v_rcp_f32 v27, v27
    v_mul_f32 v24, v24, v26
    v_mul_f32 v25, v25, v27
    v_cvt_pk_bf16_f32 v24, v24, v24
    v_cvt_pk_bf16_f32 v25, v25, v25
    v_and_b32 v64, v24, v3
    v_and_b32 v65, v25, v3
    v_lshlrev_b32 v24, 16, v21
    v_and_b32 v25, 0xffff0000, v21
    v_mul_f32 v26, s38, v24
    v_mul_f32 v27, s38, v25
    v_exp_f32 v26, v26
    v_exp_f32 v27, v27
    v_add_f32 v26, 1.0, v26
    v_add_f32 v27, 1.0, v27
    v_rcp_f32 v26, v26
    v_rcp_f32 v27, v27
    v_mul_f32 v24, v24, v26
    v_mul_f32 v25, v25, v27
    v_cvt_pk_bf16_f32 v24, v24, v24
    v_cvt_pk_bf16_f32 v25, v25, v25
    v_and_b32 v66, v24, v3
    v_and_b32 v67, v25, v3
    v_lshlrev_b32 v24, 16, v22
    v_and_b32 v25, 0xffff0000, v22
    v_mul_f32 v26, s38, v24
    v_mul_f32 v27, s38, v25
    v_exp_f32 v26, v26
    v_exp_f32 v27, v27
    v_add_f32 v26, 1.0, v26
    v_add_f32 v27, 1.0, v27
    v_rcp_f32 v26, v26
    v_rcp_f32 v27, v27
    v_mul_f32 v24, v24, v26
    v_mul_f32 v25, v25, v27
    v_cvt_pk_bf16_f32 v24, v24, v24
    v_cvt_pk_bf16_f32 v25, v25, v25
    v_and_b32 v68, v24, v3
    v_and_b32 v69, v25, v3
    v_lshlrev_b32 v24, 16, v23
    v_and_b32 v25, 0xffff0000, v23
    v_mul_f32 v26, s38, v24
    v_mul_f32 v27, s38, v25
    v_exp_f32 v26, v26
    v_exp_f32 v27, v27
    v_add_f32 v26, 1.0, v26
    v_add_f32 v27, 1.0, v27
    v_rcp_f32 v26, v26
    v_rcp_f32 v27, v27
    v_mul_f32 v24, v24, v26
    v_mul_f32 v25, v25, v27
    v_cvt_pk_bf16_f32 v24, v24, v24
    v_cvt_pk_bf16_f32 v25, v25, v25
    v_and_b32 v70, v24, v3
    v_and_b32 v71, v25, v3
L_w15:
    s_sleep 1
    ds_read_b32 v6, v0 offset:1008
    s_sub_u32 s3, s3, 1
    s_cbranch_scc1 L_end
    s_waitcnt lgkmcnt(0)
    v_cmp_gt_u32 vcc, 4, v6
    s_cbranch_vccnz L_w15
L_w16:
    s_sleep 1
    ds_read_b32 v6, v0 offset:7060
    s_sub_u32 s3, s3, 1
    s_cbranch_scc1 L_end
    s_waitcnt lgkmcnt(0)
    v_cmp_gt_u32 vcc, 4, v6
    s_cbranch_vccnz L_w16
    s_add_u32 s39, s48, 0
    buffer_load_dwordx2 v[104:105], v2, s[44:47], s39 offen nt
    s_add_u32 s39, s48, 6144
    buffer_load_dwordx2 v[108:109], v2, s[44:47], s39 offen nt
    s_add_u32 s39, s48, 12288
    buffer_load_dwordx2 v[106:107], v2, s[44:47], s39 offen nt
    s_add_u32 s39, s48, 18432
    buffer_load_dwordx2 v[110:111], v2, s[44:47], s39 offen nt
    s_add_u32 s39, s48, 24576
    buffer_load_dwordx2 v[112:113], v2, s[44:47], s39 offen nt
    s_add_u32 s39, s48, 30720
    buffer_load_dwordx2 v[116:117], v2, s[44:47], s39 offen nt
    s_add_u32 s39, s48, 36864
    buffer_load_dwordx2 v[114:115], v2, s[44:47], s39 offen nt
    s_add_u32 s39, s48, 43008
    buffer_load_dwordx2 v[118:119], v2, s[44:47], s39 offen nt
    s_add_u32 s39, s48, 49152
    buffer_load_dwordx2 v[120:121], v2, s[44:47], s39 offen nt
    s_add_u32 s39, s48, 55296
    buffer_load_dwordx2 v[124:125], v2, s[44:47], s39 offen nt
    s_add_u32 s39, s48, 61440
    buffer_load_dwordx2 v[122:123], v2, s[44:47], s39 offen nt
    s_add_u32 s39, s48, 67584
    buffer_load_dwordx2 v[126:127], v2, s[44:47], s39 offen nt
    s_add_u32 s39, s48, 73728
    buffer_load_dwordx2 v[128:129], v2, s[44:47], s39 offen nt
    s_add_u32 s39, s48, 79872
    buffer_load_dwordx2 v[132:133], v2, s[44:47], s39 offen nt
    s_add_u32 s39, s48, 86016
    buffer_load_dwordx2 v[130:131], v2, s[44:47], s39 offen nt
    s_add_u32 s39, s48, 92160
    buffer_load_dwordx2 v[134:135], v2, s[44:47], s39 offen nt
    s_add_u32 s39, s48, 98304
    buffer_load_dwordx2 v[136:137], v2, s[44:47], s39 offen nt
    s_add_u32 s39, s48, 104448
    buffer_load_dwordx2 v[140:141], v2, s[44:47], s39 offen nt
    s_add_u32 s39, s48, 110592
    buffer_load_dwordx2 v[138:139], v2, s[44:47], s39 offen nt
    s_add_u32 s39, s48, 116736
    buffer_load_dwordx2 v[142:143], v2, s[44:47], s39 offen nt
    s_add_u32 s39, s48, 122880
    buffer_load_dwordx2 v[144:145], v2, s[44:47], s39 offen nt
    s_add_u32 s39, s48, 129024
    buffer_load_dwordx2 v[148:149], v2, s[44:47], s39 offen nt
    s_add_u32 s39, s48, 135168
    buffer_load_dwordx2 v[146:147], v2, s[44:47], s39 offen nt
    s_add_u32 s39, s48, 141312
    buffer_load_dwordx2 v[150:151], v2, s[44:47], s39 offen nt
    s_add_u32 s39, s48, 147456
    buffer_load_dwordx2 v[152:153], v2, s[44:47], s39 offen nt
    s_add_u32 s39, s48, 153600
    buffer_load_dwordx2 v[156:157], v2, s[44:47], s39 offen nt
    s_add_u32 s39, s48, 159744
    buffer_load_dwordx2 v[154:155], v2, s[44:47], s39 offen nt
    s_add_u32 s39, s48, 165888
    buffer_load_dwordx2 v[158:159], v2, s[44:47], s39 offen nt
    s_add_u32 s39, s48, 172032
    buffer_load_dwordx2 v[160:161], v2, s[44:47], s39 offen nt
    s_add_u32 s39, s48, 178176
    buffer_load_dwordx2 v[164:165], v2, s[44:47], s39 offen nt
    s_add_u32 s39, s48, 184320
    buffer_load_dwordx2 v[162:163], v2, s[44:47], s39 offen nt
    s_add_u32 s39, s48, 190464
    buffer_load_dwordx2 v[166:167], v2, s[44:47], s39 offen nt
    s_waitcnt vmcnt(31)
    v_mov_b32 v6, 1
    s_mov_b64 exec, 1
    ds_add_u32 v0, v6 offset:6060
    s_mov_b64 exec, -1
    s_waitcnt vmcnt(0)
    v_swap_b32 v105, v108
    v_swap_b32 v107, v110
    v_swap_b32 v113, v116
    v_swap_b32 v115, v118
    v_swap_b32 v121, v124
    v_swap_b32 v123, v126
    v_swap_b32 v129, v132
    v_swap_b32 v131, v134
    v_swap_b32 v137, v140
    v_swap_b32 v139, v142
    v_swap_b32 v145, v148
    v_swap_b32 v147, v150
    v_swap_b32 v153, v156
    v_swap_b32 v155, v158
    v_swap_b32 v161, v164
    v_swap_b32 v163, v166
    v_mfma_f32_16x16x32_bf16 v[24:27], v[40:43], v[104:107], 0
    v_mfma_f32_16x16x32_bf16 v[28:31], v[40:43], v[108:111], 0
    v_mfma_f32_16x16x32_bf16 v[24:27], v[44:47], v[112:115], v[24:27]
    v_mfma_f32_16x16x32_bf16 v[28:31], v[44:47], v[116:119], v[28:31]
    v_mfma_f32_16x16x32_bf16 v[24:27], v[48:51], v[120:123], v[24:27]
    v_mfma_f32_16x16x32_bf16 v[28:31], v[48:51], v[124:127], v[28:31]
    v_mfma_f32_16x16x32_bf16 v[24:27], v[52:55], v[128:131], v[24:27]
    v_mfma_f32_16x16x32_bf16 v[28:31], v[52:55], v[132:135], v[28:31]
    v_mfma_f32_16x16x32_bf16 v[24:27], v[56:59], v[136:139], v[24:27]
    v_mfma_f32_16x16x32_bf16 v[28:31], v[56:59], v[140:143], v[28:31]
    v_mfma_f32_16x16x32_bf16 v[24:27], v[60:63], v[144:147], v[24:27]
    v_mfma_f32_16x16x32_bf16 v[28:31], v[60:63], v[148:151], v[28:31]
    v_mfma_f32_16x16x32_bf16 v[24:27], v[64:67], v[152:155], v[24:27]
    v_mfma_f32_16x16x32_bf16 v[28:31], v[64:67], v[156:159], v[28:31]
    v_mfma_f32_16x16x32_bf16 v[24:27], v[68:71], v[160:163], v[24:27]
    v_mfma_f32_16x16x32_bf16 v[28:31], v[68:71], v[164:167], v[28:31]
    s_nop 6
    v_cvt_pk_bf16_f32 v8, v24, v25
    v_cvt_pk_bf16_f32 v10, v26, v27
    v_cvt_pk_bf16_f32 v9, v28, v29
    v_cvt_pk_bf16_f32 v11, v30, v31
    buffer_store_dwordx2 v[8:9], v4, s[40:43], s49 offen sc1
    buffer_store_dwordx2 v[10:11], v4, s[40:43], s49 offen offset:1024 sc1
    s_branch L_end
L_B_uv:
    s_mov_b32 s44, s12
    s_mov_b32 s45, s13
    s_mov_b32 s46, 4194304
    s_mov_b32 s47, 0x20000

    v_lshrrev_b32 v4, 4, v1
    v_and_b32 v5, 15, v1
    v_lshlrev_b32 v2, 13, v4
    v_lshl_add_u32 v2, v5, 3, v2
    s_and_b32 s62, s34, 3
    s_lshl_b32 s48, s62, 20
    s_lshl1_add_u32 s38, s35, s33
    s_lshl_b32 s38, s38, 7
    s_add_u32 s48, s48, s38
    v_mul_u32_u24 v3, 528, v5
    v_lshl_add_u32 v3, v4, 5, v3
    v_add_u32 v3, 141312, v3
    v_lshlrev_b32 v4, 4, v1
    s_lshl2_add_u32 s49, s35, s62
    s_lshl1_add_u32 s49, s49, s33
    s_lshl_b32 s49, s49, 10
    s_add_u32 s49, s49, 1114112
L_w17:
    s_sleep 1
    ds_read_b32 v6, v0 offset:7060
    s_sub_u32 s3, s3, 1
    s_cbranch_scc1 L_end
    s_waitcnt lgkmcnt(0)
    v_cmp_gt_u32 vcc, 4, v6
    s_cbranch_vccnz L_w17
    s_add_u32 s39, s48, 0
    buffer_load_dwordx2 v[104:105], v2, s[44:47], s39 offen nt
    s_add_u32 s39, s48, 262144
    buffer_load_dwordx2 v[108:109], v2, s[44:47], s39 offen nt
    s_add_u32 s39, s48, 131072
    buffer_load_dwordx2 v[106:107], v2, s[44:47], s39 offen nt
    s_add_u32 s39, s48, 393216
    buffer_load_dwordx2 v[110:111], v2, s[44:47], s39 offen nt
    s_add_u32 s39, s48, 524288
    buffer_load_dwordx2 v[112:113], v2, s[44:47], s39 offen nt
    s_add_u32 s39, s48, 786432
    buffer_load_dwordx2 v[116:117], v2, s[44:47], s39 offen nt
    s_add_u32 s39, s48, 655360
    buffer_load_dwordx2 v[114:115], v2, s[44:47], s39 offen nt
    s_add_u32 s39, s48, 917504
    buffer_load_dwordx2 v[118:119], v2, s[44:47], s39 offen nt
    s_add_u32 s39, s48, 32768
    buffer_load_dwordx2 v[120:121], v2, s[44:47], s39 offen nt
    s_add_u32 s39, s48, 294912
    buffer_load_dwordx2 v[124:125], v2, s[44:47], s39 offen nt
    s_add_u32 s39, s48, 163840
    buffer_load_dwordx2 v[122:123], v2, s[44:47], s39 offen nt
    s_add_u32 s39, s48, 425984
    buffer_load_dwordx2 v[126:127], v2, s[44:47], s39 offen nt
    s_add_u32 s39, s48, 557056
    buffer_load_dwordx2 v[128:129], v2, s[44:47], s39 offen nt
    s_add_u32 s39, s48, 819200
    buffer_load_dwordx2 v[132:133], v2, s[44:47], s39 offen nt
    s_add_u32 s39, s48, 688128
    buffer_load_dwordx2 v[130:131], v2, s[44:47], s39 offen nt
    s_add_u32 s39, s48, 950272
    buffer_load_dwordx2 v[134:135], v2, s[44:47], s39 offen nt
    s_add_u32 s39, s48, 65536
    buffer_load_dwordx2 v[136:137], v2, s[44:47], s39 offen nt
    s_add_u32 s39, s48, 327680
    buffer_load_dwordx2 v[140:141], v2, s[44:47], s39 offen nt
    s_add_u32 s39, s48, 196608
    buffer_load_dwordx2 v[138:139], v2, s[44:47], s39 offen nt
    s_add_u32 s39, s48, 458752
    buffer_load_dwordx2 v[142:143], v2, s[44:47], s39 offen nt
    s_add_u32 s39, s48, 589824
    buffer_load_dwordx2 v[144:145], v2, s[44:47], s39 offen nt
    s_add_u32 s39, s48, 851968
    buffer_load_dwordx2 v[148:149], v2, s[44:47], s39 offen nt
    s_add_u32 s39, s48, 720896
    buffer_load_dwordx2 v[146:147], v2, s[44:47], s39 offen nt
    s_add_u32 s39, s48, 983040
    buffer_load_dwordx2 v[150:151], v2, s[44:47], s39 offen nt
    s_add_u32 s39, s48, 98304
    buffer_load_dwordx2 v[152:153], v2, s[44:47], s39 offen nt
    s_add_u32 s39, s48, 360448
    buffer_load_dwordx2 v[156:157], v2, s[44:47], s39 offen nt
    s_add_u32 s39, s48, 229376
    buffer_load_dwordx2 v[154:155], v2, s[44:47], s39 offen nt
    s_add_u32 s39, s48, 491520
    buffer_load_dwordx2 v[158:159], v2, s[44:47], s39 offen nt
    s_add_u32 s39, s48, 622592
    buffer_load_dwordx2 v[160:161], v2, s[44:47], s39 offen nt
    s_add_u32 s39, s48, 884736
    buffer_load_dwordx2 v[164:165], v2, s[44:47], s39 offen nt
    s_add_u32 s39, s48, 753664
    buffer_load_dwordx2 v[162:163], v2, s[44:47], s39 offen nt
    s_add_u32 s39, s48, 1015808
    buffer_load_dwordx2 v[166:167], v2, s[44:47], s39 offen nt
    s_waitcnt vmcnt(31)
    v_mov_b32 v6, 1
    s_mov_b64 exec, 1
    ds_add_u32 v0, v6 offset:6060
    s_mov_b64 exec, -1
    s_waitcnt vmcnt(0)
    v_swap_b32 v105, v108
    v_swap_b32 v107, v110
    v_swap_b32 v113, v116
    v_swap_b32 v115, v118
    v_swap_b32 v121, v124
    v_swap_b32 v123, v126
    v_swap_b32 v129, v132
    v_swap_b32 v131, v134
    v_swap_b32 v137, v140
    v_swap_b32 v139, v142
    v_swap_b32 v145, v148
    v_swap_b32 v147, v150
    v_swap_b32 v153, v156
    v_swap_b32 v155, v158
    v_swap_b32 v161, v164
    v_swap_b32 v163, v166
L_w18:
    s_sleep 1
    ds_read_b32 v6, v0 offset:6048
    s_sub_u32 s3, s3, 1
    s_cbranch_scc1 L_end
    s_waitcnt lgkmcnt(0)
    v_cmp_gt_u32 vcc, 5, v6
    s_cbranch_vccnz L_w18
    s_setprio 2
L_w19:
    ds_read_b32 v6, v0 offset:6048
    s_sub_u32 s3, s3, 1
    s_cbranch_scc1 L_end
    s_waitcnt lgkmcnt(0)
    v_cmp_gt_u32 vcc, 8, v6
    s_cbranch_vccnz L_w19
    ds_read_b128 v[40:43], v3 offset:0
    ds_read_b128 v[44:47], v3 offset:16
    ds_read_b128 v[48:51], v3 offset:128
    ds_read_b128 v[52:55], v3 offset:144
    ds_read_b128 v[56:59], v3 offset:256
    ds_read_b128 v[60:63], v3 offset:272
    ds_read_b128 v[64:67], v3 offset:384
    ds_read_b128 v[68:71], v3 offset:400
    s_waitcnt lgkmcnt(7)
    v_mfma_f32_16x16x32_bf16 v[24:27], v[40:43], v[104:107], 0
    v_mfma_f32_16x16x32_bf16 v[28:31], v[40:43], v[108:111], 0
    s_waitcnt lgkmcnt(6)
    v_mfma_f32_16x16x32_bf16 v[24:27], v[44:47], v[112:115], v[24:27]
    v_mfma_f32_16x16x32_bf16 v[28:31], v[44:47], v[116:119], v[28:31]
    s_waitcnt lgkmcnt(5)
    v_mfma_f32_16x16x32_bf16 v[24:27], v[48:51], v[120:123], v[24:27]
    v_mfma_f32_16x16x32_bf16 v[28:31], v[48:51], v[124:127], v[28:31]
    s_waitcnt lgkmcnt(4)
    v_mfma_f32_16x16x32_bf16 v[24:27], v[52:55], v[128:131], v[24:27]
    v_mfma_f32_16x16x32_bf16 v[28:31], v[52:55], v[132:135], v[28:31]
    s_waitcnt lgkmcnt(3)
    v_mfma_f32_16x16x32_bf16 v[24:27], v[56:59], v[136:139], v[24:27]
    v_mfma_f32_16x16x32_bf16 v[28:31], v[56:59], v[140:143], v[28:31]
    s_waitcnt lgkmcnt(2)
    v_mfma_f32_16x16x32_bf16 v[24:27], v[60:63], v[144:147], v[24:27]
    v_mfma_f32_16x16x32_bf16 v[28:31], v[60:63], v[148:151], v[28:31]
    s_waitcnt lgkmcnt(1)
    v_mfma_f32_16x16x32_bf16 v[24:27], v[64:67], v[152:155], v[24:27]
    v_mfma_f32_16x16x32_bf16 v[28:31], v[64:67], v[156:159], v[28:31]
    s_waitcnt lgkmcnt(0)
    v_mfma_f32_16x16x32_bf16 v[24:27], v[68:71], v[160:163], v[24:27]
    v_mfma_f32_16x16x32_bf16 v[28:31], v[68:71], v[164:167], v[28:31]
    s_nop 6
    v_cvt_pk_bf16_f32 v8, v24, v25
    v_cvt_pk_bf16_f32 v10, v26, v27
    v_cvt_pk_bf16_f32 v9, v28, v29
    v_cvt_pk_bf16_f32 v11, v30, v31
    buffer_store_dwordx4 v[8:11], v4, s[40:43], s49 offen sc1
    s_waitcnt vmcnt(0)
    v_mov_b32 v6, 1
    s_mov_b64 exec, 1
    ds_add_u32 v0, v6 offset:6052
    s_mov_b64 exec, -1
    s_branch L_end
L_Cs:
    s_setprio 2
    s_waitcnt lgkmcnt(0)
    s_mov_b32 s44, s22
    s_mov_b32 s45, s23
    s_mov_b32 s46, 8192
    s_mov_b32 s47, 0x20000
    v_and_b32 v2, 7, v1
    v_lshlrev_b32 v2, 10, v2
    v_bfe_u32 v3, v1, 3, 1
    v_lshl_add_u32 v2, v3, 7, v2
    v_lshrrev_b32 v3, 4, v1
    v_lshl_add_u32 v2, v3, 4, v2
    s_lshl_b32 s38, s33, 8
    buffer_load_dwordx4 v[8:11], v2, s[44:47], s38 offen
    buffer_load_dwordx4 v[12:15], v2, s[44:47], s38 offen offset:64
    s_mov_b32 s44, s4
    s_mov_b32 s45, s5
    s_mov_b32 s46, 8192
    s_mov_b32 s47, 0x20000
    s_lshl_b32 s55, s36, 2
    s_add_u32 s55, s55, s37
    v_mov_b32 v24, 0x3f803f80
    v_mov_b32 v25, v24
    v_mov_b32 v26, v24
    v_mov_b32 v27, v24
    v_mov_b32 v28, v24
    v_mov_b32 v29, v24
    v_mov_b32 v30, v24
    v_mov_b32 v31, v24
    v_mov_b32 v32, v24
    v_mov_b32 v33, v24
    v_mov_b32 v34, v24
    v_mov_b32 v35, v24
    v_mov_b32 v36, v24
    v_mov_b32 v37, v24
    v_mov_b32 v38, v24
    v_mov_b32 v39, v24

    v_and_b32 v2, 15, v1
    v_lshlrev_b32 v2, 10, v2
    v_lshrrev_b32 v3, 4, v1
    v_lshl_add_u32 v4, v3, 4, v2
    v_lshl_add_u32 v5, v3, 3, v2
    s_lshl_b32 s39, s55, 5
    s_mov_b32 s56, 0x00ff00ff
    s_mov_b32 s57, 0x00ff00ff
    s_mov_b64 exec, s[56:57]
    buffer_load_dwordx4 v[24:27], v4, s[44:47], s38 offen offset:0
    buffer_load_dwordx4 v[28:31], v4, s[44:47], s38 offen offset:64
    buffer_load_dwordx4 v[32:35], v4, s[44:47], s38 offen offset:128
    buffer_load_dwordx4 v[36:39], v4, s[44:47], s38 offen offset:192
    buffer_load_dwordx2 v[6:7], v5, s[44:47], s39 offen
    s_mov_b64 exec, -1
    s_barrier
    s_mov_b32 s40, s30
    s_mov_b32 s41, s31
    s_mov_b32 s42, 16777216
    s_mov_b32 s43, 0x20000

    s_mov_b32 s3, 0x400000
    v_mov_b32 v0, 156256
    s_lshl_b32 s54, s34, 5
    s_add_u32 s54, s54, s35
    s_lshl_b32 s54, s54, 10
    s_and_b32 s96, s36, 3
    s_and_b32 s39, s34, 4
    s_add_u32 s96, s96, s39

    s_lshl_b32 s59, s33, 13
    s_add_u32 s59, s59, 98304
    v_bfe_u32 v2, v1, 2, 2
    v_lshl_add_u32 v2, v3, 3, v2
    v_lshlrev_b32 v2, 6, v2
    v_and_b32 v4, 1, v3
    v_lshl_add_u32 v2, v4, 5, v2
    v_and_b32 v4, 3, v1
    v_lshl_add_u32 v2, v4, 3, v2
    v_add_u32 v2, s59, v2
    v_xor_b32 v3, 32, v2
    s_mul_i32 s38, s33, 3072
    s_add_u32 s38, s38, 131072
    v_lshl_add_u32 v4, v1, 4, s38
    s_lshl_b32 s38, s33, 2
    v_add_u32 v5, s38, v0
    s_waitcnt vmcnt(0)
    v_mfma_f32_16x16x32_bf16 v[88:91], v[24:27], v[24:27], 0
    v_mfma_f32_16x16x32_bf16 v[88:91], v[28:31], v[28:31], v[88:91]
    v_mfma_f32_16x16x32_bf16 v[88:91], v[32:35], v[32:35], v[88:91]
    v_mfma_f32_16x16x32_bf16 v[88:91], v[36:39], v[36:39], v[88:91]
    s_mov_b32 s38, 0xbfb8aa3b
    v_lshlrev_b32 v40, 16, v8
    v_and_b32 v41, 0xffff0000, v8
    v_mul_f32 v42, s38, v40
    v_mul_f32 v43, s38, v41
    v_exp_f32 v42, v42
    v_exp_f32 v43, v43
    v_add_f32 v42, 1.0, v42
    v_add_f32 v43, 1.0, v43
    v_rcp_f32 v42, v42
    v_rcp_f32 v43, v43
    v_mul_f32 v40, v40, v42
    v_mul_f32 v41, v41, v43
    v_cvt_pk_bf16_f32 v8, v40, v41
    ds_write_b128 v4, v[88:91] offset:2048
    v_mov_b32 v44, 1
    s_mov_b64 exec, 1
    ds_add_u32 v0, v44 offset:4044
    s_mov_b64 exec, -1
    v_lshlrev_b32 v40, 16, v9
    v_and_b32 v41, 0xffff0000, v9
    v_mul_f32 v42, s38, v40
    v_mul_f32 v43, s38, v41
    v_exp_f32 v42, v42
    v_exp_f32 v43, v43
    v_add_f32 v42, 1.0, v42
    v_add_f32 v43, 1.0, v43
    v_rcp_f32 v42, v42
    v_rcp_f32 v43, v43
    v_mul_f32 v40, v40, v42
    v_mul_f32 v41, v41, v43
    v_cvt_pk_bf16_f32 v9, v40, v41
    v_lshlrev_b32 v40, 16, v10
    v_and_b32 v41, 0xffff0000, v10
    v_mul_f32 v42, s38, v40
    v_mul_f32 v43, s38, v41
    v_exp_f32 v42, v42
    v_exp_f32 v43, v43
    v_add_f32 v42, 1.0, v42
    v_add_f32 v43, 1.0, v43
    v_rcp_f32 v42, v42
    v_rcp_f32 v43, v43
    v_mul_f32 v40, v40, v42
    v_mul_f32 v41, v41, v43
    v_cvt_pk_bf16_f32 v10, v40, v41
    v_lshlrev_b32 v40, 16, v11
    v_and_b32 v41, 0xffff0000, v11
    v_mul_f32 v42, s38, v40
    v_mul_f32 v43, s38, v41
    v_exp_f32 v42, v42
    v_exp_f32 v43, v43
    v_add_f32 v42, 1.0, v42
    v_add_f32 v43, 1.0, v43
    v_rcp_f32 v42, v42
    v_rcp_f32 v43, v43
    v_mul_f32 v40, v40, v42
    v_mul_f32 v41, v41, v43
    v_cvt_pk_bf16_f32 v11, v40, v41
    v_lshlrev_b32 v40, 16, v12
    v_and_b32 v41, 0xffff0000, v12
    v_mul_f32 v42, s38, v40
    v_mul_f32 v43, s38, v41
    v_exp_f32 v42, v42
    v_exp_f32 v43, v43
    v_add_f32 v42, 1.0, v42
    v_add_f32 v43, 1.0, v43
    v_rcp_f32 v42, v42
    v_rcp_f32 v43, v43
    v_mul_f32 v40, v40, v42
    v_mul_f32 v41, v41, v43
    v_cvt_pk_bf16_f32 v12, v40, v41
    v_lshlrev_b32 v40, 16, v13
    v_and_b32 v41, 0xffff0000, v13
    v_mul_f32 v42, s38, v40
    v_mul_f32 v43, s38, v41
    v_exp_f32 v42, v42
    v_exp_f32 v43, v43
    v_add_f32 v42, 1.0, v42
    v_add_f32 v43, 1.0, v43
    v_rcp_f32 v42, v42
    v_rcp_f32 v43, v43
    v_mul_f32 v40, v40, v42
    v_mul_f32 v41, v41, v43
    v_cvt_pk_bf16_f32 v13, v40, v41
    v_lshlrev_b32 v40, 16, v14
    v_and_b32 v41, 0xffff0000, v14
    v_mul_f32 v42, s38, v40
    v_mul_f32 v43, s38, v41
    v_exp_f32 v42, v42
    v_exp_f32 v43, v43
    v_add_f32 v42, 1.0, v42
    v_add_f32 v43, 1.0, v43
    v_rcp_f32 v42, v42
    v_rcp_f32 v43, v43
    v_mul_f32 v40, v40, v42
    v_mul_f32 v41, v41, v43
    v_cvt_pk_bf16_f32 v14, v40, v41
    v_lshlrev_b32 v40, 16, v15
    v_and_b32 v41, 0xffff0000, v15
    v_mul_f32 v42, s38, v40
    v_mul_f32 v43, s38, v41
    v_exp_f32 v42, v42
    v_exp_f32 v43, v43
    v_add_f32 v42, 1.0, v42
    v_add_f32 v43, 1.0, v43
    v_rcp_f32 v42, v42
    v_rcp_f32 v43, v43
    v_mul_f32 v40, v40, v42
    v_mul_f32 v41, v41, v43
    v_cvt_pk_bf16_f32 v15, v40, v41
    v_mov_b32_dpp v16, v8 row_ror:8 row_mask:0xf bank_mask:0xf
    v_mov_b32_dpp v17, v9 row_ror:8 row_mask:0xf bank_mask:0xf
    v_mov_b32_dpp v18, v10 row_ror:8 row_mask:0xf bank_mask:0xf
    v_mov_b32_dpp v19, v11 row_ror:8 row_mask:0xf bank_mask:0xf
    v_mov_b32_dpp v20, v12 row_ror:8 row_mask:0xf bank_mask:0xf
    v_mov_b32_dpp v21, v13 row_ror:8 row_mask:0xf bank_mask:0xf
    v_mov_b32_dpp v22, v14 row_ror:8 row_mask:0xf bank_mask:0xf
    v_mov_b32_dpp v23, v15 row_ror:8 row_mask:0xf bank_mask:0xf
    v_and_b32 v92, 7, v1
    s_cmp_lg_u32 s33, 0
    s_cbranch_scc1 L_C_nln
    v_lshrrev_b32 v93, 2, v92
    v_lshl_add_u32 v93, v93, 4, v92
    v_lshlrev_b32 v93, 4, v93
    v_and_b32 v94, 3, v1
    v_lshl_add_u32 v93, v94, 2, v93
    v_add_u32 v93, 133120, v93
    v_lshlrev_b32 v92, 4, v92
    v_add_u32 v94, 133632, v92
    v_lshrrev_b32 v95, 5, v1
    v_lshl_add_u32 v92, v95, 7, v92
    v_bfe_u32 v95, v1, 4, 1
    v_lshl_add_u32 v92, v95, 3, v92
    v_lshlrev_b32 v96, 16, v6
    v_and_b32 v97, 0xffff0000, v6
    v_lshlrev_b32 v98, 16, v7
    v_and_b32 v99, 0xffff0000, v7
    s_lshl_b32 s39, s55, 8
L_w20:
    ds_read_b32 v40, v0 offset:4044
    s_sub_u32 s3, s3, 1
    s_cbranch_scc1 L_end
    s_waitcnt lgkmcnt(0)
    v_cmp_gt_u32 vcc, 4, v40
    s_cbranch_vccnz L_w20
    ds_read_b32 v24, v94 offset:0
    ds_read_b32 v28, v93 offset:0
    ds_read_b32 v25, v94 offset:3072
    ds_read_b32 v29, v93 offset:3072
    ds_read_b32 v26, v94 offset:6144
    ds_read_b32 v30, v93 offset:6144
    ds_read_b32 v27, v94 offset:9216
    ds_read_b32 v31, v93 offset:9216
    s_mov_b32 s38, 0x3b000000
    s_waitcnt lgkmcnt(0)
    v_add_f32 v24, v24, v25
    v_add_f32 v28, v28, v29
    v_add_f32 v26, v26, v27
    v_add_f32 v30, v30, v31
    v_add_f32 v24, v24, v26
    v_add_f32 v28, v28, v30
    v_mul_f32 v24, s38, v24
    v_mul_f32 v28, s38, v28
    v_fma_f32 v28, -v24, v24, v28
    v_max_f32 v28, 0, v28
    v_add_f32 v28, 0x3727c5ac, v28
    v_rsq_f32 v28, v28
    v_sub_f32 v96, v96, v24
    v_sub_f32 v97, v97, v24
    v_sub_f32 v98, v98, v24
    v_sub_f32 v99, v99, v24
    v_mul_f32 v96, v96, v28
    v_mul_f32 v97, v97, v28
    v_mul_f32 v98, v98, v28
    v_mul_f32 v99, v99, v28
L_C_nln:
L_w21:
    ds_read_b32 v40, v5 offset:5040
    s_sub_u32 s3, s3, 1
    s_cbranch_scc1 L_end
    s_waitcnt lgkmcnt(0)
    v_cmp_gt_u32 vcc, 1, v40
    s_cbranch_vccnz L_w21
    ds_read_b64_tr_b16 v[48:49], v2 offset:0
    ds_read_b64_tr_b16 v[50:51], v2 offset:256
    ds_read_b64_tr_b16 v[52:53], v3 offset:0
    ds_read_b64_tr_b16 v[54:55], v3 offset:256
    ds_read_b64_tr_b16 v[56:57], v2 offset:2048
    ds_read_b64_tr_b16 v[58:59], v2 offset:2304
    ds_read_b64_tr_b16 v[60:61], v3 offset:2048
    ds_read_b64_tr_b16 v[62:63], v3 offset:2304
    ds_read_b64_tr_b16 v[64:65], v2 offset:4096
    ds_read_b64_tr_b16 v[66:67], v2 offset:4352
    ds_read_b64_tr_b16 v[68:69], v3 offset:4096
    ds_read_b64_tr_b16 v[70:71], v3 offset:4352
    s_waitcnt lgkmcnt(8)
    ds_read_b64_tr_b16 v[72:73], v2 offset:6144
    ds_read_b64_tr_b16 v[74:75], v2 offset:6400
    ds_read_b64_tr_b16 v[76:77], v3 offset:6144
    ds_read_b64_tr_b16 v[78:79], v3 offset:6400
    s_waitcnt lgkmcnt(12)
    v_mfma_f32_16x16x32_bf16 v[80:83], v[48:51], v[8:11], 0
    v_mfma_f32_16x16x32_bf16 v[84:87], v[52:55], v[8:11], 0
    s_waitcnt lgkmcnt(8)
    v_mfma_f32_16x16x32_bf16 v[80:83], v[56:59], v[12:15], v[80:83]
    v_mfma_f32_16x16x32_bf16 v[84:87], v[60:63], v[12:15], v[84:87]
    s_waitcnt lgkmcnt(4)
    v_mfma_f32_16x16x32_bf16 v[80:83], v[64:67], v[16:19], v[80:83]
    v_mfma_f32_16x16x32_bf16 v[84:87], v[68:71], v[16:19], v[84:87]
    s_waitcnt lgkmcnt(0)
    v_mfma_f32_16x16x32_bf16 v[80:83], v[72:75], v[20:23], v[80:83]
    v_mfma_f32_16x16x32_bf16 v[84:87], v[76:79], v[20:23], v[84:87]
    s_cmp_eq_u32 s33, 0
    s_cbranch_scc1 L_C_red
    s_nop 4
    ds_write_b128 v4, v[80:83] offset:0
    ds_write_b128 v4, v[84:87] offset:1024
    v_mov_b32 v5, 1
    s_mov_b64 exec, 1
    ds_add_u32 v0, v5 offset:0
    s_mov_b64 exec, -1
    s_branch L_C_nl
L_C_red:
L_w22:
    ds_read_b32 v5, v0 offset:0
    s_sub_u32 s3, s3, 1
    s_cbranch_scc1 L_end
    s_waitcnt lgkmcnt(0)
    v_cmp_gt_u32 vcc, 3, v5
    s_cbranch_vccnz L_w22
    ds_read_b128 v[48:51], v4 offset:3072
    ds_read_b128 v[52:55], v4 offset:4096
    ds_read_b128 v[56:59], v4 offset:6144
    ds_read_b128 v[60:63], v4 offset:7168
    ds_read_b128 v[64:67], v4 offset:9216
    ds_read_b128 v[68:71], v4 offset:10240
    ds_read_b32 v5, v0 offset:4040
    v_add_f32 v80, v80, v96
    v_add_f32 v81, v81, v97
    v_add_f32 v82, v82, v98
    v_add_f32 v83, v83, v99
    s_waitcnt lgkmcnt(0)
    v_pk_add_f32 v[80:81], v[80:81], v[48:49]
    v_pk_add_f32 v[56:57], v[56:57], v[64:65]
    v_pk_add_f32 v[82:83], v[82:83], v[50:51]
    v_pk_add_f32 v[58:59], v[58:59], v[66:67]
    v_pk_add_f32 v[84:85], v[84:85], v[52:53]
    v_pk_add_f32 v[60:61], v[60:61], v[68:69]
    v_pk_add_f32 v[86:87], v[86:87], v[54:55]
    v_pk_add_f32 v[62:63], v[62:63], v[70:71]
    v_pk_add_f32 v[80:81], v[80:81], v[56:57]
    v_pk_add_f32 v[82:83], v[82:83], v[58:59]
    v_pk_add_f32 v[84:85], v[84:85], v[60:61]
    v_pk_add_f32 v[86:87], v[86:87], v[62:63]
    v_cmp_eq_u32 vcc, 0, v5
    v_fmac_f32 v80, v84, v96
    v_fmac_f32 v81, v85, v97
    v_fmac_f32 v82, v86, v98
    v_fmac_f32 v83, v87, v99
    v_cvt_pk_bf16_f32 v80, v80, v81
    v_cvt_pk_bf16_f32 v81, v82, v83
    s_cbranch_vccz L_C_pub
L_w23:
    ds_read_b32 v5, v0 offset:4040
    s_sub_u32 s3, s3, 1
    s_cbranch_scc1 L_end
    s_waitcnt lgkmcnt(0)
    v_cmp_gt_u32 vcc, 1, v5
    s_cbranch_vccnz L_w23
L_C_pub:
    s_mov_b64 exec, s[56:57]
    buffer_store_dwordx2 v[80:81], v92, s[40:43], s39 offen sc1
    s_mov_b64 exec, -1
    v_mov_b32 v5, 4
    ds_write_b32 v0, v5 offset:12
    s_branch L_C_nl
L_Co:
    s_waitcnt lgkmcnt(0)
    s_cmp_lt_u32 s34, 5
    s_cbranch_scc1 L_C_nt
    s_cmp_eq_u32 s2, 40
    s_cbranch_scc1 L_C_nt
    s_mul_i32 s38, s32, 3
    s_add_u32 s38, s38, s34
    s_sub_u32 s38, s38, 17
    s_cmp_ge_u32 s38, 16
    s_cbranch_scc1 L_C_nt
    v_lshrrev_b32 v2, 1, v1
    v_and_b32 v3, 1, v1
    v_lshl_add_u32 v2, v2, 6, v3
    s_lshl_b32 s38, s38, 10
    s_add_u32 s38, s38, s35
    s_lshl_b32 s38, s38, 8
    v_lshl_add_u32 v2, v2, 7, s38
    global_load_dword v166, v2, s[10:11]
L_C_nt:
    s_mov_b32 s40, s30
    s_mov_b32 s41, s31
    s_mov_b32 s42, 16777216
    s_mov_b32 s43, 0x20000

    s_mov_b32 s3, 0x400000
    v_mov_b32 v0, 156256
    s_lshl_b32 s54, s34, 5
    s_add_u32 s54, s54, s35
    s_lshl_b32 s54, s54, 10
    s_and_b32 s96, s36, 3
    s_and_b32 s39, s34, 4
    s_add_u32 s96, s96, s39

    s_barrier
    s_cmp_ge_u32 s34, 4
    s_cbranch_scc1 L_C_nl
    s_cmp_lt_u32 s33, 2
    s_cbranch_scc1 L_C_s3
L_C_nl:
    v_mov_b32 v5, 1
    s_mov_b64 exec, 1
    ds_add_u32 v0, v5 offset:8
    s_mov_b64 exec, -1
    s_branch L_C_t
L_C_s3:
    s_mov_b32 s44, s10
    s_mov_b32 s45, s11
    s_mov_b32 s46, 4194304
    s_mov_b32 s47, 0x20000

    v_lshrrev_b32 v3, 4, v1
    v_and_b32 v2, 15, v1
    v_xor_b32 v4, v2, v3
    v_lshlrev_b32 v4, 4, v4
    v_lshl_add_u32 v4, v3, 13, v4
    v_xor_b32 v5, 64, v4
    v_xor_b32 v6, 0x80, v4
    v_xor_b32 v7, 0xc0, v4
    s_lshl_b32 s63, s34, 1
    s_add_u32 s63, s63, s33
    s_lshl_b32 s48, s63, 19
    s_lshl_b32 s38, s35, 8
    s_add_u32 s48, s48, s38
    s_lshl_b32 s51, s33, 14
    s_add_u32 s51, s51, 98304
    v_lshlrev_b32 v12, 4, v1
    v_mov_b32 v8, -1
    v_mov_b32 v9, -1
    v_mov_b32 v10, -1
    v_mov_b32 v11, -1
    s_lshl_b32 s52, s33, 17
    s_add_u32 s52, s52, s54
    s_add_u32 s38, s52, 327680
    buffer_store_dwordx4 v[8:11], v12, s[40:43], s38 offen sc1
    s_add_u32 s38, s52, 851968
    buffer_store_dwordx4 v[8:11], v12, s[40:43], s38 offen sc1
    s_add_u32 s38, s52, 589824
    buffer_store_dwordx4 v[8:11], v12, s[40:43], s38 offen sc1
    s_lshl3_add_u32 s38, s35, s63
    s_lshl_b32 s38, s38, 10
    s_add_u32 s38, s38, 1114112
    buffer_store_dwordx4 v[8:11], v12, s[40:43], s38 offen sc1
    s_cmp_lg_u32 s33, 1
    s_cbranch_scc1 L_C_nm
    s_add_u32 s38, s54, 1376256
    buffer_store_dwordx4 v[8:11], v12, s[40:43], s38 offen sc1
L_C_nm:
L_w24:
    s_sleep 1
    ds_read_b32 v13, v0 offset:2020
    s_sub_u32 s3, s3, 1
    s_cbranch_scc1 L_end
    s_waitcnt lgkmcnt(0)
    v_cmp_gt_u32 vcc, 4, v13
    s_cbranch_vccnz L_w24
    s_add_u32 m0, s51, 0
    s_add_u32 s38, s48, 0
    buffer_load_dwordx4 v4, s[44:47], s38 offen nt lds
    s_add_u32 m0, s51, 1024
    s_add_u32 s38, s48, 131072
    buffer_load_dwordx4 v5, s[44:47], s38 offen nt lds
    s_add_u32 m0, s51, 2048
    s_add_u32 s38, s48, 262144
    buffer_load_dwordx4 v6, s[44:47], s38 offen nt lds
    s_add_u32 m0, s51, 3072
    s_add_u32 s38, s48, 393216
    buffer_load_dwordx4 v7, s[44:47], s38 offen nt lds
    s_add_u32 m0, s51, 4096
    s_add_u32 s38, s48, 32768
    buffer_load_dwordx4 v4, s[44:47], s38 offen nt lds
    s_add_u32 m0, s51, 5120
    s_add_u32 s38, s48, 163840
    buffer_load_dwordx4 v5, s[44:47], s38 offen nt lds
    s_add_u32 m0, s51, 6144
    s_add_u32 s38, s48, 294912
    buffer_load_dwordx4 v6, s[44:47], s38 offen nt lds
    s_add_u32 m0, s51, 7168
    s_add_u32 s38, s48, 425984
    buffer_load_dwordx4 v7, s[44:47], s38 offen nt lds
    s_add_u32 m0, s51, 8192
    s_add_u32 s38, s48, 65536
    buffer_load_dwordx4 v4, s[44:47], s38 offen nt lds
    s_add_u32 m0, s51, 9216
    s_add_u32 s38, s48, 196608
    buffer_load_dwordx4 v5, s[44:47], s38 offen nt lds
    s_add_u32 m0, s51, 10240
    s_add_u32 s38, s48, 327680
    buffer_load_dwordx4 v6, s[44:47], s38 offen nt lds
    s_add_u32 m0, s51, 11264
    s_add_u32 s38, s48, 458752
    buffer_load_dwordx4 v7, s[44:47], s38 offen nt lds
    s_add_u32 m0, s51, 12288
    s_add_u32 s38, s48, 98304
    buffer_load_dwordx4 v4, s[44:47], s38 offen nt lds
    s_add_u32 m0, s51, 13312
    s_add_u32 s38, s48, 229376
    buffer_load_dwordx4 v5, s[44:47], s38 offen nt lds
    s_add_u32 m0, s51, 14336
    s_add_u32 s38, s48, 360448
    buffer_load_dwordx4 v6, s[44:47], s38 offen nt lds
    s_add_u32 m0, s51, 15360
    s_add_u32 s38, s48, 491520
    buffer_load_dwordx4 v7, s[44:47], s38 offen nt lds
    v_mov_b32 v13, 1
    s_mov_b64 exec, 1
    ds_add_u32 v0, v13 offset:2024
    s_mov_b64 exec, -1

    v_lshlrev_b32 v4, 2, v3
    v_xor_b32 v4, v4, v2
    v_lshlrev_b32 v4, 4, v4
    v_lshl_add_u32 v4, v2, 8, v4
    v_add_u32 v4, s51, v4
    v_xor_b32 v5, 16, v4
    v_xor_b32 v6, 32, v4
    v_xor_b32 v7, 48, v4
    v_add_u32 v12, 131072, v12
    v_and_b32 v13, 1, v1
    v_lshlrev_b32 v14, 4, v13
    v_lshl_add_u32 v15, v3, 5, v14
    v_lshrrev_b32 v2, 1, v2
    v_lshl_add_u32 v15, v2, 15, v15
    s_mov_b32 s38, 0xffff
    v_lshlrev_b32 v14, v14, s38
    v_cmp_eq_u32 s[56:57], 1, v13
    s_lshl_b32 s49, s35, 10
    s_lshl_b32 s38, s63, 7
    s_add_u32 s49, s49, s38
    s_add_u32 s49, s49, 65536
    s_waitcnt vmcnt(0)
    ds_read_b128 v[104:107], v4 offset:0
    ds_read_b128 v[108:111], v5 offset:0
    ds_read_b128 v[112:115], v6 offset:0
    ds_read_b128 v[116:119], v7 offset:0
    s_waitcnt lgkmcnt(0)
    ds_read_b128 v[120:123], v4 offset:4096
    ds_read_b128 v[124:127], v5 offset:4096
    ds_read_b128 v[128:131], v6 offset:4096
    ds_read_b128 v[132:135], v7 offset:4096
    s_waitcnt lgkmcnt(0)
    ds_read_b128 v[136:139], v4 offset:8192
    ds_read_b128 v[140:143], v5 offset:8192
    ds_read_b128 v[144:147], v6 offset:8192
    ds_read_b128 v[148:151], v7 offset:8192
    s_waitcnt lgkmcnt(0)
    ds_read_b128 v[152:155], v4 offset:12288
    ds_read_b128 v[156:159], v5 offset:12288
    ds_read_b128 v[160:163], v6 offset:12288
    ds_read_b128 v[164:167], v7 offset:12288
    s_waitcnt lgkmcnt(0)
    v_mov_b32 v5, 1
    s_mov_b64 exec, 1
    ds_add_u32 v0, v5 offset:8
    s_mov_b64 exec, -1
    s_setprio 2
L_w25:
    ds_read_b32 v5, v0 offset:4
    s_sub_u32 s3, s3, 1
    s_cbranch_scc1 L_end
    s_waitcnt lgkmcnt(0)
    v_cmp_gt_u32 vcc, 4, v5
    s_cbranch_vccnz L_w25
    s_or_b32 s38, s2, s33
    s_cbranch_scc1 L_C_f2
    v_mov_b32 v5, 0
    s_mov_b64 exec, 1
    global_store_dword v5, v8, s[28:29] offset:128 sc1
    s_mov_b64 exec, -1
L_C_f2:
    ds_read_b128 v[40:43], v12 offset:0
    ds_read_b128 v[44:47], v12 offset:4096
    ds_read_b128 v[48:51], v12 offset:8192
    ds_read_b128 v[52:55], v12 offset:12288
    ds_read_b128 v[56:59], v12 offset:1024
    ds_read_b128 v[60:63], v12 offset:5120
    ds_read_b128 v[64:67], v12 offset:9216
    ds_read_b128 v[68:71], v12 offset:13312
    ds_read_b128 v[72:75], v12 offset:2048
    ds_read_b128 v[76:79], v12 offset:6144
    ds_read_b128 v[80:83], v12 offset:10240
    ds_read_b128 v[84:87], v12 offset:14336
    s_waitcnt lgkmcnt(8)
    ds_read_b128 v[88:91], v12 offset:3072
    ds_read_b128 v[92:95], v12 offset:7168
    ds_read_b128 v[96:99], v12 offset:11264
    ds_read_b128 v[100:103], v12 offset:15360
    s_waitcnt lgkmcnt(12)
    v_add_f32 v40, v40, v44
    v_add_f32 v48, v48, v52
    v_add_f32 v41, v41, v45
    v_add_f32 v49, v49, v53
    v_add_f32 v42, v42, v46
    v_add_f32 v50, v50, v54
    v_add_f32 v43, v43, v47
    v_add_f32 v51, v51, v55
    v_add_f32 v40, v40, v48
    v_add_f32 v41, v41, v49
    v_add_f32 v42, v42, v50
    v_add_f32 v43, v43, v51
    v_cvt_pk_bf16_f32 v40, v40, v40
    v_cvt_pk_bf16_f32 v41, v41, v41
    v_cvt_pk_bf16_f32 v42, v42, v42
    v_cvt_pk_bf16_f32 v43, v43, v43
    v_and_b32 v16, v40, v14
    v_and_b32 v20, v41, v14
    v_and_b32 v24, v42, v14
    v_and_b32 v28, v43, v14
    s_waitcnt lgkmcnt(8)
    v_add_f32 v56, v56, v60
    v_add_f32 v64, v64, v68
    v_add_f32 v57, v57, v61
    v_add_f32 v65, v65, v69
    v_add_f32 v58, v58, v62
    v_add_f32 v66, v66, v70
    v_add_f32 v59, v59, v63
    v_add_f32 v67, v67, v71
    v_add_f32 v56, v56, v64
    v_add_f32 v57, v57, v65
    v_add_f32 v58, v58, v66
    v_add_f32 v59, v59, v67
    v_cvt_pk_bf16_f32 v56, v56, v56
    v_cvt_pk_bf16_f32 v57, v57, v57
    v_cvt_pk_bf16_f32 v58, v58, v58
    v_cvt_pk_bf16_f32 v59, v59, v59
    v_and_b32 v17, v56, v14
    v_and_b32 v21, v57, v14
    v_and_b32 v25, v58, v14
    v_and_b32 v29, v59, v14
    s_waitcnt lgkmcnt(4)
    v_add_f32 v72, v72, v76
    v_add_f32 v80, v80, v84
    v_add_f32 v73, v73, v77
    v_add_f32 v81, v81, v85
    v_add_f32 v74, v74, v78
    v_add_f32 v82, v82, v86
    v_add_f32 v75, v75, v79
    v_add_f32 v83, v83, v87
    v_add_f32 v72, v72, v80
    v_add_f32 v73, v73, v81
    v_add_f32 v74, v74, v82
    v_add_f32 v75, v75, v83
    v_cvt_pk_bf16_f32 v72, v72, v72
    v_cvt_pk_bf16_f32 v73, v73, v73
    v_cvt_pk_bf16_f32 v74, v74, v74
    v_cvt_pk_bf16_f32 v75, v75, v75
    v_and_b32 v18, v72, v14
    v_and_b32 v22, v73, v14
    v_and_b32 v26, v74, v14
    v_and_b32 v30, v75, v14
    s_waitcnt lgkmcnt(0)
    v_add_f32 v88, v88, v92
    v_add_f32 v96, v96, v100
    v_add_f32 v89, v89, v93
    v_add_f32 v97, v97, v101
    v_add_f32 v90, v90, v94
    v_add_f32 v98, v98, v102
    v_add_f32 v91, v91, v95
    v_add_f32 v99, v99, v103
    v_add_f32 v88, v88, v96
    v_add_f32 v89, v89, v97
    v_add_f32 v90, v90, v98
    v_add_f32 v91, v91, v99
    v_cvt_pk_bf16_f32 v88, v88, v88
    v_cvt_pk_bf16_f32 v89, v89, v89
    v_cvt_pk_bf16_f32 v90, v90, v90
    v_cvt_pk_bf16_f32 v91, v91, v91
    v_and_b32 v19, v88, v14
    v_and_b32 v23, v89, v14
    v_and_b32 v27, v90, v14
    v_and_b32 v31, v91, v14
    v_mfma_f32_16x16x32_bf16 v[40:43], v[104:107], v[16:19], 0
    v_mfma_f32_16x16x32_bf16 v[44:47], v[120:123], v[16:19], 0
    v_mfma_f32_16x16x32_bf16 v[48:51], v[136:139], v[16:19], 0
    v_mfma_f32_16x16x32_bf16 v[52:55], v[152:155], v[16:19], 0
    v_mfma_f32_16x16x32_bf16 v[40:43], v[108:111], v[20:23], v[40:43]
    v_mfma_f32_16x16x32_bf16 v[44:47], v[124:127], v[20:23], v[44:47]
    v_mfma_f32_16x16x32_bf16 v[48:51], v[140:143], v[20:23], v[48:51]
    v_mfma_f32_16x16x32_bf16 v[52:55], v[156:159], v[20:23], v[52:55]
    v_mfma_f32_16x16x32_bf16 v[40:43], v[112:115], v[24:27], v[40:43]
    v_mfma_f32_16x16x32_bf16 v[44:47], v[128:131], v[24:27], v[44:47]
    v_mfma_f32_16x16x32_bf16 v[48:51], v[144:147], v[24:27], v[48:51]
    v_mfma_f32_16x16x32_bf16 v[52:55], v[160:163], v[24:27], v[52:55]
    v_mfma_f32_16x16x32_bf16 v[40:43], v[116:119], v[28:31], v[40:43]
    v_mfma_f32_16x16x32_bf16 v[44:47], v[132:135], v[28:31], v[44:47]
    v_mfma_f32_16x16x32_bf16 v[48:51], v[148:151], v[28:31], v[48:51]
    v_mfma_f32_16x16x32_bf16 v[52:55], v[164:167], v[28:31], v[52:55]
    s_nop 4
    v_add_f32_dpp v40, v40, v40 quad_perm:[1,0,3,2] row_mask:0xf bank_mask:0xf
    v_add_f32_dpp v41, v41, v41 quad_perm:[1,0,3,2] row_mask:0xf bank_mask:0xf
    v_add_f32_dpp v42, v42, v42 quad_perm:[1,0,3,2] row_mask:0xf bank_mask:0xf
    v_add_f32_dpp v43, v43, v43 quad_perm:[1,0,3,2] row_mask:0xf bank_mask:0xf
    v_add_f32_dpp v44, v44, v44 quad_perm:[1,0,3,2] row_mask:0xf bank_mask:0xf
    v_add_f32_dpp v45, v45, v45 quad_perm:[1,0,3,2] row_mask:0xf bank_mask:0xf
    v_add_f32_dpp v46, v46, v46 quad_perm:[1,0,3,2] row_mask:0xf bank_mask:0xf
    v_add_f32_dpp v47, v47, v47 quad_perm:[1,0,3,2] row_mask:0xf bank_mask:0xf
    v_add_f32_dpp v48, v48, v48 quad_perm:[1,0,3,2] row_mask:0xf bank_mask:0xf
    v_add_f32_dpp v49, v49, v49 quad_perm:[1,0,3,2] row_mask:0xf bank_mask:0xf
    v_add_f32_dpp v50, v50, v50 quad_perm:[1,0,3,2] row_mask:0xf bank_mask:0xf
    v_add_f32_dpp v51, v51, v51 quad_perm:[1,0,3,2] row_mask:0xf bank_mask:0xf
    v_add_f32_dpp v52, v52, v52 quad_perm:[1,0,3,2] row_mask:0xf bank_mask:0xf
    v_add_f32_dpp v53, v53, v53 quad_perm:[1,0,3,2] row_mask:0xf bank_mask:0xf
    v_add_f32_dpp v54, v54, v54 quad_perm:[1,0,3,2] row_mask:0xf bank_mask:0xf
    v_add_f32_dpp v55, v55, v55 quad_perm:[1,0,3,2] row_mask:0xf bank_mask:0xf
    v_cndmask_b32 v40, v40, v48, s[56:57]
    v_cndmask_b32 v41, v41, v49, s[56:57]
    v_cndmask_b32 v42, v42, v50, s[56:57]
    v_cndmask_b32 v43, v43, v51, s[56:57]
    v_cndmask_b32 v44, v44, v52, s[56:57]
    v_cndmask_b32 v45, v45, v53, s[56:57]
    v_cndmask_b32 v46, v46, v54, s[56:57]
    v_cndmask_b32 v47, v47, v55, s[56:57]
    v_cvt_pk_bf16_f32 v40, v40, v41
    v_cvt_pk_bf16_f32 v41, v42, v43
    v_cvt_pk_bf16_f32 v42, v44, v45
    v_cvt_pk_bf16_f32 v43, v46, v47
    buffer_store_dwordx4 v[40:43], v15, s[40:43], s49 offen sc1
    v_mov_b32 v5, 1
    s_mov_b64 exec, 1
    ds_add_u32 v0, v5 offset:2028
    s_mov_b64 exec, -1
    s_waitcnt vmcnt(0)
    v_mov_b32 v5, 1
    s_mov_b64 exec, 1
    ds_add_u32 v0, v5 offset:3036
    s_mov_b64 exec, -1
L_C_t:
    s_setprio 0
    v_and_b32 v5, 15, v1
    s_cmp_ge_u32 s34, 4
    s_cbranch_scc1 L_C_o
    s_cmp_ge_u32 s35, 28
    s_cbranch_scc1 L_end
    s_and_b32 s38, s34, 1
    s_lshl2_add_u32 s38, s38, s33
    s_lshl_b32 s38, s38, 6
    v_add_u32 v12, s38, v1
    s_cmp_lt_u32 s34, 2
    s_movk_i32 s38, 128
    s_cselect_b32 s38, 3584, s38
    s_cselect_b32 s39, 7, 16
    s_cselect_b32 s52, s18, s20
    s_cselect_b32 s53, s19, s21
    v_mul_lo_u32 v12, v12, s38
    s_lshl_b32 s38, s35, s39
    v_add_u32 v12, s38, v12
L_w26:
    s_sleep 1
    ds_read_b32 v6, v0 offset:7060
    s_sub_u32 s3, s3, 1
    s_cbranch_scc1 L_end
    s_waitcnt lgkmcnt(0)
    v_cmp_gt_u32 vcc, 4, v6
    s_cbranch_vccnz L_w26
    global_load_dword v166, v12, s[52:53]
    v_bfe_u32 v12, v1, 4, 1
    v_lshlrev_b32 v12, 1, v12
    v_and_b32 v13, 7, v1
    v_xor_b32 v12, v12, v13
    v_lshlrev_b32 v164, 4, v12
    v_lshrrev_b32 v165, 3, v1
    v_lshlrev_b32 v14, 2, v5
    v_add_u32 v14, 145408, v14
    v_mov_b32 v15, -1
L_w27:
    s_sleep 1
    ds_read_b32 v6, v0 offset:1012
    s_sub_u32 s3, s3, 1
    s_cbranch_scc1 L_end
    s_waitcnt lgkmcnt(0)
    v_cmp_gt_u32 vcc, 4, v6
    s_cbranch_vccnz L_w27
    ds_write_b32 v14, v15
    s_mov_b32 s44, s18
    s_mov_b32 s45, s19
    s_mov_b32 s46, 1835008
    s_mov_b32 s47, 0x20000
    s_lshl_b32 s58, s35, 7

    v_mul_u32_u24 v12, 3584, v165
    v_add_u32 v12, v12, v164
    v_xor_b32 v13, 64, v12
    s_mul_i32 s38, s33, 458752
    s_add_u32 s58, s58, s38
    s_lshl_b32 s57, s33, 14
    s_add_u32 s57, s57, 0
    s_and_b32 s56, s34, 3
    s_mov_b32 s59, 0
L_A_f1:
    s_xor_b32 s38, s59, s56
    s_lshl_b32 s39, s38, 12
    s_add_u32 s39, s39, s57
    s_mul_i32 s38, s38, 114688
    s_add_u32 s38, s38, s58
    s_add_u32 m0, s39, 0
    s_add_u32 s60, s38, 0
    buffer_load_dwordx4 v12, s[44:47], s60 offen lds
    s_waitcnt vmcnt(6)
    s_add_u32 m0, s39, 1024
    s_add_u32 s60, s38, 28672
    buffer_load_dwordx4 v13, s[44:47], s60 offen lds
    s_waitcnt vmcnt(6)
    s_add_u32 m0, s39, 2048
    s_add_u32 s60, s38, 57344
    buffer_load_dwordx4 v12, s[44:47], s60 offen lds
    s_waitcnt vmcnt(6)
    s_add_u32 m0, s39, 3072
    s_add_u32 s60, s38, 86016
    buffer_load_dwordx4 v13, s[44:47], s60 offen lds
    s_waitcnt vmcnt(6)
    s_add_u32 s59, s59, 1
    s_cmp_lt_u32 s59, 4
    s_cbranch_scc1 L_A_f1

    s_mov_b32 s44, s20
    s_mov_b32 s45, s21
    v_lshrrev_b32 v6, 4, v1
    v_lshlrev_b32 v12, 1, v6
    v_xor_b32 v12, v12, v5
    v_lshlrev_b32 v12, 4, v12
    v_lshl_add_u32 v12, v6, 10, v12
    v_xor_b32 v13, 0x80, v12
    s_lshl_b32 s58, s35, 16
    s_lshl_b32 s38, s33, 8
    s_add_u32 s58, s58, s38
    s_add_u32 s57, s57, 65536
    s_mov_b32 s59, 0
L_A_f2:
    s_xor_b32 s38, s59, s56
    s_lshl_b32 s39, s38, 12
    s_add_u32 s39, s39, s57
    s_lshl_b32 s38, s38, 14
    s_add_u32 s38, s38, s58
    s_add_u32 m0, s39, 0
    s_add_u32 s60, s38, 0
    buffer_load_dwordx4 v12, s[44:47], s60 offen lds
    s_waitcnt vmcnt(6)
    s_add_u32 m0, s39, 1024
    s_add_u32 s60, s38, 4096
    buffer_load_dwordx4 v12, s[44:47], s60 offen lds
    s_waitcnt vmcnt(6)
    s_add_u32 m0, s39, 2048
    s_add_u32 s60, s38, 8192
    buffer_load_dwordx4 v13, s[44:47], s60 offen lds
    s_waitcnt vmcnt(6)
    s_add_u32 m0, s39, 3072
    s_add_u32 s60, s38, 12288
    buffer_load_dwordx4 v13, s[44:47], s60 offen lds
    s_waitcnt vmcnt(6)
    s_add_u32 s59, s59, 1
    s_cmp_lt_u32 s59, 4
    s_cbranch_scc1 L_A_f2
    s_waitcnt vmcnt(0)
    v_mov_b32 v6, 1
    s_mov_b64 exec, 1
    ds_add_u32 v0, v6 offset:7056
    s_mov_b64 exec, -1
    s_branch L_end
L_C_o:
    s_mov_b32 s44, s14
    s_mov_b32 s45, s15
    s_mov_b32 s46, 4194304
    s_mov_b32 s47, 0x20000
    v_and_b32 v16, 1, v1
    v_lshlrev_b32 v16, 4, v16
    s_mov_b32 s38, 0xffff
    v_lshlrev_b32 v16, v16, s38
    v_bfe_u32 v17, v1, 1, 2
    v_cmp_eq_u32 vcc, 0, v17
    s_nop 1
    v_cndmask_b32 v20, 0, v16, vcc
    v_cmp_eq_u32 vcc, 1, v17
    s_nop 1
    v_cndmask_b32 v21, 0, v16, vcc
    v_cmp_eq_u32 vcc, 2, v17
    s_nop 1
    v_cndmask_b32 v22, 0, v16, vcc
    v_cmp_eq_u32 vcc, 3, v17
    s_nop 1
    v_cndmask_b32 v23, 0, v16, vcc

    s_mov_b32 s38, 0x3f803f80
    v_and_b32 v20, s38, v20
    v_and_b32 v21, s38, v21
    v_and_b32 v22, s38, v22
    v_and_b32 v23, s38, v23
    v_lshrrev_b32 v4, 4, v1
    s_and_b32 s62, s34, 3
    v_lshlrev_b32 v7, 11, v4
    v_lshl_add_u32 v7, v5, 4, v7
    s_lshl_b32 s50, s35, 13
    s_lshl_b32 s38, s33, 8
    s_add_u32 s50, s50, s38
    s_add_u32 s50, s50, 1114112
    v_and_b32 v12, 1, v4
    v_lshrrev_b32 v13, 1, v4
    v_lshl_add_u32 v12, v12, 1, v13
    s_lshl_b32 s38, s33, 2
    v_add_u32 v12, s38, v12
    v_mul_u32_u24 v12, 528, v12
    v_lshl_add_u32 v18, v5, 4, v12
    v_lshlrev_b32 v13, 4, v13
    s_mov_b32 s38, 0xffff
    v_lshlrev_b32 v19, v13, s38
    v_mul_u32_u24 v3, 528, v5
    v_lshl_add_u32 v3, v4, 4, v3
    v_lshlrev_b32 v2, 12, v4
    v_lshl_add_u32 v2, v5, 3, v2
    v_lshlrev_b32 v4, 16, v4
    v_lshl_add_u32 v4, v5, 3, v4
    s_lshl1_add_u32 s38, s62, s33
    s_lshl_b32 s38, s38, 7
    s_lshl_b32 s48, s35, 17
    s_add_u32 s48, s48, s38
    s_lshl_b32 s49, s35, 10
    s_add_u32 s49, s49, s38
    s_add_u32 s49, s49, 851968
    s_add_u32 s51, s49, 32768
    s_lshl_b32 s38, s62, 15
    s_lshl_b32 s60, s35, 7
    s_add_u32 s60, s60, s38
    s_add_u32 s60, s60, 618496
    s_cmp_ge_u32 s33, 2
    s_cbranch_scc1 L_C_o1
L_w28:
    s_sleep 1
    ds_read_b32 v6, v0 offset:7068
    s_sub_u32 s3, s3, 1
    s_cbranch_scc1 L_end
    s_waitcnt lgkmcnt(0)
    v_cmp_gt_u32 vcc, 4, v6
    s_cbranch_vccnz L_w28
    s_add_u32 s39, s48, 0
    buffer_load_dwordx2 v[104:105], v2, s[44:47], s39 offen nt
    s_add_u32 s39, s48, 1024
    buffer_load_dwordx2 v[108:109], v2, s[44:47], s39 offen nt
    s_add_u32 s39, s48, 2048
    buffer_load_dwordx2 v[106:107], v2, s[44:47], s39 offen nt
    s_add_u32 s39, s48, 3072
    buffer_load_dwordx2 v[110:111], v2, s[44:47], s39 offen nt
    s_add_u32 s39, s48, 16384
    buffer_load_dwordx2 v[112:113], v2, s[44:47], s39 offen nt
    s_add_u32 s39, s48, 17408
    buffer_load_dwordx2 v[116:117], v2, s[44:47], s39 offen nt
    s_add_u32 s39, s48, 18432
    buffer_load_dwordx2 v[114:115], v2, s[44:47], s39 offen nt
    s_add_u32 s39, s48, 19456
    buffer_load_dwordx2 v[118:119], v2, s[44:47], s39 offen nt
    s_add_u32 s39, s48, 32768
    buffer_load_dwordx2 v[120:121], v2, s[44:47], s39 offen nt
    s_add_u32 s39, s48, 33792
    buffer_load_dwordx2 v[124:125], v2, s[44:47], s39 offen nt
    s_add_u32 s39, s48, 34816
    buffer_load_dwordx2 v[122:123], v2, s[44:47], s39 offen nt
    s_add_u32 s39, s48, 35840
    buffer_load_dwordx2 v[126:127], v2, s[44:47], s39 offen nt
    s_add_u32 s39, s48, 49152
    buffer_load_dwordx2 v[128:129], v2, s[44:47], s39 offen nt
    s_add_u32 s39, s48, 50176
    buffer_load_dwordx2 v[132:133], v2, s[44:47], s39 offen nt
    s_add_u32 s39, s48, 51200
    buffer_load_dwordx2 v[130:131], v2, s[44:47], s39 offen nt
    s_add_u32 s39, s48, 52224
    buffer_load_dwordx2 v[134:135], v2, s[44:47], s39 offen nt
    s_add_u32 s39, s48, 65536
    buffer_load_dwordx2 v[136:137], v2, s[44:47], s39 offen nt
    s_add_u32 s39, s48, 66560
    buffer_load_dwordx2 v[140:141], v2, s[44:47], s39 offen nt
    s_add_u32 s39, s48, 67584
    buffer_load_dwordx2 v[138:139], v2, s[44:47], s39 offen nt
    s_add_u32 s39, s48, 68608
    buffer_load_dwordx2 v[142:143], v2, s[44:47], s39 offen nt
    s_add_u32 s39, s48, 81920
    buffer_load_dwordx2 v[144:145], v2, s[44:47], s39 offen nt
    s_add_u32 s39, s48, 82944
    buffer_load_dwordx2 v[148:149], v2, s[44:47], s39 offen nt
    s_add_u32 s39, s48, 83968
    buffer_load_dwordx2 v[146:147], v2, s[44:47], s39 offen nt
    s_add_u32 s39, s48, 84992
    buffer_load_dwordx2 v[150:151], v2, s[44:47], s39 offen nt
    s_add_u32 s39, s48, 98304
    buffer_load_dwordx2 v[152:153], v2, s[44:47], s39 offen nt
    s_add_u32 s39, s48, 99328
    buffer_load_dwordx2 v[156:157], v2, s[44:47], s39 offen nt
    s_add_u32 s39, s48, 100352
    buffer_load_dwordx2 v[154:155], v2, s[44:47], s39 offen nt
    s_add_u32 s39, s48, 101376
    buffer_load_dwordx2 v[158:159], v2, s[44:47], s39 offen nt
    s_add_u32 s39, s48, 114688
    buffer_load_dwordx2 v[160:161], v2, s[44:47], s39 offen nt
    s_add_u32 s39, s48, 115712
    buffer_load_dwordx2 v[164:165], v2, s[44:47], s39 offen nt
    s_add_u32 s39, s48, 116736
    buffer_load_dwordx2 v[162:163], v2, s[44:47], s39 offen nt
    s_add_u32 s39, s48, 117760
    buffer_load_dwordx2 v[166:167], v2, s[44:47], s39 offen nt
    s_waitcnt vmcnt(31)
    v_mov_b32 v6, 1
    s_mov_b64 exec, 1
    ds_add_u32 v0, v6 offset:6060
    s_mov_b64 exec, -1
    s_waitcnt vmcnt(0)
    v_swap_b32 v105, v108
    v_swap_b32 v107, v110
    v_swap_b32 v113, v116
    v_swap_b32 v115, v118
    v_swap_b32 v121, v124
    v_swap_b32 v123, v126
    v_swap_b32 v129, v132
    v_swap_b32 v131, v134
    v_swap_b32 v137, v140
    v_swap_b32 v139, v142
    v_swap_b32 v145, v148
    v_swap_b32 v147, v150
    v_swap_b32 v153, v156
    v_swap_b32 v155, v158
    v_swap_b32 v161, v164
    v_swap_b32 v163, v166
L_C_o1:
L_w29:
    s_sleep 1
    ds_read_b32 v6, v0 offset:6048
    s_sub_u32 s3, s3, 1
    s_cbranch_scc1 L_end
    s_waitcnt lgkmcnt(0)
    v_cmp_gt_u32 vcc, 8, v6
    s_cbranch_vccnz L_w29
    s_setprio 2
L_w30:
    ds_read_b32 v6, v0 offset:6052
    s_sub_u32 s3, s3, 1
    s_cbranch_scc1 L_end
    s_waitcnt lgkmcnt(0)
    v_cmp_gt_u32 vcc, 2, v6
    s_cbranch_vccnz L_w30
L_C_x:
    buffer_load_dwordx4 v[40:43], v7, s[40:43], s50 offen sc1
    buffer_load_dwordx4 v[44:47], v7, s[40:43], s50 offen offset:1024 sc1
    s_sub_u32 s3, s3, 1
    s_cbranch_scc1 L_end
    s_waitcnt vmcnt(1)
    v_mfma_f32_16x16x32_bf16 v[24:27], v[20:23], v[40:43], 0
    s_waitcnt vmcnt(0)
    v_mfma_f32_16x16x32_bf16 v[28:31], v[20:23], v[44:47], 0
    v_max3_u32 v12, v40, v41, v42
    v_max3_u32 v12, v12, v43, v44
    v_max3_u32 v12, v12, v45, v46
    v_max_u32 v12, v12, v47
    v_cmp_eq_u32 vcc, -1, v12
    s_cbranch_vccnz L_C_x
    v_cvt_pk_bf16_f32 v24, v24, v24
    v_cvt_pk_bf16_f32 v25, v25, v25
    v_cvt_pk_bf16_f32 v26, v26, v26
    v_cvt_pk_bf16_f32 v27, v27, v27
    v_and_b32 v24, v24, v19
    v_and_b32 v25, v25, v19
    v_and_b32 v26, v26, v19
    v_and_b32 v27, v27, v19
    ds_write_b128 v18, v[24:27] offset:0
    v_cvt_pk_bf16_f32 v28, v28, v28
    v_cvt_pk_bf16_f32 v29, v29, v29
    v_cvt_pk_bf16_f32 v30, v30, v30
    v_cvt_pk_bf16_f32 v31, v31, v31
    v_and_b32 v28, v28, v19
    v_and_b32 v29, v29, v19
    v_and_b32 v30, v30, v19
    v_and_b32 v31, v31, v19
    ds_write_b128 v18, v[28:31] offset:256
    v_mov_b32 v6, 1
    s_mov_b64 exec, 1
    ds_add_u32 v0, v6 offset:6056
    s_mov_b64 exec, -1
    s_cmp_lt_u32 s33, 2
    s_cbranch_scc1 L_C_o2
    s_cmp_lg_u32 s33, 2
    s_cbranch_scc1 L_C_nh
    v_mov_b32 v12, 0
    s_mov_b64 exec, 1
    buffer_store_dword v12, v12, s[40:43], s60 offen sc1
    s_mov_b64 exec, -1
L_C_nh:
    s_branch L_end
L_C_o2:
L_w31:
    ds_read_b32 v6, v0 offset:6056
    s_sub_u32 s3, s3, 1
    s_cbranch_scc1 L_end
    s_waitcnt lgkmcnt(0)
    v_cmp_gt_u32 vcc, 4, v6
    s_cbranch_vccnz L_w31
    ds_read_b128 v[40:43], v3 offset:0
    ds_read_b128 v[44:47], v3 offset:64
    ds_read_b128 v[48:51], v3 offset:128
    ds_read_b128 v[52:55], v3 offset:192
    ds_read_b128 v[56:59], v3 offset:256
    ds_read_b128 v[60:63], v3 offset:320
    ds_read_b128 v[64:67], v3 offset:384
    ds_read_b128 v[68:71], v3 offset:448
    s_waitcnt lgkmcnt(7)
    v_mfma_f32_16x16x32_bf16 v[24:27], v[40:43], v[104:107], 0
    v_mfma_f32_16x16x32_bf16 v[28:31], v[40:43], v[108:111], 0
    s_waitcnt lgkmcnt(6)
    v_mfma_f32_16x16x32_bf16 v[24:27], v[44:47], v[112:115], v[24:27]
    v_mfma_f32_16x16x32_bf16 v[28:31], v[44:47], v[116:119], v[28:31]
    s_waitcnt lgkmcnt(5)
    v_mfma_f32_16x16x32_bf16 v[24:27], v[48:51], v[120:123], v[24:27]
    v_mfma_f32_16x16x32_bf16 v[28:31], v[48:51], v[124:127], v[28:31]
    s_waitcnt lgkmcnt(4)
    v_mfma_f32_16x16x32_bf16 v[24:27], v[52:55], v[128:131], v[24:27]
    v_mfma_f32_16x16x32_bf16 v[28:31], v[52:55], v[132:135], v[28:31]
    s_waitcnt lgkmcnt(3)
    v_mfma_f32_16x16x32_bf16 v[24:27], v[56:59], v[136:139], v[24:27]
    v_mfma_f32_16x16x32_bf16 v[28:31], v[56:59], v[140:143], v[28:31]
    s_waitcnt lgkmcnt(2)
    v_mfma_f32_16x16x32_bf16 v[24:27], v[60:63], v[144:147], v[24:27]
    v_mfma_f32_16x16x32_bf16 v[28:31], v[60:63], v[148:151], v[28:31]
    s_waitcnt lgkmcnt(1)
    v_mfma_f32_16x16x32_bf16 v[24:27], v[64:67], v[152:155], v[24:27]
    v_mfma_f32_16x16x32_bf16 v[28:31], v[64:67], v[156:159], v[28:31]
    s_waitcnt lgkmcnt(0)
    v_mfma_f32_16x16x32_bf16 v[24:27], v[68:71], v[160:163], v[24:27]
    v_mfma_f32_16x16x32_bf16 v[28:31], v[68:71], v[164:167], v[28:31]
    s_nop 6
    v_cvt_pk_bf16_f32 v8, v24, v25
    v_cvt_pk_bf16_f32 v10, v26, v27
    v_cvt_pk_bf16_f32 v9, v28, v29
    v_cvt_pk_bf16_f32 v11, v30, v31
    buffer_store_dwordx2 v[8:9], v4, s[40:43], s49 offen sc1
    buffer_store_dwordx2 v[10:11], v4, s[40:43], s51 offen sc1
L_end:
L_exit:
    s_endpgm
L_codeend:
.section .rodata,"a"
.p2align 6
.amdhsa_kernel adaLN_cond__compressed_kv_cla__dense_activation_relu__decode_kernel
.amdhsa_next_free_vgpr 168
.amdhsa_next_free_sgpr 102
.amdhsa_accum_offset 168
.amdhsa_group_segment_fixed_size 0
.amdhsa_kernarg_size 112
.amdhsa_user_sgpr_count 2
.amdhsa_user_sgpr_kernarg_segment_ptr 1
.amdhsa_system_sgpr_workgroup_id_x 1
.amdhsa_float_denorm_mode_32 3
.end_amdhsa_kernel
.text
```

```asm
; @launch grid=(256,1,1) block=(768,1,1) lds=163840
.amdgcn_target "amdgcn-amd-amdhsa--gfx950"
.text
.globl adaLN_cond__compressed_kv_cla__dense_activation_relu__decode_kernel
.p2align 8
.type adaLN_cond__compressed_kv_cla__dense_activation_relu__decode_kernel,@function
adaLN_cond__compressed_kv_cla__dense_activation_relu__decode_kernel:

    s_cmpk_ge_u32 s2, 256
    s_cbranch_scc1 L_exit
    s_load_dwordx16 s[4:19], s[0:1], 0
    s_load_dwordx8 s[20:27], s[0:1], 64
    s_load_dwordx4 s[28:31], s[0:1], 96
    v_lshrrev_b32 v2, 6, v0
    v_and_b32 v1, 63, v0
    v_readfirstlane_b32 s32, v2
    s_lshr_b32 s37, s2, 3
    s_getpc_b64 s[52:53]
L_pc:
    s_mul_i32 s38, s37, 12
    s_add_u32 s38, s38, s32
    s_lshl_b32 s38, s38, 7
    s_min_u32 s38, s38, L_codeend-L_pc-4
    v_mov_b32 v2, s38
    global_load_dword v167, v2, s[52:53]
    s_and_b32 s36, s2, 7
    s_and_b32 s34, s37, 7
    s_lshr_b32 s37, s37, 3
    s_lshl3_add_u32 s35, s37, s36
    s_and_b32 s33, s32, 3
    s_cmp_lt_u32 s32, 4
    s_cbranch_scc1 L_pA
    s_cmp_lt_u32 s32, 8
    s_cbranch_scc1 L_pB
    s_cmp_eq_u32 s34, 0
    s_cbranch_scc1 L_Cs
    s_branch L_Co
L_pB:
    s_cmp_lt_u32 s34, 4
    s_cbranch_scc1 L_Bc
    s_branch L_Be
L_pA:
    s_lshr_b32 s38, s34, 2
    s_or_b32 s38, s38, s32
    s_cbranch_scc0 L_pT
    s_lshl3_add_u32 s38, s32, s34
    s_cmp_lg_u32 s38, 8
    s_cbranch_scc1 L_A
    v_lshlrev_b32 v2, 7, v1
    s_waitcnt lgkmcnt(0)
    global_load_dword v166, v2, s[22:23]
    global_load_dword v166, v2, s[4:5]
    s_branch L_A
L_pT:
    v_and_b32 v3, 1, v1
    v_lshrrev_b32 v2, 1, v1
    s_lshl2_add_u32 s38, s37, s34
    v_lshl_add_u32 v2, s38, 5, v2
    v_mul_u32_u24 v2, 6, v2
    v_add_u32 v2, v2, v3
    s_lshl_b32 s39, s36, 7
    v_lshl_add_u32 v2, v2, 10, s39
    s_waitcnt lgkmcnt(0)
    global_load_dword v166, v2, s[24:25]

L_A:
    v_mov_b32 v8, -1
    v_mov_b32 v9, -1
    v_mov_b32 v10, -1
    v_mov_b32 v11, -1
    v_lshlrev_b32 v14, 4, v1
    s_waitcnt lgkmcnt(0)
    s_mov_b32 s40, s30
    s_mov_b32 s41, s31
    s_mov_b32 s42, 16777216
    s_mov_b32 s43, 0x20000

    s_mov_b32 s3, 0x400000
    v_mov_b32 v0, 156256
    s_and_b32 s62, s34, 3
    s_lshl2_add_u32 s97, s62, s37
    s_lshl4_add_u32 s61, s36, s97

    s_xor_b32 s98, s2, 40
    s_or_b32 s98, s98, s33
    s_cbranch_scc1 L_A_nx
    s_movk_i32 s39, 4096
    buffer_store_dwordx4 v[8:11], v14, s[40:43], 0 offen offset:0 sc1
    buffer_store_dwordx4 v[8:11], v14, s[40:43], 0 offen offset:1024 sc1
    buffer_store_dwordx4 v[8:11], v14, s[40:43], 0 offen offset:2048 sc1
    buffer_store_dwordx4 v[8:11], v14, s[40:43], 0 offen offset:3072 sc1
    buffer_store_dwordx4 v[8:11], v14, s[40:43], s39 offen offset:0 sc1
    buffer_store_dwordx4 v[8:11], v14, s[40:43], s39 offen offset:1024 sc1
    buffer_store_dwordx4 v[8:11], v14, s[40:43], s39 offen offset:2048 sc1
    buffer_store_dwordx4 v[8:11], v14, s[40:43], s39 offen offset:3072 sc1
L_A_nx:
    s_cmp_lg_u32 s34, 0
    s_cbranch_scc1 L_A_nc
    s_lshl2_add_u32 s55, s36, s37
    s_lshl2_add_u32 s38, s55, s33
    s_lshl_b32 s38, s38, 11
    s_add_u32 s38, s38, 65536
    buffer_store_dwordx4 v[8:11], v14, s[40:43], s38 offen offset:0 sc1
    buffer_store_dwordx4 v[8:11], v14, s[40:43], s38 offen offset:1024 sc1
L_A_nc:
    s_cmp_lg_u32 s33, 3
    s_cbranch_scc1 L_noinit
    v_mul_u32_u24 v13, 1008, v1
    v_mov_b32 v4, 0
    v_add_u32 v13, v13, v0
    v_mov_b32 v5, v4
    v_mov_b32 v6, v4
    v_mov_b32 v7, v4
    v_add_u32 v12, v14, v0
    s_mov_b64 exec, 0xff
    ds_write_b128 v13, v[4:7]
    s_mov_b32 exec_lo, -1
    ds_write_b128 v12, v[8:11] offset:7072
    s_mov_b64 exec, -1
L_noinit:
    s_cmp_lt_u32 s34, 4
    s_cbranch_scc1 L_AD
    s_mov_b32 s44, s6
    s_mov_b32 s45, s7
    s_mov_b32 s46, 33554432
    s_mov_b32 s47, 0x20000

    v_lshrrev_b32 v4, 3, v1
    v_bfe_u32 v5, v4, 1, 1
    v_lshlrev_b32 v5, 2, v5
    v_bfe_u32 v6, v4, 2, 1
    v_or_b32 v5, v5, v6
    v_and_b32 v6, 7, v1
    v_xor_b32 v5, v5, v6
    v_lshlrev_b32 v5, 4, v5
    v_lshl_add_u32 v2, v4, 10, v5
    v_xor_b32 v3, 32, v2
    s_lshl_b32 s48, s61, 18
    s_lshl_b32 s38, s33, 15
    s_add_u32 s48, s48, s38
    s_lshl_b32 s49, s33, 12
    s_mov_b32 s50, 0
    s_waitcnt lgkmcnt(0)
    s_barrier
    s_cmp_lg_u32 s98, 0
    s_cbranch_scc1 L_A_go
    s_mov_b64 exec, 1
    s_waitcnt vmcnt(0)
    global_store_dword v14, v8, s[28:29] sc1
    s_mov_b64 exec, -1
L_A_go:
L_w1:
    s_sleep 1
    ds_read_b32 v8, v0 offset:4
    s_sub_u32 s3, s3, 1
    s_cbranch_scc1 L_end
    s_waitcnt lgkmcnt(0)
    v_cmp_gt_u32 vcc, 4, v8
    s_cbranch_vccnz L_w1
    s_setprio 2
    s_lshl_b32 s38, s33, 2
    v_add_u32 v4, s38, v0
    v_mov_b32 v5, v0
    s_mov_b32 s53, 2
L_A_dma:
    s_and_b32 s38, s50, 9
    s_cmp_lg_u32 s38, 8
    s_cbranch_scc1 L_A_dma1
L_w2:
    ds_read_b32 v8, v5 offset:3024
    s_sub_u32 s3, s3, 1
    s_cbranch_scc1 L_end
    s_waitcnt lgkmcnt(0)
    v_cmp_gt_u32 vcc, 8, v8
    s_cbranch_vccnz L_w2
    v_add_u32 v5, 4, v5
    s_cmp_lg_u32 s50, 8
    s_cbranch_scc1 L_A_dma1
    s_add_u32 s48, s48, 130048
    s_sub_u32 s49, s49, 131072
L_A_dma1:
    s_cmp_lg_u32 s50, 9
    s_cbranch_scc1 L_A_dma2
    v_mov_b32 v8, 8
    s_waitcnt vmcnt(4)
    ds_write_b32 v4, v8 offset:4032
    v_mov_b32 v7, 9
    s_waitcnt vmcnt(0)
    ds_write_b32 v4, v7 offset:4032
L_w3:
    ds_read_b32 v8, v0 offset:2028
    s_sub_u32 s3, s3, 1
    s_cbranch_scc1 L_end
    s_waitcnt lgkmcnt(0)
    v_cmp_gt_u32 vcc, 4, v8
    s_cbranch_vccnz L_w3
    s_mov_b32 s53, 11
L_A_dma2:
    s_add_u32 m0, s49, 0
    s_add_u32 s38, s48, 0
    buffer_load_dwordx4 v2, s[44:47], s38 offen nt lds
    s_waitcnt vmcnt(7)
    s_add_u32 m0, s49, 1024
    s_add_u32 s38, s48, 8192
    buffer_load_dwordx4 v3, s[44:47], s38 offen nt lds
    s_waitcnt vmcnt(7)
    s_add_u32 m0, s49, 2048
    s_add_u32 s38, s48, 16384
    buffer_load_dwordx4 v2, s[44:47], s38 offen nt lds
    s_waitcnt vmcnt(7)
    s_add_u32 m0, s49, 3072
    s_add_u32 s38, s48, 24576
    buffer_load_dwordx4 v3, s[44:47], s38 offen nt lds
    s_waitcnt vmcnt(7)
    s_add_u32 s49, s49, 16384
    s_add_u32 s48, s48, 128
    s_add_u32 s50, s50, 1
    s_max_u32 s38, s50, s53
    s_sub_u32 s38, s38, 2
    v_mov_b32 v6, s38
    ds_write_b32 v4, v6 offset:4032
    s_cmp_lt_u32 s50, 16
    s_cbranch_scc1 L_A_dma
    s_cmp_lg_u32 s98, 0
    s_cbranch_scc1 L_A_n3
L_w4:
    s_sleep 1
    ds_read_b32 v12, v0 offset:1008
    s_sub_u32 s3, s3, 1
    s_cbranch_scc1 L_end
    s_waitcnt lgkmcnt(0)
    v_cmp_gt_u32 vcc, 4, v12
    s_cbranch_vccnz L_w4
    v_mov_b32 v12, 4
    s_mov_b64 exec, 1
    global_store_dword v12, v12, s[28:29] sc1
    s_mov_b64 exec, -1
L_A_n3:
    v_mov_b32 v8, 15
    s_waitcnt vmcnt(4)
    ds_write_b32 v4, v8 offset:4032
    v_mov_b32 v7, 16
    s_waitcnt vmcnt(0)
    ds_write_b32 v4, v7 offset:4032
    v_bfe_u32 v16, v1, 4, 1
    v_lshrrev_b32 v17, 5, v1
    v_lshl_add_u32 v16, v17, 2, v16
    v_lshlrev_b32 v16, 14, v16
    v_and_b32 v17, 15, v1
    v_lshl_add_u32 v16, v17, 4, v16
    s_lshl_b32 s55, s36, 19
    s_lshl2_add_u32 s38, s97, s33
    s_lshl_b32 s38, s38, 8
    s_add_u32 s55, s55, s38
    s_add_u32 s55, s55, 2097152
    v_mov_b32 v20, -1
    v_mov_b32 v21, -1
    v_mov_b32 v22, -1
    v_mov_b32 v23, -1
    s_add_u32 s38, s55, 0
    buffer_store_dwordx4 v[20:23], v16, s[40:43], s38 offen sc1
    s_add_u32 s38, s55, 32768
    buffer_store_dwordx4 v[20:23], v16, s[40:43], s38 offen sc1
    s_add_u32 s38, s55, 131072
    buffer_store_dwordx4 v[20:23], v16, s[40:43], s38 offen sc1
    s_add_u32 s38, s55, 163840
    buffer_store_dwordx4 v[20:23], v16, s[40:43], s38 offen sc1
    s_add_u32 s38, s55, 262144
    buffer_store_dwordx4 v[20:23], v16, s[40:43], s38 offen sc1
    s_add_u32 s38, s55, 294912
    buffer_store_dwordx4 v[20:23], v16, s[40:43], s38 offen sc1
    s_add_u32 s38, s55, 393216
    buffer_store_dwordx4 v[20:23], v16, s[40:43], s38 offen sc1
    s_add_u32 s38, s55, 425984
    buffer_store_dwordx4 v[20:23], v16, s[40:43], s38 offen sc1
    s_waitcnt vmcnt(0)
    v_mov_b32 v12, 1
    s_mov_b64 exec, 1
    ds_add_u32 v0, v12 offset:2024
    s_mov_b64 exec, -1
    s_setprio 0
    s_cmp_ge_u32 s35, 28
    s_cbranch_scc1 L_end

    v_and_b32 v9, 31, v1
    v_lshrrev_b32 v10, 5, v1
    v_and_b32 v3, 15, v1
    v_bfe_u32 v12, v1, 4, 1
    v_lshlrev_b32 v12, 1, v12
    v_and_b32 v13, 7, v1
    v_xor_b32 v12, v12, v13
    v_lshlrev_b32 v164, 4, v12
    v_lshrrev_b32 v165, 3, v1
    v_lshrrev_b32 v6, 4, v1
    v_bfe_u32 v12, v1, 2, 2
    v_lshl_add_u32 v13, v6, 3, v12
    v_lshrrev_b32 v14, 1, v12
    v_and_b32 v15, 1, v6
    v_lshl_or_b32 v14, v15, 1, v14
    v_lshlrev_b32 v14, 5, v14
    v_lshl_add_u32 v14, v13, 7, v14
    v_and_b32 v16, 3, v1
    v_lshl_add_u32 v14, v16, 3, v14
    s_lshl_b32 s38, s33, 14
    v_add_u32 v160, s38, v14
    v_xor_b32 v161, 32, v160
    v_xor_b32 v162, 64, v160
    v_xor_b32 v163, 0x60, v160
    v_lshl_or_b32 v14, v15, 2, v12
    v_lshlrev_b32 v14, 5, v14
    v_lshl_add_u32 v14, v13, 8, v14
    v_lshl_add_u32 v14, v16, 3, v14
    s_add_u32 s38, s38, 65536
    v_add_u32 v2, s38, v14

    v_and_b32 v16, 1, v1
    v_lshlrev_b32 v16, 4, v16
    s_mov_b32 s38, 0xffff
    v_lshlrev_b32 v16, v16, s38
    v_bfe_u32 v17, v1, 1, 2
    v_cmp_eq_u32 vcc, 0, v17
    s_nop 1
    v_cndmask_b32 v20, 0, v16, vcc
    v_cmp_eq_u32 vcc, 1, v17
    s_nop 1
    v_cndmask_b32 v21, 0, v16, vcc
    v_cmp_eq_u32 vcc, 2, v17
    s_nop 1
    v_cndmask_b32 v22, 0, v16, vcc
    v_cmp_eq_u32 vcc, 3, v17
    s_nop 1
    v_cndmask_b32 v23, 0, v16, vcc
L_w5:
    s_sleep 2
    ds_read_b32 v12, v0 offset:1012
    s_sub_u32 s3, s3, 1
    s_cbranch_scc1 L_end
    s_waitcnt lgkmcnt(0)
    v_cmp_gt_u32 vcc, 4, v12
    s_cbranch_vccnz L_w5
    s_mov_b32 s44, s18
    s_mov_b32 s45, s19
    s_mov_b32 s46, 1835008
    s_mov_b32 s47, 0x20000
    s_lshl_b32 s58, s35, 7

    v_mul_u32_u24 v12, 3584, v165
    v_add_u32 v12, v12, v164
    v_xor_b32 v13, 64, v12
    s_mul_i32 s38, s33, 458752
    s_add_u32 s58, s58, s38
    s_lshl_b32 s57, s33, 14
    s_add_u32 s57, s57, 0
    s_and_b32 s56, s34, 3
    s_mov_b32 s59, 0
L_A_f1:
    s_xor_b32 s38, s59, s56
    s_lshl_b32 s39, s38, 12
    s_add_u32 s39, s39, s57
    s_mul_i32 s38, s38, 114688
    s_add_u32 s38, s38, s58
    s_add_u32 m0, s39, 0
    s_add_u32 s60, s38, 0
    buffer_load_dwordx4 v12, s[44:47], s60 offen lds
    s_waitcnt vmcnt(6)
    s_add_u32 m0, s39, 1024
    s_add_u32 s60, s38, 28672
    buffer_load_dwordx4 v13, s[44:47], s60 offen lds
    s_waitcnt vmcnt(6)
    s_add_u32 m0, s39, 2048
    s_add_u32 s60, s38, 57344
    buffer_load_dwordx4 v12, s[44:47], s60 offen lds
    s_waitcnt vmcnt(6)
    s_add_u32 m0, s39, 3072
    s_add_u32 s60, s38, 86016
    buffer_load_dwordx4 v13, s[44:47], s60 offen lds
    s_waitcnt vmcnt(6)
    s_add_u32 s59, s59, 1
    s_cmp_lt_u32 s59, 4
    s_cbranch_scc1 L_A_f1

    s_mov_b32 s44, s20
    s_mov_b32 s45, s21
    v_lshlrev_b32 v12, 1, v6
    v_xor_b32 v12, v12, v3
    v_lshlrev_b32 v12, 4, v12
    v_lshl_add_u32 v12, v6, 10, v12
    v_xor_b32 v13, 0x80, v12
    s_lshl_b32 s58, s35, 16
    s_lshl_b32 s38, s33, 8
    s_add_u32 s58, s58, s38
    s_add_u32 s57, s57, 65536
    s_mov_b32 s59, 0
L_A_f2:
    s_xor_b32 s38, s59, s56
    s_lshl_b32 s39, s38, 12
    s_add_u32 s39, s39, s57
    s_lshl_b32 s38, s38, 14
    s_add_u32 s38, s38, s58
    s_add_u32 m0, s39, 0
    s_add_u32 s60, s38, 0
    buffer_load_dwordx4 v12, s[44:47], s60 offen lds
    s_waitcnt vmcnt(6)
    s_add_u32 m0, s39, 1024
    s_add_u32 s60, s38, 4096
    buffer_load_dwordx4 v12, s[44:47], s60 offen lds
    s_waitcnt vmcnt(6)
    s_add_u32 m0, s39, 2048
    s_add_u32 s60, s38, 8192
    buffer_load_dwordx4 v13, s[44:47], s60 offen lds
    s_waitcnt vmcnt(6)
    s_add_u32 m0, s39, 3072
    s_add_u32 s60, s38, 12288
    buffer_load_dwordx4 v13, s[44:47], s60 offen lds
    s_waitcnt vmcnt(6)
    s_add_u32 s59, s59, 1
    s_cmp_lt_u32 s59, 4
    s_cbranch_scc1 L_A_f2
    ds_read_b64_tr_b16 v[96:97], v160 offset:0
    ds_read_b64_tr_b16 v[98:99], v160 offset:512
    ds_read_b64_tr_b16 v[100:101], v161 offset:0
    ds_read_b64_tr_b16 v[102:103], v161 offset:512
    ds_read_b64_tr_b16 v[104:105], v162 offset:0
    ds_read_b64_tr_b16 v[106:107], v162 offset:512
    ds_read_b64_tr_b16 v[108:109], v163 offset:0
    ds_read_b64_tr_b16 v[110:111], v163 offset:512
    s_waitcnt lgkmcnt(6)
    ds_read_b64_tr_b16 v[112:113], v160 offset:4096
    ds_read_b64_tr_b16 v[114:115], v160 offset:4608
    ds_read_b64_tr_b16 v[116:117], v161 offset:4096
    ds_read_b64_tr_b16 v[118:119], v161 offset:4608
    ds_read_b64_tr_b16 v[120:121], v162 offset:4096
    ds_read_b64_tr_b16 v[122:123], v162 offset:4608
    ds_read_b64_tr_b16 v[124:125], v163 offset:4096
    ds_read_b64_tr_b16 v[126:127], v163 offset:4608
    s_waitcnt lgkmcnt(0)
    s_branch L_A_F
L_AD:
    s_cmp_eq_u32 s34, 0
    s_cbranch_scc1 L_AS
    s_waitcnt lgkmcnt(0)
    s_barrier
    s_branch L_AD0
L_AS:
    s_mov_b32 s44, s24
    s_mov_b32 s45, s25
    s_mov_b32 s46, 3145728
    s_mov_b32 s47, 0x20000

    v_lshrrev_b32 v2, 2, v1
    v_mul_u32_u24 v4, 6144, v2
    v_lshrrev_b32 v2, 5, v1
    v_bfe_u32 v5, v1, 1, 1
    v_xor_b32 v2, v2, v5
    v_lshl_add_u32 v4, v2, 10, v4
    v_and_b32 v2, 1, v1
    v_lshl_add_u32 v4, v2, 4, v4
    s_mul_i32 s58, s33, 786432
    s_lshl_b32 s39, s55, 5
    s_add_u32 s58, s58, s39
    s_lshl_b32 s59, s33, 13
    s_add_u32 m0, s59, 65536
    s_lshl_b32 s38, s33, 2
    v_add_u32 v5, s38, v0
    s_waitcnt lgkmcnt(0)
    s_barrier
    buffer_load_dwordx4 v4, s[44:47], s58 offen lds
    s_add_u32 m0, m0, 1024
    s_add_u32 s58, s58, 98304
    buffer_load_dwordx4 v4, s[44:47], s58 offen lds
    s_add_u32 m0, m0, 1024
    s_add_u32 s58, s58, 98304
    buffer_load_dwordx4 v4, s[44:47], s58 offen lds
    s_add_u32 m0, m0, 1024
    s_add_u32 s58, s58, 98304
    buffer_load_dwordx4 v4, s[44:47], s58 offen lds
    s_add_u32 m0, m0, 1024
    s_add_u32 s58, s58, 98304
    buffer_load_dwordx4 v4, s[44:47], s58 offen lds
    s_add_u32 m0, m0, 1024
    s_add_u32 s58, s58, 98304
    buffer_load_dwordx4 v4, s[44:47], s58 offen lds
    s_add_u32 m0, m0, 1024
    s_add_u32 s58, s58, 98304
    buffer_load_dwordx4 v4, s[44:47], s58 offen lds
    s_add_u32 m0, m0, 1024
    s_add_u32 s58, s58, 98304
    buffer_load_dwordx4 v4, s[44:47], s58 offen lds
    s_add_u32 m0, m0, 1024
    s_add_u32 s58, s58, 98304
    v_mov_b32 v6, 1
    s_waitcnt vmcnt(0)
    ds_write_b32 v5, v6 offset:4032
    v_mov_b32 v6, 1
    s_mov_b64 exec, 1
    ds_add_u32 v0, v6 offset:7056
    s_mov_b64 exec, -1
    s_cmp_lg_u32 s33, 1
    s_cbranch_scc1 L_AD0
    v_mov_b32 v4, 0
L_fl6:
    global_load_dword v5, v4, s[28:29] offset:0 sc1
    s_sub_u32 s3, s3, 1
    s_cbranch_scc1 L_end
    s_waitcnt vmcnt(0)
    v_cmp_eq_u32 vcc, 0, v5
    s_cbranch_vccnz L_fl6
L_w7:
    ds_read_b32 v8, v0 offset:7056
    s_sub_u32 s3, s3, 1
    s_cbranch_scc1 L_end
    s_waitcnt lgkmcnt(0)
    v_cmp_gt_u32 vcc, 4, v8
    s_cbranch_vccnz L_w7
    v_mov_b32 v8, 1
    s_mov_b64 exec, 1
    ds_add_u32 v0, v8 offset:2020
    s_mov_b64 exec, -1
L_AD0:
    s_mov_b32 s44, s6
    s_mov_b32 s45, s7
    s_mov_b32 s46, 33554432
    s_mov_b32 s47, 0x20000
    v_lshlrev_b32 v4, 10, v1
    s_lshl_b32 s51, s61, 18
    s_and_b32 s38, s33, 1
    s_lshl_b32 s38, s38, 16
    s_add_u32 s51, s51, s38
    s_lshr_b32 s38, s33, 1
    s_lshl_b32 s38, s38, 7
    s_add_u32 s51, s51, s38
    s_add_u32 s51, s51, 131072
L_w8:
    s_sleep 1
    ds_read_b32 v8, v0 offset:5044
    s_sub_u32 s3, s3, 1
    s_cbranch_scc1 L_end
    s_waitcnt lgkmcnt(0)
    v_cmp_gt_u32 vcc, 3, v8
    s_cbranch_vccnz L_w8
    s_cmp_lg_u32 s34, 0
    s_cbranch_scc1 L_AD_k1
    s_add_u32 s38, s51, 917504
    buffer_load_dword v166, v4, s[44:47], s38 offen offset:768
    s_waitcnt vmcnt(0)
    s_add_u32 s38, s51, 1966080
    buffer_load_dword v166, v4, s[44:47], s38 offen offset:768
    s_waitcnt vmcnt(0)
    s_add_u32 s38, s51, 3014656
    buffer_load_dword v166, v4, s[44:47], s38 offen offset:768
    s_waitcnt vmcnt(0)
L_AD_k1:
    s_add_u32 s38, s51, -131072
    buffer_load_dword v166, v4, s[44:47], s38 offen offset:768
    s_waitcnt vmcnt(0)
    buffer_load_dword v166, v4, s[44:47], s51 offen offset:256
    s_waitcnt vmcnt(0)
    buffer_load_dword v166, v4, s[44:47], s51 offen offset:512
    s_waitcnt vmcnt(0)
    buffer_load_dword v166, v4, s[44:47], s51 offen offset:768
    s_waitcnt vmcnt(0)
    v_mov_b32 v8, 1
    s_mov_b64 exec, 1
    ds_add_u32 v0, v8 offset:5048
    s_mov_b64 exec, -1
    s_cmp_lg_u32 s33, 0
    s_cbranch_scc1 L_AD1
    v_mov_b32 v4, 0
L_fl9:
    s_sleep 2
    global_load_dword v5, v4, s[28:29] offset:4 sc1
    s_sub_u32 s3, s3, 1
    s_cbranch_scc1 L_end
    s_waitcnt vmcnt(0)
    v_cmp_eq_u32 vcc, 0, v5
    s_cbranch_vccnz L_fl9
    v_mov_b32 v8, 1
    s_mov_b64 exec, 1
    ds_add_u32 v0, v8 offset:5052
    s_mov_b64 exec, -1
L_AD1:
    v_and_b32 v9, 31, v1
    v_lshrrev_b32 v10, 5, v1
    v_and_b32 v3, 15, v1
    v_lshrrev_b32 v6, 4, v1
    v_lshlrev_b32 v7, 12, v6
    v_lshl_add_u32 v7, v3, 4, v7
    v_and_b32 v5, 1, v6
    v_lshlrev_b32 v5, 6, v5
    v_add_lshl_u32 v5, v5, v3, 10
    s_lshl_b32 s38, s62, 8
    s_lshl_b32 s50, s33, 14
    s_lshl3_add_u32 s50, s35, s50
    s_add_u32 s50, s50, 1048576
    s_lshl_b32 s51, s33, 5
    s_add_u32 s51, s51, s35
    s_lshl_b32 s51, s51, 14
    s_add_u32 s51, s51, s38
    s_add_u32 s51, s51, 2097152
    s_add_u32 s52, s51, 2097152
    s_lshl_b32 s38, s33, 8
    s_add_u32 s38, s38, 139776
    v_lshl_add_u32 v24, v1, 2, s38
    v_bfe_u32 v16, v1, 3, 1
    v_lshlrev_b32 v16, 7, v16
    v_lshl_add_u32 v16, v6, 4, v16
    v_add_u32 v25, s38, v16
    v_bfe_u32 v16, v1, 4, 1
    v_lshlrev_b32 v16, 4, v16
    v_lshl_add_u32 v16, v3, 5, v16
    v_lshl_add_u32 v16, v10, 3, v16
    s_mul_i32 s38, s33, 1056
    s_add_u32 s38, s38, 141312
    v_add_u32 v26, s38, v16
    v_add_u32 v27, 4224, v26
    v_and_b32 v16, 1, v1
    v_lshlrev_b32 v16, 4, v16
    s_mov_b32 s38, 0xffff
    v_lshlrev_b32 v16, v16, s38
    v_bfe_u32 v17, v1, 1, 2
    v_cmp_eq_u32 vcc, 0, v17
    s_nop 1
    v_cndmask_b32 v20, 0, v16, vcc
    v_cmp_eq_u32 vcc, 1, v17
    s_nop 1
    v_cndmask_b32 v21, 0, v16, vcc
    v_cmp_eq_u32 vcc, 2, v17
    s_nop 1
    v_cndmask_b32 v22, 0, v16, vcc
    v_cmp_eq_u32 vcc, 3, v17
    s_nop 1
    v_cndmask_b32 v23, 0, v16, vcc
L_w10:
    s_sleep 1
    ds_read_b32 v12, v0 offset:5052
    s_sub_u32 s3, s3, 1
    s_cbranch_scc1 L_end
    s_waitcnt lgkmcnt(0)
    v_cmp_gt_u32 vcc, 1, v12
    s_cbranch_vccnz L_w10
L_w11:
    s_sleep 1
    ds_read_b32 v12, v0 offset:6060
    s_sub_u32 s3, s3, 1
    s_cbranch_scc1 L_end
    s_waitcnt lgkmcnt(0)
    v_cmp_gt_u32 vcc, 5, v12
    s_cbranch_vccnz L_w11
L_A_st1:
    buffer_load_dwordx2 v[12:13], v5, s[40:43], s50 offen sc1
    s_sub_u32 s3, s3, 1
    s_cbranch_scc1 L_end
    s_waitcnt vmcnt(0)
    v_max_u32 v14, v12, v13
    v_cmp_eq_u32 vcc, -1, v14
    s_cbranch_vccz L_A_st3
    s_mov_b64 exec, vcc
    s_branch L_A_st1
L_A_st3:
    s_mov_b64 exec, -1
    buffer_load_dwordx4 v[32:35], v7, s[40:43], s51 offen offset:0 sc1
    buffer_load_dwordx4 v[36:39], v7, s[40:43], s51 offen offset:1024 sc1
    buffer_load_dwordx4 v[40:43], v7, s[40:43], s51 offen offset:2048 sc1
    buffer_load_dwordx4 v[44:47], v7, s[40:43], s51 offen offset:3072 sc1
    buffer_load_dwordx4 v[48:51], v7, s[40:43], s52 offen offset:0 sc1
    buffer_load_dwordx4 v[52:55], v7, s[40:43], s52 offen offset:1024 sc1
    buffer_load_dwordx4 v[56:59], v7, s[40:43], s52 offen offset:2048 sc1
    buffer_load_dwordx4 v[60:63], v7, s[40:43], s52 offen offset:3072 sc1
    v_mov_b32 v14, v12
    s_nop 1
    v_max_f32_dpp v14, v14, v14 quad_perm:[1,0,3,2] row_mask:0xf bank_mask:0xf
    s_nop 1
    v_max_f32_dpp v14, v14, v14 quad_perm:[2,3,0,1] row_mask:0xf bank_mask:0xf
    s_nop 1
    v_max_f32_dpp v14, v14, v14 row_half_mirror row_mask:0xf bank_mask:0xf
    s_nop 1
    v_max_f32_dpp v14, v14, v14 row_mirror row_mask:0xf bank_mask:0xf
    v_sub_f32 v12, v12, v14
    v_exp_f32 v12, v12
    s_nop 0
    v_mul_f32 v14, v12, v13
    s_nop 1
    v_add_f32_dpp v14, v14, v14 quad_perm:[1,0,3,2] row_mask:0xf bank_mask:0xf
    s_nop 1
    v_add_f32_dpp v14, v14, v14 quad_perm:[2,3,0,1] row_mask:0xf bank_mask:0xf
    s_nop 1
    v_add_f32_dpp v14, v14, v14 row_half_mirror row_mask:0xf bank_mask:0xf
    s_nop 1
    v_add_f32_dpp v14, v14, v14 row_mirror row_mask:0xf bank_mask:0xf
    v_rcp_f32 v14, v14
    v_cmp_gt_u32 vcc, 32, v1
    v_mul_f32 v12, v12, v14
    v_cvt_pk_bf16_f32 v13, v12, v12
    v_and_b32 v14, 0xffff0000, v13
    v_sub_f32 v12, v12, v14
    v_cvt_pk_bf16_f32 v12, v12, v12
    v_cndmask_b32 v12, v12, v13, vcc
    ds_write_b32 v24, v12
    ds_read_b128 v[12:15], v25
    ds_read_b128 v[16:19], v25 offset:64
    s_waitcnt lgkmcnt(0)
    v_and_b32 v64, v12, v20
    v_and_b32 v65, v12, v21
    v_and_b32 v66, v12, v22
    v_and_b32 v67, v12, v23
    v_and_b32 v68, v13, v20
    v_and_b32 v69, v13, v21
    v_and_b32 v70, v13, v22
    v_and_b32 v71, v13, v23
    v_and_b32 v72, v14, v20
    v_and_b32 v73, v14, v21
    v_and_b32 v74, v14, v22
    v_and_b32 v75, v14, v23
    v_and_b32 v76, v15, v20
    v_and_b32 v77, v15, v21
    v_and_b32 v78, v15, v22
    v_and_b32 v79, v15, v23
    v_and_b32 v80, v16, v20
    v_and_b32 v81, v16, v21
    v_and_b32 v82, v16, v22
    v_and_b32 v83, v16, v23
    v_and_b32 v84, v17, v20
    v_and_b32 v85, v17, v21
    v_and_b32 v86, v17, v22
    v_and_b32 v87, v17, v23
    v_and_b32 v88, v18, v20
    v_and_b32 v89, v18, v21
    v_and_b32 v90, v18, v22
    v_and_b32 v91, v18, v23
    v_and_b32 v92, v19, v20
    v_and_b32 v93, v19, v21
    v_and_b32 v94, v19, v22
    v_and_b32 v95, v19, v23
    s_waitcnt vmcnt(4)
L_h3_c0:
    v_mfma_f32_16x16x32_bf16 v[28:31], v[64:67], v[32:35], 0
    v_mfma_f32_16x16x32_bf16 v[28:31], v[68:71], v[36:39], v[28:31]
    v_mfma_f32_16x16x32_bf16 v[28:31], v[72:75], v[40:43], v[28:31]
    v_mfma_f32_16x16x32_bf16 v[28:31], v[76:79], v[44:47], v[28:31]
    v_max3_u32 v12, v32, v33, v34
    v_max3_u32 v12, v12, v35, v36
    v_max3_u32 v12, v12, v37, v38
    v_max3_u32 v12, v12, v39, v40
    v_max3_u32 v12, v12, v41, v42
    v_max3_u32 v12, v12, v43, v44
    v_max3_u32 v12, v12, v45, v46
    v_max_u32 v12, v12, v47
    v_cmp_eq_u32 vcc, -1, v12
    s_cbranch_vccnz L_h3_r0
    s_waitcnt vmcnt(0)
L_h3_c1:
    v_mfma_f32_16x16x32_bf16 v[96:99], v[80:83], v[48:51], 0
    v_mfma_f32_16x16x32_bf16 v[96:99], v[84:87], v[52:55], v[96:99]
    v_mfma_f32_16x16x32_bf16 v[96:99], v[88:91], v[56:59], v[96:99]
    v_mfma_f32_16x16x32_bf16 v[96:99], v[92:95], v[60:63], v[96:99]
    v_max3_u32 v12, v48, v49, v50
    v_max3_u32 v12, v12, v51, v52
    v_max3_u32 v12, v12, v53, v54
    v_max3_u32 v12, v12, v55, v56
    v_max3_u32 v12, v12, v57, v58
    v_max3_u32 v12, v12, v59, v60
    v_max3_u32 v12, v12, v61, v62
    v_max_u32 v12, v12, v63
    v_cmp_eq_u32 vcc, -1, v12
    s_cbranch_vccnz L_h3_r1
    v_permlane32_swap_b32 v28, v30
    v_permlane32_swap_b32 v29, v31
    v_add_f32 v28, v28, v30
    v_add_f32 v29, v29, v31
    v_cvt_pk_bf16_f32 v12, v28, 0
    v_cvt_pk_bf16_f32 v13, v29, 0
    v_cvt_pk_bf16_f32 v14, 0, v28
    v_cvt_pk_bf16_f32 v15, 0, v29
    ds_write2_b64 v26, v[12:13], v[14:15] offset0:0 offset1:66
    v_permlane32_swap_b32 v96, v98
    v_permlane32_swap_b32 v97, v99
    v_add_f32 v96, v96, v98
    v_add_f32 v97, v97, v99
    v_cvt_pk_bf16_f32 v16, v96, 0
    v_cvt_pk_bf16_f32 v17, v97, 0
    v_cvt_pk_bf16_f32 v18, 0, v96
    v_cvt_pk_bf16_f32 v19, 0, v97
    ds_write2_b64 v27, v[16:17], v[18:19] offset0:0 offset1:66
    v_mov_b32 v28, 1
    s_mov_b64 exec, 1
    ds_add_u32 v0, v28 offset:6048
    s_mov_b64 exec, -1
    s_cmp_lg_u32 s35, s33
    s_cbranch_scc1 L_end
    s_waitcnt lgkmcnt(0)
L_A_F:
    s_mov_b32 s44, s4
    s_mov_b32 s45, s5
    s_mov_b32 s46, 8192
    s_mov_b32 s47, 0x20000

    v_bfe_u32 v17, v1, 3, 1
    v_cmp_eq_u32 vcc, v17, v10
    v_mov_b32 v12, 0x3f803f80
    s_nop 0
    v_cndmask_b32 v12, 0, v12, vcc
    v_and_b32 v20, v12, v20
    v_and_b32 v21, v12, v21
    v_and_b32 v22, v12, v22
    v_and_b32 v23, v12, v23
    v_and_b32 v12, 1, v6
    v_lshlrev_b32 v13, 3, v12
    v_lshl_add_u32 v13, v3, 4, v13
    v_lshl_add_u32 v16, v10, 12, v13
    s_lshl_b32 s38, s62, 10
    s_lshl_b32 s39, s33, 8
    s_add_u32 s48, s38, s39
    buffer_load_dwordx2 v[128:129], v16, s[44:47], s48 offen
L_A_md:
    s_add_u32 s49, s48, 1179648
    buffer_load_dwordx2 v[32:33], v16, s[40:43], s49 offen sc1
    s_add_u32 s49, s49, 8192
    buffer_load_dwordx2 v[34:35], v16, s[40:43], s49 offen sc1
    s_add_u32 s49, s49, 8192
    buffer_load_dwordx2 v[36:37], v16, s[40:43], s49 offen sc1
    s_add_u32 s49, s49, 8192
    buffer_load_dwordx2 v[38:39], v16, s[40:43], s49 offen sc1
    s_add_u32 s49, s49, 8192
    buffer_load_dwordx2 v[40:41], v16, s[40:43], s49 offen sc1
    s_add_u32 s49, s49, 8192
    buffer_load_dwordx2 v[42:43], v16, s[40:43], s49 offen sc1
    s_add_u32 s49, s49, 8192
    buffer_load_dwordx2 v[44:45], v16, s[40:43], s49 offen sc1
    s_add_u32 s49, s49, 8192
    buffer_load_dwordx2 v[46:47], v16, s[40:43], s49 offen sc1
    s_add_u32 s49, s49, 8192
    buffer_load_dwordx2 v[48:49], v16, s[40:43], s49 offen sc1
    s_add_u32 s49, s49, 8192
    buffer_load_dwordx2 v[50:51], v16, s[40:43], s49 offen sc1
    s_add_u32 s49, s49, 8192
    buffer_load_dwordx2 v[52:53], v16, s[40:43], s49 offen sc1
    s_add_u32 s49, s49, 8192
    buffer_load_dwordx2 v[54:55], v16, s[40:43], s49 offen sc1
    s_add_u32 s49, s49, 8192
    buffer_load_dwordx2 v[56:57], v16, s[40:43], s49 offen sc1
    s_add_u32 s49, s49, 8192
    buffer_load_dwordx2 v[58:59], v16, s[40:43], s49 offen sc1
    s_add_u32 s49, s49, 8192
    buffer_load_dwordx2 v[60:61], v16, s[40:43], s49 offen sc1
    s_add_u32 s49, s49, 8192
    buffer_load_dwordx2 v[62:63], v16, s[40:43], s49 offen sc1
    s_sub_u32 s3, s3, 1
    s_cbranch_scc1 L_end
    s_waitcnt vmcnt(0)
    v_max3_u32 v15, v32, v33, v34
    v_max3_u32 v15, v15, v35, v36
    v_max3_u32 v15, v15, v37, v38
    v_max3_u32 v15, v15, v39, v40
    v_max3_u32 v15, v15, v41, v42
    v_max3_u32 v15, v15, v43, v44
    v_max3_u32 v15, v15, v45, v46
    v_max3_u32 v15, v15, v47, v48
    v_max3_u32 v15, v15, v49, v50
    v_max3_u32 v15, v15, v51, v52
    v_max3_u32 v15, v15, v53, v54
    v_max3_u32 v15, v15, v55, v56
    v_max3_u32 v15, v15, v57, v58
    v_max3_u32 v15, v15, v59, v60
    v_max3_u32 v15, v15, v61, v62
    v_max_u32 v15, v15, v63
    v_cmp_eq_u32 vcc, -1, v15
    s_cbranch_vccz L_A_md1
    s_sleep 4
    s_branch L_A_md
L_A_md1:
    v_lshlrev_b32 v140, 16, v128
    v_and_b32 v141, 0xffff0000, v128
    v_lshlrev_b32 v142, 16, v129
    v_and_b32 v143, 0xffff0000, v129
    v_lshlrev_b32 v144, 16, v32
    v_and_b32 v145, 0xffff0000, v32
    v_lshlrev_b32 v146, 16, v33
    v_and_b32 v147, 0xffff0000, v33
    v_lshlrev_b32 v14, 16, v34
    v_and_b32 v15, 0xffff0000, v34
    v_pk_add_f32 v[144:145], v[144:145], v[14:15]
    v_lshlrev_b32 v14, 16, v35
    v_and_b32 v15, 0xffff0000, v35
    v_pk_add_f32 v[146:147], v[146:147], v[14:15]
    v_lshlrev_b32 v14, 16, v36
    v_and_b32 v15, 0xffff0000, v36
    v_pk_add_f32 v[144:145], v[144:145], v[14:15]
    v_lshlrev_b32 v14, 16, v37
    v_and_b32 v15, 0xffff0000, v37
    v_pk_add_f32 v[146:147], v[146:147], v[14:15]
    v_lshlrev_b32 v14, 16, v38
    v_and_b32 v15, 0xffff0000, v38
    v_pk_add_f32 v[144:145], v[144:145], v[14:15]
    v_lshlrev_b32 v14, 16, v39
    v_and_b32 v15, 0xffff0000, v39
    v_pk_add_f32 v[146:147], v[146:147], v[14:15]
    v_lshlrev_b32 v148, 16, v40
    v_and_b32 v149, 0xffff0000, v40
    v_lshlrev_b32 v150, 16, v41
    v_and_b32 v151, 0xffff0000, v41
    v_lshlrev_b32 v14, 16, v42
    v_and_b32 v15, 0xffff0000, v42
    v_pk_add_f32 v[148:149], v[148:149], v[14:15]
    v_lshlrev_b32 v14, 16, v43
    v_and_b32 v15, 0xffff0000, v43
    v_pk_add_f32 v[150:151], v[150:151], v[14:15]
    v_lshlrev_b32 v14, 16, v44
    v_and_b32 v15, 0xffff0000, v44
    v_pk_add_f32 v[148:149], v[148:149], v[14:15]
    v_lshlrev_b32 v14, 16, v45
    v_and_b32 v15, 0xffff0000, v45
    v_pk_add_f32 v[150:151], v[150:151], v[14:15]
    v_lshlrev_b32 v14, 16, v46
    v_and_b32 v15, 0xffff0000, v46
    v_pk_add_f32 v[148:149], v[148:149], v[14:15]
    v_lshlrev_b32 v14, 16, v47
    v_and_b32 v15, 0xffff0000, v47
    v_pk_add_f32 v[150:151], v[150:151], v[14:15]
    v_lshlrev_b32 v152, 16, v48
    v_and_b32 v153, 0xffff0000, v48
    v_lshlrev_b32 v154, 16, v49
    v_and_b32 v155, 0xffff0000, v49
    v_lshlrev_b32 v14, 16, v50
    v_and_b32 v15, 0xffff0000, v50
    v_pk_add_f32 v[152:153], v[152:153], v[14:15]
    v_lshlrev_b32 v14, 16, v51
    v_and_b32 v15, 0xffff0000, v51
    v_pk_add_f32 v[154:155], v[154:155], v[14:15]
    v_lshlrev_b32 v14, 16, v52
    v_and_b32 v15, 0xffff0000, v52
    v_pk_add_f32 v[152:153], v[152:153], v[14:15]
    v_lshlrev_b32 v14, 16, v53
    v_and_b32 v15, 0xffff0000, v53
    v_pk_add_f32 v[154:155], v[154:155], v[14:15]
    v_lshlrev_b32 v14, 16, v54
    v_and_b32 v15, 0xffff0000, v54
    v_pk_add_f32 v[152:153], v[152:153], v[14:15]
    v_lshlrev_b32 v14, 16, v55
    v_and_b32 v15, 0xffff0000, v55
    v_pk_add_f32 v[154:155], v[154:155], v[14:15]
    v_lshlrev_b32 v156, 16, v56
    v_and_b32 v157, 0xffff0000, v56
    v_lshlrev_b32 v158, 16, v57
    v_and_b32 v159, 0xffff0000, v57
    v_lshlrev_b32 v14, 16, v58
    v_and_b32 v15, 0xffff0000, v58
    v_pk_add_f32 v[156:157], v[156:157], v[14:15]
    v_lshlrev_b32 v14, 16, v59
    v_and_b32 v15, 0xffff0000, v59
    v_pk_add_f32 v[158:159], v[158:159], v[14:15]
    v_lshlrev_b32 v14, 16, v60
    v_and_b32 v15, 0xffff0000, v60
    v_pk_add_f32 v[156:157], v[156:157], v[14:15]
    v_lshlrev_b32 v14, 16, v61
    v_and_b32 v15, 0xffff0000, v61
    v_pk_add_f32 v[158:159], v[158:159], v[14:15]
    v_lshlrev_b32 v14, 16, v62
    v_and_b32 v15, 0xffff0000, v62
    v_pk_add_f32 v[156:157], v[156:157], v[14:15]
    v_lshlrev_b32 v14, 16, v63
    v_and_b32 v15, 0xffff0000, v63
    v_pk_add_f32 v[158:159], v[158:159], v[14:15]
    v_add_f32 v152, 1.0, v152
    v_add_f32 v153, 1.0, v153
    v_add_f32 v154, 1.0, v154
    v_add_f32 v155, 1.0, v155

    s_lshl_b32 s53, s62, 15
    s_add_u32 s53, s53, s39
    s_add_u32 s56, s53, 1572864
    s_add_u32 s53, s53, 1310720
    s_and_b32 s38, s35, 24
    s_lshl_b32 s38, s38, 9
    s_add_u32 s56, s56, s38
    s_xor_b32 s57, s56, 4096
    s_xor_b32 s58, s56, 8192
    s_xor_b32 s59, s56, 12288
    v_lshlrev_b32 v5, 17, v10
    v_lshl_add_u32 v5, v3, 4, v5
    v_lshl_add_u32 v7, v12, 14, v5
    s_add_u32 s38, s39, 141312
    v_lshl_add_u32 v24, v10, 10, v13
    v_add_u32 v24, s38, v24
    v_lshlrev_b32 v15, 10, v17
    v_lshl_add_u32 v16, v6, 4, v15
    v_add_u32 v25, s38, v16
    s_add_u32 s38, s39, 143360
    v_add_u32 v27, s38, v16
    s_lshl_b32 s38, s33, 2
    s_add_u32 s38, s38, 149504
    v_lshl_add_u32 v26, v6, 4, s38
    v_lshlrev_b32 v8, 5, v10
    v_add_u32 v8, 149504, v8
    v_bfe_u32 v16, v1, 2, 1
    v_lshl_add_u32 v15, v16, 9, v15
    v_mul_u32_u24 v16, 3, v16
    v_xor_b32 v16, v16, v1
    v_bfe_u32 v18, v16, 1, 1
    v_lshl_add_u32 v15, v18, 7, v15
    v_and_b32 v18, 1, v16
    v_lshl_add_u32 v15, v18, 4, v15
    v_lshl_add_u32 v15, v6, 5, v15
    v_add_u32 v4, 143360, v15
    s_lshl_b32 s60, s33, 15
    s_add_u32 s60, s60, 1339392
    v_lshlrev_b32 v13, 7, v9
    s_mov_b32 exec_hi, 0
L_A_hint1:
    buffer_load_dword v12, v13, s[40:43], s60 offen sc1
    s_sub_u32 s3, s3, 1
    s_cbranch_scc1 L_end
    s_waitcnt vmcnt(0)
    v_cmp_eq_u32 vcc, -1, v12
    s_mov_b64 exec, vcc
    s_cbranch_vccnz L_A_hint1
    s_mov_b64 exec, -1
    buffer_load_dwordx4 v[32:35], v7, s[40:43], s56 offen offset:0 sc1
    buffer_load_dwordx4 v[36:39], v7, s[40:43], s56 offen offset:1024 sc1
    buffer_load_dwordx4 v[40:43], v7, s[40:43], s56 offen offset:2048 sc1
    buffer_load_dwordx4 v[44:47], v7, s[40:43], s56 offen offset:3072 sc1
    buffer_load_dwordx4 v[48:51], v7, s[40:43], s57 offen offset:0 sc1
    buffer_load_dwordx4 v[52:55], v7, s[40:43], s57 offen offset:1024 sc1
    buffer_load_dwordx4 v[56:59], v7, s[40:43], s57 offen offset:2048 sc1
    buffer_load_dwordx4 v[60:63], v7, s[40:43], s57 offen offset:3072 sc1
    buffer_load_dwordx4 v[64:67], v7, s[40:43], s58 offen offset:0 sc1
    buffer_load_dwordx4 v[68:71], v7, s[40:43], s58 offen offset:1024 sc1
    buffer_load_dwordx4 v[72:75], v7, s[40:43], s58 offen offset:2048 sc1
    buffer_load_dwordx4 v[76:79], v7, s[40:43], s58 offen offset:3072 sc1
    buffer_load_dwordx4 v[80:83], v7, s[40:43], s59 offen offset:0 sc1
    buffer_load_dwordx4 v[84:87], v7, s[40:43], s59 offen offset:1024 sc1
    buffer_load_dwordx4 v[88:91], v7, s[40:43], s59 offen offset:2048 sc1
    buffer_load_dwordx4 v[92:95], v7, s[40:43], s59 offen offset:3072 sc1
    s_waitcnt vmcnt(12)
L_h4_c0:
    v_max3_u32 v12, v32, v33, v34
    v_max3_u32 v12, v12, v35, v36
    v_max3_u32 v12, v12, v37, v38
    v_max3_u32 v12, v12, v39, v40
    v_max3_u32 v12, v12, v41, v42
    v_max3_u32 v12, v12, v43, v44
    v_max3_u32 v12, v12, v45, v46
    v_max_u32 v12, v12, v47
    v_cmp_eq_u32 vcc, -1, v12
    s_cbranch_vccnz L_h4_r0
    v_mfma_f32_16x16x32_bf16 v[28:31], v[20:23], v[32:35], 0
    v_mfma_f32_16x16x32_bf16 v[28:31], v[20:23], v[36:39], v[28:31]
    v_mfma_f32_16x16x32_bf16 v[28:31], v[20:23], v[40:43], v[28:31]
    v_mfma_f32_16x16x32_bf16 v[28:31], v[20:23], v[44:47], v[28:31]
    s_waitcnt vmcnt(8)
L_h4_c1:
    v_max3_u32 v12, v48, v49, v50
    v_max3_u32 v12, v12, v51, v52
    v_max3_u32 v12, v12, v53, v54
    v_max3_u32 v12, v12, v55, v56
    v_max3_u32 v12, v12, v57, v58
    v_max3_u32 v12, v12, v59, v60
    v_max3_u32 v12, v12, v61, v62
    v_max_u32 v12, v12, v63
    v_cmp_eq_u32 vcc, -1, v12
    s_cbranch_vccnz L_h4_r1
    v_mfma_f32_16x16x32_bf16 v[28:31], v[20:23], v[48:51], v[28:31]
    v_mfma_f32_16x16x32_bf16 v[28:31], v[20:23], v[52:55], v[28:31]
    v_mfma_f32_16x16x32_bf16 v[28:31], v[20:23], v[56:59], v[28:31]
    v_mfma_f32_16x16x32_bf16 v[28:31], v[20:23], v[60:63], v[28:31]
    s_waitcnt vmcnt(4)
L_h4_c2:
    v_max3_u32 v12, v64, v65, v66
    v_max3_u32 v12, v12, v67, v68
    v_max3_u32 v12, v12, v69, v70
    v_max3_u32 v12, v12, v71, v72
    v_max3_u32 v12, v12, v73, v74
    v_max3_u32 v12, v12, v75, v76
    v_max3_u32 v12, v12, v77, v78
    v_max_u32 v12, v12, v79
    v_cmp_eq_u32 vcc, -1, v12
    s_cbranch_vccnz L_h4_r2
    v_mfma_f32_16x16x32_bf16 v[28:31], v[20:23], v[64:67], v[28:31]
    v_mfma_f32_16x16x32_bf16 v[28:31], v[20:23], v[68:71], v[28:31]
    v_mfma_f32_16x16x32_bf16 v[28:31], v[20:23], v[72:75], v[28:31]
    v_mfma_f32_16x16x32_bf16 v[28:31], v[20:23], v[76:79], v[28:31]
    s_waitcnt vmcnt(0)
L_h4_c3:
    v_max3_u32 v12, v80, v81, v82
    v_max3_u32 v12, v12, v83, v84
    v_max3_u32 v12, v12, v85, v86
    v_max3_u32 v12, v12, v87, v88
    v_max3_u32 v12, v12, v89, v90
    v_max3_u32 v12, v12, v91, v92
    v_max3_u32 v12, v12, v93, v94
    v_max_u32 v12, v12, v95
    v_cmp_eq_u32 vcc, -1, v12
    s_cbranch_vccnz L_h4_r3
    v_mfma_f32_16x16x32_bf16 v[28:31], v[20:23], v[80:83], v[28:31]
    v_mfma_f32_16x16x32_bf16 v[28:31], v[20:23], v[84:87], v[28:31]
    v_mfma_f32_16x16x32_bf16 v[28:31], v[20:23], v[88:91], v[28:31]
    v_mfma_f32_16x16x32_bf16 v[28:31], v[20:23], v[92:95], v[28:31]
    s_nop 7
    v_fma_f32 v28, v28, v144, v140
    v_fma_f32 v29, v29, v145, v141
    v_fma_f32 v30, v30, v146, v142
    v_fma_f32 v31, v31, v147, v143
    s_cmp_lt_u32 s34, 4
    s_cbranch_scc1 L_A_fin
    ds_read_b64_tr_b16 v[64:65], v160 offset:8192
    ds_read_b64_tr_b16 v[66:67], v160 offset:8704
    ds_read_b64_tr_b16 v[68:69], v161 offset:8192
    ds_read_b64_tr_b16 v[70:71], v161 offset:8704
    ds_read_b64_tr_b16 v[72:73], v162 offset:8192
    ds_read_b64_tr_b16 v[74:75], v162 offset:8704
    ds_read_b64_tr_b16 v[76:77], v163 offset:8192
    ds_read_b64_tr_b16 v[78:79], v163 offset:8704

    v_add_f32 v12, v28, v29
    v_mul_f32 v13, v28, v28
    v_add_f32 v14, v30, v31
    v_fmac_f32 v13, v29, v29
    v_add_f32 v12, v12, v14
    v_fmac_f32 v13, v30, v30
    v_fmac_f32 v13, v31, v31
    s_nop 1
    v_permlane16_swap_b32 v12, v13
    v_add_f32 v12, v12, v13
    s_nop 1
    v_add_f32_dpp v12, v12, v12 quad_perm:[1,0,3,2] row_mask:0xf bank_mask:0xf
    s_nop 1
    v_add_f32_dpp v12, v12, v12 quad_perm:[2,3,0,1] row_mask:0xf bank_mask:0xf
    s_nop 1
    v_add_f32_dpp v12, v12, v12 row_half_mirror row_mask:0xf bank_mask:0xf
    s_nop 1
    v_add_f32_dpp v12, v12, v12 row_mirror row_mask:0xf bank_mask:0xf
    ds_write_b32 v26, v12
    ds_read_b64_tr_b16 v[80:81], v160 offset:12288
    ds_read_b64_tr_b16 v[82:83], v160 offset:12800
    ds_read_b64_tr_b16 v[84:85], v161 offset:12288
    ds_read_b64_tr_b16 v[86:87], v161 offset:12800
    ds_read_b64_tr_b16 v[88:89], v162 offset:12288
    ds_read_b64_tr_b16 v[90:91], v162 offset:12800
    ds_read_b64_tr_b16 v[92:93], v163 offset:12288
    ds_read_b64_tr_b16 v[94:95], v163 offset:12800
L_A_ln:
    ds_read_b128 v[12:15], v8
    ds_read_b128 v[16:19], v8 offset:16
    s_sub_u32 s3, s3, 1
    s_cbranch_scc1 L_end
    s_waitcnt lgkmcnt(0)
    v_max3_u32 v32, v12, v13, v14
    v_max3_u32 v32, v32, v15, v16
    v_max3_u32 v32, v32, v17, v18
    v_max_u32 v32, v32, v19
    v_cmp_eq_u32 vcc, -1, v32
    s_cbranch_vccnz L_A_ln
    v_add_f32 v12, v12, v13
    v_add_f32 v16, v16, v17
    v_add_f32 v14, v14, v15
    v_add_f32 v18, v18, v19
    s_mov_b32 s38, 0x3b000000
    v_add_f32 v12, v12, v14
    v_add_f32 v16, v16, v18
    v_mul_f32 v12, s38, v12
    v_mul_f32 v16, s38, v16
    v_fma_f32 v16, -v12, v12, v16
    v_max_f32 v16, 0, v16
    v_add_f32 v16, 0x3727c5ac, v16
    v_rsq_f32 v16, v16
    v_sub_f32 v28, v28, v12
    v_sub_f32 v29, v29, v12
    v_sub_f32 v30, v30, v12
    v_sub_f32 v31, v31, v12
    v_mul_f32 v152, v152, v16
    v_mul_f32 v153, v153, v16
    v_mul_f32 v154, v154, v16
    v_mul_f32 v155, v155, v16
    v_fma_f32 v28, v28, v152, v148
    v_fma_f32 v29, v29, v153, v149
    v_fma_f32 v30, v30, v154, v150
    v_fma_f32 v31, v31, v155, v151
    v_cvt_pk_bf16_f32 v28, v28, v29
    v_cvt_pk_bf16_f32 v29, v30, v31
    ds_write_b64 v24, v[28:29]
    ds_read_b128 v[128:131], v25 offset:0
    ds_read_b128 v[132:135], v25 offset:64
    ds_read_b128 v[136:139], v25 offset:128
    ds_read_b128 v[140:143], v25 offset:192
    v_xor_b32 v13, 32, v2
    v_xor_b32 v14, 64, v2
    v_xor_b32 v15, 96, v2
    v_xor_b32 v16, 128, v2
    v_xor_b32 v17, 160, v2
    v_xor_b32 v18, 192, v2
    v_xor_b32 v19, 224, v2
    s_waitcnt lgkmcnt(3)
    v_mfma_f32_16x16x32_bf16 v[32:35], v[96:99], v[128:131], 0
    v_mfma_f32_16x16x32_bf16 v[36:39], v[100:103], v[128:131], 0
    v_mfma_f32_16x16x32_bf16 v[40:43], v[104:107], v[128:131], 0
    v_mfma_f32_16x16x32_bf16 v[44:47], v[108:111], v[128:131], 0
    s_waitcnt lgkmcnt(2)
    v_mfma_f32_16x16x32_bf16 v[32:35], v[112:115], v[132:135], v[32:35]
    v_mfma_f32_16x16x32_bf16 v[36:39], v[116:119], v[132:135], v[36:39]
    v_mfma_f32_16x16x32_bf16 v[40:43], v[120:123], v[132:135], v[40:43]
    v_mfma_f32_16x16x32_bf16 v[44:47], v[124:127], v[132:135], v[44:47]
    s_waitcnt lgkmcnt(1)
    v_mfma_f32_16x16x32_bf16 v[32:35], v[64:67], v[136:139], v[32:35]
    v_mfma_f32_16x16x32_bf16 v[36:39], v[68:71], v[136:139], v[36:39]
    v_mfma_f32_16x16x32_bf16 v[40:43], v[72:75], v[136:139], v[40:43]
    v_mfma_f32_16x16x32_bf16 v[44:47], v[76:79], v[136:139], v[44:47]
    s_waitcnt lgkmcnt(0)
    v_mfma_f32_16x16x32_bf16 v[32:35], v[80:83], v[140:143], v[32:35]
    v_mfma_f32_16x16x32_bf16 v[36:39], v[84:87], v[140:143], v[36:39]
    v_mfma_f32_16x16x32_bf16 v[40:43], v[88:91], v[140:143], v[40:43]
    v_mfma_f32_16x16x32_bf16 v[44:47], v[92:95], v[140:143], v[44:47]
    ds_read_b64_tr_b16 v[96:97], v2 offset:0
    ds_read_b64_tr_b16 v[98:99], v2 offset:1024
    ds_read_b64_tr_b16 v[100:101], v13 offset:0
    ds_read_b64_tr_b16 v[102:103], v13 offset:1024
    ds_read_b64_tr_b16 v[104:105], v14 offset:0
    ds_read_b64_tr_b16 v[106:107], v14 offset:1024
    ds_read_b64_tr_b16 v[108:109], v15 offset:0
    ds_read_b64_tr_b16 v[110:111], v15 offset:1024
    s_mov_b32 exec_lo, 0x01010101
    s_mov_b32 exec_hi, 0x01010101
    ds_write_b128 v27, v[32:35] offset:0
    ds_write_b128 v27, v[36:39] offset:64
    ds_write_b128 v27, v[40:43] offset:128
    ds_write_b128 v27, v[44:47] offset:192
    s_mov_b64 exec, -1
    v_mov_b32 v12, 1
    s_mov_b64 exec, 1
    ds_add_u32 v0, v12 offset:2016
    s_mov_b64 exec, -1
    s_waitcnt lgkmcnt(6)
    ds_read_b64_tr_b16 v[112:113], v16 offset:0
    ds_read_b64_tr_b16 v[114:115], v16 offset:1024
    ds_read_b64_tr_b16 v[116:117], v17 offset:0
    ds_read_b64_tr_b16 v[118:119], v17 offset:1024
    ds_read_b64_tr_b16 v[120:121], v18 offset:0
    ds_read_b64_tr_b16 v[122:123], v18 offset:1024
    ds_read_b64_tr_b16 v[124:125], v19 offset:0
    ds_read_b64_tr_b16 v[126:127], v19 offset:1024
    s_waitcnt lgkmcnt(4)
    ds_read_b64_tr_b16 v[64:65], v2 offset:8192
    ds_read_b64_tr_b16 v[66:67], v2 offset:9216
    ds_read_b64_tr_b16 v[68:69], v13 offset:8192
    ds_read_b64_tr_b16 v[70:71], v13 offset:9216
    ds_read_b64_tr_b16 v[72:73], v14 offset:8192
    ds_read_b64_tr_b16 v[74:75], v14 offset:9216
    ds_read_b64_tr_b16 v[76:77], v15 offset:8192
    ds_read_b64_tr_b16 v[78:79], v15 offset:9216
    s_waitcnt lgkmcnt(4)
    ds_read_b64_tr_b16 v[80:81], v16 offset:8192
    ds_read_b64_tr_b16 v[82:83], v16 offset:9216
    ds_read_b64_tr_b16 v[84:85], v17 offset:8192
    ds_read_b64_tr_b16 v[86:87], v17 offset:9216
    ds_read_b64_tr_b16 v[88:89], v18 offset:8192
    ds_read_b64_tr_b16 v[90:91], v18 offset:9216
    ds_read_b64_tr_b16 v[92:93], v19 offset:8192
    ds_read_b64_tr_b16 v[94:95], v19 offset:9216
L_w12:
    ds_read_b32 v12, v0 offset:2016
    s_sub_u32 s3, s3, 1
    s_cbranch_scc1 L_end
    s_waitcnt lgkmcnt(0)
    v_cmp_gt_u32 vcc, 4, v12
    s_cbranch_vccnz L_w12
    ds_read_b128 v[28:31], v4
    ds_read_b128 v[12:15], v4 offset:256
    s_waitcnt lgkmcnt(0)
    v_add_f32 v28, v28, v12
    v_add_f32 v29, v29, v13
    v_add_f32 v30, v30, v14
    v_add_f32 v31, v31, v15
    v_add_f32_dpp v28, v28, v28 row_half_mirror row_mask:0xf bank_mask:0xf
    v_add_f32_dpp v29, v29, v29 row_half_mirror row_mask:0xf bank_mask:0xf
    v_add_f32_dpp v30, v30, v30 row_half_mirror row_mask:0xf bank_mask:0xf
    v_add_f32_dpp v31, v31, v31 row_half_mirror row_mask:0xf bank_mask:0xf
    v_max_f32 v28, 0, v28
    v_max_f32 v29, 0, v29
    v_max_f32 v30, 0, v30
    v_max_f32 v31, 0, v31
    v_cvt_pk_bf16_f32 v28, v28, v29
    v_cvt_pk_bf16_f32 v29, v30, v31
    s_nop 0
    v_mov_b32_dpp v128, v28 row_newbcast:0 row_mask:0xf bank_mask:0x3
    v_mov_b32_dpp v129, v29 row_newbcast:0 row_mask:0xf bank_mask:0x3
    v_mov_b32_dpp v130, v28 row_newbcast:1 row_mask:0xf bank_mask:0x3
    v_mov_b32_dpp v131, v29 row_newbcast:1 row_mask:0xf bank_mask:0x3
    v_mov_b32_dpp v128, v28 row_newbcast:8 row_mask:0xf bank_mask:0xc
    v_mov_b32_dpp v129, v29 row_newbcast:8 row_mask:0xf bank_mask:0xc
    v_mov_b32_dpp v130, v28 row_newbcast:9 row_mask:0xf bank_mask:0xc
    v_mov_b32_dpp v131, v29 row_newbcast:9 row_mask:0xf bank_mask:0xc
    s_nop 1
    v_mfma_f32_16x16x32_bf16 v[32:35], v[128:131], v[96:99], 0
    v_mov_b32_dpp v132, v28 row_newbcast:2 row_mask:0xf bank_mask:0x3
    v_mov_b32_dpp v133, v29 row_newbcast:2 row_mask:0xf bank_mask:0x3
    v_mov_b32_dpp v134, v28 row_newbcast:3 row_mask:0xf bank_mask:0x3
    v_mov_b32_dpp v135, v29 row_newbcast:3 row_mask:0xf bank_mask:0x3
    v_mfma_f32_16x16x32_bf16 v[36:39], v[128:131], v[100:103], 0
    v_mfma_f32_16x16x32_bf16 v[40:43], v[128:131], v[104:107], 0
    v_mov_b32_dpp v132, v28 row_newbcast:10 row_mask:0xf bank_mask:0xc
    v_mov_b32_dpp v133, v29 row_newbcast:10 row_mask:0xf bank_mask:0xc
    v_mov_b32_dpp v134, v28 row_newbcast:11 row_mask:0xf bank_mask:0xc
    v_mov_b32_dpp v135, v29 row_newbcast:11 row_mask:0xf bank_mask:0xc
    v_mfma_f32_16x16x32_bf16 v[44:47], v[128:131], v[108:111], 0
    v_mfma_f32_16x16x32_bf16 v[48:51], v[128:131], v[112:115], 0
    v_mfma_f32_16x16x32_bf16 v[52:55], v[128:131], v[116:119], 0
    v_mfma_f32_16x16x32_bf16 v[56:59], v[128:131], v[120:123], 0
    v_mfma_f32_16x16x32_bf16 v[60:63], v[128:131], v[124:127], 0
    v_mfma_f32_16x16x32_bf16 v[32:35], v[132:135], v[64:67], v[32:35]
    v_mfma_f32_16x16x32_bf16 v[36:39], v[132:135], v[68:71], v[36:39]
    v_mfma_f32_16x16x32_bf16 v[40:43], v[132:135], v[72:75], v[40:43]
    v_mfma_f32_16x16x32_bf16 v[44:47], v[132:135], v[76:79], v[44:47]
    v_mfma_f32_16x16x32_bf16 v[48:51], v[132:135], v[80:83], v[48:51]
    v_mfma_f32_16x16x32_bf16 v[52:55], v[132:135], v[84:87], v[52:55]
    v_mfma_f32_16x16x32_bf16 v[56:59], v[132:135], v[88:91], v[56:59]
    v_mfma_f32_16x16x32_bf16 v[60:63], v[132:135], v[92:95], v[60:63]
    s_lshl_b32 s38, s35, 10
    s_add_u32 s38, s38, s53
    v_cvt_pk_bf16_f32 v28, v32, v36
    s_nop 0
    v_cvt_pk_bf16_f32 v29, v40, v44
    s_nop 0
    v_cvt_pk_bf16_f32 v30, v48, v52
    s_nop 0
    v_cvt_pk_bf16_f32 v31, v56, v60
    s_mov_b32 exec_lo, 0xffff
    s_mov_b32 exec_hi, 0xffff
    buffer_store_dwordx4 v[28:31], v5, s[40:43], s38 offen sc1
    s_branch L_end
L_A_fin:
    s_mov_b32 s44, s26
    s_mov_b32 s45, s27
    s_mov_b32 s46, 8192
    s_mov_b32 s47, 0x20000

    v_and_b32 v12, 7, v1
    v_lshlrev_b32 v13, 1, v12
    v_lshrrev_b32 v14, 1, v6
    v_add_u32 v13, v13, v14
    v_and_b32 v14, 1, v6
    v_lshl_add_u32 v13, v14, 4, v13
    v_lshl_add_u32 v13, v17, 5, v13
    v_lshlrev_b32 v13, 2, v13
    ds_bpermute_b32 v140, v13, v28
    ds_bpermute_b32 v144, v13, v156
    ds_bpermute_b32 v141, v13, v29
    ds_bpermute_b32 v145, v13, v157
    ds_bpermute_b32 v142, v13, v30
    ds_bpermute_b32 v146, v13, v158
    ds_bpermute_b32 v143, v13, v31
    ds_bpermute_b32 v147, v13, v159

    v_lshlrev_b32 v4, 5, v12
    v_lshl_add_u32 v4, v6, 3, v4
    v_lshl_add_u32 v4, v17, 12, v4
    v_mul_u32_u24 v7, 14336, v14
    v_add_u32 v7, v7, v5
    s_mov_b32 s56, s53
    s_add_u32 s57, s53, 4096
    s_add_u32 s58, s53, 8192
    s_add_u32 s59, s53, 12288
    s_waitcnt lgkmcnt(0)
    buffer_load_dwordx4 v[32:35], v7, s[40:43], s56 offen offset:0 sc1
    buffer_load_dwordx4 v[36:39], v7, s[40:43], s56 offen offset:1024 sc1
    buffer_load_dwordx4 v[40:43], v7, s[40:43], s56 offen offset:2048 sc1
    buffer_load_dwordx4 v[44:47], v7, s[40:43], s56 offen offset:3072 sc1
    buffer_load_dwordx4 v[48:51], v7, s[40:43], s57 offen offset:0 sc1
    buffer_load_dwordx4 v[52:55], v7, s[40:43], s57 offen offset:1024 sc1
    buffer_load_dwordx4 v[56:59], v7, s[40:43], s57 offen offset:2048 sc1
    buffer_load_dwordx4 v[60:63], v7, s[40:43], s57 offen offset:3072 sc1
    buffer_load_dwordx4 v[64:67], v7, s[40:43], s58 offen offset:0 sc1
    buffer_load_dwordx4 v[68:71], v7, s[40:43], s58 offen offset:1024 sc1
    buffer_load_dwordx4 v[72:75], v7, s[40:43], s58 offen offset:2048 sc1
    buffer_load_dwordx4 v[76:79], v7, s[40:43], s58 offen offset:3072 sc1
    buffer_load_dwordx4 v[80:83], v7, s[40:43], s59 offen offset:0 sc1
    buffer_load_dwordx4 v[84:87], v7, s[40:43], s59 offen offset:1024 sc1
    s_waitcnt vmcnt(10)
L_h5_c0:
    v_max3_u32 v12, v32, v33, v34
    v_max3_u32 v12, v12, v35, v36
    v_max3_u32 v12, v12, v37, v38
    v_max3_u32 v12, v12, v39, v40
    v_max3_u32 v12, v12, v41, v42
    v_max3_u32 v12, v12, v43, v44
    v_max3_u32 v12, v12, v45, v46
    v_max_u32 v12, v12, v47
    v_cmp_eq_u32 vcc, -1, v12
    s_cbranch_vccnz L_h5_r0
    v_mfma_f32_16x16x32_bf16 v[28:31], v[32:35], v[20:23], 0
    v_mfma_f32_16x16x32_bf16 v[28:31], v[36:39], v[20:23], v[28:31]
    v_mfma_f32_16x16x32_bf16 v[28:31], v[40:43], v[20:23], v[28:31]
    v_mfma_f32_16x16x32_bf16 v[28:31], v[44:47], v[20:23], v[28:31]
    s_waitcnt vmcnt(6)
L_h5_c1:
    v_max3_u32 v12, v48, v49, v50
    v_max3_u32 v12, v12, v51, v52
    v_max3_u32 v12, v12, v53, v54
    v_max3_u32 v12, v12, v55, v56
    v_max3_u32 v12, v12, v57, v58
    v_max3_u32 v12, v12, v59, v60
    v_max3_u32 v12, v12, v61, v62
    v_max_u32 v12, v12, v63
    v_cmp_eq_u32 vcc, -1, v12
    s_cbranch_vccnz L_h5_r1
    v_mfma_f32_16x16x32_bf16 v[28:31], v[48:51], v[20:23], v[28:31]
    v_mfma_f32_16x16x32_bf16 v[28:31], v[52:55], v[20:23], v[28:31]
    v_mfma_f32_16x16x32_bf16 v[28:31], v[56:59], v[20:23], v[28:31]
    v_mfma_f32_16x16x32_bf16 v[28:31], v[60:63], v[20:23], v[28:31]
    s_waitcnt vmcnt(2)
L_h5_c2:
    v_max3_u32 v12, v64, v65, v66
    v_max3_u32 v12, v12, v67, v68
    v_max3_u32 v12, v12, v69, v70
    v_max3_u32 v12, v12, v71, v72
    v_max3_u32 v12, v12, v73, v74
    v_max3_u32 v12, v12, v75, v76
    v_max3_u32 v12, v12, v77, v78
    v_max_u32 v12, v12, v79
    v_cmp_eq_u32 vcc, -1, v12
    s_cbranch_vccnz L_h5_r2
    v_mfma_f32_16x16x32_bf16 v[28:31], v[64:67], v[20:23], v[28:31]
    v_mfma_f32_16x16x32_bf16 v[28:31], v[68:71], v[20:23], v[28:31]
    v_mfma_f32_16x16x32_bf16 v[28:31], v[72:75], v[20:23], v[28:31]
    v_mfma_f32_16x16x32_bf16 v[28:31], v[76:79], v[20:23], v[28:31]
    s_waitcnt vmcnt(0)
L_h5_c3:
    v_max3_u32 v12, v80, v81, v82
    v_max3_u32 v12, v12, v83, v84
    v_max3_u32 v12, v12, v85, v86
    v_max_u32 v12, v12, v87
    v_cmp_eq_u32 vcc, -1, v12
    s_cbranch_vccnz L_h5_r3
    v_mfma_f32_16x16x32_bf16 v[28:31], v[80:83], v[20:23], v[28:31]
    v_mfma_f32_16x16x32_bf16 v[28:31], v[84:87], v[20:23], v[28:31]
    s_nop 7
    v_fma_f32 v28, v28, v144, v140
    v_fma_f32 v29, v29, v145, v141
    v_fma_f32 v30, v30, v146, v142
    v_fma_f32 v31, v31, v147, v143
    v_cvt_pk_bf16_f32 v28, v28, v29
    v_cvt_pk_bf16_f32 v29, v30, v31
    buffer_store_dwordx2 v[28:29], v4, s[44:47], s48 offen
    s_branch L_end
L_h3_r0:
    buffer_load_dwordx4 v[32:35], v7, s[40:43], s51 offen offset:0 sc1
    buffer_load_dwordx4 v[36:39], v7, s[40:43], s51 offen offset:1024 sc1
    buffer_load_dwordx4 v[40:43], v7, s[40:43], s51 offen offset:2048 sc1
    buffer_load_dwordx4 v[44:47], v7, s[40:43], s51 offen offset:3072 sc1
    buffer_load_dwordx4 v[48:51], v7, s[40:43], s52 offen offset:0 sc1
    buffer_load_dwordx4 v[52:55], v7, s[40:43], s52 offen offset:1024 sc1
    buffer_load_dwordx4 v[56:59], v7, s[40:43], s52 offen offset:2048 sc1
    buffer_load_dwordx4 v[60:63], v7, s[40:43], s52 offen offset:3072 sc1
    s_sub_u32 s3, s3, 1
    s_cbranch_scc1 L_end
    s_waitcnt vmcnt(4)
    s_branch L_h3_c0
L_h3_r1:
    buffer_load_dwordx4 v[48:51], v7, s[40:43], s52 offen offset:0 sc1
    buffer_load_dwordx4 v[52:55], v7, s[40:43], s52 offen offset:1024 sc1
    buffer_load_dwordx4 v[56:59], v7, s[40:43], s52 offen offset:2048 sc1
    buffer_load_dwordx4 v[60:63], v7, s[40:43], s52 offen offset:3072 sc1
    s_sub_u32 s3, s3, 1
    s_cbranch_scc1 L_end
    s_waitcnt vmcnt(0)
    s_branch L_h3_c1
L_h4_r0:
    buffer_load_dwordx4 v[32:35], v7, s[40:43], s56 offen offset:0 sc1
    buffer_load_dwordx4 v[36:39], v7, s[40:43], s56 offen offset:1024 sc1
    buffer_load_dwordx4 v[40:43], v7, s[40:43], s56 offen offset:2048 sc1
    buffer_load_dwordx4 v[44:47], v7, s[40:43], s56 offen offset:3072 sc1
    buffer_load_dwordx4 v[48:51], v7, s[40:43], s57 offen offset:0 sc1
    buffer_load_dwordx4 v[52:55], v7, s[40:43], s57 offen offset:1024 sc1
    buffer_load_dwordx4 v[56:59], v7, s[40:43], s57 offen offset:2048 sc1
    buffer_load_dwordx4 v[60:63], v7, s[40:43], s57 offen offset:3072 sc1
    buffer_load_dwordx4 v[64:67], v7, s[40:43], s58 offen offset:0 sc1
    buffer_load_dwordx4 v[68:71], v7, s[40:43], s58 offen offset:1024 sc1
    buffer_load_dwordx4 v[72:75], v7, s[40:43], s58 offen offset:2048 sc1
    buffer_load_dwordx4 v[76:79], v7, s[40:43], s58 offen offset:3072 sc1
    buffer_load_dwordx4 v[80:83], v7, s[40:43], s59 offen offset:0 sc1
    buffer_load_dwordx4 v[84:87], v7, s[40:43], s59 offen offset:1024 sc1
    buffer_load_dwordx4 v[88:91], v7, s[40:43], s59 offen offset:2048 sc1
    buffer_load_dwordx4 v[92:95], v7, s[40:43], s59 offen offset:3072 sc1
    s_sub_u32 s3, s3, 1
    s_cbranch_scc1 L_end
    s_waitcnt vmcnt(12)
    s_branch L_h4_c0
L_h4_r1:
    buffer_load_dwordx4 v[48:51], v7, s[40:43], s57 offen offset:0 sc1
    buffer_load_dwordx4 v[52:55], v7, s[40:43], s57 offen offset:1024 sc1
    buffer_load_dwordx4 v[56:59], v7, s[40:43], s57 offen offset:2048 sc1
    buffer_load_dwordx4 v[60:63], v7, s[40:43], s57 offen offset:3072 sc1
    buffer_load_dwordx4 v[64:67], v7, s[40:43], s58 offen offset:0 sc1
    buffer_load_dwordx4 v[68:71], v7, s[40:43], s58 offen offset:1024 sc1
    buffer_load_dwordx4 v[72:75], v7, s[40:43], s58 offen offset:2048 sc1
    buffer_load_dwordx4 v[76:79], v7, s[40:43], s58 offen offset:3072 sc1
    buffer_load_dwordx4 v[80:83], v7, s[40:43], s59 offen offset:0 sc1
    buffer_load_dwordx4 v[84:87], v7, s[40:43], s59 offen offset:1024 sc1
    buffer_load_dwordx4 v[88:91], v7, s[40:43], s59 offen offset:2048 sc1
    buffer_load_dwordx4 v[92:95], v7, s[40:43], s59 offen offset:3072 sc1
    s_sub_u32 s3, s3, 1
    s_cbranch_scc1 L_end
    s_waitcnt vmcnt(8)
    s_branch L_h4_c1
L_h4_r2:
    buffer_load_dwordx4 v[64:67], v7, s[40:43], s58 offen offset:0 sc1
    buffer_load_dwordx4 v[68:71], v7, s[40:43], s58 offen offset:1024 sc1
    buffer_load_dwordx4 v[72:75], v7, s[40:43], s58 offen offset:2048 sc1
    buffer_load_dwordx4 v[76:79], v7, s[40:43], s58 offen offset:3072 sc1
    buffer_load_dwordx4 v[80:83], v7, s[40:43], s59 offen offset:0 sc1
    buffer_load_dwordx4 v[84:87], v7, s[40:43], s59 offen offset:1024 sc1
    buffer_load_dwordx4 v[88:91], v7, s[40:43], s59 offen offset:2048 sc1
    buffer_load_dwordx4 v[92:95], v7, s[40:43], s59 offen offset:3072 sc1
    s_sub_u32 s3, s3, 1
    s_cbranch_scc1 L_end
    s_waitcnt vmcnt(4)
    s_branch L_h4_c2
L_h4_r3:
    buffer_load_dwordx4 v[80:83], v7, s[40:43], s59 offen offset:0 sc1
    buffer_load_dwordx4 v[84:87], v7, s[40:43], s59 offen offset:1024 sc1
    buffer_load_dwordx4 v[88:91], v7, s[40:43], s59 offen offset:2048 sc1
    buffer_load_dwordx4 v[92:95], v7, s[40:43], s59 offen offset:3072 sc1
    s_sub_u32 s3, s3, 1
    s_cbranch_scc1 L_end
    s_waitcnt vmcnt(0)
    s_branch L_h4_c3
L_h5_r0:
    buffer_load_dwordx4 v[32:35], v7, s[40:43], s56 offen offset:0 sc1
    buffer_load_dwordx4 v[36:39], v7, s[40:43], s56 offen offset:1024 sc1
    buffer_load_dwordx4 v[40:43], v7, s[40:43], s56 offen offset:2048 sc1
    buffer_load_dwordx4 v[44:47], v7, s[40:43], s56 offen offset:3072 sc1
    buffer_load_dwordx4 v[48:51], v7, s[40:43], s57 offen offset:0 sc1
    buffer_load_dwordx4 v[52:55], v7, s[40:43], s57 offen offset:1024 sc1
    buffer_load_dwordx4 v[56:59], v7, s[40:43], s57 offen offset:2048 sc1
    buffer_load_dwordx4 v[60:63], v7, s[40:43], s57 offen offset:3072 sc1
    buffer_load_dwordx4 v[64:67], v7, s[40:43], s58 offen offset:0 sc1
    buffer_load_dwordx4 v[68:71], v7, s[40:43], s58 offen offset:1024 sc1
    buffer_load_dwordx4 v[72:75], v7, s[40:43], s58 offen offset:2048 sc1
    buffer_load_dwordx4 v[76:79], v7, s[40:43], s58 offen offset:3072 sc1
    buffer_load_dwordx4 v[80:83], v7, s[40:43], s59 offen offset:0 sc1
    buffer_load_dwordx4 v[84:87], v7, s[40:43], s59 offen offset:1024 sc1
    s_sub_u32 s3, s3, 1
    s_cbranch_scc1 L_end
    s_waitcnt vmcnt(10)
    s_branch L_h5_c0
L_h5_r1:
    buffer_load_dwordx4 v[48:51], v7, s[40:43], s57 offen offset:0 sc1
    buffer_load_dwordx4 v[52:55], v7, s[40:43], s57 offen offset:1024 sc1
    buffer_load_dwordx4 v[56:59], v7, s[40:43], s57 offen offset:2048 sc1
    buffer_load_dwordx4 v[60:63], v7, s[40:43], s57 offen offset:3072 sc1
    buffer_load_dwordx4 v[64:67], v7, s[40:43], s58 offen offset:0 sc1
    buffer_load_dwordx4 v[68:71], v7, s[40:43], s58 offen offset:1024 sc1
    buffer_load_dwordx4 v[72:75], v7, s[40:43], s58 offen offset:2048 sc1
    buffer_load_dwordx4 v[76:79], v7, s[40:43], s58 offen offset:3072 sc1
    buffer_load_dwordx4 v[80:83], v7, s[40:43], s59 offen offset:0 sc1
    buffer_load_dwordx4 v[84:87], v7, s[40:43], s59 offen offset:1024 sc1
    s_sub_u32 s3, s3, 1
    s_cbranch_scc1 L_end
    s_waitcnt vmcnt(6)
    s_branch L_h5_c1
L_h5_r2:
    buffer_load_dwordx4 v[64:67], v7, s[40:43], s58 offen offset:0 sc1
    buffer_load_dwordx4 v[68:71], v7, s[40:43], s58 offen offset:1024 sc1
    buffer_load_dwordx4 v[72:75], v7, s[40:43], s58 offen offset:2048 sc1
    buffer_load_dwordx4 v[76:79], v7, s[40:43], s58 offen offset:3072 sc1
    buffer_load_dwordx4 v[80:83], v7, s[40:43], s59 offen offset:0 sc1
    buffer_load_dwordx4 v[84:87], v7, s[40:43], s59 offen offset:1024 sc1
    s_sub_u32 s3, s3, 1
    s_cbranch_scc1 L_end
    s_waitcnt vmcnt(2)
    s_branch L_h5_c2
L_h5_r3:
    buffer_load_dwordx4 v[80:83], v7, s[40:43], s59 offen offset:0 sc1
    buffer_load_dwordx4 v[84:87], v7, s[40:43], s59 offen offset:1024 sc1
    s_sub_u32 s3, s3, 1
    s_cbranch_scc1 L_end
    s_waitcnt vmcnt(0)
    s_branch L_h5_c3
L_Bc:

    s_lshl_b32 s48, s33, 20
    s_lshl_b32 s38, s35, 8
    s_add_u32 s48, s48, s38
    s_and_b32 s49, s34, 3
    v_lshrrev_b32 v4, 4, v1
    v_and_b32 v5, 15, v1
    v_lshlrev_b32 v2, 18, v4
    v_lshl_add_u32 v2, v5, 4, v2
    s_waitcnt lgkmcnt(0)
    s_mov_b32 s44, s8
    s_mov_b32 s45, s9
    s_mov_b32 s46, 4194304
    s_mov_b32 s47, 0x20000
    s_cmp_lg_u32 s34, 0
    s_cbranch_scc1 L_B_go
    s_mov_b32 s40, s30
    s_mov_b32 s41, s31
    s_mov_b32 s42, 16777216
    s_mov_b32 s43, 0x20000

    s_mov_b32 s3, 0x400000
    v_mov_b32 v0, 156256
    s_and_b32 s62, s34, 3
    s_lshl2_add_u32 s97, s62, s37
    s_lshl4_add_u32 s61, s36, s97

    s_barrier
    s_branch L_B_t
L_B_go:
    s_xor_b32 s38, s49, 0
    s_lshl_b32 s38, s38, 16
    s_add_u32 s38, s38, s48
    buffer_load_dwordx4 v[40:43], v2, s[44:47], s38 offen
    s_add_u32 s38, s38, 8192
    buffer_load_dwordx4 v[44:47], v2, s[44:47], s38 offen
    s_add_u32 s38, s38, 8192
    buffer_load_dwordx4 v[48:51], v2, s[44:47], s38 offen
    s_add_u32 s38, s38, 8192
    buffer_load_dwordx4 v[52:55], v2, s[44:47], s38 offen
    s_add_u32 s38, s38, 8192
    buffer_load_dwordx4 v[56:59], v2, s[44:47], s38 offen
    s_add_u32 s38, s38, 8192
    buffer_load_dwordx4 v[60:63], v2, s[44:47], s38 offen
    s_add_u32 s38, s38, 8192
    buffer_load_dwordx4 v[64:67], v2, s[44:47], s38 offen
    s_add_u32 s38, s38, 8192
    buffer_load_dwordx4 v[68:71], v2, s[44:47], s38 offen
    s_mov_b32 s40, s30
    s_mov_b32 s41, s31
    s_mov_b32 s42, 16777216
    s_mov_b32 s43, 0x20000

    s_mov_b32 s3, 0x400000
    v_mov_b32 v0, 156256
    s_and_b32 s62, s34, 3
    s_lshl2_add_u32 s97, s62, s37
    s_lshl4_add_u32 s61, s36, s97

    s_barrier
    s_xor_b32 s38, s49, 1
    s_lshl_b32 s38, s38, 16
    s_add_u32 s38, s38, s48
    buffer_load_dwordx4 v[72:75], v2, s[44:47], s38 offen
    s_add_u32 s38, s38, 8192
    buffer_load_dwordx4 v[76:79], v2, s[44:47], s38 offen
    s_add_u32 s38, s38, 8192
    buffer_load_dwordx4 v[80:83], v2, s[44:47], s38 offen
    s_add_u32 s38, s38, 8192
    buffer_load_dwordx4 v[84:87], v2, s[44:47], s38 offen
    s_add_u32 s38, s38, 8192
    buffer_load_dwordx4 v[88:91], v2, s[44:47], s38 offen
    s_add_u32 s38, s38, 8192
    buffer_load_dwordx4 v[92:95], v2, s[44:47], s38 offen
    s_add_u32 s38, s38, 8192
    buffer_load_dwordx4 v[96:99], v2, s[44:47], s38 offen
    s_add_u32 s38, s38, 8192
    buffer_load_dwordx4 v[100:103], v2, s[44:47], s38 offen
    s_xor_b32 s38, s49, 2
    s_lshl_b32 s38, s38, 16
    s_add_u32 s38, s38, s48
    buffer_load_dwordx4 v[104:107], v2, s[44:47], s38 offen
    s_add_u32 s38, s38, 8192
    buffer_load_dwordx4 v[108:111], v2, s[44:47], s38 offen
    s_add_u32 s38, s38, 8192
    buffer_load_dwordx4 v[112:115], v2, s[44:47], s38 offen
    s_add_u32 s38, s38, 8192
    buffer_load_dwordx4 v[116:119], v2, s[44:47], s38 offen
    s_add_u32 s38, s38, 8192
    buffer_load_dwordx4 v[120:123], v2, s[44:47], s38 offen
    s_add_u32 s38, s38, 8192
    buffer_load_dwordx4 v[124:127], v2, s[44:47], s38 offen
    s_add_u32 s38, s38, 8192
    buffer_load_dwordx4 v[128:131], v2, s[44:47], s38 offen
    s_add_u32 s38, s38, 8192
    buffer_load_dwordx4 v[132:135], v2, s[44:47], s38 offen
    s_xor_b32 s38, s49, 3
    s_lshl_b32 s38, s38, 16
    s_add_u32 s38, s38, s48
    buffer_load_dwordx4 v[136:139], v2, s[44:47], s38 offen
    s_add_u32 s38, s38, 8192
    buffer_load_dwordx4 v[140:143], v2, s[44:47], s38 offen
    s_add_u32 s38, s38, 8192
    buffer_load_dwordx4 v[144:147], v2, s[44:47], s38 offen
    s_add_u32 s38, s38, 8192
    buffer_load_dwordx4 v[148:151], v2, s[44:47], s38 offen
    s_add_u32 s38, s38, 8192
    buffer_load_dwordx4 v[152:155], v2, s[44:47], s38 offen
    s_add_u32 s38, s38, 8192
    buffer_load_dwordx4 v[156:159], v2, s[44:47], s38 offen
    s_add_u32 s38, s38, 8192
    buffer_load_dwordx4 v[160:163], v2, s[44:47], s38 offen
    s_add_u32 s38, s38, 8192
    buffer_load_dwordx4 v[164:167], v2, s[44:47], s38 offen
    v_mov_b32 v6, 1
    s_mov_b64 exec, 1
    ds_add_u32 v0, v6 offset:0
    s_mov_b64 exec, -1

    v_lshrrev_b32 v5, 1, v5
    v_lshlrev_b32 v5, 4, v5
    v_lshl_add_u32 v7, v4, 9, v5
    s_lshl_b32 s38, s33, 11
    s_xor_b32 s50, s49, 0
    s_lshl_b32 s50, s50, 7
    s_add_u32 s50, s50, s38
    s_xor_b32 s51, s49, 1
    s_lshl_b32 s51, s51, 7
    s_add_u32 s51, s51, s38
    s_xor_b32 s52, s49, 2
    s_lshl_b32 s52, s52, 7
    s_add_u32 s52, s52, s38
    s_xor_b32 s53, s49, 3
    s_lshl_b32 s53, s53, 7
    s_add_u32 s53, s53, s38

    v_and_b32 v4, 1, v1
    v_cmp_eq_u32 vcc, 1, v4
    v_mov_b32 v2, 0x0c0c0100
    v_mov_b32 v4, 0x01000c0c
    v_cndmask_b32 v2, v2, v4, vcc
    v_mov_b32 v3, 0x0c0c0302
    v_mov_b32 v4, 0x03020c0c
    v_cndmask_b32 v3, v3, v4, vcc

    v_mov_b32 v6, 0
L_fl13:
    global_load_dword v4, v6, s[28:29] offset:0 sc1
    s_sub_u32 s3, s3, 1
    s_cbranch_scc1 L_end
    s_waitcnt vmcnt(0)
    v_cmp_eq_u32 vcc, 0, v4
    s_cbranch_vccnz L_fl13
    buffer_load_dwordx4 v[8:11], v7, s[40:43], s50 offen sc1
    buffer_load_dwordx4 v[12:15], v7, s[40:43], s51 offen sc1
    buffer_load_dwordx4 v[16:19], v7, s[40:43], s52 offen sc1
    buffer_load_dwordx4 v[20:23], v7, s[40:43], s53 offen sc1
    v_swap_b32 v41, v44
    v_swap_b32 v42, v48
    v_swap_b32 v43, v52
    v_swap_b32 v46, v49
    v_swap_b32 v47, v53
    v_swap_b32 v51, v54
    v_swap_b32 v57, v60
    v_swap_b32 v58, v64
    v_swap_b32 v59, v68
    v_swap_b32 v62, v65
    v_swap_b32 v63, v69
    v_swap_b32 v67, v70
    v_swap_b32 v73, v76
    v_swap_b32 v74, v80
    v_swap_b32 v75, v84
    v_swap_b32 v78, v81
    v_swap_b32 v79, v85
    v_swap_b32 v83, v86
    v_swap_b32 v89, v92
    v_swap_b32 v90, v96
    v_swap_b32 v91, v100
    v_swap_b32 v94, v97
    v_swap_b32 v95, v101
    v_swap_b32 v99, v102
    v_swap_b32 v105, v108
    v_swap_b32 v106, v112
    v_swap_b32 v107, v116
    v_swap_b32 v110, v113
    v_swap_b32 v111, v117
    v_swap_b32 v115, v118
    v_swap_b32 v121, v124
    v_swap_b32 v122, v128
    v_swap_b32 v123, v132
    v_swap_b32 v126, v129
    v_swap_b32 v127, v133
    v_swap_b32 v131, v134
    v_swap_b32 v137, v140
    v_swap_b32 v138, v144
    v_swap_b32 v139, v148
    v_swap_b32 v142, v145
    v_swap_b32 v143, v149
    v_swap_b32 v147, v150
    v_swap_b32 v153, v156
    v_swap_b32 v154, v160
    v_swap_b32 v155, v164
    v_swap_b32 v158, v161
    v_swap_b32 v159, v165
    v_swap_b32 v163, v166
    s_branch L_B_h1
L_B_h0:
    buffer_load_dwordx4 v[8:11], v7, s[40:43], s50 offen sc1
    buffer_load_dwordx4 v[12:15], v7, s[40:43], s51 offen sc1
    buffer_load_dwordx4 v[16:19], v7, s[40:43], s52 offen sc1
    buffer_load_dwordx4 v[20:23], v7, s[40:43], s53 offen sc1
    s_sub_u32 s3, s3, 1
    s_cbranch_scc1 L_end
L_B_h1:
    s_waitcnt vmcnt(0)
    v_max3_u32 v24, v8, v9, v10
    v_max3_u32 v24, v24, v11, v12
    v_max3_u32 v24, v24, v13, v14
    v_max3_u32 v24, v24, v15, v16
    v_max3_u32 v24, v24, v17, v18
    v_max3_u32 v24, v24, v19, v20
    v_max3_u32 v24, v24, v21, v22
    v_max_u32 v24, v24, v23
    v_cmp_eq_u32 vcc, -1, v24
    s_cbranch_vccnz L_B_h0
    v_mov_b32 v24, 1
    s_mov_b64 exec, 1
    ds_add_u32 v0, v24 offset:4
    s_mov_b64 exec, -1
    v_perm_b32 v4, v8, v8, v2
    v_perm_b32 v5, v8, v8, v3
    v_perm_b32 v6, v9, v9, v2
    v_perm_b32 v7, v9, v9, v3
    s_nop 1
    v_mfma_f32_16x16x32_bf16 v[24:27], v[40:43], v[4:7], 0
    v_perm_b32 v40, v10, v10, v2
    v_perm_b32 v41, v10, v10, v3
    v_mfma_f32_16x16x32_bf16 v[28:31], v[44:47], v[4:7], 0
    v_perm_b32 v42, v11, v11, v2
    v_perm_b32 v43, v11, v11, v3
    v_mfma_f32_16x16x32_bf16 v[32:35], v[48:51], v[4:7], 0
    v_mfma_f32_16x16x32_bf16 v[36:39], v[52:55], v[4:7], 0
    v_mfma_f32_16x16x32_bf16 v[24:27], v[56:59], v[40:43], v[24:27]
    v_perm_b32 v56, v12, v12, v2
    v_perm_b32 v57, v12, v12, v3
    v_mfma_f32_16x16x32_bf16 v[28:31], v[60:63], v[40:43], v[28:31]
    v_perm_b32 v58, v13, v13, v2
    v_perm_b32 v59, v13, v13, v3
    v_mfma_f32_16x16x32_bf16 v[32:35], v[64:67], v[40:43], v[32:35]
    v_mfma_f32_16x16x32_bf16 v[36:39], v[68:71], v[40:43], v[36:39]
    v_mfma_f32_16x16x32_bf16 v[24:27], v[72:75], v[56:59], v[24:27]
    v_perm_b32 v72, v14, v14, v2
    v_perm_b32 v73, v14, v14, v3
    v_mfma_f32_16x16x32_bf16 v[28:31], v[76:79], v[56:59], v[28:31]
    v_perm_b32 v74, v15, v15, v2
    v_perm_b32 v75, v15, v15, v3
    v_mfma_f32_16x16x32_bf16 v[32:35], v[80:83], v[56:59], v[32:35]
    v_mfma_f32_16x16x32_bf16 v[36:39], v[84:87], v[56:59], v[36:39]
    v_mfma_f32_16x16x32_bf16 v[24:27], v[88:91], v[72:75], v[24:27]
    v_perm_b32 v88, v16, v16, v2
    v_perm_b32 v89, v16, v16, v3
    v_mfma_f32_16x16x32_bf16 v[28:31], v[92:95], v[72:75], v[28:31]
    v_perm_b32 v90, v17, v17, v2
    v_perm_b32 v91, v17, v17, v3
    v_mfma_f32_16x16x32_bf16 v[32:35], v[96:99], v[72:75], v[32:35]
    v_mfma_f32_16x16x32_bf16 v[36:39], v[100:103], v[72:75], v[36:39]
    v_mfma_f32_16x16x32_bf16 v[24:27], v[104:107], v[88:91], v[24:27]
    v_perm_b32 v104, v18, v18, v2
    v_perm_b32 v105, v18, v18, v3
    v_mfma_f32_16x16x32_bf16 v[28:31], v[108:111], v[88:91], v[28:31]
    v_perm_b32 v106, v19, v19, v2
    v_perm_b32 v107, v19, v19, v3
    v_mfma_f32_16x16x32_bf16 v[32:35], v[112:115], v[88:91], v[32:35]
    v_mfma_f32_16x16x32_bf16 v[36:39], v[116:119], v[88:91], v[36:39]
    v_mfma_f32_16x16x32_bf16 v[24:27], v[120:123], v[104:107], v[24:27]
    v_perm_b32 v120, v20, v20, v2
    v_perm_b32 v121, v20, v20, v3
    v_mfma_f32_16x16x32_bf16 v[28:31], v[124:127], v[104:107], v[28:31]
    v_perm_b32 v122, v21, v21, v2
    v_perm_b32 v123, v21, v21, v3
    v_mfma_f32_16x16x32_bf16 v[32:35], v[128:131], v[104:107], v[32:35]
    v_mfma_f32_16x16x32_bf16 v[36:39], v[132:135], v[104:107], v[36:39]
    v_mfma_f32_16x16x32_bf16 v[24:27], v[136:139], v[120:123], v[24:27]
    v_perm_b32 v136, v22, v22, v2
    v_perm_b32 v137, v22, v22, v3
    v_mfma_f32_16x16x32_bf16 v[28:31], v[140:143], v[120:123], v[28:31]
    v_perm_b32 v138, v23, v23, v2
    v_perm_b32 v139, v23, v23, v3
    v_mfma_f32_16x16x32_bf16 v[32:35], v[144:147], v[120:123], v[32:35]
    v_mfma_f32_16x16x32_bf16 v[36:39], v[148:151], v[120:123], v[36:39]
    v_mfma_f32_16x16x32_bf16 v[24:27], v[152:155], v[136:139], v[24:27]
    v_mfma_f32_16x16x32_bf16 v[28:31], v[156:159], v[136:139], v[28:31]
    v_mfma_f32_16x16x32_bf16 v[32:35], v[160:163], v[136:139], v[32:35]
    v_mfma_f32_16x16x32_bf16 v[36:39], v[164:167], v[136:139], v[36:39]
    s_lshl_b32 s38, s33, 12
    s_add_u32 s38, s38, 131072
    v_lshl_add_u32 v4, v1, 4, s38
    s_nop 1
    ds_write_b128 v4, v[24:27] offset:0
    ds_write_b128 v4, v[28:31] offset:1024
    ds_write_b128 v4, v[32:35] offset:2048
    ds_write_b128 v4, v[36:39] offset:3072
    v_mov_b32 v5, 1
    s_mov_b64 exec, 1
    ds_add_u32 v0, v5 offset:5040
    s_mov_b64 exec, -1
L_B_t:
    s_cmp_lt_u32 s33, 2
    s_cbranch_scc1 L_B_uv
    s_cmp_eq_u32 s33, 3
    s_cbranch_scc1 L_end
L_w14:
    s_sleep 1
    ds_read_b32 v6, v0 offset:5044
    s_sub_u32 s3, s3, 1
    s_cbranch_scc1 L_end
    s_waitcnt lgkmcnt(0)
    v_cmp_gt_u32 vcc, 3, v6
    s_cbranch_vccnz L_w14
    s_mov_b32 s44, s22
    s_mov_b32 s45, s23
    s_mov_b32 s46, 8192
    s_mov_b32 s47, 0x20000

    v_lshrrev_b32 v4, 4, v1
    v_and_b32 v5, 15, v1
    v_lshrrev_b32 v2, 1, v5
    v_lshlrev_b32 v2, 10, v2
    v_lshl_add_u32 v2, v4, 6, v2
    s_lshl_b32 s38, s62, 8
    buffer_load_dwordx4 v[8:11], v2, s[44:47], s38 offen offset:0
    buffer_load_dwordx4 v[12:15], v2, s[44:47], s38 offen offset:16
    buffer_load_dwordx4 v[16:19], v2, s[44:47], s38 offen offset:32
    buffer_load_dwordx4 v[20:23], v2, s[44:47], s38 offen offset:48
    s_mov_b32 s44, s24
    s_mov_b32 s45, s25
    s_mov_b32 s46, 3145728
    s_mov_b32 s47, 0x20000

    v_mul_u32_u24 v2, 196608, v4
    v_lshl_add_u32 v2, v5, 3, v2
    v_lshlrev_b32 v4, 11, v4
    v_lshl_add_u32 v4, v5, 3, v4
    v_and_b32 v3, 1, v1
    v_lshlrev_b32 v3, 4, v3
    s_mov_b32 s38, 0xffff
    v_lshlrev_b32 v3, v3, s38
    s_mul_i32 s48, s62, 786432
    s_lshl_b32 s38, s35, 7
    s_add_u32 s48, s48, s38
    s_add_u32 s48, s48, 2048
    s_lshl2_add_u32 s49, s37, s62
    s_lshl_b32 s49, s49, 13
    s_lshl_b32 s38, s36, 7
    s_add_u32 s49, s49, s38
    s_add_u32 s49, s49, 1179648
    s_mov_b32 s38, 0xbfb8aa3b
    s_waitcnt vmcnt(0)
    v_lshlrev_b32 v24, 16, v8
    v_and_b32 v25, 0xffff0000, v8
    v_mul_f32 v26, s38, v24
    v_mul_f32 v27, s38, v25
    v_exp_f32 v26, v26
    v_exp_f32 v27, v27
    v_add_f32 v26, 1.0, v26
    v_add_f32 v27, 1.0, v27
    v_rcp_f32 v26, v26
    v_rcp_f32 v27, v27
    v_mul_f32 v24, v24, v26
    v_mul_f32 v25, v25, v27
    v_cvt_pk_bf16_f32 v24, v24, v24
    v_cvt_pk_bf16_f32 v25, v25, v25
    v_and_b32 v40, v24, v3
    v_and_b32 v41, v25, v3
    v_lshlrev_b32 v24, 16, v9
    v_and_b32 v25, 0xffff0000, v9
    v_mul_f32 v26, s38, v24
    v_mul_f32 v27, s38, v25
    v_exp_f32 v26, v26
    v_exp_f32 v27, v27
    v_add_f32 v26, 1.0, v26
    v_add_f32 v27, 1.0, v27
    v_rcp_f32 v26, v26
    v_rcp_f32 v27, v27
    v_mul_f32 v24, v24, v26
    v_mul_f32 v25, v25, v27
    v_cvt_pk_bf16_f32 v24, v24, v24
    v_cvt_pk_bf16_f32 v25, v25, v25
    v_and_b32 v42, v24, v3
    v_and_b32 v43, v25, v3
    v_lshlrev_b32 v24, 16, v10
    v_and_b32 v25, 0xffff0000, v10
    v_mul_f32 v26, s38, v24
    v_mul_f32 v27, s38, v25
    v_exp_f32 v26, v26
    v_exp_f32 v27, v27
    v_add_f32 v26, 1.0, v26
    v_add_f32 v27, 1.0, v27
    v_rcp_f32 v26, v26
    v_rcp_f32 v27, v27
    v_mul_f32 v24, v24, v26
    v_mul_f32 v25, v25, v27
    v_cvt_pk_bf16_f32 v24, v24, v24
    v_cvt_pk_bf16_f32 v25, v25, v25
    v_and_b32 v44, v24, v3
    v_and_b32 v45, v25, v3
    v_lshlrev_b32 v24, 16, v11
    v_and_b32 v25, 0xffff0000, v11
    v_mul_f32 v26, s38, v24
    v_mul_f32 v27, s38, v25
    v_exp_f32 v26, v26
    v_exp_f32 v27, v27
    v_add_f32 v26, 1.0, v26
    v_add_f32 v27, 1.0, v27
    v_rcp_f32 v26, v26
    v_rcp_f32 v27, v27
    v_mul_f32 v24, v24, v26
    v_mul_f32 v25, v25, v27
    v_cvt_pk_bf16_f32 v24, v24, v24
    v_cvt_pk_bf16_f32 v25, v25, v25
    v_and_b32 v46, v24, v3
    v_and_b32 v47, v25, v3
    v_lshlrev_b32 v24, 16, v12
    v_and_b32 v25, 0xffff0000, v12
    v_mul_f32 v26, s38, v24
    v_mul_f32 v27, s38, v25
    v_exp_f32 v26, v26
    v_exp_f32 v27, v27
    v_add_f32 v26, 1.0, v26
    v_add_f32 v27, 1.0, v27
    v_rcp_f32 v26, v26
    v_rcp_f32 v27, v27
    v_mul_f32 v24, v24, v26
    v_mul_f32 v25, v25, v27
    v_cvt_pk_bf16_f32 v24, v24, v24
    v_cvt_pk_bf16_f32 v25, v25, v25
    v_and_b32 v48, v24, v3
    v_and_b32 v49, v25, v3
    v_lshlrev_b32 v24, 16, v13
    v_and_b32 v25, 0xffff0000, v13
    v_mul_f32 v26, s38, v24
    v_mul_f32 v27, s38, v25
    v_exp_f32 v26, v26
    v_exp_f32 v27, v27
    v_add_f32 v26, 1.0, v26
    v_add_f32 v27, 1.0, v27
    v_rcp_f32 v26, v26
    v_rcp_f32 v27, v27
    v_mul_f32 v24, v24, v26
    v_mul_f32 v25, v25, v27
    v_cvt_pk_bf16_f32 v24, v24, v24
    v_cvt_pk_bf16_f32 v25, v25, v25
    v_and_b32 v50, v24, v3
    v_and_b32 v51, v25, v3
    v_lshlrev_b32 v24, 16, v14
    v_and_b32 v25, 0xffff0000, v14
    v_mul_f32 v26, s38, v24
    v_mul_f32 v27, s38, v25
    v_exp_f32 v26, v26
    v_exp_f32 v27, v27
    v_add_f32 v26, 1.0, v26
    v_add_f32 v27, 1.0, v27
    v_rcp_f32 v26, v26
    v_rcp_f32 v27, v27
    v_mul_f32 v24, v24, v26
    v_mul_f32 v25, v25, v27
    v_cvt_pk_bf16_f32 v24, v24, v24
    v_cvt_pk_bf16_f32 v25, v25, v25
    v_and_b32 v52, v24, v3
    v_and_b32 v53, v25, v3
    v_lshlrev_b32 v24, 16, v15
    v_and_b32 v25, 0xffff0000, v15
    v_mul_f32 v26, s38, v24
    v_mul_f32 v27, s38, v25
    v_exp_f32 v26, v26
    v_exp_f32 v27, v27
    v_add_f32 v26, 1.0, v26
    v_add_f32 v27, 1.0, v27
    v_rcp_f32 v26, v26
    v_rcp_f32 v27, v27
    v_mul_f32 v24, v24, v26
    v_mul_f32 v25, v25, v27
    v_cvt_pk_bf16_f32 v24, v24, v24
    v_cvt_pk_bf16_f32 v25, v25, v25
    v_and_b32 v54, v24, v3
    v_and_b32 v55, v25, v3
    v_lshlrev_b32 v24, 16, v16
    v_and_b32 v25, 0xffff0000, v16
    v_mul_f32 v26, s38, v24
    v_mul_f32 v27, s38, v25
    v_exp_f32 v26, v26
    v_exp_f32 v27, v27
    v_add_f32 v26, 1.0, v26
    v_add_f32 v27, 1.0, v27
    v_rcp_f32 v26, v26
    v_rcp_f32 v27, v27
    v_mul_f32 v24, v24, v26
    v_mul_f32 v25, v25, v27
    v_cvt_pk_bf16_f32 v24, v24, v24
    v_cvt_pk_bf16_f32 v25, v25, v25
    v_and_b32 v56, v24, v3
    v_and_b32 v57, v25, v3
    v_lshlrev_b32 v24, 16, v17
    v_and_b32 v25, 0xffff0000, v17
    v_mul_f32 v26, s38, v24
    v_mul_f32 v27, s38, v25
    v_exp_f32 v26, v26
    v_exp_f32 v27, v27
    v_add_f32 v26, 1.0, v26
    v_add_f32 v27, 1.0, v27
    v_rcp_f32 v26, v26
    v_rcp_f32 v27, v27
    v_mul_f32 v24, v24, v26
    v_mul_f32 v25, v25, v27
    v_cvt_pk_bf16_f32 v24, v24, v24
    v_cvt_pk_bf16_f32 v25, v25, v25
    v_and_b32 v58, v24, v3
    v_and_b32 v59, v25, v3
    v_lshlrev_b32 v24, 16, v18
    v_and_b32 v25, 0xffff0000, v18
    v_mul_f32 v26, s38, v24
    v_mul_f32 v27, s38, v25
    v_exp_f32 v26, v26
    v_exp_f32 v27, v27
    v_add_f32 v26, 1.0, v26
    v_add_f32 v27, 1.0, v27
    v_rcp_f32 v26, v26
    v_rcp_f32 v27, v27
    v_mul_f32 v24, v24, v26
    v_mul_f32 v25, v25, v27
    v_cvt_pk_bf16_f32 v24, v24, v24
    v_cvt_pk_bf16_f32 v25, v25, v25
    v_and_b32 v60, v24, v3
    v_and_b32 v61, v25, v3
    v_lshlrev_b32 v24, 16, v19
    v_and_b32 v25, 0xffff0000, v19
    v_mul_f32 v26, s38, v24
    v_mul_f32 v27, s38, v25
    v_exp_f32 v26, v26
    v_exp_f32 v27, v27
    v_add_f32 v26, 1.0, v26
    v_add_f32 v27, 1.0, v27
    v_rcp_f32 v26, v26
    v_rcp_f32 v27, v27
    v_mul_f32 v24, v24, v26
    v_mul_f32 v25, v25, v27
    v_cvt_pk_bf16_f32 v24, v24, v24
    v_cvt_pk_bf16_f32 v25, v25, v25
    v_and_b32 v62, v24, v3
    v_and_b32 v63, v25, v3
    v_lshlrev_b32 v24, 16, v20
    v_and_b32 v25, 0xffff0000, v20
    v_mul_f32 v26, s38, v24
    v_mul_f32 v27, s38, v25
    v_exp_f32 v26, v26
    v_exp_f32 v27, v27
    v_add_f32 v26, 1.0, v26
    v_add_f32 v27, 1.0, v27
    v_rcp_f32 v26, v26
    v_rcp_f32 v27, v27
    v_mul_f32 v24, v24, v26
    v_mul_f32 v25, v25, v27
    v_cvt_pk_bf16_f32 v24, v24, v24
    v_cvt_pk_bf16_f32 v25, v25, v25
    v_and_b32 v64, v24, v3
    v_and_b32 v65, v25, v3
    v_lshlrev_b32 v24, 16, v21
    v_and_b32 v25, 0xffff0000, v21
    v_mul_f32 v26, s38, v24
    v_mul_f32 v27, s38, v25
    v_exp_f32 v26, v26
    v_exp_f32 v27, v27
    v_add_f32 v26, 1.0, v26
    v_add_f32 v27, 1.0, v27
    v_rcp_f32 v26, v26
    v_rcp_f32 v27, v27
    v_mul_f32 v24, v24, v26
    v_mul_f32 v25, v25, v27
    v_cvt_pk_bf16_f32 v24, v24, v24
    v_cvt_pk_bf16_f32 v25, v25, v25
    v_and_b32 v66, v24, v3
    v_and_b32 v67, v25, v3
    v_lshlrev_b32 v24, 16, v22
    v_and_b32 v25, 0xffff0000, v22
    v_mul_f32 v26, s38, v24
    v_mul_f32 v27, s38, v25
    v_exp_f32 v26, v26
    v_exp_f32 v27, v27
    v_add_f32 v26, 1.0, v26
    v_add_f32 v27, 1.0, v27
    v_rcp_f32 v26, v26
    v_rcp_f32 v27, v27
    v_mul_f32 v24, v24, v26
    v_mul_f32 v25, v25, v27
    v_cvt_pk_bf16_f32 v24, v24, v24
    v_cvt_pk_bf16_f32 v25, v25, v25
    v_and_b32 v68, v24, v3
    v_and_b32 v69, v25, v3
    v_lshlrev_b32 v24, 16, v23
    v_and_b32 v25, 0xffff0000, v23
    v_mul_f32 v26, s38, v24
    v_mul_f32 v27, s38, v25
    v_exp_f32 v26, v26
    v_exp_f32 v27, v27
    v_add_f32 v26, 1.0, v26
    v_add_f32 v27, 1.0, v27
    v_rcp_f32 v26, v26
    v_rcp_f32 v27, v27
    v_mul_f32 v24, v24, v26
    v_mul_f32 v25, v25, v27
    v_cvt_pk_bf16_f32 v24, v24, v24
    v_cvt_pk_bf16_f32 v25, v25, v25
    v_and_b32 v70, v24, v3
    v_and_b32 v71, v25, v3
L_w15:
    s_sleep 1
    ds_read_b32 v6, v0 offset:5048
    s_sub_u32 s3, s3, 1
    s_cbranch_scc1 L_end
    s_waitcnt lgkmcnt(0)
    v_cmp_gt_u32 vcc, 4, v6
    s_cbranch_vccnz L_w15
    s_add_u32 s39, s48, 0
    buffer_load_dwordx2 v[104:105], v2, s[44:47], s39 offen nt
    s_add_u32 s39, s48, 6144
    buffer_load_dwordx2 v[108:109], v2, s[44:47], s39 offen nt
    s_add_u32 s39, s48, 12288
    buffer_load_dwordx2 v[106:107], v2, s[44:47], s39 offen nt
    s_add_u32 s39, s48, 18432
    buffer_load_dwordx2 v[110:111], v2, s[44:47], s39 offen nt
    s_add_u32 s39, s48, 24576
    buffer_load_dwordx2 v[112:113], v2, s[44:47], s39 offen nt
    s_add_u32 s39, s48, 30720
    buffer_load_dwordx2 v[116:117], v2, s[44:47], s39 offen nt
    s_add_u32 s39, s48, 36864
    buffer_load_dwordx2 v[114:115], v2, s[44:47], s39 offen nt
    s_add_u32 s39, s48, 43008
    buffer_load_dwordx2 v[118:119], v2, s[44:47], s39 offen nt
    s_add_u32 s39, s48, 49152
    buffer_load_dwordx2 v[120:121], v2, s[44:47], s39 offen nt
    s_add_u32 s39, s48, 55296
    buffer_load_dwordx2 v[124:125], v2, s[44:47], s39 offen nt
    s_add_u32 s39, s48, 61440
    buffer_load_dwordx2 v[122:123], v2, s[44:47], s39 offen nt
    s_add_u32 s39, s48, 67584
    buffer_load_dwordx2 v[126:127], v2, s[44:47], s39 offen nt
    s_add_u32 s39, s48, 73728
    buffer_load_dwordx2 v[128:129], v2, s[44:47], s39 offen nt
    s_add_u32 s39, s48, 79872
    buffer_load_dwordx2 v[132:133], v2, s[44:47], s39 offen nt
    s_add_u32 s39, s48, 86016
    buffer_load_dwordx2 v[130:131], v2, s[44:47], s39 offen nt
    s_add_u32 s39, s48, 92160
    buffer_load_dwordx2 v[134:135], v2, s[44:47], s39 offen nt
    s_add_u32 s39, s48, 98304
    buffer_load_dwordx2 v[136:137], v2, s[44:47], s39 offen nt
    s_add_u32 s39, s48, 104448
    buffer_load_dwordx2 v[140:141], v2, s[44:47], s39 offen nt
    s_add_u32 s39, s48, 110592
    buffer_load_dwordx2 v[138:139], v2, s[44:47], s39 offen nt
    s_add_u32 s39, s48, 116736
    buffer_load_dwordx2 v[142:143], v2, s[44:47], s39 offen nt
    s_add_u32 s39, s48, 122880
    buffer_load_dwordx2 v[144:145], v2, s[44:47], s39 offen nt
    s_add_u32 s39, s48, 129024
    buffer_load_dwordx2 v[148:149], v2, s[44:47], s39 offen nt
    s_add_u32 s39, s48, 135168
    buffer_load_dwordx2 v[146:147], v2, s[44:47], s39 offen nt
    s_add_u32 s39, s48, 141312
    buffer_load_dwordx2 v[150:151], v2, s[44:47], s39 offen nt
    s_add_u32 s39, s48, 147456
    buffer_load_dwordx2 v[152:153], v2, s[44:47], s39 offen nt
    s_add_u32 s39, s48, 153600
    buffer_load_dwordx2 v[156:157], v2, s[44:47], s39 offen nt
    s_add_u32 s39, s48, 159744
    buffer_load_dwordx2 v[154:155], v2, s[44:47], s39 offen nt
    s_add_u32 s39, s48, 165888
    buffer_load_dwordx2 v[158:159], v2, s[44:47], s39 offen nt
    s_add_u32 s39, s48, 172032
    buffer_load_dwordx2 v[160:161], v2, s[44:47], s39 offen nt
    s_add_u32 s39, s48, 178176
    buffer_load_dwordx2 v[164:165], v2, s[44:47], s39 offen nt
    s_add_u32 s39, s48, 184320
    buffer_load_dwordx2 v[162:163], v2, s[44:47], s39 offen nt
    s_add_u32 s39, s48, 190464
    buffer_load_dwordx2 v[166:167], v2, s[44:47], s39 offen nt
    s_waitcnt vmcnt(31)
    v_mov_b32 v6, 1
    s_mov_b64 exec, 1
    ds_add_u32 v0, v6 offset:6060
    s_mov_b64 exec, -1
    s_waitcnt vmcnt(0)
    v_swap_b32 v105, v108
    v_swap_b32 v107, v110
    v_swap_b32 v113, v116
    v_swap_b32 v115, v118
    v_swap_b32 v121, v124
    v_swap_b32 v123, v126
    v_swap_b32 v129, v132
    v_swap_b32 v131, v134
    v_swap_b32 v137, v140
    v_swap_b32 v139, v142
    v_swap_b32 v145, v148
    v_swap_b32 v147, v150
    v_swap_b32 v153, v156
    v_swap_b32 v155, v158
    v_swap_b32 v161, v164
    v_swap_b32 v163, v166
    v_mfma_f32_16x16x32_bf16 v[24:27], v[40:43], v[104:107], 0
    v_mfma_f32_16x16x32_bf16 v[28:31], v[40:43], v[108:111], 0
    v_mfma_f32_16x16x32_bf16 v[24:27], v[44:47], v[112:115], v[24:27]
    v_mfma_f32_16x16x32_bf16 v[28:31], v[44:47], v[116:119], v[28:31]
    v_mfma_f32_16x16x32_bf16 v[24:27], v[48:51], v[120:123], v[24:27]
    v_mfma_f32_16x16x32_bf16 v[28:31], v[48:51], v[124:127], v[28:31]
    v_mfma_f32_16x16x32_bf16 v[24:27], v[52:55], v[128:131], v[24:27]
    v_mfma_f32_16x16x32_bf16 v[28:31], v[52:55], v[132:135], v[28:31]
    v_mfma_f32_16x16x32_bf16 v[24:27], v[56:59], v[136:139], v[24:27]
    v_mfma_f32_16x16x32_bf16 v[28:31], v[56:59], v[140:143], v[28:31]
    v_mfma_f32_16x16x32_bf16 v[24:27], v[60:63], v[144:147], v[24:27]
    v_mfma_f32_16x16x32_bf16 v[28:31], v[60:63], v[148:151], v[28:31]
    v_mfma_f32_16x16x32_bf16 v[24:27], v[64:67], v[152:155], v[24:27]
    v_mfma_f32_16x16x32_bf16 v[28:31], v[64:67], v[156:159], v[28:31]
    v_mfma_f32_16x16x32_bf16 v[24:27], v[68:71], v[160:163], v[24:27]
    v_mfma_f32_16x16x32_bf16 v[28:31], v[68:71], v[164:167], v[28:31]
    s_nop 6
    v_cvt_pk_bf16_f32 v8, v24, v25
    v_cvt_pk_bf16_f32 v10, v26, v27
    v_cvt_pk_bf16_f32 v9, v28, v29
    v_cvt_pk_bf16_f32 v11, v30, v31
L_w16:
    s_sleep 1
    ds_read_b32 v6, v0 offset:5052
    s_sub_u32 s3, s3, 1
    s_cbranch_scc1 L_end
    s_waitcnt lgkmcnt(0)
    v_cmp_gt_u32 vcc, 1, v6
    s_cbranch_vccnz L_w16
    buffer_store_dwordx2 v[8:9], v4, s[40:43], s49 offen sc1
    buffer_store_dwordx2 v[10:11], v4, s[40:43], s49 offen offset:1024 sc1
    s_branch L_end
L_B_uv:
    s_mov_b32 s44, s12
    s_mov_b32 s45, s13
    s_mov_b32 s46, 4194304
    s_mov_b32 s47, 0x20000

    v_lshrrev_b32 v4, 4, v1
    v_and_b32 v5, 15, v1
    v_lshlrev_b32 v2, 13, v4
    v_lshl_add_u32 v2, v5, 3, v2
    s_lshl_b32 s48, s62, 18
    s_lshl1_add_u32 s38, s35, s33
    s_lshl_b32 s38, s38, 7
    s_add_u32 s48, s48, s38
    v_mul_u32_u24 v3, 528, v5
    v_lshl_add_u32 v3, v4, 5, v3
    v_add_u32 v3, 141312, v3
    v_lshlrev_b32 v4, 4, v1
    s_lshl2_add_u32 s49, s35, s62
    s_lshl1_add_u32 s49, s49, s33
    s_lshl_b32 s49, s49, 10
    s_add_u32 s49, s49, 1835008
L_w17:
    s_sleep 1
    ds_read_b32 v6, v0 offset:5048
    s_sub_u32 s3, s3, 1
    s_cbranch_scc1 L_end
    s_waitcnt lgkmcnt(0)
    v_cmp_gt_u32 vcc, 4, v6
    s_cbranch_vccnz L_w17
    s_add_u32 s39, s48, 0
    buffer_load_dwordx2 v[104:105], v2, s[44:47], s39 offen nt
    s_add_u32 s39, s48, 1048576
    buffer_load_dwordx2 v[108:109], v2, s[44:47], s39 offen nt
    s_add_u32 s39, s48, 131072
    buffer_load_dwordx2 v[106:107], v2, s[44:47], s39 offen nt
    s_add_u32 s39, s48, 1179648
    buffer_load_dwordx2 v[110:111], v2, s[44:47], s39 offen nt
    s_add_u32 s39, s48, 2097152
    buffer_load_dwordx2 v[112:113], v2, s[44:47], s39 offen nt
    s_add_u32 s39, s48, 3145728
    buffer_load_dwordx2 v[116:117], v2, s[44:47], s39 offen nt
    s_add_u32 s39, s48, 2228224
    buffer_load_dwordx2 v[114:115], v2, s[44:47], s39 offen nt
    s_add_u32 s39, s48, 3276800
    buffer_load_dwordx2 v[118:119], v2, s[44:47], s39 offen nt
    s_add_u32 s39, s48, 32768
    buffer_load_dwordx2 v[120:121], v2, s[44:47], s39 offen nt
    s_add_u32 s39, s48, 1081344
    buffer_load_dwordx2 v[124:125], v2, s[44:47], s39 offen nt
    s_add_u32 s39, s48, 163840
    buffer_load_dwordx2 v[122:123], v2, s[44:47], s39 offen nt
    s_add_u32 s39, s48, 1212416
    buffer_load_dwordx2 v[126:127], v2, s[44:47], s39 offen nt
    s_add_u32 s39, s48, 2129920
    buffer_load_dwordx2 v[128:129], v2, s[44:47], s39 offen nt
    s_add_u32 s39, s48, 3178496
    buffer_load_dwordx2 v[132:133], v2, s[44:47], s39 offen nt
    s_add_u32 s39, s48, 2260992
    buffer_load_dwordx2 v[130:131], v2, s[44:47], s39 offen nt
    s_add_u32 s39, s48, 3309568
    buffer_load_dwordx2 v[134:135], v2, s[44:47], s39 offen nt
    s_add_u32 s39, s48, 65536
    buffer_load_dwordx2 v[136:137], v2, s[44:47], s39 offen nt
    s_add_u32 s39, s48, 1114112
    buffer_load_dwordx2 v[140:141], v2, s[44:47], s39 offen nt
    s_add_u32 s39, s48, 196608
    buffer_load_dwordx2 v[138:139], v2, s[44:47], s39 offen nt
    s_add_u32 s39, s48, 1245184
    buffer_load_dwordx2 v[142:143], v2, s[44:47], s39 offen nt
    s_add_u32 s39, s48, 2162688
    buffer_load_dwordx2 v[144:145], v2, s[44:47], s39 offen nt
    s_add_u32 s39, s48, 3211264
    buffer_load_dwordx2 v[148:149], v2, s[44:47], s39 offen nt
    s_add_u32 s39, s48, 2293760
    buffer_load_dwordx2 v[146:147], v2, s[44:47], s39 offen nt
    s_add_u32 s39, s48, 3342336
    buffer_load_dwordx2 v[150:151], v2, s[44:47], s39 offen nt
    s_add_u32 s39, s48, 98304
    buffer_load_dwordx2 v[152:153], v2, s[44:47], s39 offen nt
    s_add_u32 s39, s48, 1146880
    buffer_load_dwordx2 v[156:157], v2, s[44:47], s39 offen nt
    s_add_u32 s39, s48, 229376
    buffer_load_dwordx2 v[154:155], v2, s[44:47], s39 offen nt
    s_add_u32 s39, s48, 1277952
    buffer_load_dwordx2 v[158:159], v2, s[44:47], s39 offen nt
    s_add_u32 s39, s48, 2195456
    buffer_load_dwordx2 v[160:161], v2, s[44:47], s39 offen nt
    s_add_u32 s39, s48, 3244032
    buffer_load_dwordx2 v[164:165], v2, s[44:47], s39 offen nt
    s_add_u32 s39, s48, 2326528
    buffer_load_dwordx2 v[162:163], v2, s[44:47], s39 offen nt
    s_add_u32 s39, s48, 3375104
    buffer_load_dwordx2 v[166:167], v2, s[44:47], s39 offen nt
    s_waitcnt vmcnt(31)
    v_mov_b32 v6, 1
    s_mov_b64 exec, 1
    ds_add_u32 v0, v6 offset:6060
    s_mov_b64 exec, -1
    s_waitcnt vmcnt(0)
    v_swap_b32 v105, v108
    v_swap_b32 v107, v110
    v_swap_b32 v113, v116
    v_swap_b32 v115, v118
    v_swap_b32 v121, v124
    v_swap_b32 v123, v126
    v_swap_b32 v129, v132
    v_swap_b32 v131, v134
    v_swap_b32 v137, v140
    v_swap_b32 v139, v142
    v_swap_b32 v145, v148
    v_swap_b32 v147, v150
    v_swap_b32 v153, v156
    v_swap_b32 v155, v158
    v_swap_b32 v161, v164
    v_swap_b32 v163, v166
L_w18:
    s_sleep 1
    ds_read_b32 v6, v0 offset:6048
    s_sub_u32 s3, s3, 1
    s_cbranch_scc1 L_end
    s_waitcnt lgkmcnt(0)
    v_cmp_gt_u32 vcc, 1, v6
    s_cbranch_vccnz L_w18
    s_setprio 2
L_w19:
    ds_read_b32 v6, v0 offset:6048
    s_sub_u32 s3, s3, 1
    s_cbranch_scc1 L_end
    s_waitcnt lgkmcnt(0)
    v_cmp_gt_u32 vcc, 4, v6
    s_cbranch_vccnz L_w19
    ds_read_b128 v[40:43], v3 offset:0
    ds_read_b128 v[44:47], v3 offset:16
    ds_read_b128 v[48:51], v3 offset:128
    ds_read_b128 v[52:55], v3 offset:144
    ds_read_b128 v[56:59], v3 offset:256
    ds_read_b128 v[60:63], v3 offset:272
    ds_read_b128 v[64:67], v3 offset:384
    ds_read_b128 v[68:71], v3 offset:400
    s_waitcnt lgkmcnt(7)
    v_mfma_f32_16x16x32_bf16 v[24:27], v[40:43], v[104:107], 0
    v_mfma_f32_16x16x32_bf16 v[28:31], v[40:43], v[108:111], 0
    s_waitcnt lgkmcnt(6)
    v_mfma_f32_16x16x32_bf16 v[24:27], v[44:47], v[112:115], v[24:27]
    v_mfma_f32_16x16x32_bf16 v[28:31], v[44:47], v[116:119], v[28:31]
    s_waitcnt lgkmcnt(5)
    v_mfma_f32_16x16x32_bf16 v[24:27], v[48:51], v[120:123], v[24:27]
    v_mfma_f32_16x16x32_bf16 v[28:31], v[48:51], v[124:127], v[28:31]
    s_waitcnt lgkmcnt(4)
    v_mfma_f32_16x16x32_bf16 v[24:27], v[52:55], v[128:131], v[24:27]
    v_mfma_f32_16x16x32_bf16 v[28:31], v[52:55], v[132:135], v[28:31]
    s_waitcnt lgkmcnt(3)
    v_mfma_f32_16x16x32_bf16 v[24:27], v[56:59], v[136:139], v[24:27]
    v_mfma_f32_16x16x32_bf16 v[28:31], v[56:59], v[140:143], v[28:31]
    s_waitcnt lgkmcnt(2)
    v_mfma_f32_16x16x32_bf16 v[24:27], v[60:63], v[144:147], v[24:27]
    v_mfma_f32_16x16x32_bf16 v[28:31], v[60:63], v[148:151], v[28:31]
    s_waitcnt lgkmcnt(1)
    v_mfma_f32_16x16x32_bf16 v[24:27], v[64:67], v[152:155], v[24:27]
    v_mfma_f32_16x16x32_bf16 v[28:31], v[64:67], v[156:159], v[28:31]
    s_waitcnt lgkmcnt(0)
    v_mfma_f32_16x16x32_bf16 v[24:27], v[68:71], v[160:163], v[24:27]
    v_mfma_f32_16x16x32_bf16 v[28:31], v[68:71], v[164:167], v[28:31]
    s_nop 6
    v_cvt_pk_bf16_f32 v8, v24, v25
    v_cvt_pk_bf16_f32 v10, v26, v27
    v_cvt_pk_bf16_f32 v9, v28, v29
    v_cvt_pk_bf16_f32 v11, v30, v31
    buffer_store_dwordx4 v[8:11], v4, s[40:43], s49 offen sc1
    s_waitcnt vmcnt(0)
    v_mov_b32 v6, 1
    s_mov_b64 exec, 1
    ds_add_u32 v0, v6 offset:6052
    s_mov_b64 exec, -1
    s_branch L_end
L_Be:
    s_waitcnt lgkmcnt(0)
    s_cmp_lg_u32 s33, 0
    s_cbranch_scc1 L_B_t1
    v_lshrrev_b32 v2, 1, v1
    v_and_b32 v3, 1, v1
    v_and_b32 v4, 24, v2
    v_and_b32 v2, 7, v2
    v_lshl_add_u32 v2, v4, 2, v2
    v_lshl_add_u32 v2, v2, 6, v3
    s_and_b32 s38, s34, 3
    s_lshl_b32 s38, s38, 12
    s_add_u32 s38, s38, s35
    s_lshl_b32 s38, s38, 8
    v_lshl_add_u32 v2, v2, 7, s38
    global_load_dword v166, v2, s[8:9]
L_B_t1:
    s_mov_b32 s40, s30
    s_mov_b32 s41, s31
    s_mov_b32 s42, 16777216
    s_mov_b32 s43, 0x20000

    s_mov_b32 s3, 0x400000
    v_mov_b32 v0, 156256
    s_and_b32 s62, s34, 3
    s_lshl2_add_u32 s97, s62, s37
    s_lshl4_add_u32 s61, s36, s97

    s_barrier
    s_cmp_eq_u32 s33, 0
    s_cbranch_scc1 L_B_nt
    v_lshrrev_b32 v2, 1, v1
    v_and_b32 v3, 1, v1
    s_lshl2_add_u32 s38, s33, s34
    s_sub_u32 s38, s38, 4
    v_lshl_add_u32 v2, v2, 6, v3
    s_lshl_b32 s38, s38, 10
    s_add_u32 s38, s38, s35
    s_lshl_b32 s38, s38, 8
    v_lshl_add_u32 v2, v2, 7, s38
    s_mov_b64 exec, 1
    global_load_dword v166, v2, s[10:11]
    s_mov_b64 exec, -1
    s_waitcnt vmcnt(0)
    global_load_dword v166, v2, s[10:11]
    v_mov_b32 v3, 1
    s_mov_b64 exec, 1
    ds_add_u32 v0, v3 offset:4
    s_mov_b64 exec, -1
L_B_nt:

    v_and_b32 v5, 31, v1
    v_lshrrev_b32 v7, 5, v1
    v_bfe_u32 v2, v5, 1, 1
    v_lshlrev_b32 v2, 2, v2
    v_bfe_u32 v3, v5, 2, 2
    v_or_b32 v2, v2, v3
    v_xor_b32 v2, v2, v7
    v_lshlrev_b32 v2, 4, v2
    v_lshl_add_u32 v2, v5, 7, v2
    s_lshl_b32 s38, s33, 12
    v_add_u32 v2, s38, v2
    v_mov_b32 v8, v2
    v_xor_b32 v9, 32, v2
    v_xor_b32 v10, 64, v2
    v_xor_b32 v11, 0x60, v2
    v_mul_u32_u24 v4, 1008, v5
    v_lshl_add_u32 v4, v7, 4, v4
    v_add_u32 v4, 131072, v4
    v_lshlrev_b32 v12, 10, v5
    v_lshl_add_u32 v7, v7, 4, v12
    v_lshl_add_u32 v5, v5, 4, v0
    s_lshl_b32 s53, s33, 2
    v_add_u32 v6, s53, v0
    s_lshl_b32 s50, s36, 15
    s_add_u32 s50, s50, 65536
    s_lshl_b32 s51, s33, 13
    s_add_u32 s51, s51, s50
    s_mul_i32 s49, s33, 8064
    s_add_u32 s49, s49, 131072
    s_mov_b32 s52, 0x3e0293ee
    s_mov_b32 s56, -1
    s_mov_b32 s57, 0x3fffffff
L_w20:
    s_sleep 1
    ds_read_b32 v3, v6 offset:4032
    s_sub_u32 s3, s3, 1
    s_cbranch_scc1 L_end
    s_waitcnt lgkmcnt(0)
    v_cmp_gt_u32 vcc, 2, v3
    s_cbranch_vccnz L_w20
    ds_read_b128 v[40:43], v8 offset:0
    ds_read_b128 v[44:47], v9 offset:0
    ds_read_b128 v[48:51], v10 offset:0
    ds_read_b128 v[52:55], v11 offset:0
    ds_read_b128 v[56:59], v8 offset:16384
    ds_read_b128 v[60:63], v9 offset:16384
    ds_read_b128 v[64:67], v10 offset:16384
    ds_read_b128 v[68:71], v11 offset:16384
    v_mov_b32 v3, 1
    s_mov_b64 exec, 1
    ds_add_u32 v0, v3 offset:3024
    s_mov_b64 exec, -1
L_w21:
    s_sleep 1
    ds_read_b32 v3, v6 offset:4032
    s_sub_u32 s3, s3, 1
    s_cbranch_scc1 L_end
    s_waitcnt lgkmcnt(0)
    v_cmp_gt_u32 vcc, 4, v3
    s_cbranch_vccnz L_w21
    ds_read_b128 v[72:75], v8 offset:32768
    ds_read_b128 v[76:79], v9 offset:32768
    ds_read_b128 v[80:83], v10 offset:32768
    ds_read_b128 v[84:87], v11 offset:32768
    ds_read_b128 v[88:91], v8 offset:49152
    ds_read_b128 v[92:95], v9 offset:49152
    ds_read_b128 v[96:99], v10 offset:49152
    ds_read_b128 v[100:103], v11 offset:49152
    v_mov_b32 v3, 1
    s_mov_b64 exec, 1
    ds_add_u32 v0, v3 offset:3028
    s_mov_b64 exec, -1
    v_mov_b32 v3, 0
    v_mov_b32 v13, 0
    v_mov_b32 v14, 0
    s_waitcnt vmcnt(0)
L_B_f2:
    global_load_dword v12, v3, s[28:29] offset:128 sc1
    s_sub_u32 s3, s3, 1
    s_cbranch_scc1 L_end
    s_sleep 4
    s_waitcnt vmcnt(2)
    v_cmp_ne_u32 vcc, 0, v13
    s_cbranch_vccnz L_B_f2d
    global_load_dword v13, v3, s[28:29] offset:128 sc1
    s_sub_u32 s3, s3, 1
    s_cbranch_scc1 L_end
    s_sleep 4
    s_waitcnt vmcnt(2)
    v_cmp_ne_u32 vcc, 0, v14
    s_cbranch_vccnz L_B_f2d
    global_load_dword v14, v3, s[28:29] offset:128 sc1
    s_sub_u32 s3, s3, 1
    s_cbranch_scc1 L_end
    s_sleep 4
    s_waitcnt vmcnt(2)
    v_cmp_ne_u32 vcc, 0, v12
    s_cbranch_vccnz L_B_f2d
    s_branch L_B_f2
L_B_f2d:
    s_setprio 3
    v_lshlrev_b32 v3, 4, v1
    s_mov_b32 m0, s49
    s_mov_b32 s38, s51
    s_mov_b64 exec, s[56:57]
    buffer_load_dwordx4 v3, s[40:43], s38 offen sc1 lds
    s_add_u32 m0, m0, 1008
    s_add_u32 s38, s38, 1024
    buffer_load_dwordx4 v3, s[40:43], s38 offen sc1 lds
    s_add_u32 m0, m0, 1008
    s_add_u32 s38, s38, 1024
    buffer_load_dwordx4 v3, s[40:43], s38 offen sc1 lds
    s_add_u32 m0, m0, 1008
    s_add_u32 s38, s38, 1024
    buffer_load_dwordx4 v3, s[40:43], s38 offen sc1 lds
    s_add_u32 m0, m0, 1008
    s_add_u32 s38, s38, 1024
    buffer_load_dwordx4 v3, s[40:43], s38 offen sc1 lds
    s_add_u32 m0, m0, 1008
    s_add_u32 s38, s38, 1024
    buffer_load_dwordx4 v3, s[40:43], s38 offen sc1 lds
    s_add_u32 m0, m0, 1008
    s_add_u32 s38, s38, 1024
    buffer_load_dwordx4 v3, s[40:43], s38 offen sc1 lds
    s_add_u32 m0, m0, 1008
    s_add_u32 s38, s38, 1024
    buffer_load_dwordx4 v3, s[40:43], s38 offen sc1 lds
    s_mov_b64 exec, -1
    buffer_load_dwordx4 v[24:27], v7, s[40:43], s50 offen offset:992 sc1
    v_mov_b32 v3, 1
    s_mov_b64 exec, 1
    ds_add_u32 v0, v3 offset:2028
    s_mov_b64 exec, -1
L_w22:
    s_sleep 1
    ds_read_b32 v3, v6 offset:4032
    s_sub_u32 s3, s3, 1
    s_cbranch_scc1 L_end
    s_waitcnt lgkmcnt(0)
    v_cmp_gt_u32 vcc, 6, v3
    s_cbranch_vccnz L_w22
    v_add_u32 v8, 0x10000, v8
    v_add_u32 v9, 0x10000, v9
    v_add_u32 v10, 0x10000, v10
    v_add_u32 v11, 0x10000, v11
    ds_read_b128 v[104:107], v8 offset:0
    ds_read_b128 v[108:111], v9 offset:0
    ds_read_b128 v[112:115], v10 offset:0
    ds_read_b128 v[116:119], v11 offset:0
    ds_read_b128 v[120:123], v8 offset:16384
    ds_read_b128 v[124:127], v9 offset:16384
    ds_read_b128 v[128:131], v10 offset:16384
    ds_read_b128 v[132:135], v11 offset:16384
    v_mov_b32 v3, 1
    s_mov_b64 exec, 1
    ds_add_u32 v0, v3 offset:3032
    s_mov_b64 exec, -1
L_w23:
    s_sleep 1
    ds_read_b32 v3, v6 offset:4032
    s_sub_u32 s3, s3, 1
    s_cbranch_scc1 L_end
    s_waitcnt lgkmcnt(0)
    v_cmp_gt_u32 vcc, 8, v3
    s_cbranch_vccnz L_w23
    ds_read_b128 v[136:139], v8 offset:32768
    ds_read_b128 v[140:143], v9 offset:32768
    ds_read_b128 v[144:147], v10 offset:32768
    ds_read_b128 v[148:151], v11 offset:32768
    ds_read_b128 v[152:155], v8 offset:49152
    ds_read_b128 v[156:159], v9 offset:49152
    ds_read_b128 v[160:163], v10 offset:49152
    ds_read_b128 v[164:167], v11 offset:49152
    v_mov_b32 v3, 1
    s_mov_b64 exec, 1
    ds_add_u32 v0, v3 offset:3036
    s_mov_b64 exec, -1
    s_branch L_B_qv
L_B_qr:
    v_lshlrev_b32 v3, 4, v1
    s_mov_b32 m0, s49
    s_mov_b32 s38, s51
    s_mov_b64 exec, s[56:57]
    buffer_load_dwordx4 v3, s[40:43], s38 offen sc1 lds
    s_add_u32 m0, m0, 1008
    s_add_u32 s38, s38, 1024
    buffer_load_dwordx4 v3, s[40:43], s38 offen sc1 lds
    s_add_u32 m0, m0, 1008
    s_add_u32 s38, s38, 1024
    buffer_load_dwordx4 v3, s[40:43], s38 offen sc1 lds
    s_add_u32 m0, m0, 1008
    s_add_u32 s38, s38, 1024
    buffer_load_dwordx4 v3, s[40:43], s38 offen sc1 lds
    s_add_u32 m0, m0, 1008
    s_add_u32 s38, s38, 1024
    buffer_load_dwordx4 v3, s[40:43], s38 offen sc1 lds
    s_add_u32 m0, m0, 1008
    s_add_u32 s38, s38, 1024
    buffer_load_dwordx4 v3, s[40:43], s38 offen sc1 lds
    s_add_u32 m0, m0, 1008
    s_add_u32 s38, s38, 1024
    buffer_load_dwordx4 v3, s[40:43], s38 offen sc1 lds
    s_add_u32 m0, m0, 1008
    s_add_u32 s38, s38, 1024
    buffer_load_dwordx4 v3, s[40:43], s38 offen sc1 lds
    s_mov_b64 exec, -1
    buffer_load_dwordx4 v[24:27], v7, s[40:43], s50 offen offset:992 sc1
    s_sub_u32 s3, s3, 1
    s_cbranch_scc1 L_end
L_B_qv:
    v_lshl_add_u32 v3, v1, 4, s49
    s_waitcnt vmcnt(0) lgkmcnt(0)
    v_max3_u32 v6, v24, v25, v26
    v_max_u32 v6, v6, v27
    s_mov_b64 exec, s[56:57]
    ds_read_b128 v[8:11], v3 offset:0
    ds_read_b128 v[12:15], v3 offset:1008
    ds_read_b128 v[16:19], v3 offset:2016
    ds_read_b128 v[20:23], v3 offset:3024
    ds_read_b128 v[28:31], v3 offset:4032
    ds_read_b128 v[32:35], v3 offset:5040
    ds_read_b128 v[36:39], v3 offset:6048
    s_waitcnt lgkmcnt(6)
    v_max3_u32 v6, v6, v8, v9
    v_max3_u32 v6, v6, v10, v11
    ds_read_b128 v[8:11], v3 offset:7056
    s_waitcnt lgkmcnt(6)
    v_max3_u32 v6, v6, v12, v13
    v_max3_u32 v6, v6, v14, v15
    s_waitcnt lgkmcnt(5)
    v_max3_u32 v6, v6, v16, v17
    v_max3_u32 v6, v6, v18, v19
    s_waitcnt lgkmcnt(4)
    v_max3_u32 v6, v6, v20, v21
    v_max3_u32 v6, v6, v22, v23
    s_waitcnt lgkmcnt(3)
    v_max3_u32 v6, v6, v28, v29
    v_max3_u32 v6, v6, v30, v31
    s_waitcnt lgkmcnt(2)
    v_max3_u32 v6, v6, v32, v33
    v_max3_u32 v6, v6, v34, v35
    s_waitcnt lgkmcnt(1)
    v_max3_u32 v6, v6, v36, v37
    v_max3_u32 v6, v6, v38, v39
    s_waitcnt lgkmcnt(0)
    v_max3_u32 v6, v6, v8, v9
    v_max3_u32 v6, v6, v10, v11
    s_mov_b64 exec, -1
    v_cmp_eq_u32 vcc, -1, v6
    s_cbranch_vccnz L_B_qr
    v_mov_b32 v3, 1
    s_mov_b64 exec, 1
    ds_add_u32 v0, v3 offset:1008
    s_mov_b64 exec, -1
    s_setprio 2
L_w24:
    ds_read_b32 v3, v0 offset:1008
    s_sub_u32 s3, s3, 1
    s_cbranch_scc1 L_end
    s_waitcnt lgkmcnt(0)
    v_cmp_gt_u32 vcc, 4, v3
    s_cbranch_vccnz L_w24
    ds_read_b128 v[28:31], v4 offset:0
    ds_read_b128 v[32:35], v4 offset:32
    ds_read_b128 v[36:39], v4 offset:64
    s_waitcnt lgkmcnt(2)
    v_mfma_f32_32x32x16_bf16 v[8:23], v[40:43], v[28:31], 0
    ds_read_b128 v[40:43], v4 offset:96
    s_waitcnt lgkmcnt(2)
    v_mfma_f32_32x32x16_bf16 v[8:23], v[44:47], v[32:35], v[8:23]
    ds_read_b128 v[44:47], v4 offset:128
    s_waitcnt lgkmcnt(2)
    v_mfma_f32_32x32x16_bf16 v[8:23], v[48:51], v[36:39], v[8:23]
    ds_read_b128 v[48:51], v4 offset:160
    s_waitcnt lgkmcnt(2)
    v_mfma_f32_32x32x16_bf16 v[8:23], v[52:55], v[40:43], v[8:23]
    ds_read_b128 v[52:55], v4 offset:192
    s_waitcnt lgkmcnt(2)
    v_mfma_f32_32x32x16_bf16 v[8:23], v[56:59], v[44:47], v[8:23]
    ds_read_b128 v[56:59], v4 offset:224
    s_waitcnt lgkmcnt(2)
    v_mfma_f32_32x32x16_bf16 v[8:23], v[60:63], v[48:51], v[8:23]
    ds_read_b128 v[60:63], v4 offset:256
    s_waitcnt lgkmcnt(2)
    v_mfma_f32_32x32x16_bf16 v[8:23], v[64:67], v[52:55], v[8:23]
    ds_read_b128 v[64:67], v4 offset:288
    s_waitcnt lgkmcnt(2)
    v_mfma_f32_32x32x16_bf16 v[8:23], v[68:71], v[56:59], v[8:23]
    ds_read_b128 v[68:71], v4 offset:320
    s_waitcnt lgkmcnt(2)
    v_mfma_f32_32x32x16_bf16 v[8:23], v[72:75], v[60:63], v[8:23]
    ds_read_b128 v[72:75], v4 offset:352
    s_waitcnt lgkmcnt(2)
    v_mfma_f32_32x32x16_bf16 v[8:23], v[76:79], v[64:67], v[8:23]
    ds_read_b128 v[76:79], v4 offset:384
    s_waitcnt lgkmcnt(2)
    v_mfma_f32_32x32x16_bf16 v[8:23], v[80:83], v[68:71], v[8:23]
    ds_read_b128 v[80:83], v4 offset:416
    s_waitcnt lgkmcnt(2)
    v_mfma_f32_32x32x16_bf16 v[8:23], v[84:87], v[72:75], v[8:23]
    ds_read_b128 v[84:87], v4 offset:448
    s_waitcnt lgkmcnt(2)
    v_mfma_f32_32x32x16_bf16 v[8:23], v[88:91], v[76:79], v[8:23]
    ds_read_b128 v[88:91], v4 offset:480
    s_waitcnt lgkmcnt(2)
    v_mfma_f32_32x32x16_bf16 v[8:23], v[92:95], v[80:83], v[8:23]
    ds_read_b128 v[92:95], v4 offset:512
    s_waitcnt lgkmcnt(2)
    v_mfma_f32_32x32x16_bf16 v[8:23], v[96:99], v[84:87], v[8:23]
    ds_read_b128 v[96:99], v4 offset:544
    s_waitcnt lgkmcnt(2)
    v_mfma_f32_32x32x16_bf16 v[8:23], v[100:103], v[88:91], v[8:23]
    ds_read_b128 v[100:103], v4 offset:576
    s_waitcnt lgkmcnt(2)
    v_mfma_f32_32x32x16_bf16 v[8:23], v[104:107], v[92:95], v[8:23]
    ds_read_b128 v[104:107], v4 offset:608
    s_waitcnt lgkmcnt(2)
    v_mfma_f32_32x32x16_bf16 v[8:23], v[108:111], v[96:99], v[8:23]
    ds_read_b128 v[108:111], v4 offset:640
    s_waitcnt lgkmcnt(2)
    v_mfma_f32_32x32x16_bf16 v[8:23], v[112:115], v[100:103], v[8:23]
    ds_read_b128 v[112:115], v4 offset:672
    s_waitcnt lgkmcnt(2)
    v_mfma_f32_32x32x16_bf16 v[8:23], v[116:119], v[104:107], v[8:23]
    ds_read_b128 v[116:119], v4 offset:704
    s_waitcnt lgkmcnt(2)
    v_mfma_f32_32x32x16_bf16 v[8:23], v[120:123], v[108:111], v[8:23]
    ds_read_b128 v[120:123], v4 offset:736
    s_waitcnt lgkmcnt(2)
    v_mfma_f32_32x32x16_bf16 v[8:23], v[124:127], v[112:115], v[8:23]
    ds_read_b128 v[124:127], v4 offset:768
    s_waitcnt lgkmcnt(2)
    v_mfma_f32_32x32x16_bf16 v[8:23], v[128:131], v[116:119], v[8:23]
    ds_read_b128 v[128:131], v4 offset:800
    s_waitcnt lgkmcnt(2)
    v_mfma_f32_32x32x16_bf16 v[8:23], v[132:135], v[120:123], v[8:23]
    ds_read_b128 v[132:135], v4 offset:832
    s_waitcnt lgkmcnt(2)
    v_mfma_f32_32x32x16_bf16 v[8:23], v[136:139], v[124:127], v[8:23]
    ds_read_b128 v[136:139], v4 offset:864
    s_waitcnt lgkmcnt(2)
    v_mfma_f32_32x32x16_bf16 v[8:23], v[140:143], v[128:131], v[8:23]
    ds_read_b128 v[140:143], v4 offset:896
    s_waitcnt lgkmcnt(2)
    v_mfma_f32_32x32x16_bf16 v[8:23], v[144:147], v[132:135], v[8:23]
    ds_read_b128 v[144:147], v4 offset:928
    s_waitcnt lgkmcnt(2)
    v_mfma_f32_32x32x16_bf16 v[8:23], v[148:151], v[136:139], v[8:23]
    ds_read_b128 v[148:151], v4 offset:960
    s_waitcnt lgkmcnt(2)
    v_mfma_f32_32x32x16_bf16 v[8:23], v[152:155], v[140:143], v[8:23]
    s_waitcnt lgkmcnt(1)
    v_mfma_f32_32x32x16_bf16 v[8:23], v[156:159], v[144:147], v[8:23]
    s_waitcnt lgkmcnt(0)
    v_mfma_f32_32x32x16_bf16 v[8:23], v[160:163], v[148:151], v[8:23]
    v_mfma_f32_32x32x16_bf16 v[8:23], v[164:167], v[24:27], v[8:23]
    v_add_u32 v4, s53, v0
    v_add_u32 v166, s53, v5
    s_lshl_b32 s38, s33, 11
    s_add_u32 s38, s38, 131072
    v_lshl_add_u32 v167, v1, 4, s38
    s_nop 6
    v_max3_f32 v164, v8, v9, v10
    v_max3_f32 v165, v11, v12, v13
    v_max3_f32 v164, v164, v14, v15
    v_max3_f32 v165, v165, v16, v17
    v_max3_f32 v164, v164, v18, v19
    v_max3_f32 v165, v165, v20, v21
    v_max3_f32 v164, v164, v22, v23
    v_max_f32 v164, v164, v165
    v_mov_b32 v165, v164
    s_nop 1
    v_permlane32_swap_b32 v164, v165
    v_max_f32 v164, v164, v165
    ds_write_b32 v166, v164 offset:7072
L_B_mx0:
    ds_read_b128 v[160:163], v5 offset:7072
    s_sub_u32 s3, s3, 1
    s_cbranch_scc1 L_end
    s_waitcnt lgkmcnt(0)
    v_max3_u32 v164, v160, v161, v162
    v_max_u32 v164, v164, v163
    v_cmp_eq_u32 vcc, -1, v164
    s_cbranch_vccnz L_B_mx0
    v_max3_f32 v164, v160, v161, v162
    v_max_f32 v164, v164, v163
    v_mul_f32 v6, s52, v164
    v_add_u32 v5, -8800, v5
    v_add_u32 v166, s53, v5
    v_mov_b32 v165, -1
    ds_write_b32 v166, v165
    v_fma_f32 v8, v8, s52, -v6
    v_fma_f32 v9, v9, s52, -v6
    v_fma_f32 v10, v10, s52, -v6
    v_fma_f32 v11, v11, s52, -v6
    v_fma_f32 v12, v12, s52, -v6
    v_fma_f32 v13, v13, s52, -v6
    v_fma_f32 v14, v14, s52, -v6
    v_fma_f32 v15, v15, s52, -v6
    v_exp_f32 v8, v8
    v_exp_f32 v9, v9
    v_exp_f32 v10, v10
    v_exp_f32 v11, v11
    v_exp_f32 v12, v12
    v_exp_f32 v13, v13
    v_exp_f32 v14, v14
    v_exp_f32 v15, v15
    v_cvt_pk_bf16_f32 v152, v8, v9
    v_cvt_pk_bf16_f32 v153, v10, v11
    v_cvt_pk_bf16_f32 v154, v12, v13
    v_cvt_pk_bf16_f32 v155, v14, v15
    ds_write_b128 v167, v[152:155] offset:0
    v_fma_f32 v16, v16, s52, -v6
    v_fma_f32 v17, v17, s52, -v6
    v_fma_f32 v18, v18, s52, -v6
    v_fma_f32 v19, v19, s52, -v6
    v_fma_f32 v20, v20, s52, -v6
    v_fma_f32 v21, v21, s52, -v6
    v_fma_f32 v22, v22, s52, -v6
    v_fma_f32 v23, v23, s52, -v6
    v_exp_f32 v16, v16
    v_exp_f32 v17, v17
    v_exp_f32 v18, v18
    v_exp_f32 v19, v19
    v_exp_f32 v20, v20
    v_exp_f32 v21, v21
    v_exp_f32 v22, v22
    v_exp_f32 v23, v23
    v_cvt_pk_bf16_f32 v156, v16, v17
    v_cvt_pk_bf16_f32 v157, v18, v19
    v_cvt_pk_bf16_f32 v158, v20, v21
    v_cvt_pk_bf16_f32 v159, v22, v23
    ds_write_b128 v167, v[156:159] offset:1024
    v_mov_b32 v164, 1
    s_mov_b64 exec, 1
    ds_add_u32 v0, v164 offset:1016
    s_mov_b64 exec, -1
    v_pk_add_f32 v[8:9], v[8:9], v[16:17]
    v_pk_add_f32 v[10:11], v[10:11], v[18:19]
    v_pk_add_f32 v[12:13], v[12:13], v[20:21]
    v_pk_add_f32 v[14:15], v[14:15], v[22:23]
    v_pk_add_f32 v[8:9], v[8:9], v[12:13]
    v_pk_add_f32 v[10:11], v[10:11], v[14:15]
    v_pk_add_f32 v[8:9], v[8:9], v[10:11]
    v_add_f32 v7, v8, v9
L_w25:
    ds_read_b32 v3, v0 offset:1016
    s_sub_u32 s3, s3, 1
    s_cbranch_scc1 L_end
    s_waitcnt lgkmcnt(0)
    v_cmp_gt_u32 vcc, 4, v3
    s_cbranch_vccnz L_w25
L_w26:
    ds_read_b32 v3, v4 offset:4032
    s_sub_u32 s3, s3, 1
    s_cbranch_scc1 L_end
    s_waitcnt lgkmcnt(0)
    v_cmp_gt_u32 vcc, 10, v3
    s_cbranch_vccnz L_w26
    ds_read_b128 v[152:155], v2 offset:0
    v_xor_b32 v3, 32, v2
    ds_read_b128 v[156:159], v3 offset:0
    v_xor_b32 v3, 64, v2
    ds_read_b128 v[160:163], v3 offset:0
    v_xor_b32 v3, 96, v2
    ds_read_b128 v[164:167], v3 offset:0
    s_waitcnt lgkmcnt(3)
    v_mfma_f32_32x32x16_bf16 v[8:23], v[152:155], v[28:31], 0
    ds_read_b128 v[152:155], v2 offset:16384
    s_waitcnt lgkmcnt(3)
    v_mfma_f32_32x32x16_bf16 v[8:23], v[156:159], v[32:35], v[8:23]
    v_xor_b32 v3, 32, v2
    ds_read_b128 v[156:159], v3 offset:16384
    s_waitcnt lgkmcnt(3)
    v_mfma_f32_32x32x16_bf16 v[8:23], v[160:163], v[36:39], v[8:23]
    v_xor_b32 v3, 64, v2
    ds_read_b128 v[160:163], v3 offset:16384
    s_waitcnt lgkmcnt(3)
    v_mfma_f32_32x32x16_bf16 v[8:23], v[164:167], v[40:43], v[8:23]
    v_xor_b32 v3, 96, v2
    ds_read_b128 v[164:167], v3 offset:16384
    s_waitcnt lgkmcnt(3)
    v_mfma_f32_32x32x16_bf16 v[8:23], v[152:155], v[44:47], v[8:23]
L_w27:
    ds_read_b32 v3, v4 offset:4032
    s_sub_u32 s3, s3, 1
    s_cbranch_scc1 L_end
    s_waitcnt lgkmcnt(0)
    v_cmp_gt_u32 vcc, 12, v3
    s_cbranch_vccnz L_w27
    ds_read_b128 v[152:155], v2 offset:32768
    s_waitcnt lgkmcnt(3)
    v_mfma_f32_32x32x16_bf16 v[8:23], v[156:159], v[48:51], v[8:23]
    v_xor_b32 v3, 32, v2
    ds_read_b128 v[156:159], v3 offset:32768
    s_waitcnt lgkmcnt(3)
    v_mfma_f32_32x32x16_bf16 v[8:23], v[160:163], v[52:55], v[8:23]
    v_xor_b32 v3, 64, v2
    ds_read_b128 v[160:163], v3 offset:32768
    s_waitcnt lgkmcnt(3)
    v_mfma_f32_32x32x16_bf16 v[8:23], v[164:167], v[56:59], v[8:23]
    v_xor_b32 v3, 96, v2
    ds_read_b128 v[164:167], v3 offset:32768
    s_waitcnt lgkmcnt(3)
    v_mfma_f32_32x32x16_bf16 v[8:23], v[152:155], v[60:63], v[8:23]
    ds_read_b128 v[152:155], v2 offset:49152
    s_waitcnt lgkmcnt(3)
    v_mfma_f32_32x32x16_bf16 v[8:23], v[156:159], v[64:67], v[8:23]
    v_xor_b32 v3, 32, v2
    ds_read_b128 v[156:159], v3 offset:49152
    s_waitcnt lgkmcnt(3)
    v_mfma_f32_32x32x16_bf16 v[8:23], v[160:163], v[68:71], v[8:23]
    v_xor_b32 v3, 64, v2
    ds_read_b128 v[160:163], v3 offset:49152
    s_waitcnt lgkmcnt(3)
    v_mfma_f32_32x32x16_bf16 v[8:23], v[164:167], v[72:75], v[8:23]
    v_xor_b32 v3, 96, v2
    ds_read_b128 v[164:167], v3 offset:49152
    s_waitcnt lgkmcnt(3)
    v_mfma_f32_32x32x16_bf16 v[8:23], v[152:155], v[76:79], v[8:23]
    v_add_u32 v2, 0x10000, v2
L_w28:
    ds_read_b32 v3, v4 offset:4032
    s_sub_u32 s3, s3, 1
    s_cbranch_scc1 L_end
    s_waitcnt lgkmcnt(0)
    v_cmp_gt_u32 vcc, 14, v3
    s_cbranch_vccnz L_w28
    ds_read_b128 v[152:155], v2 offset:0
    s_waitcnt lgkmcnt(3)
    v_mfma_f32_32x32x16_bf16 v[8:23], v[156:159], v[80:83], v[8:23]
    v_xor_b32 v3, 32, v2
    ds_read_b128 v[156:159], v3 offset:0
    s_waitcnt lgkmcnt(3)
    v_mfma_f32_32x32x16_bf16 v[8:23], v[160:163], v[84:87], v[8:23]
    v_xor_b32 v3, 64, v2
    ds_read_b128 v[160:163], v3 offset:0
    s_waitcnt lgkmcnt(3)
    v_mfma_f32_32x32x16_bf16 v[8:23], v[164:167], v[88:91], v[8:23]
    v_xor_b32 v3, 96, v2
    ds_read_b128 v[164:167], v3 offset:0
    s_waitcnt lgkmcnt(3)
    v_mfma_f32_32x32x16_bf16 v[8:23], v[152:155], v[92:95], v[8:23]
    ds_read_b128 v[152:155], v2 offset:16384
    s_waitcnt lgkmcnt(3)
    v_mfma_f32_32x32x16_bf16 v[8:23], v[156:159], v[96:99], v[8:23]
    v_xor_b32 v3, 32, v2
    ds_read_b128 v[156:159], v3 offset:16384
    s_waitcnt lgkmcnt(3)
    v_mfma_f32_32x32x16_bf16 v[8:23], v[160:163], v[100:103], v[8:23]
    v_xor_b32 v3, 64, v2
    ds_read_b128 v[160:163], v3 offset:16384
    s_waitcnt lgkmcnt(3)
    v_mfma_f32_32x32x16_bf16 v[8:23], v[164:167], v[104:107], v[8:23]
    v_xor_b32 v3, 96, v2
    ds_read_b128 v[164:167], v3 offset:16384
    s_waitcnt lgkmcnt(3)
    v_mfma_f32_32x32x16_bf16 v[8:23], v[152:155], v[108:111], v[8:23]
L_w29:
    ds_read_b32 v3, v4 offset:4032
    s_sub_u32 s3, s3, 1
    s_cbranch_scc1 L_end
    s_waitcnt lgkmcnt(0)
    v_cmp_gt_u32 vcc, 15, v3
    s_cbranch_vccnz L_w29
    ds_read_b128 v[152:155], v2 offset:32768
    s_waitcnt lgkmcnt(3)
    v_mfma_f32_32x32x16_bf16 v[8:23], v[156:159], v[112:115], v[8:23]
    v_xor_b32 v3, 32, v2
    ds_read_b128 v[156:159], v3 offset:32768
    s_waitcnt lgkmcnt(3)
    v_mfma_f32_32x32x16_bf16 v[8:23], v[160:163], v[116:119], v[8:23]
    v_xor_b32 v3, 64, v2
    ds_read_b128 v[160:163], v3 offset:32768
    s_waitcnt lgkmcnt(3)
    v_mfma_f32_32x32x16_bf16 v[8:23], v[164:167], v[120:123], v[8:23]
    v_xor_b32 v3, 96, v2
    ds_read_b128 v[164:167], v3 offset:32768
    s_waitcnt lgkmcnt(3)
    v_mfma_f32_32x32x16_bf16 v[8:23], v[152:155], v[124:127], v[8:23]
L_w30:
    ds_read_b32 v3, v4 offset:4032
    s_sub_u32 s3, s3, 1
    s_cbranch_scc1 L_end
    s_waitcnt lgkmcnt(0)
    v_cmp_gt_u32 vcc, 16, v3
    s_cbranch_vccnz L_w30
    ds_read_b128 v[152:155], v2 offset:49152
    s_waitcnt lgkmcnt(3)
    v_mfma_f32_32x32x16_bf16 v[8:23], v[156:159], v[128:131], v[8:23]
    v_xor_b32 v3, 32, v2
    ds_read_b128 v[156:159], v3 offset:49152
    s_waitcnt lgkmcnt(3)
    v_mfma_f32_32x32x16_bf16 v[8:23], v[160:163], v[132:135], v[8:23]
    v_xor_b32 v3, 64, v2
    ds_read_b128 v[160:163], v3 offset:49152
    s_waitcnt lgkmcnt(3)
    v_mfma_f32_32x32x16_bf16 v[8:23], v[164:167], v[136:139], v[8:23]
    v_xor_b32 v3, 96, v2
    ds_read_b128 v[164:167], v3 offset:49152
    s_waitcnt lgkmcnt(3)
    v_mfma_f32_32x32x16_bf16 v[8:23], v[152:155], v[140:143], v[8:23]
    s_waitcnt lgkmcnt(2)
    v_mfma_f32_32x32x16_bf16 v[8:23], v[156:159], v[144:147], v[8:23]
    s_waitcnt lgkmcnt(1)
    v_mfma_f32_32x32x16_bf16 v[8:23], v[160:163], v[148:151], v[8:23]
    s_waitcnt lgkmcnt(0)
    v_mfma_f32_32x32x16_bf16 v[8:23], v[164:167], v[24:27], v[8:23]
    v_add_u32 v166, s53, v5
    s_lshl_b32 s38, s33, 11
    s_add_u32 s38, s38, 139264
    v_lshl_add_u32 v167, v1, 4, s38
    s_nop 7
    v_max3_f32 v164, v8, v9, v10
    v_max3_f32 v165, v11, v12, v13
    v_max3_f32 v164, v164, v14, v15
    v_max3_f32 v165, v165, v16, v17
    v_max3_f32 v164, v164, v18, v19
    v_max3_f32 v165, v165, v20, v21
    v_max3_f32 v164, v164, v22, v23
    v_max_f32 v164, v164, v165
    v_mov_b32 v165, v164
    s_nop 1
    v_permlane32_swap_b32 v164, v165
    v_max_f32 v164, v164, v165
    ds_write_b32 v166, v164 offset:0
L_B_mx1:
    ds_read_b128 v[160:163], v5 offset:0
    s_sub_u32 s3, s3, 1
    s_cbranch_scc1 L_end
    s_waitcnt lgkmcnt(0)
    v_max3_u32 v164, v160, v161, v162
    v_max_u32 v164, v164, v163
    v_cmp_eq_u32 vcc, -1, v164
    s_cbranch_vccnz L_B_mx1
    v_max3_f32 v164, v160, v161, v162
    v_max_f32 v164, v164, v163
    v_mul_f32 v164, s52, v164
    v_max_f32 v164, v164, v6
    v_sub_f32 v165, v6, v164
    v_exp_f32 v165, v165
    v_mov_b32 v6, v164
    v_and_b32 v3, 31, v1
    v_lshlrev_b32 v3, 2, v3
    v_add_u32 v3, 147968, v3
    ds_write_b32 v3, v165
    v_mov_b32 v164, 1
    s_mov_b64 exec, 1
    ds_add_u32 v0, v164 offset:1020
    s_mov_b64 exec, -1
    v_fma_f32 v8, v8, s52, -v6
    v_fma_f32 v9, v9, s52, -v6
    v_fma_f32 v10, v10, s52, -v6
    v_fma_f32 v11, v11, s52, -v6
    v_fma_f32 v12, v12, s52, -v6
    v_fma_f32 v13, v13, s52, -v6
    v_fma_f32 v14, v14, s52, -v6
    v_fma_f32 v15, v15, s52, -v6
    v_exp_f32 v8, v8
    v_exp_f32 v9, v9
    v_exp_f32 v10, v10
    v_exp_f32 v11, v11
    v_exp_f32 v12, v12
    v_exp_f32 v13, v13
    v_exp_f32 v14, v14
    v_exp_f32 v15, v15
    v_cvt_pk_bf16_f32 v152, v8, v9
    v_cvt_pk_bf16_f32 v153, v10, v11
    v_cvt_pk_bf16_f32 v154, v12, v13
    v_cvt_pk_bf16_f32 v155, v14, v15
    ds_write_b128 v167, v[152:155] offset:0
    v_fma_f32 v16, v16, s52, -v6
    v_fma_f32 v17, v17, s52, -v6
    v_fma_f32 v18, v18, s52, -v6
    v_fma_f32 v19, v19, s52, -v6
    v_fma_f32 v20, v20, s52, -v6
    v_fma_f32 v21, v21, s52, -v6
    v_fma_f32 v22, v22, s52, -v6
    v_fma_f32 v23, v23, s52, -v6
    v_exp_f32 v16, v16
    v_exp_f32 v17, v17
    v_exp_f32 v18, v18
    v_exp_f32 v19, v19
    v_exp_f32 v20, v20
    v_exp_f32 v21, v21
    v_exp_f32 v22, v22
    v_exp_f32 v23, v23
    v_cvt_pk_bf16_f32 v156, v16, v17
    v_cvt_pk_bf16_f32 v157, v18, v19
    v_cvt_pk_bf16_f32 v158, v20, v21
    v_cvt_pk_bf16_f32 v159, v22, v23
    ds_write_b128 v167, v[156:159] offset:1024
    v_mov_b32 v164, 1
    s_mov_b64 exec, 1
    ds_add_u32 v0, v164 offset:1016
    s_mov_b64 exec, -1
    v_pk_add_f32 v[8:9], v[8:9], v[16:17]
    v_pk_add_f32 v[10:11], v[10:11], v[18:19]
    v_pk_add_f32 v[12:13], v[12:13], v[20:21]
    v_pk_add_f32 v[14:15], v[14:15], v[22:23]
    v_pk_add_f32 v[8:9], v[8:9], v[12:13]
    v_pk_add_f32 v[10:11], v[10:11], v[14:15]
    v_pk_add_f32 v[8:9], v[8:9], v[10:11]
    v_add_f32 v8, v8, v9
    v_fmac_f32 v8, v7, v165
    v_mov_b32 v9, v8
    s_nop 1
    v_permlane32_swap_b32 v8, v9
    v_add_f32 v8, v8, v9
    ds_write_b32 v166, v8 offset:1024
    v_mov_b32 v164, 1
    s_mov_b64 exec, 1
    ds_add_u32 v0, v164 offset:1020
    s_mov_b64 exec, -1
    s_cmp_lg_u32 s33, 0
    s_cbranch_scc1 L_end
    v_and_b32 v2, 31, v1
    v_lshlrev_b32 v2, 3, v2
    s_lshl_b32 s49, s61, 10
    s_add_u32 s49, s49, 1048576
L_w31:
    ds_read_b32 v3, v0 offset:1020
    s_sub_u32 s3, s3, 1
    s_cbranch_scc1 L_end
    s_waitcnt lgkmcnt(0)
    v_cmp_gt_u32 vcc, 8, v3
    s_cbranch_vccnz L_w31
    ds_read_b128 v[8:11], v5 offset:1024
    s_waitcnt lgkmcnt(0)
    v_add_f32 v8, v8, v9
    v_add_f32 v10, v10, v11
    v_add_f32 v7, v8, v10
L_w32:
    ds_read_b32 v3, v0 offset:2024
    s_sub_u32 s3, s3, 1
    s_cbranch_scc1 L_end
    s_waitcnt lgkmcnt(0)
    v_cmp_gt_u32 vcc, 4, v3
    s_cbranch_vccnz L_w32
L_w33:
    s_sleep 1
    ds_read_b32 v3, v0 offset:7060
    s_sub_u32 s3, s3, 1
    s_cbranch_scc1 L_end
    s_waitcnt lgkmcnt(0)
    v_cmp_gt_u32 vcc, 1, v3
    s_cbranch_vccnz L_w33
    s_mov_b32 exec_hi, 0
    buffer_store_dwordx2 v[6:7], v2, s[40:43], s49 offen sc1
    s_branch L_end
L_Cs:
    s_setprio 2

    v_lshrrev_b32 v3, 4, v1
    v_and_b32 v5, 15, v1
    v_lshlrev_b32 v2, 10, v3
    v_lshl_add_u32 v2, v5, 4, v2
    s_lshl_b32 s38, s33, 8
    v_add_u32 v2, s38, v2
    v_add_u32 v4, 0x1000, v2
    s_waitcnt lgkmcnt(0)
    global_load_dwordx4 v[24:27], v2, s[4:5]
    global_load_dwordx4 v[28:31], v4, s[4:5]
    global_load_dwordx4 v[8:11], v2, s[22:23]
    global_load_dwordx4 v[12:15], v4, s[22:23]
    s_barrier
    s_mov_b32 s40, s30
    s_mov_b32 s41, s31
    s_mov_b32 s42, 16777216
    s_mov_b32 s43, 0x20000

    s_mov_b32 s3, 0x400000
    v_mov_b32 v0, 156256
    s_and_b32 s62, s34, 3
    s_lshl2_add_u32 s97, s62, s37
    s_lshl4_add_u32 s61, s36, s97

    s_lshl2_add_u32 s55, s36, s37
    v_mov_b32 v32, 0x3f803f80
    v_mov_b32 v33, v32
    v_mov_b32 v34, v32
    v_mov_b32 v35, v32
    v_mov_b32 v36, v32
    v_mov_b32 v37, v32
    v_mov_b32 v38, v32
    v_mov_b32 v39, v32
    v_mov_b32 v40, v32
    v_mov_b32 v41, v32
    v_mov_b32 v42, v32
    v_mov_b32 v43, v32
    v_mov_b32 v44, v32
    v_mov_b32 v45, v32
    v_mov_b32 v46, v32
    v_mov_b32 v47, v32

    s_mov_b32 s56, 0x00ff00ff
    s_mov_b32 s57, 0x00ff00ff
    s_mul_i32 s38, s33, 2176
    v_mul_u32_u24 v6, 272, v3
    v_lshl_add_u32 v6, v5, 4, v6
    v_add_u32 v6, s38, v6
    v_and_b32 v92, 7, v1
    v_mul_u32_u24 v95, 272, v92
    v_lshl_add_u32 v7, v3, 4, v95
    v_add_u32 v7, s38, v7
    v_lshl_add_u32 v95, v3, 3, v95
    s_lshr_b32 s38, s55, 3
    s_mul_i32 s38, s38, 2176
    s_and_b32 s39, s55, 7
    s_lshl_b32 s39, s39, 5
    s_add_u32 s38, s38, s39
    v_add_u32 v95, s38, v95
    s_lshl_b32 s59, s33, 13
    s_add_u32 s59, s59, 65536
    v_bfe_u32 v2, v1, 2, 2
    v_lshl_add_u32 v2, v3, 3, v2
    v_lshlrev_b32 v2, 6, v2
    v_and_b32 v4, 1, v3
    v_lshl_add_u32 v2, v4, 5, v2
    v_and_b32 v4, 3, v1
    v_lshl_add_u32 v2, v4, 3, v2
    v_add_u32 v2, s59, v2
    v_xor_b32 v3, 32, v2
    s_mul_i32 s38, s33, 3072
    s_add_u32 s38, s38, 49152
    v_lshl_add_u32 v4, v1, 4, s38
    s_lshl_b32 s38, s33, 2
    v_add_u32 v5, s38, v0
    s_mov_b32 s38, 0xbfb8aa3b
    s_waitcnt vmcnt(2)
    ds_write_b128 v6, v[24:27] offset:16384
    ds_write_b128 v6, v[28:31] offset:17472
    s_mov_b64 exec, s[56:57]
    ds_read_b128 v[32:35], v7 offset:16384
    ds_read_b128 v[36:39], v7 offset:16448
    ds_read_b128 v[40:43], v7 offset:16512
    ds_read_b128 v[44:47], v7 offset:16576
    s_mov_b64 exec, -1
    s_waitcnt vmcnt(0)
    v_lshlrev_b32 v48, 16, v8
    v_and_b32 v49, 0xffff0000, v8
    v_mul_f32 v50, s38, v48
    v_mul_f32 v51, s38, v49
    v_exp_f32 v50, v50
    v_exp_f32 v51, v51
    v_add_f32 v50, 1.0, v50
    v_add_f32 v51, 1.0, v51
    v_rcp_f32 v50, v50
    v_rcp_f32 v51, v51
    v_mul_f32 v48, v48, v50
    v_mul_f32 v49, v49, v51
    v_cvt_pk_bf16_f32 v8, v48, v49
    s_waitcnt lgkmcnt(0)
    v_mfma_f32_16x16x32_bf16 v[88:91], v[32:35], v[32:35], 0
    v_mfma_f32_16x16x32_bf16 v[88:91], v[36:39], v[36:39], v[88:91]
    v_mfma_f32_16x16x32_bf16 v[88:91], v[40:43], v[40:43], v[88:91]
    v_mfma_f32_16x16x32_bf16 v[88:91], v[44:47], v[44:47], v[88:91]
    v_lshlrev_b32 v48, 16, v9
    v_and_b32 v49, 0xffff0000, v9
    v_mul_f32 v50, s38, v48
    v_mul_f32 v51, s38, v49
    v_exp_f32 v50, v50
    v_exp_f32 v51, v51
    v_add_f32 v50, 1.0, v50
    v_add_f32 v51, 1.0, v51
    v_rcp_f32 v50, v50
    v_rcp_f32 v51, v51
    v_mul_f32 v48, v48, v50
    v_mul_f32 v49, v49, v51
    v_cvt_pk_bf16_f32 v9, v48, v49
    ds_write_b128 v4, v[88:91] offset:2048
    v_mov_b32 v52, 1
    s_mov_b64 exec, 1
    ds_add_u32 v0, v52 offset:12
    s_mov_b64 exec, -1
    v_lshlrev_b32 v48, 16, v10
    v_and_b32 v49, 0xffff0000, v10
    v_mul_f32 v50, s38, v48
    v_mul_f32 v51, s38, v49
    v_exp_f32 v50, v50
    v_exp_f32 v51, v51
    v_add_f32 v50, 1.0, v50
    v_add_f32 v51, 1.0, v51
    v_rcp_f32 v50, v50
    v_rcp_f32 v51, v51
    v_mul_f32 v48, v48, v50
    v_mul_f32 v49, v49, v51
    v_cvt_pk_bf16_f32 v10, v48, v49
    v_lshlrev_b32 v48, 16, v11
    v_and_b32 v49, 0xffff0000, v11
    v_mul_f32 v50, s38, v48
    v_mul_f32 v51, s38, v49
    v_exp_f32 v50, v50
    v_exp_f32 v51, v51
    v_add_f32 v50, 1.0, v50
    v_add_f32 v51, 1.0, v51
    v_rcp_f32 v50, v50
    v_rcp_f32 v51, v51
    v_mul_f32 v48, v48, v50
    v_mul_f32 v49, v49, v51
    v_cvt_pk_bf16_f32 v11, v48, v49
    v_lshlrev_b32 v48, 16, v12
    v_and_b32 v49, 0xffff0000, v12
    v_mul_f32 v50, s38, v48
    v_mul_f32 v51, s38, v49
    v_exp_f32 v50, v50
    v_exp_f32 v51, v51
    v_add_f32 v50, 1.0, v50
    v_add_f32 v51, 1.0, v51
    v_rcp_f32 v50, v50
    v_rcp_f32 v51, v51
    v_mul_f32 v48, v48, v50
    v_mul_f32 v49, v49, v51
    v_cvt_pk_bf16_f32 v12, v48, v49
    v_lshlrev_b32 v48, 16, v13
    v_and_b32 v49, 0xffff0000, v13
    v_mul_f32 v50, s38, v48
    v_mul_f32 v51, s38, v49
    v_exp_f32 v50, v50
    v_exp_f32 v51, v51
    v_add_f32 v50, 1.0, v50
    v_add_f32 v51, 1.0, v51
    v_rcp_f32 v50, v50
    v_rcp_f32 v51, v51
    v_mul_f32 v48, v48, v50
    v_mul_f32 v49, v49, v51
    v_cvt_pk_bf16_f32 v13, v48, v49
    v_lshlrev_b32 v48, 16, v14
    v_and_b32 v49, 0xffff0000, v14
    v_mul_f32 v50, s38, v48
    v_mul_f32 v51, s38, v49
    v_exp_f32 v50, v50
    v_exp_f32 v51, v51
    v_add_f32 v50, 1.0, v50
    v_add_f32 v51, 1.0, v51
    v_rcp_f32 v50, v50
    v_rcp_f32 v51, v51
    v_mul_f32 v48, v48, v50
    v_mul_f32 v49, v49, v51
    v_cvt_pk_bf16_f32 v14, v48, v49
    v_lshlrev_b32 v48, 16, v15
    v_and_b32 v49, 0xffff0000, v15
    v_mul_f32 v50, s38, v48
    v_mul_f32 v51, s38, v49
    v_exp_f32 v50, v50
    v_exp_f32 v51, v51
    v_add_f32 v50, 1.0, v50
    v_add_f32 v51, 1.0, v51
    v_rcp_f32 v50, v50
    v_rcp_f32 v51, v51
    v_mul_f32 v48, v48, v50
    v_mul_f32 v49, v49, v51
    v_cvt_pk_bf16_f32 v15, v48, v49
    ds_write_b128 v6, v[8:11] offset:32768
    ds_write_b128 v6, v[12:15] offset:33856
    ds_read_b128 v[8:11], v7 offset:32768
    ds_read_b128 v[12:15], v7 offset:32832
    ds_read_b128 v[16:19], v7 offset:32896
    ds_read_b128 v[20:23], v7 offset:32960
    s_cmp_lg_u32 s33, 0
    s_cbranch_scc1 L_C_nln
    v_lshrrev_b32 v93, 2, v92
    v_lshl_add_u32 v93, v93, 4, v92
    v_lshlrev_b32 v93, 4, v93
    v_and_b32 v94, 3, v1
    v_lshl_add_u32 v93, v94, 2, v93
    v_add_u32 v93, 51200, v93
    v_lshlrev_b32 v92, 4, v92
    v_add_u32 v94, 51712, v92
    v_lshrrev_b32 v96, 5, v1
    v_lshl_add_u32 v92, v96, 7, v92
    v_bfe_u32 v96, v1, 4, 1
    v_lshl_add_u32 v92, v96, 3, v92
    s_lshl_b32 s39, s55, 8
L_w34:
    ds_read_b32 v40, v0 offset:12
    s_sub_u32 s3, s3, 1
    s_cbranch_scc1 L_end
    s_waitcnt lgkmcnt(0)
    v_cmp_gt_u32 vcc, 4, v40
    s_cbranch_vccnz L_w34
    ds_read_b32 v24, v94 offset:0
    ds_read_b32 v28, v93 offset:0
    ds_read_b32 v25, v94 offset:3072
    ds_read_b32 v29, v93 offset:3072
    ds_read_b32 v26, v94 offset:6144
    ds_read_b32 v30, v93 offset:6144
    ds_read_b32 v27, v94 offset:9216
    ds_read_b32 v31, v93 offset:9216
    ds_read_b64 v[6:7], v95 offset:16384
    s_mov_b32 s38, 0x3b000000
    s_waitcnt lgkmcnt(0)
    v_lshlrev_b32 v96, 16, v6
    v_and_b32 v97, 0xffff0000, v6
    v_lshlrev_b32 v98, 16, v7
    v_and_b32 v99, 0xffff0000, v7
    v_add_f32 v24, v24, v25
    v_add_f32 v28, v28, v29
    v_add_f32 v26, v26, v27
    v_add_f32 v30, v30, v31
    v_add_f32 v24, v24, v26
    v_add_f32 v28, v28, v30
    v_mul_f32 v24, s38, v24
    v_mul_f32 v28, s38, v28
    v_fma_f32 v28, -v24, v24, v28
    v_max_f32 v28, 0, v28
    v_add_f32 v28, 0x3727c5ac, v28
    v_rsq_f32 v28, v28
    v_sub_f32 v96, v96, v24
    v_sub_f32 v97, v97, v24
    v_sub_f32 v98, v98, v24
    v_sub_f32 v99, v99, v24
    v_mul_f32 v96, v96, v28
    v_mul_f32 v97, v97, v28
    v_mul_f32 v98, v98, v28
    v_mul_f32 v99, v99, v28
L_C_nln:
L_w35:
    ds_read_b32 v40, v5 offset:4032
    s_sub_u32 s3, s3, 1
    s_cbranch_scc1 L_end
    s_waitcnt lgkmcnt(0)
    v_cmp_gt_u32 vcc, 1, v40
    s_cbranch_vccnz L_w35
    ds_read_b64_tr_b16 v[48:49], v2 offset:0
    ds_read_b64_tr_b16 v[50:51], v2 offset:256
    ds_read_b64_tr_b16 v[52:53], v3 offset:0
    ds_read_b64_tr_b16 v[54:55], v3 offset:256
    ds_read_b64_tr_b16 v[56:57], v2 offset:2048
    ds_read_b64_tr_b16 v[58:59], v2 offset:2304
    ds_read_b64_tr_b16 v[60:61], v3 offset:2048
    ds_read_b64_tr_b16 v[62:63], v3 offset:2304
    ds_read_b64_tr_b16 v[64:65], v2 offset:4096
    ds_read_b64_tr_b16 v[66:67], v2 offset:4352
    ds_read_b64_tr_b16 v[68:69], v3 offset:4096
    ds_read_b64_tr_b16 v[70:71], v3 offset:4352
    s_waitcnt lgkmcnt(8)
    ds_read_b64_tr_b16 v[72:73], v2 offset:6144
    ds_read_b64_tr_b16 v[74:75], v2 offset:6400
    ds_read_b64_tr_b16 v[76:77], v3 offset:6144
    ds_read_b64_tr_b16 v[78:79], v3 offset:6400
    s_waitcnt lgkmcnt(12)
    v_mfma_f32_16x16x32_bf16 v[80:83], v[48:51], v[8:11], 0
    v_mfma_f32_16x16x32_bf16 v[84:87], v[52:55], v[8:11], 0
    s_waitcnt lgkmcnt(8)
    v_mfma_f32_16x16x32_bf16 v[80:83], v[56:59], v[12:15], v[80:83]
    v_mfma_f32_16x16x32_bf16 v[84:87], v[60:63], v[12:15], v[84:87]
    s_waitcnt lgkmcnt(4)
    v_mfma_f32_16x16x32_bf16 v[80:83], v[64:67], v[16:19], v[80:83]
    v_mfma_f32_16x16x32_bf16 v[84:87], v[68:71], v[16:19], v[84:87]
    s_waitcnt lgkmcnt(0)
    v_mfma_f32_16x16x32_bf16 v[80:83], v[72:75], v[20:23], v[80:83]
    v_mfma_f32_16x16x32_bf16 v[84:87], v[76:79], v[20:23], v[84:87]
    s_cmp_eq_u32 s33, 0
    s_cbranch_scc1 L_C_red
    s_nop 4
    ds_write_b128 v4, v[80:83] offset:0
    ds_write_b128 v4, v[84:87] offset:1024
    v_mov_b32 v5, 1
    s_mov_b64 exec, 1
    ds_add_u32 v0, v5 offset:8
    s_mov_b64 exec, -1
    s_branch L_C_o
L_C_red:
L_w36:
    ds_read_b32 v5, v0 offset:8
    s_sub_u32 s3, s3, 1
    s_cbranch_scc1 L_end
    s_waitcnt lgkmcnt(0)
    v_cmp_gt_u32 vcc, 3, v5
    s_cbranch_vccnz L_w36
    ds_read_b128 v[48:51], v4 offset:3072
    ds_read_b128 v[52:55], v4 offset:4096
    ds_read_b128 v[56:59], v4 offset:6144
    ds_read_b128 v[60:63], v4 offset:7168
    ds_read_b128 v[64:67], v4 offset:9216
    ds_read_b128 v[68:71], v4 offset:10240
    ds_read_b32 v5, v0 offset:2020
    v_add_f32 v80, v80, v96
    v_add_f32 v81, v81, v97
    v_add_f32 v82, v82, v98
    v_add_f32 v83, v83, v99
    s_waitcnt lgkmcnt(0)
    v_pk_add_f32 v[80:81], v[80:81], v[48:49]
    v_pk_add_f32 v[56:57], v[56:57], v[64:65]
    v_pk_add_f32 v[82:83], v[82:83], v[50:51]
    v_pk_add_f32 v[58:59], v[58:59], v[66:67]
    v_pk_add_f32 v[84:85], v[84:85], v[52:53]
    v_pk_add_f32 v[60:61], v[60:61], v[68:69]
    v_pk_add_f32 v[86:87], v[86:87], v[54:55]
    v_pk_add_f32 v[62:63], v[62:63], v[70:71]
    v_pk_add_f32 v[80:81], v[80:81], v[56:57]
    v_pk_add_f32 v[82:83], v[82:83], v[58:59]
    v_pk_add_f32 v[84:85], v[84:85], v[60:61]
    v_pk_add_f32 v[86:87], v[86:87], v[62:63]
    v_cmp_eq_u32 vcc, 0, v5
    v_fmac_f32 v80, v84, v96
    v_fmac_f32 v81, v85, v97
    v_fmac_f32 v82, v86, v98
    v_fmac_f32 v83, v87, v99
    v_cvt_pk_bf16_f32 v80, v80, v81
    v_cvt_pk_bf16_f32 v81, v82, v83
    s_cbranch_vccz L_C_pub
L_w37:
    ds_read_b32 v5, v0 offset:2020
    s_sub_u32 s3, s3, 1
    s_cbranch_scc1 L_end
    s_waitcnt lgkmcnt(0)
    v_cmp_gt_u32 vcc, 1, v5
    s_cbranch_vccnz L_w37
L_C_pub:
    s_mov_b64 exec, s[56:57]
    buffer_store_dwordx2 v[80:81], v92, s[40:43], s39 offen sc1
    s_mov_b64 exec, -1
    v_mov_b32 v5, 4
    ds_write_b32 v0, v5 offset:5044
    ds_write_b32 v0, v5 offset:4
    s_branch L_C_o
L_Co:
    s_waitcnt lgkmcnt(0)
    s_mov_b32 s40, s30
    s_mov_b32 s41, s31
    s_mov_b32 s42, 16777216
    s_mov_b32 s43, 0x20000

    s_mov_b32 s3, 0x400000
    v_mov_b32 v0, 156256
    s_and_b32 s62, s34, 3
    s_lshl2_add_u32 s97, s62, s37
    s_lshl4_add_u32 s61, s36, s97

    s_barrier
    s_cmp_lt_u32 s34, 4
    s_cbranch_scc1 L_C_nt
    s_cmp_lg_u32 s33, 0
    s_cbranch_scc1 L_C_nt
    v_lshrrev_b32 v2, 1, v1
    v_and_b32 v3, 1, v1
    s_lshl2_add_u32 s38, s33, s34
    s_sub_u32 s38, s38, 4
    v_lshl_add_u32 v2, v2, 6, v3
    s_lshl_b32 s38, s38, 10
    s_add_u32 s38, s38, s35
    s_lshl_b32 s38, s38, 8
    v_lshl_add_u32 v2, v2, 7, s38
    s_mov_b64 exec, 1
    global_load_dword v166, v2, s[10:11]
    s_mov_b64 exec, -1
    s_waitcnt vmcnt(0)
    global_load_dword v166, v2, s[10:11]
    v_mov_b32 v3, 1
    s_mov_b64 exec, 1
    ds_add_u32 v0, v3 offset:4
    s_mov_b64 exec, -1
L_C_nt:
    s_cmp_ge_u32 s34, 4
    s_cbranch_scc1 L_C_at
    s_mul_i32 s63, s34, 3
    s_add_u32 s63, s63, s33
    s_sub_u32 s63, s63, 3
    s_cmp_eq_u32 s33, 3
    s_cbranch_scc1 L_C_o
    s_cmp_eq_u32 s63, 8
    s_cbranch_scc1 L_C_qs
    s_mov_b32 s44, s10
    s_mov_b32 s45, s11
    s_mov_b32 s46, 4194304
    s_mov_b32 s47, 0x20000

    v_lshrrev_b32 v3, 4, v1
    v_and_b32 v2, 15, v1
    v_xor_b32 v4, v2, v3
    v_lshlrev_b32 v4, 4, v4
    v_lshl_add_u32 v4, v3, 13, v4
    v_xor_b32 v5, 64, v4
    v_xor_b32 v6, 0x80, v4
    v_xor_b32 v7, 0xc0, v4
    s_lshl_b32 s48, s63, 19
    s_lshl_b32 s38, s35, 8
    s_add_u32 s48, s48, s38
    s_lshl_b32 s51, s33, 14
    s_add_u32 s51, s51, 65536
    v_lshlrev_b32 v12, 4, v1
    v_mov_b32 v8, -1
    v_mov_b32 v9, -1
    v_mov_b32 v10, -1
    v_mov_b32 v11, -1
    s_lshl3_add_u32 s38, s35, s63
    s_lshl_b32 s38, s38, 12
    s_add_u32 s52, s38, 1048576
    buffer_store_dwordx4 v[8:11], v12, s[40:43], s52 offen offset:0 sc1
    buffer_store_dwordx4 v[8:11], v12, s[40:43], s52 offen offset:1024 sc1
    buffer_store_dwordx4 v[8:11], v12, s[40:43], s52 offen offset:2048 sc1
    buffer_store_dwordx4 v[8:11], v12, s[40:43], s52 offen offset:3072 sc1
L_w38:
    s_sleep 1
    ds_read_b32 v13, v0 offset:0
    s_sub_u32 s3, s3, 1
    s_cbranch_scc1 L_end
    s_waitcnt lgkmcnt(0)
    v_cmp_gt_u32 vcc, 4, v13
    s_cbranch_vccnz L_w38
    s_add_u32 m0, s51, 0
    s_add_u32 s38, s48, 0
    buffer_load_dwordx4 v4, s[44:47], s38 offen nt lds
    s_add_u32 m0, s51, 1024
    s_add_u32 s38, s48, 131072
    buffer_load_dwordx4 v5, s[44:47], s38 offen nt lds
    s_add_u32 m0, s51, 2048
    s_add_u32 s38, s48, 262144
    buffer_load_dwordx4 v6, s[44:47], s38 offen nt lds
    s_add_u32 m0, s51, 3072
    s_add_u32 s38, s48, 393216
    buffer_load_dwordx4 v7, s[44:47], s38 offen nt lds
    s_add_u32 m0, s51, 4096
    s_add_u32 s38, s48, 32768
    buffer_load_dwordx4 v4, s[44:47], s38 offen nt lds
    s_add_u32 m0, s51, 5120
    s_add_u32 s38, s48, 163840
    buffer_load_dwordx4 v5, s[44:47], s38 offen nt lds
    s_add_u32 m0, s51, 6144
    s_add_u32 s38, s48, 294912
    buffer_load_dwordx4 v6, s[44:47], s38 offen nt lds
    s_add_u32 m0, s51, 7168
    s_add_u32 s38, s48, 425984
    buffer_load_dwordx4 v7, s[44:47], s38 offen nt lds
    s_add_u32 m0, s51, 8192
    s_add_u32 s38, s48, 65536
    buffer_load_dwordx4 v4, s[44:47], s38 offen nt lds
    s_add_u32 m0, s51, 9216
    s_add_u32 s38, s48, 196608
    buffer_load_dwordx4 v5, s[44:47], s38 offen nt lds
    s_add_u32 m0, s51, 10240
    s_add_u32 s38, s48, 327680
    buffer_load_dwordx4 v6, s[44:47], s38 offen nt lds
    s_add_u32 m0, s51, 11264
    s_add_u32 s38, s48, 458752
    buffer_load_dwordx4 v7, s[44:47], s38 offen nt lds
    s_add_u32 m0, s51, 12288
    s_add_u32 s38, s48, 98304
    buffer_load_dwordx4 v4, s[44:47], s38 offen nt lds
    s_add_u32 m0, s51, 13312
    s_add_u32 s38, s48, 229376
    buffer_load_dwordx4 v5, s[44:47], s38 offen nt lds
    s_add_u32 m0, s51, 14336
    s_add_u32 s38, s48, 360448
    buffer_load_dwordx4 v6, s[44:47], s38 offen nt lds
    s_add_u32 m0, s51, 15360
    s_add_u32 s38, s48, 491520
    buffer_load_dwordx4 v7, s[44:47], s38 offen nt lds

    v_lshlrev_b32 v4, 2, v3
    v_xor_b32 v4, v4, v2
    v_lshlrev_b32 v4, 4, v4
    v_lshl_add_u32 v4, v2, 8, v4
    v_add_u32 v4, s51, v4
    v_xor_b32 v5, 16, v4
    v_xor_b32 v6, 32, v4
    v_xor_b32 v7, 48, v4
    v_add_u32 v12, 131072, v12
    v_and_b32 v13, 1, v1
    v_lshlrev_b32 v14, 4, v13
    v_lshl_add_u32 v15, v3, 5, v14
    v_lshrrev_b32 v2, 1, v2
    v_lshl_add_u32 v15, v2, 15, v15
    s_mov_b32 s38, 0xffff
    v_lshlrev_b32 v14, v14, s38
    v_cmp_eq_u32 s[56:57], 1, v13
    s_lshl_b32 s49, s35, 10
    s_lshl_b32 s38, s63, 7
    s_add_u32 s49, s49, s38
    s_add_u32 s49, s49, 65536
    s_waitcnt vmcnt(0)
    ds_read_b128 v[104:107], v4 offset:0
    ds_read_b128 v[108:111], v5 offset:0
    ds_read_b128 v[112:115], v6 offset:0
    ds_read_b128 v[116:119], v7 offset:0
    s_waitcnt lgkmcnt(0)
    ds_read_b128 v[120:123], v4 offset:4096
    ds_read_b128 v[124:127], v5 offset:4096
    ds_read_b128 v[128:131], v6 offset:4096
    ds_read_b128 v[132:135], v7 offset:4096
    s_waitcnt lgkmcnt(0)
    ds_read_b128 v[136:139], v4 offset:8192
    ds_read_b128 v[140:143], v5 offset:8192
    ds_read_b128 v[144:147], v6 offset:8192
    ds_read_b128 v[148:151], v7 offset:8192
    s_waitcnt lgkmcnt(0)
    ds_read_b128 v[152:155], v4 offset:12288
    ds_read_b128 v[156:159], v5 offset:12288
    ds_read_b128 v[160:163], v6 offset:12288
    ds_read_b128 v[164:167], v7 offset:12288
    s_waitcnt lgkmcnt(0)
    s_setprio 2
L_w39:
    ds_read_b32 v5, v0 offset:5040
    s_sub_u32 s3, s3, 1
    s_cbranch_scc1 L_end
    s_waitcnt lgkmcnt(0)
    v_cmp_gt_u32 vcc, 4, v5
    s_cbranch_vccnz L_w39
    s_xor_b32 s38, s2, 8
    s_or_b32 s38, s38, s33
    s_cbranch_scc1 L_C_f2
    v_mov_b32 v5, 0
    s_mov_b64 exec, 1
    global_store_dword v5, v8, s[28:29] offset:128 sc1
    s_mov_b64 exec, -1
L_C_f2:
    ds_read_b128 v[40:43], v12 offset:0
    ds_read_b128 v[44:47], v12 offset:4096
    ds_read_b128 v[48:51], v12 offset:8192
    ds_read_b128 v[52:55], v12 offset:12288
    ds_read_b128 v[56:59], v12 offset:1024
    ds_read_b128 v[60:63], v12 offset:5120
    ds_read_b128 v[64:67], v12 offset:9216
    ds_read_b128 v[68:71], v12 offset:13312
    ds_read_b128 v[72:75], v12 offset:2048
    ds_read_b128 v[76:79], v12 offset:6144
    ds_read_b128 v[80:83], v12 offset:10240
    ds_read_b128 v[84:87], v12 offset:14336
    s_waitcnt lgkmcnt(8)
    ds_read_b128 v[88:91], v12 offset:3072
    ds_read_b128 v[92:95], v12 offset:7168
    ds_read_b128 v[96:99], v12 offset:11264
    ds_read_b128 v[100:103], v12 offset:15360
    s_waitcnt lgkmcnt(12)
    v_pk_add_f32 v[40:41], v[40:41], v[44:45]
    v_pk_add_f32 v[48:49], v[48:49], v[52:53]
    v_pk_add_f32 v[42:43], v[42:43], v[46:47]
    v_pk_add_f32 v[50:51], v[50:51], v[54:55]
    v_pk_add_f32 v[40:41], v[40:41], v[48:49]
    v_pk_add_f32 v[42:43], v[42:43], v[50:51]
    v_cvt_pk_bf16_f32 v40, v40, v40
    v_cvt_pk_bf16_f32 v41, v41, v41
    v_cvt_pk_bf16_f32 v42, v42, v42
    v_cvt_pk_bf16_f32 v43, v43, v43
    v_and_b32 v16, v40, v14
    v_and_b32 v20, v41, v14
    v_and_b32 v24, v42, v14
    v_and_b32 v28, v43, v14
    s_waitcnt lgkmcnt(8)
    v_pk_add_f32 v[56:57], v[56:57], v[60:61]
    v_pk_add_f32 v[64:65], v[64:65], v[68:69]
    v_pk_add_f32 v[58:59], v[58:59], v[62:63]
    v_pk_add_f32 v[66:67], v[66:67], v[70:71]
    v_pk_add_f32 v[56:57], v[56:57], v[64:65]
    v_pk_add_f32 v[58:59], v[58:59], v[66:67]
    v_cvt_pk_bf16_f32 v56, v56, v56
    v_cvt_pk_bf16_f32 v57, v57, v57
    v_cvt_pk_bf16_f32 v58, v58, v58
    v_cvt_pk_bf16_f32 v59, v59, v59
    v_and_b32 v17, v56, v14
    v_and_b32 v21, v57, v14
    v_and_b32 v25, v58, v14
    v_and_b32 v29, v59, v14
    s_waitcnt lgkmcnt(4)
    v_pk_add_f32 v[72:73], v[72:73], v[76:77]
    v_pk_add_f32 v[80:81], v[80:81], v[84:85]
    v_pk_add_f32 v[74:75], v[74:75], v[78:79]
    v_pk_add_f32 v[82:83], v[82:83], v[86:87]
    v_pk_add_f32 v[72:73], v[72:73], v[80:81]
    v_pk_add_f32 v[74:75], v[74:75], v[82:83]
    v_cvt_pk_bf16_f32 v72, v72, v72
    v_cvt_pk_bf16_f32 v73, v73, v73
    v_cvt_pk_bf16_f32 v74, v74, v74
    v_cvt_pk_bf16_f32 v75, v75, v75
    v_and_b32 v18, v72, v14
    v_and_b32 v22, v73, v14
    v_and_b32 v26, v74, v14
    v_and_b32 v30, v75, v14
    s_waitcnt lgkmcnt(0)
    v_pk_add_f32 v[88:89], v[88:89], v[92:93]
    v_pk_add_f32 v[96:97], v[96:97], v[100:101]
    v_pk_add_f32 v[90:91], v[90:91], v[94:95]
    v_pk_add_f32 v[98:99], v[98:99], v[102:103]
    v_pk_add_f32 v[88:89], v[88:89], v[96:97]
    v_pk_add_f32 v[90:91], v[90:91], v[98:99]
    v_cvt_pk_bf16_f32 v88, v88, v88
    v_cvt_pk_bf16_f32 v89, v89, v89
    v_cvt_pk_bf16_f32 v90, v90, v90
    v_cvt_pk_bf16_f32 v91, v91, v91
    v_and_b32 v19, v88, v14
    v_and_b32 v23, v89, v14
    v_and_b32 v27, v90, v14
    v_and_b32 v31, v91, v14
    v_mfma_f32_16x16x32_bf16 v[40:43], v[104:107], v[16:19], 0
    v_mfma_f32_16x16x32_bf16 v[44:47], v[120:123], v[16:19], 0
    v_mfma_f32_16x16x32_bf16 v[48:51], v[136:139], v[16:19], 0
    v_mfma_f32_16x16x32_bf16 v[52:55], v[152:155], v[16:19], 0
    v_mfma_f32_16x16x32_bf16 v[40:43], v[108:111], v[20:23], v[40:43]
    v_mfma_f32_16x16x32_bf16 v[44:47], v[124:127], v[20:23], v[44:47]
    v_mfma_f32_16x16x32_bf16 v[48:51], v[140:143], v[20:23], v[48:51]
    v_mfma_f32_16x16x32_bf16 v[52:55], v[156:159], v[20:23], v[52:55]
    v_mfma_f32_16x16x32_bf16 v[40:43], v[112:115], v[24:27], v[40:43]
    v_mfma_f32_16x16x32_bf16 v[44:47], v[128:131], v[24:27], v[44:47]
    v_mfma_f32_16x16x32_bf16 v[48:51], v[144:147], v[24:27], v[48:51]
    v_mfma_f32_16x16x32_bf16 v[52:55], v[160:163], v[24:27], v[52:55]
    v_mfma_f32_16x16x32_bf16 v[40:43], v[116:119], v[28:31], v[40:43]
    v_mfma_f32_16x16x32_bf16 v[44:47], v[132:135], v[28:31], v[44:47]
    v_mfma_f32_16x16x32_bf16 v[48:51], v[148:151], v[28:31], v[48:51]
    v_mfma_f32_16x16x32_bf16 v[52:55], v[164:167], v[28:31], v[52:55]
    s_nop 4
    v_add_f32_dpp v40, v40, v40 quad_perm:[1,0,3,2] row_mask:0xf bank_mask:0xf
    v_add_f32_dpp v41, v41, v41 quad_perm:[1,0,3,2] row_mask:0xf bank_mask:0xf
    v_add_f32_dpp v42, v42, v42 quad_perm:[1,0,3,2] row_mask:0xf bank_mask:0xf
    v_add_f32_dpp v43, v43, v43 quad_perm:[1,0,3,2] row_mask:0xf bank_mask:0xf
    v_add_f32_dpp v44, v44, v44 quad_perm:[1,0,3,2] row_mask:0xf bank_mask:0xf
    v_add_f32_dpp v45, v45, v45 quad_perm:[1,0,3,2] row_mask:0xf bank_mask:0xf
    v_add_f32_dpp v46, v46, v46 quad_perm:[1,0,3,2] row_mask:0xf bank_mask:0xf
    v_add_f32_dpp v47, v47, v47 quad_perm:[1,0,3,2] row_mask:0xf bank_mask:0xf
    v_add_f32_dpp v48, v48, v48 quad_perm:[1,0,3,2] row_mask:0xf bank_mask:0xf
    v_add_f32_dpp v49, v49, v49 quad_perm:[1,0,3,2] row_mask:0xf bank_mask:0xf
    v_add_f32_dpp v50, v50, v50 quad_perm:[1,0,3,2] row_mask:0xf bank_mask:0xf
    v_add_f32_dpp v51, v51, v51 quad_perm:[1,0,3,2] row_mask:0xf bank_mask:0xf
    v_add_f32_dpp v52, v52, v52 quad_perm:[1,0,3,2] row_mask:0xf bank_mask:0xf
    v_add_f32_dpp v53, v53, v53 quad_perm:[1,0,3,2] row_mask:0xf bank_mask:0xf
    v_add_f32_dpp v54, v54, v54 quad_perm:[1,0,3,2] row_mask:0xf bank_mask:0xf
    v_add_f32_dpp v55, v55, v55 quad_perm:[1,0,3,2] row_mask:0xf bank_mask:0xf
    v_cndmask_b32 v40, v40, v48, s[56:57]
    v_cndmask_b32 v41, v41, v49, s[56:57]
    v_cndmask_b32 v42, v42, v50, s[56:57]
    v_cndmask_b32 v43, v43, v51, s[56:57]
    v_cndmask_b32 v44, v44, v52, s[56:57]
    v_cndmask_b32 v45, v45, v53, s[56:57]
    v_cndmask_b32 v46, v46, v54, s[56:57]
    v_cndmask_b32 v47, v47, v55, s[56:57]
    v_cvt_pk_bf16_f32 v40, v40, v41
    v_cvt_pk_bf16_f32 v41, v42, v43
    v_cvt_pk_bf16_f32 v42, v44, v45
    v_cvt_pk_bf16_f32 v43, v46, v47
    buffer_store_dwordx4 v[40:43], v15, s[40:43], s49 offen sc1
L_C_qs:
    v_mov_b32 v5, 1
    s_mov_b64 exec, 1
    ds_add_u32 v0, v5 offset:5044
    s_mov_b64 exec, -1
L_C_o:
    s_setprio 0
    v_and_b32 v5, 15, v1
    s_mov_b32 s44, s14
    s_mov_b32 s45, s15
    s_mov_b32 s46, 4194304
    s_mov_b32 s47, 0x20000
    v_and_b32 v16, 1, v1
    v_lshlrev_b32 v16, 4, v16
    s_mov_b32 s38, 0xffff
    v_lshlrev_b32 v16, v16, s38
    v_bfe_u32 v17, v1, 1, 2
    v_cmp_eq_u32 vcc, 0, v17
    s_nop 1
    v_cndmask_b32 v20, 0, v16, vcc
    v_cmp_eq_u32 vcc, 1, v17
    s_nop 1
    v_cndmask_b32 v21, 0, v16, vcc
    v_cmp_eq_u32 vcc, 2, v17
    s_nop 1
    v_cndmask_b32 v22, 0, v16, vcc
    v_cmp_eq_u32 vcc, 3, v17
    s_nop 1
    v_cndmask_b32 v23, 0, v16, vcc

    s_mov_b32 s38, 0x3f803f80
    v_and_b32 v20, s38, v20
    v_and_b32 v21, s38, v21
    v_and_b32 v22, s38, v22
    v_and_b32 v23, s38, v23
    v_lshrrev_b32 v4, 4, v1
    v_lshlrev_b32 v7, 11, v4
    v_lshl_add_u32 v7, v5, 4, v7
    s_lshl_b32 s50, s35, 13
    s_lshl_b32 s38, s33, 8
    s_add_u32 s50, s50, s38
    s_add_u32 s50, s50, 1835008
    v_and_b32 v12, 1, v4
    v_lshrrev_b32 v13, 1, v4
    v_lshl_add_u32 v12, v12, 1, v13
    s_lshl_b32 s38, s33, 2
    v_add_u32 v12, s38, v12
    v_mul_u32_u24 v12, 528, v12
    v_lshl_add_u32 v18, v5, 4, v12
    v_lshlrev_b32 v13, 4, v13
    s_mov_b32 s38, 0xffff
    v_lshlrev_b32 v19, v13, s38
    v_mul_u32_u24 v3, 528, v5
    v_lshl_add_u32 v3, v4, 4, v3
    v_lshlrev_b32 v2, 12, v4
    v_lshl_add_u32 v2, v5, 3, v2
    v_lshlrev_b32 v4, 16, v4
    v_lshl_add_u32 v4, v5, 3, v4
    s_lshl1_add_u32 s38, s62, s33
    s_lshl_b32 s38, s38, 7
    s_lshl_b32 s48, s35, 17
    s_add_u32 s48, s48, s38
    s_lshl_b32 s49, s35, 10
    s_add_u32 s49, s49, s38
    s_add_u32 s49, s49, 1572864
    s_add_u32 s51, s49, 32768
    s_lshl_b32 s38, s62, 15
    s_lshl_b32 s60, s35, 7
    s_add_u32 s60, s60, s38
    s_add_u32 s60, s60, 1339392
    s_cmp_ge_u32 s33, 2
    s_cbranch_scc1 L_C_o1
L_w40:
    s_sleep 1
    ds_read_b32 v6, v0 offset:5048
    s_sub_u32 s3, s3, 1
    s_cbranch_scc1 L_end
    s_waitcnt lgkmcnt(0)
    v_cmp_gt_u32 vcc, 4, v6
    s_cbranch_vccnz L_w40
    s_add_u32 s39, s48, 0
    buffer_load_dwordx2 v[104:105], v2, s[44:47], s39 offen nt
    s_add_u32 s39, s48, 1024
    buffer_load_dwordx2 v[108:109], v2, s[44:47], s39 offen nt
    s_add_u32 s39, s48, 2048
    buffer_load_dwordx2 v[106:107], v2, s[44:47], s39 offen nt
    s_add_u32 s39, s48, 3072
    buffer_load_dwordx2 v[110:111], v2, s[44:47], s39 offen nt
    s_add_u32 s39, s48, 16384
    buffer_load_dwordx2 v[112:113], v2, s[44:47], s39 offen nt
    s_add_u32 s39, s48, 17408
    buffer_load_dwordx2 v[116:117], v2, s[44:47], s39 offen nt
    s_add_u32 s39, s48, 18432
    buffer_load_dwordx2 v[114:115], v2, s[44:47], s39 offen nt
    s_add_u32 s39, s48, 19456
    buffer_load_dwordx2 v[118:119], v2, s[44:47], s39 offen nt
    s_add_u32 s39, s48, 32768
    buffer_load_dwordx2 v[120:121], v2, s[44:47], s39 offen nt
    s_add_u32 s39, s48, 33792
    buffer_load_dwordx2 v[124:125], v2, s[44:47], s39 offen nt
    s_add_u32 s39, s48, 34816
    buffer_load_dwordx2 v[122:123], v2, s[44:47], s39 offen nt
    s_add_u32 s39, s48, 35840
    buffer_load_dwordx2 v[126:127], v2, s[44:47], s39 offen nt
    s_add_u32 s39, s48, 49152
    buffer_load_dwordx2 v[128:129], v2, s[44:47], s39 offen nt
    s_add_u32 s39, s48, 50176
    buffer_load_dwordx2 v[132:133], v2, s[44:47], s39 offen nt
    s_add_u32 s39, s48, 51200
    buffer_load_dwordx2 v[130:131], v2, s[44:47], s39 offen nt
    s_add_u32 s39, s48, 52224
    buffer_load_dwordx2 v[134:135], v2, s[44:47], s39 offen nt
    s_add_u32 s39, s48, 65536
    buffer_load_dwordx2 v[136:137], v2, s[44:47], s39 offen nt
    s_add_u32 s39, s48, 66560
    buffer_load_dwordx2 v[140:141], v2, s[44:47], s39 offen nt
    s_add_u32 s39, s48, 67584
    buffer_load_dwordx2 v[138:139], v2, s[44:47], s39 offen nt
    s_add_u32 s39, s48, 68608
    buffer_load_dwordx2 v[142:143], v2, s[44:47], s39 offen nt
    s_add_u32 s39, s48, 81920
    buffer_load_dwordx2 v[144:145], v2, s[44:47], s39 offen nt
    s_add_u32 s39, s48, 82944
    buffer_load_dwordx2 v[148:149], v2, s[44:47], s39 offen nt
    s_add_u32 s39, s48, 83968
    buffer_load_dwordx2 v[146:147], v2, s[44:47], s39 offen nt
    s_add_u32 s39, s48, 84992
    buffer_load_dwordx2 v[150:151], v2, s[44:47], s39 offen nt
    s_add_u32 s39, s48, 98304
    buffer_load_dwordx2 v[152:153], v2, s[44:47], s39 offen nt
    s_add_u32 s39, s48, 99328
    buffer_load_dwordx2 v[156:157], v2, s[44:47], s39 offen nt
    s_add_u32 s39, s48, 100352
    buffer_load_dwordx2 v[154:155], v2, s[44:47], s39 offen nt
    s_add_u32 s39, s48, 101376
    buffer_load_dwordx2 v[158:159], v2, s[44:47], s39 offen nt
    s_add_u32 s39, s48, 114688
    buffer_load_dwordx2 v[160:161], v2, s[44:47], s39 offen nt
    s_add_u32 s39, s48, 115712
    buffer_load_dwordx2 v[164:165], v2, s[44:47], s39 offen nt
    s_add_u32 s39, s48, 116736
    buffer_load_dwordx2 v[162:163], v2, s[44:47], s39 offen nt
    s_add_u32 s39, s48, 117760
    buffer_load_dwordx2 v[166:167], v2, s[44:47], s39 offen nt
    s_waitcnt vmcnt(31)
    v_mov_b32 v6, 1
    s_mov_b64 exec, 1
    ds_add_u32 v0, v6 offset:6060
    s_mov_b64 exec, -1
    s_waitcnt vmcnt(0)
    v_swap_b32 v105, v108
    v_swap_b32 v107, v110
    v_swap_b32 v113, v116
    v_swap_b32 v115, v118
    v_swap_b32 v121, v124
    v_swap_b32 v123, v126
    v_swap_b32 v129, v132
    v_swap_b32 v131, v134
    v_swap_b32 v137, v140
    v_swap_b32 v139, v142
    v_swap_b32 v145, v148
    v_swap_b32 v147, v150
    v_swap_b32 v153, v156
    v_swap_b32 v155, v158
    v_swap_b32 v161, v164
    v_swap_b32 v163, v166
L_C_o1:
L_w41:
    s_sleep 1
    ds_read_b32 v6, v0 offset:6048
    s_sub_u32 s3, s3, 1
    s_cbranch_scc1 L_end
    s_waitcnt lgkmcnt(0)
    v_cmp_gt_u32 vcc, 4, v6
    s_cbranch_vccnz L_w41
    s_setprio 2
L_w42:
    ds_read_b32 v6, v0 offset:6052
    s_sub_u32 s3, s3, 1
    s_cbranch_scc1 L_end
    s_waitcnt lgkmcnt(0)
    v_cmp_gt_u32 vcc, 2, v6
    s_cbranch_vccnz L_w42
L_C_x:
    buffer_load_dwordx4 v[40:43], v7, s[40:43], s50 offen sc1
    buffer_load_dwordx4 v[44:47], v7, s[40:43], s50 offen offset:1024 sc1
    s_sub_u32 s3, s3, 1
    s_cbranch_scc1 L_end
    s_waitcnt vmcnt(1)
    v_mfma_f32_16x16x32_bf16 v[24:27], v[20:23], v[40:43], 0
    s_waitcnt vmcnt(0)
    v_mfma_f32_16x16x32_bf16 v[28:31], v[20:23], v[44:47], 0
    v_max3_u32 v12, v40, v41, v42
    v_max3_u32 v12, v12, v43, v44
    v_max3_u32 v12, v12, v45, v46
    v_max_u32 v12, v12, v47
    v_cmp_eq_u32 vcc, -1, v12
    s_cbranch_vccnz L_C_x
    v_cvt_pk_bf16_f32 v24, v24, v24
    v_cvt_pk_bf16_f32 v25, v25, v25
    v_cvt_pk_bf16_f32 v26, v26, v26
    v_cvt_pk_bf16_f32 v27, v27, v27
    v_and_b32 v24, v24, v19
    v_and_b32 v25, v25, v19
    v_and_b32 v26, v26, v19
    v_and_b32 v27, v27, v19
    ds_write_b128 v18, v[24:27] offset:0
    v_cvt_pk_bf16_f32 v28, v28, v28
    v_cvt_pk_bf16_f32 v29, v29, v29
    v_cvt_pk_bf16_f32 v30, v30, v30
    v_cvt_pk_bf16_f32 v31, v31, v31
    v_and_b32 v28, v28, v19
    v_and_b32 v29, v29, v19
    v_and_b32 v30, v30, v19
    v_and_b32 v31, v31, v19
    ds_write_b128 v18, v[28:31] offset:256
    v_mov_b32 v6, 1
    s_mov_b64 exec, 1
    ds_add_u32 v0, v6 offset:6056
    s_mov_b64 exec, -1
    s_cmp_lt_u32 s33, 2
    s_cbranch_scc1 L_C_o2
    s_cmp_lg_u32 s33, 2
    s_cbranch_scc1 L_C_nh
    v_mov_b32 v12, 0
    s_mov_b64 exec, 1
    buffer_store_dword v12, v12, s[40:43], s60 offen sc1
    s_mov_b64 exec, -1
L_C_nh:
    s_branch L_end
L_C_o2:
L_w43:
    ds_read_b32 v6, v0 offset:6056
    s_sub_u32 s3, s3, 1
    s_cbranch_scc1 L_end
    s_waitcnt lgkmcnt(0)
    v_cmp_gt_u32 vcc, 4, v6
    s_cbranch_vccnz L_w43
    ds_read_b128 v[40:43], v3 offset:0
    ds_read_b128 v[44:47], v3 offset:64
    ds_read_b128 v[48:51], v3 offset:128
    ds_read_b128 v[52:55], v3 offset:192
    ds_read_b128 v[56:59], v3 offset:256
    ds_read_b128 v[60:63], v3 offset:320
    ds_read_b128 v[64:67], v3 offset:384
    ds_read_b128 v[68:71], v3 offset:448
    s_waitcnt lgkmcnt(7)
    v_mfma_f32_16x16x32_bf16 v[24:27], v[40:43], v[104:107], 0
    v_mfma_f32_16x16x32_bf16 v[28:31], v[40:43], v[108:111], 0
    s_waitcnt lgkmcnt(6)
    v_mfma_f32_16x16x32_bf16 v[24:27], v[44:47], v[112:115], v[24:27]
    v_mfma_f32_16x16x32_bf16 v[28:31], v[44:47], v[116:119], v[28:31]
    s_waitcnt lgkmcnt(5)
    v_mfma_f32_16x16x32_bf16 v[24:27], v[48:51], v[120:123], v[24:27]
    v_mfma_f32_16x16x32_bf16 v[28:31], v[48:51], v[124:127], v[28:31]
    s_waitcnt lgkmcnt(4)
    v_mfma_f32_16x16x32_bf16 v[24:27], v[52:55], v[128:131], v[24:27]
    v_mfma_f32_16x16x32_bf16 v[28:31], v[52:55], v[132:135], v[28:31]
    s_waitcnt lgkmcnt(3)
    v_mfma_f32_16x16x32_bf16 v[24:27], v[56:59], v[136:139], v[24:27]
    v_mfma_f32_16x16x32_bf16 v[28:31], v[56:59], v[140:143], v[28:31]
    s_waitcnt lgkmcnt(2)
    v_mfma_f32_16x16x32_bf16 v[24:27], v[60:63], v[144:147], v[24:27]
    v_mfma_f32_16x16x32_bf16 v[28:31], v[60:63], v[148:151], v[28:31]
    s_waitcnt lgkmcnt(1)
    v_mfma_f32_16x16x32_bf16 v[24:27], v[64:67], v[152:155], v[24:27]
    v_mfma_f32_16x16x32_bf16 v[28:31], v[64:67], v[156:159], v[28:31]
    s_waitcnt lgkmcnt(0)
    v_mfma_f32_16x16x32_bf16 v[24:27], v[68:71], v[160:163], v[24:27]
    v_mfma_f32_16x16x32_bf16 v[28:31], v[68:71], v[164:167], v[28:31]
    s_nop 6
    v_cvt_pk_bf16_f32 v8, v24, v25
    v_cvt_pk_bf16_f32 v10, v26, v27
    v_cvt_pk_bf16_f32 v9, v28, v29
    v_cvt_pk_bf16_f32 v11, v30, v31
    buffer_store_dwordx2 v[8:9], v4, s[40:43], s49 offen sc1
    buffer_store_dwordx2 v[10:11], v4, s[40:43], s51 offen sc1
    s_branch L_end
L_C_at:

    v_lshrrev_b32 v7, 5, v1
    v_bfe_u32 v2, v1, 2, 2
    v_lshl_add_u32 v3, v7, 2, v2
    v_lshrrev_b32 v2, 1, v2
    v_lshl_or_b32 v2, v2, 2, v7
    v_bfe_u32 v4, v1, 4, 1
    v_bfe_u32 v5, v1, 1, 1
    v_lshl_or_b32 v4, v4, 1, v5
    v_xor_b32 v2, v2, v4
    v_lshlrev_b32 v2, 4, v2
    v_lshl_add_u32 v2, v3, 7, v2
    v_and_b32 v3, 1, v1
    v_lshl_add_u32 v2, v3, 3, v2
    s_and_b32 s38, s33, 1
    s_lshl_b32 s38, s38, 6
    s_lshr_b32 s39, s33, 1
    s_lshl_b32 s39, s39, 14
    s_or_b32 s38, s38, s39
    v_xor_b32 v2, s38, v2
    v_xor_b32 v3, 1056, v2
    v_lshlrev_b32 v4, 4, v1
    v_add_u32 v4, 131072, v4
    s_waitcnt vmcnt(0)
L_w444:
    s_sleep 1
    ds_read_b128 v[8:11], v0 offset:4032
    s_sub_u32 s3, s3, 1
    s_cbranch_scc1 L_end
    s_waitcnt lgkmcnt(0)
    v_min3_u32 v8, v8, v9, v10
    v_min_u32 v8, v8, v11
    v_cmp_gt_u32 vcc, 2, v8
    s_cbranch_vccnz L_w444
    ds_read_b64_tr_b16 v[40:41], v2 offset:0
    ds_read_b64_tr_b16 v[42:43], v3 offset:0
    ds_read_b64_tr_b16 v[44:45], v2 offset:2048
    ds_read_b64_tr_b16 v[46:47], v3 offset:2048
    ds_read_b64_tr_b16 v[48:49], v2 offset:4096
    ds_read_b64_tr_b16 v[50:51], v3 offset:4096
    ds_read_b64_tr_b16 v[52:53], v2 offset:6144
    ds_read_b64_tr_b16 v[54:55], v3 offset:6144
    ds_read_b64_tr_b16 v[56:57], v2 offset:8192
    ds_read_b64_tr_b16 v[58:59], v3 offset:8192
    ds_read_b64_tr_b16 v[60:61], v2 offset:10240
    ds_read_b64_tr_b16 v[62:63], v3 offset:10240
    s_waitcnt lgkmcnt(6)
    ds_read_b64_tr_b16 v[64:65], v2 offset:12288
    ds_read_b64_tr_b16 v[66:67], v3 offset:12288
    ds_read_b64_tr_b16 v[68:69], v2 offset:14336
    ds_read_b64_tr_b16 v[70:71], v3 offset:14336
    v_mov_b32 v5, 1
    s_mov_b64 exec, 1
    ds_add_u32 v0, v5 offset:3024
    s_mov_b64 exec, -1
L_w445:
    s_sleep 1
    ds_read_b128 v[8:11], v0 offset:4032
    s_sub_u32 s3, s3, 1
    s_cbranch_scc1 L_end
    s_waitcnt lgkmcnt(0)
    v_min3_u32 v8, v8, v9, v10
    v_min_u32 v8, v8, v11
    v_cmp_gt_u32 vcc, 4, v8
    s_cbranch_vccnz L_w445
    ds_read_b64_tr_b16 v[72:73], v2 offset:32768
    ds_read_b64_tr_b16 v[74:75], v3 offset:32768
    ds_read_b64_tr_b16 v[76:77], v2 offset:34816
    ds_read_b64_tr_b16 v[78:79], v3 offset:34816
    ds_read_b64_tr_b16 v[80:81], v2 offset:36864
    ds_read_b64_tr_b16 v[82:83], v3 offset:36864
    ds_read_b64_tr_b16 v[84:85], v2 offset:38912
    ds_read_b64_tr_b16 v[86:87], v3 offset:38912
    ds_read_b64_tr_b16 v[88:89], v2 offset:40960
    ds_read_b64_tr_b16 v[90:91], v3 offset:40960
    ds_read_b64_tr_b16 v[92:93], v2 offset:43008
    ds_read_b64_tr_b16 v[94:95], v3 offset:43008
    s_waitcnt lgkmcnt(6)
    ds_read_b64_tr_b16 v[96:97], v2 offset:45056
    ds_read_b64_tr_b16 v[98:99], v3 offset:45056
    ds_read_b64_tr_b16 v[100:101], v2 offset:47104
    ds_read_b64_tr_b16 v[102:103], v3 offset:47104
    v_mov_b32 v5, 1
    s_mov_b64 exec, 1
    ds_add_u32 v0, v5 offset:3028
    s_mov_b64 exec, -1
L_w446:
    s_sleep 1
    ds_read_b128 v[8:11], v0 offset:4032
    s_sub_u32 s3, s3, 1
    s_cbranch_scc1 L_end
    s_waitcnt lgkmcnt(0)
    v_min3_u32 v8, v8, v9, v10
    v_min_u32 v8, v8, v11
    v_cmp_gt_u32 vcc, 6, v8
    s_cbranch_vccnz L_w446
    v_add_u32 v2, 0x10000, v2
    v_add_u32 v3, 0x10000, v3
    ds_read_b64_tr_b16 v[104:105], v2 offset:0
    ds_read_b64_tr_b16 v[106:107], v3 offset:0
    ds_read_b64_tr_b16 v[108:109], v2 offset:2048
    ds_read_b64_tr_b16 v[110:111], v3 offset:2048
    ds_read_b64_tr_b16 v[112:113], v2 offset:4096
    ds_read_b64_tr_b16 v[114:115], v3 offset:4096
    ds_read_b64_tr_b16 v[116:117], v2 offset:6144
    ds_read_b64_tr_b16 v[118:119], v3 offset:6144
    ds_read_b64_tr_b16 v[120:121], v2 offset:8192
    ds_read_b64_tr_b16 v[122:123], v3 offset:8192
    ds_read_b64_tr_b16 v[124:125], v2 offset:10240
    ds_read_b64_tr_b16 v[126:127], v3 offset:10240
    s_waitcnt lgkmcnt(6)
    ds_read_b64_tr_b16 v[128:129], v2 offset:12288
    ds_read_b64_tr_b16 v[130:131], v3 offset:12288
    ds_read_b64_tr_b16 v[132:133], v2 offset:14336
    ds_read_b64_tr_b16 v[134:135], v3 offset:14336
    v_mov_b32 v5, 1
    s_mov_b64 exec, 1
    ds_add_u32 v0, v5 offset:3032
    s_mov_b64 exec, -1
L_w447:
    s_sleep 1
    ds_read_b128 v[8:11], v0 offset:4032
    s_sub_u32 s3, s3, 1
    s_cbranch_scc1 L_end
    s_waitcnt lgkmcnt(0)
    v_min3_u32 v8, v8, v9, v10
    v_min_u32 v8, v8, v11
    v_cmp_gt_u32 vcc, 8, v8
    s_cbranch_vccnz L_w447
    ds_read_b64_tr_b16 v[136:137], v2 offset:32768
    ds_read_b64_tr_b16 v[138:139], v3 offset:32768
    ds_read_b64_tr_b16 v[140:141], v2 offset:34816
    ds_read_b64_tr_b16 v[142:143], v3 offset:34816
    ds_read_b64_tr_b16 v[144:145], v2 offset:36864
    ds_read_b64_tr_b16 v[146:147], v3 offset:36864
    ds_read_b64_tr_b16 v[148:149], v2 offset:38912
    ds_read_b64_tr_b16 v[150:151], v3 offset:38912
    ds_read_b64_tr_b16 v[152:153], v2 offset:40960
    ds_read_b64_tr_b16 v[154:155], v3 offset:40960
    ds_read_b64_tr_b16 v[156:157], v2 offset:43008
    ds_read_b64_tr_b16 v[158:159], v3 offset:43008
    s_waitcnt lgkmcnt(6)
    ds_read_b64_tr_b16 v[160:161], v2 offset:45056
    ds_read_b64_tr_b16 v[162:163], v3 offset:45056
    ds_read_b64_tr_b16 v[164:165], v2 offset:47104
    ds_read_b64_tr_b16 v[166:167], v3 offset:47104
    v_mov_b32 v5, 1
    s_mov_b64 exec, 1
    ds_add_u32 v0, v5 offset:3036
    s_mov_b64 exec, -1
    v_subrev_u32 v2, 0x10000, v2
    v_subrev_u32 v3, 0x10000, v3
L_w48:
    s_sleep 2
    ds_read_b32 v5, v0 offset:1008
    s_sub_u32 s3, s3, 1
    s_cbranch_scc1 L_end
    s_waitcnt lgkmcnt(0)
    v_cmp_gt_u32 vcc, 4, v5
    s_cbranch_vccnz L_w48
    s_setprio 1
L_w49:
    s_sleep 1
    ds_read_b32 v5, v0 offset:1016
    s_sub_u32 s3, s3, 1
    s_cbranch_scc1 L_end
    s_waitcnt lgkmcnt(0)
    v_cmp_gt_u32 vcc, 1, v5
    s_cbranch_vccnz L_w49
L_w50:
    ds_read_b32 v5, v0 offset:1016
    s_sub_u32 s3, s3, 1
    s_cbranch_scc1 L_end
    s_waitcnt lgkmcnt(0)
    v_cmp_gt_u32 vcc, 4, v5
    s_cbranch_vccnz L_w50
    ds_read_b128 v[24:27], v4 offset:0
    ds_read_b128 v[28:31], v4 offset:1024
    ds_read_b128 v[32:35], v4 offset:2048
    ds_read_b128 v[36:39], v4 offset:3072
    s_waitcnt lgkmcnt(3)
    v_mfma_f32_32x32x16_bf16 v[8:23], v[24:27], v[40:43], 0
    ds_read_b128 v[24:27], v4 offset:4096
    s_waitcnt lgkmcnt(3)
    v_mfma_f32_32x32x16_bf16 v[8:23], v[28:31], v[44:47], v[8:23]
    ds_read_b128 v[28:31], v4 offset:5120
    s_waitcnt lgkmcnt(3)
    v_mfma_f32_32x32x16_bf16 v[8:23], v[32:35], v[48:51], v[8:23]
    ds_read_b128 v[32:35], v4 offset:6144
    s_waitcnt lgkmcnt(3)
    v_mfma_f32_32x32x16_bf16 v[8:23], v[36:39], v[52:55], v[8:23]
    ds_read_b128 v[36:39], v4 offset:7168
    s_waitcnt lgkmcnt(3)
    v_mfma_f32_32x32x16_bf16 v[8:23], v[24:27], v[56:59], v[8:23]
    ds_read_b128 v[24:27], v4 offset:0
    s_waitcnt lgkmcnt(3)
    v_mfma_f32_32x32x16_bf16 v[8:23], v[28:31], v[60:63], v[8:23]
    ds_read_b128 v[28:31], v4 offset:1024
    s_waitcnt lgkmcnt(3)
    v_mfma_f32_32x32x16_bf16 v[8:23], v[32:35], v[64:67], v[8:23]
    ds_read_b128 v[32:35], v4 offset:2048
    s_waitcnt lgkmcnt(3)
    v_mfma_f32_32x32x16_bf16 v[8:23], v[36:39], v[68:71], v[8:23]
    ds_read_b128 v[36:39], v4 offset:3072
    s_waitcnt lgkmcnt(3)
    v_mfma_f32_32x32x16_bf16 v[40:55], v[24:27], v[72:75], 0
    ds_read_b128 v[24:27], v4 offset:4096
    s_waitcnt lgkmcnt(3)
    v_mfma_f32_32x32x16_bf16 v[40:55], v[28:31], v[76:79], v[40:55]
    ds_read_b128 v[28:31], v4 offset:5120
    s_waitcnt lgkmcnt(3)
    v_mfma_f32_32x32x16_bf16 v[40:55], v[32:35], v[80:83], v[40:55]
    ds_read_b128 v[32:35], v4 offset:6144
    s_waitcnt lgkmcnt(3)
    v_mfma_f32_32x32x16_bf16 v[40:55], v[36:39], v[84:87], v[40:55]
    ds_read_b128 v[36:39], v4 offset:7168
    s_waitcnt lgkmcnt(3)
    v_mfma_f32_32x32x16_bf16 v[40:55], v[24:27], v[88:91], v[40:55]
    ds_read_b128 v[24:27], v4 offset:0
    s_waitcnt lgkmcnt(3)
    v_mfma_f32_32x32x16_bf16 v[40:55], v[28:31], v[92:95], v[40:55]
    ds_read_b128 v[28:31], v4 offset:1024
    s_waitcnt lgkmcnt(3)
    v_mfma_f32_32x32x16_bf16 v[40:55], v[32:35], v[96:99], v[40:55]
    ds_read_b128 v[32:35], v4 offset:2048
    s_waitcnt lgkmcnt(3)
    v_mfma_f32_32x32x16_bf16 v[40:55], v[36:39], v[100:103], v[40:55]
    ds_read_b128 v[36:39], v4 offset:3072
    s_waitcnt lgkmcnt(3)
    v_mfma_f32_32x32x16_bf16 v[56:71], v[24:27], v[104:107], 0
    ds_read_b128 v[24:27], v4 offset:4096
    s_waitcnt lgkmcnt(3)
    v_mfma_f32_32x32x16_bf16 v[56:71], v[28:31], v[108:111], v[56:71]
    ds_read_b128 v[28:31], v4 offset:5120
    s_waitcnt lgkmcnt(3)
    v_mfma_f32_32x32x16_bf16 v[56:71], v[32:35], v[112:115], v[56:71]
    ds_read_b128 v[32:35], v4 offset:6144
    s_waitcnt lgkmcnt(3)
    v_mfma_f32_32x32x16_bf16 v[56:71], v[36:39], v[116:119], v[56:71]
    ds_read_b128 v[36:39], v4 offset:7168
    s_waitcnt lgkmcnt(3)
    v_mfma_f32_32x32x16_bf16 v[56:71], v[24:27], v[120:123], v[56:71]
    ds_read_b128 v[24:27], v4 offset:0
    s_waitcnt lgkmcnt(3)
    v_mfma_f32_32x32x16_bf16 v[56:71], v[28:31], v[124:127], v[56:71]
    ds_read_b128 v[28:31], v4 offset:1024
    s_waitcnt lgkmcnt(3)
    v_mfma_f32_32x32x16_bf16 v[56:71], v[32:35], v[128:131], v[56:71]
    ds_read_b128 v[32:35], v4 offset:2048
    s_waitcnt lgkmcnt(3)
    v_mfma_f32_32x32x16_bf16 v[56:71], v[36:39], v[132:135], v[56:71]
    ds_read_b128 v[36:39], v4 offset:3072
    s_waitcnt lgkmcnt(3)
    v_mfma_f32_32x32x16_bf16 v[72:87], v[24:27], v[136:139], 0
    ds_read_b128 v[24:27], v4 offset:4096
    s_waitcnt lgkmcnt(3)
    v_mfma_f32_32x32x16_bf16 v[72:87], v[28:31], v[140:143], v[72:87]
    ds_read_b128 v[28:31], v4 offset:5120
    s_waitcnt lgkmcnt(3)
    v_mfma_f32_32x32x16_bf16 v[72:87], v[32:35], v[144:147], v[72:87]
    ds_read_b128 v[32:35], v4 offset:6144
    s_waitcnt lgkmcnt(3)
    v_mfma_f32_32x32x16_bf16 v[72:87], v[36:39], v[148:151], v[72:87]
    ds_read_b128 v[36:39], v4 offset:7168
    s_waitcnt lgkmcnt(3)
    v_mfma_f32_32x32x16_bf16 v[72:87], v[24:27], v[152:155], v[72:87]
    s_waitcnt lgkmcnt(2)
    v_mfma_f32_32x32x16_bf16 v[72:87], v[28:31], v[156:159], v[72:87]
    s_waitcnt lgkmcnt(1)
    v_mfma_f32_32x32x16_bf16 v[72:87], v[32:35], v[160:163], v[72:87]
    s_waitcnt lgkmcnt(0)
    v_mfma_f32_32x32x16_bf16 v[72:87], v[36:39], v[164:167], v[72:87]

    v_lshlrev_b32 v32, 4, v7
    v_add_u32 v32, 147968, v32
    v_bfe_u32 v36, v1, 4, 1
    v_lshrrev_b32 v37, 5, v1
    v_lshl_add_u32 v36, v37, 2, v36
    v_lshlrev_b32 v36, 14, v36
    v_and_b32 v37, 15, v1
    v_lshl_add_u32 v36, v37, 4, v36
    s_lshl_b32 s55, s36, 19
    s_lshl2_add_u32 s38, s97, s33
    s_lshl_b32 s38, s38, 8
    s_add_u32 s55, s55, s38
    s_add_u32 s55, s55, 2097152
    v_lshlrev_b32 v37, 2, v37
    v_add_u32 v37, 149504, v37
    v_mov_b32 v38, -1
    ds_write_b32 v37, v38
L_w451:
    s_sleep 1
    ds_read_b128 v[24:27], v0 offset:4032
    s_sub_u32 s3, s3, 1
    s_cbranch_scc1 L_end
    s_waitcnt lgkmcnt(0)
    v_min3_u32 v24, v24, v25, v26
    v_min_u32 v24, v24, v27
    v_cmp_gt_u32 vcc, 16, v24
    s_cbranch_vccnz L_w451
    s_setprio 3
    ds_read_b64_tr_b16 v[136:137], v2 offset:0
    ds_read_b64_tr_b16 v[138:139], v3 offset:0
    ds_read_b64_tr_b16 v[140:141], v2 offset:2048
    ds_read_b64_tr_b16 v[142:143], v3 offset:2048
    ds_read_b64_tr_b16 v[144:145], v2 offset:4096
    ds_read_b64_tr_b16 v[146:147], v3 offset:4096
    ds_read_b64_tr_b16 v[148:149], v2 offset:6144
    ds_read_b64_tr_b16 v[150:151], v3 offset:6144
L_w52:
    ds_read_b32 v5, v0 offset:1020
    s_sub_u32 s3, s3, 1
    s_cbranch_scc1 L_end
    s_waitcnt lgkmcnt(0)
    v_cmp_gt_u32 vcc, 1, v5
    s_cbranch_vccnz L_w52
    ds_read_b128 v[88:91], v32 offset:0
    ds_read_b128 v[92:95], v32 offset:32
    ds_read_b128 v[96:99], v32 offset:64
    ds_read_b128 v[100:103], v32 offset:96
    s_waitcnt lgkmcnt(0)
    v_pk_mul_f32 v[8:9], v[8:9], v[88:89]
    v_pk_mul_f32 v[10:11], v[10:11], v[90:91]
    v_pk_mul_f32 v[12:13], v[12:13], v[92:93]
    v_pk_mul_f32 v[14:15], v[14:15], v[94:95]
    v_pk_mul_f32 v[16:17], v[16:17], v[96:97]
    v_pk_mul_f32 v[18:19], v[18:19], v[98:99]
    v_pk_mul_f32 v[20:21], v[20:21], v[100:101]
    v_pk_mul_f32 v[22:23], v[22:23], v[102:103]
    v_pk_mul_f32 v[40:41], v[40:41], v[88:89]
    v_pk_mul_f32 v[42:43], v[42:43], v[90:91]
    v_pk_mul_f32 v[44:45], v[44:45], v[92:93]
    v_pk_mul_f32 v[46:47], v[46:47], v[94:95]
    v_pk_mul_f32 v[48:49], v[48:49], v[96:97]
    v_pk_mul_f32 v[50:51], v[50:51], v[98:99]
    v_pk_mul_f32 v[52:53], v[52:53], v[100:101]
    v_pk_mul_f32 v[54:55], v[54:55], v[102:103]
    v_pk_mul_f32 v[56:57], v[56:57], v[88:89]
    v_pk_mul_f32 v[58:59], v[58:59], v[90:91]
    v_pk_mul_f32 v[60:61], v[60:61], v[92:93]
    v_pk_mul_f32 v[62:63], v[62:63], v[94:95]
    v_pk_mul_f32 v[64:65], v[64:65], v[96:97]
    v_pk_mul_f32 v[66:67], v[66:67], v[98:99]
    v_pk_mul_f32 v[68:69], v[68:69], v[100:101]
    v_pk_mul_f32 v[70:71], v[70:71], v[102:103]
    v_pk_mul_f32 v[72:73], v[72:73], v[88:89]
    v_pk_mul_f32 v[74:75], v[74:75], v[90:91]
    v_pk_mul_f32 v[76:77], v[76:77], v[92:93]
    v_pk_mul_f32 v[78:79], v[78:79], v[94:95]
    v_pk_mul_f32 v[80:81], v[80:81], v[96:97]
    v_pk_mul_f32 v[82:83], v[82:83], v[98:99]
    v_pk_mul_f32 v[84:85], v[84:85], v[100:101]
    v_pk_mul_f32 v[86:87], v[86:87], v[102:103]
L_w53:
    ds_read_b32 v5, v0 offset:1016
    s_sub_u32 s3, s3, 1
    s_cbranch_scc1 L_end
    s_waitcnt lgkmcnt(0)
    v_cmp_gt_u32 vcc, 8, v5
    s_cbranch_vccnz L_w53
    ds_read_b128 v[104:107], v4 offset:8192
    ds_read_b128 v[108:111], v4 offset:9216
    ds_read_b128 v[112:115], v4 offset:10240
    ds_read_b128 v[116:119], v4 offset:11264
    ds_read_b128 v[120:123], v4 offset:12288
    ds_read_b128 v[124:127], v4 offset:13312
    ds_read_b128 v[128:131], v4 offset:14336
    ds_read_b128 v[132:135], v4 offset:15360
    ds_read_b64_tr_b16 v[152:153], v2 offset:8192
    ds_read_b64_tr_b16 v[154:155], v3 offset:8192
    s_waitcnt lgkmcnt(9)
    v_mfma_f32_32x32x16_bf16 v[8:23], v[104:107], v[136:139], v[8:23]
    ds_read_b64_tr_b16 v[156:157], v2 offset:10240
    ds_read_b64_tr_b16 v[158:159], v3 offset:10240
    s_waitcnt lgkmcnt(10)
    v_mfma_f32_32x32x16_bf16 v[8:23], v[108:111], v[140:143], v[8:23]
    ds_read_b64_tr_b16 v[160:161], v2 offset:12288
    ds_read_b64_tr_b16 v[162:163], v3 offset:12288
    s_waitcnt lgkmcnt(11)
    v_mfma_f32_32x32x16_bf16 v[8:23], v[112:115], v[144:147], v[8:23]
    ds_read_b64_tr_b16 v[136:137], v2 offset:14336
    ds_read_b64_tr_b16 v[138:139], v3 offset:14336
    s_waitcnt lgkmcnt(12)
    v_mfma_f32_32x32x16_bf16 v[8:23], v[116:119], v[148:151], v[8:23]
    s_waitcnt lgkmcnt(11)
    ds_read_b64_tr_b16 v[140:141], v2 offset:32768
    ds_read_b64_tr_b16 v[142:143], v3 offset:32768
    s_waitcnt lgkmcnt(8)
    v_mfma_f32_32x32x16_bf16 v[8:23], v[120:123], v[152:155], v[8:23]
    ds_read_b64_tr_b16 v[144:145], v2 offset:34816
    ds_read_b64_tr_b16 v[146:147], v3 offset:34816
    s_waitcnt lgkmcnt(8)
    v_mfma_f32_32x32x16_bf16 v[8:23], v[124:127], v[156:159], v[8:23]
    ds_read_b64_tr_b16 v[148:149], v2 offset:36864
    ds_read_b64_tr_b16 v[150:151], v3 offset:36864
    s_waitcnt lgkmcnt(8)
    v_mfma_f32_32x32x16_bf16 v[8:23], v[128:131], v[160:163], v[8:23]
    ds_read_b64_tr_b16 v[152:153], v2 offset:38912
    ds_read_b64_tr_b16 v[154:155], v3 offset:38912
    s_waitcnt lgkmcnt(8)
    v_mfma_f32_32x32x16_bf16 v[8:23], v[132:135], v[136:139], v[8:23]
    ds_read_b64_tr_b16 v[156:157], v2 offset:40960
    ds_read_b64_tr_b16 v[158:159], v3 offset:40960
    s_waitcnt lgkmcnt(8)
    v_mfma_f32_32x32x16_bf16 v[40:55], v[104:107], v[140:143], v[40:55]
    ds_read_b64_tr_b16 v[160:161], v2 offset:43008
    ds_read_b64_tr_b16 v[162:163], v3 offset:43008
    s_waitcnt lgkmcnt(8)
    v_mfma_f32_32x32x16_bf16 v[40:55], v[108:111], v[144:147], v[40:55]
    ds_read_b64_tr_b16 v[136:137], v2 offset:45056
    ds_read_b64_tr_b16 v[138:139], v3 offset:45056
    s_waitcnt lgkmcnt(8)
    v_mfma_f32_32x32x16_bf16 v[40:55], v[112:115], v[148:151], v[40:55]
    ds_read_b64_tr_b16 v[140:141], v2 offset:47104
    ds_read_b64_tr_b16 v[142:143], v3 offset:47104
    s_waitcnt lgkmcnt(8)
    v_mfma_f32_32x32x16_bf16 v[40:55], v[116:119], v[152:155], v[40:55]
    v_add_u32 v2, 0x10000, v2
    v_add_u32 v3, 0x10000, v3
    ds_read_b64_tr_b16 v[144:145], v2 offset:0
    ds_read_b64_tr_b16 v[146:147], v3 offset:0
    s_waitcnt lgkmcnt(8)
    v_mfma_f32_32x32x16_bf16 v[40:55], v[120:123], v[156:159], v[40:55]
    ds_read_b64_tr_b16 v[148:149], v2 offset:2048
    ds_read_b64_tr_b16 v[150:151], v3 offset:2048
    s_waitcnt lgkmcnt(8)
    v_mfma_f32_32x32x16_bf16 v[40:55], v[124:127], v[160:163], v[40:55]
    ds_read_b64_tr_b16 v[152:153], v2 offset:4096
    ds_read_b64_tr_b16 v[154:155], v3 offset:4096
    s_waitcnt lgkmcnt(8)
    v_mfma_f32_32x32x16_bf16 v[40:55], v[128:131], v[136:139], v[40:55]
    ds_read_b64_tr_b16 v[156:157], v2 offset:6144
    ds_read_b64_tr_b16 v[158:159], v3 offset:6144
    s_waitcnt lgkmcnt(8)
    v_mfma_f32_32x32x16_bf16 v[40:55], v[132:135], v[140:143], v[40:55]
    ds_read_b64_tr_b16 v[160:161], v2 offset:8192
    ds_read_b64_tr_b16 v[162:163], v3 offset:8192
    s_waitcnt lgkmcnt(8)
    v_mfma_f32_32x32x16_bf16 v[56:71], v[104:107], v[144:147], v[56:71]
    ds_write_b32 v0, v38 offset:7060
    ds_read_b64_tr_b16 v[136:137], v2 offset:10240
    ds_read_b64_tr_b16 v[138:139], v3 offset:10240
    s_waitcnt lgkmcnt(9)
    v_mfma_f32_32x32x16_bf16 v[56:71], v[108:111], v[148:151], v[56:71]
    ds_read_b64_tr_b16 v[140:141], v2 offset:12288
    ds_read_b64_tr_b16 v[142:143], v3 offset:12288
    s_waitcnt lgkmcnt(9)
    v_mfma_f32_32x32x16_bf16 v[56:71], v[112:115], v[152:155], v[56:71]
    ds_read_b64_tr_b16 v[144:145], v2 offset:14336
    ds_read_b64_tr_b16 v[146:147], v3 offset:14336
    s_waitcnt lgkmcnt(9)
    v_mfma_f32_32x32x16_bf16 v[56:71], v[116:119], v[156:159], v[56:71]
    ds_read_b64_tr_b16 v[148:149], v2 offset:32768
    ds_read_b64_tr_b16 v[150:151], v3 offset:32768
    s_waitcnt lgkmcnt(9)
    v_mfma_f32_32x32x16_bf16 v[56:71], v[120:123], v[160:163], v[56:71]
    ds_read_b64_tr_b16 v[152:153], v2 offset:34816
    ds_read_b64_tr_b16 v[154:155], v3 offset:34816
    s_waitcnt lgkmcnt(8)
    v_mfma_f32_32x32x16_bf16 v[56:71], v[124:127], v[136:139], v[56:71]
    ds_read_b64_tr_b16 v[156:157], v2 offset:36864
    ds_read_b64_tr_b16 v[158:159], v3 offset:36864
    s_waitcnt lgkmcnt(8)
    v_mfma_f32_32x32x16_bf16 v[56:71], v[128:131], v[140:143], v[56:71]
    ds_read_b64_tr_b16 v[160:161], v2 offset:38912
    ds_read_b64_tr_b16 v[162:163], v3 offset:38912
    s_waitcnt lgkmcnt(8)
    v_mfma_f32_32x32x16_bf16 v[56:71], v[132:135], v[144:147], v[56:71]
    ds_read_b64_tr_b16 v[136:137], v2 offset:40960
    ds_read_b64_tr_b16 v[138:139], v3 offset:40960
    s_waitcnt lgkmcnt(8)
    v_mfma_f32_32x32x16_bf16 v[72:87], v[104:107], v[148:151], v[72:87]
    ds_read_b64_tr_b16 v[140:141], v2 offset:43008
    ds_read_b64_tr_b16 v[142:143], v3 offset:43008
    s_waitcnt lgkmcnt(8)
    v_mfma_f32_32x32x16_bf16 v[72:87], v[108:111], v[152:155], v[72:87]
    ds_read_b64_tr_b16 v[144:145], v2 offset:45056
    ds_read_b64_tr_b16 v[146:147], v3 offset:45056
    s_waitcnt lgkmcnt(8)
    v_mfma_f32_32x32x16_bf16 v[72:87], v[112:115], v[156:159], v[72:87]
    ds_read_b64_tr_b16 v[148:149], v2 offset:47104
    ds_read_b64_tr_b16 v[150:151], v3 offset:47104
    s_waitcnt lgkmcnt(8)
    v_mfma_f32_32x32x16_bf16 v[72:87], v[116:119], v[160:163], v[72:87]
    s_waitcnt lgkmcnt(6)
    v_mfma_f32_32x32x16_bf16 v[72:87], v[120:123], v[136:139], v[72:87]
    s_waitcnt lgkmcnt(4)
    v_mfma_f32_32x32x16_bf16 v[72:87], v[124:127], v[140:143], v[72:87]
    s_waitcnt lgkmcnt(2)
    v_mfma_f32_32x32x16_bf16 v[72:87], v[128:131], v[144:147], v[72:87]
    s_waitcnt lgkmcnt(0)
    v_mfma_f32_32x32x16_bf16 v[72:87], v[132:135], v[148:151], v[72:87]
L_w54:
    ds_read_b32 v5, v0 offset:2024
    s_sub_u32 s3, s3, 1
    s_cbranch_scc1 L_end
    s_waitcnt lgkmcnt(0)
    v_cmp_gt_u32 vcc, 4, v5
    s_cbranch_vccnz L_w54
    v_cvt_pk_bf16_f32 v136, v8, v40
    v_cvt_pk_bf16_f32 v137, v9, v41
    s_nop 3
    v_cvt_pk_bf16_f32 v138, v56, v72
    v_cvt_pk_bf16_f32 v139, v57, v73
    s_add_u32 s38, s55, 0
    v_permlane16_swap_b32 v136, v137
    v_permlane16_swap_b32 v138, v139
    buffer_store_dwordx4 v[136:139], v36, s[40:43], s38 offen sc1
    v_cvt_pk_bf16_f32 v140, v10, v42
    v_cvt_pk_bf16_f32 v141, v11, v43
    v_cvt_pk_bf16_f32 v142, v58, v74
    v_cvt_pk_bf16_f32 v143, v59, v75
    s_add_u32 s38, s55, 32768
    v_permlane16_swap_b32 v140, v141
    v_permlane16_swap_b32 v142, v143
    buffer_store_dwordx4 v[140:143], v36, s[40:43], s38 offen sc1
    v_cvt_pk_bf16_f32 v144, v12, v44
    v_cvt_pk_bf16_f32 v145, v13, v45
    v_cvt_pk_bf16_f32 v146, v60, v76
    v_cvt_pk_bf16_f32 v147, v61, v77
    s_add_u32 s38, s55, 131072
    v_permlane16_swap_b32 v144, v145
    v_permlane16_swap_b32 v146, v147
    buffer_store_dwordx4 v[144:147], v36, s[40:43], s38 offen sc1
    v_cvt_pk_bf16_f32 v148, v14, v46
    v_cvt_pk_bf16_f32 v149, v15, v47
    v_cvt_pk_bf16_f32 v150, v62, v78
    v_cvt_pk_bf16_f32 v151, v63, v79
    s_add_u32 s38, s55, 163840
    v_permlane16_swap_b32 v148, v149
    v_permlane16_swap_b32 v150, v151
    buffer_store_dwordx4 v[148:151], v36, s[40:43], s38 offen sc1
    v_cvt_pk_bf16_f32 v152, v16, v48
    v_cvt_pk_bf16_f32 v153, v17, v49
    v_cvt_pk_bf16_f32 v154, v64, v80
    v_cvt_pk_bf16_f32 v155, v65, v81
    s_add_u32 s38, s55, 262144
    v_permlane16_swap_b32 v152, v153
    v_permlane16_swap_b32 v154, v155
    buffer_store_dwordx4 v[152:155], v36, s[40:43], s38 offen sc1
    v_cvt_pk_bf16_f32 v156, v18, v50
    v_cvt_pk_bf16_f32 v157, v19, v51
    v_cvt_pk_bf16_f32 v158, v66, v82
    v_cvt_pk_bf16_f32 v159, v67, v83
    s_add_u32 s38, s55, 294912
    v_permlane16_swap_b32 v156, v157
    v_permlane16_swap_b32 v158, v159
    buffer_store_dwordx4 v[156:159], v36, s[40:43], s38 offen sc1
    v_cvt_pk_bf16_f32 v160, v20, v52
    v_cvt_pk_bf16_f32 v161, v21, v53
    v_cvt_pk_bf16_f32 v162, v68, v84
    v_cvt_pk_bf16_f32 v163, v69, v85
    s_add_u32 s38, s55, 393216
    v_permlane16_swap_b32 v160, v161
    v_permlane16_swap_b32 v162, v163
    buffer_store_dwordx4 v[160:163], v36, s[40:43], s38 offen sc1
    v_cvt_pk_bf16_f32 v164, v22, v54
    v_cvt_pk_bf16_f32 v165, v23, v55
    v_cvt_pk_bf16_f32 v166, v70, v86
    v_cvt_pk_bf16_f32 v167, v71, v87
    s_add_u32 s38, s55, 425984
    v_permlane16_swap_b32 v164, v165
    v_permlane16_swap_b32 v166, v167
    buffer_store_dwordx4 v[164:167], v36, s[40:43], s38 offen sc1
    s_waitcnt vmcnt(0)
    v_mov_b32 v5, 1
    s_mov_b64 exec, 1
    ds_add_u32 v0, v5 offset:1012
    s_mov_b64 exec, -1
L_end:
L_exit:
    s_endpgm
L_codeend:
.section .rodata,"a"
.p2align 6
.amdhsa_kernel adaLN_cond__compressed_kv_cla__dense_activation_relu__decode_kernel
.amdhsa_next_free_vgpr 168
.amdhsa_next_free_sgpr 102
.amdhsa_accum_offset 168
.amdhsa_group_segment_fixed_size 0
.amdhsa_kernarg_size 112
.amdhsa_user_sgpr_count 2
.amdhsa_user_sgpr_kernarg_segment_ptr 1
.amdhsa_system_sgpr_workgroup_id_x 1
.amdhsa_float_denorm_mode_32 3
.end_amdhsa_kernel
.text
```

```asm
; @launch grid=(256,1,1) block=(768,1,1) lds=163840
.amdgcn_target "amdgcn-amd-amdhsa--gfx950"
.text
.globl adaLN_cond__compressed_kv_cla__dense_activation_relu__decode_kernel
.p2align 8
.type adaLN_cond__compressed_kv_cla__dense_activation_relu__decode_kernel,@function
adaLN_cond__compressed_kv_cla__dense_activation_relu__decode_kernel:

    s_cmpk_ge_u32 s2, 256
    s_cbranch_scc1 L_exit
    s_load_dwordx16 s[4:19], s[0:1], 0
    s_load_dwordx8 s[20:27], s[0:1], 64
    s_load_dwordx4 s[28:31], s[0:1], 96
    v_lshrrev_b32 v2, 6, v0
    v_and_b32 v1, 63, v0
    v_readfirstlane_b32 s32, v2
    s_lshr_b32 s37, s2, 3
    s_getpc_b64 s[52:53]
L_pc:
    s_mul_i32 s38, s37, 12
    s_add_u32 s38, s38, s32
    s_lshl_b32 s38, s38, 7
    s_min_u32 s38, s38, L_codeend-L_pc-4
    v_mov_b32 v2, s38
    global_load_dword v167, v2, s[52:53]
    s_and_b32 s36, s2, 7
    s_and_b32 s34, s37, 7
    s_lshr_b32 s37, s37, 3
    s_lshl3_add_u32 s35, s37, s36
    s_and_b32 s33, s32, 3
    s_cmp_lt_u32 s32, 4
    s_cbranch_scc1 L_pA
    s_cmp_lt_u32 s32, 8
    s_cbranch_scc1 L_pB
    s_cmp_eq_u32 s34, 0
    s_cbranch_scc1 L_Cs
    s_branch L_Co
L_pB:
    s_cmp_lt_u32 s34, 4
    s_cbranch_scc1 L_Bc
    s_branch L_Be
L_pA:
    s_lshr_b32 s38, s34, 2
    s_or_b32 s38, s38, s32
    s_cbranch_scc0 L_pT
    s_lshl3_add_u32 s38, s32, s34
    s_cmp_lg_u32 s38, 8
    s_cbranch_scc1 L_A
    v_lshlrev_b32 v2, 7, v1
    s_waitcnt lgkmcnt(0)
    global_load_dword v166, v2, s[22:23]
    global_load_dword v166, v2, s[4:5]
    s_branch L_A
L_pT:
    v_and_b32 v3, 1, v1
    v_lshrrev_b32 v2, 1, v1
    s_lshl2_add_u32 s38, s37, s34
    v_lshl_add_u32 v2, s38, 5, v2
    v_mul_u32_u24 v2, 6, v2
    v_add_u32 v2, v2, v3
    s_lshl_b32 s39, s36, 7
    v_lshl_add_u32 v2, v2, 10, s39
    s_waitcnt lgkmcnt(0)
    global_load_dword v166, v2, s[24:25]

L_A:
    v_mov_b32 v8, -1
    v_mov_b32 v9, -1
    v_mov_b32 v10, -1
    v_mov_b32 v11, -1
    v_lshlrev_b32 v14, 4, v1
    s_waitcnt lgkmcnt(0)
    s_mov_b32 s40, s30
    s_mov_b32 s41, s31
    s_mov_b32 s42, 16777216
    s_mov_b32 s43, 0x20000

    s_mov_b32 s3, 0x400000
    v_mov_b32 v0, 156256
    s_and_b32 s62, s34, 3
    s_lshl2_add_u32 s97, s62, s37
    s_lshl4_add_u32 s61, s36, s97

    s_xor_b32 s98, s2, 40
    s_or_b32 s98, s98, s33
    s_cbranch_scc1 L_A_nx
    s_movk_i32 s39, 4096
    buffer_store_dwordx4 v[8:11], v14, s[40:43], 0 offen offset:0 sc1
    buffer_store_dwordx4 v[8:11], v14, s[40:43], 0 offen offset:1024 sc1
    buffer_store_dwordx4 v[8:11], v14, s[40:43], 0 offen offset:2048 sc1
    buffer_store_dwordx4 v[8:11], v14, s[40:43], 0 offen offset:3072 sc1
    buffer_store_dwordx4 v[8:11], v14, s[40:43], s39 offen offset:0 sc1
    buffer_store_dwordx4 v[8:11], v14, s[40:43], s39 offen offset:1024 sc1
    buffer_store_dwordx4 v[8:11], v14, s[40:43], s39 offen offset:2048 sc1
    buffer_store_dwordx4 v[8:11], v14, s[40:43], s39 offen offset:3072 sc1
L_A_nx:
    s_cmp_lg_u32 s34, 0
    s_cbranch_scc1 L_A_nc
    s_lshl2_add_u32 s55, s36, s37
    s_lshl2_add_u32 s38, s55, s33
    s_lshl_b32 s38, s38, 11
    s_add_u32 s38, s38, 65536
    buffer_store_dwordx4 v[8:11], v14, s[40:43], s38 offen offset:0 sc1
    buffer_store_dwordx4 v[8:11], v14, s[40:43], s38 offen offset:1024 sc1
L_A_nc:
    s_cmp_lg_u32 s33, 3
    s_cbranch_scc1 L_noinit
    v_mul_u32_u24 v13, 1008, v1
    v_mov_b32 v4, 0
    v_add_u32 v13, v13, v0
    v_mov_b32 v5, v4
    v_mov_b32 v6, v4
    v_mov_b32 v7, v4
    v_add_u32 v12, v14, v0
    s_mov_b64 exec, 0xff
    ds_write_b128 v13, v[4:7]
    s_mov_b32 exec_lo, -1
    ds_write_b128 v12, v[8:11] offset:7072
    s_mov_b64 exec, -1
L_noinit:
    s_cmp_lt_u32 s34, 4
    s_cbranch_scc1 L_AD
    s_mov_b32 s44, s6
    s_mov_b32 s45, s7
    s_mov_b32 s46, 33554432
    s_mov_b32 s47, 0x20000

    v_lshrrev_b32 v4, 3, v1
    v_bfe_u32 v5, v4, 1, 1
    v_lshlrev_b32 v5, 2, v5
    v_bfe_u32 v6, v4, 2, 1
    v_or_b32 v5, v5, v6
    v_and_b32 v6, 7, v1
    v_xor_b32 v5, v5, v6
    v_lshlrev_b32 v5, 4, v5
    v_lshl_add_u32 v2, v4, 10, v5
    v_xor_b32 v3, 32, v2
    s_lshl_b32 s48, s61, 18
    s_lshl_b32 s38, s33, 15
    s_add_u32 s48, s48, s38
    s_lshl_b32 s49, s33, 12
    s_mov_b32 s50, 0
    s_waitcnt lgkmcnt(0)
    s_barrier
    s_cmp_lg_u32 s98, 0
    s_cbranch_scc1 L_A_go
    s_mov_b64 exec, 1
    s_waitcnt vmcnt(0)
    global_store_dword v14, v8, s[28:29] sc1
    s_mov_b64 exec, -1
L_A_go:
L_w1:
    s_sleep 1
    ds_read_b32 v8, v0 offset:4
    s_sub_u32 s3, s3, 1
    s_cbranch_scc1 L_end
    s_waitcnt lgkmcnt(0)
    v_cmp_gt_u32 vcc, 4, v8
    s_cbranch_vccnz L_w1
    s_setprio 2
    s_lshl_b32 s38, s33, 2
    v_add_u32 v4, s38, v0
    v_mov_b32 v5, v0
    s_mov_b32 s53, 2
L_A_dma:
    s_and_b32 s38, s50, 9
    s_cmp_lg_u32 s38, 8
    s_cbranch_scc1 L_A_dma1
L_w2:
    ds_read_b32 v8, v5 offset:3024
    s_sub_u32 s3, s3, 1
    s_cbranch_scc1 L_end
    s_waitcnt lgkmcnt(0)
    v_cmp_gt_u32 vcc, 8, v8
    s_cbranch_vccnz L_w2
    v_add_u32 v5, 4, v5
    s_cmp_lg_u32 s50, 8
    s_cbranch_scc1 L_A_dma1
    s_add_u32 s48, s48, 130048
    s_sub_u32 s49, s49, 131072
L_A_dma1:
    s_cmp_lg_u32 s50, 8
    s_cbranch_scc1 L_A_dma2
    v_mov_b32 v8, 7
    s_waitcnt vmcnt(4)
    ds_write_b32 v4, v8 offset:4032
    v_mov_b32 v7, 8
    s_waitcnt vmcnt(0)
    ds_write_b32 v4, v7 offset:4032
L_w3:
    ds_read_b32 v8, v0 offset:2028
    s_sub_u32 s3, s3, 1
    s_cbranch_scc1 L_end
    s_waitcnt lgkmcnt(0)
    v_cmp_gt_u32 vcc, 4, v8
    s_cbranch_vccnz L_w3
    s_mov_b32 s53, 10
L_A_dma2:
    s_cmp_lg_u32 s50, 9
    s_cbranch_scc1 L_A_dma3
L_w4:
    ds_read_b32 v8, v0 offset:1008
    s_sub_u32 s3, s3, 1
    s_cbranch_scc1 L_end
    s_waitcnt lgkmcnt(0)
    v_cmp_gt_u32 vcc, 4, v8
    s_cbranch_vccnz L_w4
L_A_dma3:
    s_add_u32 m0, s49, 0
    s_add_u32 s38, s48, 0
    buffer_load_dwordx4 v2, s[44:47], s38 offen nt lds
    s_waitcnt vmcnt(7)
    s_add_u32 m0, s49, 1024
    s_add_u32 s38, s48, 8192
    buffer_load_dwordx4 v3, s[44:47], s38 offen nt lds
    s_waitcnt vmcnt(7)
    s_add_u32 m0, s49, 2048
    s_add_u32 s38, s48, 16384
    buffer_load_dwordx4 v2, s[44:47], s38 offen nt lds
    s_waitcnt vmcnt(7)
    s_add_u32 m0, s49, 3072
    s_add_u32 s38, s48, 24576
    buffer_load_dwordx4 v3, s[44:47], s38 offen nt lds
    s_waitcnt vmcnt(7)
    s_add_u32 s49, s49, 16384
    s_add_u32 s48, s48, 128
    s_add_u32 s50, s50, 1
    s_max_u32 s38, s50, s53
    s_sub_u32 s38, s38, 2
    v_mov_b32 v6, s38
    ds_write_b32 v4, v6 offset:4032
    s_cmp_lt_u32 s50, 16
    s_cbranch_scc1 L_A_dma
    v_mov_b32 v8, 15
    s_waitcnt vmcnt(4)
    ds_write_b32 v4, v8 offset:4032
    v_mov_b32 v7, 16
    s_waitcnt vmcnt(0)
    ds_write_b32 v4, v7 offset:4032
    v_bfe_u32 v16, v1, 4, 1
    v_lshrrev_b32 v17, 5, v1
    v_lshl_add_u32 v16, v17, 2, v16
    v_lshlrev_b32 v16, 14, v16
    v_and_b32 v17, 15, v1
    v_lshl_add_u32 v16, v17, 4, v16
    s_lshl_b32 s55, s36, 19
    s_lshl2_add_u32 s38, s97, s33
    s_lshl_b32 s38, s38, 8
    s_add_u32 s55, s55, s38
    s_add_u32 s55, s55, 2097152
    v_mov_b32 v20, -1
    v_mov_b32 v21, -1
    v_mov_b32 v22, -1
    v_mov_b32 v23, -1
    s_add_u32 s38, s55, 0
    buffer_store_dwordx4 v[20:23], v16, s[40:43], s38 offen sc1
    s_add_u32 s38, s55, 32768
    buffer_store_dwordx4 v[20:23], v16, s[40:43], s38 offen sc1
    s_add_u32 s38, s55, 131072
    buffer_store_dwordx4 v[20:23], v16, s[40:43], s38 offen sc1
    s_add_u32 s38, s55, 163840
    buffer_store_dwordx4 v[20:23], v16, s[40:43], s38 offen sc1
    s_add_u32 s38, s55, 262144
    buffer_store_dwordx4 v[20:23], v16, s[40:43], s38 offen sc1
    s_add_u32 s38, s55, 294912
    buffer_store_dwordx4 v[20:23], v16, s[40:43], s38 offen sc1
    s_add_u32 s38, s55, 393216
    buffer_store_dwordx4 v[20:23], v16, s[40:43], s38 offen sc1
    s_add_u32 s38, s55, 425984
    buffer_store_dwordx4 v[20:23], v16, s[40:43], s38 offen sc1
    s_waitcnt vmcnt(0)
    v_mov_b32 v12, 1
    s_mov_b64 exec, 1
    ds_add_u32 v0, v12 offset:2024
    s_mov_b64 exec, -1
    s_setprio 0
    s_cmp_ge_u32 s35, 28
    s_cbranch_scc1 L_end

    v_and_b32 v9, 31, v1
    v_lshrrev_b32 v10, 5, v1
    v_and_b32 v3, 15, v1
    v_lshrrev_b32 v6, 4, v1
    v_and_b32 v16, 1, v1
    v_lshlrev_b32 v16, 4, v16
    s_mov_b32 s38, 0xffff
    v_lshlrev_b32 v16, v16, s38
    v_bfe_u32 v17, v1, 1, 2
    v_cmp_eq_u32 vcc, 0, v17
    s_nop 1
    v_cndmask_b32 v20, 0, v16, vcc
    v_cmp_eq_u32 vcc, 1, v17
    s_nop 1
    v_cndmask_b32 v21, 0, v16, vcc
    v_cmp_eq_u32 vcc, 2, v17
    s_nop 1
    v_cndmask_b32 v22, 0, v16, vcc
    v_cmp_eq_u32 vcc, 3, v17
    s_nop 1
    v_cndmask_b32 v23, 0, v16, vcc
L_w5:
    s_sleep 2
    ds_read_b32 v12, v0 offset:5044
    s_sub_u32 s3, s3, 1
    s_cbranch_scc1 L_end
    s_waitcnt lgkmcnt(0)
    v_cmp_gt_u32 vcc, 8, v12
    s_cbranch_vccnz L_w5
    s_branch L_A_F
L_AD:
    s_waitcnt lgkmcnt(0)
    s_barrier
    s_cmp_lg_u32 s34, 0
    s_cbranch_scc1 L_AD0
    s_waitcnt vmcnt(0)
    v_mov_b32 v8, 1
    s_mov_b64 exec, 1
    ds_add_u32 v0, v8 offset:2020
    s_mov_b64 exec, -1
    s_cmp_lg_u32 s33, 1
    s_cbranch_scc1 L_AD0
L_w6:
    s_sleep 1
    ds_read_b32 v8, v0 offset:7056
    s_sub_u32 s3, s3, 1
    s_cbranch_scc1 L_end
    s_waitcnt lgkmcnt(0)
    v_cmp_gt_u32 vcc, 4, v8
    s_cbranch_vccnz L_w6
    v_mov_b32 v4, 0
L_fl7:
    global_load_dword v5, v4, s[28:29] offset:0 sc1
    s_sub_u32 s3, s3, 1
    s_cbranch_scc1 L_end
    s_waitcnt vmcnt(0)
    v_cmp_eq_u32 vcc, 0, v5
    s_cbranch_vccnz L_fl7
    v_mov_b32 v8, 1
    s_mov_b64 exec, 1
    ds_add_u32 v0, v8 offset:2020
    s_mov_b64 exec, -1
L_AD0:
    s_mov_b32 s44, s6
    s_mov_b32 s45, s7
    s_mov_b32 s46, 33554432
    s_mov_b32 s47, 0x20000
    v_lshlrev_b32 v4, 10, v1
    s_lshl_b32 s51, s61, 18
    s_and_b32 s38, s33, 1
    s_lshl_b32 s38, s38, 16
    s_add_u32 s51, s51, s38
    s_lshr_b32 s38, s33, 1
    s_lshl_b32 s38, s38, 7
    s_add_u32 s51, s51, s38
    s_add_u32 s51, s51, 131072
L_w8:
    s_sleep 1
    ds_read_b32 v8, v0 offset:5044
    s_sub_u32 s3, s3, 1
    s_cbranch_scc1 L_end
    s_waitcnt lgkmcnt(0)
    v_cmp_gt_u32 vcc, 3, v8
    s_cbranch_vccnz L_w8
    s_cmp_lg_u32 s34, 0
    s_cbranch_scc1 L_AD_k1
    s_add_u32 s38, s51, 917504
    buffer_load_dword v166, v4, s[44:47], s38 offen offset:768
    s_waitcnt vmcnt(0)
    s_add_u32 s38, s51, 1966080
    buffer_load_dword v166, v4, s[44:47], s38 offen offset:768
    s_waitcnt vmcnt(0)
    s_branch L_AD_k2
L_AD_k1:
L_AD_k2:
    s_sub_u32 s38, s51, 131072
    buffer_load_dword v166, v4, s[44:47], s38 offen offset:768
    s_waitcnt vmcnt(0)
L_AD_k3:
    buffer_load_dword v166, v4, s[44:47], s51 offen offset:256
    s_waitcnt vmcnt(0)
    buffer_load_dword v166, v4, s[44:47], s51 offen offset:512
    s_waitcnt vmcnt(0)
    buffer_load_dword v166, v4, s[44:47], s51 offen offset:768
    v_mov_b32 v8, 1
    s_mov_b64 exec, 1
    ds_add_u32 v0, v8 offset:5048
    s_mov_b64 exec, -1
L_AD1:
    v_and_b32 v9, 31, v1
    v_lshrrev_b32 v10, 5, v1
    v_and_b32 v3, 15, v1
    v_lshrrev_b32 v6, 4, v1
    v_lshlrev_b32 v7, 12, v6
    v_lshl_add_u32 v7, v3, 4, v7
    v_and_b32 v5, 1, v6
    v_lshlrev_b32 v5, 6, v5
    v_add_lshl_u32 v5, v5, v3, 10
    s_lshl_b32 s38, s62, 8
    s_lshl_b32 s50, s33, 11
    s_lshl4_add_u32 s50, s36, s50
    s_add_u32 s50, s50, s37
    s_lshl_b32 s50, s50, 3
    s_add_u32 s50, s50, 1048576
    s_lshl_b32 s51, s33, 5
    s_add_u32 s51, s51, s35
    s_lshl_b32 s51, s51, 14
    s_add_u32 s51, s51, s38
    s_add_u32 s51, s51, 2097152
    s_add_u32 s52, s51, 2097152
    s_lshl_b32 s38, s33, 8
    s_add_u32 s38, s38, 139776
    v_lshl_add_u32 v24, v1, 2, s38
    v_bfe_u32 v16, v1, 3, 1
    v_lshlrev_b32 v16, 7, v16
    v_lshl_add_u32 v16, v6, 4, v16
    v_add_u32 v25, s38, v16
    v_bfe_u32 v16, v1, 4, 1
    v_lshlrev_b32 v16, 4, v16
    v_lshl_add_u32 v16, v3, 5, v16
    v_lshl_add_u32 v16, v10, 3, v16
    s_mul_i32 s38, s33, 1056
    s_add_u32 s38, s38, 141312
    v_add_u32 v26, s38, v16
    v_add_u32 v27, 4224, v26
    v_and_b32 v16, 1, v1
    v_lshlrev_b32 v16, 4, v16
    s_mov_b32 s38, 0xffff
    v_lshlrev_b32 v16, v16, s38
    v_bfe_u32 v17, v1, 1, 2
    v_cmp_eq_u32 vcc, 0, v17
    s_nop 1
    v_cndmask_b32 v20, 0, v16, vcc
    v_cmp_eq_u32 vcc, 1, v17
    s_nop 1
    v_cndmask_b32 v21, 0, v16, vcc
    v_cmp_eq_u32 vcc, 2, v17
    s_nop 1
    v_cndmask_b32 v22, 0, v16, vcc
    v_cmp_eq_u32 vcc, 3, v17
    s_nop 1
    v_cndmask_b32 v23, 0, v16, vcc
L_w9:
    s_sleep 1
    ds_read_b32 v12, v0 offset:5052
    s_sub_u32 s3, s3, 1
    s_cbranch_scc1 L_end
    s_waitcnt lgkmcnt(0)
    v_cmp_gt_u32 vcc, 1, v12
    s_cbranch_vccnz L_w9
L_w10:
    s_sleep 1
    ds_read_b32 v12, v0 offset:6060
    s_sub_u32 s3, s3, 1
    s_cbranch_scc1 L_end
    s_waitcnt lgkmcnt(0)
    v_cmp_gt_u32 vcc, 5, v12
    s_cbranch_vccnz L_w10
L_A_st1:
    buffer_load_dwordx2 v[12:13], v5, s[40:43], s50 offen sc1
    s_sub_u32 s3, s3, 1
    s_cbranch_scc1 L_end
    s_waitcnt vmcnt(0)
    v_max_u32 v14, v12, v13
    v_cmp_eq_u32 vcc, -1, v14
    s_cbranch_vccz L_A_st3
    s_mov_b64 exec, vcc
    s_sleep 4
    s_branch L_A_st1
L_A_st3:
    s_mov_b64 exec, -1
    buffer_load_dwordx4 v[32:35], v7, s[40:43], s51 offen offset:0 sc1
    buffer_load_dwordx4 v[36:39], v7, s[40:43], s51 offen offset:1024 sc1
    buffer_load_dwordx4 v[40:43], v7, s[40:43], s51 offen offset:2048 sc1
    buffer_load_dwordx4 v[44:47], v7, s[40:43], s51 offen offset:3072 sc1
    buffer_load_dwordx4 v[48:51], v7, s[40:43], s52 offen offset:0 sc1
    buffer_load_dwordx4 v[52:55], v7, s[40:43], s52 offen offset:1024 sc1
    buffer_load_dwordx4 v[56:59], v7, s[40:43], s52 offen offset:2048 sc1
    buffer_load_dwordx4 v[60:63], v7, s[40:43], s52 offen offset:3072 sc1
    v_mov_b32 v14, v12
    s_nop 1
    v_max_f32_dpp v14, v14, v14 quad_perm:[1,0,3,2] row_mask:0xf bank_mask:0xf
    s_nop 1
    v_max_f32_dpp v14, v14, v14 quad_perm:[2,3,0,1] row_mask:0xf bank_mask:0xf
    s_nop 1
    v_max_f32_dpp v14, v14, v14 row_half_mirror row_mask:0xf bank_mask:0xf
    s_nop 1
    v_max_f32_dpp v14, v14, v14 row_mirror row_mask:0xf bank_mask:0xf
    v_sub_f32 v12, v12, v14
    v_exp_f32 v12, v12
    s_nop 0
    v_mul_f32 v14, v12, v13
    s_nop 1
    v_add_f32_dpp v14, v14, v14 quad_perm:[1,0,3,2] row_mask:0xf bank_mask:0xf
    s_nop 1
    v_add_f32_dpp v14, v14, v14 quad_perm:[2,3,0,1] row_mask:0xf bank_mask:0xf
    s_nop 1
    v_add_f32_dpp v14, v14, v14 row_half_mirror row_mask:0xf bank_mask:0xf
    s_nop 1
    v_add_f32_dpp v14, v14, v14 row_mirror row_mask:0xf bank_mask:0xf
    v_rcp_f32 v14, v14
    v_cmp_gt_u32 vcc, 32, v1
    v_mul_f32 v12, v12, v14
    v_cvt_pk_bf16_f32 v13, v12, v12
    v_and_b32 v14, 0xffff0000, v13
    v_sub_f32 v12, v12, v14
    v_cvt_pk_bf16_f32 v12, v12, v12
    v_cndmask_b32 v12, v12, v13, vcc
    ds_write_b32 v24, v12
    ds_read_b128 v[12:15], v25
    ds_read_b128 v[16:19], v25 offset:64
    s_waitcnt lgkmcnt(0)
    v_and_b32 v64, v12, v20
    v_and_b32 v65, v12, v21
    v_and_b32 v66, v12, v22
    v_and_b32 v67, v12, v23
    v_and_b32 v68, v13, v20
    v_and_b32 v69, v13, v21
    v_and_b32 v70, v13, v22
    v_and_b32 v71, v13, v23
    v_and_b32 v72, v14, v20
    v_and_b32 v73, v14, v21
    v_and_b32 v74, v14, v22
    v_and_b32 v75, v14, v23
    v_and_b32 v76, v15, v20
    v_and_b32 v77, v15, v21
    v_and_b32 v78, v15, v22
    v_and_b32 v79, v15, v23
    v_and_b32 v80, v16, v20
    v_and_b32 v81, v16, v21
    v_and_b32 v82, v16, v22
    v_and_b32 v83, v16, v23
    v_and_b32 v84, v17, v20
    v_and_b32 v85, v17, v21
    v_and_b32 v86, v17, v22
    v_and_b32 v87, v17, v23
    v_and_b32 v88, v18, v20
    v_and_b32 v89, v18, v21
    v_and_b32 v90, v18, v22
    v_and_b32 v91, v18, v23
    v_and_b32 v92, v19, v20
    v_and_b32 v93, v19, v21
    v_and_b32 v94, v19, v22
    v_and_b32 v95, v19, v23
    s_waitcnt vmcnt(4)
L_h3_c0:
    v_mfma_f32_16x16x32_bf16 v[28:31], v[64:67], v[32:35], 0
    v_mfma_f32_16x16x32_bf16 v[28:31], v[68:71], v[36:39], v[28:31]
    v_mfma_f32_16x16x32_bf16 v[28:31], v[72:75], v[40:43], v[28:31]
    v_mfma_f32_16x16x32_bf16 v[28:31], v[76:79], v[44:47], v[28:31]
    v_max3_u32 v12, v32, v33, v34
    v_max3_u32 v12, v12, v35, v36
    v_max3_u32 v12, v12, v37, v38
    v_max3_u32 v12, v12, v39, v40
    v_max3_u32 v12, v12, v41, v42
    v_max3_u32 v12, v12, v43, v44
    v_max3_u32 v12, v12, v45, v46
    v_max_u32 v12, v12, v47
    v_cmp_eq_u32 vcc, -1, v12
    s_cbranch_vccnz L_h3_r0
    s_waitcnt vmcnt(0)
L_h3_c1:
    v_mfma_f32_16x16x32_bf16 v[96:99], v[80:83], v[48:51], 0
    v_mfma_f32_16x16x32_bf16 v[96:99], v[84:87], v[52:55], v[96:99]
    v_mfma_f32_16x16x32_bf16 v[96:99], v[88:91], v[56:59], v[96:99]
    v_mfma_f32_16x16x32_bf16 v[96:99], v[92:95], v[60:63], v[96:99]
    v_max3_u32 v12, v48, v49, v50
    v_max3_u32 v12, v12, v51, v52
    v_max3_u32 v12, v12, v53, v54
    v_max3_u32 v12, v12, v55, v56
    v_max3_u32 v12, v12, v57, v58
    v_max3_u32 v12, v12, v59, v60
    v_max3_u32 v12, v12, v61, v62
    v_max_u32 v12, v12, v63
    v_cmp_eq_u32 vcc, -1, v12
    s_cbranch_vccnz L_h3_r1
    v_permlane32_swap_b32 v28, v30
    v_permlane32_swap_b32 v29, v31
    v_add_f32 v28, v28, v30
    v_add_f32 v29, v29, v31
    v_cvt_pk_bf16_f32 v12, v28, 0
    v_cvt_pk_bf16_f32 v13, v29, 0
    v_cvt_pk_bf16_f32 v14, 0, v28
    v_cvt_pk_bf16_f32 v15, 0, v29
    ds_write2_b64 v26, v[12:13], v[14:15] offset0:0 offset1:66
    v_permlane32_swap_b32 v96, v98
    v_permlane32_swap_b32 v97, v99
    v_add_f32 v96, v96, v98
    v_add_f32 v97, v97, v99
    v_cvt_pk_bf16_f32 v16, v96, 0
    v_cvt_pk_bf16_f32 v17, v97, 0
    v_cvt_pk_bf16_f32 v18, 0, v96
    v_cvt_pk_bf16_f32 v19, 0, v97
    ds_write2_b64 v27, v[16:17], v[18:19] offset0:0 offset1:66
    v_mov_b32 v28, 1
    s_mov_b64 exec, 1
    ds_add_u32 v0, v28 offset:6048
    s_mov_b64 exec, -1
    s_cmp_lg_u32 s35, s33
    s_cbranch_scc1 L_end
    s_waitcnt lgkmcnt(0)
L_A_F:
    s_mov_b32 s44, s4
    s_mov_b32 s45, s5
    s_mov_b32 s46, 8192
    s_mov_b32 s47, 0x20000

    v_bfe_u32 v17, v1, 3, 1
    v_cmp_eq_u32 vcc, v17, v10
    v_mov_b32 v12, 0x3f803f80
    s_nop 0
    v_cndmask_b32 v12, 0, v12, vcc
    v_and_b32 v20, v12, v20
    v_and_b32 v21, v12, v21
    v_and_b32 v22, v12, v22
    v_and_b32 v23, v12, v23
    v_and_b32 v12, 1, v6
    v_lshlrev_b32 v13, 3, v12
    v_lshl_add_u32 v13, v3, 4, v13
    v_lshl_add_u32 v16, v10, 12, v13
    s_lshl_b32 s38, s62, 10
    s_lshl_b32 s39, s33, 8
    s_add_u32 s48, s38, s39
    buffer_load_dwordx2 v[128:129], v16, s[44:47], s48 offen
    s_cmp_lt_u32 s34, 4
    s_cselect_b32 s50, 65536, 0

    s_add_u32 s49, s48, 1179648
    buffer_load_dwordx2 v[96:97], v16, s[40:43], s49 offen sc1
    s_add_u32 s49, s49, 8192
    buffer_load_dwordx2 v[98:99], v16, s[40:43], s49 offen sc1
    s_add_u32 s49, s49, 8192
    buffer_load_dwordx2 v[100:101], v16, s[40:43], s49 offen sc1
    s_add_u32 s49, s49, 8192
    buffer_load_dwordx2 v[102:103], v16, s[40:43], s49 offen sc1
    s_add_u32 s49, s49, 8192
    s_add_u32 s49, s49, s50
    buffer_load_dwordx2 v[104:105], v16, s[40:43], s49 offen sc1
    s_add_u32 s49, s49, 8192
    buffer_load_dwordx2 v[106:107], v16, s[40:43], s49 offen sc1
    s_add_u32 s49, s49, 8192
    buffer_load_dwordx2 v[108:109], v16, s[40:43], s49 offen sc1
    s_add_u32 s49, s49, 8192
    buffer_load_dwordx2 v[110:111], v16, s[40:43], s49 offen sc1
    s_add_u32 s49, s49, 8192
    s_sub_u32 s49, s49, s50
    buffer_load_dwordx2 v[112:113], v16, s[40:43], s49 offen sc1
    s_add_u32 s49, s49, 8192
    buffer_load_dwordx2 v[114:115], v16, s[40:43], s49 offen sc1
    s_add_u32 s49, s49, 8192
    buffer_load_dwordx2 v[116:117], v16, s[40:43], s49 offen sc1
    s_add_u32 s49, s49, 8192
    buffer_load_dwordx2 v[118:119], v16, s[40:43], s49 offen sc1
    s_add_u32 s49, s49, 8192

    s_lshl_b32 s53, s62, 15
    s_add_u32 s53, s53, s39
    s_add_u32 s56, s53, 1572864
    s_add_u32 s53, s53, 1310720
    s_and_b32 s38, s35, 24
    s_lshl_b32 s38, s38, 9
    s_add_u32 s56, s56, s38
    s_xor_b32 s57, s56, 4096
    s_xor_b32 s58, s56, 8192
    s_xor_b32 s59, s56, 12288
    v_lshlrev_b32 v5, 17, v10
    v_lshl_add_u32 v5, v3, 4, v5
    v_lshl_add_u32 v7, v12, 14, v5
    s_add_u32 s38, s39, 131072
    v_mul_u32_u24 v24, 2080, v10
    v_add3_u32 v25, v24, v13, s38
    s_lshl_b32 s38, s33, 2
    s_add_u32 s38, s38, 149504
    v_lshl_add_u32 v26, v6, 4, s38
    v_add_u32 v24, v24, v25
    v_add_u32 v24, 4160, v24
    v_add_u32 v27, 2080, v24
    s_and_b32 s60, s36, 3
    s_lshl2_add_u32 s60, s60, s33
    s_lshl_b32 s60, s60, 12
    s_add_u32 s60, s60, 983040
    v_and_b32 v13, 3, v1
    v_lshlrev_b32 v13, 10, v13
    s_lshl_b32 s38, s36, 7
    v_add_u32 v13, s38, v13
    s_mov_b32 s51, 15
    buffer_load_dword v18, v13, s[40:43], s60 offen sc1
    s_branch L_A_md1
L_A_md:
    s_sleep 4
    s_add_u32 s49, s48, 1179648
    buffer_load_dwordx2 v[96:97], v16, s[40:43], s49 offen sc1
    s_add_u32 s49, s49, 8192
    buffer_load_dwordx2 v[98:99], v16, s[40:43], s49 offen sc1
    s_add_u32 s49, s49, 8192
    buffer_load_dwordx2 v[100:101], v16, s[40:43], s49 offen sc1
    s_add_u32 s49, s49, 8192
    buffer_load_dwordx2 v[102:103], v16, s[40:43], s49 offen sc1
    s_add_u32 s49, s49, 8192
    s_add_u32 s49, s49, s50
    buffer_load_dwordx2 v[104:105], v16, s[40:43], s49 offen sc1
    s_add_u32 s49, s49, 8192
    buffer_load_dwordx2 v[106:107], v16, s[40:43], s49 offen sc1
    s_add_u32 s49, s49, 8192
    buffer_load_dwordx2 v[108:109], v16, s[40:43], s49 offen sc1
    s_add_u32 s49, s49, 8192
    buffer_load_dwordx2 v[110:111], v16, s[40:43], s49 offen sc1
    s_add_u32 s49, s49, 8192
    s_sub_u32 s49, s49, s50
    buffer_load_dwordx2 v[112:113], v16, s[40:43], s49 offen sc1
    s_add_u32 s49, s49, 8192
    buffer_load_dwordx2 v[114:115], v16, s[40:43], s49 offen sc1
    s_add_u32 s49, s49, 8192
    buffer_load_dwordx2 v[116:117], v16, s[40:43], s49 offen sc1
    s_add_u32 s49, s49, 8192
    buffer_load_dwordx2 v[118:119], v16, s[40:43], s49 offen sc1
    s_add_u32 s49, s49, 8192
    s_sub_u32 s3, s3, 1
    s_cbranch_scc1 L_end
L_A_md1:
    s_waitcnt vmcnt(0)
    v_max3_u32 v15, v96, v97, v98
    v_max3_u32 v15, v15, v99, v100
    v_max3_u32 v15, v15, v101, v102
    v_max3_u32 v15, v15, v103, v104
    v_max3_u32 v15, v15, v105, v106
    v_max3_u32 v15, v15, v107, v108
    v_max3_u32 v15, v15, v109, v110
    v_max3_u32 v15, v15, v111, v112
    v_max3_u32 v15, v15, v113, v114
    v_max3_u32 v15, v15, v115, v116
    v_max3_u32 v15, v15, v117, v118
    v_max_u32 v15, v15, v119
    v_cmp_eq_u32 vcc, -1, v15
    s_cbranch_vccnz L_A_md
    s_mov_b32 s52, 1
    v_cmp_eq_u32 vcc, -1, v18
    s_cbranch_vccz L_A_h4s
    s_mov_b32 s52, 0
    v_lshlrev_b32 v140, 16, v128
    v_and_b32 v141, 0xffff0000, v128
    v_lshlrev_b32 v142, 16, v129
    v_and_b32 v143, 0xffff0000, v129
    v_lshlrev_b32 v152, 16, v112
    v_and_b32 v153, 0xffff0000, v112
    v_lshlrev_b32 v154, 16, v113
    v_and_b32 v155, 0xffff0000, v113
    v_lshlrev_b32 v14, 16, v114
    v_and_b32 v15, 0xffff0000, v114
    v_pk_add_f32 v[152:153], v[152:153], v[14:15]
    v_lshlrev_b32 v14, 16, v115
    v_and_b32 v15, 0xffff0000, v115
    v_pk_add_f32 v[154:155], v[154:155], v[14:15]
    v_lshlrev_b32 v14, 16, v116
    v_and_b32 v15, 0xffff0000, v116
    v_pk_add_f32 v[152:153], v[152:153], v[14:15]
    v_lshlrev_b32 v14, 16, v117
    v_and_b32 v15, 0xffff0000, v117
    v_pk_add_f32 v[154:155], v[154:155], v[14:15]
    v_lshlrev_b32 v14, 16, v118
    v_and_b32 v15, 0xffff0000, v118
    v_pk_add_f32 v[152:153], v[152:153], v[14:15]
    v_lshlrev_b32 v14, 16, v119
    v_and_b32 v15, 0xffff0000, v119
    v_pk_add_f32 v[154:155], v[154:155], v[14:15]
    v_lshlrev_b32 v148, 16, v104
    v_and_b32 v149, 0xffff0000, v104
    v_lshlrev_b32 v150, 16, v105
    v_and_b32 v151, 0xffff0000, v105
    v_lshlrev_b32 v14, 16, v106
    v_and_b32 v15, 0xffff0000, v106
    v_pk_add_f32 v[148:149], v[148:149], v[14:15]
    v_lshlrev_b32 v14, 16, v107
    v_and_b32 v15, 0xffff0000, v107
    v_pk_add_f32 v[150:151], v[150:151], v[14:15]
    v_lshlrev_b32 v14, 16, v108
    v_and_b32 v15, 0xffff0000, v108
    v_pk_add_f32 v[148:149], v[148:149], v[14:15]
    v_lshlrev_b32 v14, 16, v109
    v_and_b32 v15, 0xffff0000, v109
    v_pk_add_f32 v[150:151], v[150:151], v[14:15]
    v_lshlrev_b32 v14, 16, v110
    v_and_b32 v15, 0xffff0000, v110
    v_pk_add_f32 v[148:149], v[148:149], v[14:15]
    v_lshlrev_b32 v14, 16, v111
    v_and_b32 v15, 0xffff0000, v111
    v_pk_add_f32 v[150:151], v[150:151], v[14:15]
    v_add_f32 v152, 1.0, v152
    v_add_f32 v153, 1.0, v153
    v_add_f32 v154, 1.0, v154
    v_add_f32 v155, 1.0, v155
    s_cmp_lt_u32 s34, 4
    s_cbranch_scc1 L_nk11
    v_cvt_pk_bf16_f32 v120, v152, v153
    v_cvt_pk_bf16_f32 v121, v154, v155
    v_lshlrev_b32 v124, 16, v120
    v_and_b32 v125, 0xffff0000, v120
    v_lshlrev_b32 v126, 16, v121
    v_and_b32 v127, 0xffff0000, v121
    v_pk_add_f32 v[124:125], v[152:153], v[124:125] neg_lo:[0,1] neg_hi:[0,1]
    v_pk_add_f32 v[126:127], v[154:155], v[126:127] neg_lo:[0,1] neg_hi:[0,1]
    v_cvt_pk_bf16_f32 v122, v124, v125
    v_cvt_pk_bf16_f32 v123, v126, v127
    ds_write2_b64 v24, v[120:121], v[122:123] offset0:0 offset1:130
    v_cvt_pk_bf16_f32 v130, v148, v149
    v_cvt_pk_bf16_f32 v131, v150, v151
    v_lshlrev_b32 v134, 16, v130
    v_and_b32 v135, 0xffff0000, v130
    v_lshlrev_b32 v136, 16, v131
    v_and_b32 v137, 0xffff0000, v131
    v_pk_add_f32 v[134:135], v[148:149], v[134:135] neg_lo:[0,1] neg_hi:[0,1]
    v_pk_add_f32 v[136:137], v[150:151], v[136:137] neg_lo:[0,1] neg_hi:[0,1]
    v_cvt_pk_bf16_f32 v132, v134, v135
    v_cvt_pk_bf16_f32 v133, v136, v137
    ds_write2_b64 v27, v[130:131], v[132:133] offset0:0 offset1:130
    v_mov_b32 v14, 1
    s_mov_b64 exec, 1
    ds_add_u32 v0, v14 offset:5048
    s_mov_b64 exec, -1
L_nk11:
    v_lshlrev_b32 v144, 16, v96
    v_and_b32 v145, 0xffff0000, v96
    v_lshlrev_b32 v146, 16, v97
    v_and_b32 v147, 0xffff0000, v97
    v_lshlrev_b32 v14, 16, v98
    v_and_b32 v15, 0xffff0000, v98
    v_pk_add_f32 v[144:145], v[144:145], v[14:15]
    v_lshlrev_b32 v14, 16, v99
    v_and_b32 v15, 0xffff0000, v99
    v_pk_add_f32 v[146:147], v[146:147], v[14:15]
    v_lshlrev_b32 v14, 16, v100
    v_and_b32 v15, 0xffff0000, v100
    v_pk_add_f32 v[144:145], v[144:145], v[14:15]
    v_lshlrev_b32 v14, 16, v101
    v_and_b32 v15, 0xffff0000, v101
    v_pk_add_f32 v[146:147], v[146:147], v[14:15]
    v_lshlrev_b32 v14, 16, v102
    v_and_b32 v15, 0xffff0000, v102
    v_pk_add_f32 v[144:145], v[144:145], v[14:15]
    v_lshlrev_b32 v14, 16, v103
    v_and_b32 v15, 0xffff0000, v103
    v_pk_add_f32 v[146:147], v[146:147], v[14:15]
    s_mov_b32 exec_lo, s51
    s_mov_b32 exec_hi, 0
L_A_hint1:
    buffer_load_dword v12, v13, s[40:43], s60 offen sc1
    s_sub_u32 s3, s3, 1
    s_cbranch_scc1 L_end
    s_waitcnt vmcnt(0)
    v_cmp_eq_u32 vcc, -1, v12
    s_mov_b64 exec, vcc
    s_cbranch_vccnz L_A_hint1
    s_mov_b64 exec, -1
L_A_h4s:
    buffer_load_dwordx4 v[32:35], v7, s[40:43], s56 offen offset:0 sc1
    buffer_load_dwordx4 v[36:39], v7, s[40:43], s56 offen offset:1024 sc1
    buffer_load_dwordx4 v[40:43], v7, s[40:43], s56 offen offset:2048 sc1
    buffer_load_dwordx4 v[44:47], v7, s[40:43], s56 offen offset:3072 sc1
    buffer_load_dwordx4 v[48:51], v7, s[40:43], s57 offen offset:0 sc1
    buffer_load_dwordx4 v[52:55], v7, s[40:43], s57 offen offset:1024 sc1
    buffer_load_dwordx4 v[56:59], v7, s[40:43], s57 offen offset:2048 sc1
    buffer_load_dwordx4 v[60:63], v7, s[40:43], s57 offen offset:3072 sc1
    buffer_load_dwordx4 v[64:67], v7, s[40:43], s58 offen offset:0 sc1
    buffer_load_dwordx4 v[68:71], v7, s[40:43], s58 offen offset:1024 sc1
    buffer_load_dwordx4 v[72:75], v7, s[40:43], s58 offen offset:2048 sc1
    buffer_load_dwordx4 v[76:79], v7, s[40:43], s58 offen offset:3072 sc1
    buffer_load_dwordx4 v[80:83], v7, s[40:43], s59 offen offset:0 sc1
    buffer_load_dwordx4 v[84:87], v7, s[40:43], s59 offen offset:1024 sc1
    buffer_load_dwordx4 v[88:91], v7, s[40:43], s59 offen offset:2048 sc1
    buffer_load_dwordx4 v[92:95], v7, s[40:43], s59 offen offset:3072 sc1
    s_cmp_eq_u32 s52, 0
    s_cbranch_scc1 L_A_mu
    v_lshlrev_b32 v140, 16, v128
    v_and_b32 v141, 0xffff0000, v128
    v_lshlrev_b32 v142, 16, v129
    v_and_b32 v143, 0xffff0000, v129
    v_lshlrev_b32 v152, 16, v112
    v_and_b32 v153, 0xffff0000, v112
    v_lshlrev_b32 v154, 16, v113
    v_and_b32 v155, 0xffff0000, v113
    v_lshlrev_b32 v14, 16, v114
    v_and_b32 v15, 0xffff0000, v114
    v_pk_add_f32 v[152:153], v[152:153], v[14:15]
    v_lshlrev_b32 v14, 16, v115
    v_and_b32 v15, 0xffff0000, v115
    v_pk_add_f32 v[154:155], v[154:155], v[14:15]
    v_lshlrev_b32 v14, 16, v116
    v_and_b32 v15, 0xffff0000, v116
    v_pk_add_f32 v[152:153], v[152:153], v[14:15]
    v_lshlrev_b32 v14, 16, v117
    v_and_b32 v15, 0xffff0000, v117
    v_pk_add_f32 v[154:155], v[154:155], v[14:15]
    v_lshlrev_b32 v14, 16, v118
    v_and_b32 v15, 0xffff0000, v118
    v_pk_add_f32 v[152:153], v[152:153], v[14:15]
    v_lshlrev_b32 v14, 16, v119
    v_and_b32 v15, 0xffff0000, v119
    v_pk_add_f32 v[154:155], v[154:155], v[14:15]
    v_lshlrev_b32 v148, 16, v104
    v_and_b32 v149, 0xffff0000, v104
    v_lshlrev_b32 v150, 16, v105
    v_and_b32 v151, 0xffff0000, v105
    v_lshlrev_b32 v14, 16, v106
    v_and_b32 v15, 0xffff0000, v106
    v_pk_add_f32 v[148:149], v[148:149], v[14:15]
    v_lshlrev_b32 v14, 16, v107
    v_and_b32 v15, 0xffff0000, v107
    v_pk_add_f32 v[150:151], v[150:151], v[14:15]
    v_lshlrev_b32 v14, 16, v108
    v_and_b32 v15, 0xffff0000, v108
    v_pk_add_f32 v[148:149], v[148:149], v[14:15]
    v_lshlrev_b32 v14, 16, v109
    v_and_b32 v15, 0xffff0000, v109
    v_pk_add_f32 v[150:151], v[150:151], v[14:15]
    v_lshlrev_b32 v14, 16, v110
    v_and_b32 v15, 0xffff0000, v110
    v_pk_add_f32 v[148:149], v[148:149], v[14:15]
    v_lshlrev_b32 v14, 16, v111
    v_and_b32 v15, 0xffff0000, v111
    v_pk_add_f32 v[150:151], v[150:151], v[14:15]
    v_add_f32 v152, 1.0, v152
    v_add_f32 v153, 1.0, v153
    v_add_f32 v154, 1.0, v154
    v_add_f32 v155, 1.0, v155
    s_cmp_lt_u32 s34, 4
    s_cbranch_scc1 L_nk12
    v_cvt_pk_bf16_f32 v120, v152, v153
    v_cvt_pk_bf16_f32 v121, v154, v155
    v_lshlrev_b32 v124, 16, v120
    v_and_b32 v125, 0xffff0000, v120
    v_lshlrev_b32 v126, 16, v121
    v_and_b32 v127, 0xffff0000, v121
    v_pk_add_f32 v[124:125], v[152:153], v[124:125] neg_lo:[0,1] neg_hi:[0,1]
    v_pk_add_f32 v[126:127], v[154:155], v[126:127] neg_lo:[0,1] neg_hi:[0,1]
    v_cvt_pk_bf16_f32 v122, v124, v125
    v_cvt_pk_bf16_f32 v123, v126, v127
    ds_write2_b64 v24, v[120:121], v[122:123] offset0:0 offset1:130
    v_cvt_pk_bf16_f32 v130, v148, v149
    v_cvt_pk_bf16_f32 v131, v150, v151
    v_lshlrev_b32 v134, 16, v130
    v_and_b32 v135, 0xffff0000, v130
    v_lshlrev_b32 v136, 16, v131
    v_and_b32 v137, 0xffff0000, v131
    v_pk_add_f32 v[134:135], v[148:149], v[134:135] neg_lo:[0,1] neg_hi:[0,1]
    v_pk_add_f32 v[136:137], v[150:151], v[136:137] neg_lo:[0,1] neg_hi:[0,1]
    v_cvt_pk_bf16_f32 v132, v134, v135
    v_cvt_pk_bf16_f32 v133, v136, v137
    ds_write2_b64 v27, v[130:131], v[132:133] offset0:0 offset1:130
    v_mov_b32 v14, 1
    s_mov_b64 exec, 1
    ds_add_u32 v0, v14 offset:5048
    s_mov_b64 exec, -1
L_nk12:
    v_lshlrev_b32 v144, 16, v96
    v_and_b32 v145, 0xffff0000, v96
    v_lshlrev_b32 v146, 16, v97
    v_and_b32 v147, 0xffff0000, v97
    v_lshlrev_b32 v14, 16, v98
    v_and_b32 v15, 0xffff0000, v98
    v_pk_add_f32 v[144:145], v[144:145], v[14:15]
    v_lshlrev_b32 v14, 16, v99
    v_and_b32 v15, 0xffff0000, v99
    v_pk_add_f32 v[146:147], v[146:147], v[14:15]
    v_lshlrev_b32 v14, 16, v100
    v_and_b32 v15, 0xffff0000, v100
    v_pk_add_f32 v[144:145], v[144:145], v[14:15]
    v_lshlrev_b32 v14, 16, v101
    v_and_b32 v15, 0xffff0000, v101
    v_pk_add_f32 v[146:147], v[146:147], v[14:15]
    v_lshlrev_b32 v14, 16, v102
    v_and_b32 v15, 0xffff0000, v102
    v_pk_add_f32 v[144:145], v[144:145], v[14:15]
    v_lshlrev_b32 v14, 16, v103
    v_and_b32 v15, 0xffff0000, v103
    v_pk_add_f32 v[146:147], v[146:147], v[14:15]
L_A_mu:
    v_mov_b32 v28, 0
    v_mov_b32 v29, 0
    v_mov_b32 v30, 0
    v_mov_b32 v31, 0
    s_mov_b32 s63, 0
    s_waitcnt vmcnt(14)
    v_max3_u32 v12, v32, v33, v34
    v_max3_u32 v12, v12, v35, v36
    v_max3_u32 v12, v12, v37, v38
    v_max_u32 v12, v12, v39
    v_cmp_eq_u32 vcc, -1, v12
    s_cbranch_vccnz L_h4_f0
    v_mfma_f32_16x16x32_bf16 v[28:31], v[20:23], v[32:35], v[28:31]
    v_mfma_f32_16x16x32_bf16 v[28:31], v[20:23], v[36:39], v[28:31]
L_h4_n0:
    s_waitcnt vmcnt(12)
    v_max3_u32 v12, v40, v41, v42
    v_max3_u32 v12, v12, v43, v44
    v_max3_u32 v12, v12, v45, v46
    v_max_u32 v12, v12, v47
    v_cmp_eq_u32 vcc, -1, v12
    s_cbranch_vccnz L_h4_f2
    v_mfma_f32_16x16x32_bf16 v[28:31], v[20:23], v[40:43], v[28:31]
    v_mfma_f32_16x16x32_bf16 v[28:31], v[20:23], v[44:47], v[28:31]
L_h4_n2:
    s_waitcnt vmcnt(10)
    v_max3_u32 v12, v48, v49, v50
    v_max3_u32 v12, v12, v51, v52
    v_max3_u32 v12, v12, v53, v54
    v_max_u32 v12, v12, v55
    v_cmp_eq_u32 vcc, -1, v12
    s_cbranch_vccnz L_h4_f4
    v_mfma_f32_16x16x32_bf16 v[28:31], v[20:23], v[48:51], v[28:31]
    v_mfma_f32_16x16x32_bf16 v[28:31], v[20:23], v[52:55], v[28:31]
L_h4_n4:
    s_waitcnt vmcnt(8)
    v_max3_u32 v12, v56, v57, v58
    v_max3_u32 v12, v12, v59, v60
    v_max3_u32 v12, v12, v61, v62
    v_max_u32 v12, v12, v63
    v_cmp_eq_u32 vcc, -1, v12
    s_cbranch_vccnz L_h4_f6
    v_mfma_f32_16x16x32_bf16 v[28:31], v[20:23], v[56:59], v[28:31]
    v_mfma_f32_16x16x32_bf16 v[28:31], v[20:23], v[60:63], v[28:31]
L_h4_n6:
    s_waitcnt vmcnt(6)
    v_max3_u32 v12, v64, v65, v66
    v_max3_u32 v12, v12, v67, v68
    v_max3_u32 v12, v12, v69, v70
    v_max_u32 v12, v12, v71
    v_cmp_eq_u32 vcc, -1, v12
    s_cbranch_vccnz L_h4_f8
    v_mfma_f32_16x16x32_bf16 v[28:31], v[20:23], v[64:67], v[28:31]
    v_mfma_f32_16x16x32_bf16 v[28:31], v[20:23], v[68:71], v[28:31]
L_h4_n8:
    s_waitcnt vmcnt(4)
    v_max3_u32 v12, v72, v73, v74
    v_max3_u32 v12, v12, v75, v76
    v_max3_u32 v12, v12, v77, v78
    v_max_u32 v12, v12, v79
    v_cmp_eq_u32 vcc, -1, v12
    s_cbranch_vccnz L_h4_f10
    v_mfma_f32_16x16x32_bf16 v[28:31], v[20:23], v[72:75], v[28:31]
    v_mfma_f32_16x16x32_bf16 v[28:31], v[20:23], v[76:79], v[28:31]
L_h4_n10:
    s_waitcnt vmcnt(2)
    v_max3_u32 v12, v80, v81, v82
    v_max3_u32 v12, v12, v83, v84
    v_max3_u32 v12, v12, v85, v86
    v_max_u32 v12, v12, v87
    v_cmp_eq_u32 vcc, -1, v12
    s_cbranch_vccnz L_h4_f12
    v_mfma_f32_16x16x32_bf16 v[28:31], v[20:23], v[80:83], v[28:31]
    v_mfma_f32_16x16x32_bf16 v[28:31], v[20:23], v[84:87], v[28:31]
L_h4_n12:
    s_waitcnt vmcnt(0)
    v_max3_u32 v12, v88, v89, v90
    v_max3_u32 v12, v12, v91, v92
    v_max3_u32 v12, v12, v93, v94
    v_max_u32 v12, v12, v95
    v_cmp_eq_u32 vcc, -1, v12
    s_cbranch_vccnz L_h4_f14
    v_mfma_f32_16x16x32_bf16 v[28:31], v[20:23], v[88:91], v[28:31]
    v_mfma_f32_16x16x32_bf16 v[28:31], v[20:23], v[92:95], v[28:31]
L_h4_n14:
    s_cmp_lg_u32 s63, 0
    s_cbranch_scc1 L_h4_r
L_h4_d:
    s_nop 5
    v_pk_fma_f32 v[28:29], v[28:29], v[144:145], v[140:141]
    v_pk_fma_f32 v[30:31], v[30:31], v[146:147], v[142:143]
    s_cmp_lt_u32 s34, 4
    s_cbranch_scc1 L_A_fin
    v_pk_mul_f32 v[152:153], v[152:153], v[28:29]
    v_pk_mul_f32 v[154:155], v[154:155], v[30:31]
    v_cvt_pk_bf16_f32 v32, v152, v153
    v_cvt_pk_bf16_f32 v33, v154, v155
    v_lshlrev_b32 v36, 16, v32
    v_and_b32 v37, 0xffff0000, v32
    v_lshlrev_b32 v38, 16, v33
    v_and_b32 v39, 0xffff0000, v33
    v_pk_add_f32 v[36:37], v[152:153], v[36:37] neg_lo:[0,1] neg_hi:[0,1]
    v_pk_add_f32 v[38:39], v[154:155], v[38:39] neg_lo:[0,1] neg_hi:[0,1]
    v_cvt_pk_bf16_f32 v34, v36, v37
    v_cvt_pk_bf16_f32 v35, v38, v39
    ds_write2_b64 v25, v[32:33], v[34:35] offset0:0 offset1:130
    v_mov_b32 v14, 1
    s_mov_b64 exec, 1
    ds_add_u32 v0, v14 offset:5052
    s_mov_b64 exec, -1

    v_add_f32 v12, v28, v29
    v_mul_f32 v13, v28, v28
    v_add_f32 v14, v30, v31
    v_fmac_f32 v13, v29, v29
    v_add_f32 v12, v12, v14
    v_fmac_f32 v13, v30, v30
    v_fmac_f32 v13, v31, v31
    s_nop 1
    v_permlane16_swap_b32 v12, v13
    v_add_f32 v12, v12, v13
    s_nop 1
    v_add_f32_dpp v12, v12, v12 quad_perm:[1,0,3,2] row_mask:0xf bank_mask:0xf
    s_nop 1
    v_add_f32_dpp v12, v12, v12 quad_perm:[2,3,0,1] row_mask:0xf bank_mask:0xf
    s_nop 1
    v_add_f32_dpp v12, v12, v12 row_half_mirror row_mask:0xf bank_mask:0xf
    s_nop 1
    v_add_f32_dpp v12, v12, v12 row_mirror row_mask:0xf bank_mask:0xf
    ds_write_b32 v26, v12
    s_branch L_end
L_A_fin:
    s_mov_b32 s44, s26
    s_mov_b32 s45, s27
    s_mov_b32 s46, 8192
    s_mov_b32 s47, 0x20000

    v_and_b32 v12, 7, v1
    v_lshlrev_b32 v13, 1, v12
    v_lshrrev_b32 v14, 1, v6
    v_add_u32 v13, v13, v14
    v_and_b32 v14, 1, v6
    v_lshl_add_u32 v13, v14, 4, v13
    v_lshl_add_u32 v13, v17, 5, v13
    v_lshlrev_b32 v13, 2, v13
    ds_bpermute_b32 v140, v13, v28
    ds_bpermute_b32 v144, v13, v148
    ds_bpermute_b32 v141, v13, v29
    ds_bpermute_b32 v145, v13, v149
    ds_bpermute_b32 v142, v13, v30
    ds_bpermute_b32 v146, v13, v150
    ds_bpermute_b32 v143, v13, v31
    ds_bpermute_b32 v147, v13, v151

    v_lshlrev_b32 v4, 5, v12
    v_lshl_add_u32 v4, v6, 3, v4
    v_lshl_add_u32 v4, v17, 12, v4
    v_mul_u32_u24 v7, 14336, v14
    v_add_u32 v7, v7, v5
    s_mov_b32 s56, s53
    s_add_u32 s57, s53, 4096
    s_add_u32 s58, s53, 8192
    s_add_u32 s59, s53, 12288
    s_waitcnt lgkmcnt(0)
L_h5:
    buffer_load_dwordx4 v[32:35], v7, s[40:43], s56 offen offset:0 sc1
    buffer_load_dwordx4 v[36:39], v7, s[40:43], s56 offen offset:1024 sc1
    buffer_load_dwordx4 v[40:43], v7, s[40:43], s56 offen offset:2048 sc1
    buffer_load_dwordx4 v[44:47], v7, s[40:43], s56 offen offset:3072 sc1
    buffer_load_dwordx4 v[48:51], v7, s[40:43], s57 offen offset:0 sc1
    buffer_load_dwordx4 v[52:55], v7, s[40:43], s57 offen offset:1024 sc1
    buffer_load_dwordx4 v[56:59], v7, s[40:43], s57 offen offset:2048 sc1
    buffer_load_dwordx4 v[60:63], v7, s[40:43], s57 offen offset:3072 sc1
    buffer_load_dwordx4 v[64:67], v7, s[40:43], s58 offen offset:0 sc1
    buffer_load_dwordx4 v[68:71], v7, s[40:43], s58 offen offset:1024 sc1
    buffer_load_dwordx4 v[72:75], v7, s[40:43], s58 offen offset:2048 sc1
    buffer_load_dwordx4 v[76:79], v7, s[40:43], s58 offen offset:3072 sc1
    buffer_load_dwordx4 v[80:83], v7, s[40:43], s59 offen offset:0 sc1
    buffer_load_dwordx4 v[84:87], v7, s[40:43], s59 offen offset:1024 sc1
    s_sub_u32 s3, s3, 1
    s_cbranch_scc1 L_end
    s_waitcnt vmcnt(13)
    v_mfma_f32_16x16x32_bf16 v[28:31], v[32:35], v[20:23], 0
    v_max3_u32 v12, v32, v33, v34
    v_max_u32 v12, v12, v35
    s_waitcnt vmcnt(12)
    v_mfma_f32_16x16x32_bf16 v[28:31], v[36:39], v[20:23], v[28:31]
    v_max3_u32 v12, v12, v36, v37
    v_max3_u32 v12, v12, v38, v39
    s_waitcnt vmcnt(11)
    v_mfma_f32_16x16x32_bf16 v[28:31], v[40:43], v[20:23], v[28:31]
    v_max3_u32 v12, v12, v40, v41
    v_max3_u32 v12, v12, v42, v43
    s_waitcnt vmcnt(10)
    v_mfma_f32_16x16x32_bf16 v[28:31], v[44:47], v[20:23], v[28:31]
    v_max3_u32 v12, v12, v44, v45
    v_max3_u32 v12, v12, v46, v47
    s_waitcnt vmcnt(9)
    v_mfma_f32_16x16x32_bf16 v[28:31], v[48:51], v[20:23], v[28:31]
    v_max3_u32 v12, v12, v48, v49
    v_max3_u32 v12, v12, v50, v51
    s_waitcnt vmcnt(8)
    v_mfma_f32_16x16x32_bf16 v[28:31], v[52:55], v[20:23], v[28:31]
    v_max3_u32 v12, v12, v52, v53
    v_max3_u32 v12, v12, v54, v55
    s_waitcnt vmcnt(7)
    v_mfma_f32_16x16x32_bf16 v[28:31], v[56:59], v[20:23], v[28:31]
    v_max3_u32 v12, v12, v56, v57
    v_max3_u32 v12, v12, v58, v59
    s_waitcnt vmcnt(6)
    v_mfma_f32_16x16x32_bf16 v[28:31], v[60:63], v[20:23], v[28:31]
    v_max3_u32 v12, v12, v60, v61
    v_max3_u32 v12, v12, v62, v63
    s_waitcnt vmcnt(5)
    v_mfma_f32_16x16x32_bf16 v[28:31], v[64:67], v[20:23], v[28:31]
    v_max3_u32 v12, v12, v64, v65
    v_max3_u32 v12, v12, v66, v67
    s_waitcnt vmcnt(4)
    v_mfma_f32_16x16x32_bf16 v[28:31], v[68:71], v[20:23], v[28:31]
    v_max3_u32 v12, v12, v68, v69
    v_max3_u32 v12, v12, v70, v71
    s_waitcnt vmcnt(3)
    v_mfma_f32_16x16x32_bf16 v[28:31], v[72:75], v[20:23], v[28:31]
    v_max3_u32 v12, v12, v72, v73
    v_max3_u32 v12, v12, v74, v75
    s_waitcnt vmcnt(2)
    v_mfma_f32_16x16x32_bf16 v[28:31], v[76:79], v[20:23], v[28:31]
    v_max3_u32 v12, v12, v76, v77
    v_max3_u32 v12, v12, v78, v79
    s_waitcnt vmcnt(1)
    v_mfma_f32_16x16x32_bf16 v[28:31], v[80:83], v[20:23], v[28:31]
    v_max3_u32 v12, v12, v80, v81
    v_max3_u32 v12, v12, v82, v83
    s_waitcnt vmcnt(0)
    v_mfma_f32_16x16x32_bf16 v[28:31], v[84:87], v[20:23], v[28:31]
    v_max3_u32 v12, v12, v84, v85
    v_max3_u32 v12, v12, v86, v87
    v_cmp_eq_u32 vcc, -1, v12
    s_cbranch_vccnz L_h5
    s_nop 3
    v_fma_f32 v28, v28, v144, v140
    v_fma_f32 v29, v29, v145, v141
    v_fma_f32 v30, v30, v146, v142
    v_fma_f32 v31, v31, v147, v143
    v_cvt_pk_bf16_f32 v28, v28, v29
    v_cvt_pk_bf16_f32 v29, v30, v31
    buffer_store_dwordx2 v[28:29], v4, s[44:47], s48 offen
    s_branch L_end
L_h4_f0:
    buffer_load_dwordx4 v[32:35], v7, s[40:43], s56 offen offset:0 sc1
    buffer_load_dwordx4 v[36:39], v7, s[40:43], s56 offen offset:1024 sc1
    s_bitset1_b32 s63, 0
    s_branch L_h4_n0
L_h4_f2:
    buffer_load_dwordx4 v[40:43], v7, s[40:43], s56 offen offset:2048 sc1
    buffer_load_dwordx4 v[44:47], v7, s[40:43], s56 offen offset:3072 sc1
    s_bitset1_b32 s63, 2
    s_branch L_h4_n2
L_h4_f4:
    buffer_load_dwordx4 v[48:51], v7, s[40:43], s57 offen offset:0 sc1
    buffer_load_dwordx4 v[52:55], v7, s[40:43], s57 offen offset:1024 sc1
    s_bitset1_b32 s63, 4
    s_branch L_h4_n4
L_h4_f6:
    buffer_load_dwordx4 v[56:59], v7, s[40:43], s57 offen offset:2048 sc1
    buffer_load_dwordx4 v[60:63], v7, s[40:43], s57 offen offset:3072 sc1
    s_bitset1_b32 s63, 6
    s_branch L_h4_n6
L_h4_f8:
    buffer_load_dwordx4 v[64:67], v7, s[40:43], s58 offen offset:0 sc1
    buffer_load_dwordx4 v[68:71], v7, s[40:43], s58 offen offset:1024 sc1
    s_bitset1_b32 s63, 8
    s_branch L_h4_n8
L_h4_f10:
    buffer_load_dwordx4 v[72:75], v7, s[40:43], s58 offen offset:2048 sc1
    buffer_load_dwordx4 v[76:79], v7, s[40:43], s58 offen offset:3072 sc1
    s_bitset1_b32 s63, 10
    s_branch L_h4_n10
L_h4_f12:
    buffer_load_dwordx4 v[80:83], v7, s[40:43], s59 offen offset:0 sc1
    buffer_load_dwordx4 v[84:87], v7, s[40:43], s59 offen offset:1024 sc1
    s_bitset1_b32 s63, 12
    s_branch L_h4_n12
L_h4_f14:
    buffer_load_dwordx4 v[88:91], v7, s[40:43], s59 offen offset:2048 sc1
    buffer_load_dwordx4 v[92:95], v7, s[40:43], s59 offen offset:3072 sc1
    s_bitset1_b32 s63, 14
    s_branch L_h4_n14
L_h4_r:
    s_sub_u32 s3, s3, 1
    s_cbranch_scc1 L_end
    s_waitcnt vmcnt(0)
    s_bitcmp1_b32 s63, 0
    s_cbranch_scc0 L_h4_s0
    v_max3_u32 v12, v32, v33, v34
    v_max3_u32 v12, v12, v35, v36
    v_max3_u32 v12, v12, v37, v38
    v_max_u32 v12, v12, v39
    v_cmp_eq_u32 vcc, -1, v12
    s_cbranch_vccz L_h4_g0
    buffer_load_dwordx4 v[32:35], v7, s[40:43], s56 offen offset:0 sc1
    buffer_load_dwordx4 v[36:39], v7, s[40:43], s56 offen offset:1024 sc1
    s_branch L_h4_s0
L_h4_g0:
    s_bitset0_b32 s63, 0
    v_mfma_f32_16x16x32_bf16 v[28:31], v[20:23], v[32:35], v[28:31]
    v_mfma_f32_16x16x32_bf16 v[28:31], v[20:23], v[36:39], v[28:31]
L_h4_s0:
    s_bitcmp1_b32 s63, 2
    s_cbranch_scc0 L_h4_s2
    v_max3_u32 v12, v40, v41, v42
    v_max3_u32 v12, v12, v43, v44
    v_max3_u32 v12, v12, v45, v46
    v_max_u32 v12, v12, v47
    v_cmp_eq_u32 vcc, -1, v12
    s_cbranch_vccz L_h4_g2
    buffer_load_dwordx4 v[40:43], v7, s[40:43], s56 offen offset:2048 sc1
    buffer_load_dwordx4 v[44:47], v7, s[40:43], s56 offen offset:3072 sc1
    s_branch L_h4_s2
L_h4_g2:
    s_bitset0_b32 s63, 2
    v_mfma_f32_16x16x32_bf16 v[28:31], v[20:23], v[40:43], v[28:31]
    v_mfma_f32_16x16x32_bf16 v[28:31], v[20:23], v[44:47], v[28:31]
L_h4_s2:
    s_bitcmp1_b32 s63, 4
    s_cbranch_scc0 L_h4_s4
    v_max3_u32 v12, v48, v49, v50
    v_max3_u32 v12, v12, v51, v52
    v_max3_u32 v12, v12, v53, v54
    v_max_u32 v12, v12, v55
    v_cmp_eq_u32 vcc, -1, v12
    s_cbranch_vccz L_h4_g4
    buffer_load_dwordx4 v[48:51], v7, s[40:43], s57 offen offset:0 sc1
    buffer_load_dwordx4 v[52:55], v7, s[40:43], s57 offen offset:1024 sc1
    s_branch L_h4_s4
L_h4_g4:
    s_bitset0_b32 s63, 4
    v_mfma_f32_16x16x32_bf16 v[28:31], v[20:23], v[48:51], v[28:31]
    v_mfma_f32_16x16x32_bf16 v[28:31], v[20:23], v[52:55], v[28:31]
L_h4_s4:
    s_bitcmp1_b32 s63, 6
    s_cbranch_scc0 L_h4_s6
    v_max3_u32 v12, v56, v57, v58
    v_max3_u32 v12, v12, v59, v60
    v_max3_u32 v12, v12, v61, v62
    v_max_u32 v12, v12, v63
    v_cmp_eq_u32 vcc, -1, v12
    s_cbranch_vccz L_h4_g6
    buffer_load_dwordx4 v[56:59], v7, s[40:43], s57 offen offset:2048 sc1
    buffer_load_dwordx4 v[60:63], v7, s[40:43], s57 offen offset:3072 sc1
    s_branch L_h4_s6
L_h4_g6:
    s_bitset0_b32 s63, 6
    v_mfma_f32_16x16x32_bf16 v[28:31], v[20:23], v[56:59], v[28:31]
    v_mfma_f32_16x16x32_bf16 v[28:31], v[20:23], v[60:63], v[28:31]
L_h4_s6:
    s_bitcmp1_b32 s63, 8
    s_cbranch_scc0 L_h4_s8
    v_max3_u32 v12, v64, v65, v66
    v_max3_u32 v12, v12, v67, v68
    v_max3_u32 v12, v12, v69, v70
    v_max_u32 v12, v12, v71
    v_cmp_eq_u32 vcc, -1, v12
    s_cbranch_vccz L_h4_g8
    buffer_load_dwordx4 v[64:67], v7, s[40:43], s58 offen offset:0 sc1
    buffer_load_dwordx4 v[68:71], v7, s[40:43], s58 offen offset:1024 sc1
    s_branch L_h4_s8
L_h4_g8:
    s_bitset0_b32 s63, 8
    v_mfma_f32_16x16x32_bf16 v[28:31], v[20:23], v[64:67], v[28:31]
    v_mfma_f32_16x16x32_bf16 v[28:31], v[20:23], v[68:71], v[28:31]
L_h4_s8:
    s_bitcmp1_b32 s63, 10
    s_cbranch_scc0 L_h4_s10
    v_max3_u32 v12, v72, v73, v74
    v_max3_u32 v12, v12, v75, v76
    v_max3_u32 v12, v12, v77, v78
    v_max_u32 v12, v12, v79
    v_cmp_eq_u32 vcc, -1, v12
    s_cbranch_vccz L_h4_g10
    buffer_load_dwordx4 v[72:75], v7, s[40:43], s58 offen offset:2048 sc1
    buffer_load_dwordx4 v[76:79], v7, s[40:43], s58 offen offset:3072 sc1
    s_branch L_h4_s10
L_h4_g10:
    s_bitset0_b32 s63, 10
    v_mfma_f32_16x16x32_bf16 v[28:31], v[20:23], v[72:75], v[28:31]
    v_mfma_f32_16x16x32_bf16 v[28:31], v[20:23], v[76:79], v[28:31]
L_h4_s10:
    s_bitcmp1_b32 s63, 12
    s_cbranch_scc0 L_h4_s12
    v_max3_u32 v12, v80, v81, v82
    v_max3_u32 v12, v12, v83, v84
    v_max3_u32 v12, v12, v85, v86
    v_max_u32 v12, v12, v87
    v_cmp_eq_u32 vcc, -1, v12
    s_cbranch_vccz L_h4_g12
    buffer_load_dwordx4 v[80:83], v7, s[40:43], s59 offen offset:0 sc1
    buffer_load_dwordx4 v[84:87], v7, s[40:43], s59 offen offset:1024 sc1
    s_branch L_h4_s12
L_h4_g12:
    s_bitset0_b32 s63, 12
    v_mfma_f32_16x16x32_bf16 v[28:31], v[20:23], v[80:83], v[28:31]
    v_mfma_f32_16x16x32_bf16 v[28:31], v[20:23], v[84:87], v[28:31]
L_h4_s12:
    s_bitcmp1_b32 s63, 14
    s_cbranch_scc0 L_h4_s14
    v_max3_u32 v12, v88, v89, v90
    v_max3_u32 v12, v12, v91, v92
    v_max3_u32 v12, v12, v93, v94
    v_max_u32 v12, v12, v95
    v_cmp_eq_u32 vcc, -1, v12
    s_cbranch_vccz L_h4_g14
    buffer_load_dwordx4 v[88:91], v7, s[40:43], s59 offen offset:2048 sc1
    buffer_load_dwordx4 v[92:95], v7, s[40:43], s59 offen offset:3072 sc1
    s_branch L_h4_s14
L_h4_g14:
    s_bitset0_b32 s63, 14
    v_mfma_f32_16x16x32_bf16 v[28:31], v[20:23], v[88:91], v[28:31]
    v_mfma_f32_16x16x32_bf16 v[28:31], v[20:23], v[92:95], v[28:31]
L_h4_s14:
    s_cmp_lg_u32 s63, 0
    s_cbranch_scc1 L_h4_r
    s_branch L_h4_d
L_h3_r0:
    buffer_load_dwordx4 v[32:35], v7, s[40:43], s51 offen offset:0 sc1
    buffer_load_dwordx4 v[36:39], v7, s[40:43], s51 offen offset:1024 sc1
    buffer_load_dwordx4 v[40:43], v7, s[40:43], s51 offen offset:2048 sc1
    buffer_load_dwordx4 v[44:47], v7, s[40:43], s51 offen offset:3072 sc1
    buffer_load_dwordx4 v[48:51], v7, s[40:43], s52 offen offset:0 sc1
    buffer_load_dwordx4 v[52:55], v7, s[40:43], s52 offen offset:1024 sc1
    buffer_load_dwordx4 v[56:59], v7, s[40:43], s52 offen offset:2048 sc1
    buffer_load_dwordx4 v[60:63], v7, s[40:43], s52 offen offset:3072 sc1
    s_sub_u32 s3, s3, 1
    s_cbranch_scc1 L_end
    s_waitcnt vmcnt(4)
    s_branch L_h3_c0
L_h3_r1:
    buffer_load_dwordx4 v[48:51], v7, s[40:43], s52 offen offset:0 sc1
    buffer_load_dwordx4 v[52:55], v7, s[40:43], s52 offen offset:1024 sc1
    buffer_load_dwordx4 v[56:59], v7, s[40:43], s52 offen offset:2048 sc1
    buffer_load_dwordx4 v[60:63], v7, s[40:43], s52 offen offset:3072 sc1
    s_sub_u32 s3, s3, 1
    s_cbranch_scc1 L_end
    s_waitcnt vmcnt(0)
    s_branch L_h3_c1
L_Bc:
    s_cmp_lg_u32 s34, 0
    s_cbranch_scc1 L_B_go
    s_lshl2_add_u32 s55, s36, s37

    v_lshrrev_b32 v2, 2, v1
    v_mul_u32_u24 v4, 6144, v2
    v_lshrrev_b32 v2, 5, v1
    v_bfe_u32 v5, v1, 1, 1
    v_xor_b32 v2, v2, v5
    v_lshl_add_u32 v4, v2, 10, v4
    v_and_b32 v2, 1, v1
    v_lshl_add_u32 v4, v2, 4, v4
    s_mul_i32 s58, s33, 786432
    s_lshl_b32 s39, s55, 5
    s_add_u32 s58, s58, s39
    s_lshl_b32 s59, s33, 13
    s_add_u32 m0, s59, 65536
    s_waitcnt lgkmcnt(0)
    s_mov_b32 s44, s24
    s_mov_b32 s45, s25
    s_mov_b32 s46, 3145728
    s_mov_b32 s47, 0x20000
    s_mov_b32 s40, s30
    s_mov_b32 s41, s31
    s_mov_b32 s42, 16777216
    s_mov_b32 s43, 0x20000

    s_mov_b32 s3, 0x400000
    v_mov_b32 v0, 156256
    s_and_b32 s62, s34, 3
    s_lshl2_add_u32 s97, s62, s37
    s_lshl4_add_u32 s61, s36, s97

    s_barrier
    buffer_load_dwordx4 v4, s[44:47], s58 offen lds
    s_add_u32 m0, m0, 1024
    s_add_u32 s58, s58, 98304
    buffer_load_dwordx4 v4, s[44:47], s58 offen lds
    s_add_u32 m0, m0, 1024
    s_add_u32 s58, s58, 98304
    buffer_load_dwordx4 v4, s[44:47], s58 offen lds
    s_add_u32 m0, m0, 1024
    s_add_u32 s58, s58, 98304
    buffer_load_dwordx4 v4, s[44:47], s58 offen lds
    s_add_u32 m0, m0, 1024
    s_add_u32 s58, s58, 98304
    buffer_load_dwordx4 v4, s[44:47], s58 offen lds
    s_add_u32 m0, m0, 1024
    s_add_u32 s58, s58, 98304
    buffer_load_dwordx4 v4, s[44:47], s58 offen lds
    s_add_u32 m0, m0, 1024
    s_add_u32 s58, s58, 98304
    buffer_load_dwordx4 v4, s[44:47], s58 offen lds
    s_add_u32 m0, m0, 1024
    s_add_u32 s58, s58, 98304
    buffer_load_dwordx4 v4, s[44:47], s58 offen lds
    s_add_u32 m0, m0, 1024
    s_add_u32 s58, s58, 98304
    v_mov_b32 v6, 1
    s_mov_b64 exec, 1
    ds_add_u32 v0, v6 offset:7056
    s_mov_b64 exec, -1
    s_lshl_b32 s38, s33, 2
    v_add_u32 v5, s38, v0
    v_mov_b32 v7, 2
    s_waitcnt vmcnt(4)
    ds_write_b32 v5, v6 offset:4032
    s_waitcnt vmcnt(0)
    ds_write_b32 v5, v7 offset:4032
    s_branch L_B_t
L_B_go:
    s_lshl_b32 s48, s33, 20
    s_lshl_b32 s38, s35, 8
    s_add_u32 s48, s48, s38
    s_and_b32 s49, s34, 3
    v_lshrrev_b32 v4, 4, v1
    v_and_b32 v5, 15, v1
    v_lshlrev_b32 v2, 18, v4
    v_lshl_add_u32 v2, v5, 4, v2
    s_waitcnt lgkmcnt(0)
    s_mov_b32 s44, s8
    s_mov_b32 s45, s9
    s_mov_b32 s46, 4194304
    s_mov_b32 s47, 0x20000
    s_xor_b32 s38, s49, 0
    s_lshl_b32 s38, s38, 16
    s_add_u32 s38, s38, s48
    buffer_load_dwordx4 v[40:43], v2, s[44:47], s38 offen
    s_add_u32 s38, s38, 8192
    buffer_load_dwordx4 v[44:47], v2, s[44:47], s38 offen
    s_add_u32 s38, s38, 8192
    buffer_load_dwordx4 v[48:51], v2, s[44:47], s38 offen
    s_add_u32 s38, s38, 8192
    buffer_load_dwordx4 v[52:55], v2, s[44:47], s38 offen
    s_add_u32 s38, s38, 8192
    buffer_load_dwordx4 v[56:59], v2, s[44:47], s38 offen
    s_add_u32 s38, s38, 8192
    buffer_load_dwordx4 v[60:63], v2, s[44:47], s38 offen
    s_add_u32 s38, s38, 8192
    buffer_load_dwordx4 v[64:67], v2, s[44:47], s38 offen
    s_add_u32 s38, s38, 8192
    buffer_load_dwordx4 v[68:71], v2, s[44:47], s38 offen
    s_mov_b32 s40, s30
    s_mov_b32 s41, s31
    s_mov_b32 s42, 16777216
    s_mov_b32 s43, 0x20000

    s_mov_b32 s3, 0x400000
    v_mov_b32 v0, 156256
    s_and_b32 s62, s34, 3
    s_lshl2_add_u32 s97, s62, s37
    s_lshl4_add_u32 s61, s36, s97

    s_barrier
    s_xor_b32 s38, s49, 1
    s_lshl_b32 s38, s38, 16
    s_add_u32 s38, s38, s48
    buffer_load_dwordx4 v[72:75], v2, s[44:47], s38 offen
    s_add_u32 s38, s38, 8192
    s_waitcnt vmcnt(6)
    buffer_load_dwordx4 v[76:79], v2, s[44:47], s38 offen
    s_add_u32 s38, s38, 8192
    s_waitcnt vmcnt(6)
    buffer_load_dwordx4 v[80:83], v2, s[44:47], s38 offen
    s_add_u32 s38, s38, 8192
    s_waitcnt vmcnt(6)
    buffer_load_dwordx4 v[84:87], v2, s[44:47], s38 offen
    s_add_u32 s38, s38, 8192
    s_waitcnt vmcnt(6)
    buffer_load_dwordx4 v[88:91], v2, s[44:47], s38 offen
    s_add_u32 s38, s38, 8192
    s_waitcnt vmcnt(6)
    buffer_load_dwordx4 v[92:95], v2, s[44:47], s38 offen
    s_add_u32 s38, s38, 8192
    s_waitcnt vmcnt(6)
    buffer_load_dwordx4 v[96:99], v2, s[44:47], s38 offen
    s_add_u32 s38, s38, 8192
    s_waitcnt vmcnt(6)
    buffer_load_dwordx4 v[100:103], v2, s[44:47], s38 offen
    s_waitcnt vmcnt(6)
    s_xor_b32 s38, s49, 2
    s_lshl_b32 s38, s38, 16
    s_add_u32 s38, s38, s48
    buffer_load_dwordx4 v[104:107], v2, s[44:47], s38 offen
    s_add_u32 s38, s38, 8192
    s_waitcnt vmcnt(6)
    buffer_load_dwordx4 v[108:111], v2, s[44:47], s38 offen
    s_add_u32 s38, s38, 8192
    s_waitcnt vmcnt(6)
    buffer_load_dwordx4 v[112:115], v2, s[44:47], s38 offen
    s_add_u32 s38, s38, 8192
    s_waitcnt vmcnt(6)
    buffer_load_dwordx4 v[116:119], v2, s[44:47], s38 offen
    s_add_u32 s38, s38, 8192
    s_waitcnt vmcnt(6)
    buffer_load_dwordx4 v[120:123], v2, s[44:47], s38 offen
    s_add_u32 s38, s38, 8192
    s_waitcnt vmcnt(6)
    buffer_load_dwordx4 v[124:127], v2, s[44:47], s38 offen
    s_add_u32 s38, s38, 8192
    s_waitcnt vmcnt(6)
    buffer_load_dwordx4 v[128:131], v2, s[44:47], s38 offen
    s_add_u32 s38, s38, 8192
    s_waitcnt vmcnt(6)
    buffer_load_dwordx4 v[132:135], v2, s[44:47], s38 offen
    s_waitcnt vmcnt(6)
    s_xor_b32 s38, s49, 3
    s_lshl_b32 s38, s38, 16
    s_add_u32 s38, s38, s48
    buffer_load_dwordx4 v[136:139], v2, s[44:47], s38 offen
    s_add_u32 s38, s38, 8192
    s_waitcnt vmcnt(6)
    buffer_load_dwordx4 v[140:143], v2, s[44:47], s38 offen
    s_add_u32 s38, s38, 8192
    s_waitcnt vmcnt(6)
    buffer_load_dwordx4 v[144:147], v2, s[44:47], s38 offen
    s_add_u32 s38, s38, 8192
    s_waitcnt vmcnt(6)
    buffer_load_dwordx4 v[148:151], v2, s[44:47], s38 offen
    s_add_u32 s38, s38, 8192
    s_waitcnt vmcnt(6)
    buffer_load_dwordx4 v[152:155], v2, s[44:47], s38 offen
    s_add_u32 s38, s38, 8192
    s_waitcnt vmcnt(6)
    buffer_load_dwordx4 v[156:159], v2, s[44:47], s38 offen
    s_add_u32 s38, s38, 8192
    s_waitcnt vmcnt(6)
    buffer_load_dwordx4 v[160:163], v2, s[44:47], s38 offen
    s_add_u32 s38, s38, 8192
    s_waitcnt vmcnt(6)
    buffer_load_dwordx4 v[164:167], v2, s[44:47], s38 offen
    s_waitcnt vmcnt(6)
    v_mov_b32 v6, 1
    s_mov_b64 exec, 1
    ds_add_u32 v0, v6 offset:0
    s_mov_b64 exec, -1

    v_lshrrev_b32 v5, 1, v5
    v_lshlrev_b32 v5, 4, v5
    v_lshl_add_u32 v7, v4, 9, v5
    s_lshl_b32 s38, s33, 11
    s_xor_b32 s50, s49, 0
    s_lshl_b32 s50, s50, 7
    s_add_u32 s50, s50, s38
    s_xor_b32 s51, s49, 1
    s_lshl_b32 s51, s51, 7
    s_add_u32 s51, s51, s38
    s_xor_b32 s52, s49, 2
    s_lshl_b32 s52, s52, 7
    s_add_u32 s52, s52, s38
    s_xor_b32 s53, s49, 3
    s_lshl_b32 s53, s53, 7
    s_add_u32 s53, s53, s38

    v_and_b32 v4, 1, v1
    v_cmp_eq_u32 vcc, 1, v4
    v_mov_b32 v2, 0x0c0c0100
    v_mov_b32 v4, 0x01000c0c
    v_cndmask_b32 v2, v2, v4, vcc
    v_mov_b32 v3, 0x0c0c0302
    v_mov_b32 v4, 0x03020c0c
    v_cndmask_b32 v3, v3, v4, vcc

    v_mov_b32 v6, 0
L_fl13:
    global_load_dword v4, v6, s[28:29] offset:0 sc1
    s_sub_u32 s3, s3, 1
    s_cbranch_scc1 L_end
    s_waitcnt vmcnt(0)
    v_cmp_eq_u32 vcc, 0, v4
    s_cbranch_vccnz L_fl13
    buffer_load_dwordx4 v[8:11], v7, s[40:43], s50 offen sc1
    buffer_load_dwordx4 v[12:15], v7, s[40:43], s51 offen sc1
    buffer_load_dwordx4 v[16:19], v7, s[40:43], s52 offen sc1
    buffer_load_dwordx4 v[20:23], v7, s[40:43], s53 offen sc1
    v_swap_b32 v41, v44
    v_swap_b32 v42, v48
    v_swap_b32 v43, v52
    v_swap_b32 v46, v49
    v_swap_b32 v47, v53
    v_swap_b32 v51, v54
    v_swap_b32 v57, v60
    v_swap_b32 v58, v64
    v_swap_b32 v59, v68
    v_swap_b32 v62, v65
    v_swap_b32 v63, v69
    v_swap_b32 v67, v70
    v_swap_b32 v73, v76
    v_swap_b32 v74, v80
    v_swap_b32 v75, v84
    v_swap_b32 v78, v81
    v_swap_b32 v79, v85
    v_swap_b32 v83, v86
    v_swap_b32 v89, v92
    v_swap_b32 v90, v96
    v_swap_b32 v91, v100
    v_swap_b32 v94, v97
    v_swap_b32 v95, v101
    v_swap_b32 v99, v102
    v_swap_b32 v105, v108
    v_swap_b32 v106, v112
    v_swap_b32 v107, v116
    v_swap_b32 v110, v113
    v_swap_b32 v111, v117
    v_swap_b32 v115, v118
    v_swap_b32 v121, v124
    v_swap_b32 v122, v128
    v_swap_b32 v123, v132
    v_swap_b32 v126, v129
    v_swap_b32 v127, v133
    v_swap_b32 v131, v134
    v_swap_b32 v137, v140
    v_swap_b32 v138, v144
    v_swap_b32 v139, v148
    v_swap_b32 v142, v145
    v_swap_b32 v143, v149
    v_swap_b32 v147, v150
    v_swap_b32 v153, v156
    v_swap_b32 v154, v160
    v_swap_b32 v155, v164
    v_swap_b32 v158, v161
    v_swap_b32 v159, v165
    v_swap_b32 v163, v166
    s_branch L_B_h1
L_B_h0:
    buffer_load_dwordx4 v[8:11], v7, s[40:43], s50 offen sc1
    buffer_load_dwordx4 v[12:15], v7, s[40:43], s51 offen sc1
    buffer_load_dwordx4 v[16:19], v7, s[40:43], s52 offen sc1
    buffer_load_dwordx4 v[20:23], v7, s[40:43], s53 offen sc1
    s_sub_u32 s3, s3, 1
    s_cbranch_scc1 L_end
L_B_h1:
    s_waitcnt vmcnt(0)
    v_max3_u32 v24, v8, v9, v10
    v_max3_u32 v24, v24, v11, v12
    v_max3_u32 v24, v24, v13, v14
    v_max3_u32 v24, v24, v15, v16
    v_max3_u32 v24, v24, v17, v18
    v_max3_u32 v24, v24, v19, v20
    v_max3_u32 v24, v24, v21, v22
    v_max_u32 v24, v24, v23
    v_cmp_eq_u32 vcc, -1, v24
    s_cbranch_vccnz L_B_h0
    v_mov_b32 v24, 1
    s_mov_b64 exec, 1
    ds_add_u32 v0, v24 offset:4
    s_mov_b64 exec, -1
    v_perm_b32 v4, v8, v8, v2
    v_perm_b32 v5, v8, v8, v3
    v_perm_b32 v6, v9, v9, v2
    v_perm_b32 v7, v9, v9, v3
    s_nop 1
    v_mfma_f32_16x16x32_bf16 v[24:27], v[40:43], v[4:7], 0
    v_perm_b32 v40, v10, v10, v2
    v_perm_b32 v41, v10, v10, v3
    v_mfma_f32_16x16x32_bf16 v[28:31], v[44:47], v[4:7], 0
    v_perm_b32 v42, v11, v11, v2
    v_perm_b32 v43, v11, v11, v3
    v_mfma_f32_16x16x32_bf16 v[32:35], v[48:51], v[4:7], 0
    v_mfma_f32_16x16x32_bf16 v[36:39], v[52:55], v[4:7], 0
    v_mfma_f32_16x16x32_bf16 v[24:27], v[56:59], v[40:43], v[24:27]
    v_perm_b32 v56, v12, v12, v2
    v_perm_b32 v57, v12, v12, v3
    v_mfma_f32_16x16x32_bf16 v[28:31], v[60:63], v[40:43], v[28:31]
    v_perm_b32 v58, v13, v13, v2
    v_perm_b32 v59, v13, v13, v3
    v_mfma_f32_16x16x32_bf16 v[32:35], v[64:67], v[40:43], v[32:35]
    v_mfma_f32_16x16x32_bf16 v[36:39], v[68:71], v[40:43], v[36:39]
    v_mfma_f32_16x16x32_bf16 v[24:27], v[72:75], v[56:59], v[24:27]
    v_perm_b32 v72, v14, v14, v2
    v_perm_b32 v73, v14, v14, v3
    v_mfma_f32_16x16x32_bf16 v[28:31], v[76:79], v[56:59], v[28:31]
    v_perm_b32 v74, v15, v15, v2
    v_perm_b32 v75, v15, v15, v3
    v_mfma_f32_16x16x32_bf16 v[32:35], v[80:83], v[56:59], v[32:35]
    v_mfma_f32_16x16x32_bf16 v[36:39], v[84:87], v[56:59], v[36:39]
    v_mfma_f32_16x16x32_bf16 v[24:27], v[88:91], v[72:75], v[24:27]
    v_perm_b32 v88, v16, v16, v2
    v_perm_b32 v89, v16, v16, v3
    v_mfma_f32_16x16x32_bf16 v[28:31], v[92:95], v[72:75], v[28:31]
    v_perm_b32 v90, v17, v17, v2
    v_perm_b32 v91, v17, v17, v3
    v_mfma_f32_16x16x32_bf16 v[32:35], v[96:99], v[72:75], v[32:35]
    v_mfma_f32_16x16x32_bf16 v[36:39], v[100:103], v[72:75], v[36:39]
    v_mfma_f32_16x16x32_bf16 v[24:27], v[104:107], v[88:91], v[24:27]
    v_perm_b32 v104, v18, v18, v2
    v_perm_b32 v105, v18, v18, v3
    v_mfma_f32_16x16x32_bf16 v[28:31], v[108:111], v[88:91], v[28:31]
    v_perm_b32 v106, v19, v19, v2
    v_perm_b32 v107, v19, v19, v3
    v_mfma_f32_16x16x32_bf16 v[32:35], v[112:115], v[88:91], v[32:35]
    v_mfma_f32_16x16x32_bf16 v[36:39], v[116:119], v[88:91], v[36:39]
    v_mfma_f32_16x16x32_bf16 v[24:27], v[120:123], v[104:107], v[24:27]
    v_perm_b32 v120, v20, v20, v2
    v_perm_b32 v121, v20, v20, v3
    v_mfma_f32_16x16x32_bf16 v[28:31], v[124:127], v[104:107], v[28:31]
    v_perm_b32 v122, v21, v21, v2
    v_perm_b32 v123, v21, v21, v3
    v_mfma_f32_16x16x32_bf16 v[32:35], v[128:131], v[104:107], v[32:35]
    v_mfma_f32_16x16x32_bf16 v[36:39], v[132:135], v[104:107], v[36:39]
    v_mfma_f32_16x16x32_bf16 v[24:27], v[136:139], v[120:123], v[24:27]
    v_perm_b32 v136, v22, v22, v2
    v_perm_b32 v137, v22, v22, v3
    v_mfma_f32_16x16x32_bf16 v[28:31], v[140:143], v[120:123], v[28:31]
    v_perm_b32 v138, v23, v23, v2
    v_perm_b32 v139, v23, v23, v3
    v_mfma_f32_16x16x32_bf16 v[32:35], v[144:147], v[120:123], v[32:35]
    v_mfma_f32_16x16x32_bf16 v[36:39], v[148:151], v[120:123], v[36:39]
    v_mfma_f32_16x16x32_bf16 v[24:27], v[152:155], v[136:139], v[24:27]
    v_mfma_f32_16x16x32_bf16 v[28:31], v[156:159], v[136:139], v[28:31]
    v_mfma_f32_16x16x32_bf16 v[32:35], v[160:163], v[136:139], v[32:35]
    v_mfma_f32_16x16x32_bf16 v[36:39], v[164:167], v[136:139], v[36:39]
    s_lshl_b32 s38, s33, 12
    s_add_u32 s38, s38, 131072
    v_lshl_add_u32 v4, v1, 4, s38
    s_nop 1
    ds_write_b128 v4, v[24:27] offset:0
    ds_write_b128 v4, v[28:31] offset:1024
    ds_write_b128 v4, v[32:35] offset:2048
    ds_write_b128 v4, v[36:39] offset:3072
    v_mov_b32 v5, 1
    s_mov_b64 exec, 1
    ds_add_u32 v0, v5 offset:5040
    s_mov_b64 exec, -1
L_B_t:
    s_cmp_lt_u32 s33, 2
    s_cbranch_scc1 L_B_uv
    s_cmp_eq_u32 s33, 2
    s_cbranch_scc1 L_B_mo
L_w14:
    s_sleep 1
    ds_read_b32 v6, v0 offset:5044
    s_sub_u32 s3, s3, 1
    s_cbranch_scc1 L_end
    s_waitcnt lgkmcnt(0)
    v_cmp_gt_u32 vcc, 3, v6
    s_cbranch_vccnz L_w14
    v_mov_b32 v4, 0
L_fl15:
    s_sleep 8
    global_load_dword v5, v4, s[28:29] offset:4 sc1
    s_sub_u32 s3, s3, 1
    s_cbranch_scc1 L_end
    s_waitcnt vmcnt(0)
    v_cmp_eq_u32 vcc, 0, v5
    s_cbranch_vccnz L_fl15
    v_mov_b32 v6, 1
    s_mov_b64 exec, 1
    ds_add_u32 v0, v6 offset:5052
    s_mov_b64 exec, -1
    s_branch L_end
L_B_mo:
L_w16:
    s_sleep 1
    ds_read_b32 v6, v0 offset:5044
    s_sub_u32 s3, s3, 1
    s_cbranch_scc1 L_end
    s_waitcnt lgkmcnt(0)
    v_cmp_gt_u32 vcc, 3, v6
    s_cbranch_vccnz L_w16
    s_mov_b32 s44, s22
    s_mov_b32 s45, s23
    s_mov_b32 s46, 8192
    s_mov_b32 s47, 0x20000

    v_lshrrev_b32 v4, 4, v1
    v_and_b32 v5, 15, v1
    v_lshrrev_b32 v2, 1, v5
    v_lshlrev_b32 v2, 10, v2
    v_lshl_add_u32 v2, v4, 6, v2
    s_lshl_b32 s38, s62, 8
    buffer_load_dwordx4 v[8:11], v2, s[44:47], s38 offen offset:0
    buffer_load_dwordx4 v[12:15], v2, s[44:47], s38 offen offset:16
    buffer_load_dwordx4 v[16:19], v2, s[44:47], s38 offen offset:32
    buffer_load_dwordx4 v[20:23], v2, s[44:47], s38 offen offset:48
    s_mov_b32 s44, s24
    s_mov_b32 s45, s25
    s_mov_b32 s46, 3145728
    s_mov_b32 s47, 0x20000

    v_mul_u32_u24 v2, 196608, v4
    v_lshl_add_u32 v2, v5, 3, v2
    v_lshlrev_b32 v4, 11, v4
    v_lshl_add_u32 v4, v5, 3, v4
    v_and_b32 v3, 1, v1
    v_lshlrev_b32 v3, 4, v3
    s_mov_b32 s38, 0xffff
    v_lshlrev_b32 v3, v3, s38
    s_mul_i32 s48, s62, 786432
    s_lshl_b32 s38, s35, 7
    s_add_u32 s48, s48, s38
    s_add_u32 s48, s48, 2048
    s_lshl2_add_u32 s49, s37, s62
    s_lshl_b32 s49, s49, 13
    s_lshl_b32 s38, s36, 7
    s_add_u32 s49, s49, s38
    s_add_u32 s49, s49, 1179648
    s_mov_b32 s38, 0xbfb8aa3b
    s_waitcnt vmcnt(0)
    v_lshlrev_b32 v24, 16, v8
    v_and_b32 v25, 0xffff0000, v8
    v_mul_f32 v26, s38, v24
    v_mul_f32 v27, s38, v25
    v_exp_f32 v26, v26
    v_exp_f32 v27, v27
    v_add_f32 v26, 1.0, v26
    v_add_f32 v27, 1.0, v27
    v_rcp_f32 v26, v26
    v_rcp_f32 v27, v27
    v_mul_f32 v24, v24, v26
    v_mul_f32 v25, v25, v27
    v_cvt_pk_bf16_f32 v24, v24, v24
    v_cvt_pk_bf16_f32 v25, v25, v25
    v_and_b32 v40, v24, v3
    v_and_b32 v41, v25, v3
    v_lshlrev_b32 v24, 16, v9
    v_and_b32 v25, 0xffff0000, v9
    v_mul_f32 v26, s38, v24
    v_mul_f32 v27, s38, v25
    v_exp_f32 v26, v26
    v_exp_f32 v27, v27
    v_add_f32 v26, 1.0, v26
    v_add_f32 v27, 1.0, v27
    v_rcp_f32 v26, v26
    v_rcp_f32 v27, v27
    v_mul_f32 v24, v24, v26
    v_mul_f32 v25, v25, v27
    v_cvt_pk_bf16_f32 v24, v24, v24
    v_cvt_pk_bf16_f32 v25, v25, v25
    v_and_b32 v42, v24, v3
    v_and_b32 v43, v25, v3
    v_lshlrev_b32 v24, 16, v10
    v_and_b32 v25, 0xffff0000, v10
    v_mul_f32 v26, s38, v24
    v_mul_f32 v27, s38, v25
    v_exp_f32 v26, v26
    v_exp_f32 v27, v27
    v_add_f32 v26, 1.0, v26
    v_add_f32 v27, 1.0, v27
    v_rcp_f32 v26, v26
    v_rcp_f32 v27, v27
    v_mul_f32 v24, v24, v26
    v_mul_f32 v25, v25, v27
    v_cvt_pk_bf16_f32 v24, v24, v24
    v_cvt_pk_bf16_f32 v25, v25, v25
    v_and_b32 v44, v24, v3
    v_and_b32 v45, v25, v3
    v_lshlrev_b32 v24, 16, v11
    v_and_b32 v25, 0xffff0000, v11
    v_mul_f32 v26, s38, v24
    v_mul_f32 v27, s38, v25
    v_exp_f32 v26, v26
    v_exp_f32 v27, v27
    v_add_f32 v26, 1.0, v26
    v_add_f32 v27, 1.0, v27
    v_rcp_f32 v26, v26
    v_rcp_f32 v27, v27
    v_mul_f32 v24, v24, v26
    v_mul_f32 v25, v25, v27
    v_cvt_pk_bf16_f32 v24, v24, v24
    v_cvt_pk_bf16_f32 v25, v25, v25
    v_and_b32 v46, v24, v3
    v_and_b32 v47, v25, v3
    v_lshlrev_b32 v24, 16, v12
    v_and_b32 v25, 0xffff0000, v12
    v_mul_f32 v26, s38, v24
    v_mul_f32 v27, s38, v25
    v_exp_f32 v26, v26
    v_exp_f32 v27, v27
    v_add_f32 v26, 1.0, v26
    v_add_f32 v27, 1.0, v27
    v_rcp_f32 v26, v26
    v_rcp_f32 v27, v27
    v_mul_f32 v24, v24, v26
    v_mul_f32 v25, v25, v27
    v_cvt_pk_bf16_f32 v24, v24, v24
    v_cvt_pk_bf16_f32 v25, v25, v25
    v_and_b32 v48, v24, v3
    v_and_b32 v49, v25, v3
    v_lshlrev_b32 v24, 16, v13
    v_and_b32 v25, 0xffff0000, v13
    v_mul_f32 v26, s38, v24
    v_mul_f32 v27, s38, v25
    v_exp_f32 v26, v26
    v_exp_f32 v27, v27
    v_add_f32 v26, 1.0, v26
    v_add_f32 v27, 1.0, v27
    v_rcp_f32 v26, v26
    v_rcp_f32 v27, v27
    v_mul_f32 v24, v24, v26
    v_mul_f32 v25, v25, v27
    v_cvt_pk_bf16_f32 v24, v24, v24
    v_cvt_pk_bf16_f32 v25, v25, v25
    v_and_b32 v50, v24, v3
    v_and_b32 v51, v25, v3
    v_lshlrev_b32 v24, 16, v14
    v_and_b32 v25, 0xffff0000, v14
    v_mul_f32 v26, s38, v24
    v_mul_f32 v27, s38, v25
    v_exp_f32 v26, v26
    v_exp_f32 v27, v27
    v_add_f32 v26, 1.0, v26
    v_add_f32 v27, 1.0, v27
    v_rcp_f32 v26, v26
    v_rcp_f32 v27, v27
    v_mul_f32 v24, v24, v26
    v_mul_f32 v25, v25, v27
    v_cvt_pk_bf16_f32 v24, v24, v24
    v_cvt_pk_bf16_f32 v25, v25, v25
    v_and_b32 v52, v24, v3
    v_and_b32 v53, v25, v3
    v_lshlrev_b32 v24, 16, v15
    v_and_b32 v25, 0xffff0000, v15
    v_mul_f32 v26, s38, v24
    v_mul_f32 v27, s38, v25
    v_exp_f32 v26, v26
    v_exp_f32 v27, v27
    v_add_f32 v26, 1.0, v26
    v_add_f32 v27, 1.0, v27
    v_rcp_f32 v26, v26
    v_rcp_f32 v27, v27
    v_mul_f32 v24, v24, v26
    v_mul_f32 v25, v25, v27
    v_cvt_pk_bf16_f32 v24, v24, v24
    v_cvt_pk_bf16_f32 v25, v25, v25
    v_and_b32 v54, v24, v3
    v_and_b32 v55, v25, v3
    v_lshlrev_b32 v24, 16, v16
    v_and_b32 v25, 0xffff0000, v16
    v_mul_f32 v26, s38, v24
    v_mul_f32 v27, s38, v25
    v_exp_f32 v26, v26
    v_exp_f32 v27, v27
    v_add_f32 v26, 1.0, v26
    v_add_f32 v27, 1.0, v27
    v_rcp_f32 v26, v26
    v_rcp_f32 v27, v27
    v_mul_f32 v24, v24, v26
    v_mul_f32 v25, v25, v27
    v_cvt_pk_bf16_f32 v24, v24, v24
    v_cvt_pk_bf16_f32 v25, v25, v25
    v_and_b32 v56, v24, v3
    v_and_b32 v57, v25, v3
    v_lshlrev_b32 v24, 16, v17
    v_and_b32 v25, 0xffff0000, v17
    v_mul_f32 v26, s38, v24
    v_mul_f32 v27, s38, v25
    v_exp_f32 v26, v26
    v_exp_f32 v27, v27
    v_add_f32 v26, 1.0, v26
    v_add_f32 v27, 1.0, v27
    v_rcp_f32 v26, v26
    v_rcp_f32 v27, v27
    v_mul_f32 v24, v24, v26
    v_mul_f32 v25, v25, v27
    v_cvt_pk_bf16_f32 v24, v24, v24
    v_cvt_pk_bf16_f32 v25, v25, v25
    v_and_b32 v58, v24, v3
    v_and_b32 v59, v25, v3
    v_lshlrev_b32 v24, 16, v18
    v_and_b32 v25, 0xffff0000, v18
    v_mul_f32 v26, s38, v24
    v_mul_f32 v27, s38, v25
    v_exp_f32 v26, v26
    v_exp_f32 v27, v27
    v_add_f32 v26, 1.0, v26
    v_add_f32 v27, 1.0, v27
    v_rcp_f32 v26, v26
    v_rcp_f32 v27, v27
    v_mul_f32 v24, v24, v26
    v_mul_f32 v25, v25, v27
    v_cvt_pk_bf16_f32 v24, v24, v24
    v_cvt_pk_bf16_f32 v25, v25, v25
    v_and_b32 v60, v24, v3
    v_and_b32 v61, v25, v3
    v_lshlrev_b32 v24, 16, v19
    v_and_b32 v25, 0xffff0000, v19
    v_mul_f32 v26, s38, v24
    v_mul_f32 v27, s38, v25
    v_exp_f32 v26, v26
    v_exp_f32 v27, v27
    v_add_f32 v26, 1.0, v26
    v_add_f32 v27, 1.0, v27
    v_rcp_f32 v26, v26
    v_rcp_f32 v27, v27
    v_mul_f32 v24, v24, v26
    v_mul_f32 v25, v25, v27
    v_cvt_pk_bf16_f32 v24, v24, v24
    v_cvt_pk_bf16_f32 v25, v25, v25
    v_and_b32 v62, v24, v3
    v_and_b32 v63, v25, v3
    v_lshlrev_b32 v24, 16, v20
    v_and_b32 v25, 0xffff0000, v20
    v_mul_f32 v26, s38, v24
    v_mul_f32 v27, s38, v25
    v_exp_f32 v26, v26
    v_exp_f32 v27, v27
    v_add_f32 v26, 1.0, v26
    v_add_f32 v27, 1.0, v27
    v_rcp_f32 v26, v26
    v_rcp_f32 v27, v27
    v_mul_f32 v24, v24, v26
    v_mul_f32 v25, v25, v27
    v_cvt_pk_bf16_f32 v24, v24, v24
    v_cvt_pk_bf16_f32 v25, v25, v25
    v_and_b32 v64, v24, v3
    v_and_b32 v65, v25, v3
    v_lshlrev_b32 v24, 16, v21
    v_and_b32 v25, 0xffff0000, v21
    v_mul_f32 v26, s38, v24
    v_mul_f32 v27, s38, v25
    v_exp_f32 v26, v26
    v_exp_f32 v27, v27
    v_add_f32 v26, 1.0, v26
    v_add_f32 v27, 1.0, v27
    v_rcp_f32 v26, v26
    v_rcp_f32 v27, v27
    v_mul_f32 v24, v24, v26
    v_mul_f32 v25, v25, v27
    v_cvt_pk_bf16_f32 v24, v24, v24
    v_cvt_pk_bf16_f32 v25, v25, v25
    v_and_b32 v66, v24, v3
    v_and_b32 v67, v25, v3
    v_lshlrev_b32 v24, 16, v22
    v_and_b32 v25, 0xffff0000, v22
    v_mul_f32 v26, s38, v24
    v_mul_f32 v27, s38, v25
    v_exp_f32 v26, v26
    v_exp_f32 v27, v27
    v_add_f32 v26, 1.0, v26
    v_add_f32 v27, 1.0, v27
    v_rcp_f32 v26, v26
    v_rcp_f32 v27, v27
    v_mul_f32 v24, v24, v26
    v_mul_f32 v25, v25, v27
    v_cvt_pk_bf16_f32 v24, v24, v24
    v_cvt_pk_bf16_f32 v25, v25, v25
    v_and_b32 v68, v24, v3
    v_and_b32 v69, v25, v3
    v_lshlrev_b32 v24, 16, v23
    v_and_b32 v25, 0xffff0000, v23
    v_mul_f32 v26, s38, v24
    v_mul_f32 v27, s38, v25
    v_exp_f32 v26, v26
    v_exp_f32 v27, v27
    v_add_f32 v26, 1.0, v26
    v_add_f32 v27, 1.0, v27
    v_rcp_f32 v26, v26
    v_rcp_f32 v27, v27
    v_mul_f32 v24, v24, v26
    v_mul_f32 v25, v25, v27
    v_cvt_pk_bf16_f32 v24, v24, v24
    v_cvt_pk_bf16_f32 v25, v25, v25
    v_and_b32 v70, v24, v3
    v_and_b32 v71, v25, v3
L_w17:
    s_sleep 1
    ds_read_b32 v6, v0 offset:5048
    s_sub_u32 s3, s3, 1
    s_cbranch_scc1 L_end
    s_waitcnt lgkmcnt(0)
    v_cmp_gt_u32 vcc, 4, v6
    s_cbranch_vccnz L_w17
    s_add_u32 s39, s48, 0
    buffer_load_dwordx2 v[104:105], v2, s[44:47], s39 offen nt
    s_add_u32 s39, s48, 6144
    buffer_load_dwordx2 v[108:109], v2, s[44:47], s39 offen nt
    s_add_u32 s39, s48, 12288
    buffer_load_dwordx2 v[106:107], v2, s[44:47], s39 offen nt
    s_add_u32 s39, s48, 18432
    buffer_load_dwordx2 v[110:111], v2, s[44:47], s39 offen nt
    s_add_u32 s39, s48, 24576
    buffer_load_dwordx2 v[112:113], v2, s[44:47], s39 offen nt
    s_add_u32 s39, s48, 30720
    buffer_load_dwordx2 v[116:117], v2, s[44:47], s39 offen nt
    s_add_u32 s39, s48, 36864
    buffer_load_dwordx2 v[114:115], v2, s[44:47], s39 offen nt
    s_add_u32 s39, s48, 43008
    buffer_load_dwordx2 v[118:119], v2, s[44:47], s39 offen nt
    s_add_u32 s39, s48, 49152
    buffer_load_dwordx2 v[120:121], v2, s[44:47], s39 offen nt
    s_add_u32 s39, s48, 55296
    buffer_load_dwordx2 v[124:125], v2, s[44:47], s39 offen nt
    s_add_u32 s39, s48, 61440
    buffer_load_dwordx2 v[122:123], v2, s[44:47], s39 offen nt
    s_add_u32 s39, s48, 67584
    buffer_load_dwordx2 v[126:127], v2, s[44:47], s39 offen nt
    s_add_u32 s39, s48, 73728
    buffer_load_dwordx2 v[128:129], v2, s[44:47], s39 offen nt
    s_add_u32 s39, s48, 79872
    buffer_load_dwordx2 v[132:133], v2, s[44:47], s39 offen nt
    s_add_u32 s39, s48, 86016
    buffer_load_dwordx2 v[130:131], v2, s[44:47], s39 offen nt
    s_add_u32 s39, s48, 92160
    buffer_load_dwordx2 v[134:135], v2, s[44:47], s39 offen nt
    s_add_u32 s39, s48, 98304
    buffer_load_dwordx2 v[136:137], v2, s[44:47], s39 offen nt
    s_add_u32 s39, s48, 104448
    buffer_load_dwordx2 v[140:141], v2, s[44:47], s39 offen nt
    s_add_u32 s39, s48, 110592
    buffer_load_dwordx2 v[138:139], v2, s[44:47], s39 offen nt
    s_add_u32 s39, s48, 116736
    buffer_load_dwordx2 v[142:143], v2, s[44:47], s39 offen nt
    s_add_u32 s39, s48, 122880
    buffer_load_dwordx2 v[144:145], v2, s[44:47], s39 offen nt
    s_add_u32 s39, s48, 129024
    buffer_load_dwordx2 v[148:149], v2, s[44:47], s39 offen nt
    s_add_u32 s39, s48, 135168
    buffer_load_dwordx2 v[146:147], v2, s[44:47], s39 offen nt
    s_add_u32 s39, s48, 141312
    buffer_load_dwordx2 v[150:151], v2, s[44:47], s39 offen nt
    s_add_u32 s39, s48, 147456
    buffer_load_dwordx2 v[152:153], v2, s[44:47], s39 offen nt
    s_add_u32 s39, s48, 153600
    buffer_load_dwordx2 v[156:157], v2, s[44:47], s39 offen nt
    s_add_u32 s39, s48, 159744
    buffer_load_dwordx2 v[154:155], v2, s[44:47], s39 offen nt
    s_add_u32 s39, s48, 165888
    buffer_load_dwordx2 v[158:159], v2, s[44:47], s39 offen nt
    s_add_u32 s39, s48, 172032
    buffer_load_dwordx2 v[160:161], v2, s[44:47], s39 offen nt
    s_add_u32 s39, s48, 178176
    buffer_load_dwordx2 v[164:165], v2, s[44:47], s39 offen nt
    s_add_u32 s39, s48, 184320
    buffer_load_dwordx2 v[162:163], v2, s[44:47], s39 offen nt
    s_add_u32 s39, s48, 190464
    buffer_load_dwordx2 v[166:167], v2, s[44:47], s39 offen nt
    s_waitcnt vmcnt(31)
    s_waitcnt vmcnt(0)
    v_mov_b32 v6, 1
    s_mov_b64 exec, 1
    ds_add_u32 v0, v6 offset:6060
    s_mov_b64 exec, -1
    v_swap_b32 v105, v108
    v_swap_b32 v107, v110
    v_swap_b32 v113, v116
    v_swap_b32 v115, v118
    v_swap_b32 v121, v124
    v_swap_b32 v123, v126
    v_swap_b32 v129, v132
    v_swap_b32 v131, v134
    v_swap_b32 v137, v140
    v_swap_b32 v139, v142
    v_swap_b32 v145, v148
    v_swap_b32 v147, v150
    v_swap_b32 v153, v156
    v_swap_b32 v155, v158
    v_swap_b32 v161, v164
    v_swap_b32 v163, v166
    v_mfma_f32_16x16x32_bf16 v[24:27], v[40:43], v[104:107], 0
    v_mfma_f32_16x16x32_bf16 v[28:31], v[40:43], v[108:111], 0
    v_mfma_f32_16x16x32_bf16 v[24:27], v[44:47], v[112:115], v[24:27]
    v_mfma_f32_16x16x32_bf16 v[28:31], v[44:47], v[116:119], v[28:31]
    v_mfma_f32_16x16x32_bf16 v[24:27], v[48:51], v[120:123], v[24:27]
    v_mfma_f32_16x16x32_bf16 v[28:31], v[48:51], v[124:127], v[28:31]
    v_mfma_f32_16x16x32_bf16 v[24:27], v[52:55], v[128:131], v[24:27]
    v_mfma_f32_16x16x32_bf16 v[28:31], v[52:55], v[132:135], v[28:31]
    v_mfma_f32_16x16x32_bf16 v[24:27], v[56:59], v[136:139], v[24:27]
    v_mfma_f32_16x16x32_bf16 v[28:31], v[56:59], v[140:143], v[28:31]
    v_mfma_f32_16x16x32_bf16 v[24:27], v[60:63], v[144:147], v[24:27]
    v_mfma_f32_16x16x32_bf16 v[28:31], v[60:63], v[148:151], v[28:31]
    v_mfma_f32_16x16x32_bf16 v[24:27], v[64:67], v[152:155], v[24:27]
    v_mfma_f32_16x16x32_bf16 v[28:31], v[64:67], v[156:159], v[28:31]
    v_mfma_f32_16x16x32_bf16 v[24:27], v[68:71], v[160:163], v[24:27]
    v_mfma_f32_16x16x32_bf16 v[28:31], v[68:71], v[164:167], v[28:31]
    s_nop 6
    v_cvt_pk_bf16_f32 v8, v24, v25
    v_cvt_pk_bf16_f32 v10, v26, v27
    v_cvt_pk_bf16_f32 v9, v28, v29
    v_cvt_pk_bf16_f32 v11, v30, v31
L_w18:
    s_sleep 1
    ds_read_b32 v6, v0 offset:5052
    s_sub_u32 s3, s3, 1
    s_cbranch_scc1 L_end
    s_waitcnt lgkmcnt(0)
    v_cmp_gt_u32 vcc, 1, v6
    s_cbranch_vccnz L_w18
    buffer_store_dwordx2 v[8:9], v4, s[40:43], s49 offen sc1
    buffer_store_dwordx2 v[10:11], v4, s[40:43], s49 offen offset:1024 sc1
    s_branch L_end
L_B_uv:
    s_mov_b32 s44, s12
    s_mov_b32 s45, s13
    s_mov_b32 s46, 4194304
    s_mov_b32 s47, 0x20000

    v_lshrrev_b32 v4, 4, v1
    v_and_b32 v5, 15, v1
    v_lshlrev_b32 v2, 14, v4
    v_lshl_add_u32 v2, v5, 3, v2
    s_lshl_b32 s48, s62, 18
    s_lshl1_add_u32 s38, s35, s33
    s_lshl_b32 s38, s38, 7
    s_add_u32 s48, s48, s38
    v_mul_u32_u24 v3, 528, v5
    v_lshl_add_u32 v3, v4, 5, v3
    v_add_u32 v3, 141312, v3
    v_lshlrev_b32 v4, 4, v1
    s_lshl2_add_u32 s49, s35, s62
    s_lshl1_add_u32 s49, s49, s33
    s_lshl_b32 s49, s49, 10
    s_add_u32 s49, s49, 1835008
L_w19:
    s_sleep 1
    ds_read_b32 v6, v0 offset:5048
    s_sub_u32 s3, s3, 1
    s_cbranch_scc1 L_end
    s_waitcnt lgkmcnt(0)
    v_cmp_gt_u32 vcc, 4, v6
    s_cbranch_vccnz L_w19
    s_add_u32 s39, s48, 0
    buffer_load_dwordx2 v[104:105], v2, s[44:47], s39 offen nt
    s_add_u32 s39, s48, 1048576
    buffer_load_dwordx2 v[108:109], v2, s[44:47], s39 offen nt
    s_add_u32 s39, s48, 131072
    buffer_load_dwordx2 v[106:107], v2, s[44:47], s39 offen nt
    s_add_u32 s39, s48, 1179648
    buffer_load_dwordx2 v[110:111], v2, s[44:47], s39 offen nt
    s_add_u32 s39, s48, 8192
    buffer_load_dwordx2 v[112:113], v2, s[44:47], s39 offen nt
    s_add_u32 s39, s48, 1056768
    buffer_load_dwordx2 v[116:117], v2, s[44:47], s39 offen nt
    s_add_u32 s39, s48, 139264
    buffer_load_dwordx2 v[114:115], v2, s[44:47], s39 offen nt
    s_add_u32 s39, s48, 1187840
    buffer_load_dwordx2 v[118:119], v2, s[44:47], s39 offen nt
    s_add_u32 s39, s48, 65536
    buffer_load_dwordx2 v[120:121], v2, s[44:47], s39 offen nt
    s_add_u32 s39, s48, 1114112
    buffer_load_dwordx2 v[124:125], v2, s[44:47], s39 offen nt
    s_add_u32 s39, s48, 196608
    buffer_load_dwordx2 v[122:123], v2, s[44:47], s39 offen nt
    s_add_u32 s39, s48, 1245184
    buffer_load_dwordx2 v[126:127], v2, s[44:47], s39 offen nt
    s_add_u32 s39, s48, 73728
    buffer_load_dwordx2 v[128:129], v2, s[44:47], s39 offen nt
    s_add_u32 s39, s48, 1122304
    buffer_load_dwordx2 v[132:133], v2, s[44:47], s39 offen nt
    s_add_u32 s39, s48, 204800
    buffer_load_dwordx2 v[130:131], v2, s[44:47], s39 offen nt
    s_add_u32 s39, s48, 1253376
    buffer_load_dwordx2 v[134:135], v2, s[44:47], s39 offen nt
    s_add_u32 s39, s48, 2097152
    buffer_load_dwordx2 v[136:137], v2, s[44:47], s39 offen nt
    s_add_u32 s39, s48, 3145728
    buffer_load_dwordx2 v[140:141], v2, s[44:47], s39 offen nt
    s_add_u32 s39, s48, 2228224
    buffer_load_dwordx2 v[138:139], v2, s[44:47], s39 offen nt
    s_add_u32 s39, s48, 3276800
    buffer_load_dwordx2 v[142:143], v2, s[44:47], s39 offen nt
    s_add_u32 s39, s48, 2105344
    buffer_load_dwordx2 v[144:145], v2, s[44:47], s39 offen nt
    s_add_u32 s39, s48, 3153920
    buffer_load_dwordx2 v[148:149], v2, s[44:47], s39 offen nt
    s_add_u32 s39, s48, 2236416
    buffer_load_dwordx2 v[146:147], v2, s[44:47], s39 offen nt
    s_add_u32 s39, s48, 3284992
    buffer_load_dwordx2 v[150:151], v2, s[44:47], s39 offen nt
    s_add_u32 s39, s48, 2162688
    buffer_load_dwordx2 v[152:153], v2, s[44:47], s39 offen nt
    s_add_u32 s39, s48, 3211264
    buffer_load_dwordx2 v[156:157], v2, s[44:47], s39 offen nt
    s_add_u32 s39, s48, 2293760
    buffer_load_dwordx2 v[154:155], v2, s[44:47], s39 offen nt
    s_add_u32 s39, s48, 3342336
    buffer_load_dwordx2 v[158:159], v2, s[44:47], s39 offen nt
    s_add_u32 s39, s48, 2170880
    buffer_load_dwordx2 v[160:161], v2, s[44:47], s39 offen nt
    s_add_u32 s39, s48, 3219456
    buffer_load_dwordx2 v[164:165], v2, s[44:47], s39 offen nt
    s_add_u32 s39, s48, 2301952
    buffer_load_dwordx2 v[162:163], v2, s[44:47], s39 offen nt
    s_add_u32 s39, s48, 3350528
    buffer_load_dwordx2 v[166:167], v2, s[44:47], s39 offen nt
    s_waitcnt vmcnt(31)
    s_waitcnt vmcnt(0)
    v_mov_b32 v6, 1
    s_mov_b64 exec, 1
    ds_add_u32 v0, v6 offset:6060
    s_mov_b64 exec, -1
    v_swap_b32 v105, v108
    v_swap_b32 v107, v110
    v_swap_b32 v113, v116
    v_swap_b32 v115, v118
    v_swap_b32 v121, v124
    v_swap_b32 v123, v126
    v_swap_b32 v129, v132
    v_swap_b32 v131, v134
    v_swap_b32 v137, v140
    v_swap_b32 v139, v142
    v_swap_b32 v145, v148
    v_swap_b32 v147, v150
    v_swap_b32 v153, v156
    v_swap_b32 v155, v158
    v_swap_b32 v161, v164
    v_swap_b32 v163, v166
L_w20:
    s_sleep 1
    ds_read_b32 v6, v0 offset:6048
    s_sub_u32 s3, s3, 1
    s_cbranch_scc1 L_end
    s_waitcnt lgkmcnt(0)
    v_cmp_gt_u32 vcc, 1, v6
    s_cbranch_vccnz L_w20
    s_setprio 2
L_w21:
    ds_read_b32 v6, v0 offset:6048
    s_sub_u32 s3, s3, 1
    s_cbranch_scc1 L_end
    s_waitcnt lgkmcnt(0)
    v_cmp_gt_u32 vcc, 4, v6
    s_cbranch_vccnz L_w21
    ds_read_b128 v[40:43], v3 offset:0
    ds_read_b128 v[44:47], v3 offset:16
    ds_read_b128 v[48:51], v3 offset:128
    ds_read_b128 v[52:55], v3 offset:144
    ds_read_b128 v[56:59], v3 offset:256
    ds_read_b128 v[60:63], v3 offset:272
    ds_read_b128 v[64:67], v3 offset:384
    ds_read_b128 v[68:71], v3 offset:400
    s_waitcnt lgkmcnt(7)
    v_mfma_f32_16x16x32_bf16 v[24:27], v[40:43], v[104:107], 0
    v_mfma_f32_16x16x32_bf16 v[28:31], v[40:43], v[108:111], 0
    s_waitcnt lgkmcnt(6)
    v_mfma_f32_16x16x32_bf16 v[24:27], v[44:47], v[112:115], v[24:27]
    v_mfma_f32_16x16x32_bf16 v[28:31], v[44:47], v[116:119], v[28:31]
    s_waitcnt lgkmcnt(5)
    v_mfma_f32_16x16x32_bf16 v[24:27], v[48:51], v[120:123], v[24:27]
    v_mfma_f32_16x16x32_bf16 v[28:31], v[48:51], v[124:127], v[28:31]
    s_waitcnt lgkmcnt(4)
    v_mfma_f32_16x16x32_bf16 v[24:27], v[52:55], v[128:131], v[24:27]
    v_mfma_f32_16x16x32_bf16 v[28:31], v[52:55], v[132:135], v[28:31]
    s_waitcnt lgkmcnt(3)
    v_mfma_f32_16x16x32_bf16 v[24:27], v[56:59], v[136:139], v[24:27]
    v_mfma_f32_16x16x32_bf16 v[28:31], v[56:59], v[140:143], v[28:31]
    s_waitcnt lgkmcnt(2)
    v_mfma_f32_16x16x32_bf16 v[24:27], v[60:63], v[144:147], v[24:27]
    v_mfma_f32_16x16x32_bf16 v[28:31], v[60:63], v[148:151], v[28:31]
    s_waitcnt lgkmcnt(1)
    v_mfma_f32_16x16x32_bf16 v[24:27], v[64:67], v[152:155], v[24:27]
    v_mfma_f32_16x16x32_bf16 v[28:31], v[64:67], v[156:159], v[28:31]
    s_waitcnt lgkmcnt(0)
    v_mfma_f32_16x16x32_bf16 v[24:27], v[68:71], v[160:163], v[24:27]
    v_mfma_f32_16x16x32_bf16 v[28:31], v[68:71], v[164:167], v[28:31]
    s_nop 6
    v_cvt_pk_bf16_f32 v8, v24, v25
    v_cvt_pk_bf16_f32 v10, v26, v27
    v_cvt_pk_bf16_f32 v9, v28, v29
    v_cvt_pk_bf16_f32 v11, v30, v31
    buffer_store_dwordx4 v[8:11], v4, s[40:43], s49 offen sc1
    s_waitcnt vmcnt(0)
    v_mov_b32 v6, 1
    s_mov_b64 exec, 1
    ds_add_u32 v0, v6 offset:6052
    s_mov_b64 exec, -1
    s_branch L_end
L_Be:
    s_waitcnt lgkmcnt(0)
    s_cmp_lg_u32 s33, 0
    s_cbranch_scc1 L_B_t1
    v_lshrrev_b32 v2, 1, v1
    v_and_b32 v3, 1, v1
    v_and_b32 v4, 24, v2
    v_and_b32 v2, 7, v2
    v_lshl_add_u32 v2, v4, 2, v2
    v_lshl_add_u32 v2, v2, 6, v3
    s_and_b32 s38, s34, 3
    s_lshl_b32 s38, s38, 12
    s_add_u32 s38, s38, s35
    s_lshl_b32 s38, s38, 8
    v_lshl_add_u32 v2, v2, 7, s38
    global_load_dword v166, v2, s[8:9]
L_B_t1:
    s_mov_b32 s40, s30
    s_mov_b32 s41, s31
    s_mov_b32 s42, 16777216
    s_mov_b32 s43, 0x20000

    s_mov_b32 s3, 0x400000
    v_mov_b32 v0, 156256
    s_and_b32 s62, s34, 3
    s_lshl2_add_u32 s97, s62, s37
    s_lshl4_add_u32 s61, s36, s97

    s_barrier
    s_cmp_eq_u32 s33, 0
    s_cbranch_scc1 L_B_nt
    v_lshrrev_b32 v2, 1, v1
    v_and_b32 v3, 1, v1
    s_lshl2_add_u32 s38, s33, s34
    s_sub_u32 s38, s38, 4
    v_lshl_add_u32 v2, v2, 6, v3
    s_lshl_b32 s38, s38, 10
    s_add_u32 s38, s38, s35
    s_lshl_b32 s38, s38, 8
    v_lshl_add_u32 v2, v2, 7, s38
    s_mov_b64 exec, 1
    global_load_dword v166, v2, s[10:11]
    s_mov_b64 exec, -1
    s_waitcnt vmcnt(0)
    global_load_dword v166, v2, s[10:11]
    s_mov_b64 exec, -1
    v_mov_b32 v3, 1
    s_mov_b64 exec, 1
    ds_add_u32 v0, v3 offset:4
    s_mov_b64 exec, -1
L_B_nt:

    v_and_b32 v5, 31, v1
    v_lshrrev_b32 v7, 5, v1
    v_bfe_u32 v2, v5, 1, 1
    v_lshlrev_b32 v2, 2, v2
    v_bfe_u32 v3, v5, 2, 2
    v_or_b32 v2, v2, v3
    v_xor_b32 v2, v2, v7
    v_lshlrev_b32 v2, 4, v2
    v_lshl_add_u32 v2, v5, 7, v2
    s_lshl_b32 s38, s33, 12
    v_add_u32 v2, s38, v2
    v_mov_b32 v8, v2
    v_xor_b32 v9, 32, v2
    v_xor_b32 v10, 64, v2
    v_xor_b32 v11, 0x60, v2
    v_mul_u32_u24 v4, 1008, v5
    v_lshl_add_u32 v4, v7, 4, v4
    v_add_u32 v4, 131072, v4
    v_lshlrev_b32 v12, 10, v5
    v_lshl_add_u32 v7, v7, 4, v12
    v_lshl_add_u32 v5, v5, 4, v0
    s_lshl_b32 s53, s33, 2
    v_add_u32 v6, s53, v0
    s_lshl_b32 s50, s36, 15
    s_add_u32 s50, s50, 65536
    s_lshl_b32 s51, s33, 13
    s_add_u32 s51, s51, s50
    s_mul_i32 s49, s33, 8064
    s_add_u32 s49, s49, 131072
    s_mov_b32 s52, 0x3e0293ee
    s_mov_b32 s56, -1
    s_mov_b32 s57, 0x3fffffff
L_w22:
    s_sleep 1
    ds_read_b32 v3, v6 offset:4032
    s_sub_u32 s3, s3, 1
    s_cbranch_scc1 L_end
    s_waitcnt lgkmcnt(0)
    v_cmp_gt_u32 vcc, 2, v3
    s_cbranch_vccnz L_w22
    ds_read_b128 v[40:43], v8 offset:0
    ds_read_b128 v[44:47], v9 offset:0
    ds_read_b128 v[48:51], v10 offset:0
    ds_read_b128 v[52:55], v11 offset:0
    ds_read_b128 v[56:59], v8 offset:16384
    ds_read_b128 v[60:63], v9 offset:16384
    ds_read_b128 v[64:67], v10 offset:16384
    ds_read_b128 v[68:71], v11 offset:16384
    v_mov_b32 v3, 1
    s_mov_b64 exec, 1
    ds_add_u32 v0, v3 offset:3024
    s_mov_b64 exec, -1
L_w23:
    s_sleep 1
    ds_read_b32 v3, v6 offset:4032
    s_sub_u32 s3, s3, 1
    s_cbranch_scc1 L_end
    s_waitcnt lgkmcnt(0)
    v_cmp_gt_u32 vcc, 4, v3
    s_cbranch_vccnz L_w23
    ds_read_b128 v[72:75], v8 offset:32768
    ds_read_b128 v[76:79], v9 offset:32768
    ds_read_b128 v[80:83], v10 offset:32768
    ds_read_b128 v[84:87], v11 offset:32768
    ds_read_b128 v[88:91], v8 offset:49152
    ds_read_b128 v[92:95], v9 offset:49152
    ds_read_b128 v[96:99], v10 offset:49152
    ds_read_b128 v[100:103], v11 offset:49152
    v_mov_b32 v3, 1
    s_mov_b64 exec, 1
    ds_add_u32 v0, v3 offset:3028
    s_mov_b64 exec, -1
    v_mov_b32 v3, 0
    v_mov_b32 v13, 0
    v_mov_b32 v14, 0
    s_waitcnt vmcnt(0)
L_B_f2:
    global_load_dword v12, v3, s[28:29] offset:128 sc1
    s_sub_u32 s3, s3, 1
    s_cbranch_scc1 L_end
    s_sleep 4
    s_waitcnt vmcnt(2)
    v_cmp_ne_u32 vcc, 0, v13
    s_cbranch_vccnz L_B_f2d
    global_load_dword v13, v3, s[28:29] offset:128 sc1
    s_sub_u32 s3, s3, 1
    s_cbranch_scc1 L_end
    s_sleep 4
    s_waitcnt vmcnt(2)
    v_cmp_ne_u32 vcc, 0, v14
    s_cbranch_vccnz L_B_f2d
    global_load_dword v14, v3, s[28:29] offset:128 sc1
    s_sub_u32 s3, s3, 1
    s_cbranch_scc1 L_end
    s_sleep 4
    s_waitcnt vmcnt(2)
    v_cmp_ne_u32 vcc, 0, v12
    s_cbranch_vccnz L_B_f2d
    s_branch L_B_f2
L_B_f2d:
    s_setprio 3
    v_lshlrev_b32 v3, 4, v1
    s_mov_b32 m0, s49
    s_mov_b32 s38, s51
    s_mov_b64 exec, s[56:57]
    buffer_load_dwordx4 v3, s[40:43], s38 offen sc1 lds
    s_add_u32 m0, m0, 1008
    s_add_u32 s38, s38, 1024
    buffer_load_dwordx4 v3, s[40:43], s38 offen sc1 lds
    s_add_u32 m0, m0, 1008
    s_add_u32 s38, s38, 1024
    buffer_load_dwordx4 v3, s[40:43], s38 offen sc1 lds
    s_add_u32 m0, m0, 1008
    s_add_u32 s38, s38, 1024
    buffer_load_dwordx4 v3, s[40:43], s38 offen sc1 lds
    s_add_u32 m0, m0, 1008
    s_add_u32 s38, s38, 1024
    buffer_load_dwordx4 v3, s[40:43], s38 offen sc1 lds
    s_add_u32 m0, m0, 1008
    s_add_u32 s38, s38, 1024
    buffer_load_dwordx4 v3, s[40:43], s38 offen sc1 lds
    s_add_u32 m0, m0, 1008
    s_add_u32 s38, s38, 1024
    buffer_load_dwordx4 v3, s[40:43], s38 offen sc1 lds
    s_add_u32 m0, m0, 1008
    s_add_u32 s38, s38, 1024
    buffer_load_dwordx4 v3, s[40:43], s38 offen sc1 lds
    s_mov_b64 exec, -1
    buffer_load_dwordx4 v[24:27], v7, s[40:43], s50 offen offset:992 sc1
    v_mov_b32 v3, 1
    s_mov_b64 exec, 1
    ds_add_u32 v0, v3 offset:2028
    s_mov_b64 exec, -1
L_w24:
    s_sleep 1
    ds_read_b32 v3, v6 offset:4032
    s_sub_u32 s3, s3, 1
    s_cbranch_scc1 L_end
    s_waitcnt lgkmcnt(0)
    v_cmp_gt_u32 vcc, 6, v3
    s_cbranch_vccnz L_w24
    v_add_u32 v8, 0x10000, v8
    v_add_u32 v9, 0x10000, v9
    v_add_u32 v10, 0x10000, v10
    v_add_u32 v11, 0x10000, v11
    ds_read_b128 v[104:107], v8 offset:0
    ds_read_b128 v[108:111], v9 offset:0
    ds_read_b128 v[112:115], v10 offset:0
    ds_read_b128 v[116:119], v11 offset:0
    ds_read_b128 v[120:123], v8 offset:16384
    ds_read_b128 v[124:127], v9 offset:16384
    ds_read_b128 v[128:131], v10 offset:16384
    ds_read_b128 v[132:135], v11 offset:16384
    v_mov_b32 v3, 1
    s_mov_b64 exec, 1
    ds_add_u32 v0, v3 offset:3032
    s_mov_b64 exec, -1
L_w25:
    s_sleep 1
    ds_read_b32 v3, v6 offset:4032
    s_sub_u32 s3, s3, 1
    s_cbranch_scc1 L_end
    s_waitcnt lgkmcnt(0)
    v_cmp_gt_u32 vcc, 8, v3
    s_cbranch_vccnz L_w25
    ds_read_b128 v[136:139], v8 offset:32768
    ds_read_b128 v[140:143], v9 offset:32768
    ds_read_b128 v[144:147], v10 offset:32768
    ds_read_b128 v[148:151], v11 offset:32768
    ds_read_b128 v[152:155], v8 offset:49152
    ds_read_b128 v[156:159], v9 offset:49152
    ds_read_b128 v[160:163], v10 offset:49152
    ds_read_b128 v[164:167], v11 offset:49152
    v_mov_b32 v3, 1
    s_mov_b64 exec, 1
    ds_add_u32 v0, v3 offset:3036
    s_mov_b64 exec, -1
    s_branch L_B_qv
L_B_qr:
    v_lshlrev_b32 v3, 4, v1
    s_mov_b32 m0, s49
    s_mov_b32 s38, s51
    s_mov_b64 exec, s[56:57]
    buffer_load_dwordx4 v3, s[40:43], s38 offen sc1 lds
    s_add_u32 m0, m0, 1008
    s_add_u32 s38, s38, 1024
    buffer_load_dwordx4 v3, s[40:43], s38 offen sc1 lds
    s_add_u32 m0, m0, 1008
    s_add_u32 s38, s38, 1024
    buffer_load_dwordx4 v3, s[40:43], s38 offen sc1 lds
    s_add_u32 m0, m0, 1008
    s_add_u32 s38, s38, 1024
    buffer_load_dwordx4 v3, s[40:43], s38 offen sc1 lds
    s_add_u32 m0, m0, 1008
    s_add_u32 s38, s38, 1024
    buffer_load_dwordx4 v3, s[40:43], s38 offen sc1 lds
    s_add_u32 m0, m0, 1008
    s_add_u32 s38, s38, 1024
    buffer_load_dwordx4 v3, s[40:43], s38 offen sc1 lds
    s_add_u32 m0, m0, 1008
    s_add_u32 s38, s38, 1024
    buffer_load_dwordx4 v3, s[40:43], s38 offen sc1 lds
    s_add_u32 m0, m0, 1008
    s_add_u32 s38, s38, 1024
    buffer_load_dwordx4 v3, s[40:43], s38 offen sc1 lds
    s_mov_b64 exec, -1
    buffer_load_dwordx4 v[24:27], v7, s[40:43], s50 offen offset:992 sc1
    s_sub_u32 s3, s3, 1
    s_cbranch_scc1 L_end
L_B_qv:
    v_lshl_add_u32 v3, v1, 4, s49
    s_waitcnt vmcnt(0) lgkmcnt(0)
    v_max3_u32 v6, v24, v25, v26
    v_max_u32 v6, v6, v27
    s_mov_b64 exec, s[56:57]
    ds_read_b128 v[8:11], v3 offset:0
    ds_read_b128 v[12:15], v3 offset:1008
    ds_read_b128 v[16:19], v3 offset:2016
    ds_read_b128 v[20:23], v3 offset:3024
    ds_read_b128 v[28:31], v3 offset:4032
    ds_read_b128 v[32:35], v3 offset:5040
    ds_read_b128 v[36:39], v3 offset:6048
    s_waitcnt lgkmcnt(6)
    v_max3_u32 v6, v6, v8, v9
    v_max3_u32 v6, v6, v10, v11
    ds_read_b128 v[8:11], v3 offset:7056
    s_waitcnt lgkmcnt(6)
    v_max3_u32 v6, v6, v12, v13
    v_max3_u32 v6, v6, v14, v15
    s_waitcnt lgkmcnt(5)
    v_max3_u32 v6, v6, v16, v17
    v_max3_u32 v6, v6, v18, v19
    s_waitcnt lgkmcnt(4)
    v_max3_u32 v6, v6, v20, v21
    v_max3_u32 v6, v6, v22, v23
    s_waitcnt lgkmcnt(3)
    v_max3_u32 v6, v6, v28, v29
    v_max3_u32 v6, v6, v30, v31
    s_waitcnt lgkmcnt(2)
    v_max3_u32 v6, v6, v32, v33
    v_max3_u32 v6, v6, v34, v35
    s_waitcnt lgkmcnt(1)
    v_max3_u32 v6, v6, v36, v37
    v_max3_u32 v6, v6, v38, v39
    s_waitcnt lgkmcnt(0)
    v_max3_u32 v6, v6, v8, v9
    v_max3_u32 v6, v6, v10, v11
    s_mov_b64 exec, -1
    v_cmp_eq_u32 vcc, -1, v6
    s_cbranch_vccnz L_B_qr
    v_mov_b32 v3, 1
    s_mov_b64 exec, 1
    ds_add_u32 v0, v3 offset:1008
    s_mov_b64 exec, -1
    s_setprio 2
L_w26:
    ds_read_b32 v3, v0 offset:1008
    s_sub_u32 s3, s3, 1
    s_cbranch_scc1 L_end
    s_waitcnt lgkmcnt(0)
    v_cmp_gt_u32 vcc, 4, v3
    s_cbranch_vccnz L_w26
    s_xor_b32 s38, s2, 40
    s_or_b32 s38, s38, s33
    s_cbranch_scc1 L_B_n3
    v_mov_b32 v3, 4
    s_mov_b64 exec, 1
    global_store_dword v3, v3, s[28:29] sc1
    s_mov_b64 exec, -1
L_B_n3:
    ds_read_b128 v[28:31], v4 offset:0
    ds_read_b128 v[32:35], v4 offset:32
    ds_read_b128 v[36:39], v4 offset:64
    s_waitcnt lgkmcnt(2)
    v_mfma_f32_32x32x16_bf16 v[8:23], v[40:43], v[28:31], 0
    ds_read_b128 v[40:43], v4 offset:96
    s_waitcnt lgkmcnt(2)
    v_mfma_f32_32x32x16_bf16 v[8:23], v[44:47], v[32:35], v[8:23]
    ds_read_b128 v[44:47], v4 offset:128
    s_waitcnt lgkmcnt(2)
    v_mfma_f32_32x32x16_bf16 v[8:23], v[48:51], v[36:39], v[8:23]
    ds_read_b128 v[48:51], v4 offset:160
    s_waitcnt lgkmcnt(2)
    v_mfma_f32_32x32x16_bf16 v[8:23], v[52:55], v[40:43], v[8:23]
    ds_read_b128 v[52:55], v4 offset:192
    s_waitcnt lgkmcnt(2)
    v_mfma_f32_32x32x16_bf16 v[8:23], v[56:59], v[44:47], v[8:23]
    ds_read_b128 v[56:59], v4 offset:224
    s_waitcnt lgkmcnt(2)
    v_mfma_f32_32x32x16_bf16 v[8:23], v[60:63], v[48:51], v[8:23]
    ds_read_b128 v[60:63], v4 offset:256
    s_waitcnt lgkmcnt(2)
    v_mfma_f32_32x32x16_bf16 v[8:23], v[64:67], v[52:55], v[8:23]
    ds_read_b128 v[64:67], v4 offset:288
    s_waitcnt lgkmcnt(2)
    v_mfma_f32_32x32x16_bf16 v[8:23], v[68:71], v[56:59], v[8:23]
    ds_read_b128 v[68:71], v4 offset:320
    s_waitcnt lgkmcnt(2)
    v_mfma_f32_32x32x16_bf16 v[8:23], v[72:75], v[60:63], v[8:23]
    ds_read_b128 v[72:75], v4 offset:352
    s_waitcnt lgkmcnt(2)
    v_mfma_f32_32x32x16_bf16 v[8:23], v[76:79], v[64:67], v[8:23]
    ds_read_b128 v[76:79], v4 offset:384
    s_waitcnt lgkmcnt(2)
    v_mfma_f32_32x32x16_bf16 v[8:23], v[80:83], v[68:71], v[8:23]
    ds_read_b128 v[80:83], v4 offset:416
    s_waitcnt lgkmcnt(2)
    v_mfma_f32_32x32x16_bf16 v[8:23], v[84:87], v[72:75], v[8:23]
    ds_read_b128 v[84:87], v4 offset:448
    s_waitcnt lgkmcnt(2)
    v_mfma_f32_32x32x16_bf16 v[8:23], v[88:91], v[76:79], v[8:23]
    ds_read_b128 v[88:91], v4 offset:480
    s_waitcnt lgkmcnt(2)
    v_mfma_f32_32x32x16_bf16 v[8:23], v[92:95], v[80:83], v[8:23]
    ds_read_b128 v[92:95], v4 offset:512
    s_waitcnt lgkmcnt(2)
    v_mfma_f32_32x32x16_bf16 v[8:23], v[96:99], v[84:87], v[8:23]
    ds_read_b128 v[96:99], v4 offset:544
    s_waitcnt lgkmcnt(2)
    v_mfma_f32_32x32x16_bf16 v[8:23], v[100:103], v[88:91], v[8:23]
    ds_read_b128 v[100:103], v4 offset:576
    s_waitcnt lgkmcnt(2)
    v_mfma_f32_32x32x16_bf16 v[8:23], v[104:107], v[92:95], v[8:23]
    ds_read_b128 v[104:107], v4 offset:608
    s_waitcnt lgkmcnt(2)
    v_mfma_f32_32x32x16_bf16 v[8:23], v[108:111], v[96:99], v[8:23]
    ds_read_b128 v[108:111], v4 offset:640
    s_waitcnt lgkmcnt(2)
    v_mfma_f32_32x32x16_bf16 v[8:23], v[112:115], v[100:103], v[8:23]
    ds_read_b128 v[112:115], v4 offset:672
    s_waitcnt lgkmcnt(2)
    v_mfma_f32_32x32x16_bf16 v[8:23], v[116:119], v[104:107], v[8:23]
    ds_read_b128 v[116:119], v4 offset:704
    s_waitcnt lgkmcnt(2)
    v_mfma_f32_32x32x16_bf16 v[8:23], v[120:123], v[108:111], v[8:23]
    ds_read_b128 v[120:123], v4 offset:736
    s_waitcnt lgkmcnt(2)
    v_mfma_f32_32x32x16_bf16 v[8:23], v[124:127], v[112:115], v[8:23]
    ds_read_b128 v[124:127], v4 offset:768
    s_waitcnt lgkmcnt(2)
    v_mfma_f32_32x32x16_bf16 v[8:23], v[128:131], v[116:119], v[8:23]
    ds_read_b128 v[128:131], v4 offset:800
    s_waitcnt lgkmcnt(2)
    v_mfma_f32_32x32x16_bf16 v[8:23], v[132:135], v[120:123], v[8:23]
    ds_read_b128 v[132:135], v4 offset:832
    s_waitcnt lgkmcnt(2)
    v_mfma_f32_32x32x16_bf16 v[8:23], v[136:139], v[124:127], v[8:23]
    ds_read_b128 v[136:139], v4 offset:864
    s_waitcnt lgkmcnt(2)
    v_mfma_f32_32x32x16_bf16 v[8:23], v[140:143], v[128:131], v[8:23]
    ds_read_b128 v[140:143], v4 offset:896
    s_waitcnt lgkmcnt(2)
    v_mfma_f32_32x32x16_bf16 v[8:23], v[144:147], v[132:135], v[8:23]
    ds_read_b128 v[144:147], v4 offset:928
    s_waitcnt lgkmcnt(2)
    v_mfma_f32_32x32x16_bf16 v[8:23], v[148:151], v[136:139], v[8:23]
    ds_read_b128 v[148:151], v4 offset:960
    s_waitcnt lgkmcnt(2)
    v_mfma_f32_32x32x16_bf16 v[8:23], v[152:155], v[140:143], v[8:23]
    s_waitcnt lgkmcnt(1)
    v_mfma_f32_32x32x16_bf16 v[8:23], v[156:159], v[144:147], v[8:23]
    s_waitcnt lgkmcnt(0)
    v_mfma_f32_32x32x16_bf16 v[8:23], v[160:163], v[148:151], v[8:23]
    v_mfma_f32_32x32x16_bf16 v[8:23], v[164:167], v[24:27], v[8:23]
    v_add_u32 v4, s53, v0
    v_add_u32 v166, s53, v5
    s_lshl_b32 s38, s33, 11
    s_add_u32 s38, s38, 131072
    v_lshl_add_u32 v167, v1, 4, s38
    s_nop 6
    v_max3_f32 v164, v8, v9, v10
    v_max3_f32 v165, v11, v12, v13
    v_max3_f32 v164, v164, v14, v15
    v_max3_f32 v165, v165, v16, v17
    v_max3_f32 v164, v164, v18, v19
    v_max3_f32 v165, v165, v20, v21
    v_max3_f32 v164, v164, v22, v23
    v_max_f32 v164, v164, v165
    v_mov_b32 v165, v164
    s_nop 1
    v_permlane32_swap_b32 v164, v165
    v_max_f32 v164, v164, v165
    ds_write_b32 v166, v164 offset:7072
L_B_mx0:
    ds_read_b128 v[160:163], v5 offset:7072
    s_sub_u32 s3, s3, 1
    s_cbranch_scc1 L_end
    s_waitcnt lgkmcnt(0)
    v_max3_u32 v164, v160, v161, v162
    v_max_u32 v164, v164, v163
    v_cmp_eq_u32 vcc, -1, v164
    s_cbranch_vccnz L_B_mx0
    v_max3_f32 v164, v160, v161, v162
    v_max_f32 v164, v164, v163
    v_mul_f32 v6, s52, v164
    v_add_u32 v5, -8800, v5
    v_add_u32 v166, s53, v5
    v_mov_b32 v165, -1
    ds_write_b32 v166, v165
    v_fma_f32 v8, v8, s52, -v6
    v_fma_f32 v9, v9, s52, -v6
    v_fma_f32 v10, v10, s52, -v6
    v_fma_f32 v11, v11, s52, -v6
    v_fma_f32 v12, v12, s52, -v6
    v_fma_f32 v13, v13, s52, -v6
    v_fma_f32 v14, v14, s52, -v6
    v_fma_f32 v15, v15, s52, -v6
    v_exp_f32 v8, v8
    v_exp_f32 v9, v9
    v_exp_f32 v10, v10
    v_exp_f32 v11, v11
    v_exp_f32 v12, v12
    v_exp_f32 v13, v13
    v_exp_f32 v14, v14
    v_exp_f32 v15, v15
    v_cvt_pk_bf16_f32 v152, v8, v9
    v_cvt_pk_bf16_f32 v153, v10, v11
    v_cvt_pk_bf16_f32 v154, v12, v13
    v_cvt_pk_bf16_f32 v155, v14, v15
    ds_write_b128 v167, v[152:155] offset:0
    v_fma_f32 v16, v16, s52, -v6
    v_fma_f32 v17, v17, s52, -v6
    v_fma_f32 v18, v18, s52, -v6
    v_fma_f32 v19, v19, s52, -v6
    v_fma_f32 v20, v20, s52, -v6
    v_fma_f32 v21, v21, s52, -v6
    v_fma_f32 v22, v22, s52, -v6
    v_fma_f32 v23, v23, s52, -v6
    v_exp_f32 v16, v16
    v_exp_f32 v17, v17
    v_exp_f32 v18, v18
    v_exp_f32 v19, v19
    v_exp_f32 v20, v20
    v_exp_f32 v21, v21
    v_exp_f32 v22, v22
    v_exp_f32 v23, v23
    v_cvt_pk_bf16_f32 v156, v16, v17
    v_cvt_pk_bf16_f32 v157, v18, v19
    v_cvt_pk_bf16_f32 v158, v20, v21
    v_cvt_pk_bf16_f32 v159, v22, v23
    ds_write_b128 v167, v[156:159] offset:1024
    v_mov_b32 v164, 1
    s_mov_b64 exec, 1
    ds_add_u32 v0, v164 offset:1016
    s_mov_b64 exec, -1
    v_pk_add_f32 v[8:9], v[8:9], v[16:17]
    v_pk_add_f32 v[10:11], v[10:11], v[18:19]
    v_pk_add_f32 v[12:13], v[12:13], v[20:21]
    v_pk_add_f32 v[14:15], v[14:15], v[22:23]
    v_pk_add_f32 v[8:9], v[8:9], v[12:13]
    v_pk_add_f32 v[10:11], v[10:11], v[14:15]
    v_pk_add_f32 v[8:9], v[8:9], v[10:11]
    v_add_f32 v7, v8, v9
L_w27:
    ds_read_b32 v3, v0 offset:1016
    s_sub_u32 s3, s3, 1
    s_cbranch_scc1 L_end
    s_waitcnt lgkmcnt(0)
    v_cmp_gt_u32 vcc, 4, v3
    s_cbranch_vccnz L_w27
L_w28:
    ds_read_b32 v3, v4 offset:4032
    s_sub_u32 s3, s3, 1
    s_cbranch_scc1 L_end
    s_waitcnt lgkmcnt(0)
    v_cmp_gt_u32 vcc, 10, v3
    s_cbranch_vccnz L_w28
    ds_read_b128 v[152:155], v2 offset:0
    v_xor_b32 v3, 32, v2
    ds_read_b128 v[156:159], v3 offset:0
    v_xor_b32 v3, 64, v2
    ds_read_b128 v[160:163], v3 offset:0
    v_xor_b32 v3, 96, v2
    ds_read_b128 v[164:167], v3 offset:0
    s_waitcnt lgkmcnt(3)
    v_mfma_f32_32x32x16_bf16 v[8:23], v[152:155], v[28:31], 0
    ds_read_b128 v[152:155], v2 offset:16384
    s_waitcnt lgkmcnt(3)
    v_mfma_f32_32x32x16_bf16 v[8:23], v[156:159], v[32:35], v[8:23]
    v_xor_b32 v3, 32, v2
    ds_read_b128 v[156:159], v3 offset:16384
    s_waitcnt lgkmcnt(3)
    v_mfma_f32_32x32x16_bf16 v[8:23], v[160:163], v[36:39], v[8:23]
    v_xor_b32 v3, 64, v2
    ds_read_b128 v[160:163], v3 offset:16384
    s_waitcnt lgkmcnt(3)
    v_mfma_f32_32x32x16_bf16 v[8:23], v[164:167], v[40:43], v[8:23]
    v_xor_b32 v3, 96, v2
    ds_read_b128 v[164:167], v3 offset:16384
    s_waitcnt lgkmcnt(3)
    v_mfma_f32_32x32x16_bf16 v[8:23], v[152:155], v[44:47], v[8:23]
L_w29:
    ds_read_b32 v3, v4 offset:4032
    s_sub_u32 s3, s3, 1
    s_cbranch_scc1 L_end
    s_waitcnt lgkmcnt(0)
    v_cmp_gt_u32 vcc, 12, v3
    s_cbranch_vccnz L_w29
    ds_read_b128 v[152:155], v2 offset:32768
    s_waitcnt lgkmcnt(3)
    v_mfma_f32_32x32x16_bf16 v[8:23], v[156:159], v[48:51], v[8:23]
    v_xor_b32 v3, 32, v2
    ds_read_b128 v[156:159], v3 offset:32768
    s_waitcnt lgkmcnt(3)
    v_mfma_f32_32x32x16_bf16 v[8:23], v[160:163], v[52:55], v[8:23]
    v_xor_b32 v3, 64, v2
    ds_read_b128 v[160:163], v3 offset:32768
    s_waitcnt lgkmcnt(3)
    v_mfma_f32_32x32x16_bf16 v[8:23], v[164:167], v[56:59], v[8:23]
    v_xor_b32 v3, 96, v2
    ds_read_b128 v[164:167], v3 offset:32768
    s_waitcnt lgkmcnt(3)
    v_mfma_f32_32x32x16_bf16 v[8:23], v[152:155], v[60:63], v[8:23]
    ds_read_b128 v[152:155], v2 offset:49152
    s_waitcnt lgkmcnt(3)
    v_mfma_f32_32x32x16_bf16 v[8:23], v[156:159], v[64:67], v[8:23]
    v_xor_b32 v3, 32, v2
    ds_read_b128 v[156:159], v3 offset:49152
    s_waitcnt lgkmcnt(3)
    v_mfma_f32_32x32x16_bf16 v[8:23], v[160:163], v[68:71], v[8:23]
    v_xor_b32 v3, 64, v2
    ds_read_b128 v[160:163], v3 offset:49152
    s_waitcnt lgkmcnt(3)
    v_mfma_f32_32x32x16_bf16 v[8:23], v[164:167], v[72:75], v[8:23]
    v_xor_b32 v3, 96, v2
    ds_read_b128 v[164:167], v3 offset:49152
    s_waitcnt lgkmcnt(3)
    v_mfma_f32_32x32x16_bf16 v[8:23], v[152:155], v[76:79], v[8:23]
    v_add_u32 v2, 0x10000, v2
L_w30:
    ds_read_b32 v3, v4 offset:4032
    s_sub_u32 s3, s3, 1
    s_cbranch_scc1 L_end
    s_waitcnt lgkmcnt(0)
    v_cmp_gt_u32 vcc, 14, v3
    s_cbranch_vccnz L_w30
    ds_read_b128 v[152:155], v2 offset:0
    s_waitcnt lgkmcnt(3)
    v_mfma_f32_32x32x16_bf16 v[8:23], v[156:159], v[80:83], v[8:23]
    v_xor_b32 v3, 32, v2
    ds_read_b128 v[156:159], v3 offset:0
    s_waitcnt lgkmcnt(3)
    v_mfma_f32_32x32x16_bf16 v[8:23], v[160:163], v[84:87], v[8:23]
    v_xor_b32 v3, 64, v2
    ds_read_b128 v[160:163], v3 offset:0
    s_waitcnt lgkmcnt(3)
    v_mfma_f32_32x32x16_bf16 v[8:23], v[164:167], v[88:91], v[8:23]
    v_xor_b32 v3, 96, v2
    ds_read_b128 v[164:167], v3 offset:0
    s_waitcnt lgkmcnt(3)
    v_mfma_f32_32x32x16_bf16 v[8:23], v[152:155], v[92:95], v[8:23]
    ds_read_b128 v[152:155], v2 offset:16384
    s_waitcnt lgkmcnt(3)
    v_mfma_f32_32x32x16_bf16 v[8:23], v[156:159], v[96:99], v[8:23]
    v_xor_b32 v3, 32, v2
    ds_read_b128 v[156:159], v3 offset:16384
    s_waitcnt lgkmcnt(3)
    v_mfma_f32_32x32x16_bf16 v[8:23], v[160:163], v[100:103], v[8:23]
    v_xor_b32 v3, 64, v2
    ds_read_b128 v[160:163], v3 offset:16384
    s_waitcnt lgkmcnt(3)
    v_mfma_f32_32x32x16_bf16 v[8:23], v[164:167], v[104:107], v[8:23]
    v_xor_b32 v3, 96, v2
    ds_read_b128 v[164:167], v3 offset:16384
    s_waitcnt lgkmcnt(3)
    v_mfma_f32_32x32x16_bf16 v[8:23], v[152:155], v[108:111], v[8:23]
L_w31:
    ds_read_b32 v3, v4 offset:4032
    s_sub_u32 s3, s3, 1
    s_cbranch_scc1 L_end
    s_waitcnt lgkmcnt(0)
    v_cmp_gt_u32 vcc, 15, v3
    s_cbranch_vccnz L_w31
    ds_read_b128 v[152:155], v2 offset:32768
    s_waitcnt lgkmcnt(3)
    v_mfma_f32_32x32x16_bf16 v[8:23], v[156:159], v[112:115], v[8:23]
    v_xor_b32 v3, 32, v2
    ds_read_b128 v[156:159], v3 offset:32768
    s_waitcnt lgkmcnt(3)
    v_mfma_f32_32x32x16_bf16 v[8:23], v[160:163], v[116:119], v[8:23]
    v_xor_b32 v3, 64, v2
    ds_read_b128 v[160:163], v3 offset:32768
    s_waitcnt lgkmcnt(3)
    v_mfma_f32_32x32x16_bf16 v[8:23], v[164:167], v[120:123], v[8:23]
    v_xor_b32 v3, 96, v2
    ds_read_b128 v[164:167], v3 offset:32768
    s_waitcnt lgkmcnt(3)
    v_mfma_f32_32x32x16_bf16 v[8:23], v[152:155], v[124:127], v[8:23]
L_w32:
    ds_read_b32 v3, v4 offset:4032
    s_sub_u32 s3, s3, 1
    s_cbranch_scc1 L_end
    s_waitcnt lgkmcnt(0)
    v_cmp_gt_u32 vcc, 16, v3
    s_cbranch_vccnz L_w32
    ds_read_b128 v[152:155], v2 offset:49152
    s_waitcnt lgkmcnt(3)
    v_mfma_f32_32x32x16_bf16 v[8:23], v[156:159], v[128:131], v[8:23]
    v_xor_b32 v3, 32, v2
    ds_read_b128 v[156:159], v3 offset:49152
    s_waitcnt lgkmcnt(3)
    v_mfma_f32_32x32x16_bf16 v[8:23], v[160:163], v[132:135], v[8:23]
    v_xor_b32 v3, 64, v2
    ds_read_b128 v[160:163], v3 offset:49152
    s_waitcnt lgkmcnt(3)
    v_mfma_f32_32x32x16_bf16 v[8:23], v[164:167], v[136:139], v[8:23]
    v_xor_b32 v3, 96, v2
    ds_read_b128 v[164:167], v3 offset:49152
    s_waitcnt lgkmcnt(3)
    v_mfma_f32_32x32x16_bf16 v[8:23], v[152:155], v[140:143], v[8:23]
    s_waitcnt lgkmcnt(2)
    v_mfma_f32_32x32x16_bf16 v[8:23], v[156:159], v[144:147], v[8:23]
    s_waitcnt lgkmcnt(1)
    v_mfma_f32_32x32x16_bf16 v[8:23], v[160:163], v[148:151], v[8:23]
    s_waitcnt lgkmcnt(0)
    v_mfma_f32_32x32x16_bf16 v[8:23], v[164:167], v[24:27], v[8:23]
    v_add_u32 v166, s53, v5
    s_lshl_b32 s38, s33, 11
    s_add_u32 s38, s38, 139264
    v_lshl_add_u32 v167, v1, 4, s38
    s_nop 7
    v_max3_f32 v164, v8, v9, v10
    v_max3_f32 v165, v11, v12, v13
    v_max3_f32 v164, v164, v14, v15
    v_max3_f32 v165, v165, v16, v17
    v_max3_f32 v164, v164, v18, v19
    v_max3_f32 v165, v165, v20, v21
    v_max3_f32 v164, v164, v22, v23
    v_max_f32 v164, v164, v165
    v_mov_b32 v165, v164
    s_nop 1
    v_permlane32_swap_b32 v164, v165
    v_max_f32 v164, v164, v165
    ds_write_b32 v166, v164 offset:0
L_B_mx1:
    ds_read_b128 v[160:163], v5 offset:0
    s_sub_u32 s3, s3, 1
    s_cbranch_scc1 L_end
    s_waitcnt lgkmcnt(0)
    v_max3_u32 v164, v160, v161, v162
    v_max_u32 v164, v164, v163
    v_cmp_eq_u32 vcc, -1, v164
    s_cbranch_vccnz L_B_mx1
    v_max3_f32 v164, v160, v161, v162
    v_max_f32 v164, v164, v163
    v_mul_f32 v164, s52, v164
    v_max_f32 v164, v164, v6
    v_sub_f32 v165, v6, v164
    v_exp_f32 v165, v165
    v_mov_b32 v6, v164
    v_and_b32 v3, 31, v1
    v_lshlrev_b32 v3, 2, v3
    v_add_u32 v3, 147968, v3
    ds_write_b32 v3, v165
    v_mov_b32 v164, 1
    s_mov_b64 exec, 1
    ds_add_u32 v0, v164 offset:1020
    s_mov_b64 exec, -1
    v_fma_f32 v8, v8, s52, -v6
    v_fma_f32 v9, v9, s52, -v6
    v_fma_f32 v10, v10, s52, -v6
    v_fma_f32 v11, v11, s52, -v6
    v_fma_f32 v12, v12, s52, -v6
    v_fma_f32 v13, v13, s52, -v6
    v_fma_f32 v14, v14, s52, -v6
    v_fma_f32 v15, v15, s52, -v6
    v_exp_f32 v8, v8
    v_exp_f32 v9, v9
    v_exp_f32 v10, v10
    v_exp_f32 v11, v11
    v_exp_f32 v12, v12
    v_exp_f32 v13, v13
    v_exp_f32 v14, v14
    v_exp_f32 v15, v15
    v_cvt_pk_bf16_f32 v152, v8, v9
    v_cvt_pk_bf16_f32 v153, v10, v11
    v_cvt_pk_bf16_f32 v154, v12, v13
    v_cvt_pk_bf16_f32 v155, v14, v15
    ds_write_b128 v167, v[152:155] offset:0
    v_fma_f32 v16, v16, s52, -v6
    v_fma_f32 v17, v17, s52, -v6
    v_fma_f32 v18, v18, s52, -v6
    v_fma_f32 v19, v19, s52, -v6
    v_fma_f32 v20, v20, s52, -v6
    v_fma_f32 v21, v21, s52, -v6
    v_fma_f32 v22, v22, s52, -v6
    v_fma_f32 v23, v23, s52, -v6
    v_exp_f32 v16, v16
    v_exp_f32 v17, v17
    v_exp_f32 v18, v18
    v_exp_f32 v19, v19
    v_exp_f32 v20, v20
    v_exp_f32 v21, v21
    v_exp_f32 v22, v22
    v_exp_f32 v23, v23
    v_cvt_pk_bf16_f32 v156, v16, v17
    v_cvt_pk_bf16_f32 v157, v18, v19
    v_cvt_pk_bf16_f32 v158, v20, v21
    v_cvt_pk_bf16_f32 v159, v22, v23
    ds_write_b128 v167, v[156:159] offset:1024
    v_mov_b32 v164, 1
    s_mov_b64 exec, 1
    ds_add_u32 v0, v164 offset:1016
    s_mov_b64 exec, -1
    v_pk_add_f32 v[8:9], v[8:9], v[16:17]
    v_pk_add_f32 v[10:11], v[10:11], v[18:19]
    v_pk_add_f32 v[12:13], v[12:13], v[20:21]
    v_pk_add_f32 v[14:15], v[14:15], v[22:23]
    v_pk_add_f32 v[8:9], v[8:9], v[12:13]
    v_pk_add_f32 v[10:11], v[10:11], v[14:15]
    v_pk_add_f32 v[8:9], v[8:9], v[10:11]
    v_add_f32 v8, v8, v9
    v_fmac_f32 v8, v7, v165
    v_mov_b32 v9, v8
    s_nop 1
    v_permlane32_swap_b32 v8, v9
    v_add_f32 v8, v8, v9
    ds_write_b32 v166, v8 offset:1024
    v_mov_b32 v164, 1
    s_mov_b64 exec, 1
    ds_add_u32 v0, v164 offset:1020
    s_mov_b64 exec, -1
    s_cmp_lg_u32 s33, 0
    s_cbranch_scc1 L_B_F
    v_and_b32 v2, 7, v1
    v_lshlrev_b32 v2, 7, v2
    v_and_or_b32 v2, v1, 24, v2
    s_lshl_b32 s49, s61, 10
    s_add_u32 s49, s49, 1048576
L_w33:
    ds_read_b32 v3, v0 offset:1020
    s_sub_u32 s3, s3, 1
    s_cbranch_scc1 L_end
    s_waitcnt lgkmcnt(0)
    v_cmp_gt_u32 vcc, 8, v3
    s_cbranch_vccnz L_w33
    ds_read_b128 v[8:11], v5 offset:1024
    s_waitcnt lgkmcnt(0)
    v_add_f32 v8, v8, v9
    v_add_f32 v10, v10, v11
    v_add_f32 v7, v8, v10
L_w34:
    ds_read_b32 v3, v0 offset:2024
    s_sub_u32 s3, s3, 1
    s_cbranch_scc1 L_end
    s_waitcnt lgkmcnt(0)
    v_cmp_gt_u32 vcc, 4, v3
    s_cbranch_vccnz L_w34
L_w35:
    s_sleep 1
    ds_read_b32 v3, v0 offset:7060
    s_sub_u32 s3, s3, 1
    s_cbranch_scc1 L_end
    s_waitcnt lgkmcnt(0)
    v_cmp_gt_u32 vcc, 1, v3
    s_cbranch_vccnz L_w35
    s_mov_b32 exec_hi, 0
    buffer_store_dwordx2 v[6:7], v2, s[40:43], s49 offen sc1
    s_mov_b64 exec, -1
    v_mov_b32 v3, 1
    s_mov_b64 exec, 1
    ds_add_u32 v0, v3 offset:1012
    s_mov_b64 exec, -1
L_B_F:
    s_setprio 0
    s_cmp_ge_u32 s35, 28
    s_cbranch_scc1 L_end
    v_bfe_u32 v12, v1, 4, 1
    v_lshlrev_b32 v12, 1, v12
    v_and_b32 v13, 7, v1
    v_xor_b32 v12, v12, v13
    v_lshlrev_b32 v164, 4, v12
    v_lshrrev_b32 v165, 3, v1
    v_lshrrev_b32 v6, 4, v1
    v_bfe_u32 v8, v1, 2, 2
    v_lshl_add_u32 v9, v6, 3, v8
    v_lshrrev_b32 v8, 1, v8
    v_and_b32 v10, 1, v6
    v_lshl_or_b32 v8, v10, 1, v8
    v_xor_b32 v8, s33, v8
    v_lshlrev_b32 v8, 5, v8
    v_lshl_add_u32 v8, v9, 7, v8
    v_and_b32 v9, 3, v1
    v_lshl_add_u32 v2, v9, 3, v8
    v_bfe_u32 v7, v1, 3, 1
    v_lshl_add_u32 v8, v7, 2, v9
    v_mul_u32_u24 v8, 1040, v8
    v_lshl_add_u32 v8, v6, 4, v8
    v_add_u32 v4, 135232, v8
    v_and_b32 v9, 1, v1
    v_lshl_add_u32 v8, v7, 1, v9
    v_mul_u32_u24 v8, 1040, v8
    v_lshl_add_u32 v8, v6, 4, v8
    v_add_u32 v5, 131072, v8
    v_mul_u32_u24 v8, 144, v7
    v_lshl_add_u32 v8, v6, 3, v8
    s_lshl_b32 s38, s33, 5
    s_add_u32 s38, s38, 143552
    v_add_u32 v6, s38, v8
    v_lshlrev_b32 v7, 5, v7
    v_add_u32 v7, 149504, v7
    s_mov_b32 s44, s18
    s_mov_b32 s45, s19
    s_mov_b32 s46, 1835008
    s_mov_b32 s47, 0x20000
    s_lshl_b32 s58, s35, 7
L_w36:
    s_sleep 2
    ds_read_b32 v3, v0 offset:1012
    s_sub_u32 s3, s3, 1
    s_cbranch_scc1 L_end
    s_waitcnt lgkmcnt(0)
    v_cmp_gt_u32 vcc, 5, v3
    s_cbranch_vccnz L_w36

    v_mul_u32_u24 v12, 3584, v165
    v_add_u32 v12, v12, v164
    v_xor_b32 v13, 64, v12
    s_mul_i32 s38, s33, 458752
    s_add_u32 s58, s58, s38
    s_lshl_b32 s57, s33, 14
    s_add_u32 s57, s57, 0
    s_and_b32 s56, s34, 3
    s_mov_b32 s59, 0
L_A_f1:
    s_xor_b32 s38, s59, s56
    s_lshl_b32 s39, s38, 12
    s_add_u32 s39, s39, s57
    s_mul_i32 s38, s38, 114688
    s_add_u32 s38, s38, s58
    s_add_u32 m0, s39, 0
    s_add_u32 s60, s38, 0
    buffer_load_dwordx4 v12, s[44:47], s60 offen lds
    s_waitcnt vmcnt(3)
    s_add_u32 m0, s39, 1024
    s_add_u32 s60, s38, 28672
    buffer_load_dwordx4 v13, s[44:47], s60 offen lds
    s_waitcnt vmcnt(3)
    s_add_u32 m0, s39, 2048
    s_add_u32 s60, s38, 57344
    buffer_load_dwordx4 v12, s[44:47], s60 offen lds
    s_waitcnt vmcnt(3)
    s_add_u32 m0, s39, 3072
    s_add_u32 s60, s38, 86016
    buffer_load_dwordx4 v13, s[44:47], s60 offen lds
    s_waitcnt vmcnt(3)
    s_add_u32 s59, s59, 1
    s_cmp_lt_u32 s59, 4
    s_cbranch_scc1 L_A_f1
    v_mov_b32 v3, 1
    s_mov_b64 exec, 1
    ds_add_u32 v0, v3 offset:5044
    s_mov_b64 exec, -1
    s_waitcnt vmcnt(0)
    v_mov_b32 v3, 1
    s_mov_b64 exec, 1
    ds_add_u32 v0, v3 offset:5040
    s_mov_b64 exec, -1
L_w37:
    s_sleep 1
    ds_read_b32 v3, v0 offset:5040
    s_sub_u32 s3, s3, 1
    s_cbranch_scc1 L_end
    s_waitcnt lgkmcnt(0)
    v_cmp_gt_u32 vcc, 4, v3
    s_cbranch_vccnz L_w37
    ds_read_b64_tr_b16 v[104:105], v2 offset:0
    ds_read_b64_tr_b16 v[106:107], v2 offset:512
    ds_read_b64_tr_b16 v[108:109], v2 offset:4096
    ds_read_b64_tr_b16 v[110:111], v2 offset:4608
    ds_read_b64_tr_b16 v[112:113], v2 offset:8192
    ds_read_b64_tr_b16 v[114:115], v2 offset:8704
    ds_read_b64_tr_b16 v[116:117], v2 offset:12288
    ds_read_b64_tr_b16 v[118:119], v2 offset:12800
    s_waitcnt lgkmcnt(4)
    ds_read_b64_tr_b16 v[120:121], v2 offset:16384
    ds_read_b64_tr_b16 v[122:123], v2 offset:16896
    ds_read_b64_tr_b16 v[124:125], v2 offset:20480
    ds_read_b64_tr_b16 v[126:127], v2 offset:20992
    ds_read_b64_tr_b16 v[128:129], v2 offset:24576
    ds_read_b64_tr_b16 v[130:131], v2 offset:25088
    ds_read_b64_tr_b16 v[132:133], v2 offset:28672
    ds_read_b64_tr_b16 v[134:135], v2 offset:29184
    s_waitcnt lgkmcnt(4)
    ds_read_b64_tr_b16 v[136:137], v2 offset:32768
    ds_read_b64_tr_b16 v[138:139], v2 offset:33280
    ds_read_b64_tr_b16 v[140:141], v2 offset:36864
    ds_read_b64_tr_b16 v[142:143], v2 offset:37376
    ds_read_b64_tr_b16 v[144:145], v2 offset:40960
    ds_read_b64_tr_b16 v[146:147], v2 offset:41472
    ds_read_b64_tr_b16 v[148:149], v2 offset:45056
    ds_read_b64_tr_b16 v[150:151], v2 offset:45568
    s_waitcnt lgkmcnt(4)
    ds_read_b64_tr_b16 v[152:153], v2 offset:49152
    ds_read_b64_tr_b16 v[154:155], v2 offset:49664
    ds_read_b64_tr_b16 v[156:157], v2 offset:53248
    ds_read_b64_tr_b16 v[158:159], v2 offset:53760
    ds_read_b64_tr_b16 v[160:161], v2 offset:57344
    ds_read_b64_tr_b16 v[162:163], v2 offset:57856
    ds_read_b64_tr_b16 v[164:165], v2 offset:61440
    ds_read_b64_tr_b16 v[166:167], v2 offset:61952
    s_waitcnt lgkmcnt(4)
L_w38:
    s_sleep 1
    ds_read_b32 v3, v0 offset:5048
    s_sub_u32 s3, s3, 1
    s_cbranch_scc1 L_end
    s_waitcnt lgkmcnt(0)
    v_cmp_gt_u32 vcc, 4, v3
    s_cbranch_vccnz L_w38
    ds_read_b128 v[40:43], v4 offset:0
    ds_read_b128 v[44:47], v4 offset:64
    ds_read_b128 v[48:51], v4 offset:128
    ds_read_b128 v[52:55], v4 offset:192
    ds_read_b128 v[56:59], v4 offset:256
    ds_read_b128 v[60:63], v4 offset:320
    ds_read_b128 v[64:67], v4 offset:384
    ds_read_b128 v[68:71], v4 offset:448
    ds_read_b128 v[72:75], v4 offset:512
    ds_read_b128 v[76:79], v4 offset:576
    ds_read_b128 v[80:83], v4 offset:640
    ds_read_b128 v[84:87], v4 offset:704
    s_waitcnt lgkmcnt(11)
    v_mfma_f32_16x16x32_bf16 v[8:11], v[104:107], v[40:43], 0
    ds_read_b128 v[88:91], v4 offset:768
    s_waitcnt lgkmcnt(11)
    v_mfma_f32_16x16x32_bf16 v[12:15], v[108:111], v[44:47], 0
    ds_read_b128 v[92:95], v4 offset:832
    s_waitcnt lgkmcnt(11)
    v_mfma_f32_16x16x32_bf16 v[8:11], v[112:115], v[48:51], v[8:11]
    ds_read_b128 v[96:99], v4 offset:896
    s_waitcnt lgkmcnt(11)
    v_mfma_f32_16x16x32_bf16 v[12:15], v[116:119], v[52:55], v[12:15]
    ds_read_b128 v[100:103], v4 offset:960
    s_waitcnt lgkmcnt(11)
    v_mfma_f32_16x16x32_bf16 v[8:11], v[120:123], v[56:59], v[8:11]
    s_waitcnt lgkmcnt(10)
    v_mfma_f32_16x16x32_bf16 v[12:15], v[124:127], v[60:63], v[12:15]
    s_waitcnt lgkmcnt(9)
    v_mfma_f32_16x16x32_bf16 v[8:11], v[128:131], v[64:67], v[8:11]
    s_waitcnt lgkmcnt(8)
    v_mfma_f32_16x16x32_bf16 v[12:15], v[132:135], v[68:71], v[12:15]
    s_waitcnt lgkmcnt(7)
    v_mfma_f32_16x16x32_bf16 v[8:11], v[136:139], v[72:75], v[8:11]
    s_waitcnt lgkmcnt(6)
    v_mfma_f32_16x16x32_bf16 v[12:15], v[140:143], v[76:79], v[12:15]
    s_waitcnt lgkmcnt(5)
    v_mfma_f32_16x16x32_bf16 v[8:11], v[144:147], v[80:83], v[8:11]
    s_waitcnt lgkmcnt(4)
    v_mfma_f32_16x16x32_bf16 v[12:15], v[148:151], v[84:87], v[12:15]
    s_waitcnt lgkmcnt(3)
    v_mfma_f32_16x16x32_bf16 v[8:11], v[152:155], v[88:91], v[8:11]
    s_waitcnt lgkmcnt(2)
    v_mfma_f32_16x16x32_bf16 v[12:15], v[156:159], v[92:95], v[12:15]
    s_waitcnt lgkmcnt(1)
    v_mfma_f32_16x16x32_bf16 v[8:11], v[160:163], v[96:99], v[8:11]
    s_waitcnt lgkmcnt(0)
    v_mfma_f32_16x16x32_bf16 v[12:15], v[164:167], v[100:103], v[12:15]
    s_nop 7
    v_pk_add_f32 v[8:9], v[8:9], v[12:13]
    v_pk_add_f32 v[10:11], v[10:11], v[14:15]
    s_nop 0
    v_add_f32_dpp v8, v8, v8 quad_perm:[1,0,3,2] row_mask:0xf bank_mask:0xf
    v_add_f32_dpp v9, v9, v9 quad_perm:[1,0,3,2] row_mask:0xf bank_mask:0xf
    v_add_f32_dpp v10, v10, v10 quad_perm:[1,0,3,2] row_mask:0xf bank_mask:0xf
    v_add_f32_dpp v11, v11, v11 quad_perm:[1,0,3,2] row_mask:0xf bank_mask:0xf
    v_mov_b32_dpp v16, v8 quad_perm:[0,0,0,0] row_mask:0xf bank_mask:0xf
    v_mov_b32_dpp v20, v8 quad_perm:[2,2,2,2] row_mask:0xf bank_mask:0xf
    v_mov_b32_dpp v17, v9 quad_perm:[0,0,0,0] row_mask:0xf bank_mask:0xf
    v_mov_b32_dpp v21, v9 quad_perm:[2,2,2,2] row_mask:0xf bank_mask:0xf
    v_mov_b32_dpp v18, v10 quad_perm:[0,0,0,0] row_mask:0xf bank_mask:0xf
    v_mov_b32_dpp v22, v10 quad_perm:[2,2,2,2] row_mask:0xf bank_mask:0xf
    v_mov_b32_dpp v19, v11 quad_perm:[0,0,0,0] row_mask:0xf bank_mask:0xf
    v_mov_b32_dpp v23, v11 quad_perm:[2,2,2,2] row_mask:0xf bank_mask:0xf
    s_mov_b32 s38, 0x3b000000
    s_setprio 2
L_w39:
    s_sleep 1
    ds_read_b32 v3, v0 offset:5052
    s_sub_u32 s3, s3, 1
    s_cbranch_scc1 L_end
    s_waitcnt lgkmcnt(0)
    v_cmp_gt_u32 vcc, 1, v3
    s_cbranch_vccnz L_w39
L_w40:
    ds_read_b32 v3, v0 offset:5052
    s_sub_u32 s3, s3, 1
    s_cbranch_scc1 L_end
    s_waitcnt lgkmcnt(0)
    v_cmp_gt_u32 vcc, 4, v3
    s_cbranch_vccnz L_w40
    ds_read_b128 v[40:43], v5 offset:0
    ds_read_b128 v[44:47], v5 offset:64
    ds_read_b128 v[48:51], v5 offset:128
    ds_read_b128 v[52:55], v5 offset:192
    ds_read_b128 v[56:59], v5 offset:256
    ds_read_b128 v[60:63], v5 offset:320
    ds_read_b128 v[64:67], v5 offset:384
    ds_read_b128 v[68:71], v5 offset:448
    ds_read_b128 v[72:75], v5 offset:512
    ds_read_b128 v[76:79], v5 offset:576
    ds_read_b128 v[80:83], v5 offset:640
    ds_read_b128 v[84:87], v5 offset:704
    s_waitcnt lgkmcnt(11)
    v_mfma_f32_16x16x32_bf16 v[8:11], v[104:107], v[40:43], 0
    ds_read_b128 v[88:91], v5 offset:768
    s_waitcnt lgkmcnt(11)
    v_mfma_f32_16x16x32_bf16 v[12:15], v[108:111], v[44:47], 0
    ds_read_b128 v[92:95], v5 offset:832
    s_waitcnt lgkmcnt(11)
    v_mfma_f32_16x16x32_bf16 v[8:11], v[112:115], v[48:51], v[8:11]
    ds_read_b128 v[96:99], v5 offset:896
    s_waitcnt lgkmcnt(11)
    v_mfma_f32_16x16x32_bf16 v[12:15], v[116:119], v[52:55], v[12:15]
    ds_read_b128 v[100:103], v5 offset:960
    s_waitcnt lgkmcnt(11)
    v_mfma_f32_16x16x32_bf16 v[8:11], v[120:123], v[56:59], v[8:11]
    s_waitcnt lgkmcnt(10)
    v_mfma_f32_16x16x32_bf16 v[12:15], v[124:127], v[60:63], v[12:15]
    s_waitcnt lgkmcnt(9)
    v_mfma_f32_16x16x32_bf16 v[8:11], v[128:131], v[64:67], v[8:11]
    s_waitcnt lgkmcnt(8)
    v_mfma_f32_16x16x32_bf16 v[12:15], v[132:135], v[68:71], v[12:15]
    s_waitcnt lgkmcnt(7)
    v_mfma_f32_16x16x32_bf16 v[8:11], v[136:139], v[72:75], v[8:11]
    s_waitcnt lgkmcnt(6)
    v_mfma_f32_16x16x32_bf16 v[12:15], v[140:143], v[76:79], v[12:15]
    s_waitcnt lgkmcnt(5)
    v_mfma_f32_16x16x32_bf16 v[8:11], v[144:147], v[80:83], v[8:11]
    s_waitcnt lgkmcnt(4)
    v_mfma_f32_16x16x32_bf16 v[12:15], v[148:151], v[84:87], v[12:15]
    s_waitcnt lgkmcnt(3)
    v_mfma_f32_16x16x32_bf16 v[8:11], v[152:155], v[88:91], v[8:11]
    s_waitcnt lgkmcnt(2)
    v_mfma_f32_16x16x32_bf16 v[12:15], v[156:159], v[92:95], v[12:15]
    s_waitcnt lgkmcnt(1)
    v_mfma_f32_16x16x32_bf16 v[8:11], v[160:163], v[96:99], v[8:11]
    s_waitcnt lgkmcnt(0)
    v_mfma_f32_16x16x32_bf16 v[12:15], v[164:167], v[100:103], v[12:15]
L_B_ln:
    ds_read_b128 v[24:27], v7
    ds_read_b128 v[28:31], v7 offset:16
    s_sub_u32 s3, s3, 1
    s_cbranch_scc1 L_end
    s_waitcnt lgkmcnt(0)
    v_max3_u32 v32, v24, v25, v26
    v_max3_u32 v32, v32, v27, v28
    v_max3_u32 v32, v32, v29, v30
    v_max_u32 v32, v32, v31
    v_cmp_eq_u32 vcc, -1, v32
    s_cbranch_vccnz L_B_ln
    v_pk_add_f32 v[24:25], v[24:25], v[26:27]
    v_pk_add_f32 v[28:29], v[28:29], v[30:31]
    v_add_f32 v24, v24, v25
    v_add_f32 v28, v28, v29
    v_mul_f32 v24, s38, v24
    v_mul_f32 v28, s38, v28
    v_fma_f32 v28, -v24, v24, v28
    v_max_f32 v28, 0, v28
    v_add_f32 v28, 0x3727c5ac, v28
    v_rsq_f32 v28, v28
    v_pk_add_f32 v[8:9], v[8:9], v[12:13]
    v_pk_add_f32 v[10:11], v[10:11], v[14:15]
    s_nop 0
    v_add_f32_dpp v8, v8, v8 quad_perm:[1,0,3,2] row_mask:0xf bank_mask:0xf
    v_add_f32_dpp v9, v9, v9 quad_perm:[1,0,3,2] row_mask:0xf bank_mask:0xf
    v_add_f32_dpp v10, v10, v10 quad_perm:[1,0,3,2] row_mask:0xf bank_mask:0xf
    v_add_f32_dpp v11, v11, v11 quad_perm:[1,0,3,2] row_mask:0xf bank_mask:0xf
    v_fma_f32 v8, -v24, v16, v8
    v_fma_f32 v9, -v24, v17, v9
    v_fma_f32 v10, -v24, v18, v10
    v_fma_f32 v11, -v24, v19, v11
    v_fma_f32 v8, v8, v28, v20
    v_fma_f32 v9, v9, v28, v21
    v_fma_f32 v10, v10, v28, v22
    v_fma_f32 v11, v11, v28, v23
    v_max_f32 v8, 0, v8
    v_max_f32 v9, 0, v9
    v_max_f32 v10, 0, v10
    v_max_f32 v11, 0, v11
    v_cvt_pk_bf16_f32 v8, v8, v9
    v_cvt_pk_bf16_f32 v9, v10, v11
    ds_write_b64 v6, v[8:9]
    v_mov_b32 v3, 1
    s_mov_b64 exec, 1
    ds_add_u32 v0, v3 offset:2016
    s_mov_b64 exec, -1
    s_branch L_end
L_Cs:
    s_setprio 2

    v_lshrrev_b32 v3, 4, v1
    v_and_b32 v5, 15, v1
    v_lshlrev_b32 v2, 10, v3
    v_lshl_add_u32 v2, v5, 4, v2
    s_lshl_b32 s38, s33, 8
    v_add_u32 v2, s38, v2
    v_add_u32 v4, 0x1000, v2
    s_waitcnt lgkmcnt(0)
    global_load_dwordx4 v[24:27], v2, s[4:5]
    global_load_dwordx4 v[28:31], v4, s[4:5]
    global_load_dwordx4 v[8:11], v2, s[22:23]
    global_load_dwordx4 v[12:15], v4, s[22:23]
    s_barrier
    s_mov_b32 s40, s30
    s_mov_b32 s41, s31
    s_mov_b32 s42, 16777216
    s_mov_b32 s43, 0x20000

    s_mov_b32 s3, 0x400000
    v_mov_b32 v0, 156256
    s_and_b32 s62, s34, 3
    s_lshl2_add_u32 s97, s62, s37
    s_lshl4_add_u32 s61, s36, s97

    s_lshl2_add_u32 s55, s36, s37
    v_mov_b32 v32, 0x3f803f80
    v_mov_b32 v33, v32
    v_mov_b32 v34, v32
    v_mov_b32 v35, v32
    v_mov_b32 v36, v32
    v_mov_b32 v37, v32
    v_mov_b32 v38, v32
    v_mov_b32 v39, v32
    v_mov_b32 v40, v32
    v_mov_b32 v41, v32
    v_mov_b32 v42, v32
    v_mov_b32 v43, v32
    v_mov_b32 v44, v32
    v_mov_b32 v45, v32
    v_mov_b32 v46, v32
    v_mov_b32 v47, v32

    s_mov_b32 s56, 0x00ff00ff
    s_mov_b32 s57, 0x00ff00ff
    s_mul_i32 s38, s33, 2176
    v_mul_u32_u24 v6, 272, v3
    v_lshl_add_u32 v6, v5, 4, v6
    v_add_u32 v6, s38, v6
    v_and_b32 v92, 7, v1
    v_mul_u32_u24 v95, 272, v92
    v_lshl_add_u32 v7, v3, 4, v95
    v_add_u32 v7, s38, v7
    v_lshl_add_u32 v95, v3, 3, v95
    s_lshr_b32 s38, s55, 3
    s_mul_i32 s38, s38, 2176
    s_and_b32 s39, s55, 7
    s_lshl_b32 s39, s39, 5
    s_add_u32 s38, s38, s39
    v_add_u32 v95, s38, v95
    s_lshl_b32 s59, s33, 13
    s_add_u32 s59, s59, 65536
    v_bfe_u32 v2, v1, 2, 2
    v_lshl_add_u32 v2, v3, 3, v2
    v_lshlrev_b32 v2, 6, v2
    v_and_b32 v4, 1, v3
    v_lshl_add_u32 v2, v4, 5, v2
    v_and_b32 v4, 3, v1
    v_lshl_add_u32 v2, v4, 3, v2
    v_add_u32 v2, s59, v2
    v_xor_b32 v3, 32, v2
    s_mul_i32 s38, s33, 3072
    s_add_u32 s38, s38, 49152
    v_lshl_add_u32 v4, v1, 4, s38
    s_lshl_b32 s38, s33, 2
    v_add_u32 v5, s38, v0
    s_mov_b32 s38, 0xbfb8aa3b
    s_waitcnt vmcnt(2)
    ds_write_b128 v6, v[24:27] offset:16384
    ds_write_b128 v6, v[28:31] offset:17472
    s_mov_b64 exec, s[56:57]
    ds_read_b128 v[32:35], v7 offset:16384
    ds_read_b128 v[36:39], v7 offset:16448
    ds_read_b128 v[40:43], v7 offset:16512
    ds_read_b128 v[44:47], v7 offset:16576
    s_mov_b64 exec, -1
    s_waitcnt vmcnt(0)
    v_lshlrev_b32 v48, 16, v8
    v_and_b32 v49, 0xffff0000, v8
    v_mul_f32 v50, s38, v48
    v_mul_f32 v51, s38, v49
    v_exp_f32 v50, v50
    v_exp_f32 v51, v51
    v_add_f32 v50, 1.0, v50
    v_add_f32 v51, 1.0, v51
    v_rcp_f32 v50, v50
    v_rcp_f32 v51, v51
    v_mul_f32 v48, v48, v50
    v_mul_f32 v49, v49, v51
    v_cvt_pk_bf16_f32 v8, v48, v49
    s_waitcnt lgkmcnt(0)
    v_mfma_f32_16x16x32_bf16 v[88:91], v[32:35], v[32:35], 0
    v_mfma_f32_16x16x32_bf16 v[88:91], v[36:39], v[36:39], v[88:91]
    v_mfma_f32_16x16x32_bf16 v[88:91], v[40:43], v[40:43], v[88:91]
    v_mfma_f32_16x16x32_bf16 v[88:91], v[44:47], v[44:47], v[88:91]
    v_lshlrev_b32 v48, 16, v9
    v_and_b32 v49, 0xffff0000, v9
    v_mul_f32 v50, s38, v48
    v_mul_f32 v51, s38, v49
    v_exp_f32 v50, v50
    v_exp_f32 v51, v51
    v_add_f32 v50, 1.0, v50
    v_add_f32 v51, 1.0, v51
    v_rcp_f32 v50, v50
    v_rcp_f32 v51, v51
    v_mul_f32 v48, v48, v50
    v_mul_f32 v49, v49, v51
    v_cvt_pk_bf16_f32 v9, v48, v49
    ds_write_b128 v4, v[88:91] offset:2048
    v_mov_b32 v52, 1
    s_mov_b64 exec, 1
    ds_add_u32 v0, v52 offset:12
    s_mov_b64 exec, -1
    v_lshlrev_b32 v48, 16, v10
    v_and_b32 v49, 0xffff0000, v10
    v_mul_f32 v50, s38, v48
    v_mul_f32 v51, s38, v49
    v_exp_f32 v50, v50
    v_exp_f32 v51, v51
    v_add_f32 v50, 1.0, v50
    v_add_f32 v51, 1.0, v51
    v_rcp_f32 v50, v50
    v_rcp_f32 v51, v51
    v_mul_f32 v48, v48, v50
    v_mul_f32 v49, v49, v51
    v_cvt_pk_bf16_f32 v10, v48, v49
    v_lshlrev_b32 v48, 16, v11
    v_and_b32 v49, 0xffff0000, v11
    v_mul_f32 v50, s38, v48
    v_mul_f32 v51, s38, v49
    v_exp_f32 v50, v50
    v_exp_f32 v51, v51
    v_add_f32 v50, 1.0, v50
    v_add_f32 v51, 1.0, v51
    v_rcp_f32 v50, v50
    v_rcp_f32 v51, v51
    v_mul_f32 v48, v48, v50
    v_mul_f32 v49, v49, v51
    v_cvt_pk_bf16_f32 v11, v48, v49
    v_lshlrev_b32 v48, 16, v12
    v_and_b32 v49, 0xffff0000, v12
    v_mul_f32 v50, s38, v48
    v_mul_f32 v51, s38, v49
    v_exp_f32 v50, v50
    v_exp_f32 v51, v51
    v_add_f32 v50, 1.0, v50
    v_add_f32 v51, 1.0, v51
    v_rcp_f32 v50, v50
    v_rcp_f32 v51, v51
    v_mul_f32 v48, v48, v50
    v_mul_f32 v49, v49, v51
    v_cvt_pk_bf16_f32 v12, v48, v49
    v_lshlrev_b32 v48, 16, v13
    v_and_b32 v49, 0xffff0000, v13
    v_mul_f32 v50, s38, v48
    v_mul_f32 v51, s38, v49
    v_exp_f32 v50, v50
    v_exp_f32 v51, v51
    v_add_f32 v50, 1.0, v50
    v_add_f32 v51, 1.0, v51
    v_rcp_f32 v50, v50
    v_rcp_f32 v51, v51
    v_mul_f32 v48, v48, v50
    v_mul_f32 v49, v49, v51
    v_cvt_pk_bf16_f32 v13, v48, v49
    v_lshlrev_b32 v48, 16, v14
    v_and_b32 v49, 0xffff0000, v14
    v_mul_f32 v50, s38, v48
    v_mul_f32 v51, s38, v49
    v_exp_f32 v50, v50
    v_exp_f32 v51, v51
    v_add_f32 v50, 1.0, v50
    v_add_f32 v51, 1.0, v51
    v_rcp_f32 v50, v50
    v_rcp_f32 v51, v51
    v_mul_f32 v48, v48, v50
    v_mul_f32 v49, v49, v51
    v_cvt_pk_bf16_f32 v14, v48, v49
    v_lshlrev_b32 v48, 16, v15
    v_and_b32 v49, 0xffff0000, v15
    v_mul_f32 v50, s38, v48
    v_mul_f32 v51, s38, v49
    v_exp_f32 v50, v50
    v_exp_f32 v51, v51
    v_add_f32 v50, 1.0, v50
    v_add_f32 v51, 1.0, v51
    v_rcp_f32 v50, v50
    v_rcp_f32 v51, v51
    v_mul_f32 v48, v48, v50
    v_mul_f32 v49, v49, v51
    v_cvt_pk_bf16_f32 v15, v48, v49
    ds_write_b128 v6, v[8:11] offset:32768
    ds_write_b128 v6, v[12:15] offset:33856
    ds_read_b128 v[8:11], v7 offset:32768
    ds_read_b128 v[12:15], v7 offset:32832
    ds_read_b128 v[16:19], v7 offset:32896
    ds_read_b128 v[20:23], v7 offset:32960
    s_cmp_lg_u32 s33, 0
    s_cbranch_scc1 L_C_nln
    v_lshrrev_b32 v93, 2, v92
    v_lshl_add_u32 v93, v93, 4, v92
    v_lshlrev_b32 v93, 4, v93
    v_and_b32 v94, 3, v1
    v_lshl_add_u32 v93, v94, 2, v93
    v_add_u32 v93, 51200, v93
    v_lshlrev_b32 v92, 4, v92
    v_add_u32 v94, 51712, v92
    v_lshrrev_b32 v96, 5, v1
    v_lshl_add_u32 v92, v96, 7, v92
    v_bfe_u32 v96, v1, 4, 1
    v_lshl_add_u32 v92, v96, 3, v92
    s_lshl_b32 s39, s55, 8
L_w41:
    ds_read_b32 v40, v0 offset:12
    s_sub_u32 s3, s3, 1
    s_cbranch_scc1 L_end
    s_waitcnt lgkmcnt(0)
    v_cmp_gt_u32 vcc, 4, v40
    s_cbranch_vccnz L_w41
    ds_read_b32 v24, v94 offset:0
    ds_read_b32 v28, v93 offset:0
    ds_read_b32 v25, v94 offset:3072
    ds_read_b32 v29, v93 offset:3072
    ds_read_b32 v26, v94 offset:6144
    ds_read_b32 v30, v93 offset:6144
    ds_read_b32 v27, v94 offset:9216
    ds_read_b32 v31, v93 offset:9216
    ds_read_b64 v[6:7], v95 offset:16384
    s_mov_b32 s38, 0x3b000000
    s_waitcnt lgkmcnt(0)
    v_lshlrev_b32 v96, 16, v6
    v_and_b32 v97, 0xffff0000, v6
    v_lshlrev_b32 v98, 16, v7
    v_and_b32 v99, 0xffff0000, v7
    v_add_f32 v24, v24, v25
    v_add_f32 v28, v28, v29
    v_add_f32 v26, v26, v27
    v_add_f32 v30, v30, v31
    v_add_f32 v24, v24, v26
    v_add_f32 v28, v28, v30
    v_mul_f32 v24, s38, v24
    v_mul_f32 v28, s38, v28
    v_fma_f32 v28, -v24, v24, v28
    v_max_f32 v28, 0, v28
    v_add_f32 v28, 0x3727c5ac, v28
    v_rsq_f32 v28, v28
    v_sub_f32 v96, v96, v24
    v_sub_f32 v97, v97, v24
    v_sub_f32 v98, v98, v24
    v_sub_f32 v99, v99, v24
    v_mul_f32 v96, v96, v28
    v_mul_f32 v97, v97, v28
    v_mul_f32 v98, v98, v28
    v_mul_f32 v99, v99, v28
L_C_nln:
L_w42:
    ds_read_b32 v40, v5 offset:4032
    s_sub_u32 s3, s3, 1
    s_cbranch_scc1 L_end
    s_waitcnt lgkmcnt(0)
    v_cmp_gt_u32 vcc, 1, v40
    s_cbranch_vccnz L_w42
    ds_read_b64_tr_b16 v[48:49], v2 offset:0
    ds_read_b64_tr_b16 v[50:51], v2 offset:256
    ds_read_b64_tr_b16 v[52:53], v3 offset:0
    ds_read_b64_tr_b16 v[54:55], v3 offset:256
    ds_read_b64_tr_b16 v[56:57], v2 offset:2048
    ds_read_b64_tr_b16 v[58:59], v2 offset:2304
    ds_read_b64_tr_b16 v[60:61], v3 offset:2048
    ds_read_b64_tr_b16 v[62:63], v3 offset:2304
    s_waitcnt lgkmcnt(4)
    v_mfma_f32_16x16x32_bf16 v[80:83], v[48:51], v[8:11], 0
    v_mfma_f32_16x16x32_bf16 v[84:87], v[52:55], v[8:11], 0
    s_waitcnt lgkmcnt(0)
    v_mfma_f32_16x16x32_bf16 v[80:83], v[56:59], v[12:15], v[80:83]
    v_mfma_f32_16x16x32_bf16 v[84:87], v[60:63], v[12:15], v[84:87]
L_w43:
    ds_read_b32 v40, v5 offset:4032
    s_sub_u32 s3, s3, 1
    s_cbranch_scc1 L_end
    s_waitcnt lgkmcnt(0)
    v_cmp_gt_u32 vcc, 2, v40
    s_cbranch_vccnz L_w43
    ds_read_b64_tr_b16 v[64:65], v2 offset:4096
    ds_read_b64_tr_b16 v[66:67], v2 offset:4352
    ds_read_b64_tr_b16 v[68:69], v3 offset:4096
    ds_read_b64_tr_b16 v[70:71], v3 offset:4352
    ds_read_b64_tr_b16 v[72:73], v2 offset:6144
    ds_read_b64_tr_b16 v[74:75], v2 offset:6400
    ds_read_b64_tr_b16 v[76:77], v3 offset:6144
    ds_read_b64_tr_b16 v[78:79], v3 offset:6400
    s_waitcnt lgkmcnt(4)
    v_mfma_f32_16x16x32_bf16 v[80:83], v[64:67], v[16:19], v[80:83]
    v_mfma_f32_16x16x32_bf16 v[84:87], v[68:71], v[16:19], v[84:87]
    s_waitcnt lgkmcnt(0)
    v_mfma_f32_16x16x32_bf16 v[80:83], v[72:75], v[20:23], v[80:83]
    v_mfma_f32_16x16x32_bf16 v[84:87], v[76:79], v[20:23], v[84:87]
    s_cmp_eq_u32 s33, 0
    s_cbranch_scc1 L_C_red
    s_nop 4
    ds_write_b128 v4, v[80:83] offset:0
    ds_write_b128 v4, v[84:87] offset:1024
    v_mov_b32 v5, 1
    s_mov_b64 exec, 1
    ds_add_u32 v0, v5 offset:8
    s_mov_b64 exec, -1
    s_branch L_C_o
L_C_red:
L_w44:
    ds_read_b32 v5, v0 offset:8
    s_sub_u32 s3, s3, 1
    s_cbranch_scc1 L_end
    s_waitcnt lgkmcnt(0)
    v_cmp_gt_u32 vcc, 3, v5
    s_cbranch_vccnz L_w44
    ds_read_b128 v[48:51], v4 offset:3072
    ds_read_b128 v[52:55], v4 offset:4096
    ds_read_b128 v[56:59], v4 offset:6144
    ds_read_b128 v[60:63], v4 offset:7168
    ds_read_b128 v[64:67], v4 offset:9216
    ds_read_b128 v[68:71], v4 offset:10240
    ds_read_b32 v5, v0 offset:2020
    v_add_f32 v80, v80, v96
    v_add_f32 v81, v81, v97
    v_add_f32 v82, v82, v98
    v_add_f32 v83, v83, v99
    s_waitcnt lgkmcnt(0)
    v_pk_add_f32 v[80:81], v[80:81], v[48:49]
    v_pk_add_f32 v[56:57], v[56:57], v[64:65]
    v_pk_add_f32 v[82:83], v[82:83], v[50:51]
    v_pk_add_f32 v[58:59], v[58:59], v[66:67]
    v_pk_add_f32 v[84:85], v[84:85], v[52:53]
    v_pk_add_f32 v[60:61], v[60:61], v[68:69]
    v_pk_add_f32 v[86:87], v[86:87], v[54:55]
    v_pk_add_f32 v[62:63], v[62:63], v[70:71]
    v_pk_add_f32 v[80:81], v[80:81], v[56:57]
    v_pk_add_f32 v[82:83], v[82:83], v[58:59]
    v_pk_add_f32 v[84:85], v[84:85], v[60:61]
    v_pk_add_f32 v[86:87], v[86:87], v[62:63]
    v_cmp_gt_u32 vcc, 5, v5
    v_fmac_f32 v80, v84, v96
    v_fmac_f32 v81, v85, v97
    v_fmac_f32 v82, v86, v98
    v_fmac_f32 v83, v87, v99
    v_cvt_pk_bf16_f32 v80, v80, v81
    v_cvt_pk_bf16_f32 v81, v82, v83
    s_cbranch_vccz L_C_pub
L_w45:
    ds_read_b32 v5, v0 offset:2020
    s_sub_u32 s3, s3, 1
    s_cbranch_scc1 L_end
    s_waitcnt lgkmcnt(0)
    v_cmp_gt_u32 vcc, 5, v5
    s_cbranch_vccnz L_w45
L_C_pub:
    s_mov_b64 exec, s[56:57]
    buffer_store_dwordx2 v[80:81], v92, s[40:43], s39 offen sc1
    s_mov_b64 exec, -1
    v_mov_b32 v5, 4
    ds_write_b32 v0, v5 offset:5044
    ds_write_b32 v0, v5 offset:4
    s_branch L_C_o
L_Co:
    s_waitcnt lgkmcnt(0)
    s_mov_b32 s40, s30
    s_mov_b32 s41, s31
    s_mov_b32 s42, 16777216
    s_mov_b32 s43, 0x20000

    s_mov_b32 s3, 0x400000
    v_mov_b32 v0, 156256
    s_and_b32 s62, s34, 3
    s_lshl2_add_u32 s97, s62, s37
    s_lshl4_add_u32 s61, s36, s97

    s_barrier
    s_cmp_lt_u32 s34, 4
    s_cbranch_scc1 L_C_nt
    s_cmp_lg_u32 s33, 0
    s_cbranch_scc1 L_C_nt
    v_lshrrev_b32 v2, 1, v1
    v_and_b32 v3, 1, v1
    s_lshl2_add_u32 s38, s33, s34
    s_sub_u32 s38, s38, 4
    v_lshl_add_u32 v2, v2, 6, v3
    s_lshl_b32 s38, s38, 10
    s_add_u32 s38, s38, s35
    s_lshl_b32 s38, s38, 8
    v_lshl_add_u32 v2, v2, 7, s38
    s_mov_b64 exec, 1
    global_load_dword v166, v2, s[10:11]
    s_mov_b64 exec, -1
    s_waitcnt vmcnt(0)
    global_load_dword v166, v2, s[10:11]
    s_mov_b64 exec, -1
    v_mov_b32 v3, 1
    s_mov_b64 exec, 1
    ds_add_u32 v0, v3 offset:4
    s_mov_b64 exec, -1
L_C_nt:
    s_cmp_ge_u32 s34, 4
    s_cbranch_scc1 L_C_at
    s_mul_i32 s63, s34, 3
    s_add_u32 s63, s63, s33
    s_sub_u32 s63, s63, 3
    s_cmp_eq_u32 s33, 3
    s_cbranch_scc1 L_C_o
    s_cmp_eq_u32 s63, 8
    s_cbranch_scc1 L_C_qs
    s_mov_b32 s44, s10
    s_mov_b32 s45, s11
    s_mov_b32 s46, 4194304
    s_mov_b32 s47, 0x20000

    v_lshrrev_b32 v3, 4, v1
    v_and_b32 v2, 15, v1
    v_xor_b32 v4, v2, v3
    v_lshlrev_b32 v4, 4, v4
    v_lshl_add_u32 v4, v3, 13, v4
    v_xor_b32 v5, 64, v4
    v_xor_b32 v6, 0x80, v4
    v_xor_b32 v7, 0xc0, v4
    s_lshl_b32 s48, s63, 19
    s_lshl_b32 s38, s35, 8
    s_add_u32 s48, s48, s38
    s_lshl_b32 s51, s33, 14
    s_add_u32 s51, s51, 65536
    v_lshlrev_b32 v12, 4, v1
    v_mov_b32 v8, -1
    v_mov_b32 v9, -1
    v_mov_b32 v10, -1
    v_mov_b32 v11, -1
    s_lshl3_add_u32 s38, s35, s63
    s_lshl_b32 s38, s38, 12
    s_add_u32 s52, s38, 1048576
    s_lshr_b32 s53, s38, 4
    s_add_u32 s53, s53, 983040
    s_mov_b64 exec, 0xffff
    buffer_store_dwordx4 v[8:11], v12, s[40:43], s53 offen sc1
    s_mov_b64 exec, -1
    buffer_store_dwordx4 v[8:11], v12, s[40:43], s52 offen offset:0 sc1
    buffer_store_dwordx4 v[8:11], v12, s[40:43], s52 offen offset:1024 sc1
    buffer_store_dwordx4 v[8:11], v12, s[40:43], s52 offen offset:2048 sc1
    buffer_store_dwordx4 v[8:11], v12, s[40:43], s52 offen offset:3072 sc1
L_w46:
    s_sleep 1
    ds_read_b32 v13, v0 offset:0
    s_sub_u32 s3, s3, 1
    s_cbranch_scc1 L_end
    s_waitcnt lgkmcnt(0)
    v_cmp_gt_u32 vcc, 4, v13
    s_cbranch_vccnz L_w46
    s_add_u32 m0, s51, 0
    s_add_u32 s38, s48, 0
    buffer_load_dwordx4 v4, s[44:47], s38 offen nt lds
    s_add_u32 m0, s51, 1024
    s_add_u32 s38, s48, 131072
    buffer_load_dwordx4 v5, s[44:47], s38 offen nt lds
    s_add_u32 m0, s51, 2048
    s_add_u32 s38, s48, 262144
    buffer_load_dwordx4 v6, s[44:47], s38 offen nt lds
    s_add_u32 m0, s51, 3072
    s_add_u32 s38, s48, 393216
    buffer_load_dwordx4 v7, s[44:47], s38 offen nt lds
    s_add_u32 m0, s51, 4096
    s_add_u32 s38, s48, 32768
    buffer_load_dwordx4 v4, s[44:47], s38 offen nt lds
    s_add_u32 m0, s51, 5120
    s_add_u32 s38, s48, 163840
    buffer_load_dwordx4 v5, s[44:47], s38 offen nt lds
    s_add_u32 m0, s51, 6144
    s_add_u32 s38, s48, 294912
    buffer_load_dwordx4 v6, s[44:47], s38 offen nt lds
    s_add_u32 m0, s51, 7168
    s_add_u32 s38, s48, 425984
    buffer_load_dwordx4 v7, s[44:47], s38 offen nt lds
    s_add_u32 m0, s51, 8192
    s_add_u32 s38, s48, 65536
    buffer_load_dwordx4 v4, s[44:47], s38 offen nt lds
    s_add_u32 m0, s51, 9216
    s_add_u32 s38, s48, 196608
    buffer_load_dwordx4 v5, s[44:47], s38 offen nt lds
    s_add_u32 m0, s51, 10240
    s_add_u32 s38, s48, 327680
    buffer_load_dwordx4 v6, s[44:47], s38 offen nt lds
    s_add_u32 m0, s51, 11264
    s_add_u32 s38, s48, 458752
    buffer_load_dwordx4 v7, s[44:47], s38 offen nt lds
    s_add_u32 m0, s51, 12288
    s_add_u32 s38, s48, 98304
    buffer_load_dwordx4 v4, s[44:47], s38 offen nt lds
    s_add_u32 m0, s51, 13312
    s_add_u32 s38, s48, 229376
    buffer_load_dwordx4 v5, s[44:47], s38 offen nt lds
    s_add_u32 m0, s51, 14336
    s_add_u32 s38, s48, 360448
    buffer_load_dwordx4 v6, s[44:47], s38 offen nt lds
    s_add_u32 m0, s51, 15360
    s_add_u32 s38, s48, 491520
    buffer_load_dwordx4 v7, s[44:47], s38 offen nt lds
    v_mov_b32 v13, 1
    s_mov_b64 exec, 1
    ds_add_u32 v0, v13 offset:7068
    s_mov_b64 exec, -1

    v_lshlrev_b32 v4, 2, v3
    v_xor_b32 v4, v4, v2
    v_lshlrev_b32 v4, 4, v4
    v_lshl_add_u32 v4, v2, 8, v4
    v_add_u32 v4, s51, v4
    v_xor_b32 v5, 16, v4
    v_xor_b32 v6, 32, v4
    v_xor_b32 v7, 48, v4
    v_add_u32 v12, 131072, v12
    v_and_b32 v13, 1, v1
    v_lshlrev_b32 v14, 4, v13
    v_lshl_add_u32 v15, v3, 5, v14
    v_lshrrev_b32 v2, 1, v2
    v_lshl_add_u32 v15, v2, 15, v15
    s_mov_b32 s38, 0xffff
    v_lshlrev_b32 v14, v14, s38
    v_cmp_eq_u32 s[56:57], 1, v13
    s_lshl_b32 s49, s35, 10
    s_lshl_b32 s38, s63, 7
    s_add_u32 s49, s49, s38
    s_add_u32 s49, s49, 65536
    s_waitcnt vmcnt(0)
    ds_read_b128 v[104:107], v4 offset:0
    ds_read_b128 v[108:111], v5 offset:0
    ds_read_b128 v[112:115], v6 offset:0
    ds_read_b128 v[116:119], v7 offset:0
    s_waitcnt lgkmcnt(0)
    ds_read_b128 v[120:123], v4 offset:4096
    ds_read_b128 v[124:127], v5 offset:4096
    ds_read_b128 v[128:131], v6 offset:4096
    ds_read_b128 v[132:135], v7 offset:4096
    s_waitcnt lgkmcnt(0)
    ds_read_b128 v[136:139], v4 offset:8192
    ds_read_b128 v[140:143], v5 offset:8192
    ds_read_b128 v[144:147], v6 offset:8192
    ds_read_b128 v[148:151], v7 offset:8192
    s_waitcnt lgkmcnt(0)
    ds_read_b128 v[152:155], v4 offset:12288
    ds_read_b128 v[156:159], v5 offset:12288
    ds_read_b128 v[160:163], v6 offset:12288
    ds_read_b128 v[164:167], v7 offset:12288
    s_waitcnt lgkmcnt(0)
    s_setprio 2
L_w47:
    ds_read_b32 v5, v0 offset:5040
    s_sub_u32 s3, s3, 1
    s_cbranch_scc1 L_end
    s_waitcnt lgkmcnt(0)
    v_cmp_gt_u32 vcc, 4, v5
    s_cbranch_vccnz L_w47
    s_xor_b32 s38, s2, 8
    s_or_b32 s38, s38, s33
    s_cbranch_scc1 L_C_f2
    v_mov_b32 v5, 0
    s_mov_b64 exec, 1
    global_store_dword v5, v8, s[28:29] offset:128 sc1
    s_mov_b64 exec, -1
L_C_f2:
    ds_read_b128 v[40:43], v12 offset:0
    ds_read_b128 v[44:47], v12 offset:4096
    ds_read_b128 v[48:51], v12 offset:8192
    ds_read_b128 v[52:55], v12 offset:12288
    ds_read_b128 v[56:59], v12 offset:1024
    ds_read_b128 v[60:63], v12 offset:5120
    ds_read_b128 v[64:67], v12 offset:9216
    ds_read_b128 v[68:71], v12 offset:13312
    ds_read_b128 v[72:75], v12 offset:2048
    ds_read_b128 v[76:79], v12 offset:6144
    ds_read_b128 v[80:83], v12 offset:10240
    ds_read_b128 v[84:87], v12 offset:14336
    s_waitcnt lgkmcnt(8)
    ds_read_b128 v[88:91], v12 offset:3072
    ds_read_b128 v[92:95], v12 offset:7168
    ds_read_b128 v[96:99], v12 offset:11264
    ds_read_b128 v[100:103], v12 offset:15360
    s_waitcnt lgkmcnt(12)
    v_pk_add_f32 v[40:41], v[40:41], v[44:45]
    v_pk_add_f32 v[48:49], v[48:49], v[52:53]
    v_pk_add_f32 v[42:43], v[42:43], v[46:47]
    v_pk_add_f32 v[50:51], v[50:51], v[54:55]
    v_pk_add_f32 v[40:41], v[40:41], v[48:49]
    v_pk_add_f32 v[42:43], v[42:43], v[50:51]
    v_cvt_pk_bf16_f32 v40, v40, v40
    v_cvt_pk_bf16_f32 v41, v41, v41
    v_cvt_pk_bf16_f32 v42, v42, v42
    v_cvt_pk_bf16_f32 v43, v43, v43
    v_and_b32 v16, v40, v14
    v_and_b32 v20, v41, v14
    v_and_b32 v24, v42, v14
    v_and_b32 v28, v43, v14
    s_waitcnt lgkmcnt(8)
    v_pk_add_f32 v[56:57], v[56:57], v[60:61]
    v_pk_add_f32 v[64:65], v[64:65], v[68:69]
    v_pk_add_f32 v[58:59], v[58:59], v[62:63]
    v_pk_add_f32 v[66:67], v[66:67], v[70:71]
    v_pk_add_f32 v[56:57], v[56:57], v[64:65]
    v_pk_add_f32 v[58:59], v[58:59], v[66:67]
    v_cvt_pk_bf16_f32 v56, v56, v56
    v_cvt_pk_bf16_f32 v57, v57, v57
    v_cvt_pk_bf16_f32 v58, v58, v58
    v_cvt_pk_bf16_f32 v59, v59, v59
    v_and_b32 v17, v56, v14
    v_and_b32 v21, v57, v14
    v_and_b32 v25, v58, v14
    v_and_b32 v29, v59, v14
    s_waitcnt lgkmcnt(4)
    v_pk_add_f32 v[72:73], v[72:73], v[76:77]
    v_pk_add_f32 v[80:81], v[80:81], v[84:85]
    v_pk_add_f32 v[74:75], v[74:75], v[78:79]
    v_pk_add_f32 v[82:83], v[82:83], v[86:87]
    v_pk_add_f32 v[72:73], v[72:73], v[80:81]
    v_pk_add_f32 v[74:75], v[74:75], v[82:83]
    v_cvt_pk_bf16_f32 v72, v72, v72
    v_cvt_pk_bf16_f32 v73, v73, v73
    v_cvt_pk_bf16_f32 v74, v74, v74
    v_cvt_pk_bf16_f32 v75, v75, v75
    v_and_b32 v18, v72, v14
    v_and_b32 v22, v73, v14
    v_and_b32 v26, v74, v14
    v_and_b32 v30, v75, v14
    s_waitcnt lgkmcnt(0)
    v_pk_add_f32 v[88:89], v[88:89], v[92:93]
    v_pk_add_f32 v[96:97], v[96:97], v[100:101]
    v_pk_add_f32 v[90:91], v[90:91], v[94:95]
    v_pk_add_f32 v[98:99], v[98:99], v[102:103]
    v_pk_add_f32 v[88:89], v[88:89], v[96:97]
    v_pk_add_f32 v[90:91], v[90:91], v[98:99]
    v_cvt_pk_bf16_f32 v88, v88, v88
    v_cvt_pk_bf16_f32 v89, v89, v89
    v_cvt_pk_bf16_f32 v90, v90, v90
    v_cvt_pk_bf16_f32 v91, v91, v91
    v_and_b32 v19, v88, v14
    v_and_b32 v23, v89, v14
    v_and_b32 v27, v90, v14
    v_and_b32 v31, v91, v14
    v_mfma_f32_16x16x32_bf16 v[40:43], v[104:107], v[16:19], 0
    v_mfma_f32_16x16x32_bf16 v[44:47], v[120:123], v[16:19], 0
    v_mfma_f32_16x16x32_bf16 v[48:51], v[136:139], v[16:19], 0
    v_mfma_f32_16x16x32_bf16 v[52:55], v[152:155], v[16:19], 0
    v_mfma_f32_16x16x32_bf16 v[40:43], v[108:111], v[20:23], v[40:43]
    v_mfma_f32_16x16x32_bf16 v[44:47], v[124:127], v[20:23], v[44:47]
    v_mfma_f32_16x16x32_bf16 v[48:51], v[140:143], v[20:23], v[48:51]
    v_mfma_f32_16x16x32_bf16 v[52:55], v[156:159], v[20:23], v[52:55]
    v_mfma_f32_16x16x32_bf16 v[40:43], v[112:115], v[24:27], v[40:43]
    v_mfma_f32_16x16x32_bf16 v[44:47], v[128:131], v[24:27], v[44:47]
    v_mfma_f32_16x16x32_bf16 v[48:51], v[144:147], v[24:27], v[48:51]
    v_mfma_f32_16x16x32_bf16 v[52:55], v[160:163], v[24:27], v[52:55]
    v_mfma_f32_16x16x32_bf16 v[40:43], v[116:119], v[28:31], v[40:43]
    v_mfma_f32_16x16x32_bf16 v[44:47], v[132:135], v[28:31], v[44:47]
    v_mfma_f32_16x16x32_bf16 v[48:51], v[148:151], v[28:31], v[48:51]
    v_mfma_f32_16x16x32_bf16 v[52:55], v[164:167], v[28:31], v[52:55]
    s_nop 4
    v_add_f32_dpp v40, v40, v40 quad_perm:[1,0,3,2] row_mask:0xf bank_mask:0xf
    v_add_f32_dpp v41, v41, v41 quad_perm:[1,0,3,2] row_mask:0xf bank_mask:0xf
    v_add_f32_dpp v42, v42, v42 quad_perm:[1,0,3,2] row_mask:0xf bank_mask:0xf
    v_add_f32_dpp v43, v43, v43 quad_perm:[1,0,3,2] row_mask:0xf bank_mask:0xf
    v_add_f32_dpp v44, v44, v44 quad_perm:[1,0,3,2] row_mask:0xf bank_mask:0xf
    v_add_f32_dpp v45, v45, v45 quad_perm:[1,0,3,2] row_mask:0xf bank_mask:0xf
    v_add_f32_dpp v46, v46, v46 quad_perm:[1,0,3,2] row_mask:0xf bank_mask:0xf
    v_add_f32_dpp v47, v47, v47 quad_perm:[1,0,3,2] row_mask:0xf bank_mask:0xf
    v_add_f32_dpp v48, v48, v48 quad_perm:[1,0,3,2] row_mask:0xf bank_mask:0xf
    v_add_f32_dpp v49, v49, v49 quad_perm:[1,0,3,2] row_mask:0xf bank_mask:0xf
    v_add_f32_dpp v50, v50, v50 quad_perm:[1,0,3,2] row_mask:0xf bank_mask:0xf
    v_add_f32_dpp v51, v51, v51 quad_perm:[1,0,3,2] row_mask:0xf bank_mask:0xf
    v_add_f32_dpp v52, v52, v52 quad_perm:[1,0,3,2] row_mask:0xf bank_mask:0xf
    v_add_f32_dpp v53, v53, v53 quad_perm:[1,0,3,2] row_mask:0xf bank_mask:0xf
    v_add_f32_dpp v54, v54, v54 quad_perm:[1,0,3,2] row_mask:0xf bank_mask:0xf
    v_add_f32_dpp v55, v55, v55 quad_perm:[1,0,3,2] row_mask:0xf bank_mask:0xf
    v_cndmask_b32 v40, v40, v48, s[56:57]
    v_cndmask_b32 v41, v41, v49, s[56:57]
    v_cndmask_b32 v42, v42, v50, s[56:57]
    v_cndmask_b32 v43, v43, v51, s[56:57]
    v_cndmask_b32 v44, v44, v52, s[56:57]
    v_cndmask_b32 v45, v45, v53, s[56:57]
    v_cndmask_b32 v46, v46, v54, s[56:57]
    v_cndmask_b32 v47, v47, v55, s[56:57]
    v_cvt_pk_bf16_f32 v40, v40, v41
    v_cvt_pk_bf16_f32 v41, v42, v43
    v_cvt_pk_bf16_f32 v42, v44, v45
    v_cvt_pk_bf16_f32 v43, v46, v47
    buffer_store_dwordx4 v[40:43], v15, s[40:43], s49 offen sc1
L_C_qs:
    v_mov_b32 v5, 1
    s_mov_b64 exec, 1
    ds_add_u32 v0, v5 offset:5044
    s_mov_b64 exec, -1
L_C_o:
    s_setprio 0
    v_and_b32 v5, 15, v1
    s_mov_b32 s44, s14
    s_mov_b32 s45, s15
    s_mov_b32 s46, 4194304
    s_mov_b32 s47, 0x20000
    v_and_b32 v16, 1, v1
    v_lshlrev_b32 v16, 4, v16
    s_mov_b32 s38, 0xffff
    v_lshlrev_b32 v16, v16, s38
    v_bfe_u32 v17, v1, 1, 2
    v_cmp_eq_u32 vcc, 0, v17
    s_nop 1
    v_cndmask_b32 v20, 0, v16, vcc
    v_cmp_eq_u32 vcc, 1, v17
    s_nop 1
    v_cndmask_b32 v21, 0, v16, vcc
    v_cmp_eq_u32 vcc, 2, v17
    s_nop 1
    v_cndmask_b32 v22, 0, v16, vcc
    v_cmp_eq_u32 vcc, 3, v17
    s_nop 1
    v_cndmask_b32 v23, 0, v16, vcc

    s_mov_b32 s38, 0x3f803f80
    v_and_b32 v20, s38, v20
    v_and_b32 v21, s38, v21
    v_and_b32 v22, s38, v22
    v_and_b32 v23, s38, v23
    v_lshrrev_b32 v4, 4, v1
    v_lshlrev_b32 v7, 11, v4
    v_lshl_add_u32 v7, v5, 4, v7
    s_lshl_b32 s50, s35, 13
    s_lshl_b32 s38, s33, 8
    s_add_u32 s50, s50, s38
    s_add_u32 s50, s50, 1835008
    v_and_b32 v12, 1, v4
    v_lshrrev_b32 v13, 1, v4
    v_lshl_add_u32 v12, v12, 1, v13
    s_lshl_b32 s38, s33, 2
    v_add_u32 v12, s38, v12
    v_mul_u32_u24 v12, 528, v12
    v_lshl_add_u32 v18, v5, 4, v12
    v_lshlrev_b32 v13, 4, v13
    s_mov_b32 s38, 0xffff
    v_lshlrev_b32 v19, v13, s38
    v_mul_u32_u24 v3, 528, v5
    v_lshl_add_u32 v3, v4, 4, v3
    v_lshlrev_b32 v2, 12, v4
    v_lshl_add_u32 v2, v5, 3, v2
    v_lshlrev_b32 v4, 16, v4
    v_lshl_add_u32 v4, v5, 3, v4
    s_lshl1_add_u32 s38, s62, s33
    s_lshl_b32 s38, s38, 7
    s_lshl_b32 s48, s35, 17
    s_add_u32 s48, s48, s38
    s_lshl_b32 s49, s35, 10
    s_add_u32 s49, s49, s38
    s_add_u32 s49, s49, 1572864
    s_add_u32 s51, s49, 32768
    s_lshl_b32 s38, s62, 12
    s_lshl_b32 s60, s35, 7
    s_add_u32 s60, s60, s38
    s_add_u32 s60, s60, 983040
    s_cmp_ge_u32 s33, 2
    s_cbranch_scc1 L_C_o1
L_w48:
    s_sleep 1
    ds_read_b32 v6, v0 offset:5048
    s_sub_u32 s3, s3, 1
    s_cbranch_scc1 L_end
    s_waitcnt lgkmcnt(0)
    v_cmp_gt_u32 vcc, 4, v6
    s_cbranch_vccnz L_w48
    s_add_u32 s39, s48, 0
    buffer_load_dwordx2 v[104:105], v2, s[44:47], s39 offen nt
    s_add_u32 s39, s48, 1024
    buffer_load_dwordx2 v[108:109], v2, s[44:47], s39 offen nt
    s_add_u32 s39, s48, 2048
    buffer_load_dwordx2 v[106:107], v2, s[44:47], s39 offen nt
    s_add_u32 s39, s48, 3072
    buffer_load_dwordx2 v[110:111], v2, s[44:47], s39 offen nt
    s_add_u32 s39, s48, 16384
    buffer_load_dwordx2 v[112:113], v2, s[44:47], s39 offen nt
    s_add_u32 s39, s48, 17408
    buffer_load_dwordx2 v[116:117], v2, s[44:47], s39 offen nt
    s_add_u32 s39, s48, 18432
    buffer_load_dwordx2 v[114:115], v2, s[44:47], s39 offen nt
    s_add_u32 s39, s48, 19456
    buffer_load_dwordx2 v[118:119], v2, s[44:47], s39 offen nt
    s_add_u32 s39, s48, 32768
    buffer_load_dwordx2 v[120:121], v2, s[44:47], s39 offen nt
    s_add_u32 s39, s48, 33792
    buffer_load_dwordx2 v[124:125], v2, s[44:47], s39 offen nt
    s_add_u32 s39, s48, 34816
    buffer_load_dwordx2 v[122:123], v2, s[44:47], s39 offen nt
    s_add_u32 s39, s48, 35840
    buffer_load_dwordx2 v[126:127], v2, s[44:47], s39 offen nt
    s_add_u32 s39, s48, 49152
    buffer_load_dwordx2 v[128:129], v2, s[44:47], s39 offen nt
    s_add_u32 s39, s48, 50176
    buffer_load_dwordx2 v[132:133], v2, s[44:47], s39 offen nt
    s_add_u32 s39, s48, 51200
    buffer_load_dwordx2 v[130:131], v2, s[44:47], s39 offen nt
    s_add_u32 s39, s48, 52224
    buffer_load_dwordx2 v[134:135], v2, s[44:47], s39 offen nt
    s_add_u32 s39, s48, 65536
    buffer_load_dwordx2 v[136:137], v2, s[44:47], s39 offen nt
    s_add_u32 s39, s48, 66560
    buffer_load_dwordx2 v[140:141], v2, s[44:47], s39 offen nt
    s_add_u32 s39, s48, 67584
    buffer_load_dwordx2 v[138:139], v2, s[44:47], s39 offen nt
    s_add_u32 s39, s48, 68608
    buffer_load_dwordx2 v[142:143], v2, s[44:47], s39 offen nt
    s_add_u32 s39, s48, 81920
    buffer_load_dwordx2 v[144:145], v2, s[44:47], s39 offen nt
    s_add_u32 s39, s48, 82944
    buffer_load_dwordx2 v[148:149], v2, s[44:47], s39 offen nt
    s_add_u32 s39, s48, 83968
    buffer_load_dwordx2 v[146:147], v2, s[44:47], s39 offen nt
    s_add_u32 s39, s48, 84992
    buffer_load_dwordx2 v[150:151], v2, s[44:47], s39 offen nt
    s_add_u32 s39, s48, 98304
    buffer_load_dwordx2 v[152:153], v2, s[44:47], s39 offen nt
    s_add_u32 s39, s48, 99328
    buffer_load_dwordx2 v[156:157], v2, s[44:47], s39 offen nt
    s_add_u32 s39, s48, 100352
    buffer_load_dwordx2 v[154:155], v2, s[44:47], s39 offen nt
    s_add_u32 s39, s48, 101376
    buffer_load_dwordx2 v[158:159], v2, s[44:47], s39 offen nt
    s_add_u32 s39, s48, 114688
    buffer_load_dwordx2 v[160:161], v2, s[44:47], s39 offen nt
    s_add_u32 s39, s48, 115712
    buffer_load_dwordx2 v[164:165], v2, s[44:47], s39 offen nt
    s_add_u32 s39, s48, 116736
    buffer_load_dwordx2 v[162:163], v2, s[44:47], s39 offen nt
    s_add_u32 s39, s48, 117760
    buffer_load_dwordx2 v[166:167], v2, s[44:47], s39 offen nt
    s_waitcnt vmcnt(31)
    s_waitcnt vmcnt(0)
    v_mov_b32 v6, 1
    s_mov_b64 exec, 1
    ds_add_u32 v0, v6 offset:6060
    s_mov_b64 exec, -1
    v_swap_b32 v105, v108
    v_swap_b32 v107, v110
    v_swap_b32 v113, v116
    v_swap_b32 v115, v118
    v_swap_b32 v121, v124
    v_swap_b32 v123, v126
    v_swap_b32 v129, v132
    v_swap_b32 v131, v134
    v_swap_b32 v137, v140
    v_swap_b32 v139, v142
    v_swap_b32 v145, v148
    v_swap_b32 v147, v150
    v_swap_b32 v153, v156
    v_swap_b32 v155, v158
    v_swap_b32 v161, v164
    v_swap_b32 v163, v166
L_C_o1:
L_w49:
    s_sleep 1
    ds_read_b32 v6, v0 offset:6048
    s_sub_u32 s3, s3, 1
    s_cbranch_scc1 L_end
    s_waitcnt lgkmcnt(0)
    v_cmp_gt_u32 vcc, 4, v6
    s_cbranch_vccnz L_w49
    s_setprio 2
L_w50:
    ds_read_b32 v6, v0 offset:6052
    s_sub_u32 s3, s3, 1
    s_cbranch_scc1 L_end
    s_waitcnt lgkmcnt(0)
    v_cmp_gt_u32 vcc, 2, v6
    s_cbranch_vccnz L_w50
L_C_x:
    buffer_load_dwordx4 v[40:43], v7, s[40:43], s50 offen sc1
    buffer_load_dwordx4 v[44:47], v7, s[40:43], s50 offen offset:1024 sc1
    s_sub_u32 s3, s3, 1
    s_cbranch_scc1 L_end
    s_waitcnt vmcnt(1)
    v_mfma_f32_16x16x32_bf16 v[24:27], v[20:23], v[40:43], 0
    s_waitcnt vmcnt(0)
    v_mfma_f32_16x16x32_bf16 v[28:31], v[20:23], v[44:47], 0
    v_max3_u32 v12, v40, v41, v42
    v_max3_u32 v12, v12, v43, v44
    v_max3_u32 v12, v12, v45, v46
    v_max_u32 v12, v12, v47
    v_cmp_eq_u32 vcc, -1, v12
    s_cbranch_vccnz L_C_x
    v_cvt_pk_bf16_f32 v24, v24, v24
    v_cvt_pk_bf16_f32 v25, v25, v25
    v_cvt_pk_bf16_f32 v26, v26, v26
    v_cvt_pk_bf16_f32 v27, v27, v27
    v_and_b32 v24, v24, v19
    v_and_b32 v25, v25, v19
    v_and_b32 v26, v26, v19
    v_and_b32 v27, v27, v19
    ds_write_b128 v18, v[24:27] offset:0
    v_cvt_pk_bf16_f32 v28, v28, v28
    v_cvt_pk_bf16_f32 v29, v29, v29
    v_cvt_pk_bf16_f32 v30, v30, v30
    v_cvt_pk_bf16_f32 v31, v31, v31
    v_and_b32 v28, v28, v19
    v_and_b32 v29, v29, v19
    v_and_b32 v30, v30, v19
    v_and_b32 v31, v31, v19
    ds_write_b128 v18, v[28:31] offset:256
    v_mov_b32 v6, 1
    s_mov_b64 exec, 1
    ds_add_u32 v0, v6 offset:6056
    s_mov_b64 exec, -1
    s_cmp_lt_u32 s33, 2
    s_cbranch_scc1 L_C_o2
    s_cmp_lg_u32 s33, 2
    s_cbranch_scc1 L_C_nh
    v_lshlrev_b32 v12, 14, v1
    s_mov_b64 exec, 15
    buffer_store_dword v12, v12, s[40:43], s60 offen sc1
    s_mov_b64 exec, -1
L_C_nh:
    s_branch L_end
L_C_o2:
L_w51:
    ds_read_b32 v6, v0 offset:6056
    s_sub_u32 s3, s3, 1
    s_cbranch_scc1 L_end
    s_waitcnt lgkmcnt(0)
    v_cmp_gt_u32 vcc, 4, v6
    s_cbranch_vccnz L_w51
    ds_read_b128 v[40:43], v3 offset:0
    ds_read_b128 v[44:47], v3 offset:64
    ds_read_b128 v[48:51], v3 offset:128
    ds_read_b128 v[52:55], v3 offset:192
    ds_read_b128 v[56:59], v3 offset:256
    ds_read_b128 v[60:63], v3 offset:320
    ds_read_b128 v[64:67], v3 offset:384
    ds_read_b128 v[68:71], v3 offset:448
    s_waitcnt lgkmcnt(7)
    v_mfma_f32_16x16x32_bf16 v[24:27], v[40:43], v[104:107], 0
    v_mfma_f32_16x16x32_bf16 v[28:31], v[40:43], v[108:111], 0
    s_waitcnt lgkmcnt(6)
    v_mfma_f32_16x16x32_bf16 v[24:27], v[44:47], v[112:115], v[24:27]
    v_mfma_f32_16x16x32_bf16 v[28:31], v[44:47], v[116:119], v[28:31]
    s_waitcnt lgkmcnt(5)
    v_mfma_f32_16x16x32_bf16 v[24:27], v[48:51], v[120:123], v[24:27]
    v_mfma_f32_16x16x32_bf16 v[28:31], v[48:51], v[124:127], v[28:31]
    s_waitcnt lgkmcnt(4)
    v_mfma_f32_16x16x32_bf16 v[24:27], v[52:55], v[128:131], v[24:27]
    v_mfma_f32_16x16x32_bf16 v[28:31], v[52:55], v[132:135], v[28:31]
    s_waitcnt lgkmcnt(3)
    v_mfma_f32_16x16x32_bf16 v[24:27], v[56:59], v[136:139], v[24:27]
    v_mfma_f32_16x16x32_bf16 v[28:31], v[56:59], v[140:143], v[28:31]
    s_waitcnt lgkmcnt(2)
    v_mfma_f32_16x16x32_bf16 v[24:27], v[60:63], v[144:147], v[24:27]
    v_mfma_f32_16x16x32_bf16 v[28:31], v[60:63], v[148:151], v[28:31]
    s_waitcnt lgkmcnt(1)
    v_mfma_f32_16x16x32_bf16 v[24:27], v[64:67], v[152:155], v[24:27]
    v_mfma_f32_16x16x32_bf16 v[28:31], v[64:67], v[156:159], v[28:31]
    s_waitcnt lgkmcnt(0)
    v_mfma_f32_16x16x32_bf16 v[24:27], v[68:71], v[160:163], v[24:27]
    v_mfma_f32_16x16x32_bf16 v[28:31], v[68:71], v[164:167], v[28:31]
    s_nop 6
    v_cvt_pk_bf16_f32 v8, v24, v25
    v_cvt_pk_bf16_f32 v10, v26, v27
    v_cvt_pk_bf16_f32 v9, v28, v29
    v_cvt_pk_bf16_f32 v11, v30, v31
    buffer_store_dwordx2 v[8:9], v4, s[40:43], s49 offen sc1
    buffer_store_dwordx2 v[10:11], v4, s[40:43], s51 offen sc1
    s_branch L_end
L_C_at:

    v_lshrrev_b32 v7, 5, v1
    v_bfe_u32 v2, v1, 2, 2
    v_lshl_add_u32 v3, v7, 2, v2
    v_lshrrev_b32 v2, 1, v2
    v_lshl_or_b32 v2, v2, 2, v7
    v_bfe_u32 v4, v1, 4, 1
    v_bfe_u32 v5, v1, 1, 1
    v_lshl_or_b32 v4, v4, 1, v5
    v_xor_b32 v2, v2, v4
    v_lshlrev_b32 v2, 4, v2
    v_lshl_add_u32 v2, v3, 7, v2
    v_and_b32 v3, 1, v1
    v_lshl_add_u32 v2, v3, 3, v2
    s_and_b32 s38, s33, 1
    s_lshl_b32 s38, s38, 6
    s_lshr_b32 s39, s33, 1
    s_lshl_b32 s39, s39, 14
    s_or_b32 s38, s38, s39
    v_xor_b32 v2, s38, v2
    v_xor_b32 v3, 1056, v2
    v_lshlrev_b32 v4, 4, v1
    v_add_u32 v4, 131072, v4
    s_waitcnt vmcnt(0)
L_w452:
    s_sleep 1
    ds_read_b128 v[8:11], v0 offset:4032
    s_sub_u32 s3, s3, 1
    s_cbranch_scc1 L_end
    s_waitcnt lgkmcnt(0)
    v_min3_u32 v8, v8, v9, v10
    v_min_u32 v8, v8, v11
    v_cmp_gt_u32 vcc, 2, v8
    s_cbranch_vccnz L_w452
    ds_read_b64_tr_b16 v[40:41], v2 offset:0
    ds_read_b64_tr_b16 v[42:43], v3 offset:0
    ds_read_b64_tr_b16 v[44:45], v2 offset:2048
    ds_read_b64_tr_b16 v[46:47], v3 offset:2048
    ds_read_b64_tr_b16 v[48:49], v2 offset:4096
    ds_read_b64_tr_b16 v[50:51], v3 offset:4096
    ds_read_b64_tr_b16 v[52:53], v2 offset:6144
    ds_read_b64_tr_b16 v[54:55], v3 offset:6144
    ds_read_b64_tr_b16 v[56:57], v2 offset:8192
    ds_read_b64_tr_b16 v[58:59], v3 offset:8192
    ds_read_b64_tr_b16 v[60:61], v2 offset:10240
    ds_read_b64_tr_b16 v[62:63], v3 offset:10240
    s_waitcnt lgkmcnt(6)
    ds_read_b64_tr_b16 v[64:65], v2 offset:12288
    ds_read_b64_tr_b16 v[66:67], v3 offset:12288
    ds_read_b64_tr_b16 v[68:69], v2 offset:14336
    ds_read_b64_tr_b16 v[70:71], v3 offset:14336
    v_mov_b32 v5, 1
    s_mov_b64 exec, 1
    ds_add_u32 v0, v5 offset:3024
    s_mov_b64 exec, -1
L_w453:
    s_sleep 1
    ds_read_b128 v[8:11], v0 offset:4032
    s_sub_u32 s3, s3, 1
    s_cbranch_scc1 L_end
    s_waitcnt lgkmcnt(0)
    v_min3_u32 v8, v8, v9, v10
    v_min_u32 v8, v8, v11
    v_cmp_gt_u32 vcc, 4, v8
    s_cbranch_vccnz L_w453
    ds_read_b64_tr_b16 v[72:73], v2 offset:32768
    ds_read_b64_tr_b16 v[74:75], v3 offset:32768
    ds_read_b64_tr_b16 v[76:77], v2 offset:34816
    ds_read_b64_tr_b16 v[78:79], v3 offset:34816
    ds_read_b64_tr_b16 v[80:81], v2 offset:36864
    ds_read_b64_tr_b16 v[82:83], v3 offset:36864
    ds_read_b64_tr_b16 v[84:85], v2 offset:38912
    ds_read_b64_tr_b16 v[86:87], v3 offset:38912
    ds_read_b64_tr_b16 v[88:89], v2 offset:40960
    ds_read_b64_tr_b16 v[90:91], v3 offset:40960
    ds_read_b64_tr_b16 v[92:93], v2 offset:43008
    ds_read_b64_tr_b16 v[94:95], v3 offset:43008
    s_waitcnt lgkmcnt(6)
    ds_read_b64_tr_b16 v[96:97], v2 offset:45056
    ds_read_b64_tr_b16 v[98:99], v3 offset:45056
    ds_read_b64_tr_b16 v[100:101], v2 offset:47104
    ds_read_b64_tr_b16 v[102:103], v3 offset:47104
    v_mov_b32 v5, 1
    s_mov_b64 exec, 1
    ds_add_u32 v0, v5 offset:3028
    s_mov_b64 exec, -1
L_w454:
    s_sleep 1
    ds_read_b128 v[8:11], v0 offset:4032
    s_sub_u32 s3, s3, 1
    s_cbranch_scc1 L_end
    s_waitcnt lgkmcnt(0)
    v_min3_u32 v8, v8, v9, v10
    v_min_u32 v8, v8, v11
    v_cmp_gt_u32 vcc, 6, v8
    s_cbranch_vccnz L_w454
    v_add_u32 v2, 0x10000, v2
    v_add_u32 v3, 0x10000, v3
    ds_read_b64_tr_b16 v[104:105], v2 offset:0
    ds_read_b64_tr_b16 v[106:107], v3 offset:0
    ds_read_b64_tr_b16 v[108:109], v2 offset:2048
    ds_read_b64_tr_b16 v[110:111], v3 offset:2048
    ds_read_b64_tr_b16 v[112:113], v2 offset:4096
    ds_read_b64_tr_b16 v[114:115], v3 offset:4096
    ds_read_b64_tr_b16 v[116:117], v2 offset:6144
    ds_read_b64_tr_b16 v[118:119], v3 offset:6144
    ds_read_b64_tr_b16 v[120:121], v2 offset:8192
    ds_read_b64_tr_b16 v[122:123], v3 offset:8192
    ds_read_b64_tr_b16 v[124:125], v2 offset:10240
    ds_read_b64_tr_b16 v[126:127], v3 offset:10240
    s_waitcnt lgkmcnt(6)
    ds_read_b64_tr_b16 v[128:129], v2 offset:12288
    ds_read_b64_tr_b16 v[130:131], v3 offset:12288
    ds_read_b64_tr_b16 v[132:133], v2 offset:14336
    ds_read_b64_tr_b16 v[134:135], v3 offset:14336
    v_mov_b32 v5, 1
    s_mov_b64 exec, 1
    ds_add_u32 v0, v5 offset:3032
    s_mov_b64 exec, -1
L_w455:
    s_sleep 1
    ds_read_b128 v[8:11], v0 offset:4032
    s_sub_u32 s3, s3, 1
    s_cbranch_scc1 L_end
    s_waitcnt lgkmcnt(0)
    v_min3_u32 v8, v8, v9, v10
    v_min_u32 v8, v8, v11
    v_cmp_gt_u32 vcc, 8, v8
    s_cbranch_vccnz L_w455
    ds_read_b64_tr_b16 v[136:137], v2 offset:32768
    ds_read_b64_tr_b16 v[138:139], v3 offset:32768
    ds_read_b64_tr_b16 v[140:141], v2 offset:34816
    ds_read_b64_tr_b16 v[142:143], v3 offset:34816
    ds_read_b64_tr_b16 v[144:145], v2 offset:36864
    ds_read_b64_tr_b16 v[146:147], v3 offset:36864
    ds_read_b64_tr_b16 v[148:149], v2 offset:38912
    ds_read_b64_tr_b16 v[150:151], v3 offset:38912
    ds_read_b64_tr_b16 v[152:153], v2 offset:40960
    ds_read_b64_tr_b16 v[154:155], v3 offset:40960
    ds_read_b64_tr_b16 v[156:157], v2 offset:43008
    ds_read_b64_tr_b16 v[158:159], v3 offset:43008
    s_waitcnt lgkmcnt(6)
    ds_read_b64_tr_b16 v[160:161], v2 offset:45056
    ds_read_b64_tr_b16 v[162:163], v3 offset:45056
    ds_read_b64_tr_b16 v[164:165], v2 offset:47104
    ds_read_b64_tr_b16 v[166:167], v3 offset:47104
    v_mov_b32 v5, 1
    s_mov_b64 exec, 1
    ds_add_u32 v0, v5 offset:3036
    s_mov_b64 exec, -1
    v_subrev_u32 v2, 0x10000, v2
    v_subrev_u32 v3, 0x10000, v3
L_w56:
    s_sleep 2
    ds_read_b32 v5, v0 offset:1008
    s_sub_u32 s3, s3, 1
    s_cbranch_scc1 L_end
    s_waitcnt lgkmcnt(0)
    v_cmp_gt_u32 vcc, 4, v5
    s_cbranch_vccnz L_w56
    s_setprio 1
L_w57:
    s_sleep 1
    ds_read_b32 v5, v0 offset:1016
    s_sub_u32 s3, s3, 1
    s_cbranch_scc1 L_end
    s_waitcnt lgkmcnt(0)
    v_cmp_gt_u32 vcc, 1, v5
    s_cbranch_vccnz L_w57
L_w58:
    ds_read_b32 v5, v0 offset:1016
    s_sub_u32 s3, s3, 1
    s_cbranch_scc1 L_end
    s_waitcnt lgkmcnt(0)
    v_cmp_gt_u32 vcc, 4, v5
    s_cbranch_vccnz L_w58
    ds_read_b128 v[24:27], v4 offset:0
    ds_read_b128 v[28:31], v4 offset:1024
    ds_read_b128 v[32:35], v4 offset:2048
    ds_read_b128 v[36:39], v4 offset:3072
    s_waitcnt lgkmcnt(3)
    v_mfma_f32_32x32x16_bf16 v[8:23], v[24:27], v[40:43], 0
    ds_read_b128 v[24:27], v4 offset:4096
    s_waitcnt lgkmcnt(3)
    v_mfma_f32_32x32x16_bf16 v[8:23], v[28:31], v[44:47], v[8:23]
    ds_read_b128 v[28:31], v4 offset:5120
    s_waitcnt lgkmcnt(3)
    v_mfma_f32_32x32x16_bf16 v[8:23], v[32:35], v[48:51], v[8:23]
    ds_read_b128 v[32:35], v4 offset:6144
    s_waitcnt lgkmcnt(3)
    v_mfma_f32_32x32x16_bf16 v[8:23], v[36:39], v[52:55], v[8:23]
    ds_read_b128 v[36:39], v4 offset:7168
    s_waitcnt lgkmcnt(3)
    v_mfma_f32_32x32x16_bf16 v[8:23], v[24:27], v[56:59], v[8:23]
    ds_read_b128 v[24:27], v4 offset:0
    s_waitcnt lgkmcnt(3)
    v_mfma_f32_32x32x16_bf16 v[8:23], v[28:31], v[60:63], v[8:23]
    ds_read_b128 v[28:31], v4 offset:1024
    s_waitcnt lgkmcnt(3)
    v_mfma_f32_32x32x16_bf16 v[8:23], v[32:35], v[64:67], v[8:23]
    ds_read_b128 v[32:35], v4 offset:2048
    s_waitcnt lgkmcnt(3)
    v_mfma_f32_32x32x16_bf16 v[8:23], v[36:39], v[68:71], v[8:23]
    ds_read_b128 v[36:39], v4 offset:3072
    s_waitcnt lgkmcnt(3)
    v_mfma_f32_32x32x16_bf16 v[40:55], v[24:27], v[72:75], 0
    ds_read_b128 v[24:27], v4 offset:4096
    s_waitcnt lgkmcnt(3)
    v_mfma_f32_32x32x16_bf16 v[40:55], v[28:31], v[76:79], v[40:55]
    ds_read_b128 v[28:31], v4 offset:5120
    s_waitcnt lgkmcnt(3)
    v_mfma_f32_32x32x16_bf16 v[40:55], v[32:35], v[80:83], v[40:55]
    ds_read_b128 v[32:35], v4 offset:6144
    s_waitcnt lgkmcnt(3)
    v_mfma_f32_32x32x16_bf16 v[40:55], v[36:39], v[84:87], v[40:55]
    ds_read_b128 v[36:39], v4 offset:7168
    s_waitcnt lgkmcnt(3)
    v_mfma_f32_32x32x16_bf16 v[40:55], v[24:27], v[88:91], v[40:55]
    ds_read_b128 v[24:27], v4 offset:0
    s_waitcnt lgkmcnt(3)
    v_mfma_f32_32x32x16_bf16 v[40:55], v[28:31], v[92:95], v[40:55]
    ds_read_b128 v[28:31], v4 offset:1024
    s_waitcnt lgkmcnt(3)
    v_mfma_f32_32x32x16_bf16 v[40:55], v[32:35], v[96:99], v[40:55]
    ds_read_b128 v[32:35], v4 offset:2048
    s_waitcnt lgkmcnt(3)
    v_mfma_f32_32x32x16_bf16 v[40:55], v[36:39], v[100:103], v[40:55]
    ds_read_b128 v[36:39], v4 offset:3072
    s_waitcnt lgkmcnt(3)
    v_mfma_f32_32x32x16_bf16 v[56:71], v[24:27], v[104:107], 0
    ds_read_b128 v[24:27], v4 offset:4096
    s_waitcnt lgkmcnt(3)
    v_mfma_f32_32x32x16_bf16 v[56:71], v[28:31], v[108:111], v[56:71]
    ds_read_b128 v[28:31], v4 offset:5120
    s_waitcnt lgkmcnt(3)
    v_mfma_f32_32x32x16_bf16 v[56:71], v[32:35], v[112:115], v[56:71]
    ds_read_b128 v[32:35], v4 offset:6144
    s_waitcnt lgkmcnt(3)
    v_mfma_f32_32x32x16_bf16 v[56:71], v[36:39], v[116:119], v[56:71]
    ds_read_b128 v[36:39], v4 offset:7168
    s_waitcnt lgkmcnt(3)
    v_mfma_f32_32x32x16_bf16 v[56:71], v[24:27], v[120:123], v[56:71]
    ds_read_b128 v[24:27], v4 offset:0
    s_waitcnt lgkmcnt(3)
    v_mfma_f32_32x32x16_bf16 v[56:71], v[28:31], v[124:127], v[56:71]
    ds_read_b128 v[28:31], v4 offset:1024
    s_waitcnt lgkmcnt(3)
    v_mfma_f32_32x32x16_bf16 v[56:71], v[32:35], v[128:131], v[56:71]
    ds_read_b128 v[32:35], v4 offset:2048
    s_waitcnt lgkmcnt(3)
    v_mfma_f32_32x32x16_bf16 v[56:71], v[36:39], v[132:135], v[56:71]
    ds_read_b128 v[36:39], v4 offset:3072
    s_waitcnt lgkmcnt(3)
    v_mfma_f32_32x32x16_bf16 v[72:87], v[24:27], v[136:139], 0
    ds_read_b128 v[24:27], v4 offset:4096
    s_waitcnt lgkmcnt(3)
    v_mfma_f32_32x32x16_bf16 v[72:87], v[28:31], v[140:143], v[72:87]
    ds_read_b128 v[28:31], v4 offset:5120
    s_waitcnt lgkmcnt(3)
    v_mfma_f32_32x32x16_bf16 v[72:87], v[32:35], v[144:147], v[72:87]
    ds_read_b128 v[32:35], v4 offset:6144
    s_waitcnt lgkmcnt(3)
    v_mfma_f32_32x32x16_bf16 v[72:87], v[36:39], v[148:151], v[72:87]
    ds_read_b128 v[36:39], v4 offset:7168
    s_waitcnt lgkmcnt(3)
    v_mfma_f32_32x32x16_bf16 v[72:87], v[24:27], v[152:155], v[72:87]
    s_waitcnt lgkmcnt(2)
    v_mfma_f32_32x32x16_bf16 v[72:87], v[28:31], v[156:159], v[72:87]
    s_waitcnt lgkmcnt(1)
    v_mfma_f32_32x32x16_bf16 v[72:87], v[32:35], v[160:163], v[72:87]
    s_waitcnt lgkmcnt(0)
    v_mfma_f32_32x32x16_bf16 v[72:87], v[36:39], v[164:167], v[72:87]

    v_lshlrev_b32 v32, 4, v7
    v_add_u32 v32, 147968, v32
    v_bfe_u32 v36, v1, 4, 1
    v_lshrrev_b32 v37, 5, v1
    v_lshl_add_u32 v36, v37, 2, v36
    v_lshlrev_b32 v36, 14, v36
    v_and_b32 v37, 15, v1
    v_lshl_add_u32 v36, v37, 3, v36
    s_lshl_b32 s55, s36, 19
    s_lshl2_add_u32 s38, s97, s33
    s_lshl_b32 s38, s38, 8
    s_add_u32 s55, s55, s38
    s_add_u32 s55, s55, 2097152
    v_lshlrev_b32 v37, 2, v37
    v_add_u32 v37, 149504, v37
    v_mov_b32 v38, -1
    ds_write_b32 v37, v38
L_w459:
    s_sleep 1
    ds_read_b128 v[24:27], v0 offset:4032
    s_sub_u32 s3, s3, 1
    s_cbranch_scc1 L_end
    s_waitcnt lgkmcnt(0)
    v_min3_u32 v24, v24, v25, v26
    v_min_u32 v24, v24, v27
    v_cmp_gt_u32 vcc, 16, v24
    s_cbranch_vccnz L_w459
    ds_read_b64_tr_b16 v[136:137], v2 offset:0
    ds_read_b64_tr_b16 v[138:139], v3 offset:0
    ds_read_b64_tr_b16 v[140:141], v2 offset:2048
    ds_read_b64_tr_b16 v[142:143], v3 offset:2048
    ds_read_b64_tr_b16 v[144:145], v2 offset:4096
    ds_read_b64_tr_b16 v[146:147], v3 offset:4096
    ds_read_b64_tr_b16 v[148:149], v2 offset:6144
    ds_read_b64_tr_b16 v[150:151], v3 offset:6144
L_w60:
    ds_read_b32 v5, v0 offset:1020
    s_sub_u32 s3, s3, 1
    s_cbranch_scc1 L_end
    s_waitcnt lgkmcnt(0)
    v_cmp_gt_u32 vcc, 1, v5
    s_cbranch_vccnz L_w60
    ds_read_b128 v[88:91], v32 offset:0
    ds_read_b128 v[92:95], v32 offset:32
    ds_read_b128 v[96:99], v32 offset:64
    ds_read_b128 v[100:103], v32 offset:96
    s_waitcnt lgkmcnt(0)
    v_pk_mul_f32 v[8:9], v[8:9], v[88:89]
    v_pk_mul_f32 v[10:11], v[10:11], v[90:91]
    v_pk_mul_f32 v[12:13], v[12:13], v[92:93]
    v_pk_mul_f32 v[14:15], v[14:15], v[94:95]
    v_pk_mul_f32 v[16:17], v[16:17], v[96:97]
    v_pk_mul_f32 v[18:19], v[18:19], v[98:99]
    v_pk_mul_f32 v[20:21], v[20:21], v[100:101]
    v_pk_mul_f32 v[22:23], v[22:23], v[102:103]
    v_pk_mul_f32 v[40:41], v[40:41], v[88:89]
    v_pk_mul_f32 v[42:43], v[42:43], v[90:91]
    v_pk_mul_f32 v[44:45], v[44:45], v[92:93]
    v_pk_mul_f32 v[46:47], v[46:47], v[94:95]
    v_pk_mul_f32 v[48:49], v[48:49], v[96:97]
    v_pk_mul_f32 v[50:51], v[50:51], v[98:99]
    v_pk_mul_f32 v[52:53], v[52:53], v[100:101]
    v_pk_mul_f32 v[54:55], v[54:55], v[102:103]
    v_pk_mul_f32 v[56:57], v[56:57], v[88:89]
    v_pk_mul_f32 v[58:59], v[58:59], v[90:91]
    v_pk_mul_f32 v[60:61], v[60:61], v[92:93]
    v_pk_mul_f32 v[62:63], v[62:63], v[94:95]
    v_pk_mul_f32 v[64:65], v[64:65], v[96:97]
    v_pk_mul_f32 v[66:67], v[66:67], v[98:99]
    v_pk_mul_f32 v[68:69], v[68:69], v[100:101]
    v_pk_mul_f32 v[70:71], v[70:71], v[102:103]
    v_pk_mul_f32 v[72:73], v[72:73], v[88:89]
    v_pk_mul_f32 v[74:75], v[74:75], v[90:91]
    v_pk_mul_f32 v[76:77], v[76:77], v[92:93]
    v_pk_mul_f32 v[78:79], v[78:79], v[94:95]
    v_pk_mul_f32 v[80:81], v[80:81], v[96:97]
    v_pk_mul_f32 v[82:83], v[82:83], v[98:99]
    v_pk_mul_f32 v[84:85], v[84:85], v[100:101]
    v_pk_mul_f32 v[86:87], v[86:87], v[102:103]
L_w61:
    ds_read_b32 v5, v0 offset:1016
    s_sub_u32 s3, s3, 1
    s_cbranch_scc1 L_end
    s_waitcnt lgkmcnt(0)
    v_cmp_gt_u32 vcc, 8, v5
    s_cbranch_vccnz L_w61
    s_setprio 3
    ds_read_b128 v[104:107], v4 offset:8192
    ds_read_b128 v[108:111], v4 offset:9216
    ds_read_b128 v[112:115], v4 offset:10240
    ds_read_b128 v[116:119], v4 offset:11264
    ds_read_b128 v[120:123], v4 offset:12288
    ds_read_b128 v[124:127], v4 offset:13312
    ds_read_b128 v[128:131], v4 offset:14336
    ds_read_b128 v[132:135], v4 offset:15360
    ds_read_b64_tr_b16 v[152:153], v2 offset:8192
    ds_read_b64_tr_b16 v[154:155], v3 offset:8192
    s_waitcnt lgkmcnt(9)
    v_mfma_f32_32x32x16_bf16 v[8:23], v[104:107], v[136:139], v[8:23]
    ds_read_b64_tr_b16 v[156:157], v2 offset:10240
    ds_read_b64_tr_b16 v[158:159], v3 offset:10240
    s_waitcnt lgkmcnt(10)
    v_mfma_f32_32x32x16_bf16 v[8:23], v[108:111], v[140:143], v[8:23]
    ds_read_b64_tr_b16 v[160:161], v2 offset:12288
    ds_read_b64_tr_b16 v[162:163], v3 offset:12288
    s_waitcnt lgkmcnt(11)
    v_mfma_f32_32x32x16_bf16 v[8:23], v[112:115], v[144:147], v[8:23]
    ds_read_b64_tr_b16 v[136:137], v2 offset:14336
    ds_read_b64_tr_b16 v[138:139], v3 offset:14336
    s_waitcnt lgkmcnt(12)
    v_mfma_f32_32x32x16_bf16 v[8:23], v[116:119], v[148:151], v[8:23]
    s_waitcnt lgkmcnt(11)
    ds_read_b64_tr_b16 v[140:141], v2 offset:32768
    ds_read_b64_tr_b16 v[142:143], v3 offset:32768
    s_waitcnt lgkmcnt(8)
    v_mfma_f32_32x32x16_bf16 v[8:23], v[120:123], v[152:155], v[8:23]
    ds_read_b64_tr_b16 v[144:145], v2 offset:34816
    ds_read_b64_tr_b16 v[146:147], v3 offset:34816
    s_waitcnt lgkmcnt(8)
    v_mfma_f32_32x32x16_bf16 v[8:23], v[124:127], v[156:159], v[8:23]
    ds_read_b64_tr_b16 v[148:149], v2 offset:36864
    ds_read_b64_tr_b16 v[150:151], v3 offset:36864
    s_waitcnt lgkmcnt(8)
    v_mfma_f32_32x32x16_bf16 v[8:23], v[128:131], v[160:163], v[8:23]
    ds_read_b64_tr_b16 v[152:153], v2 offset:38912
    ds_read_b64_tr_b16 v[154:155], v3 offset:38912
    s_waitcnt lgkmcnt(8)
    v_mfma_f32_32x32x16_bf16 v[8:23], v[132:135], v[136:139], v[8:23]
    ds_read_b64_tr_b16 v[156:157], v2 offset:40960
    ds_read_b64_tr_b16 v[158:159], v3 offset:40960
    s_waitcnt lgkmcnt(8)
    v_mfma_f32_32x32x16_bf16 v[40:55], v[104:107], v[140:143], v[40:55]
    ds_read_b64_tr_b16 v[160:161], v2 offset:43008
    ds_read_b64_tr_b16 v[162:163], v3 offset:43008
    s_waitcnt lgkmcnt(8)
    v_mfma_f32_32x32x16_bf16 v[40:55], v[108:111], v[144:147], v[40:55]
    ds_read_b64_tr_b16 v[136:137], v2 offset:45056
    ds_read_b64_tr_b16 v[138:139], v3 offset:45056
    s_waitcnt lgkmcnt(8)
    v_mfma_f32_32x32x16_bf16 v[40:55], v[112:115], v[148:151], v[40:55]
    ds_read_b64_tr_b16 v[140:141], v2 offset:47104
    ds_read_b64_tr_b16 v[142:143], v3 offset:47104
    s_waitcnt lgkmcnt(8)
    v_mfma_f32_32x32x16_bf16 v[40:55], v[116:119], v[152:155], v[40:55]
    v_add_u32 v2, 0x10000, v2
    v_add_u32 v3, 0x10000, v3
    ds_read_b64_tr_b16 v[144:145], v2 offset:0
    ds_read_b64_tr_b16 v[146:147], v3 offset:0
    s_waitcnt lgkmcnt(8)
    v_mfma_f32_32x32x16_bf16 v[40:55], v[120:123], v[156:159], v[40:55]
    ds_write_b32 v0, v38 offset:7060
    ds_read_b64_tr_b16 v[148:149], v2 offset:2048
    ds_read_b64_tr_b16 v[150:151], v3 offset:2048
    s_waitcnt lgkmcnt(9)
    v_mfma_f32_32x32x16_bf16 v[40:55], v[124:127], v[160:163], v[40:55]
    ds_read_b64_tr_b16 v[152:153], v2 offset:4096
    ds_read_b64_tr_b16 v[154:155], v3 offset:4096
    s_waitcnt lgkmcnt(9)
    v_mfma_f32_32x32x16_bf16 v[40:55], v[128:131], v[136:139], v[40:55]
    ds_read_b64_tr_b16 v[156:157], v2 offset:6144
    ds_read_b64_tr_b16 v[158:159], v3 offset:6144
    s_waitcnt lgkmcnt(9)
    v_mfma_f32_32x32x16_bf16 v[40:55], v[132:135], v[140:143], v[40:55]
    ds_read_b64_tr_b16 v[160:161], v2 offset:8192
    ds_read_b64_tr_b16 v[162:163], v3 offset:8192
    s_waitcnt lgkmcnt(9)
    v_mfma_f32_32x32x16_bf16 v[56:71], v[104:107], v[144:147], v[56:71]
L_w62:
    ds_read_b32 v5, v0 offset:2024
    s_sub_u32 s3, s3, 1
    s_cbranch_scc1 L_end
    s_waitcnt lgkmcnt(0)
    v_cmp_gt_u32 vcc, 4, v5
    s_cbranch_vccnz L_w62
    ds_read_b64_tr_b16 v[136:137], v2 offset:10240
    ds_read_b64_tr_b16 v[138:139], v3 offset:10240
    s_waitcnt lgkmcnt(8)
    v_mfma_f32_32x32x16_bf16 v[56:71], v[108:111], v[148:151], v[56:71]
    ds_read_b64_tr_b16 v[140:141], v2 offset:12288
    ds_read_b64_tr_b16 v[142:143], v3 offset:12288
    s_waitcnt lgkmcnt(8)
    v_mfma_f32_32x32x16_bf16 v[56:71], v[112:115], v[152:155], v[56:71]
    ds_read_b64_tr_b16 v[144:145], v2 offset:14336
    ds_read_b64_tr_b16 v[146:147], v3 offset:14336
    v_cvt_pk_bf16_f32 v88, v8, v40
    v_cvt_pk_bf16_f32 v89, v9, v41
    s_waitcnt lgkmcnt(8)
    v_mfma_f32_32x32x16_bf16 v[56:71], v[116:119], v[156:159], v[56:71]
    s_add_u32 s38, s55, 0
    v_permlane16_swap_b32 v88, v89
    buffer_store_dwordx2 v[88:89], v36, s[40:43], s38 offen offset:0 sc1
    ds_read_b64_tr_b16 v[148:149], v2 offset:32768
    ds_read_b64_tr_b16 v[150:151], v3 offset:32768
    v_cvt_pk_bf16_f32 v90, v10, v42
    v_cvt_pk_bf16_f32 v91, v11, v43
    s_waitcnt lgkmcnt(8)
    v_mfma_f32_32x32x16_bf16 v[56:71], v[120:123], v[160:163], v[56:71]
    s_add_u32 s38, s55, 32768
    v_permlane16_swap_b32 v90, v91
    buffer_store_dwordx2 v[90:91], v36, s[40:43], s38 offen offset:0 sc1
    ds_read_b64_tr_b16 v[152:153], v2 offset:34816
    ds_read_b64_tr_b16 v[154:155], v3 offset:34816
    v_cvt_pk_bf16_f32 v92, v12, v44
    v_cvt_pk_bf16_f32 v93, v13, v45
    s_waitcnt lgkmcnt(8)
    v_mfma_f32_32x32x16_bf16 v[56:71], v[124:127], v[136:139], v[56:71]
    s_add_u32 s38, s55, 131072
    v_permlane16_swap_b32 v92, v93
    buffer_store_dwordx2 v[92:93], v36, s[40:43], s38 offen offset:0 sc1
    ds_read_b64_tr_b16 v[156:157], v2 offset:36864
    ds_read_b64_tr_b16 v[158:159], v3 offset:36864
    v_cvt_pk_bf16_f32 v94, v14, v46
    v_cvt_pk_bf16_f32 v95, v15, v47
    s_waitcnt lgkmcnt(8)
    v_mfma_f32_32x32x16_bf16 v[56:71], v[128:131], v[140:143], v[56:71]
    s_add_u32 s38, s55, 163840
    v_permlane16_swap_b32 v94, v95
    buffer_store_dwordx2 v[94:95], v36, s[40:43], s38 offen offset:0 sc1
    ds_read_b64_tr_b16 v[160:161], v2 offset:38912
    ds_read_b64_tr_b16 v[162:163], v3 offset:38912
    v_cvt_pk_bf16_f32 v96, v16, v48
    v_cvt_pk_bf16_f32 v97, v17, v49
    s_waitcnt lgkmcnt(8)
    v_mfma_f32_32x32x16_bf16 v[56:71], v[132:135], v[144:147], v[56:71]
    s_add_u32 s38, s55, 262144
    v_permlane16_swap_b32 v96, v97
    buffer_store_dwordx2 v[96:97], v36, s[40:43], s38 offen offset:0 sc1
    ds_read_b64_tr_b16 v[136:137], v2 offset:40960
    ds_read_b64_tr_b16 v[138:139], v3 offset:40960
    v_cvt_pk_bf16_f32 v98, v18, v50
    v_cvt_pk_bf16_f32 v99, v19, v51
    s_waitcnt lgkmcnt(8)
    v_mfma_f32_32x32x16_bf16 v[72:87], v[104:107], v[148:151], v[72:87]
    s_add_u32 s38, s55, 294912
    v_permlane16_swap_b32 v98, v99
    buffer_store_dwordx2 v[98:99], v36, s[40:43], s38 offen offset:0 sc1
    ds_read_b64_tr_b16 v[140:141], v2 offset:43008
    ds_read_b64_tr_b16 v[142:143], v3 offset:43008
    v_cvt_pk_bf16_f32 v100, v20, v52
    v_cvt_pk_bf16_f32 v101, v21, v53
    s_waitcnt lgkmcnt(8)
    v_mfma_f32_32x32x16_bf16 v[72:87], v[108:111], v[152:155], v[72:87]
    s_add_u32 s38, s55, 393216
    v_permlane16_swap_b32 v100, v101
    buffer_store_dwordx2 v[100:101], v36, s[40:43], s38 offen offset:0 sc1
    ds_read_b64_tr_b16 v[144:145], v2 offset:45056
    ds_read_b64_tr_b16 v[146:147], v3 offset:45056
    v_cvt_pk_bf16_f32 v102, v22, v54
    v_cvt_pk_bf16_f32 v103, v23, v55
    s_waitcnt lgkmcnt(8)
    v_mfma_f32_32x32x16_bf16 v[72:87], v[112:115], v[156:159], v[72:87]
    s_add_u32 s38, s55, 425984
    v_permlane16_swap_b32 v102, v103
    buffer_store_dwordx2 v[102:103], v36, s[40:43], s38 offen offset:0 sc1
    ds_read_b64_tr_b16 v[148:149], v2 offset:47104
    ds_read_b64_tr_b16 v[150:151], v3 offset:47104
    s_waitcnt lgkmcnt(8)
    v_mfma_f32_32x32x16_bf16 v[72:87], v[116:119], v[160:163], v[72:87]
    s_waitcnt lgkmcnt(6)
    v_mfma_f32_32x32x16_bf16 v[72:87], v[120:123], v[136:139], v[72:87]
    s_waitcnt lgkmcnt(4)
    v_mfma_f32_32x32x16_bf16 v[72:87], v[124:127], v[140:143], v[72:87]
    s_waitcnt lgkmcnt(2)
    v_mfma_f32_32x32x16_bf16 v[72:87], v[128:131], v[144:147], v[72:87]
    s_waitcnt lgkmcnt(0)
    v_mfma_f32_32x32x16_bf16 v[72:87], v[132:135], v[148:151], v[72:87]
    s_nop 11
    v_cvt_pk_bf16_f32 v136, v56, v72
    v_cvt_pk_bf16_f32 v137, v57, v73
    v_cvt_pk_bf16_f32 v138, v58, v74
    v_cvt_pk_bf16_f32 v139, v59, v75
    s_add_u32 s38, s55, 0
    v_permlane16_swap_b32 v136, v137
    buffer_store_dwordx2 v[136:137], v36, s[40:43], s38 offen offset:128 sc1
    v_cvt_pk_bf16_f32 v140, v60, v76
    v_cvt_pk_bf16_f32 v141, v61, v77
    s_add_u32 s38, s55, 32768
    v_permlane16_swap_b32 v138, v139
    buffer_store_dwordx2 v[138:139], v36, s[40:43], s38 offen offset:128 sc1
    v_cvt_pk_bf16_f32 v142, v62, v78
    v_cvt_pk_bf16_f32 v143, v63, v79
    s_add_u32 s38, s55, 131072
    v_permlane16_swap_b32 v140, v141
    buffer_store_dwordx2 v[140:141], v36, s[40:43], s38 offen offset:128 sc1
    v_cvt_pk_bf16_f32 v144, v64, v80
    v_cvt_pk_bf16_f32 v145, v65, v81
    s_add_u32 s38, s55, 163840
    v_permlane16_swap_b32 v142, v143
    buffer_store_dwordx2 v[142:143], v36, s[40:43], s38 offen offset:128 sc1
    v_cvt_pk_bf16_f32 v146, v66, v82
    v_cvt_pk_bf16_f32 v147, v67, v83
    s_add_u32 s38, s55, 262144
    v_permlane16_swap_b32 v144, v145
    buffer_store_dwordx2 v[144:145], v36, s[40:43], s38 offen offset:128 sc1
    v_cvt_pk_bf16_f32 v148, v68, v84
    v_cvt_pk_bf16_f32 v149, v69, v85
    s_add_u32 s38, s55, 294912
    v_permlane16_swap_b32 v146, v147
    buffer_store_dwordx2 v[146:147], v36, s[40:43], s38 offen offset:128 sc1
    v_cvt_pk_bf16_f32 v150, v70, v86
    v_cvt_pk_bf16_f32 v151, v71, v87
    s_add_u32 s38, s55, 393216
    v_permlane16_swap_b32 v148, v149
    buffer_store_dwordx2 v[148:149], v36, s[40:43], s38 offen offset:128 sc1
    s_add_u32 s38, s55, 425984
    v_permlane16_swap_b32 v150, v151
    buffer_store_dwordx2 v[150:151], v36, s[40:43], s38 offen offset:128 sc1
    v_mov_b32 v5, 1
    s_mov_b64 exec, 1
    ds_add_u32 v0, v5 offset:1012
    s_mov_b64 exec, -1
    s_setprio 0
    s_cmp_ge_u32 s35, 28
    s_cbranch_scc1 L_end
    v_lshrrev_b32 v6, 4, v1
    v_and_b32 v3, 15, v1
    v_bfe_u32 v8, v1, 2, 2
    v_lshl_add_u32 v9, v6, 3, v8
    v_and_b32 v10, 1, v6
    v_lshl_or_b32 v8, v10, 2, v8
    v_lshlrev_b32 v8, 5, v8
    v_lshl_add_u32 v8, v9, 8, v8
    v_and_b32 v9, 3, v1
    v_lshl_add_u32 v8, v9, 3, v8
    s_lshl_b32 s38, s33, 14
    s_add_u32 s38, s38, 65536
    v_add_u32 v2, s38, v8
    v_bfe_u32 v8, v1, 3, 1
    v_mul_u32_u24 v8, 144, v8
    v_lshl_add_u32 v8, v6, 4, v8
    v_add_u32 v4, 143552, v8
    v_lshlrev_b32 v7, 17, v7
    v_lshl_add_u32 v7, v3, 4, v7
    s_lshl_b32 s49, s62, 5
    s_add_u32 s49, s49, s35
    s_lshl2_add_u32 s49, s49, s33
    s_lshl_b32 s49, s49, 8
    s_add_u32 s49, s49, 1310720
    s_mov_b32 s44, s20
    s_mov_b32 s45, s21
    s_mov_b32 s46, 1835008
    s_mov_b32 s47, 0x20000
L_w63:
    s_sleep 1
    ds_read_b32 v5, v0 offset:1012
    s_sub_u32 s3, s3, 1
    s_cbranch_scc1 L_end
    s_waitcnt lgkmcnt(0)
    v_cmp_gt_u32 vcc, 5, v5
    s_cbranch_vccnz L_w63

    v_lshlrev_b32 v12, 1, v6
    v_xor_b32 v12, v12, v3
    v_lshlrev_b32 v12, 4, v12
    v_lshl_add_u32 v12, v6, 10, v12
    v_xor_b32 v13, 0x80, v12
    s_lshl_b32 s58, s35, 16
    s_lshl_b32 s38, s33, 8
    s_add_u32 s58, s58, s38
    s_lshl_b32 s57, s33, 14
    s_add_u32 s57, s57, 65536
    s_mov_b32 s56, s62
    s_mov_b32 s59, 0
L_A_f2:
    s_xor_b32 s38, s59, s56
    s_lshl_b32 s39, s38, 12
    s_add_u32 s39, s39, s57
    s_lshl_b32 s38, s38, 14
    s_add_u32 s38, s38, s58
    s_add_u32 m0, s39, 0
    s_add_u32 s60, s38, 0
    buffer_load_dwordx4 v12, s[44:47], s60 offen lds
    s_waitcnt vmcnt(3)
    s_add_u32 m0, s39, 1024
    s_add_u32 s60, s38, 4096
    buffer_load_dwordx4 v12, s[44:47], s60 offen lds
    s_waitcnt vmcnt(3)
    s_add_u32 m0, s39, 2048
    s_add_u32 s60, s38, 8192
    buffer_load_dwordx4 v13, s[44:47], s60 offen lds
    s_waitcnt vmcnt(3)
    s_add_u32 m0, s39, 3072
    s_add_u32 s60, s38, 12288
    buffer_load_dwordx4 v13, s[44:47], s60 offen lds
    s_waitcnt vmcnt(3)
    s_add_u32 s59, s59, 1
    s_cmp_lt_u32 s59, 4
    s_cbranch_scc1 L_A_f2
    v_mov_b32 v5, 1
    s_mov_b64 exec, 1
    ds_add_u32 v0, v5 offset:5044
    s_mov_b64 exec, -1
    s_waitcnt vmcnt(0)
    v_xor_b32 v5, 0, v2
    ds_read_b64_tr_b16 v[64:65], v5 offset:0
    ds_read_b64_tr_b16 v[66:67], v5 offset:1024
    ds_read_b64_tr_b16 v[96:97], v5 offset:8192
    ds_read_b64_tr_b16 v[98:99], v5 offset:9216
    v_xor_b32 v5, 32, v2
    ds_read_b64_tr_b16 v[68:69], v5 offset:0
    ds_read_b64_tr_b16 v[70:71], v5 offset:1024
    ds_read_b64_tr_b16 v[100:101], v5 offset:8192
    ds_read_b64_tr_b16 v[102:103], v5 offset:9216
    s_waitcnt lgkmcnt(4)
    v_xor_b32 v5, 64, v2
    ds_read_b64_tr_b16 v[72:73], v5 offset:0
    ds_read_b64_tr_b16 v[74:75], v5 offset:1024
    ds_read_b64_tr_b16 v[104:105], v5 offset:8192
    ds_read_b64_tr_b16 v[106:107], v5 offset:9216
    v_xor_b32 v5, 96, v2
    ds_read_b64_tr_b16 v[76:77], v5 offset:0
    ds_read_b64_tr_b16 v[78:79], v5 offset:1024
    ds_read_b64_tr_b16 v[108:109], v5 offset:8192
    ds_read_b64_tr_b16 v[110:111], v5 offset:9216
    s_waitcnt lgkmcnt(4)
    v_xor_b32 v5, 128, v2
    ds_read_b64_tr_b16 v[80:81], v5 offset:0
    ds_read_b64_tr_b16 v[82:83], v5 offset:1024
    ds_read_b64_tr_b16 v[112:113], v5 offset:8192
    ds_read_b64_tr_b16 v[114:115], v5 offset:9216
    v_xor_b32 v5, 160, v2
    ds_read_b64_tr_b16 v[84:85], v5 offset:0
    ds_read_b64_tr_b16 v[86:87], v5 offset:1024
    ds_read_b64_tr_b16 v[116:117], v5 offset:8192
    ds_read_b64_tr_b16 v[118:119], v5 offset:9216
    s_waitcnt lgkmcnt(4)
    v_xor_b32 v5, 192, v2
    ds_read_b64_tr_b16 v[88:89], v5 offset:0
    ds_read_b64_tr_b16 v[90:91], v5 offset:1024
    ds_read_b64_tr_b16 v[120:121], v5 offset:8192
    ds_read_b64_tr_b16 v[122:123], v5 offset:9216
    v_xor_b32 v5, 224, v2
    ds_read_b64_tr_b16 v[92:93], v5 offset:0
    ds_read_b64_tr_b16 v[94:95], v5 offset:1024
    ds_read_b64_tr_b16 v[124:125], v5 offset:8192
    ds_read_b64_tr_b16 v[126:127], v5 offset:9216
    s_waitcnt lgkmcnt(4)
L_w64:
    s_sleep 2
    ds_read_b32 v5, v0 offset:5052
    s_sub_u32 s3, s3, 1
    s_cbranch_scc1 L_end
    s_waitcnt lgkmcnt(0)
    v_cmp_gt_u32 vcc, 4, v5
    s_cbranch_vccnz L_w64
L_w65:
    ds_read_b32 v5, v0 offset:2016
    s_sub_u32 s3, s3, 1
    s_cbranch_scc1 L_end
    s_waitcnt lgkmcnt(0)
    v_cmp_gt_u32 vcc, 4, v5
    s_cbranch_vccnz L_w65
    ds_read_b128 v[8:11], v4
    ds_read_b128 v[12:15], v4 offset:64
    s_waitcnt lgkmcnt(0)
    v_mfma_f32_16x16x32_bf16 v[32:35], v[8:11], v[64:67], 0
    v_mfma_f32_16x16x32_bf16 v[36:39], v[8:11], v[68:71], 0
    v_mfma_f32_16x16x32_bf16 v[32:35], v[12:15], v[96:99], v[32:35]
    v_mfma_f32_16x16x32_bf16 v[36:39], v[12:15], v[100:103], v[36:39]
    v_mfma_f32_16x16x32_bf16 v[40:43], v[8:11], v[72:75], 0
    v_mfma_f32_16x16x32_bf16 v[44:47], v[8:11], v[76:79], 0
    v_mfma_f32_16x16x32_bf16 v[40:43], v[12:15], v[104:107], v[40:43]
    v_mfma_f32_16x16x32_bf16 v[44:47], v[12:15], v[108:111], v[44:47]
    v_mfma_f32_16x16x32_bf16 v[48:51], v[8:11], v[80:83], 0
    v_mfma_f32_16x16x32_bf16 v[52:55], v[8:11], v[84:87], 0
    v_mfma_f32_16x16x32_bf16 v[48:51], v[12:15], v[112:115], v[48:51]
    v_mfma_f32_16x16x32_bf16 v[52:55], v[12:15], v[116:119], v[52:55]
    v_mfma_f32_16x16x32_bf16 v[56:59], v[8:11], v[88:91], 0
    v_mfma_f32_16x16x32_bf16 v[60:63], v[8:11], v[92:95], 0
    v_mfma_f32_16x16x32_bf16 v[56:59], v[12:15], v[120:123], v[56:59]
    v_mfma_f32_16x16x32_bf16 v[60:63], v[12:15], v[124:127], v[60:63]
    v_cvt_pk_bf16_f32 v28, v32, v36
    v_cvt_pk_bf16_f32 v29, v40, v44
    s_nop 1
    v_cvt_pk_bf16_f32 v30, v48, v52
    s_nop 2
    v_cvt_pk_bf16_f32 v31, v56, v60
    s_mov_b32 exec_lo, 0xffff
    s_mov_b32 exec_hi, 0xffff
    buffer_store_dwordx4 v[28:31], v7, s[40:43], s49 offen sc1
L_end:
L_exit:
    s_endpgm
L_codeend:
.section .rodata,"a"
.p2align 6
.amdhsa_kernel adaLN_cond__compressed_kv_cla__dense_activation_relu__decode_kernel
.amdhsa_next_free_vgpr 168
.amdhsa_next_free_sgpr 102
.amdhsa_accum_offset 168
.amdhsa_group_segment_fixed_size 0
.amdhsa_kernarg_size 112
.amdhsa_user_sgpr_count 2
.amdhsa_user_sgpr_kernarg_segment_ptr 1
.amdhsa_system_sgpr_workgroup_id_x 1
.amdhsa_float_denorm_mode_32 3
.end_amdhsa_kernel
.text
```

```asm
; @launch grid=(256,1,1) block=(768,1,1) lds=163840
.amdgcn_target "amdgcn-amd-amdhsa--gfx950"
.text
.globl adaLN_cond__compressed_kv_cla__dense_activation_relu__decode_kernel
.p2align 8
.type adaLN_cond__compressed_kv_cla__dense_activation_relu__decode_kernel,@function
adaLN_cond__compressed_kv_cla__dense_activation_relu__decode_kernel:

    s_cmpk_ge_u32 s2, 256
    s_cbranch_scc1 L_exit
    s_load_dwordx16 s[4:19], s[0:1], 0
    s_load_dwordx8 s[20:27], s[0:1], 64
    s_load_dwordx4 s[28:31], s[0:1], 96
    v_lshrrev_b32 v2, 6, v0
    v_and_b32 v1, 63, v0
    v_readfirstlane_b32 s32, v2

    s_lshr_b32 s37, s2, 3
    s_getpc_b64 s[52:53]
L_pc:
    s_mul_i32 s38, s37, 12
    s_add_u32 s38, s38, s32
    s_lshl_b32 s38, s38, 7
    s_min_u32 s38, s38, L_codeend-L_pc-4
    v_mov_b32 v2, s38
    global_load_dword v167, v2, s[52:53]
    s_and_b32 s36, s2, 7
    s_and_b32 s34, s37, 7
    s_lshr_b32 s37, s37, 3
    s_lshl3_add_u32 s35, s37, s36
    s_and_b32 s33, s32, 3
    s_cmp_lt_u32 s32, 4
    s_cbranch_scc1 L_pA
    s_cmp_lt_u32 s32, 8
    s_cbranch_scc1 L_pB
    s_cmp_eq_u32 s34, 0
    s_cbranch_scc1 L_Cs
    s_branch L_Co
L_pB:
    s_cmp_lt_u32 s34, 4
    s_cbranch_scc1 L_Bc
    s_branch L_Be
L_pA:
    s_lshr_b32 s38, s34, 2
    s_or_b32 s38, s38, s32
    s_cbranch_scc0 L_pT
    s_lshl3_add_u32 s38, s32, s34
    s_cmp_lg_u32 s38, 8
    s_cbranch_scc1 L_A
    v_lshlrev_b32 v2, 7, v1
    s_waitcnt lgkmcnt(0)
    global_load_dword v166, v2, s[22:23]
    global_load_dword v166, v2, s[4:5]
    s_branch L_A
L_pT:
    v_and_b32 v3, 1, v1
    v_lshrrev_b32 v2, 1, v1
    s_lshl2_add_u32 s38, s37, s34
    v_lshl_add_u32 v2, s38, 5, v2
    v_mul_u32_u24 v2, 6, v2
    v_add_u32 v2, v2, v3
    s_lshl_b32 s39, s36, 7
    v_lshl_add_u32 v2, v2, 10, s39
    s_waitcnt lgkmcnt(0)
    global_load_dword v166, v2, s[24:25]

L_A:
    v_mov_b32 v8, -1
    v_mov_b32 v9, -1
    v_mov_b32 v10, -1
    v_mov_b32 v11, -1
    v_lshlrev_b32 v14, 4, v1
    s_waitcnt lgkmcnt(0)

    s_mov_b32 s3, 0x400000
    v_mov_b32 v0, 156256
    s_and_b32 s62, s34, 3
    s_lshl2_add_u32 s97, s62, s37
    s_lshl4_add_u32 s61, s36, s97
    s_waitcnt lgkmcnt(0)

    s_mov_b32 s40, s30
    s_mov_b32 s41, s31
    s_mov_b32 s42, 16777216
    s_mov_b32 s43, 0x20000

    s_sub_u32 s98, s2, 40
    s_cmp_ge_u32 s98, 1
    s_cbranch_scc1 L_A_nx
    s_lshl2_add_u32 s38, s98, s33
    s_lshl_b32 s38, s38, 11
    buffer_store_dwordx4 v[8:11], v14, s[40:43], s38 offen offset:0 sc1
    buffer_store_dwordx4 v[8:11], v14, s[40:43], s38 offen offset:1024 sc1
L_A_nx:
    s_cmp_lg_u32 s34, 0
    s_cbranch_scc1 L_A_nc
    s_lshl2_add_u32 s55, s36, s37
    s_lshl2_add_u32 s38, s55, s33
    s_lshl_b32 s38, s38, 11
    s_add_u32 s38, s38, 65536
    buffer_store_dwordx4 v[8:11], v14, s[40:43], s38 offen offset:0 sc1
    buffer_store_dwordx4 v[8:11], v14, s[40:43], s38 offen offset:1024 sc1
L_A_nc:
    s_cmp_lg_u32 s33, 3
    s_cbranch_scc1 L_noinit
    v_mul_u32_u24 v13, 1008, v1
    v_mov_b32 v4, 0
    v_add_u32 v13, v13, v0
    v_mov_b32 v5, v4
    v_mov_b32 v6, v4
    v_mov_b32 v7, v4
    v_add_u32 v12, v14, v0
    s_mov_b64 exec, 0xff
    ds_write_b128 v13, v[4:7]
    s_mov_b32 exec_lo, -1
    ds_write_b128 v12, v[8:11] offset:7072
    s_mov_b64 exec, -1
L_noinit:
    s_cmp_lt_u32 s34, 4
    s_cbranch_scc1 L_AD
    s_mov_b32 s44, s6
    s_mov_b32 s45, s7
    s_mov_b32 s46, 33554432
    s_mov_b32 s47, 0x20000

    v_lshrrev_b32 v4, 3, v1
    v_bfe_u32 v5, v4, 1, 1
    v_lshlrev_b32 v5, 2, v5
    v_bfe_u32 v6, v4, 2, 1
    v_or_b32 v5, v5, v6
    v_and_b32 v6, 7, v1
    v_xor_b32 v5, v5, v6
    v_lshlrev_b32 v5, 4, v5
    v_lshl_add_u32 v2, v4, 10, v5
    v_xor_b32 v3, 32, v2
    s_lshl_b32 s48, s61, 18
    s_lshl_b32 s38, s33, 15
    s_add_u32 s48, s48, s38
    s_lshl_b32 s49, s33, 12
    s_mov_b32 s50, 0
    s_waitcnt lgkmcnt(0)
    s_barrier

    s_cmp_ge_u32 s98, 1
    s_cbranch_scc1 L_A_go
    s_waitcnt vmcnt(0)
    v_mov_b32 v12, 1
    s_mov_b64 exec, 1
    ds_add_u32 v0, v12 offset:8
    s_mov_b64 exec, -1
    s_cmp_lg_u32 s33, 2
    s_cbranch_scc1 L_A_go
    s_lshl_b32 s38, s98, 2
    v_mov_b32 v13, s38
L_w1:
    ds_read_b32 v12, v0 offset:8
    s_sub_u32 s3, s3, 1
    s_cbranch_scc1 L_end
    s_waitcnt lgkmcnt(0)
    v_cmp_gt_u32 vcc, 4, v12
    s_cbranch_vccnz L_w1
    s_mov_b64 exec, 1
    global_store_dword v13, v8, s[28:29] offset:32 sc1
    s_mov_b64 exec, -1
L_A_go:
L_w2:
    s_sleep 1
    ds_read_b32 v8, v0 offset:4
    s_sub_u32 s3, s3, 1
    s_cbranch_scc1 L_end
    s_waitcnt lgkmcnt(0)
    v_cmp_gt_u32 vcc, 4, v8
    s_cbranch_vccnz L_w2
    s_setprio 2
    s_lshl_b32 s38, s33, 2
    v_add_u32 v4, s38, v0
    v_mov_b32 v5, v0
    s_mov_b32 s53, 2
L_A_dma:
    s_and_b32 s38, s50, 9
    s_cmp_lg_u32 s38, 8
    s_cbranch_scc1 L_A_dma1
L_w3:
    ds_read_b32 v8, v5 offset:3024
    s_sub_u32 s3, s3, 1
    s_cbranch_scc1 L_end
    s_waitcnt lgkmcnt(0)
    v_cmp_gt_u32 vcc, 8, v8
    s_cbranch_vccnz L_w3
    v_add_u32 v5, 4, v5
    s_cmp_lg_u32 s50, 8
    s_cbranch_scc1 L_A_dma1
    s_add_u32 s48, s48, 130048
    s_sub_u32 s49, s49, 131072
L_A_dma1:
    s_cmp_lg_u32 s50, 8
    s_cbranch_scc1 L_A_dma2
    v_mov_b32 v8, 7
    s_waitcnt vmcnt(4)
    ds_write_b32 v4, v8 offset:4032
    v_mov_b32 v7, 8
    s_waitcnt vmcnt(0)
    ds_write_b32 v4, v7 offset:4032
L_w4:
    ds_read_b32 v8, v0 offset:2028
    s_sub_u32 s3, s3, 1
    s_cbranch_scc1 L_end
    s_waitcnt lgkmcnt(0)
    v_cmp_gt_u32 vcc, 4, v8
    s_cbranch_vccnz L_w4
    s_mov_b32 s53, 10
L_A_dma2:
    s_cmp_lg_u32 s50, 9
    s_cbranch_scc1 L_A_dma3
L_w5:
    ds_read_b32 v8, v0 offset:1008
    s_sub_u32 s3, s3, 1
    s_cbranch_scc1 L_end
    s_waitcnt lgkmcnt(0)
    v_cmp_gt_u32 vcc, 4, v8
    s_cbranch_vccnz L_w5
L_A_dma3:
    s_add_u32 m0, s49, 0
    s_add_u32 s38, s48, 0
    buffer_load_dwordx4 v2, s[44:47], s38 offen nt lds
    s_waitcnt vmcnt(7)
    s_add_u32 m0, s49, 1024
    s_add_u32 s38, s48, 8192
    buffer_load_dwordx4 v3, s[44:47], s38 offen nt lds
    s_waitcnt vmcnt(7)
    s_add_u32 m0, s49, 2048
    s_add_u32 s38, s48, 16384
    buffer_load_dwordx4 v2, s[44:47], s38 offen nt lds
    s_waitcnt vmcnt(7)
    s_add_u32 m0, s49, 3072
    s_add_u32 s38, s48, 24576
    buffer_load_dwordx4 v3, s[44:47], s38 offen nt lds
    s_waitcnt vmcnt(7)
    s_add_u32 s49, s49, 16384
    s_add_u32 s48, s48, 128
    s_add_u32 s50, s50, 1
    s_max_u32 s38, s50, s53
    s_sub_u32 s38, s38, 2
    v_mov_b32 v6, s38
    ds_write_b32 v4, v6 offset:4032
    s_cmp_lt_u32 s50, 12
    s_cbranch_scc1 L_A_dma
L_w6:
    ds_read_b32 v8, v0 offset:3032
    s_sub_u32 s3, s3, 1
    s_cbranch_scc1 L_end
    s_waitcnt lgkmcnt(0)
    v_cmp_gt_u32 vcc, 8, v8
    s_cbranch_vccnz L_w6
    s_add_u32 m0, s49, 0
    s_add_u32 s38, s48, 0
    buffer_load_dwordx4 v2, s[44:47], s38 offen nt lds
    s_add_u32 m0, s49, 1024
    s_add_u32 s38, s48, 8192
    buffer_load_dwordx4 v3, s[44:47], s38 offen nt lds
    s_add_u32 m0, s49, 2048
    s_add_u32 s38, s48, 16384
    buffer_load_dwordx4 v2, s[44:47], s38 offen nt lds
    v_mov_b32 v6, 12
    s_waitcnt vmcnt(3)
    ds_write_b32 v4, v6 offset:4032
    s_add_u32 m0, s49, 3072
    s_add_u32 s38, s48, 24576
    buffer_load_dwordx4 v3, s[44:47], s38 offen nt lds
    s_add_u32 m0, s49, 16384
    s_add_u32 s38, s48, 128
    buffer_load_dwordx4 v2, s[44:47], s38 offen nt lds
    s_add_u32 m0, s49, 17408
    s_add_u32 s38, s48, 8320
    buffer_load_dwordx4 v3, s[44:47], s38 offen nt lds
    s_add_u32 m0, s49, 18432
    s_add_u32 s38, s48, 16512
    buffer_load_dwordx4 v2, s[44:47], s38 offen nt lds
    v_mov_b32 v6, 13
    s_waitcnt vmcnt(3)
    ds_write_b32 v4, v6 offset:4032
    s_add_u32 m0, s49, 19456
    s_add_u32 s38, s48, 24704
    buffer_load_dwordx4 v3, s[44:47], s38 offen nt lds
L_w7:
    ds_read_b32 v8, v0 offset:3036
    s_sub_u32 s3, s3, 1
    s_cbranch_scc1 L_end
    s_waitcnt lgkmcnt(0)
    v_cmp_gt_u32 vcc, 8, v8
    s_cbranch_vccnz L_w7
    s_add_u32 m0, s49, 32768
    s_add_u32 s38, s48, 256
    buffer_load_dwordx4 v2, s[44:47], s38 offen nt lds
    s_add_u32 m0, s49, 33792
    s_add_u32 s38, s48, 8448
    buffer_load_dwordx4 v3, s[44:47], s38 offen nt lds
    s_add_u32 m0, s49, 34816
    s_add_u32 s38, s48, 16640
    buffer_load_dwordx4 v2, s[44:47], s38 offen nt lds
    v_mov_b32 v6, 14
    s_waitcnt vmcnt(3)
    ds_write_b32 v4, v6 offset:4032
    s_add_u32 m0, s49, 35840
    s_add_u32 s38, s48, 24832
    buffer_load_dwordx4 v3, s[44:47], s38 offen nt lds
    s_add_u32 m0, s49, 49152
    s_add_u32 s38, s48, 384
    buffer_load_dwordx4 v2, s[44:47], s38 offen nt lds
    s_add_u32 m0, s49, 50176
    s_add_u32 s38, s48, 8576
    buffer_load_dwordx4 v3, s[44:47], s38 offen nt lds
    s_add_u32 m0, s49, 51200
    s_add_u32 s38, s48, 16768
    buffer_load_dwordx4 v2, s[44:47], s38 offen nt lds
    v_mov_b32 v6, 15
    s_waitcnt vmcnt(3)
    ds_write_b32 v4, v6 offset:4032
    s_add_u32 m0, s49, 52224
    s_add_u32 s38, s48, 24960
    buffer_load_dwordx4 v3, s[44:47], s38 offen nt lds
    v_mov_b32 v7, 16
    s_waitcnt vmcnt(0)
    ds_write_b32 v4, v7 offset:4032
    v_bfe_u32 v16, v1, 4, 1
    v_lshrrev_b32 v17, 5, v1
    v_lshl_add_u32 v16, v17, 2, v16
    v_lshlrev_b32 v16, 14, v16
    v_and_b32 v17, 15, v1
    v_lshl_add_u32 v16, v17, 4, v16
    s_lshl_b32 s55, s36, 19
    s_lshl2_add_u32 s38, s97, s33
    s_lshl_b32 s38, s38, 8
    s_add_u32 s55, s55, s38
    s_add_u32 s55, s55, 2097152
    v_mov_b32 v20, -1
    v_mov_b32 v21, -1
    v_mov_b32 v22, -1
    v_mov_b32 v23, -1
    s_add_u32 s38, s55, 0
    buffer_store_dwordx4 v[20:23], v16, s[40:43], s38 offen sc1
    s_add_u32 s38, s55, 32768
    buffer_store_dwordx4 v[20:23], v16, s[40:43], s38 offen sc1
    s_add_u32 s38, s55, 131072
    buffer_store_dwordx4 v[20:23], v16, s[40:43], s38 offen sc1
    s_add_u32 s38, s55, 163840
    buffer_store_dwordx4 v[20:23], v16, s[40:43], s38 offen sc1
    s_add_u32 s38, s55, 262144
    buffer_store_dwordx4 v[20:23], v16, s[40:43], s38 offen sc1
    s_add_u32 s38, s55, 294912
    buffer_store_dwordx4 v[20:23], v16, s[40:43], s38 offen sc1
    s_add_u32 s38, s55, 393216
    buffer_store_dwordx4 v[20:23], v16, s[40:43], s38 offen sc1
    s_add_u32 s38, s55, 425984
    buffer_store_dwordx4 v[20:23], v16, s[40:43], s38 offen sc1
    s_waitcnt vmcnt(0)
    v_mov_b32 v12, 1
    s_mov_b64 exec, 1
    ds_add_u32 v0, v12 offset:2024
    s_mov_b64 exec, -1
    s_setprio 0
    s_cmp_ge_u32 s35, 28
    s_cbranch_scc1 L_end

    v_and_b32 v9, 31, v1
    v_lshrrev_b32 v10, 5, v1
    v_and_b32 v3, 15, v1
    v_lshrrev_b32 v6, 4, v1
    v_and_b32 v16, 1, v1
    v_lshlrev_b32 v16, 4, v16
    s_mov_b32 s38, 0xffff
    v_lshlrev_b32 v16, v16, s38
    v_bfe_u32 v17, v1, 1, 2
    v_cmp_eq_u32 vcc, 0, v17
    s_nop 1
    v_cndmask_b32 v20, 0, v16, vcc
    v_cmp_eq_u32 vcc, 1, v17
    s_nop 1
    v_cndmask_b32 v21, 0, v16, vcc
    v_cmp_eq_u32 vcc, 2, v17
    s_nop 1
    v_cndmask_b32 v22, 0, v16, vcc
    v_cmp_eq_u32 vcc, 3, v17
    s_nop 1
    v_cndmask_b32 v23, 0, v16, vcc
L_w8:
    s_sleep 2
    ds_read_b32 v12, v0 offset:5044
    s_sub_u32 s3, s3, 1
    s_cbranch_scc1 L_end
    s_waitcnt lgkmcnt(0)
    v_cmp_gt_u32 vcc, 8, v12
    s_cbranch_vccnz L_w8
    s_branch L_A_F
L_AD:
    s_waitcnt lgkmcnt(0)
    s_barrier
    s_cmp_ge_u32 s98, 1
    s_cbranch_scc1 L_AD_nx
    s_waitcnt vmcnt(0)
    v_mov_b32 v12, 1
    s_mov_b64 exec, 1
    ds_add_u32 v0, v12 offset:8
    s_mov_b64 exec, -1
    s_cmp_lg_u32 s33, 2
    s_cbranch_scc1 L_AD_nx
    s_lshl_b32 s38, s98, 2
    v_mov_b32 v13, s38
L_w9:
    ds_read_b32 v12, v0 offset:8
    s_sub_u32 s3, s3, 1
    s_cbranch_scc1 L_end
    s_waitcnt lgkmcnt(0)
    v_cmp_gt_u32 vcc, 4, v12
    s_cbranch_vccnz L_w9
    s_mov_b64 exec, 1
    global_store_dword v13, v8, s[28:29] offset:32 sc1
    s_mov_b64 exec, -1
L_AD_nx:
    s_cmp_lg_u32 s34, 0
    s_cbranch_scc1 L_AD0
    s_waitcnt vmcnt(0)
    v_mov_b32 v8, 1
    s_mov_b64 exec, 1
    ds_add_u32 v0, v8 offset:2020
    s_mov_b64 exec, -1
    s_cmp_lg_u32 s33, 1
    s_cbranch_scc1 L_AD0
L_w10:
    s_sleep 1
    ds_read_b32 v8, v0 offset:7056
    s_sub_u32 s3, s3, 1
    s_cbranch_scc1 L_end
    s_waitcnt lgkmcnt(0)
    v_cmp_gt_u32 vcc, 4, v8
    s_cbranch_vccnz L_w10
    v_and_b32 v4, 0, v1
    v_lshlrev_b32 v4, 2, v4
L_fl11:
    global_load_dword v5, v4, s[28:29] offset:32 sc1
    s_sub_u32 s3, s3, 1
    s_cbranch_scc1 L_end
    s_waitcnt vmcnt(0)
    v_cmp_eq_u32 vcc, 0, v5
    s_cbranch_vccnz L_fl11
    v_mov_b32 v8, 1
    s_mov_b64 exec, 1
    ds_add_u32 v0, v8 offset:2020
    s_mov_b64 exec, -1
L_AD0:
    s_mov_b32 s44, s6
    s_mov_b32 s45, s7
    s_mov_b32 s46, 33554432
    s_mov_b32 s47, 0x20000
    v_lshlrev_b32 v4, 10, v1
    s_lshl_b32 s51, s61, 18
    s_and_b32 s38, s33, 1
    s_lshl_b32 s38, s38, 16
    s_add_u32 s51, s51, s38
    s_lshr_b32 s38, s33, 1
    s_lshl_b32 s38, s38, 7
    s_add_u32 s51, s51, s38
    s_add_u32 s51, s51, 131072
L_w12:
    s_sleep 1
    ds_read_b32 v8, v0 offset:5044
    s_sub_u32 s3, s3, 1
    s_cbranch_scc1 L_end
    s_waitcnt lgkmcnt(0)
    v_cmp_gt_u32 vcc, 3, v8
    s_cbranch_vccnz L_w12
    s_cmp_lg_u32 s34, 0
    s_cbranch_scc1 L_AD_k1
    s_add_u32 s38, s51, 917504
    buffer_load_dword v166, v4, s[44:47], s38 offen offset:768
    s_waitcnt vmcnt(0)
    s_add_u32 s38, s51, 1966080
    buffer_load_dword v166, v4, s[44:47], s38 offen offset:768
    s_waitcnt vmcnt(0)
    s_branch L_AD_k2
L_AD_k1:
L_AD_k2:
    s_sub_u32 s38, s51, 131072
    buffer_load_dword v166, v4, s[44:47], s38 offen offset:768
    s_waitcnt vmcnt(0)
L_AD_k3:
    buffer_load_dword v166, v4, s[44:47], s51 offen offset:256
    s_waitcnt vmcnt(0)
    buffer_load_dword v166, v4, s[44:47], s51 offen offset:512
    s_waitcnt vmcnt(0)
    buffer_load_dword v166, v4, s[44:47], s51 offen offset:768
    v_mov_b32 v8, 1
    s_mov_b64 exec, 1
    ds_add_u32 v0, v8 offset:5048
    s_mov_b64 exec, -1
L_AD1:
    v_and_b32 v9, 31, v1
    v_lshrrev_b32 v10, 5, v1
    v_and_b32 v3, 15, v1
    v_lshrrev_b32 v6, 4, v1
    v_lshlrev_b32 v7, 12, v6
    v_lshl_add_u32 v7, v3, 4, v7
    v_and_b32 v5, 1, v6
    v_lshlrev_b32 v5, 6, v5
    v_add_lshl_u32 v5, v5, v3, 10
    s_lshl_b32 s38, s62, 8
    s_lshl_b32 s50, s33, 11
    s_lshl4_add_u32 s50, s36, s50
    s_add_u32 s50, s50, s37
    s_lshl_b32 s50, s50, 3
    s_add_u32 s50, s50, 1048576
    s_lshl_b32 s51, s33, 5
    s_add_u32 s51, s51, s35
    s_lshl_b32 s51, s51, 14
    s_add_u32 s51, s51, s38
    s_add_u32 s51, s51, 2097152
    s_add_u32 s52, s51, 2097152
    s_lshl_b32 s38, s33, 8
    s_add_u32 s38, s38, 139776
    v_lshl_add_u32 v24, v1, 2, s38
    v_bfe_u32 v16, v1, 3, 1
    v_lshlrev_b32 v16, 7, v16
    v_lshl_add_u32 v16, v6, 4, v16
    v_add_u32 v25, s38, v16
    v_bfe_u32 v16, v1, 4, 1
    v_lshlrev_b32 v16, 4, v16
    v_lshl_add_u32 v16, v3, 5, v16
    v_lshl_add_u32 v16, v10, 3, v16
    s_mul_i32 s38, s33, 1056
    s_add_u32 s38, s38, 141312
    v_add_u32 v26, s38, v16
    v_add_u32 v27, 4224, v26
    v_and_b32 v16, 1, v1
    v_lshlrev_b32 v16, 4, v16
    s_mov_b32 s38, 0xffff
    v_lshlrev_b32 v16, v16, s38
    v_bfe_u32 v17, v1, 1, 2
    v_cmp_eq_u32 vcc, 0, v17
    s_nop 1
    v_cndmask_b32 v20, 0, v16, vcc
    v_cmp_eq_u32 vcc, 1, v17
    s_nop 1
    v_cndmask_b32 v21, 0, v16, vcc
    v_cmp_eq_u32 vcc, 2, v17
    s_nop 1
    v_cndmask_b32 v22, 0, v16, vcc
    v_cmp_eq_u32 vcc, 3, v17
    s_nop 1
    v_cndmask_b32 v23, 0, v16, vcc
L_w13:
    s_sleep 1
    ds_read_b32 v12, v0 offset:5052
    s_sub_u32 s3, s3, 1
    s_cbranch_scc1 L_end
    s_waitcnt lgkmcnt(0)
    v_cmp_gt_u32 vcc, 1, v12
    s_cbranch_vccnz L_w13
L_w14:
    s_sleep 1
    ds_read_b32 v12, v0 offset:6060
    s_sub_u32 s3, s3, 1
    s_cbranch_scc1 L_end
    s_waitcnt lgkmcnt(0)
    v_cmp_gt_u32 vcc, 7, v12
    s_cbranch_vccnz L_w14
L_A_st1:
    buffer_load_dwordx2 v[12:13], v5, s[40:43], s50 offen sc1
    s_sub_u32 s3, s3, 1
    s_cbranch_scc1 L_end
    s_waitcnt vmcnt(0)
    v_max_u32 v14, v12, v13
    v_cmp_eq_u32 vcc, -1, v14
    s_cbranch_vccz L_A_st3
    s_mov_b64 exec, vcc
    s_sleep 4
    s_branch L_A_st1
L_A_st3:
    s_mov_b64 exec, -1
    buffer_load_dwordx4 v[32:35], v7, s[40:43], s51 offen offset:0 sc1
    buffer_load_dwordx4 v[36:39], v7, s[40:43], s51 offen offset:1024 sc1
    buffer_load_dwordx4 v[40:43], v7, s[40:43], s51 offen offset:2048 sc1
    buffer_load_dwordx4 v[44:47], v7, s[40:43], s51 offen offset:3072 sc1
    buffer_load_dwordx4 v[48:51], v7, s[40:43], s52 offen offset:0 sc1
    buffer_load_dwordx4 v[52:55], v7, s[40:43], s52 offen offset:1024 sc1
    buffer_load_dwordx4 v[56:59], v7, s[40:43], s52 offen offset:2048 sc1
    buffer_load_dwordx4 v[60:63], v7, s[40:43], s52 offen offset:3072 sc1
    v_mov_b32 v14, v12
    s_nop 1
    v_max_f32_dpp v14, v14, v14 quad_perm:[1,0,3,2] row_mask:0xf bank_mask:0xf
    s_nop 1
    v_max_f32_dpp v14, v14, v14 quad_perm:[2,3,0,1] row_mask:0xf bank_mask:0xf
    s_nop 1
    v_max_f32_dpp v14, v14, v14 row_half_mirror row_mask:0xf bank_mask:0xf
    s_nop 1
    v_max_f32_dpp v14, v14, v14 row_mirror row_mask:0xf bank_mask:0xf
    v_sub_f32 v12, v12, v14
    v_exp_f32 v12, v12
    s_nop 0
    v_mul_f32 v14, v12, v13
    s_nop 1
    v_add_f32_dpp v14, v14, v14 quad_perm:[1,0,3,2] row_mask:0xf bank_mask:0xf
    s_nop 1
    v_add_f32_dpp v14, v14, v14 quad_perm:[2,3,0,1] row_mask:0xf bank_mask:0xf
    s_nop 1
    v_add_f32_dpp v14, v14, v14 row_half_mirror row_mask:0xf bank_mask:0xf
    s_nop 1
    v_add_f32_dpp v14, v14, v14 row_mirror row_mask:0xf bank_mask:0xf
    v_rcp_f32 v14, v14
    v_cmp_gt_u32 vcc, 32, v1
    v_mul_f32 v12, v12, v14
    v_cvt_pk_bf16_f32 v13, v12, v12
    v_and_b32 v14, 0xffff0000, v13
    v_sub_f32 v12, v12, v14
    v_cvt_pk_bf16_f32 v12, v12, v12
    v_cndmask_b32 v12, v12, v13, vcc
    ds_write_b32 v24, v12
    ds_read_b128 v[12:15], v25
    ds_read_b128 v[16:19], v25 offset:64
    s_waitcnt lgkmcnt(0)
    v_and_b32 v64, v12, v20
    v_and_b32 v65, v12, v21
    v_and_b32 v66, v12, v22
    v_and_b32 v67, v12, v23
    v_and_b32 v68, v13, v20
    v_and_b32 v69, v13, v21
    v_and_b32 v70, v13, v22
    v_and_b32 v71, v13, v23
    v_and_b32 v72, v14, v20
    v_and_b32 v73, v14, v21
    v_and_b32 v74, v14, v22
    v_and_b32 v75, v14, v23
    v_and_b32 v76, v15, v20
    v_and_b32 v77, v15, v21
    v_and_b32 v78, v15, v22
    v_and_b32 v79, v15, v23
    v_and_b32 v80, v16, v20
    v_and_b32 v81, v16, v21
    v_and_b32 v82, v16, v22
    v_and_b32 v83, v16, v23
    v_and_b32 v84, v17, v20
    v_and_b32 v85, v17, v21
    v_and_b32 v86, v17, v22
    v_and_b32 v87, v17, v23
    v_and_b32 v88, v18, v20
    v_and_b32 v89, v18, v21
    v_and_b32 v90, v18, v22
    v_and_b32 v91, v18, v23
    v_and_b32 v92, v19, v20
    v_and_b32 v93, v19, v21
    v_and_b32 v94, v19, v22
    v_and_b32 v95, v19, v23
    s_waitcnt vmcnt(4)
L_h3_c0:
    v_mfma_f32_16x16x32_bf16 v[28:31], v[64:67], v[32:35], 0
    v_mfma_f32_16x16x32_bf16 v[28:31], v[68:71], v[36:39], v[28:31]
    v_mfma_f32_16x16x32_bf16 v[28:31], v[72:75], v[40:43], v[28:31]
    v_mfma_f32_16x16x32_bf16 v[28:31], v[76:79], v[44:47], v[28:31]
    v_max3_u32 v12, v32, v33, v34
    v_max3_u32 v12, v12, v35, v36
    v_max3_u32 v12, v12, v37, v38
    v_max3_u32 v12, v12, v39, v40
    v_max3_u32 v12, v12, v41, v42
    v_max3_u32 v12, v12, v43, v44
    v_max3_u32 v12, v12, v45, v46
    v_max_u32 v12, v12, v47
    v_cmp_eq_u32 vcc, -1, v12
    s_cbranch_vccnz L_h3_r0
    s_waitcnt vmcnt(0)
L_h3_c1:
    v_mfma_f32_16x16x32_bf16 v[96:99], v[80:83], v[48:51], 0
    v_mfma_f32_16x16x32_bf16 v[96:99], v[84:87], v[52:55], v[96:99]
    v_mfma_f32_16x16x32_bf16 v[96:99], v[88:91], v[56:59], v[96:99]
    v_mfma_f32_16x16x32_bf16 v[96:99], v[92:95], v[60:63], v[96:99]
    v_max3_u32 v12, v48, v49, v50
    v_max3_u32 v12, v12, v51, v52
    v_max3_u32 v12, v12, v53, v54
    v_max3_u32 v12, v12, v55, v56
    v_max3_u32 v12, v12, v57, v58
    v_max3_u32 v12, v12, v59, v60
    v_max3_u32 v12, v12, v61, v62
    v_max_u32 v12, v12, v63
    v_cmp_eq_u32 vcc, -1, v12
    s_cbranch_vccnz L_h3_r1
    v_permlane32_swap_b32 v28, v30
    v_permlane32_swap_b32 v29, v31
    v_add_f32 v28, v28, v30
    v_add_f32 v29, v29, v31
    v_cvt_pk_bf16_f32 v12, v28, 0
    v_cvt_pk_bf16_f32 v13, v29, 0
    v_cvt_pk_bf16_f32 v14, 0, v28
    v_cvt_pk_bf16_f32 v15, 0, v29
    ds_write2_b64 v26, v[12:13], v[14:15] offset0:0 offset1:66
    v_permlane32_swap_b32 v96, v98
    v_permlane32_swap_b32 v97, v99
    v_add_f32 v96, v96, v98
    v_add_f32 v97, v97, v99
    v_cvt_pk_bf16_f32 v16, v96, 0
    v_cvt_pk_bf16_f32 v17, v97, 0
    v_cvt_pk_bf16_f32 v18, 0, v96
    v_cvt_pk_bf16_f32 v19, 0, v97
    ds_write2_b64 v27, v[16:17], v[18:19] offset0:0 offset1:66
    v_mov_b32 v28, 1
    s_mov_b64 exec, 1
    ds_add_u32 v0, v28 offset:6048
    s_mov_b64 exec, -1
    s_cmp_lg_u32 s35, s33
    s_cbranch_scc1 L_end
    s_waitcnt lgkmcnt(0)
L_A_F:
    s_mov_b32 s44, s4
    s_mov_b32 s45, s5
    s_mov_b32 s46, 8192
    s_mov_b32 s47, 0x20000

    v_bfe_u32 v17, v1, 3, 1
    v_cmp_eq_u32 vcc, v17, v10
    v_mov_b32 v12, 0x3f803f80
    s_nop 0
    v_cndmask_b32 v12, 0, v12, vcc
    v_and_b32 v20, v12, v20
    v_and_b32 v21, v12, v21
    v_and_b32 v22, v12, v22
    v_and_b32 v23, v12, v23
    v_and_b32 v12, 1, v6
    v_lshlrev_b32 v13, 3, v12
    v_lshl_add_u32 v13, v3, 4, v13
    v_lshl_add_u32 v16, v10, 12, v13
    s_lshl_b32 s38, s62, 10
    s_lshl_b32 s39, s33, 8
    s_add_u32 s48, s38, s39
    buffer_load_dwordx2 v[128:129], v16, s[44:47], s48 offen
    s_cmp_lt_u32 s34, 4
    s_cselect_b32 s50, 65536, 0

    s_add_u32 s49, s48, 1179648
    buffer_load_dwordx2 v[96:97], v16, s[40:43], s49 offen sc1
    s_add_u32 s49, s49, 8192
    buffer_load_dwordx2 v[98:99], v16, s[40:43], s49 offen sc1
    s_add_u32 s49, s49, 8192
    buffer_load_dwordx2 v[100:101], v16, s[40:43], s49 offen sc1
    s_add_u32 s49, s49, 8192
    buffer_load_dwordx2 v[102:103], v16, s[40:43], s49 offen sc1
    s_add_u32 s49, s49, 8192
    s_add_u32 s49, s49, s50
    buffer_load_dwordx2 v[104:105], v16, s[40:43], s49 offen sc1
    s_add_u32 s49, s49, 8192
    buffer_load_dwordx2 v[106:107], v16, s[40:43], s49 offen sc1
    s_add_u32 s49, s49, 8192
    buffer_load_dwordx2 v[108:109], v16, s[40:43], s49 offen sc1
    s_add_u32 s49, s49, 8192
    buffer_load_dwordx2 v[110:111], v16, s[40:43], s49 offen sc1
    s_add_u32 s49, s49, 8192
    s_sub_u32 s49, s49, s50
    buffer_load_dwordx2 v[112:113], v16, s[40:43], s49 offen sc1
    s_add_u32 s49, s49, 8192
    buffer_load_dwordx2 v[114:115], v16, s[40:43], s49 offen sc1
    s_add_u32 s49, s49, 8192
    buffer_load_dwordx2 v[116:117], v16, s[40:43], s49 offen sc1
    s_add_u32 s49, s49, 8192
    buffer_load_dwordx2 v[118:119], v16, s[40:43], s49 offen sc1
    s_add_u32 s49, s49, 8192

    s_lshl_b32 s53, s62, 15
    s_add_u32 s53, s53, s39
    s_add_u32 s56, s53, 1572864
    s_add_u32 s53, s53, 1310720
    s_and_b32 s38, s35, 8
    s_lshl_b32 s38, s38, 9
    s_add_u32 s56, s56, s38
    s_xor_b32 s57, s56, 4096
    s_xor_b32 s58, s56, 8192
    s_xor_b32 s59, s56, 12288
    v_lshlrev_b32 v5, 17, v10
    v_lshl_add_u32 v5, v3, 4, v5
    v_lshl_add_u32 v7, v12, 13, v5
    s_add_u32 s38, s39, 131072
    v_mul_u32_u24 v24, 2080, v10
    v_add3_u32 v25, v24, v13, s38
    s_lshl_b32 s38, s33, 2
    s_add_u32 s38, s38, 149504
    v_lshl_add_u32 v26, v6, 4, s38
    v_add_u32 v24, v24, v25
    v_add_u32 v24, 4160, v24
    v_add_u32 v27, 2080, v24
    s_and_b32 s60, s36, 3
    s_lshl2_add_u32 s60, s60, s33
    s_lshl_b32 s60, s60, 12
    s_add_u32 s60, s60, 983040
    v_and_b32 v13, 3, v1
    v_lshlrev_b32 v13, 10, v13
    s_lshl_b32 s38, s36, 7
    v_add_u32 v13, s38, v13
    s_mov_b32 s51, 15
    buffer_load_dword v18, v13, s[40:43], s60 offen sc1
    s_branch L_A_md1
L_A_md:
    s_sleep 4
    s_add_u32 s49, s48, 1179648
    buffer_load_dwordx2 v[96:97], v16, s[40:43], s49 offen sc1
    s_add_u32 s49, s49, 8192
    buffer_load_dwordx2 v[98:99], v16, s[40:43], s49 offen sc1
    s_add_u32 s49, s49, 8192
    buffer_load_dwordx2 v[100:101], v16, s[40:43], s49 offen sc1
    s_add_u32 s49, s49, 8192
    buffer_load_dwordx2 v[102:103], v16, s[40:43], s49 offen sc1
    s_add_u32 s49, s49, 8192
    s_add_u32 s49, s49, s50
    buffer_load_dwordx2 v[104:105], v16, s[40:43], s49 offen sc1
    s_add_u32 s49, s49, 8192
    buffer_load_dwordx2 v[106:107], v16, s[40:43], s49 offen sc1
    s_add_u32 s49, s49, 8192
    buffer_load_dwordx2 v[108:109], v16, s[40:43], s49 offen sc1
    s_add_u32 s49, s49, 8192
    buffer_load_dwordx2 v[110:111], v16, s[40:43], s49 offen sc1
    s_add_u32 s49, s49, 8192
    s_sub_u32 s49, s49, s50
    buffer_load_dwordx2 v[112:113], v16, s[40:43], s49 offen sc1
    s_add_u32 s49, s49, 8192
    buffer_load_dwordx2 v[114:115], v16, s[40:43], s49 offen sc1
    s_add_u32 s49, s49, 8192
    buffer_load_dwordx2 v[116:117], v16, s[40:43], s49 offen sc1
    s_add_u32 s49, s49, 8192
    buffer_load_dwordx2 v[118:119], v16, s[40:43], s49 offen sc1
    s_add_u32 s49, s49, 8192
    s_sub_u32 s3, s3, 1
    s_cbranch_scc1 L_end
L_A_md1:
    s_waitcnt vmcnt(0)
    v_max3_u32 v15, v96, v97, v98
    v_max3_u32 v15, v15, v99, v100
    v_max3_u32 v15, v15, v101, v102
    v_max3_u32 v15, v15, v103, v104
    v_max3_u32 v15, v15, v105, v106
    v_max3_u32 v15, v15, v107, v108
    v_max3_u32 v15, v15, v109, v110
    v_max3_u32 v15, v15, v111, v112
    v_max3_u32 v15, v15, v113, v114
    v_max3_u32 v15, v15, v115, v116
    v_max3_u32 v15, v15, v117, v118
    v_max_u32 v15, v15, v119
    v_cmp_eq_u32 vcc, -1, v15
    s_cbranch_vccnz L_A_md
    s_mov_b32 s52, 1
    v_cmp_eq_u32 vcc, -1, v18
    s_cbranch_vccz L_A_h4s
    s_mov_b32 s52, 0
    v_lshlrev_b32 v140, 16, v128
    v_and_b32 v141, 0xffff0000, v128
    v_lshlrev_b32 v142, 16, v129
    v_and_b32 v143, 0xffff0000, v129
    v_lshlrev_b32 v152, 16, v112
    v_and_b32 v153, 0xffff0000, v112
    v_lshlrev_b32 v154, 16, v113
    v_and_b32 v155, 0xffff0000, v113
    v_lshlrev_b32 v14, 16, v114
    v_and_b32 v15, 0xffff0000, v114
    v_pk_add_f32 v[152:153], v[152:153], v[14:15]
    v_lshlrev_b32 v14, 16, v115
    v_and_b32 v15, 0xffff0000, v115
    v_pk_add_f32 v[154:155], v[154:155], v[14:15]
    v_lshlrev_b32 v14, 16, v116
    v_and_b32 v15, 0xffff0000, v116
    v_pk_add_f32 v[152:153], v[152:153], v[14:15]
    v_lshlrev_b32 v14, 16, v117
    v_and_b32 v15, 0xffff0000, v117
    v_pk_add_f32 v[154:155], v[154:155], v[14:15]
    v_lshlrev_b32 v14, 16, v118
    v_and_b32 v15, 0xffff0000, v118
    v_pk_add_f32 v[152:153], v[152:153], v[14:15]
    v_lshlrev_b32 v14, 16, v119
    v_and_b32 v15, 0xffff0000, v119
    v_pk_add_f32 v[154:155], v[154:155], v[14:15]
    v_lshlrev_b32 v148, 16, v104
    v_and_b32 v149, 0xffff0000, v104
    v_lshlrev_b32 v150, 16, v105
    v_and_b32 v151, 0xffff0000, v105
    v_lshlrev_b32 v14, 16, v106
    v_and_b32 v15, 0xffff0000, v106
    v_pk_add_f32 v[148:149], v[148:149], v[14:15]
    v_lshlrev_b32 v14, 16, v107
    v_and_b32 v15, 0xffff0000, v107
    v_pk_add_f32 v[150:151], v[150:151], v[14:15]
    v_lshlrev_b32 v14, 16, v108
    v_and_b32 v15, 0xffff0000, v108
    v_pk_add_f32 v[148:149], v[148:149], v[14:15]
    v_lshlrev_b32 v14, 16, v109
    v_and_b32 v15, 0xffff0000, v109
    v_pk_add_f32 v[150:151], v[150:151], v[14:15]
    v_lshlrev_b32 v14, 16, v110
    v_and_b32 v15, 0xffff0000, v110
    v_pk_add_f32 v[148:149], v[148:149], v[14:15]
    v_lshlrev_b32 v14, 16, v111
    v_and_b32 v15, 0xffff0000, v111
    v_pk_add_f32 v[150:151], v[150:151], v[14:15]
    v_add_f32 v152, 1.0, v152
    v_add_f32 v153, 1.0, v153
    v_add_f32 v154, 1.0, v154
    v_add_f32 v155, 1.0, v155
    s_cmp_lt_u32 s34, 4
    s_cbranch_scc1 L_nk15
    v_cvt_pk_bf16_f32 v120, v152, v153
    v_cvt_pk_bf16_f32 v121, v154, v155
    v_lshlrev_b32 v124, 16, v120
    v_and_b32 v125, 0xffff0000, v120
    v_lshlrev_b32 v126, 16, v121
    v_and_b32 v127, 0xffff0000, v121
    v_pk_add_f32 v[124:125], v[152:153], v[124:125] neg_lo:[0,1] neg_hi:[0,1]
    v_pk_add_f32 v[126:127], v[154:155], v[126:127] neg_lo:[0,1] neg_hi:[0,1]
    v_cvt_pk_bf16_f32 v122, v124, v125
    v_cvt_pk_bf16_f32 v123, v126, v127
    ds_write2_b64 v24, v[120:121], v[122:123] offset0:0 offset1:130
    v_cvt_pk_bf16_f32 v130, v148, v149
    v_cvt_pk_bf16_f32 v131, v150, v151
    v_lshlrev_b32 v134, 16, v130
    v_and_b32 v135, 0xffff0000, v130
    v_lshlrev_b32 v136, 16, v131
    v_and_b32 v137, 0xffff0000, v131
    v_pk_add_f32 v[134:135], v[148:149], v[134:135] neg_lo:[0,1] neg_hi:[0,1]
    v_pk_add_f32 v[136:137], v[150:151], v[136:137] neg_lo:[0,1] neg_hi:[0,1]
    v_cvt_pk_bf16_f32 v132, v134, v135
    v_cvt_pk_bf16_f32 v133, v136, v137
    ds_write2_b64 v27, v[130:131], v[132:133] offset0:0 offset1:130
    v_mov_b32 v14, 1
    s_mov_b64 exec, 1
    ds_add_u32 v0, v14 offset:5048
    s_mov_b64 exec, -1
L_nk15:
    v_lshlrev_b32 v144, 16, v96
    v_and_b32 v145, 0xffff0000, v96
    v_lshlrev_b32 v146, 16, v97
    v_and_b32 v147, 0xffff0000, v97
    v_lshlrev_b32 v14, 16, v98
    v_and_b32 v15, 0xffff0000, v98
    v_pk_add_f32 v[144:145], v[144:145], v[14:15]
    v_lshlrev_b32 v14, 16, v99
    v_and_b32 v15, 0xffff0000, v99
    v_pk_add_f32 v[146:147], v[146:147], v[14:15]
    v_lshlrev_b32 v14, 16, v100
    v_and_b32 v15, 0xffff0000, v100
    v_pk_add_f32 v[144:145], v[144:145], v[14:15]
    v_lshlrev_b32 v14, 16, v101
    v_and_b32 v15, 0xffff0000, v101
    v_pk_add_f32 v[146:147], v[146:147], v[14:15]
    v_lshlrev_b32 v14, 16, v102
    v_and_b32 v15, 0xffff0000, v102
    v_pk_add_f32 v[144:145], v[144:145], v[14:15]
    v_lshlrev_b32 v14, 16, v103
    v_and_b32 v15, 0xffff0000, v103
    v_pk_add_f32 v[146:147], v[146:147], v[14:15]
    s_mov_b32 exec_lo, s51
    s_mov_b32 exec_hi, 0
L_A_hint1:
    buffer_load_dword v12, v13, s[40:43], s60 offen sc1
    s_sub_u32 s3, s3, 1
    s_cbranch_scc1 L_end
    s_waitcnt vmcnt(0)
    v_cmp_eq_u32 vcc, -1, v12
    s_mov_b64 exec, vcc
    s_cbranch_vccnz L_A_hint1
    s_mov_b64 exec, -1
L_A_h4s:
    buffer_load_dwordx4 v[32:35], v7, s[40:43], s56 offen offset:0 sc1
    buffer_load_dwordx4 v[36:39], v7, s[40:43], s56 offen offset:1024 sc1
    buffer_load_dwordx4 v[40:43], v7, s[40:43], s56 offen offset:2048 sc1
    buffer_load_dwordx4 v[44:47], v7, s[40:43], s56 offen offset:3072 sc1
    buffer_load_dwordx4 v[48:51], v7, s[40:43], s57 offen offset:0 sc1
    buffer_load_dwordx4 v[52:55], v7, s[40:43], s57 offen offset:1024 sc1
    buffer_load_dwordx4 v[56:59], v7, s[40:43], s57 offen offset:2048 sc1
    buffer_load_dwordx4 v[60:63], v7, s[40:43], s57 offen offset:3072 sc1
    s_cmp_eq_u32 s52, 0
    s_cbranch_scc1 L_A_mu
    v_lshlrev_b32 v140, 16, v128
    v_and_b32 v141, 0xffff0000, v128
    v_lshlrev_b32 v142, 16, v129
    v_and_b32 v143, 0xffff0000, v129
    v_lshlrev_b32 v152, 16, v112
    v_and_b32 v153, 0xffff0000, v112
    v_lshlrev_b32 v154, 16, v113
    v_and_b32 v155, 0xffff0000, v113
    v_lshlrev_b32 v14, 16, v114
    v_and_b32 v15, 0xffff0000, v114
    v_pk_add_f32 v[152:153], v[152:153], v[14:15]
    v_lshlrev_b32 v14, 16, v115
    v_and_b32 v15, 0xffff0000, v115
    v_pk_add_f32 v[154:155], v[154:155], v[14:15]
    v_lshlrev_b32 v14, 16, v116
    v_and_b32 v15, 0xffff0000, v116
    v_pk_add_f32 v[152:153], v[152:153], v[14:15]
    v_lshlrev_b32 v14, 16, v117
    v_and_b32 v15, 0xffff0000, v117
    v_pk_add_f32 v[154:155], v[154:155], v[14:15]
    v_lshlrev_b32 v14, 16, v118
    v_and_b32 v15, 0xffff0000, v118
    v_pk_add_f32 v[152:153], v[152:153], v[14:15]
    v_lshlrev_b32 v14, 16, v119
    v_and_b32 v15, 0xffff0000, v119
    v_pk_add_f32 v[154:155], v[154:155], v[14:15]
    v_lshlrev_b32 v148, 16, v104
    v_and_b32 v149, 0xffff0000, v104
    v_lshlrev_b32 v150, 16, v105
    v_and_b32 v151, 0xffff0000, v105
    v_lshlrev_b32 v14, 16, v106
    v_and_b32 v15, 0xffff0000, v106
    v_pk_add_f32 v[148:149], v[148:149], v[14:15]
    v_lshlrev_b32 v14, 16, v107
    v_and_b32 v15, 0xffff0000, v107
    v_pk_add_f32 v[150:151], v[150:151], v[14:15]
    v_lshlrev_b32 v14, 16, v108
    v_and_b32 v15, 0xffff0000, v108
    v_pk_add_f32 v[148:149], v[148:149], v[14:15]
    v_lshlrev_b32 v14, 16, v109
    v_and_b32 v15, 0xffff0000, v109
    v_pk_add_f32 v[150:151], v[150:151], v[14:15]
    v_lshlrev_b32 v14, 16, v110
    v_and_b32 v15, 0xffff0000, v110
    v_pk_add_f32 v[148:149], v[148:149], v[14:15]
    v_lshlrev_b32 v14, 16, v111
    v_and_b32 v15, 0xffff0000, v111
    v_pk_add_f32 v[150:151], v[150:151], v[14:15]
    v_add_f32 v152, 1.0, v152
    v_add_f32 v153, 1.0, v153
    v_add_f32 v154, 1.0, v154
    v_add_f32 v155, 1.0, v155
    s_cmp_lt_u32 s34, 4
    s_cbranch_scc1 L_nk16
    v_cvt_pk_bf16_f32 v120, v152, v153
    v_cvt_pk_bf16_f32 v121, v154, v155
    v_lshlrev_b32 v124, 16, v120
    v_and_b32 v125, 0xffff0000, v120
    v_lshlrev_b32 v126, 16, v121
    v_and_b32 v127, 0xffff0000, v121
    v_pk_add_f32 v[124:125], v[152:153], v[124:125] neg_lo:[0,1] neg_hi:[0,1]
    v_pk_add_f32 v[126:127], v[154:155], v[126:127] neg_lo:[0,1] neg_hi:[0,1]
    v_cvt_pk_bf16_f32 v122, v124, v125
    v_cvt_pk_bf16_f32 v123, v126, v127
    ds_write2_b64 v24, v[120:121], v[122:123] offset0:0 offset1:130
    v_cvt_pk_bf16_f32 v130, v148, v149
    v_cvt_pk_bf16_f32 v131, v150, v151
    v_lshlrev_b32 v134, 16, v130
    v_and_b32 v135, 0xffff0000, v130
    v_lshlrev_b32 v136, 16, v131
    v_and_b32 v137, 0xffff0000, v131
    v_pk_add_f32 v[134:135], v[148:149], v[134:135] neg_lo:[0,1] neg_hi:[0,1]
    v_pk_add_f32 v[136:137], v[150:151], v[136:137] neg_lo:[0,1] neg_hi:[0,1]
    v_cvt_pk_bf16_f32 v132, v134, v135
    v_cvt_pk_bf16_f32 v133, v136, v137
    ds_write2_b64 v27, v[130:131], v[132:133] offset0:0 offset1:130
    v_mov_b32 v14, 1
    s_mov_b64 exec, 1
    ds_add_u32 v0, v14 offset:5048
    s_mov_b64 exec, -1
L_nk16:
    v_lshlrev_b32 v144, 16, v96
    v_and_b32 v145, 0xffff0000, v96
    v_lshlrev_b32 v146, 16, v97
    v_and_b32 v147, 0xffff0000, v97
    v_lshlrev_b32 v14, 16, v98
    v_and_b32 v15, 0xffff0000, v98
    v_pk_add_f32 v[144:145], v[144:145], v[14:15]
    v_lshlrev_b32 v14, 16, v99
    v_and_b32 v15, 0xffff0000, v99
    v_pk_add_f32 v[146:147], v[146:147], v[14:15]
    v_lshlrev_b32 v14, 16, v100
    v_and_b32 v15, 0xffff0000, v100
    v_pk_add_f32 v[144:145], v[144:145], v[14:15]
    v_lshlrev_b32 v14, 16, v101
    v_and_b32 v15, 0xffff0000, v101
    v_pk_add_f32 v[146:147], v[146:147], v[14:15]
    v_lshlrev_b32 v14, 16, v102
    v_and_b32 v15, 0xffff0000, v102
    v_pk_add_f32 v[144:145], v[144:145], v[14:15]
    v_lshlrev_b32 v14, 16, v103
    v_and_b32 v15, 0xffff0000, v103
    v_pk_add_f32 v[146:147], v[146:147], v[14:15]
L_A_mu:
    v_mov_b32 v28, 0
    v_mov_b32 v29, 0
    v_mov_b32 v30, 0
    v_mov_b32 v31, 0
    s_mov_b32 s63, 0
    s_waitcnt vmcnt(6)
    v_max3_u32 v12, v32, v33, v34
    v_max3_u32 v12, v12, v35, v36
    v_max3_u32 v12, v12, v37, v38
    v_max_u32 v12, v12, v39
    v_cmp_eq_u32 vcc, -1, v12
    s_cbranch_vccnz L_h4_f0
    v_mfma_f32_16x16x32_bf16 v[28:31], v[20:23], v[32:35], v[28:31]
    v_mfma_f32_16x16x32_bf16 v[28:31], v[20:23], v[36:39], v[28:31]
L_h4_n0:
    s_waitcnt vmcnt(4)
    v_max3_u32 v12, v40, v41, v42
    v_max3_u32 v12, v12, v43, v44
    v_max3_u32 v12, v12, v45, v46
    v_max_u32 v12, v12, v47
    v_cmp_eq_u32 vcc, -1, v12
    s_cbranch_vccnz L_h4_f2
    v_mfma_f32_16x16x32_bf16 v[28:31], v[20:23], v[40:43], v[28:31]
    v_mfma_f32_16x16x32_bf16 v[28:31], v[20:23], v[44:47], v[28:31]
L_h4_n2:
    s_waitcnt vmcnt(2)
    v_max3_u32 v12, v48, v49, v50
    v_max3_u32 v12, v12, v51, v52
    v_max3_u32 v12, v12, v53, v54
    v_max_u32 v12, v12, v55
    v_cmp_eq_u32 vcc, -1, v12
    s_cbranch_vccnz L_h4_f4
    v_mfma_f32_16x16x32_bf16 v[28:31], v[20:23], v[48:51], v[28:31]
    v_mfma_f32_16x16x32_bf16 v[28:31], v[20:23], v[52:55], v[28:31]
L_h4_n4:
    s_waitcnt vmcnt(0)
    v_max3_u32 v12, v56, v57, v58
    v_max3_u32 v12, v12, v59, v60
    v_max3_u32 v12, v12, v61, v62
    v_max_u32 v12, v12, v63
    v_cmp_eq_u32 vcc, -1, v12
    s_cbranch_vccnz L_h4_f6
    v_mfma_f32_16x16x32_bf16 v[28:31], v[20:23], v[56:59], v[28:31]
    v_mfma_f32_16x16x32_bf16 v[28:31], v[20:23], v[60:63], v[28:31]
L_h4_n6:
    s_cmp_lg_u32 s63, 0
    s_cbranch_scc1 L_h4_r
L_h4_d:
    s_nop 5
    v_pk_fma_f32 v[28:29], v[28:29], v[144:145], v[140:141]
    v_pk_fma_f32 v[30:31], v[30:31], v[146:147], v[142:143]
    s_cmp_lt_u32 s34, 4
    s_cbranch_scc1 L_A_fin
    v_pk_mul_f32 v[152:153], v[152:153], v[28:29]
    v_pk_mul_f32 v[154:155], v[154:155], v[30:31]
    v_cvt_pk_bf16_f32 v32, v152, v153
    v_cvt_pk_bf16_f32 v33, v154, v155
    v_lshlrev_b32 v36, 16, v32
    v_and_b32 v37, 0xffff0000, v32
    v_lshlrev_b32 v38, 16, v33
    v_and_b32 v39, 0xffff0000, v33
    v_pk_add_f32 v[36:37], v[152:153], v[36:37] neg_lo:[0,1] neg_hi:[0,1]
    v_pk_add_f32 v[38:39], v[154:155], v[38:39] neg_lo:[0,1] neg_hi:[0,1]
    v_cvt_pk_bf16_f32 v34, v36, v37
    v_cvt_pk_bf16_f32 v35, v38, v39
    ds_write2_b64 v25, v[32:33], v[34:35] offset0:0 offset1:130
    v_mov_b32 v14, 1
    s_mov_b64 exec, 1
    ds_add_u32 v0, v14 offset:5052
    s_mov_b64 exec, -1

    v_add_f32 v12, v28, v29
    v_mul_f32 v13, v28, v28
    v_add_f32 v14, v30, v31
    v_fmac_f32 v13, v29, v29
    v_add_f32 v12, v12, v14
    v_fmac_f32 v13, v30, v30
    v_fmac_f32 v13, v31, v31
    s_nop 1
    v_permlane16_swap_b32 v12, v13
    v_add_f32 v12, v12, v13
    s_nop 1
    v_add_f32_dpp v12, v12, v12 quad_perm:[1,0,3,2] row_mask:0xf bank_mask:0xf
    s_nop 1
    v_add_f32_dpp v12, v12, v12 quad_perm:[2,3,0,1] row_mask:0xf bank_mask:0xf
    s_nop 1
    v_add_f32_dpp v12, v12, v12 row_half_mirror row_mask:0xf bank_mask:0xf
    s_nop 1
    v_add_f32_dpp v12, v12, v12 row_mirror row_mask:0xf bank_mask:0xf
    ds_write_b32 v26, v12
    s_branch L_end
L_A_fin:
    s_mov_b32 s44, s26
    s_mov_b32 s45, s27
    s_mov_b32 s46, 8192
    s_mov_b32 s47, 0x20000

    v_and_b32 v12, 7, v1
    v_lshlrev_b32 v13, 1, v12
    v_lshrrev_b32 v14, 1, v6
    v_add_u32 v13, v13, v14
    v_and_b32 v14, 1, v6
    v_lshl_add_u32 v13, v14, 4, v13
    v_lshl_add_u32 v13, v17, 5, v13
    v_lshlrev_b32 v13, 2, v13
    ds_bpermute_b32 v140, v13, v28
    ds_bpermute_b32 v144, v13, v148
    ds_bpermute_b32 v141, v13, v29
    ds_bpermute_b32 v145, v13, v149
    ds_bpermute_b32 v142, v13, v30
    ds_bpermute_b32 v146, v13, v150
    ds_bpermute_b32 v143, v13, v31
    ds_bpermute_b32 v147, v13, v151

    v_lshlrev_b32 v4, 5, v12
    v_lshl_add_u32 v4, v6, 3, v4
    v_lshl_add_u32 v4, v17, 12, v4
    v_mul_u32_u24 v7, 14336, v14
    v_add_u32 v7, v7, v5
    s_mov_b32 s56, s53
    s_add_u32 s57, s53, 4096
    s_add_u32 s58, s53, 8192
    s_add_u32 s59, s53, 12288
    s_waitcnt lgkmcnt(0)
L_h5:
    buffer_load_dwordx4 v[32:35], v7, s[40:43], s56 offen offset:0 sc1
    buffer_load_dwordx4 v[36:39], v7, s[40:43], s56 offen offset:1024 sc1
    buffer_load_dwordx4 v[40:43], v7, s[40:43], s56 offen offset:2048 sc1
    buffer_load_dwordx4 v[44:47], v7, s[40:43], s56 offen offset:3072 sc1
    buffer_load_dwordx4 v[48:51], v7, s[40:43], s57 offen offset:0 sc1
    buffer_load_dwordx4 v[52:55], v7, s[40:43], s57 offen offset:1024 sc1
    buffer_load_dwordx4 v[56:59], v7, s[40:43], s57 offen offset:2048 sc1
    buffer_load_dwordx4 v[60:63], v7, s[40:43], s57 offen offset:3072 sc1
    buffer_load_dwordx4 v[64:67], v7, s[40:43], s58 offen offset:0 sc1
    buffer_load_dwordx4 v[68:71], v7, s[40:43], s58 offen offset:1024 sc1
    buffer_load_dwordx4 v[72:75], v7, s[40:43], s58 offen offset:2048 sc1
    buffer_load_dwordx4 v[76:79], v7, s[40:43], s58 offen offset:3072 sc1
    buffer_load_dwordx4 v[80:83], v7, s[40:43], s59 offen offset:0 sc1
    buffer_load_dwordx4 v[84:87], v7, s[40:43], s59 offen offset:1024 sc1
    s_sub_u32 s3, s3, 1
    s_cbranch_scc1 L_end
    s_mov_b64 exec, -1
    s_waitcnt vmcnt(13)
    v_mfma_f32_16x16x32_bf16 v[28:31], v[32:35], v[20:23], 0
    v_max3_u32 v12, v32, v33, v34
    v_max_u32 v12, v12, v35
    s_waitcnt vmcnt(12)
    v_mfma_f32_16x16x32_bf16 v[28:31], v[36:39], v[20:23], v[28:31]
    v_max3_u32 v12, v12, v36, v37
    v_max3_u32 v12, v12, v38, v39
    s_waitcnt vmcnt(11)
    v_mfma_f32_16x16x32_bf16 v[28:31], v[40:43], v[20:23], v[28:31]
    v_max3_u32 v12, v12, v40, v41
    v_max3_u32 v12, v12, v42, v43
    s_waitcnt vmcnt(10)
    v_mfma_f32_16x16x32_bf16 v[28:31], v[44:47], v[20:23], v[28:31]
    v_max3_u32 v12, v12, v44, v45
    v_max3_u32 v12, v12, v46, v47
    s_waitcnt vmcnt(9)
    v_mfma_f32_16x16x32_bf16 v[28:31], v[48:51], v[20:23], v[28:31]
    v_max3_u32 v12, v12, v48, v49
    v_max3_u32 v12, v12, v50, v51
    s_waitcnt vmcnt(8)
    v_mfma_f32_16x16x32_bf16 v[28:31], v[52:55], v[20:23], v[28:31]
    v_max3_u32 v12, v12, v52, v53
    v_max3_u32 v12, v12, v54, v55
    s_waitcnt vmcnt(7)
    v_mfma_f32_16x16x32_bf16 v[28:31], v[56:59], v[20:23], v[28:31]
    v_max3_u32 v12, v12, v56, v57
    v_max3_u32 v12, v12, v58, v59
    s_waitcnt vmcnt(6)
    v_mfma_f32_16x16x32_bf16 v[28:31], v[60:63], v[20:23], v[28:31]
    v_max3_u32 v12, v12, v60, v61
    v_max3_u32 v12, v12, v62, v63
    s_waitcnt vmcnt(5)
    v_mfma_f32_16x16x32_bf16 v[28:31], v[64:67], v[20:23], v[28:31]
    v_max3_u32 v12, v12, v64, v65
    v_max3_u32 v12, v12, v66, v67
    s_waitcnt vmcnt(4)
    v_mfma_f32_16x16x32_bf16 v[28:31], v[68:71], v[20:23], v[28:31]
    v_max3_u32 v12, v12, v68, v69
    v_max3_u32 v12, v12, v70, v71
    s_waitcnt vmcnt(3)
    v_mfma_f32_16x16x32_bf16 v[28:31], v[72:75], v[20:23], v[28:31]
    v_max3_u32 v12, v12, v72, v73
    v_max3_u32 v12, v12, v74, v75
    s_waitcnt vmcnt(2)
    v_mfma_f32_16x16x32_bf16 v[28:31], v[76:79], v[20:23], v[28:31]
    v_max3_u32 v12, v12, v76, v77
    v_max3_u32 v12, v12, v78, v79
    s_waitcnt vmcnt(1)
    v_mfma_f32_16x16x32_bf16 v[28:31], v[80:83], v[20:23], v[28:31]
    v_max3_u32 v12, v12, v80, v81
    v_max3_u32 v12, v12, v82, v83
    s_waitcnt vmcnt(0)
    v_mfma_f32_16x16x32_bf16 v[28:31], v[84:87], v[20:23], v[28:31]
    v_max3_u32 v12, v12, v84, v85
    v_max3_u32 v12, v12, v86, v87
    v_cmp_eq_u32 vcc, -1, v12
    s_cbranch_vccnz L_h5
    s_nop 3
    v_fma_f32 v28, v28, v144, v140
    v_fma_f32 v29, v29, v145, v141
    v_fma_f32 v30, v30, v146, v142
    v_fma_f32 v31, v31, v147, v143
    v_cvt_pk_bf16_f32 v28, v28, v29
    v_cvt_pk_bf16_f32 v29, v30, v31
    buffer_store_dwordx2 v[28:29], v4, s[44:47], s48 offen
    s_branch L_end
L_h4_f0:
    buffer_load_dwordx4 v[32:35], v7, s[40:43], s56 offen offset:0 sc1
    buffer_load_dwordx4 v[36:39], v7, s[40:43], s56 offen offset:1024 sc1
    s_mov_b64 exec, -1
    s_bitset1_b32 s63, 0
    s_branch L_h4_n0
L_h4_f2:
    buffer_load_dwordx4 v[40:43], v7, s[40:43], s56 offen offset:2048 sc1
    buffer_load_dwordx4 v[44:47], v7, s[40:43], s56 offen offset:3072 sc1
    s_mov_b64 exec, -1
    s_bitset1_b32 s63, 2
    s_branch L_h4_n2
L_h4_f4:
    buffer_load_dwordx4 v[48:51], v7, s[40:43], s57 offen offset:0 sc1
    buffer_load_dwordx4 v[52:55], v7, s[40:43], s57 offen offset:1024 sc1
    s_mov_b64 exec, -1
    s_bitset1_b32 s63, 4
    s_branch L_h4_n4
L_h4_f6:
    buffer_load_dwordx4 v[56:59], v7, s[40:43], s57 offen offset:2048 sc1
    buffer_load_dwordx4 v[60:63], v7, s[40:43], s57 offen offset:3072 sc1
    s_mov_b64 exec, -1
    s_bitset1_b32 s63, 6
    s_branch L_h4_n6
L_h4_r:
    s_sub_u32 s3, s3, 1
    s_cbranch_scc1 L_end
    s_waitcnt vmcnt(0)
    s_bitcmp1_b32 s63, 0
    s_cbranch_scc0 L_h4_s0
    v_max3_u32 v12, v32, v33, v34
    v_max3_u32 v12, v12, v35, v36
    v_max3_u32 v12, v12, v37, v38
    v_max_u32 v12, v12, v39
    v_cmp_eq_u32 vcc, -1, v12
    s_cbranch_vccz L_h4_g0
    buffer_load_dwordx4 v[32:35], v7, s[40:43], s56 offen offset:0 sc1
    buffer_load_dwordx4 v[36:39], v7, s[40:43], s56 offen offset:1024 sc1
    s_mov_b64 exec, -1
    s_branch L_h4_s0
L_h4_g0:
    s_bitset0_b32 s63, 0
    v_mfma_f32_16x16x32_bf16 v[28:31], v[20:23], v[32:35], v[28:31]
    v_mfma_f32_16x16x32_bf16 v[28:31], v[20:23], v[36:39], v[28:31]
L_h4_s0:
    s_bitcmp1_b32 s63, 2
    s_cbranch_scc0 L_h4_s2
    v_max3_u32 v12, v40, v41, v42
    v_max3_u32 v12, v12, v43, v44
    v_max3_u32 v12, v12, v45, v46
    v_max_u32 v12, v12, v47
    v_cmp_eq_u32 vcc, -1, v12
    s_cbranch_vccz L_h4_g2
    buffer_load_dwordx4 v[40:43], v7, s[40:43], s56 offen offset:2048 sc1
    buffer_load_dwordx4 v[44:47], v7, s[40:43], s56 offen offset:3072 sc1
    s_mov_b64 exec, -1
    s_branch L_h4_s2
L_h4_g2:
    s_bitset0_b32 s63, 2
    v_mfma_f32_16x16x32_bf16 v[28:31], v[20:23], v[40:43], v[28:31]
    v_mfma_f32_16x16x32_bf16 v[28:31], v[20:23], v[44:47], v[28:31]
L_h4_s2:
    s_bitcmp1_b32 s63, 4
    s_cbranch_scc0 L_h4_s4
    v_max3_u32 v12, v48, v49, v50
    v_max3_u32 v12, v12, v51, v52
    v_max3_u32 v12, v12, v53, v54
    v_max_u32 v12, v12, v55
    v_cmp_eq_u32 vcc, -1, v12
    s_cbranch_vccz L_h4_g4
    buffer_load_dwordx4 v[48:51], v7, s[40:43], s57 offen offset:0 sc1
    buffer_load_dwordx4 v[52:55], v7, s[40:43], s57 offen offset:1024 sc1
    s_mov_b64 exec, -1
    s_branch L_h4_s4
L_h4_g4:
    s_bitset0_b32 s63, 4
    v_mfma_f32_16x16x32_bf16 v[28:31], v[20:23], v[48:51], v[28:31]
    v_mfma_f32_16x16x32_bf16 v[28:31], v[20:23], v[52:55], v[28:31]
L_h4_s4:
    s_bitcmp1_b32 s63, 6
    s_cbranch_scc0 L_h4_s6
    v_max3_u32 v12, v56, v57, v58
    v_max3_u32 v12, v12, v59, v60
    v_max3_u32 v12, v12, v61, v62
    v_max_u32 v12, v12, v63
    v_cmp_eq_u32 vcc, -1, v12
    s_cbranch_vccz L_h4_g6
    buffer_load_dwordx4 v[56:59], v7, s[40:43], s57 offen offset:2048 sc1
    buffer_load_dwordx4 v[60:63], v7, s[40:43], s57 offen offset:3072 sc1
    s_mov_b64 exec, -1
    s_branch L_h4_s6
L_h4_g6:
    s_bitset0_b32 s63, 6
    v_mfma_f32_16x16x32_bf16 v[28:31], v[20:23], v[56:59], v[28:31]
    v_mfma_f32_16x16x32_bf16 v[28:31], v[20:23], v[60:63], v[28:31]
L_h4_s6:
    s_cmp_lg_u32 s63, 0
    s_cbranch_scc1 L_h4_r
    s_branch L_h4_d
L_h3_r0:
    buffer_load_dwordx4 v[32:35], v7, s[40:43], s51 offen offset:0 sc1
    buffer_load_dwordx4 v[36:39], v7, s[40:43], s51 offen offset:1024 sc1
    buffer_load_dwordx4 v[40:43], v7, s[40:43], s51 offen offset:2048 sc1
    buffer_load_dwordx4 v[44:47], v7, s[40:43], s51 offen offset:3072 sc1
    buffer_load_dwordx4 v[48:51], v7, s[40:43], s52 offen offset:0 sc1
    buffer_load_dwordx4 v[52:55], v7, s[40:43], s52 offen offset:1024 sc1
    buffer_load_dwordx4 v[56:59], v7, s[40:43], s52 offen offset:2048 sc1
    buffer_load_dwordx4 v[60:63], v7, s[40:43], s52 offen offset:3072 sc1
    s_sub_u32 s3, s3, 1
    s_cbranch_scc1 L_end
    s_waitcnt vmcnt(4)
    s_branch L_h3_c0
L_h3_r1:
    buffer_load_dwordx4 v[48:51], v7, s[40:43], s52 offen offset:0 sc1
    buffer_load_dwordx4 v[52:55], v7, s[40:43], s52 offen offset:1024 sc1
    buffer_load_dwordx4 v[56:59], v7, s[40:43], s52 offen offset:2048 sc1
    buffer_load_dwordx4 v[60:63], v7, s[40:43], s52 offen offset:3072 sc1
    s_sub_u32 s3, s3, 1
    s_cbranch_scc1 L_end
    s_waitcnt vmcnt(0)
    s_branch L_h3_c1
L_Bc:
    s_cmp_lg_u32 s34, 0
    s_cbranch_scc1 L_B_go
    s_lshl2_add_u32 s55, s36, s37

    v_lshrrev_b32 v2, 2, v1
    v_mul_u32_u24 v4, 6144, v2
    v_lshrrev_b32 v2, 5, v1
    v_bfe_u32 v5, v1, 1, 1
    v_xor_b32 v2, v2, v5
    v_lshl_add_u32 v4, v2, 10, v4
    v_and_b32 v2, 1, v1
    v_lshl_add_u32 v4, v2, 4, v4
    s_mul_i32 s58, s33, 786432
    s_lshl_b32 s39, s55, 5
    s_add_u32 s58, s58, s39
    s_lshl_b32 s59, s33, 13
    s_add_u32 m0, s59, 65536
    s_waitcnt lgkmcnt(0)
    s_mov_b32 s44, s24
    s_mov_b32 s45, s25
    s_mov_b32 s46, 3145728
    s_mov_b32 s47, 0x20000

    s_mov_b32 s3, 0x400000
    v_mov_b32 v0, 156256
    s_and_b32 s62, s34, 3
    s_lshl2_add_u32 s97, s62, s37
    s_lshl4_add_u32 s61, s36, s97
    s_waitcnt lgkmcnt(0)

    s_mov_b32 s40, s30
    s_mov_b32 s41, s31
    s_mov_b32 s42, 16777216
    s_mov_b32 s43, 0x20000
    s_barrier
    buffer_load_dwordx4 v4, s[44:47], s58 offen lds
    s_add_u32 m0, m0, 1024
    s_add_u32 s58, s58, 98304
    buffer_load_dwordx4 v4, s[44:47], s58 offen lds
    s_add_u32 m0, m0, 1024
    s_add_u32 s58, s58, 98304
    buffer_load_dwordx4 v4, s[44:47], s58 offen lds
    s_add_u32 m0, m0, 1024
    s_add_u32 s58, s58, 98304
    buffer_load_dwordx4 v4, s[44:47], s58 offen lds
    s_add_u32 m0, m0, 1024
    s_add_u32 s58, s58, 98304
    buffer_load_dwordx4 v4, s[44:47], s58 offen lds
    s_add_u32 m0, m0, 1024
    s_add_u32 s58, s58, 98304
    buffer_load_dwordx4 v4, s[44:47], s58 offen lds
    s_add_u32 m0, m0, 1024
    s_add_u32 s58, s58, 98304
    buffer_load_dwordx4 v4, s[44:47], s58 offen lds
    s_add_u32 m0, m0, 1024
    s_add_u32 s58, s58, 98304
    buffer_load_dwordx4 v4, s[44:47], s58 offen lds
    s_add_u32 m0, m0, 1024
    s_add_u32 s58, s58, 98304
    v_mov_b32 v6, 1
    s_mov_b64 exec, 1
    ds_add_u32 v0, v6 offset:7056
    s_mov_b64 exec, -1
    s_lshl_b32 s38, s33, 2
    v_add_u32 v5, s38, v0
    v_mov_b32 v7, 2
    s_waitcnt vmcnt(4)
    ds_write_b32 v5, v6 offset:4032
    s_waitcnt vmcnt(0)
    ds_write_b32 v5, v7 offset:4032
    s_branch L_B_t
L_B_go:
    s_lshl_b32 s48, s33, 20
    s_lshl_b32 s38, s35, 8
    s_add_u32 s48, s48, s38
    s_and_b32 s49, s34, 3
    v_lshrrev_b32 v4, 4, v1
    v_and_b32 v5, 15, v1
    v_lshlrev_b32 v2, 18, v4
    v_lshl_add_u32 v2, v5, 4, v2
    s_waitcnt lgkmcnt(0)
    s_mov_b32 s44, s8
    s_mov_b32 s45, s9
    s_mov_b32 s46, 4194304
    s_mov_b32 s47, 0x20000
    s_xor_b32 s38, s49, 0
    s_lshl_b32 s38, s38, 16
    s_add_u32 s38, s38, s48
    buffer_load_dwordx4 v[40:43], v2, s[44:47], s38 offen
    s_add_u32 s38, s38, 8192
    buffer_load_dwordx4 v[44:47], v2, s[44:47], s38 offen
    s_add_u32 s38, s38, 8192
    buffer_load_dwordx4 v[48:51], v2, s[44:47], s38 offen
    s_add_u32 s38, s38, 8192
    buffer_load_dwordx4 v[52:55], v2, s[44:47], s38 offen
    s_add_u32 s38, s38, 8192
    buffer_load_dwordx4 v[56:59], v2, s[44:47], s38 offen
    s_add_u32 s38, s38, 8192
    buffer_load_dwordx4 v[60:63], v2, s[44:47], s38 offen
    s_add_u32 s38, s38, 8192
    buffer_load_dwordx4 v[64:67], v2, s[44:47], s38 offen
    s_add_u32 s38, s38, 8192
    buffer_load_dwordx4 v[68:71], v2, s[44:47], s38 offen

    s_mov_b32 s3, 0x400000
    v_mov_b32 v0, 156256
    s_and_b32 s62, s34, 3
    s_lshl2_add_u32 s97, s62, s37
    s_lshl4_add_u32 s61, s36, s97
    s_waitcnt lgkmcnt(0)

    s_mov_b32 s40, s30
    s_mov_b32 s41, s31
    s_mov_b32 s42, 16777216
    s_mov_b32 s43, 0x20000
    s_barrier
    s_xor_b32 s38, s49, 1
    s_lshl_b32 s38, s38, 16
    s_add_u32 s38, s38, s48
    buffer_load_dwordx4 v[72:75], v2, s[44:47], s38 offen
    s_add_u32 s38, s38, 8192
    s_waitcnt vmcnt(6)
    buffer_load_dwordx4 v[76:79], v2, s[44:47], s38 offen
    s_add_u32 s38, s38, 8192
    s_waitcnt vmcnt(6)
    buffer_load_dwordx4 v[80:83], v2, s[44:47], s38 offen
    s_add_u32 s38, s38, 8192
    s_waitcnt vmcnt(6)
    buffer_load_dwordx4 v[84:87], v2, s[44:47], s38 offen
    s_add_u32 s38, s38, 8192
    s_waitcnt vmcnt(6)
    buffer_load_dwordx4 v[88:91], v2, s[44:47], s38 offen
    s_add_u32 s38, s38, 8192
    s_waitcnt vmcnt(6)
    buffer_load_dwordx4 v[92:95], v2, s[44:47], s38 offen
    s_add_u32 s38, s38, 8192
    s_waitcnt vmcnt(6)
    buffer_load_dwordx4 v[96:99], v2, s[44:47], s38 offen
    s_add_u32 s38, s38, 8192
    s_waitcnt vmcnt(6)
    buffer_load_dwordx4 v[100:103], v2, s[44:47], s38 offen
    s_waitcnt vmcnt(6)
    s_xor_b32 s38, s49, 2
    s_lshl_b32 s38, s38, 16
    s_add_u32 s38, s38, s48
    buffer_load_dwordx4 v[104:107], v2, s[44:47], s38 offen
    s_add_u32 s38, s38, 8192
    s_waitcnt vmcnt(6)
    buffer_load_dwordx4 v[108:111], v2, s[44:47], s38 offen
    s_add_u32 s38, s38, 8192
    s_waitcnt vmcnt(6)
    buffer_load_dwordx4 v[112:115], v2, s[44:47], s38 offen
    s_add_u32 s38, s38, 8192
    s_waitcnt vmcnt(6)
    buffer_load_dwordx4 v[116:119], v2, s[44:47], s38 offen
    s_add_u32 s38, s38, 8192
    s_waitcnt vmcnt(6)
    buffer_load_dwordx4 v[120:123], v2, s[44:47], s38 offen
    s_add_u32 s38, s38, 8192
    s_waitcnt vmcnt(6)
    buffer_load_dwordx4 v[124:127], v2, s[44:47], s38 offen
    s_add_u32 s38, s38, 8192
    s_waitcnt vmcnt(6)
    buffer_load_dwordx4 v[128:131], v2, s[44:47], s38 offen
    s_add_u32 s38, s38, 8192
    s_waitcnt vmcnt(6)
    buffer_load_dwordx4 v[132:135], v2, s[44:47], s38 offen
    s_waitcnt vmcnt(6)
    s_xor_b32 s38, s49, 3
    s_lshl_b32 s38, s38, 16
    s_add_u32 s38, s38, s48
    buffer_load_dwordx4 v[136:139], v2, s[44:47], s38 offen
    s_add_u32 s38, s38, 8192
    s_waitcnt vmcnt(6)
    buffer_load_dwordx4 v[140:143], v2, s[44:47], s38 offen
    s_add_u32 s38, s38, 8192
    s_waitcnt vmcnt(6)
    buffer_load_dwordx4 v[144:147], v2, s[44:47], s38 offen
    s_add_u32 s38, s38, 8192
    s_waitcnt vmcnt(6)
    buffer_load_dwordx4 v[148:151], v2, s[44:47], s38 offen
    s_add_u32 s38, s38, 8192
    s_waitcnt vmcnt(6)
    buffer_load_dwordx4 v[152:155], v2, s[44:47], s38 offen
    s_add_u32 s38, s38, 8192
    s_waitcnt vmcnt(6)
    buffer_load_dwordx4 v[156:159], v2, s[44:47], s38 offen
    s_add_u32 s38, s38, 8192
    s_waitcnt vmcnt(6)
    buffer_load_dwordx4 v[160:163], v2, s[44:47], s38 offen
    s_add_u32 s38, s38, 8192
    s_waitcnt vmcnt(6)
    buffer_load_dwordx4 v[164:167], v2, s[44:47], s38 offen
    s_waitcnt vmcnt(6)
    v_mov_b32 v6, 1
    s_mov_b64 exec, 1
    ds_add_u32 v0, v6 offset:0
    s_mov_b64 exec, -1

    v_lshrrev_b32 v5, 1, v5
    v_lshlrev_b32 v5, 4, v5
    v_lshl_add_u32 v7, v4, 9, v5
    s_and_b32 s38, s36, 0
    s_lshl2_add_u32 s38, s38, s33
    s_lshl_b32 s38, s38, 11
    s_xor_b32 s50, s49, 0
    s_lshl_b32 s50, s50, 7
    s_add_u32 s50, s50, s38
    s_xor_b32 s51, s49, 1
    s_lshl_b32 s51, s51, 7
    s_add_u32 s51, s51, s38
    s_xor_b32 s52, s49, 2
    s_lshl_b32 s52, s52, 7
    s_add_u32 s52, s52, s38
    s_xor_b32 s53, s49, 3
    s_lshl_b32 s53, s53, 7
    s_add_u32 s53, s53, s38

    v_and_b32 v4, 1, v1
    v_cmp_eq_u32 vcc, 1, v4
    v_mov_b32 v2, 0x0c0c0100
    v_mov_b32 v4, 0x01000c0c
    v_cndmask_b32 v2, v2, v4, vcc
    v_mov_b32 v3, 0x0c0c0302
    v_mov_b32 v4, 0x03020c0c
    v_cndmask_b32 v3, v3, v4, vcc

    v_and_b32 v6, 0, v1
    v_lshlrev_b32 v6, 2, v6
L_fl17:
    global_load_dword v4, v6, s[28:29] offset:32 sc1
    s_sub_u32 s3, s3, 1
    s_cbranch_scc1 L_end
    s_waitcnt vmcnt(0)
    v_cmp_eq_u32 vcc, 0, v4
    s_cbranch_vccnz L_fl17
    v_swap_b32 v41, v44
    v_swap_b32 v42, v48
    v_swap_b32 v43, v52
    v_swap_b32 v46, v49
    v_swap_b32 v47, v53
    v_swap_b32 v51, v54
    v_swap_b32 v57, v60
    v_swap_b32 v58, v64
    v_swap_b32 v59, v68
    v_swap_b32 v62, v65
    v_swap_b32 v63, v69
    v_swap_b32 v67, v70
    v_swap_b32 v73, v76
    v_swap_b32 v74, v80
    v_swap_b32 v75, v84
    v_swap_b32 v78, v81
    v_swap_b32 v79, v85
    v_swap_b32 v83, v86
    v_swap_b32 v89, v92
    v_swap_b32 v90, v96
    v_swap_b32 v91, v100
    v_swap_b32 v94, v97
    v_swap_b32 v95, v101
    v_swap_b32 v99, v102
    v_swap_b32 v105, v108
    v_swap_b32 v106, v112
    v_swap_b32 v107, v116
    v_swap_b32 v110, v113
    v_swap_b32 v111, v117
    v_swap_b32 v115, v118
    v_swap_b32 v121, v124
    v_swap_b32 v122, v128
    v_swap_b32 v123, v132
    v_swap_b32 v126, v129
    v_swap_b32 v127, v133
    v_swap_b32 v131, v134
    v_swap_b32 v137, v140
    v_swap_b32 v138, v144
    v_swap_b32 v139, v148
    v_swap_b32 v142, v145
    v_swap_b32 v143, v149
    v_swap_b32 v147, v150
    v_swap_b32 v153, v156
    v_swap_b32 v154, v160
    v_swap_b32 v155, v164
    v_swap_b32 v158, v161
    v_swap_b32 v159, v165
    v_swap_b32 v163, v166
L_w18:
    ds_read_b32 v24, v0 offset:7068
    s_sub_u32 s3, s3, 1
    s_cbranch_scc1 L_end
    s_waitcnt lgkmcnt(0)
    v_cmp_gt_u32 vcc, 2, v24
    s_cbranch_vccnz L_w18
L_B_h0:
    buffer_load_dwordx4 v[8:11], v7, s[40:43], s50 offen sc1
    buffer_load_dwordx4 v[12:15], v7, s[40:43], s51 offen sc1
    buffer_load_dwordx4 v[16:19], v7, s[40:43], s52 offen sc1
    buffer_load_dwordx4 v[20:23], v7, s[40:43], s53 offen sc1
    s_sub_u32 s3, s3, 1
    s_cbranch_scc1 L_end
L_B_h1:
    s_waitcnt vmcnt(0)
    v_max3_u32 v24, v8, v9, v10
    v_max3_u32 v24, v24, v11, v12
    v_max3_u32 v24, v24, v13, v14
    v_max3_u32 v24, v24, v15, v16
    v_max3_u32 v24, v24, v17, v18
    v_max3_u32 v24, v24, v19, v20
    v_max3_u32 v24, v24, v21, v22
    v_max_u32 v24, v24, v23
    v_cmp_eq_u32 vcc, -1, v24
    s_cbranch_vccnz L_B_h0
    v_mov_b32 v24, 1
    s_mov_b64 exec, 1
    ds_add_u32 v0, v24 offset:4
    s_mov_b64 exec, -1
    v_perm_b32 v4, v8, v8, v2
    v_perm_b32 v5, v8, v8, v3
    v_perm_b32 v6, v9, v9, v2
    v_perm_b32 v7, v9, v9, v3
    s_nop 1
    v_mfma_f32_16x16x32_bf16 v[24:27], v[40:43], v[4:7], 0
    v_perm_b32 v40, v10, v10, v2
    v_perm_b32 v41, v10, v10, v3
    v_mfma_f32_16x16x32_bf16 v[28:31], v[44:47], v[4:7], 0
    v_perm_b32 v42, v11, v11, v2
    v_perm_b32 v43, v11, v11, v3
    v_mfma_f32_16x16x32_bf16 v[32:35], v[48:51], v[4:7], 0
    v_mfma_f32_16x16x32_bf16 v[36:39], v[52:55], v[4:7], 0
    v_mfma_f32_16x16x32_bf16 v[24:27], v[56:59], v[40:43], v[24:27]
    v_perm_b32 v56, v12, v12, v2
    v_perm_b32 v57, v12, v12, v3
    v_mfma_f32_16x16x32_bf16 v[28:31], v[60:63], v[40:43], v[28:31]
    v_perm_b32 v58, v13, v13, v2
    v_perm_b32 v59, v13, v13, v3
    v_mfma_f32_16x16x32_bf16 v[32:35], v[64:67], v[40:43], v[32:35]
    v_mfma_f32_16x16x32_bf16 v[36:39], v[68:71], v[40:43], v[36:39]
    v_mfma_f32_16x16x32_bf16 v[24:27], v[72:75], v[56:59], v[24:27]
    v_perm_b32 v72, v14, v14, v2
    v_perm_b32 v73, v14, v14, v3
    v_mfma_f32_16x16x32_bf16 v[28:31], v[76:79], v[56:59], v[28:31]
    v_perm_b32 v74, v15, v15, v2
    v_perm_b32 v75, v15, v15, v3
    v_mfma_f32_16x16x32_bf16 v[32:35], v[80:83], v[56:59], v[32:35]
    v_mfma_f32_16x16x32_bf16 v[36:39], v[84:87], v[56:59], v[36:39]
    v_mfma_f32_16x16x32_bf16 v[24:27], v[88:91], v[72:75], v[24:27]
    v_perm_b32 v88, v16, v16, v2
    v_perm_b32 v89, v16, v16, v3
    v_mfma_f32_16x16x32_bf16 v[28:31], v[92:95], v[72:75], v[28:31]
    v_perm_b32 v90, v17, v17, v2
    v_perm_b32 v91, v17, v17, v3
    v_mfma_f32_16x16x32_bf16 v[32:35], v[96:99], v[72:75], v[32:35]
    v_mfma_f32_16x16x32_bf16 v[36:39], v[100:103], v[72:75], v[36:39]
    v_mfma_f32_16x16x32_bf16 v[24:27], v[104:107], v[88:91], v[24:27]
    v_perm_b32 v104, v18, v18, v2
    v_perm_b32 v105, v18, v18, v3
    v_mfma_f32_16x16x32_bf16 v[28:31], v[108:111], v[88:91], v[28:31]
    v_perm_b32 v106, v19, v19, v2
    v_perm_b32 v107, v19, v19, v3
    v_mfma_f32_16x16x32_bf16 v[32:35], v[112:115], v[88:91], v[32:35]
    v_mfma_f32_16x16x32_bf16 v[36:39], v[116:119], v[88:91], v[36:39]
    v_mfma_f32_16x16x32_bf16 v[24:27], v[120:123], v[104:107], v[24:27]
    v_perm_b32 v120, v20, v20, v2
    v_perm_b32 v121, v20, v20, v3
    v_mfma_f32_16x16x32_bf16 v[28:31], v[124:127], v[104:107], v[28:31]
    v_perm_b32 v122, v21, v21, v2
    v_perm_b32 v123, v21, v21, v3
    v_mfma_f32_16x16x32_bf16 v[32:35], v[128:131], v[104:107], v[32:35]
    v_mfma_f32_16x16x32_bf16 v[36:39], v[132:135], v[104:107], v[36:39]
    v_mfma_f32_16x16x32_bf16 v[24:27], v[136:139], v[120:123], v[24:27]
    v_perm_b32 v136, v22, v22, v2
    v_perm_b32 v137, v22, v22, v3
    v_mfma_f32_16x16x32_bf16 v[28:31], v[140:143], v[120:123], v[28:31]
    v_perm_b32 v138, v23, v23, v2
    v_perm_b32 v139, v23, v23, v3
    v_mfma_f32_16x16x32_bf16 v[32:35], v[144:147], v[120:123], v[32:35]
    v_mfma_f32_16x16x32_bf16 v[36:39], v[148:151], v[120:123], v[36:39]
    v_mfma_f32_16x16x32_bf16 v[24:27], v[152:155], v[136:139], v[24:27]
    v_mfma_f32_16x16x32_bf16 v[28:31], v[156:159], v[136:139], v[28:31]
    v_mfma_f32_16x16x32_bf16 v[32:35], v[160:163], v[136:139], v[32:35]
    v_mfma_f32_16x16x32_bf16 v[36:39], v[164:167], v[136:139], v[36:39]
    s_lshl_b32 s38, s33, 12
    s_add_u32 s38, s38, 131072
    v_lshl_add_u32 v4, v1, 4, s38
    s_nop 1
    ds_write_b128 v4, v[24:27] offset:0
    ds_write_b128 v4, v[28:31] offset:1024
    ds_write_b128 v4, v[32:35] offset:2048
    ds_write_b128 v4, v[36:39] offset:3072
    v_mov_b32 v5, 1
    s_mov_b64 exec, 1
    ds_add_u32 v0, v5 offset:5040
    s_mov_b64 exec, -1
L_B_t:
    s_cmp_lt_u32 s33, 2
    s_cbranch_scc1 L_B_uv
    s_cmp_eq_u32 s33, 2
    s_cbranch_scc1 L_B_mo
L_w19:
    s_sleep 1
    ds_read_b32 v6, v0 offset:5044
    s_sub_u32 s3, s3, 1
    s_cbranch_scc1 L_end
    s_waitcnt lgkmcnt(0)
    v_cmp_gt_u32 vcc, 3, v6
    s_cbranch_vccnz L_w19
    v_mov_b32 v4, 0
L_fl20:
    s_sleep 8
    global_load_dword v5, v4, s[28:29] offset:4 sc1
    s_sub_u32 s3, s3, 1
    s_cbranch_scc1 L_end
    s_waitcnt vmcnt(0)
    v_cmp_eq_u32 vcc, 0, v5
    s_cbranch_vccnz L_fl20
    v_mov_b32 v6, 1
    s_mov_b64 exec, 1
    ds_add_u32 v0, v6 offset:5052
    s_mov_b64 exec, -1
    s_branch L_end
L_B_mo:
L_w21:
    s_sleep 1
    ds_read_b32 v6, v0 offset:5044
    s_sub_u32 s3, s3, 1
    s_cbranch_scc1 L_end
    s_waitcnt lgkmcnt(0)
    v_cmp_gt_u32 vcc, 3, v6
    s_cbranch_vccnz L_w21
    s_mov_b32 s44, s22
    s_mov_b32 s45, s23
    s_mov_b32 s46, 8192
    s_mov_b32 s47, 0x20000

    v_lshrrev_b32 v4, 4, v1
    v_and_b32 v5, 15, v1
    v_lshrrev_b32 v2, 1, v5
    v_lshlrev_b32 v2, 10, v2
    v_lshl_add_u32 v2, v4, 6, v2
    s_lshl_b32 s38, s62, 8
    buffer_load_dwordx4 v[8:11], v2, s[44:47], s38 offen offset:0
    buffer_load_dwordx4 v[12:15], v2, s[44:47], s38 offen offset:16
    buffer_load_dwordx4 v[16:19], v2, s[44:47], s38 offen offset:32
    buffer_load_dwordx4 v[20:23], v2, s[44:47], s38 offen offset:48
    s_mov_b32 s44, s24
    s_mov_b32 s45, s25
    s_mov_b32 s46, 3145728
    s_mov_b32 s47, 0x20000

    v_mul_u32_u24 v2, 196608, v4
    v_lshl_add_u32 v2, v5, 3, v2
    v_lshlrev_b32 v4, 11, v4
    v_lshl_add_u32 v4, v5, 3, v4
    v_and_b32 v3, 1, v1
    v_lshlrev_b32 v3, 4, v3
    s_mov_b32 s38, 0xffff
    v_lshlrev_b32 v3, v3, s38
    s_mul_i32 s48, s62, 786432
    s_lshl_b32 s38, s35, 7
    s_add_u32 s48, s48, s38
    s_add_u32 s48, s48, 2048
    s_lshl2_add_u32 s49, s37, s62
    s_lshl_b32 s49, s49, 13
    s_lshl_b32 s38, s36, 7
    s_add_u32 s49, s49, s38
    s_add_u32 s49, s49, 1179648
    s_mov_b32 s38, 0xbfb8aa3b
    s_waitcnt vmcnt(0)
    v_lshlrev_b32 v24, 16, v8
    v_and_b32 v25, 0xffff0000, v8
    v_mul_f32 v26, s38, v24
    v_mul_f32 v27, s38, v25
    v_exp_f32 v26, v26
    v_exp_f32 v27, v27
    v_add_f32 v26, 1.0, v26
    v_add_f32 v27, 1.0, v27
    v_rcp_f32 v26, v26
    v_rcp_f32 v27, v27
    v_mul_f32 v24, v24, v26
    v_mul_f32 v25, v25, v27
    v_cvt_pk_bf16_f32 v24, v24, v24
    v_cvt_pk_bf16_f32 v25, v25, v25
    v_and_b32 v40, v24, v3
    v_and_b32 v41, v25, v3
    v_lshlrev_b32 v24, 16, v9
    v_and_b32 v25, 0xffff0000, v9
    v_mul_f32 v26, s38, v24
    v_mul_f32 v27, s38, v25
    v_exp_f32 v26, v26
    v_exp_f32 v27, v27
    v_add_f32 v26, 1.0, v26
    v_add_f32 v27, 1.0, v27
    v_rcp_f32 v26, v26
    v_rcp_f32 v27, v27
    v_mul_f32 v24, v24, v26
    v_mul_f32 v25, v25, v27
    v_cvt_pk_bf16_f32 v24, v24, v24
    v_cvt_pk_bf16_f32 v25, v25, v25
    v_and_b32 v42, v24, v3
    v_and_b32 v43, v25, v3
    v_lshlrev_b32 v24, 16, v10
    v_and_b32 v25, 0xffff0000, v10
    v_mul_f32 v26, s38, v24
    v_mul_f32 v27, s38, v25
    v_exp_f32 v26, v26
    v_exp_f32 v27, v27
    v_add_f32 v26, 1.0, v26
    v_add_f32 v27, 1.0, v27
    v_rcp_f32 v26, v26
    v_rcp_f32 v27, v27
    v_mul_f32 v24, v24, v26
    v_mul_f32 v25, v25, v27
    v_cvt_pk_bf16_f32 v24, v24, v24
    v_cvt_pk_bf16_f32 v25, v25, v25
    v_and_b32 v44, v24, v3
    v_and_b32 v45, v25, v3
    v_lshlrev_b32 v24, 16, v11
    v_and_b32 v25, 0xffff0000, v11
    v_mul_f32 v26, s38, v24
    v_mul_f32 v27, s38, v25
    v_exp_f32 v26, v26
    v_exp_f32 v27, v27
    v_add_f32 v26, 1.0, v26
    v_add_f32 v27, 1.0, v27
    v_rcp_f32 v26, v26
    v_rcp_f32 v27, v27
    v_mul_f32 v24, v24, v26
    v_mul_f32 v25, v25, v27
    v_cvt_pk_bf16_f32 v24, v24, v24
    v_cvt_pk_bf16_f32 v25, v25, v25
    v_and_b32 v46, v24, v3
    v_and_b32 v47, v25, v3
    v_lshlrev_b32 v24, 16, v12
    v_and_b32 v25, 0xffff0000, v12
    v_mul_f32 v26, s38, v24
    v_mul_f32 v27, s38, v25
    v_exp_f32 v26, v26
    v_exp_f32 v27, v27
    v_add_f32 v26, 1.0, v26
    v_add_f32 v27, 1.0, v27
    v_rcp_f32 v26, v26
    v_rcp_f32 v27, v27
    v_mul_f32 v24, v24, v26
    v_mul_f32 v25, v25, v27
    v_cvt_pk_bf16_f32 v24, v24, v24
    v_cvt_pk_bf16_f32 v25, v25, v25
    v_and_b32 v48, v24, v3
    v_and_b32 v49, v25, v3
    v_lshlrev_b32 v24, 16, v13
    v_and_b32 v25, 0xffff0000, v13
    v_mul_f32 v26, s38, v24
    v_mul_f32 v27, s38, v25
    v_exp_f32 v26, v26
    v_exp_f32 v27, v27
    v_add_f32 v26, 1.0, v26
    v_add_f32 v27, 1.0, v27
    v_rcp_f32 v26, v26
    v_rcp_f32 v27, v27
    v_mul_f32 v24, v24, v26
    v_mul_f32 v25, v25, v27
    v_cvt_pk_bf16_f32 v24, v24, v24
    v_cvt_pk_bf16_f32 v25, v25, v25
    v_and_b32 v50, v24, v3
    v_and_b32 v51, v25, v3
    v_lshlrev_b32 v24, 16, v14
    v_and_b32 v25, 0xffff0000, v14
    v_mul_f32 v26, s38, v24
    v_mul_f32 v27, s38, v25
    v_exp_f32 v26, v26
    v_exp_f32 v27, v27
    v_add_f32 v26, 1.0, v26
    v_add_f32 v27, 1.0, v27
    v_rcp_f32 v26, v26
    v_rcp_f32 v27, v27
    v_mul_f32 v24, v24, v26
    v_mul_f32 v25, v25, v27
    v_cvt_pk_bf16_f32 v24, v24, v24
    v_cvt_pk_bf16_f32 v25, v25, v25
    v_and_b32 v52, v24, v3
    v_and_b32 v53, v25, v3
    v_lshlrev_b32 v24, 16, v15
    v_and_b32 v25, 0xffff0000, v15
    v_mul_f32 v26, s38, v24
    v_mul_f32 v27, s38, v25
    v_exp_f32 v26, v26
    v_exp_f32 v27, v27
    v_add_f32 v26, 1.0, v26
    v_add_f32 v27, 1.0, v27
    v_rcp_f32 v26, v26
    v_rcp_f32 v27, v27
    v_mul_f32 v24, v24, v26
    v_mul_f32 v25, v25, v27
    v_cvt_pk_bf16_f32 v24, v24, v24
    v_cvt_pk_bf16_f32 v25, v25, v25
    v_and_b32 v54, v24, v3
    v_and_b32 v55, v25, v3
    v_lshlrev_b32 v24, 16, v16
    v_and_b32 v25, 0xffff0000, v16
    v_mul_f32 v26, s38, v24
    v_mul_f32 v27, s38, v25
    v_exp_f32 v26, v26
    v_exp_f32 v27, v27
    v_add_f32 v26, 1.0, v26
    v_add_f32 v27, 1.0, v27
    v_rcp_f32 v26, v26
    v_rcp_f32 v27, v27
    v_mul_f32 v24, v24, v26
    v_mul_f32 v25, v25, v27
    v_cvt_pk_bf16_f32 v24, v24, v24
    v_cvt_pk_bf16_f32 v25, v25, v25
    v_and_b32 v56, v24, v3
    v_and_b32 v57, v25, v3
    v_lshlrev_b32 v24, 16, v17
    v_and_b32 v25, 0xffff0000, v17
    v_mul_f32 v26, s38, v24
    v_mul_f32 v27, s38, v25
    v_exp_f32 v26, v26
    v_exp_f32 v27, v27
    v_add_f32 v26, 1.0, v26
    v_add_f32 v27, 1.0, v27
    v_rcp_f32 v26, v26
    v_rcp_f32 v27, v27
    v_mul_f32 v24, v24, v26
    v_mul_f32 v25, v25, v27
    v_cvt_pk_bf16_f32 v24, v24, v24
    v_cvt_pk_bf16_f32 v25, v25, v25
    v_and_b32 v58, v24, v3
    v_and_b32 v59, v25, v3
    v_lshlrev_b32 v24, 16, v18
    v_and_b32 v25, 0xffff0000, v18
    v_mul_f32 v26, s38, v24
    v_mul_f32 v27, s38, v25
    v_exp_f32 v26, v26
    v_exp_f32 v27, v27
    v_add_f32 v26, 1.0, v26
    v_add_f32 v27, 1.0, v27
    v_rcp_f32 v26, v26
    v_rcp_f32 v27, v27
    v_mul_f32 v24, v24, v26
    v_mul_f32 v25, v25, v27
    v_cvt_pk_bf16_f32 v24, v24, v24
    v_cvt_pk_bf16_f32 v25, v25, v25
    v_and_b32 v60, v24, v3
    v_and_b32 v61, v25, v3
    v_lshlrev_b32 v24, 16, v19
    v_and_b32 v25, 0xffff0000, v19
    v_mul_f32 v26, s38, v24
    v_mul_f32 v27, s38, v25
    v_exp_f32 v26, v26
    v_exp_f32 v27, v27
    v_add_f32 v26, 1.0, v26
    v_add_f32 v27, 1.0, v27
    v_rcp_f32 v26, v26
    v_rcp_f32 v27, v27
    v_mul_f32 v24, v24, v26
    v_mul_f32 v25, v25, v27
    v_cvt_pk_bf16_f32 v24, v24, v24
    v_cvt_pk_bf16_f32 v25, v25, v25
    v_and_b32 v62, v24, v3
    v_and_b32 v63, v25, v3
    v_lshlrev_b32 v24, 16, v20
    v_and_b32 v25, 0xffff0000, v20
    v_mul_f32 v26, s38, v24
    v_mul_f32 v27, s38, v25
    v_exp_f32 v26, v26
    v_exp_f32 v27, v27
    v_add_f32 v26, 1.0, v26
    v_add_f32 v27, 1.0, v27
    v_rcp_f32 v26, v26
    v_rcp_f32 v27, v27
    v_mul_f32 v24, v24, v26
    v_mul_f32 v25, v25, v27
    v_cvt_pk_bf16_f32 v24, v24, v24
    v_cvt_pk_bf16_f32 v25, v25, v25
    v_and_b32 v64, v24, v3
    v_and_b32 v65, v25, v3
    v_lshlrev_b32 v24, 16, v21
    v_and_b32 v25, 0xffff0000, v21
    v_mul_f32 v26, s38, v24
    v_mul_f32 v27, s38, v25
    v_exp_f32 v26, v26
    v_exp_f32 v27, v27
    v_add_f32 v26, 1.0, v26
    v_add_f32 v27, 1.0, v27
    v_rcp_f32 v26, v26
    v_rcp_f32 v27, v27
    v_mul_f32 v24, v24, v26
    v_mul_f32 v25, v25, v27
    v_cvt_pk_bf16_f32 v24, v24, v24
    v_cvt_pk_bf16_f32 v25, v25, v25
    v_and_b32 v66, v24, v3
    v_and_b32 v67, v25, v3
    v_lshlrev_b32 v24, 16, v22
    v_and_b32 v25, 0xffff0000, v22
    v_mul_f32 v26, s38, v24
    v_mul_f32 v27, s38, v25
    v_exp_f32 v26, v26
    v_exp_f32 v27, v27
    v_add_f32 v26, 1.0, v26
    v_add_f32 v27, 1.0, v27
    v_rcp_f32 v26, v26
    v_rcp_f32 v27, v27
    v_mul_f32 v24, v24, v26
    v_mul_f32 v25, v25, v27
    v_cvt_pk_bf16_f32 v24, v24, v24
    v_cvt_pk_bf16_f32 v25, v25, v25
    v_and_b32 v68, v24, v3
    v_and_b32 v69, v25, v3
    v_lshlrev_b32 v24, 16, v23
    v_and_b32 v25, 0xffff0000, v23
    v_mul_f32 v26, s38, v24
    v_mul_f32 v27, s38, v25
    v_exp_f32 v26, v26
    v_exp_f32 v27, v27
    v_add_f32 v26, 1.0, v26
    v_add_f32 v27, 1.0, v27
    v_rcp_f32 v26, v26
    v_rcp_f32 v27, v27
    v_mul_f32 v24, v24, v26
    v_mul_f32 v25, v25, v27
    v_cvt_pk_bf16_f32 v24, v24, v24
    v_cvt_pk_bf16_f32 v25, v25, v25
    v_and_b32 v70, v24, v3
    v_and_b32 v71, v25, v3
L_w22:
    s_sleep 1
    ds_read_b32 v6, v0 offset:5048
    s_sub_u32 s3, s3, 1
    s_cbranch_scc1 L_end
    s_waitcnt lgkmcnt(0)
    v_cmp_gt_u32 vcc, 4, v6
    s_cbranch_vccnz L_w22
    s_add_u32 s39, s48, 0
    buffer_load_dwordx2 v[104:105], v2, s[44:47], s39 offen nt
    s_add_u32 s39, s48, 6144
    buffer_load_dwordx2 v[108:109], v2, s[44:47], s39 offen nt
    s_add_u32 s39, s48, 12288
    buffer_load_dwordx2 v[106:107], v2, s[44:47], s39 offen nt
    s_add_u32 s39, s48, 18432
    buffer_load_dwordx2 v[110:111], v2, s[44:47], s39 offen nt
    s_add_u32 s39, s48, 24576
    buffer_load_dwordx2 v[112:113], v2, s[44:47], s39 offen nt
    s_add_u32 s39, s48, 30720
    buffer_load_dwordx2 v[116:117], v2, s[44:47], s39 offen nt
    s_add_u32 s39, s48, 36864
    buffer_load_dwordx2 v[114:115], v2, s[44:47], s39 offen nt
    s_add_u32 s39, s48, 43008
    buffer_load_dwordx2 v[118:119], v2, s[44:47], s39 offen nt
    s_add_u32 s39, s48, 49152
    buffer_load_dwordx2 v[120:121], v2, s[44:47], s39 offen nt
    s_add_u32 s39, s48, 55296
    buffer_load_dwordx2 v[124:125], v2, s[44:47], s39 offen nt
    s_add_u32 s39, s48, 61440
    buffer_load_dwordx2 v[122:123], v2, s[44:47], s39 offen nt
    s_add_u32 s39, s48, 67584
    buffer_load_dwordx2 v[126:127], v2, s[44:47], s39 offen nt
    s_add_u32 s39, s48, 73728
    buffer_load_dwordx2 v[128:129], v2, s[44:47], s39 offen nt
    s_add_u32 s39, s48, 79872
    buffer_load_dwordx2 v[132:133], v2, s[44:47], s39 offen nt
    s_add_u32 s39, s48, 86016
    buffer_load_dwordx2 v[130:131], v2, s[44:47], s39 offen nt
    s_add_u32 s39, s48, 92160
    buffer_load_dwordx2 v[134:135], v2, s[44:47], s39 offen nt
    s_add_u32 s39, s48, 98304
    buffer_load_dwordx2 v[136:137], v2, s[44:47], s39 offen nt
    s_add_u32 s39, s48, 104448
    buffer_load_dwordx2 v[140:141], v2, s[44:47], s39 offen nt
    s_add_u32 s39, s48, 110592
    buffer_load_dwordx2 v[138:139], v2, s[44:47], s39 offen nt
    s_add_u32 s39, s48, 116736
    buffer_load_dwordx2 v[142:143], v2, s[44:47], s39 offen nt
    s_add_u32 s39, s48, 122880
    buffer_load_dwordx2 v[144:145], v2, s[44:47], s39 offen nt
    s_add_u32 s39, s48, 129024
    buffer_load_dwordx2 v[148:149], v2, s[44:47], s39 offen nt
    s_add_u32 s39, s48, 135168
    buffer_load_dwordx2 v[146:147], v2, s[44:47], s39 offen nt
    s_add_u32 s39, s48, 141312
    buffer_load_dwordx2 v[150:151], v2, s[44:47], s39 offen nt
    s_add_u32 s39, s48, 147456
    buffer_load_dwordx2 v[152:153], v2, s[44:47], s39 offen nt
    s_add_u32 s39, s48, 153600
    buffer_load_dwordx2 v[156:157], v2, s[44:47], s39 offen nt
    s_add_u32 s39, s48, 159744
    buffer_load_dwordx2 v[154:155], v2, s[44:47], s39 offen nt
    s_add_u32 s39, s48, 165888
    buffer_load_dwordx2 v[158:159], v2, s[44:47], s39 offen nt
    s_add_u32 s39, s48, 172032
    buffer_load_dwordx2 v[160:161], v2, s[44:47], s39 offen nt
    s_add_u32 s39, s48, 178176
    buffer_load_dwordx2 v[164:165], v2, s[44:47], s39 offen nt
    s_add_u32 s39, s48, 184320
    buffer_load_dwordx2 v[162:163], v2, s[44:47], s39 offen nt
    s_add_u32 s39, s48, 190464
    buffer_load_dwordx2 v[166:167], v2, s[44:47], s39 offen nt
    s_waitcnt vmcnt(31)
    s_waitcnt vmcnt(0)
    v_mov_b32 v6, 1
    s_mov_b64 exec, 1
    ds_add_u32 v0, v6 offset:6060
    s_mov_b64 exec, -1
    v_swap_b32 v105, v108
    v_swap_b32 v107, v110
    v_swap_b32 v113, v116
    v_swap_b32 v115, v118
    v_swap_b32 v121, v124
    v_swap_b32 v123, v126
    v_swap_b32 v129, v132
    v_swap_b32 v131, v134
    v_swap_b32 v137, v140
    v_swap_b32 v139, v142
    v_swap_b32 v145, v148
    v_swap_b32 v147, v150
    v_swap_b32 v153, v156
    v_swap_b32 v155, v158
    v_swap_b32 v161, v164
    v_swap_b32 v163, v166
    v_mfma_f32_16x16x32_bf16 v[24:27], v[40:43], v[104:107], 0
    v_mfma_f32_16x16x32_bf16 v[28:31], v[40:43], v[108:111], 0
    v_mfma_f32_16x16x32_bf16 v[24:27], v[44:47], v[112:115], v[24:27]
    v_mfma_f32_16x16x32_bf16 v[28:31], v[44:47], v[116:119], v[28:31]
    v_mfma_f32_16x16x32_bf16 v[24:27], v[48:51], v[120:123], v[24:27]
    v_mfma_f32_16x16x32_bf16 v[28:31], v[48:51], v[124:127], v[28:31]
    v_mfma_f32_16x16x32_bf16 v[24:27], v[52:55], v[128:131], v[24:27]
    v_mfma_f32_16x16x32_bf16 v[28:31], v[52:55], v[132:135], v[28:31]
    v_mfma_f32_16x16x32_bf16 v[24:27], v[56:59], v[136:139], v[24:27]
    v_mfma_f32_16x16x32_bf16 v[28:31], v[56:59], v[140:143], v[28:31]
    v_mfma_f32_16x16x32_bf16 v[24:27], v[60:63], v[144:147], v[24:27]
    v_mfma_f32_16x16x32_bf16 v[28:31], v[60:63], v[148:151], v[28:31]
    v_mfma_f32_16x16x32_bf16 v[24:27], v[64:67], v[152:155], v[24:27]
    v_mfma_f32_16x16x32_bf16 v[28:31], v[64:67], v[156:159], v[28:31]
    v_mfma_f32_16x16x32_bf16 v[24:27], v[68:71], v[160:163], v[24:27]
    v_mfma_f32_16x16x32_bf16 v[28:31], v[68:71], v[164:167], v[28:31]
    s_nop 6
    v_cvt_pk_bf16_f32 v8, v24, v25
    v_cvt_pk_bf16_f32 v10, v26, v27
    v_cvt_pk_bf16_f32 v9, v28, v29
    v_cvt_pk_bf16_f32 v11, v30, v31
L_w23:
    s_sleep 1
    ds_read_b32 v6, v0 offset:5052
    s_sub_u32 s3, s3, 1
    s_cbranch_scc1 L_end
    s_waitcnt lgkmcnt(0)
    v_cmp_gt_u32 vcc, 1, v6
    s_cbranch_vccnz L_w23
    buffer_store_dwordx2 v[8:9], v4, s[40:43], s49 offen sc1
    buffer_store_dwordx2 v[10:11], v4, s[40:43], s49 offen offset:1024 sc1
    s_branch L_end
L_B_uv:
    s_mov_b32 s44, s12
    s_mov_b32 s45, s13
    s_mov_b32 s46, 4194304
    s_mov_b32 s47, 0x20000

    v_lshrrev_b32 v4, 4, v1
    v_and_b32 v5, 15, v1
    v_lshlrev_b32 v2, 14, v4
    v_lshl_add_u32 v2, v5, 3, v2
    s_lshl_b32 s48, s62, 18
    s_lshl1_add_u32 s38, s35, s33
    s_lshl_b32 s38, s38, 7
    s_add_u32 s48, s48, s38
    v_mul_u32_u24 v3, 528, v5
    v_lshl_add_u32 v3, v4, 5, v3
    v_add_u32 v3, 141312, v3
    v_lshlrev_b32 v4, 4, v1
    s_lshl2_add_u32 s49, s35, s62
    s_lshl1_add_u32 s49, s49, s33
    s_lshl_b32 s49, s49, 10
    s_add_u32 s49, s49, 1835008
L_w24:
    s_sleep 1
    ds_read_b32 v6, v0 offset:5048
    s_sub_u32 s3, s3, 1
    s_cbranch_scc1 L_end
    s_waitcnt lgkmcnt(0)
    v_cmp_gt_u32 vcc, 4, v6
    s_cbranch_vccnz L_w24
    s_add_u32 s39, s48, 0
    buffer_load_dwordx2 v[104:105], v2, s[44:47], s39 offen nt
    s_add_u32 s39, s48, 1048576
    buffer_load_dwordx2 v[108:109], v2, s[44:47], s39 offen nt
    s_add_u32 s39, s48, 131072
    buffer_load_dwordx2 v[106:107], v2, s[44:47], s39 offen nt
    s_add_u32 s39, s48, 1179648
    buffer_load_dwordx2 v[110:111], v2, s[44:47], s39 offen nt
    s_add_u32 s39, s48, 8192
    buffer_load_dwordx2 v[112:113], v2, s[44:47], s39 offen nt
    s_add_u32 s39, s48, 1056768
    buffer_load_dwordx2 v[116:117], v2, s[44:47], s39 offen nt
    s_add_u32 s39, s48, 139264
    buffer_load_dwordx2 v[114:115], v2, s[44:47], s39 offen nt
    s_add_u32 s39, s48, 1187840
    buffer_load_dwordx2 v[118:119], v2, s[44:47], s39 offen nt
    s_add_u32 s39, s48, 65536
    buffer_load_dwordx2 v[120:121], v2, s[44:47], s39 offen nt
    s_add_u32 s39, s48, 1114112
    buffer_load_dwordx2 v[124:125], v2, s[44:47], s39 offen nt
    s_add_u32 s39, s48, 196608
    buffer_load_dwordx2 v[122:123], v2, s[44:47], s39 offen nt
    s_add_u32 s39, s48, 1245184
    buffer_load_dwordx2 v[126:127], v2, s[44:47], s39 offen nt
    s_add_u32 s39, s48, 73728
    buffer_load_dwordx2 v[128:129], v2, s[44:47], s39 offen nt
    s_add_u32 s39, s48, 1122304
    buffer_load_dwordx2 v[132:133], v2, s[44:47], s39 offen nt
    s_add_u32 s39, s48, 204800
    buffer_load_dwordx2 v[130:131], v2, s[44:47], s39 offen nt
    s_add_u32 s39, s48, 1253376
    buffer_load_dwordx2 v[134:135], v2, s[44:47], s39 offen nt
    s_add_u32 s39, s48, 2097152
    buffer_load_dwordx2 v[136:137], v2, s[44:47], s39 offen nt
    s_add_u32 s39, s48, 3145728
    buffer_load_dwordx2 v[140:141], v2, s[44:47], s39 offen nt
    s_add_u32 s39, s48, 2228224
    buffer_load_dwordx2 v[138:139], v2, s[44:47], s39 offen nt
    s_add_u32 s39, s48, 3276800
    buffer_load_dwordx2 v[142:143], v2, s[44:47], s39 offen nt
    s_add_u32 s39, s48, 2105344
    buffer_load_dwordx2 v[144:145], v2, s[44:47], s39 offen nt
    s_add_u32 s39, s48, 3153920
    buffer_load_dwordx2 v[148:149], v2, s[44:47], s39 offen nt
    s_add_u32 s39, s48, 2236416
    buffer_load_dwordx2 v[146:147], v2, s[44:47], s39 offen nt
    s_add_u32 s39, s48, 3284992
    buffer_load_dwordx2 v[150:151], v2, s[44:47], s39 offen nt
    s_add_u32 s39, s48, 2162688
    buffer_load_dwordx2 v[152:153], v2, s[44:47], s39 offen nt
    s_add_u32 s39, s48, 3211264
    buffer_load_dwordx2 v[156:157], v2, s[44:47], s39 offen nt
    s_add_u32 s39, s48, 2293760
    buffer_load_dwordx2 v[154:155], v2, s[44:47], s39 offen nt
    s_add_u32 s39, s48, 3342336
    buffer_load_dwordx2 v[158:159], v2, s[44:47], s39 offen nt
    s_add_u32 s39, s48, 2170880
    buffer_load_dwordx2 v[160:161], v2, s[44:47], s39 offen nt
    s_add_u32 s39, s48, 3219456
    buffer_load_dwordx2 v[164:165], v2, s[44:47], s39 offen nt
    s_add_u32 s39, s48, 2301952
    buffer_load_dwordx2 v[162:163], v2, s[44:47], s39 offen nt
    s_add_u32 s39, s48, 3350528
    buffer_load_dwordx2 v[166:167], v2, s[44:47], s39 offen nt
    s_waitcnt vmcnt(31)
    s_waitcnt vmcnt(0)
    v_mov_b32 v6, 1
    s_mov_b64 exec, 1
    ds_add_u32 v0, v6 offset:6060
    s_mov_b64 exec, -1
    v_swap_b32 v105, v108
    v_swap_b32 v107, v110
    v_swap_b32 v113, v116
    v_swap_b32 v115, v118
    v_swap_b32 v121, v124
    v_swap_b32 v123, v126
    v_swap_b32 v129, v132
    v_swap_b32 v131, v134
    v_swap_b32 v137, v140
    v_swap_b32 v139, v142
    v_swap_b32 v145, v148
    v_swap_b32 v147, v150
    v_swap_b32 v153, v156
    v_swap_b32 v155, v158
    v_swap_b32 v161, v164
    v_swap_b32 v163, v166
L_w25:
    s_sleep 1
    ds_read_b32 v6, v0 offset:6048
    s_sub_u32 s3, s3, 1
    s_cbranch_scc1 L_end
    s_waitcnt lgkmcnt(0)
    v_cmp_gt_u32 vcc, 1, v6
    s_cbranch_vccnz L_w25
    s_setprio 2
L_w26:
    ds_read_b32 v6, v0 offset:6048
    s_sub_u32 s3, s3, 1
    s_cbranch_scc1 L_end
    s_waitcnt lgkmcnt(0)
    v_cmp_gt_u32 vcc, 4, v6
    s_cbranch_vccnz L_w26
    ds_read_b128 v[40:43], v3 offset:0
    ds_read_b128 v[44:47], v3 offset:16
    ds_read_b128 v[48:51], v3 offset:128
    ds_read_b128 v[52:55], v3 offset:144
    ds_read_b128 v[56:59], v3 offset:256
    ds_read_b128 v[60:63], v3 offset:272
    ds_read_b128 v[64:67], v3 offset:384
    ds_read_b128 v[68:71], v3 offset:400
    s_waitcnt lgkmcnt(7)
    v_mfma_f32_16x16x32_bf16 v[24:27], v[40:43], v[104:107], 0
    v_mfma_f32_16x16x32_bf16 v[28:31], v[40:43], v[108:111], 0
    s_waitcnt lgkmcnt(6)
    v_mfma_f32_16x16x32_bf16 v[24:27], v[44:47], v[112:115], v[24:27]
    v_mfma_f32_16x16x32_bf16 v[28:31], v[44:47], v[116:119], v[28:31]
    s_waitcnt lgkmcnt(5)
    v_mfma_f32_16x16x32_bf16 v[24:27], v[48:51], v[120:123], v[24:27]
    v_mfma_f32_16x16x32_bf16 v[28:31], v[48:51], v[124:127], v[28:31]
    s_waitcnt lgkmcnt(4)
    v_mfma_f32_16x16x32_bf16 v[24:27], v[52:55], v[128:131], v[24:27]
    v_mfma_f32_16x16x32_bf16 v[28:31], v[52:55], v[132:135], v[28:31]
    s_waitcnt lgkmcnt(3)
    v_mfma_f32_16x16x32_bf16 v[24:27], v[56:59], v[136:139], v[24:27]
    v_mfma_f32_16x16x32_bf16 v[28:31], v[56:59], v[140:143], v[28:31]
    s_waitcnt lgkmcnt(2)
    v_mfma_f32_16x16x32_bf16 v[24:27], v[60:63], v[144:147], v[24:27]
    v_mfma_f32_16x16x32_bf16 v[28:31], v[60:63], v[148:151], v[28:31]
    s_waitcnt lgkmcnt(1)
    v_mfma_f32_16x16x32_bf16 v[24:27], v[64:67], v[152:155], v[24:27]
    v_mfma_f32_16x16x32_bf16 v[28:31], v[64:67], v[156:159], v[28:31]
    s_waitcnt lgkmcnt(0)
    v_mfma_f32_16x16x32_bf16 v[24:27], v[68:71], v[160:163], v[24:27]
    v_mfma_f32_16x16x32_bf16 v[28:31], v[68:71], v[164:167], v[28:31]
    s_nop 6
    v_cvt_pk_bf16_f32 v8, v24, v25
    v_cvt_pk_bf16_f32 v10, v26, v27
    v_cvt_pk_bf16_f32 v9, v28, v29
    v_cvt_pk_bf16_f32 v11, v30, v31
    buffer_store_dwordx4 v[8:11], v4, s[40:43], s49 offen sc1
    s_waitcnt vmcnt(0)
    v_mov_b32 v6, 1
    s_mov_b64 exec, 1
    ds_add_u32 v0, v6 offset:6052
    s_mov_b64 exec, -1
    s_branch L_end
L_Be:
    s_waitcnt lgkmcnt(0)
    s_cmp_lg_u32 s33, 0
    s_cbranch_scc1 L_B_t1
    v_lshrrev_b32 v2, 1, v1
    v_and_b32 v3, 1, v1
    v_and_b32 v4, 24, v2
    v_and_b32 v2, 7, v2
    v_lshl_add_u32 v2, v4, 2, v2
    v_lshl_add_u32 v2, v2, 6, v3
    s_and_b32 s38, s34, 3
    s_lshl_b32 s38, s38, 12
    s_add_u32 s38, s38, s35
    s_lshl_b32 s38, s38, 8
    v_lshl_add_u32 v2, v2, 7, s38
    global_load_dword v166, v2, s[8:9]
L_B_t1:

    s_mov_b32 s3, 0x400000
    v_mov_b32 v0, 156256
    s_and_b32 s62, s34, 3
    s_lshl2_add_u32 s97, s62, s37
    s_lshl4_add_u32 s61, s36, s97
    s_waitcnt lgkmcnt(0)

    s_mov_b32 s40, s30
    s_mov_b32 s41, s31
    s_mov_b32 s42, 16777216
    s_mov_b32 s43, 0x20000
    s_barrier
    s_cmp_eq_u32 s33, 0
    s_cbranch_scc1 L_B_nt
    v_lshrrev_b32 v2, 1, v1
    v_and_b32 v3, 1, v1
    s_lshl2_add_u32 s38, s33, s34
    s_sub_u32 s38, s38, 4
    v_lshl_add_u32 v2, v2, 6, v3
    s_lshl_b32 s38, s38, 10
    s_add_u32 s38, s38, s35
    s_lshl_b32 s38, s38, 8
    v_lshl_add_u32 v2, v2, 7, s38
    s_mov_b32 exec_hi, 0
    global_load_dword v166, v2, s[10:11]
    s_not_b64 exec, exec
    s_waitcnt vmcnt(0)
    global_load_dword v166, v2, s[10:11]
    s_mov_b64 exec, -1
    v_mov_b32 v3, 1
    s_mov_b64 exec, 1
    ds_add_u32 v0, v3 offset:4
    s_mov_b64 exec, -1
L_B_nt:

    v_and_b32 v5, 31, v1
    v_lshrrev_b32 v7, 5, v1
    v_bfe_u32 v2, v5, 1, 1
    v_lshlrev_b32 v2, 2, v2
    v_bfe_u32 v3, v5, 2, 2
    v_or_b32 v2, v2, v3
    v_xor_b32 v2, v2, v7
    v_lshlrev_b32 v2, 4, v2
    v_lshl_add_u32 v2, v5, 7, v2
    s_lshl_b32 s38, s33, 12
    v_add_u32 v2, s38, v2
    v_mov_b32 v8, v2
    v_xor_b32 v9, 32, v2
    v_xor_b32 v10, 64, v2
    v_xor_b32 v11, 0x60, v2
    v_mul_u32_u24 v4, 1008, v5
    v_lshl_add_u32 v4, v7, 4, v4
    v_add_u32 v4, 131072, v4
    v_lshlrev_b32 v12, 10, v5
    v_lshl_add_u32 v7, v7, 4, v12
    v_lshl_add_u32 v5, v5, 4, v0
    s_lshl_b32 s53, s33, 2
    v_add_u32 v6, s53, v0
    s_lshl_b32 s50, s36, 15
    s_add_u32 s50, s50, 65536
    s_lshl_b32 s51, s33, 13
    s_add_u32 s51, s51, s50
    s_mul_i32 s49, s33, 8064
    s_add_u32 s49, s49, 131072
    s_mov_b32 s52, 0x3e0293ee
    s_mov_b32 s56, -1
    s_mov_b32 s57, 0x3fffffff
L_w27:
    s_sleep 1
    ds_read_b32 v3, v6 offset:4032
    s_sub_u32 s3, s3, 1
    s_cbranch_scc1 L_end
    s_waitcnt lgkmcnt(0)
    v_cmp_gt_u32 vcc, 2, v3
    s_cbranch_vccnz L_w27
    ds_read_b128 v[40:43], v8 offset:0
    ds_read_b128 v[44:47], v9 offset:0
    ds_read_b128 v[48:51], v10 offset:0
    ds_read_b128 v[52:55], v11 offset:0
    ds_read_b128 v[56:59], v8 offset:16384
    ds_read_b128 v[60:63], v9 offset:16384
    ds_read_b128 v[64:67], v10 offset:16384
    ds_read_b128 v[68:71], v11 offset:16384
    v_mov_b32 v3, 1
    s_mov_b64 exec, 1
    ds_add_u32 v0, v3 offset:3024
    s_mov_b64 exec, -1
L_w28:
    s_sleep 1
    ds_read_b32 v3, v6 offset:4032
    s_sub_u32 s3, s3, 1
    s_cbranch_scc1 L_end
    s_waitcnt lgkmcnt(0)
    v_cmp_gt_u32 vcc, 4, v3
    s_cbranch_vccnz L_w28
    ds_read_b128 v[72:75], v8 offset:32768
    ds_read_b128 v[76:79], v9 offset:32768
    ds_read_b128 v[80:83], v10 offset:32768
    ds_read_b128 v[84:87], v11 offset:32768
    ds_read_b128 v[88:91], v8 offset:49152
    ds_read_b128 v[92:95], v9 offset:49152
    ds_read_b128 v[96:99], v10 offset:49152
    ds_read_b128 v[100:103], v11 offset:49152
    v_mov_b32 v3, 1
    s_mov_b64 exec, 1
    ds_add_u32 v0, v3 offset:3028
    s_mov_b64 exec, -1
    v_mov_b32 v3, 0
    v_mov_b32 v13, 0
    v_mov_b32 v14, 0
    s_waitcnt vmcnt(0)
L_B_f2:
    global_load_dword v12, v3, s[28:29] offset:128 sc1
    s_sub_u32 s3, s3, 1
    s_cbranch_scc1 L_end
    s_sleep 4
    s_waitcnt vmcnt(2)
    v_cmp_eq_u32 vcc, 0, v13
    s_cbranch_vccz L_B_f2d
    global_load_dword v13, v3, s[28:29] offset:128 sc1
    s_sub_u32 s3, s3, 1
    s_cbranch_scc1 L_end
    s_sleep 4
    s_waitcnt vmcnt(2)
    v_cmp_eq_u32 vcc, 0, v14
    s_cbranch_vccz L_B_f2d
    global_load_dword v14, v3, s[28:29] offset:128 sc1
    s_sub_u32 s3, s3, 1
    s_cbranch_scc1 L_end
    s_sleep 4
    s_waitcnt vmcnt(2)
    v_cmp_eq_u32 vcc, 0, v12
    s_cbranch_vccz L_B_f2d
    s_branch L_B_f2
L_B_f2d:
    s_setprio 3
    v_lshlrev_b32 v3, 4, v1
    s_mov_b32 m0, s49
    s_mov_b32 s38, s51
    s_mov_b64 exec, s[56:57]
    buffer_load_dwordx4 v3, s[40:43], s38 offen sc1 lds
    s_add_u32 m0, m0, 1008
    s_add_u32 s38, s38, 1024
    buffer_load_dwordx4 v3, s[40:43], s38 offen sc1 lds
    s_add_u32 m0, m0, 1008
    s_add_u32 s38, s38, 1024
    buffer_load_dwordx4 v3, s[40:43], s38 offen sc1 lds
    s_add_u32 m0, m0, 1008
    s_add_u32 s38, s38, 1024
    buffer_load_dwordx4 v3, s[40:43], s38 offen sc1 lds
    s_add_u32 m0, m0, 1008
    s_add_u32 s38, s38, 1024
    buffer_load_dwordx4 v3, s[40:43], s38 offen sc1 lds
    s_add_u32 m0, m0, 1008
    s_add_u32 s38, s38, 1024
    buffer_load_dwordx4 v3, s[40:43], s38 offen sc1 lds
    s_add_u32 m0, m0, 1008
    s_add_u32 s38, s38, 1024
    buffer_load_dwordx4 v3, s[40:43], s38 offen sc1 lds
    s_add_u32 m0, m0, 1008
    s_add_u32 s38, s38, 1024
    buffer_load_dwordx4 v3, s[40:43], s38 offen sc1 lds
    s_mov_b64 exec, -1
    buffer_load_dwordx4 v[24:27], v7, s[40:43], s50 offen offset:992 sc1
    v_mov_b32 v3, 1
    s_mov_b64 exec, 1
    ds_add_u32 v0, v3 offset:2028
    s_mov_b64 exec, -1
L_w29:
    s_sleep 1
    ds_read_b32 v3, v6 offset:4032
    s_sub_u32 s3, s3, 1
    s_cbranch_scc1 L_end
    s_waitcnt lgkmcnt(0)
    v_cmp_gt_u32 vcc, 6, v3
    s_cbranch_vccnz L_w29
    v_add_u32 v8, 0x10000, v8
    v_add_u32 v9, 0x10000, v9
    v_add_u32 v10, 0x10000, v10
    v_add_u32 v11, 0x10000, v11
    ds_read_b128 v[104:107], v8 offset:0
    ds_read_b128 v[108:111], v9 offset:0
    ds_read_b128 v[112:115], v10 offset:0
    ds_read_b128 v[116:119], v11 offset:0
    ds_read_b128 v[120:123], v8 offset:16384
    ds_read_b128 v[124:127], v9 offset:16384
    ds_read_b128 v[128:131], v10 offset:16384
    ds_read_b128 v[132:135], v11 offset:16384
    v_mov_b32 v3, 1
    s_mov_b64 exec, 1
    ds_add_u32 v0, v3 offset:3032
    s_mov_b64 exec, -1
L_w30:
    s_sleep 1
    ds_read_b32 v3, v6 offset:4032
    s_sub_u32 s3, s3, 1
    s_cbranch_scc1 L_end
    s_waitcnt lgkmcnt(0)
    v_cmp_gt_u32 vcc, 8, v3
    s_cbranch_vccnz L_w30
    ds_read_b128 v[136:139], v8 offset:32768
    ds_read_b128 v[140:143], v9 offset:32768
    ds_read_b128 v[144:147], v10 offset:32768
    ds_read_b128 v[148:151], v11 offset:32768
    ds_read_b128 v[152:155], v8 offset:49152
    ds_read_b128 v[156:159], v9 offset:49152
    ds_read_b128 v[160:163], v10 offset:49152
    ds_read_b128 v[164:167], v11 offset:49152
    v_mov_b32 v3, 1
    s_mov_b64 exec, 1
    ds_add_u32 v0, v3 offset:3036
    s_mov_b64 exec, -1
L_B_qv:
    v_lshl_add_u32 v3, v1, 4, s49
    s_mov_b32 s63, 0
    s_waitcnt vmcnt(0) lgkmcnt(0)
    s_mov_b64 exec, s[56:57]
    ds_read_b128 v[8:11], v3 offset:0
    ds_read_b128 v[12:15], v3 offset:1008
    ds_read_b128 v[16:19], v3 offset:2016
    ds_read_b128 v[20:23], v3 offset:3024
    ds_read_b128 v[28:31], v3 offset:4032
    ds_read_b128 v[32:35], v3 offset:5040
    ds_read_b128 v[36:39], v3 offset:6048
    s_mov_b64 exec, -1
    v_max3_u32 v6, v24, v25, v26
    v_max_u32 v6, v6, v27
    v_cmp_eq_u32 vcc, -1, v6
    s_cbranch_vccnz L_B_qf8
L_B_qn8:
    s_mov_b64 exec, s[56:57]
    s_waitcnt lgkmcnt(6)
    v_max3_u32 v6, v8, v9, v10
    v_max_u32 v6, v6, v11
    v_cmp_eq_u32 vcc, -1, v6
    ds_read_b128 v[8:11], v3 offset:7056
    s_cbranch_vccnz L_B_qf0
L_B_qn0:
    s_waitcnt lgkmcnt(6)
    v_max3_u32 v6, v12, v13, v14
    v_max_u32 v6, v6, v15
    v_cmp_eq_u32 vcc, -1, v6
    s_cbranch_vccnz L_B_qf1
L_B_qn1:
    s_waitcnt lgkmcnt(5)
    v_max3_u32 v6, v16, v17, v18
    v_max_u32 v6, v6, v19
    v_cmp_eq_u32 vcc, -1, v6
    s_cbranch_vccnz L_B_qf2
L_B_qn2:
    s_waitcnt lgkmcnt(4)
    v_max3_u32 v6, v20, v21, v22
    v_max_u32 v6, v6, v23
    v_cmp_eq_u32 vcc, -1, v6
    s_cbranch_vccnz L_B_qf3
L_B_qn3:
    s_waitcnt lgkmcnt(3)
    v_max3_u32 v6, v28, v29, v30
    v_max_u32 v6, v6, v31
    v_cmp_eq_u32 vcc, -1, v6
    s_cbranch_vccnz L_B_qf4
L_B_qn4:
    s_waitcnt lgkmcnt(2)
    v_max3_u32 v6, v32, v33, v34
    v_max_u32 v6, v6, v35
    v_cmp_eq_u32 vcc, -1, v6
    s_cbranch_vccnz L_B_qf5
L_B_qn5:
    s_waitcnt lgkmcnt(1)
    v_max3_u32 v6, v36, v37, v38
    v_max_u32 v6, v6, v39
    v_cmp_eq_u32 vcc, -1, v6
    s_cbranch_vccnz L_B_qf6
L_B_qn6:
    s_waitcnt lgkmcnt(0)
    v_max3_u32 v6, v8, v9, v10
    v_max_u32 v6, v6, v11
    v_cmp_eq_u32 vcc, -1, v6
    s_cbranch_vccnz L_B_qf7
L_B_qn7:
    s_mov_b64 exec, -1
    s_cmp_lg_u32 s63, 0
    s_cbranch_scc1 L_B_qv
    v_mov_b32 v3, 1
    s_mov_b64 exec, 1
    ds_add_u32 v0, v3 offset:1008
    s_mov_b64 exec, -1
    s_setprio 2
L_w31:
    ds_read_b32 v3, v0 offset:1008
    s_sub_u32 s3, s3, 1
    s_cbranch_scc1 L_end
    s_waitcnt lgkmcnt(0)
    v_cmp_gt_u32 vcc, 4, v3
    s_cbranch_vccnz L_w31
    s_xor_b32 s38, s2, 40
    s_or_b32 s38, s38, s33
    s_cbranch_scc1 L_B_n3
    v_mov_b32 v3, 4
    s_mov_b64 exec, 1
    global_store_dword v3, v3, s[28:29] sc1
    s_mov_b64 exec, -1
L_B_n3:
    ds_read_b128 v[28:31], v4 offset:0
    ds_read_b128 v[32:35], v4 offset:32
    ds_read_b128 v[36:39], v4 offset:64
    s_waitcnt lgkmcnt(2)
    v_mfma_f32_32x32x16_bf16 v[8:23], v[40:43], v[28:31], 0
    ds_read_b128 v[40:43], v4 offset:96
    s_waitcnt lgkmcnt(2)
    v_mfma_f32_32x32x16_bf16 v[8:23], v[44:47], v[32:35], v[8:23]
    ds_read_b128 v[44:47], v4 offset:128
    s_waitcnt lgkmcnt(2)
    v_mfma_f32_32x32x16_bf16 v[8:23], v[48:51], v[36:39], v[8:23]
    ds_read_b128 v[48:51], v4 offset:160
    s_waitcnt lgkmcnt(2)
    v_mfma_f32_32x32x16_bf16 v[8:23], v[52:55], v[40:43], v[8:23]
    ds_read_b128 v[52:55], v4 offset:192
    s_waitcnt lgkmcnt(2)
    v_mfma_f32_32x32x16_bf16 v[8:23], v[56:59], v[44:47], v[8:23]
    ds_read_b128 v[56:59], v4 offset:224
    s_waitcnt lgkmcnt(2)
    v_mfma_f32_32x32x16_bf16 v[8:23], v[60:63], v[48:51], v[8:23]
    ds_read_b128 v[60:63], v4 offset:256
    s_waitcnt lgkmcnt(2)
    v_mfma_f32_32x32x16_bf16 v[8:23], v[64:67], v[52:55], v[8:23]
    ds_read_b128 v[64:67], v4 offset:288
    s_waitcnt lgkmcnt(2)
    v_mfma_f32_32x32x16_bf16 v[8:23], v[68:71], v[56:59], v[8:23]
    ds_read_b128 v[68:71], v4 offset:320
    s_waitcnt lgkmcnt(2)
    v_mfma_f32_32x32x16_bf16 v[8:23], v[72:75], v[60:63], v[8:23]
    ds_read_b128 v[72:75], v4 offset:352
    s_waitcnt lgkmcnt(2)
    v_mfma_f32_32x32x16_bf16 v[8:23], v[76:79], v[64:67], v[8:23]
    ds_read_b128 v[76:79], v4 offset:384
    s_waitcnt lgkmcnt(2)
    v_mfma_f32_32x32x16_bf16 v[8:23], v[80:83], v[68:71], v[8:23]
    ds_read_b128 v[80:83], v4 offset:416
    s_waitcnt lgkmcnt(2)
    v_mfma_f32_32x32x16_bf16 v[8:23], v[84:87], v[72:75], v[8:23]
    ds_read_b128 v[84:87], v4 offset:448
    s_waitcnt lgkmcnt(2)
    v_mfma_f32_32x32x16_bf16 v[8:23], v[88:91], v[76:79], v[8:23]
    ds_read_b128 v[88:91], v4 offset:480
    s_waitcnt lgkmcnt(2)
    v_mfma_f32_32x32x16_bf16 v[8:23], v[92:95], v[80:83], v[8:23]
    ds_read_b128 v[92:95], v4 offset:512
    s_waitcnt lgkmcnt(2)
    v_mfma_f32_32x32x16_bf16 v[8:23], v[96:99], v[84:87], v[8:23]
    ds_read_b128 v[96:99], v4 offset:544
    s_waitcnt lgkmcnt(2)
    v_mfma_f32_32x32x16_bf16 v[8:23], v[100:103], v[88:91], v[8:23]
    ds_read_b128 v[100:103], v4 offset:576
    s_waitcnt lgkmcnt(2)
    v_mfma_f32_32x32x16_bf16 v[8:23], v[104:107], v[92:95], v[8:23]
    ds_read_b128 v[104:107], v4 offset:608
    s_waitcnt lgkmcnt(2)
    v_mfma_f32_32x32x16_bf16 v[8:23], v[108:111], v[96:99], v[8:23]
    ds_read_b128 v[108:111], v4 offset:640
    s_waitcnt lgkmcnt(2)
    v_mfma_f32_32x32x16_bf16 v[8:23], v[112:115], v[100:103], v[8:23]
    ds_read_b128 v[112:115], v4 offset:672
    s_waitcnt lgkmcnt(2)
    v_mfma_f32_32x32x16_bf16 v[8:23], v[116:119], v[104:107], v[8:23]
    ds_read_b128 v[116:119], v4 offset:704
    s_waitcnt lgkmcnt(2)
    v_mfma_f32_32x32x16_bf16 v[8:23], v[120:123], v[108:111], v[8:23]
    ds_read_b128 v[120:123], v4 offset:736
    s_waitcnt lgkmcnt(2)
    v_mfma_f32_32x32x16_bf16 v[8:23], v[124:127], v[112:115], v[8:23]
    ds_read_b128 v[124:127], v4 offset:768
    s_waitcnt lgkmcnt(2)
    v_mfma_f32_32x32x16_bf16 v[8:23], v[128:131], v[116:119], v[8:23]
    ds_read_b128 v[128:131], v4 offset:800
    s_waitcnt lgkmcnt(2)
    v_mfma_f32_32x32x16_bf16 v[8:23], v[132:135], v[120:123], v[8:23]
    ds_read_b128 v[132:135], v4 offset:832
    s_waitcnt lgkmcnt(2)
    v_mfma_f32_32x32x16_bf16 v[8:23], v[136:139], v[124:127], v[8:23]
    ds_read_b128 v[136:139], v4 offset:864
    s_waitcnt lgkmcnt(2)
    v_mfma_f32_32x32x16_bf16 v[8:23], v[140:143], v[128:131], v[8:23]
    ds_read_b128 v[140:143], v4 offset:896
    s_waitcnt lgkmcnt(2)
    v_mfma_f32_32x32x16_bf16 v[8:23], v[144:147], v[132:135], v[8:23]
    ds_read_b128 v[144:147], v4 offset:928
    s_waitcnt lgkmcnt(2)
    v_mfma_f32_32x32x16_bf16 v[8:23], v[148:151], v[136:139], v[8:23]
    ds_read_b128 v[148:151], v4 offset:960
    s_waitcnt lgkmcnt(2)
    v_mfma_f32_32x32x16_bf16 v[8:23], v[152:155], v[140:143], v[8:23]
    s_waitcnt lgkmcnt(1)
    v_mfma_f32_32x32x16_bf16 v[8:23], v[156:159], v[144:147], v[8:23]
    s_waitcnt lgkmcnt(0)
    v_mfma_f32_32x32x16_bf16 v[8:23], v[160:163], v[148:151], v[8:23]
    v_mfma_f32_32x32x16_bf16 v[8:23], v[164:167], v[24:27], v[8:23]
    v_add_u32 v4, s53, v0
    v_add_u32 v166, s53, v5
    s_lshl_b32 s38, s33, 11
    s_add_u32 s38, s38, 131072
    v_lshl_add_u32 v167, v1, 4, s38
    s_nop 6
    v_max3_f32 v164, v8, v9, v10
    v_max3_f32 v165, v11, v12, v13
    v_max3_f32 v164, v164, v14, v15
    v_max3_f32 v165, v165, v16, v17
    v_max3_f32 v164, v164, v18, v19
    v_max3_f32 v165, v165, v20, v21
    v_max3_f32 v164, v164, v22, v23
    v_max_f32 v164, v164, v165
    v_mov_b32 v165, v164
    s_nop 1
    v_permlane32_swap_b32 v164, v165
    v_max_f32 v164, v164, v165
    ds_write_b32 v166, v164 offset:7072
L_B_mx0:
    ds_read_b128 v[160:163], v5 offset:7072
    s_sub_u32 s3, s3, 1
    s_cbranch_scc1 L_end
    s_waitcnt lgkmcnt(0)
    v_max3_u32 v164, v160, v161, v162
    v_max_u32 v164, v164, v163
    v_cmp_eq_u32 vcc, -1, v164
    s_cbranch_vccnz L_B_mx0
    v_max3_f32 v164, v160, v161, v162
    v_max_f32 v164, v164, v163
    v_mul_f32 v6, s52, v164
    v_add_u32 v5, -8800, v5
    v_add_u32 v166, s53, v5
    v_mov_b32 v165, -1
    ds_write_b32 v166, v165
    v_fma_f32 v8, v8, s52, -v6
    v_fma_f32 v9, v9, s52, -v6
    v_fma_f32 v10, v10, s52, -v6
    v_fma_f32 v11, v11, s52, -v6
    v_fma_f32 v12, v12, s52, -v6
    v_fma_f32 v13, v13, s52, -v6
    v_fma_f32 v14, v14, s52, -v6
    v_fma_f32 v15, v15, s52, -v6
    v_exp_f32 v8, v8
    v_exp_f32 v9, v9
    v_exp_f32 v10, v10
    v_exp_f32 v11, v11
    v_exp_f32 v12, v12
    v_exp_f32 v13, v13
    v_exp_f32 v14, v14
    v_exp_f32 v15, v15
    v_cvt_pk_bf16_f32 v152, v8, v9
    v_cvt_pk_bf16_f32 v153, v10, v11
    v_cvt_pk_bf16_f32 v154, v12, v13
    v_cvt_pk_bf16_f32 v155, v14, v15
    ds_write_b128 v167, v[152:155] offset:0
    v_fma_f32 v16, v16, s52, -v6
    v_fma_f32 v17, v17, s52, -v6
    v_fma_f32 v18, v18, s52, -v6
    v_fma_f32 v19, v19, s52, -v6
    v_fma_f32 v20, v20, s52, -v6
    v_fma_f32 v21, v21, s52, -v6
    v_fma_f32 v22, v22, s52, -v6
    v_fma_f32 v23, v23, s52, -v6
    v_exp_f32 v16, v16
    v_exp_f32 v17, v17
    v_exp_f32 v18, v18
    v_exp_f32 v19, v19
    v_exp_f32 v20, v20
    v_exp_f32 v21, v21
    v_exp_f32 v22, v22
    v_exp_f32 v23, v23
    v_cvt_pk_bf16_f32 v156, v16, v17
    v_cvt_pk_bf16_f32 v157, v18, v19
    v_cvt_pk_bf16_f32 v158, v20, v21
    v_cvt_pk_bf16_f32 v159, v22, v23
    ds_write_b128 v167, v[156:159] offset:1024
    v_mov_b32 v164, 1
    s_mov_b64 exec, 1
    ds_add_u32 v0, v164 offset:1016
    s_mov_b64 exec, -1
    v_pk_add_f32 v[8:9], v[8:9], v[16:17]
    v_pk_add_f32 v[10:11], v[10:11], v[18:19]
    v_pk_add_f32 v[12:13], v[12:13], v[20:21]
    v_pk_add_f32 v[14:15], v[14:15], v[22:23]
    v_pk_add_f32 v[8:9], v[8:9], v[12:13]
    v_pk_add_f32 v[10:11], v[10:11], v[14:15]
    v_pk_add_f32 v[8:9], v[8:9], v[10:11]
    v_add_f32 v7, v8, v9
L_w32:
    ds_read_b32 v3, v0 offset:1016
    s_sub_u32 s3, s3, 1
    s_cbranch_scc1 L_end
    s_waitcnt lgkmcnt(0)
    v_cmp_gt_u32 vcc, 4, v3
    s_cbranch_vccnz L_w32
L_w33:
    ds_read_b32 v3, v4 offset:4032
    s_sub_u32 s3, s3, 1
    s_cbranch_scc1 L_end
    s_waitcnt lgkmcnt(0)
    v_cmp_gt_u32 vcc, 10, v3
    s_cbranch_vccnz L_w33
    ds_read_b128 v[152:155], v2 offset:0
    v_xor_b32 v3, 32, v2
    ds_read_b128 v[156:159], v3 offset:0
    v_xor_b32 v3, 64, v2
    ds_read_b128 v[160:163], v3 offset:0
    v_xor_b32 v3, 96, v2
    ds_read_b128 v[164:167], v3 offset:0
    s_waitcnt lgkmcnt(3)
    v_mfma_f32_32x32x16_bf16 v[8:23], v[152:155], v[28:31], 0
    ds_read_b128 v[152:155], v2 offset:16384
    s_waitcnt lgkmcnt(3)
    v_mfma_f32_32x32x16_bf16 v[8:23], v[156:159], v[32:35], v[8:23]
    v_xor_b32 v3, 32, v2
    ds_read_b128 v[156:159], v3 offset:16384
    s_waitcnt lgkmcnt(3)
    v_mfma_f32_32x32x16_bf16 v[8:23], v[160:163], v[36:39], v[8:23]
    v_xor_b32 v3, 64, v2
    ds_read_b128 v[160:163], v3 offset:16384
    s_waitcnt lgkmcnt(3)
    v_mfma_f32_32x32x16_bf16 v[8:23], v[164:167], v[40:43], v[8:23]
    v_xor_b32 v3, 96, v2
    ds_read_b128 v[164:167], v3 offset:16384
    s_waitcnt lgkmcnt(3)
    v_mfma_f32_32x32x16_bf16 v[8:23], v[152:155], v[44:47], v[8:23]
L_w34:
    ds_read_b32 v3, v4 offset:4032
    s_sub_u32 s3, s3, 1
    s_cbranch_scc1 L_end
    s_waitcnt lgkmcnt(0)
    v_cmp_gt_u32 vcc, 12, v3
    s_cbranch_vccnz L_w34
    ds_read_b128 v[152:155], v2 offset:32768
    s_waitcnt lgkmcnt(3)
    v_mfma_f32_32x32x16_bf16 v[8:23], v[156:159], v[48:51], v[8:23]
    v_xor_b32 v3, 32, v2
    ds_read_b128 v[156:159], v3 offset:32768
    s_waitcnt lgkmcnt(3)
    v_mfma_f32_32x32x16_bf16 v[8:23], v[160:163], v[52:55], v[8:23]
    v_xor_b32 v3, 64, v2
    ds_read_b128 v[160:163], v3 offset:32768
    s_waitcnt lgkmcnt(3)
    v_mfma_f32_32x32x16_bf16 v[8:23], v[164:167], v[56:59], v[8:23]
    v_xor_b32 v3, 96, v2
    ds_read_b128 v[164:167], v3 offset:32768
    s_waitcnt lgkmcnt(3)
    v_mfma_f32_32x32x16_bf16 v[8:23], v[152:155], v[60:63], v[8:23]
    ds_read_b128 v[152:155], v2 offset:49152
    s_waitcnt lgkmcnt(3)
    v_mfma_f32_32x32x16_bf16 v[8:23], v[156:159], v[64:67], v[8:23]
    v_xor_b32 v3, 32, v2
    ds_read_b128 v[156:159], v3 offset:49152
    s_waitcnt lgkmcnt(3)
    v_mfma_f32_32x32x16_bf16 v[8:23], v[160:163], v[68:71], v[8:23]
    v_xor_b32 v3, 64, v2
    ds_read_b128 v[160:163], v3 offset:49152
    s_waitcnt lgkmcnt(3)
    v_mfma_f32_32x32x16_bf16 v[8:23], v[164:167], v[72:75], v[8:23]
    v_xor_b32 v3, 96, v2
    ds_read_b128 v[164:167], v3 offset:49152
    s_waitcnt lgkmcnt(3)
    v_mfma_f32_32x32x16_bf16 v[8:23], v[152:155], v[76:79], v[8:23]
    v_add_u32 v2, 0x10000, v2
L_w35:
    ds_read_b32 v3, v4 offset:4032
    s_sub_u32 s3, s3, 1
    s_cbranch_scc1 L_end
    s_waitcnt lgkmcnt(0)
    v_cmp_gt_u32 vcc, 13, v3
    s_cbranch_vccnz L_w35
    ds_read_b128 v[152:155], v2 offset:0
    s_waitcnt lgkmcnt(3)
    v_mfma_f32_32x32x16_bf16 v[8:23], v[156:159], v[80:83], v[8:23]
    v_xor_b32 v3, 32, v2
    ds_read_b128 v[156:159], v3 offset:0
    s_waitcnt lgkmcnt(3)
    v_mfma_f32_32x32x16_bf16 v[8:23], v[160:163], v[84:87], v[8:23]
    v_xor_b32 v3, 64, v2
    ds_read_b128 v[160:163], v3 offset:0
    s_waitcnt lgkmcnt(3)
    v_mfma_f32_32x32x16_bf16 v[8:23], v[164:167], v[88:91], v[8:23]
    v_xor_b32 v3, 96, v2
    ds_read_b128 v[164:167], v3 offset:0
    s_waitcnt lgkmcnt(3)
    v_mfma_f32_32x32x16_bf16 v[8:23], v[152:155], v[92:95], v[8:23]
L_w36:
    ds_read_b32 v3, v4 offset:4032
    s_sub_u32 s3, s3, 1
    s_cbranch_scc1 L_end
    s_waitcnt lgkmcnt(0)
    v_cmp_gt_u32 vcc, 14, v3
    s_cbranch_vccnz L_w36
    ds_read_b128 v[152:155], v2 offset:16384
    s_waitcnt lgkmcnt(3)
    v_mfma_f32_32x32x16_bf16 v[8:23], v[156:159], v[96:99], v[8:23]
    v_xor_b32 v3, 32, v2
    ds_read_b128 v[156:159], v3 offset:16384
    s_waitcnt lgkmcnt(3)
    v_mfma_f32_32x32x16_bf16 v[8:23], v[160:163], v[100:103], v[8:23]
    v_xor_b32 v3, 64, v2
    ds_read_b128 v[160:163], v3 offset:16384
    s_waitcnt lgkmcnt(3)
    v_mfma_f32_32x32x16_bf16 v[8:23], v[164:167], v[104:107], v[8:23]
    v_xor_b32 v3, 96, v2
    ds_read_b128 v[164:167], v3 offset:16384
    s_waitcnt lgkmcnt(3)
    v_mfma_f32_32x32x16_bf16 v[8:23], v[152:155], v[108:111], v[8:23]
L_w37:
    ds_read_b32 v3, v4 offset:4032
    s_sub_u32 s3, s3, 1
    s_cbranch_scc1 L_end
    s_waitcnt lgkmcnt(0)
    v_cmp_gt_u32 vcc, 15, v3
    s_cbranch_vccnz L_w37
    ds_read_b128 v[152:155], v2 offset:32768
    s_waitcnt lgkmcnt(3)
    v_mfma_f32_32x32x16_bf16 v[8:23], v[156:159], v[112:115], v[8:23]
    v_xor_b32 v3, 32, v2
    ds_read_b128 v[156:159], v3 offset:32768
    s_waitcnt lgkmcnt(3)
    v_mfma_f32_32x32x16_bf16 v[8:23], v[160:163], v[116:119], v[8:23]
    v_xor_b32 v3, 64, v2
    ds_read_b128 v[160:163], v3 offset:32768
    s_waitcnt lgkmcnt(3)
    v_mfma_f32_32x32x16_bf16 v[8:23], v[164:167], v[120:123], v[8:23]
    v_xor_b32 v3, 96, v2
    ds_read_b128 v[164:167], v3 offset:32768
    s_waitcnt lgkmcnt(3)
    v_mfma_f32_32x32x16_bf16 v[8:23], v[152:155], v[124:127], v[8:23]
L_w38:
    ds_read_b32 v3, v4 offset:4032
    s_sub_u32 s3, s3, 1
    s_cbranch_scc1 L_end
    s_waitcnt lgkmcnt(0)
    v_cmp_gt_u32 vcc, 16, v3
    s_cbranch_vccnz L_w38
    ds_read_b128 v[152:155], v2 offset:49152
    s_waitcnt lgkmcnt(3)
    v_mfma_f32_32x32x16_bf16 v[8:23], v[156:159], v[128:131], v[8:23]
    v_xor_b32 v3, 32, v2
    ds_read_b128 v[156:159], v3 offset:49152
    s_waitcnt lgkmcnt(3)
    v_mfma_f32_32x32x16_bf16 v[8:23], v[160:163], v[132:135], v[8:23]
    v_xor_b32 v3, 64, v2
    ds_read_b128 v[160:163], v3 offset:49152
    s_waitcnt lgkmcnt(3)
    v_mfma_f32_32x32x16_bf16 v[8:23], v[164:167], v[136:139], v[8:23]
    v_xor_b32 v3, 96, v2
    ds_read_b128 v[164:167], v3 offset:49152
    s_waitcnt lgkmcnt(3)
    v_mfma_f32_32x32x16_bf16 v[8:23], v[152:155], v[140:143], v[8:23]
    s_waitcnt lgkmcnt(2)
    v_mfma_f32_32x32x16_bf16 v[8:23], v[156:159], v[144:147], v[8:23]
    s_waitcnt lgkmcnt(1)
    v_mfma_f32_32x32x16_bf16 v[8:23], v[160:163], v[148:151], v[8:23]
    s_waitcnt lgkmcnt(0)
    v_mfma_f32_32x32x16_bf16 v[8:23], v[164:167], v[24:27], v[8:23]
    v_add_u32 v166, s53, v5
    s_lshl_b32 s38, s33, 11
    s_add_u32 s38, s38, 139264
    v_lshl_add_u32 v167, v1, 4, s38
    s_nop 7
    v_max3_f32 v164, v8, v9, v10
    v_max3_f32 v165, v11, v12, v13
    v_max3_f32 v164, v164, v14, v15
    v_max3_f32 v165, v165, v16, v17
    v_max3_f32 v164, v164, v18, v19
    v_max3_f32 v165, v165, v20, v21
    v_max3_f32 v164, v164, v22, v23
    v_max_f32 v164, v164, v165
    v_mov_b32 v165, v164
    s_nop 1
    v_permlane32_swap_b32 v164, v165
    v_max_f32 v164, v164, v165
    ds_write_b32 v166, v164 offset:0
L_B_mx1:
    ds_read_b128 v[160:163], v5 offset:0
    s_sub_u32 s3, s3, 1
    s_cbranch_scc1 L_end
    s_waitcnt lgkmcnt(0)
    v_max3_u32 v164, v160, v161, v162
    v_max_u32 v164, v164, v163
    v_cmp_eq_u32 vcc, -1, v164
    s_cbranch_vccnz L_B_mx1
    v_max3_f32 v164, v160, v161, v162
    v_max_f32 v164, v164, v163
    v_mul_f32 v164, s52, v164
    v_max_f32 v164, v164, v6
    v_sub_f32 v165, v6, v164
    v_exp_f32 v165, v165
    v_mov_b32 v6, v164
    v_and_b32 v3, 31, v1
    v_lshlrev_b32 v3, 2, v3
    v_add_u32 v3, 147968, v3
    ds_write_b32 v3, v165
    v_mov_b32 v164, 1
    s_mov_b64 exec, 1
    ds_add_u32 v0, v164 offset:1020
    s_mov_b64 exec, -1
    v_fma_f32 v8, v8, s52, -v6
    v_fma_f32 v9, v9, s52, -v6
    v_fma_f32 v10, v10, s52, -v6
    v_fma_f32 v11, v11, s52, -v6
    v_fma_f32 v12, v12, s52, -v6
    v_fma_f32 v13, v13, s52, -v6
    v_fma_f32 v14, v14, s52, -v6
    v_fma_f32 v15, v15, s52, -v6
    v_exp_f32 v8, v8
    v_exp_f32 v9, v9
    v_exp_f32 v10, v10
    v_exp_f32 v11, v11
    v_exp_f32 v12, v12
    v_exp_f32 v13, v13
    v_exp_f32 v14, v14
    v_exp_f32 v15, v15
    v_cvt_pk_bf16_f32 v152, v8, v9
    v_cvt_pk_bf16_f32 v153, v10, v11
    v_cvt_pk_bf16_f32 v154, v12, v13
    v_cvt_pk_bf16_f32 v155, v14, v15
    ds_write_b128 v167, v[152:155] offset:0
    v_fma_f32 v16, v16, s52, -v6
    v_fma_f32 v17, v17, s52, -v6
    v_fma_f32 v18, v18, s52, -v6
    v_fma_f32 v19, v19, s52, -v6
    v_fma_f32 v20, v20, s52, -v6
    v_fma_f32 v21, v21, s52, -v6
    v_fma_f32 v22, v22, s52, -v6
    v_fma_f32 v23, v23, s52, -v6
    v_exp_f32 v16, v16
    v_exp_f32 v17, v17
    v_exp_f32 v18, v18
    v_exp_f32 v19, v19
    v_exp_f32 v20, v20
    v_exp_f32 v21, v21
    v_exp_f32 v22, v22
    v_exp_f32 v23, v23
    v_cvt_pk_bf16_f32 v156, v16, v17
    v_cvt_pk_bf16_f32 v157, v18, v19
    v_cvt_pk_bf16_f32 v158, v20, v21
    v_cvt_pk_bf16_f32 v159, v22, v23
    ds_write_b128 v167, v[156:159] offset:1024
    v_mov_b32 v164, 1
    s_mov_b64 exec, 1
    ds_add_u32 v0, v164 offset:1016
    s_mov_b64 exec, -1
    v_pk_add_f32 v[8:9], v[8:9], v[16:17]
    v_pk_add_f32 v[10:11], v[10:11], v[18:19]
    v_pk_add_f32 v[12:13], v[12:13], v[20:21]
    v_pk_add_f32 v[14:15], v[14:15], v[22:23]
    v_pk_add_f32 v[8:9], v[8:9], v[12:13]
    v_pk_add_f32 v[10:11], v[10:11], v[14:15]
    v_pk_add_f32 v[8:9], v[8:9], v[10:11]
    v_add_f32 v8, v8, v9
    v_fmac_f32 v8, v7, v165
    v_mov_b32 v9, v8
    s_nop 1
    v_permlane32_swap_b32 v8, v9
    v_add_f32 v8, v8, v9
    ds_write_b32 v166, v8 offset:1024
    v_mov_b32 v164, 1
    s_mov_b64 exec, 1
    ds_add_u32 v0, v164 offset:1020
    s_mov_b64 exec, -1
    s_cmp_lg_u32 s33, 0
    s_cbranch_scc1 L_B_F
    v_and_b32 v2, 7, v1
    v_lshlrev_b32 v2, 7, v2
    v_and_or_b32 v2, v1, 24, v2
    s_lshl_b32 s49, s61, 10
    s_add_u32 s49, s49, 1048576
L_w39:
    ds_read_b32 v3, v0 offset:1020
    s_sub_u32 s3, s3, 1
    s_cbranch_scc1 L_end
    s_waitcnt lgkmcnt(0)
    v_cmp_gt_u32 vcc, 8, v3
    s_cbranch_vccnz L_w39
    ds_read_b128 v[8:11], v5 offset:1024
    s_waitcnt lgkmcnt(0)
    v_add_f32 v8, v8, v9
    v_add_f32 v10, v10, v11
    v_add_f32 v7, v8, v10
L_w40:
    ds_read_b32 v3, v0 offset:2024
    s_sub_u32 s3, s3, 1
    s_cbranch_scc1 L_end
    s_waitcnt lgkmcnt(0)
    v_cmp_gt_u32 vcc, 4, v3
    s_cbranch_vccnz L_w40
L_w41:
    s_sleep 1
    ds_read_b32 v3, v0 offset:7060
    s_sub_u32 s3, s3, 1
    s_cbranch_scc1 L_end
    s_waitcnt lgkmcnt(0)
    v_cmp_gt_u32 vcc, 1, v3
    s_cbranch_vccnz L_w41
    s_mov_b32 exec_hi, 0
    buffer_store_dwordx2 v[6:7], v2, s[40:43], s49 offen sc1
    s_mov_b64 exec, -1
    v_mov_b32 v3, 1
    s_mov_b64 exec, 1
    ds_add_u32 v0, v3 offset:1012
    s_mov_b64 exec, -1
L_B_F:
    s_setprio 0
    s_cmp_ge_u32 s35, 28
    s_cbranch_scc1 L_end
    v_bfe_u32 v12, v1, 4, 1
    v_lshlrev_b32 v12, 1, v12
    v_and_b32 v13, 7, v1
    v_xor_b32 v12, v12, v13
    v_lshlrev_b32 v164, 4, v12
    v_lshrrev_b32 v165, 3, v1
    v_lshrrev_b32 v6, 4, v1
    v_bfe_u32 v8, v1, 2, 2
    v_lshl_add_u32 v9, v6, 3, v8
    v_lshrrev_b32 v8, 1, v8
    v_and_b32 v10, 1, v6
    v_lshl_or_b32 v8, v10, 1, v8
    v_xor_b32 v8, s33, v8
    v_lshlrev_b32 v8, 5, v8
    v_lshl_add_u32 v8, v9, 7, v8
    v_and_b32 v9, 3, v1
    v_lshl_add_u32 v2, v9, 3, v8
    v_bfe_u32 v7, v1, 3, 1
    v_lshl_add_u32 v8, v7, 2, v9
    v_mul_u32_u24 v8, 1040, v8
    v_lshl_add_u32 v8, v6, 4, v8
    v_add_u32 v4, 135232, v8
    v_and_b32 v9, 1, v1
    v_lshl_add_u32 v8, v7, 1, v9
    v_mul_u32_u24 v8, 1040, v8
    v_lshl_add_u32 v8, v6, 4, v8
    v_add_u32 v5, 131072, v8
    v_mul_u32_u24 v8, 144, v7
    v_lshl_add_u32 v8, v6, 3, v8
    s_lshl_b32 s38, s33, 5
    s_add_u32 s38, s38, 143552
    v_add_u32 v6, s38, v8
    v_lshlrev_b32 v7, 5, v7
    v_add_u32 v7, 149504, v7
    s_mov_b32 s44, s18
    s_mov_b32 s45, s19
    s_mov_b32 s46, 1835008
    s_mov_b32 s47, 0x20000
    s_lshl_b32 s58, s35, 7
L_w42:
    s_sleep 2
    ds_read_b32 v3, v0 offset:1012
    s_sub_u32 s3, s3, 1
    s_cbranch_scc1 L_end
    s_waitcnt lgkmcnt(0)
    v_cmp_gt_u32 vcc, 5, v3
    s_cbranch_vccnz L_w42

    v_mul_u32_u24 v12, 3584, v165
    v_add_u32 v12, v12, v164
    v_xor_b32 v13, 64, v12
    s_mul_i32 s38, s33, 458752
    s_add_u32 s58, s58, s38
    s_lshl_b32 s57, s33, 14
    s_add_u32 s57, s57, 0
    s_and_b32 s56, s34, 3
    s_mov_b32 s59, 0
L_A_f1:
    s_xor_b32 s38, s59, s56
    s_lshl_b32 s39, s38, 12
    s_add_u32 s39, s39, s57
    s_mul_i32 s38, s38, 114688
    s_add_u32 s38, s38, s58
    s_add_u32 m0, s39, 0
    s_add_u32 s60, s38, 0
    buffer_load_dwordx4 v12, s[44:47], s60 offen lds
    s_waitcnt vmcnt(3)
    s_add_u32 m0, s39, 1024
    s_add_u32 s60, s38, 28672
    buffer_load_dwordx4 v13, s[44:47], s60 offen lds
    s_waitcnt vmcnt(3)
    s_add_u32 m0, s39, 2048
    s_add_u32 s60, s38, 57344
    buffer_load_dwordx4 v12, s[44:47], s60 offen lds
    s_waitcnt vmcnt(3)
    s_add_u32 m0, s39, 3072
    s_add_u32 s60, s38, 86016
    buffer_load_dwordx4 v13, s[44:47], s60 offen lds
    s_waitcnt vmcnt(3)
    s_add_u32 s59, s59, 1
    s_cmp_lt_u32 s59, 4
    s_cbranch_scc1 L_A_f1
    v_mov_b32 v3, 1
    s_mov_b64 exec, 1
    ds_add_u32 v0, v3 offset:5044
    s_mov_b64 exec, -1
    s_waitcnt vmcnt(0)
    v_mov_b32 v3, 1
    s_mov_b64 exec, 1
    ds_add_u32 v0, v3 offset:5040
    s_mov_b64 exec, -1
L_w43:
    s_sleep 1
    ds_read_b32 v3, v0 offset:5040
    s_sub_u32 s3, s3, 1
    s_cbranch_scc1 L_end
    s_waitcnt lgkmcnt(0)
    v_cmp_gt_u32 vcc, 4, v3
    s_cbranch_vccnz L_w43
    ds_read_b64_tr_b16 v[104:105], v2 offset:0
    ds_read_b64_tr_b16 v[106:107], v2 offset:512
    ds_read_b64_tr_b16 v[108:109], v2 offset:4096
    ds_read_b64_tr_b16 v[110:111], v2 offset:4608
    ds_read_b64_tr_b16 v[112:113], v2 offset:8192
    ds_read_b64_tr_b16 v[114:115], v2 offset:8704
    ds_read_b64_tr_b16 v[116:117], v2 offset:12288
    ds_read_b64_tr_b16 v[118:119], v2 offset:12800
    s_waitcnt lgkmcnt(4)
    ds_read_b64_tr_b16 v[120:121], v2 offset:16384
    ds_read_b64_tr_b16 v[122:123], v2 offset:16896
    ds_read_b64_tr_b16 v[124:125], v2 offset:20480
    ds_read_b64_tr_b16 v[126:127], v2 offset:20992
    ds_read_b64_tr_b16 v[128:129], v2 offset:24576
    ds_read_b64_tr_b16 v[130:131], v2 offset:25088
    ds_read_b64_tr_b16 v[132:133], v2 offset:28672
    ds_read_b64_tr_b16 v[134:135], v2 offset:29184
    s_waitcnt lgkmcnt(4)
    ds_read_b64_tr_b16 v[136:137], v2 offset:32768
    ds_read_b64_tr_b16 v[138:139], v2 offset:33280
    ds_read_b64_tr_b16 v[140:141], v2 offset:36864
    ds_read_b64_tr_b16 v[142:143], v2 offset:37376
    ds_read_b64_tr_b16 v[144:145], v2 offset:40960
    ds_read_b64_tr_b16 v[146:147], v2 offset:41472
    ds_read_b64_tr_b16 v[148:149], v2 offset:45056
    ds_read_b64_tr_b16 v[150:151], v2 offset:45568
    s_waitcnt lgkmcnt(4)
    ds_read_b64_tr_b16 v[152:153], v2 offset:49152
    ds_read_b64_tr_b16 v[154:155], v2 offset:49664
    ds_read_b64_tr_b16 v[156:157], v2 offset:53248
    ds_read_b64_tr_b16 v[158:159], v2 offset:53760
    ds_read_b64_tr_b16 v[160:161], v2 offset:57344
    ds_read_b64_tr_b16 v[162:163], v2 offset:57856
    ds_read_b64_tr_b16 v[164:165], v2 offset:61440
    ds_read_b64_tr_b16 v[166:167], v2 offset:61952
    s_waitcnt lgkmcnt(4)
L_w44:
    s_sleep 1
    ds_read_b32 v3, v0 offset:5048
    s_sub_u32 s3, s3, 1
    s_cbranch_scc1 L_end
    s_waitcnt lgkmcnt(0)
    v_cmp_gt_u32 vcc, 4, v3
    s_cbranch_vccnz L_w44
    ds_read_b128 v[40:43], v4 offset:0
    ds_read_b128 v[44:47], v4 offset:64
    ds_read_b128 v[48:51], v4 offset:128
    ds_read_b128 v[52:55], v4 offset:192
    ds_read_b128 v[56:59], v4 offset:256
    ds_read_b128 v[60:63], v4 offset:320
    ds_read_b128 v[64:67], v4 offset:384
    ds_read_b128 v[68:71], v4 offset:448
    ds_read_b128 v[72:75], v4 offset:512
    ds_read_b128 v[76:79], v4 offset:576
    ds_read_b128 v[80:83], v4 offset:640
    ds_read_b128 v[84:87], v4 offset:704
    s_waitcnt lgkmcnt(11)
    v_mfma_f32_16x16x32_bf16 v[8:11], v[104:107], v[40:43], 0
    ds_read_b128 v[88:91], v4 offset:768
    s_waitcnt lgkmcnt(11)
    v_mfma_f32_16x16x32_bf16 v[12:15], v[108:111], v[44:47], 0
    ds_read_b128 v[92:95], v4 offset:832
    s_waitcnt lgkmcnt(11)
    v_mfma_f32_16x16x32_bf16 v[8:11], v[112:115], v[48:51], v[8:11]
    ds_read_b128 v[96:99], v4 offset:896
    s_waitcnt lgkmcnt(11)
    v_mfma_f32_16x16x32_bf16 v[12:15], v[116:119], v[52:55], v[12:15]
    ds_read_b128 v[100:103], v4 offset:960
    s_waitcnt lgkmcnt(11)
    v_mfma_f32_16x16x32_bf16 v[8:11], v[120:123], v[56:59], v[8:11]
    s_waitcnt lgkmcnt(10)
    v_mfma_f32_16x16x32_bf16 v[12:15], v[124:127], v[60:63], v[12:15]
    s_waitcnt lgkmcnt(9)
    v_mfma_f32_16x16x32_bf16 v[8:11], v[128:131], v[64:67], v[8:11]
    s_waitcnt lgkmcnt(8)
    v_mfma_f32_16x16x32_bf16 v[12:15], v[132:135], v[68:71], v[12:15]
    s_waitcnt lgkmcnt(7)
    v_mfma_f32_16x16x32_bf16 v[8:11], v[136:139], v[72:75], v[8:11]
    s_waitcnt lgkmcnt(6)
    v_mfma_f32_16x16x32_bf16 v[12:15], v[140:143], v[76:79], v[12:15]
    s_waitcnt lgkmcnt(5)
    v_mfma_f32_16x16x32_bf16 v[8:11], v[144:147], v[80:83], v[8:11]
    s_waitcnt lgkmcnt(4)
    v_mfma_f32_16x16x32_bf16 v[12:15], v[148:151], v[84:87], v[12:15]
    s_waitcnt lgkmcnt(3)
    v_mfma_f32_16x16x32_bf16 v[8:11], v[152:155], v[88:91], v[8:11]
    s_waitcnt lgkmcnt(2)
    v_mfma_f32_16x16x32_bf16 v[12:15], v[156:159], v[92:95], v[12:15]
    s_waitcnt lgkmcnt(1)
    v_mfma_f32_16x16x32_bf16 v[8:11], v[160:163], v[96:99], v[8:11]
    s_waitcnt lgkmcnt(0)
    v_mfma_f32_16x16x32_bf16 v[12:15], v[164:167], v[100:103], v[12:15]
    s_nop 7
    v_pk_add_f32 v[8:9], v[8:9], v[12:13]
    v_pk_add_f32 v[10:11], v[10:11], v[14:15]
    s_nop 0
    v_add_f32_dpp v8, v8, v8 quad_perm:[1,0,3,2] row_mask:0xf bank_mask:0xf
    v_add_f32_dpp v9, v9, v9 quad_perm:[1,0,3,2] row_mask:0xf bank_mask:0xf
    v_add_f32_dpp v10, v10, v10 quad_perm:[1,0,3,2] row_mask:0xf bank_mask:0xf
    v_add_f32_dpp v11, v11, v11 quad_perm:[1,0,3,2] row_mask:0xf bank_mask:0xf
    v_mov_b32_dpp v16, v8 quad_perm:[0,0,0,0] row_mask:0xf bank_mask:0xf
    v_mov_b32_dpp v20, v8 quad_perm:[2,2,2,2] row_mask:0xf bank_mask:0xf
    v_mov_b32_dpp v17, v9 quad_perm:[0,0,0,0] row_mask:0xf bank_mask:0xf
    v_mov_b32_dpp v21, v9 quad_perm:[2,2,2,2] row_mask:0xf bank_mask:0xf
    v_mov_b32_dpp v18, v10 quad_perm:[0,0,0,0] row_mask:0xf bank_mask:0xf
    v_mov_b32_dpp v22, v10 quad_perm:[2,2,2,2] row_mask:0xf bank_mask:0xf
    v_mov_b32_dpp v19, v11 quad_perm:[0,0,0,0] row_mask:0xf bank_mask:0xf
    v_mov_b32_dpp v23, v11 quad_perm:[2,2,2,2] row_mask:0xf bank_mask:0xf
    s_mov_b32 s38, 0x3b000000
    s_setprio 2
L_w45:
    s_sleep 1
    ds_read_b32 v3, v0 offset:5052
    s_sub_u32 s3, s3, 1
    s_cbranch_scc1 L_end
    s_waitcnt lgkmcnt(0)
    v_cmp_gt_u32 vcc, 1, v3
    s_cbranch_vccnz L_w45
L_w46:
    ds_read_b32 v3, v0 offset:5052
    s_sub_u32 s3, s3, 1
    s_cbranch_scc1 L_end
    s_waitcnt lgkmcnt(0)
    v_cmp_gt_u32 vcc, 4, v3
    s_cbranch_vccnz L_w46
    ds_read_b128 v[40:43], v5 offset:0
    ds_read_b128 v[44:47], v5 offset:64
    ds_read_b128 v[48:51], v5 offset:128
    ds_read_b128 v[52:55], v5 offset:192
    ds_read_b128 v[56:59], v5 offset:256
    ds_read_b128 v[60:63], v5 offset:320
    ds_read_b128 v[64:67], v5 offset:384
    ds_read_b128 v[68:71], v5 offset:448
    ds_read_b128 v[72:75], v5 offset:512
    ds_read_b128 v[76:79], v5 offset:576
    ds_read_b128 v[80:83], v5 offset:640
    ds_read_b128 v[84:87], v5 offset:704
    s_waitcnt lgkmcnt(11)
    v_mfma_f32_16x16x32_bf16 v[8:11], v[104:107], v[40:43], 0
    ds_read_b128 v[88:91], v5 offset:768
    s_waitcnt lgkmcnt(11)
    v_mfma_f32_16x16x32_bf16 v[12:15], v[108:111], v[44:47], 0
    ds_read_b128 v[92:95], v5 offset:832
    s_waitcnt lgkmcnt(11)
    v_mfma_f32_16x16x32_bf16 v[8:11], v[112:115], v[48:51], v[8:11]
    ds_read_b128 v[96:99], v5 offset:896
    s_waitcnt lgkmcnt(11)
    v_mfma_f32_16x16x32_bf16 v[12:15], v[116:119], v[52:55], v[12:15]
    ds_read_b128 v[100:103], v5 offset:960
    s_waitcnt lgkmcnt(11)
    v_mfma_f32_16x16x32_bf16 v[8:11], v[120:123], v[56:59], v[8:11]
    s_waitcnt lgkmcnt(10)
    v_mfma_f32_16x16x32_bf16 v[12:15], v[124:127], v[60:63], v[12:15]
    s_waitcnt lgkmcnt(9)
    v_mfma_f32_16x16x32_bf16 v[8:11], v[128:131], v[64:67], v[8:11]
    s_waitcnt lgkmcnt(8)
    v_mfma_f32_16x16x32_bf16 v[12:15], v[132:135], v[68:71], v[12:15]
    s_waitcnt lgkmcnt(7)
    v_mfma_f32_16x16x32_bf16 v[8:11], v[136:139], v[72:75], v[8:11]
    s_waitcnt lgkmcnt(6)
    v_mfma_f32_16x16x32_bf16 v[12:15], v[140:143], v[76:79], v[12:15]
    s_waitcnt lgkmcnt(5)
    v_mfma_f32_16x16x32_bf16 v[8:11], v[144:147], v[80:83], v[8:11]
    s_waitcnt lgkmcnt(4)
    v_mfma_f32_16x16x32_bf16 v[12:15], v[148:151], v[84:87], v[12:15]
    s_waitcnt lgkmcnt(3)
    v_mfma_f32_16x16x32_bf16 v[8:11], v[152:155], v[88:91], v[8:11]
    s_waitcnt lgkmcnt(2)
    v_mfma_f32_16x16x32_bf16 v[12:15], v[156:159], v[92:95], v[12:15]
    s_waitcnt lgkmcnt(1)
    v_mfma_f32_16x16x32_bf16 v[8:11], v[160:163], v[96:99], v[8:11]
    s_waitcnt lgkmcnt(0)
    v_mfma_f32_16x16x32_bf16 v[12:15], v[164:167], v[100:103], v[12:15]
L_B_ln:
    ds_read_b128 v[24:27], v7
    ds_read_b128 v[28:31], v7 offset:16
    s_sub_u32 s3, s3, 1
    s_cbranch_scc1 L_end
    s_waitcnt lgkmcnt(0)
    v_max3_u32 v32, v24, v25, v26
    v_max3_u32 v32, v32, v27, v28
    v_max3_u32 v32, v32, v29, v30
    v_max_u32 v32, v32, v31
    v_cmp_eq_u32 vcc, -1, v32
    s_cbranch_vccnz L_B_ln
    v_pk_add_f32 v[24:25], v[24:25], v[26:27]
    v_pk_add_f32 v[28:29], v[28:29], v[30:31]
    v_add_f32 v24, v24, v25
    v_add_f32 v28, v28, v29
    v_mul_f32 v24, s38, v24
    v_mul_f32 v28, s38, v28
    v_fma_f32 v28, -v24, v24, v28
    v_max_f32 v28, 0, v28
    v_add_f32 v28, 0x3727c5ac, v28
    v_rsq_f32 v28, v28
    v_pk_add_f32 v[8:9], v[8:9], v[12:13]
    v_pk_add_f32 v[10:11], v[10:11], v[14:15]
    s_nop 0
    v_add_f32_dpp v8, v8, v8 quad_perm:[1,0,3,2] row_mask:0xf bank_mask:0xf
    v_add_f32_dpp v9, v9, v9 quad_perm:[1,0,3,2] row_mask:0xf bank_mask:0xf
    v_add_f32_dpp v10, v10, v10 quad_perm:[1,0,3,2] row_mask:0xf bank_mask:0xf
    v_add_f32_dpp v11, v11, v11 quad_perm:[1,0,3,2] row_mask:0xf bank_mask:0xf
    v_fma_f32 v8, -v24, v16, v8
    v_fma_f32 v9, -v24, v17, v9
    v_fma_f32 v10, -v24, v18, v10
    v_fma_f32 v11, -v24, v19, v11
    v_fma_f32 v8, v8, v28, v20
    v_fma_f32 v9, v9, v28, v21
    v_fma_f32 v10, v10, v28, v22
    v_fma_f32 v11, v11, v28, v23
    v_max_f32 v8, 0, v8
    v_max_f32 v9, 0, v9
    v_max_f32 v10, 0, v10
    v_max_f32 v11, 0, v11
    v_cvt_pk_bf16_f32 v8, v8, v9
    v_cvt_pk_bf16_f32 v9, v10, v11
    ds_write_b64 v6, v[8:9]
    v_mov_b32 v3, 1
    s_mov_b64 exec, 1
    ds_add_u32 v0, v3 offset:2016
    s_mov_b64 exec, -1
    s_branch L_end
L_B_qf0:
    s_mov_b32 s63, 1
    s_sub_u32 s3, s3, 1
    s_cbranch_scc1 L_end
    s_add_u32 m0, s49, 0
    s_add_u32 s38, s51, 0
    v_lshlrev_b32 v6, 4, v1
    buffer_load_dwordx4 v6, s[40:43], s38 offen sc1 lds
    s_branch L_B_qn0
L_B_qf1:
    s_mov_b32 s63, 1
    s_sub_u32 s3, s3, 1
    s_cbranch_scc1 L_end
    s_add_u32 m0, s49, 1008
    s_add_u32 s38, s51, 1024
    v_lshlrev_b32 v6, 4, v1
    buffer_load_dwordx4 v6, s[40:43], s38 offen sc1 lds
    s_branch L_B_qn1
L_B_qf2:
    s_mov_b32 s63, 1
    s_sub_u32 s3, s3, 1
    s_cbranch_scc1 L_end
    s_add_u32 m0, s49, 2016
    s_add_u32 s38, s51, 2048
    v_lshlrev_b32 v6, 4, v1
    buffer_load_dwordx4 v6, s[40:43], s38 offen sc1 lds
    s_branch L_B_qn2
L_B_qf3:
    s_mov_b32 s63, 1
    s_sub_u32 s3, s3, 1
    s_cbranch_scc1 L_end
    s_add_u32 m0, s49, 3024
    s_add_u32 s38, s51, 3072
    v_lshlrev_b32 v6, 4, v1
    buffer_load_dwordx4 v6, s[40:43], s38 offen sc1 lds
    s_branch L_B_qn3
L_B_qf4:
    s_mov_b32 s63, 1
    s_sub_u32 s3, s3, 1
    s_cbranch_scc1 L_end
    s_add_u32 m0, s49, 4032
    s_add_u32 s38, s51, 4096
    v_lshlrev_b32 v6, 4, v1
    buffer_load_dwordx4 v6, s[40:43], s38 offen sc1 lds
    s_branch L_B_qn4
L_B_qf5:
    s_mov_b32 s63, 1
    s_sub_u32 s3, s3, 1
    s_cbranch_scc1 L_end
    s_add_u32 m0, s49, 5040
    s_add_u32 s38, s51, 5120
    v_lshlrev_b32 v6, 4, v1
    buffer_load_dwordx4 v6, s[40:43], s38 offen sc1 lds
    s_branch L_B_qn5
L_B_qf6:
    s_mov_b32 s63, 1
    s_sub_u32 s3, s3, 1
    s_cbranch_scc1 L_end
    s_add_u32 m0, s49, 6048
    s_add_u32 s38, s51, 6144
    v_lshlrev_b32 v6, 4, v1
    buffer_load_dwordx4 v6, s[40:43], s38 offen sc1 lds
    s_branch L_B_qn6
L_B_qf7:
    s_mov_b32 s63, 1
    s_sub_u32 s3, s3, 1
    s_cbranch_scc1 L_end
    s_add_u32 m0, s49, 7056
    s_add_u32 s38, s51, 7168
    v_lshlrev_b32 v6, 4, v1
    buffer_load_dwordx4 v6, s[40:43], s38 offen sc1 lds
    s_branch L_B_qn7
L_B_qf8:
    s_mov_b32 s63, 1
    s_sub_u32 s3, s3, 1
    s_cbranch_scc1 L_end
    buffer_load_dwordx4 v[24:27], v7, s[40:43], s50 offen offset:992 sc1
    s_branch L_B_qn8
L_Cs:
    s_setprio 2

    v_lshrrev_b32 v3, 4, v1
    v_and_b32 v5, 15, v1
    v_lshlrev_b32 v2, 10, v3
    v_lshl_add_u32 v2, v5, 4, v2
    s_lshl_b32 s38, s33, 8
    v_add_u32 v2, s38, v2
    v_add_u32 v4, 0x1000, v2
    s_waitcnt lgkmcnt(0)
    global_load_dwordx4 v[24:27], v2, s[4:5]
    global_load_dwordx4 v[28:31], v4, s[4:5]
    global_load_dwordx4 v[8:11], v2, s[22:23]
    global_load_dwordx4 v[12:15], v4, s[22:23]
    s_barrier

    s_mov_b32 s3, 0x400000
    v_mov_b32 v0, 156256
    s_and_b32 s62, s34, 3
    s_lshl2_add_u32 s97, s62, s37
    s_lshl4_add_u32 s61, s36, s97
    s_waitcnt lgkmcnt(0)

    s_mov_b32 s40, s30
    s_mov_b32 s41, s31
    s_mov_b32 s42, 16777216
    s_mov_b32 s43, 0x20000
    s_lshl2_add_u32 s55, s36, s37
    v_mov_b32 v32, 0x3f803f80
    v_mov_b32 v33, v32
    v_mov_b32 v34, v32
    v_mov_b32 v35, v32
    v_mov_b32 v36, v32
    v_mov_b32 v37, v32
    v_mov_b32 v38, v32
    v_mov_b32 v39, v32
    v_mov_b32 v40, v32
    v_mov_b32 v41, v32
    v_mov_b32 v42, v32
    v_mov_b32 v43, v32
    v_mov_b32 v44, v32
    v_mov_b32 v45, v32
    v_mov_b32 v46, v32
    v_mov_b32 v47, v32

    s_mov_b32 s56, 0x00ff00ff
    s_mov_b32 s57, 0x00ff00ff
    s_mul_i32 s38, s33, 2176
    v_mul_u32_u24 v6, 272, v3
    v_lshl_add_u32 v6, v5, 4, v6
    v_add_u32 v6, s38, v6
    v_and_b32 v92, 7, v1
    v_mul_u32_u24 v95, 272, v92
    v_lshl_add_u32 v7, v3, 4, v95
    v_add_u32 v7, s38, v7
    v_lshl_add_u32 v95, v3, 3, v95
    s_lshr_b32 s38, s55, 3
    s_mul_i32 s38, s38, 2176
    s_and_b32 s39, s55, 7
    s_lshl_b32 s39, s39, 5
    s_add_u32 s38, s38, s39
    v_add_u32 v95, s38, v95
    s_lshl_b32 s59, s33, 13
    s_add_u32 s59, s59, 65536
    v_bfe_u32 v2, v1, 2, 2
    v_lshl_add_u32 v2, v3, 3, v2
    v_lshlrev_b32 v2, 6, v2
    v_and_b32 v4, 1, v3
    v_lshl_add_u32 v2, v4, 5, v2
    v_and_b32 v4, 3, v1
    v_lshl_add_u32 v2, v4, 3, v2
    v_add_u32 v2, s59, v2
    v_xor_b32 v3, 32, v2
    s_mul_i32 s38, s33, 3072
    s_add_u32 s38, s38, 49152
    v_lshl_add_u32 v4, v1, 4, s38
    s_lshl_b32 s38, s33, 2
    v_add_u32 v5, s38, v0
    s_mov_b32 s38, 0xbfb8aa3b
    s_waitcnt vmcnt(2)
    ds_write_b128 v6, v[24:27] offset:16384
    ds_write_b128 v6, v[28:31] offset:17472
    s_mov_b64 exec, s[56:57]
    ds_read_b128 v[32:35], v7 offset:16384
    ds_read_b128 v[36:39], v7 offset:16448
    ds_read_b128 v[40:43], v7 offset:16512
    ds_read_b128 v[44:47], v7 offset:16576
    s_mov_b64 exec, -1
    s_waitcnt vmcnt(0)
    v_lshlrev_b32 v48, 16, v8
    v_and_b32 v49, 0xffff0000, v8
    v_mul_f32 v50, s38, v48
    v_mul_f32 v51, s38, v49
    v_exp_f32 v50, v50
    v_exp_f32 v51, v51
    v_add_f32 v50, 1.0, v50
    v_add_f32 v51, 1.0, v51
    v_rcp_f32 v50, v50
    v_rcp_f32 v51, v51
    v_mul_f32 v48, v48, v50
    v_mul_f32 v49, v49, v51
    v_cvt_pk_bf16_f32 v8, v48, v49
    s_waitcnt lgkmcnt(0)
    v_mfma_f32_16x16x32_bf16 v[88:91], v[32:35], v[32:35], 0
    v_mfma_f32_16x16x32_bf16 v[88:91], v[36:39], v[36:39], v[88:91]
    v_mfma_f32_16x16x32_bf16 v[88:91], v[40:43], v[40:43], v[88:91]
    v_mfma_f32_16x16x32_bf16 v[88:91], v[44:47], v[44:47], v[88:91]
    v_lshlrev_b32 v48, 16, v9
    v_and_b32 v49, 0xffff0000, v9
    v_mul_f32 v50, s38, v48
    v_mul_f32 v51, s38, v49
    v_exp_f32 v50, v50
    v_exp_f32 v51, v51
    v_add_f32 v50, 1.0, v50
    v_add_f32 v51, 1.0, v51
    v_rcp_f32 v50, v50
    v_rcp_f32 v51, v51
    v_mul_f32 v48, v48, v50
    v_mul_f32 v49, v49, v51
    v_cvt_pk_bf16_f32 v9, v48, v49
    ds_write_b128 v4, v[88:91] offset:2048
    v_mov_b32 v52, 1
    s_mov_b64 exec, 1
    ds_add_u32 v0, v52 offset:12
    s_mov_b64 exec, -1
    v_lshlrev_b32 v48, 16, v10
    v_and_b32 v49, 0xffff0000, v10
    v_mul_f32 v50, s38, v48
    v_mul_f32 v51, s38, v49
    v_exp_f32 v50, v50
    v_exp_f32 v51, v51
    v_add_f32 v50, 1.0, v50
    v_add_f32 v51, 1.0, v51
    v_rcp_f32 v50, v50
    v_rcp_f32 v51, v51
    v_mul_f32 v48, v48, v50
    v_mul_f32 v49, v49, v51
    v_cvt_pk_bf16_f32 v10, v48, v49
    v_lshlrev_b32 v48, 16, v11
    v_and_b32 v49, 0xffff0000, v11
    v_mul_f32 v50, s38, v48
    v_mul_f32 v51, s38, v49
    v_exp_f32 v50, v50
    v_exp_f32 v51, v51
    v_add_f32 v50, 1.0, v50
    v_add_f32 v51, 1.0, v51
    v_rcp_f32 v50, v50
    v_rcp_f32 v51, v51
    v_mul_f32 v48, v48, v50
    v_mul_f32 v49, v49, v51
    v_cvt_pk_bf16_f32 v11, v48, v49
    v_lshlrev_b32 v48, 16, v12
    v_and_b32 v49, 0xffff0000, v12
    v_mul_f32 v50, s38, v48
    v_mul_f32 v51, s38, v49
    v_exp_f32 v50, v50
    v_exp_f32 v51, v51
    v_add_f32 v50, 1.0, v50
    v_add_f32 v51, 1.0, v51
    v_rcp_f32 v50, v50
    v_rcp_f32 v51, v51
    v_mul_f32 v48, v48, v50
    v_mul_f32 v49, v49, v51
    v_cvt_pk_bf16_f32 v12, v48, v49
    v_lshlrev_b32 v48, 16, v13
    v_and_b32 v49, 0xffff0000, v13
    v_mul_f32 v50, s38, v48
    v_mul_f32 v51, s38, v49
    v_exp_f32 v50, v50
    v_exp_f32 v51, v51
    v_add_f32 v50, 1.0, v50
    v_add_f32 v51, 1.0, v51
    v_rcp_f32 v50, v50
    v_rcp_f32 v51, v51
    v_mul_f32 v48, v48, v50
    v_mul_f32 v49, v49, v51
    v_cvt_pk_bf16_f32 v13, v48, v49
    v_lshlrev_b32 v48, 16, v14
    v_and_b32 v49, 0xffff0000, v14
    v_mul_f32 v50, s38, v48
    v_mul_f32 v51, s38, v49
    v_exp_f32 v50, v50
    v_exp_f32 v51, v51
    v_add_f32 v50, 1.0, v50
    v_add_f32 v51, 1.0, v51
    v_rcp_f32 v50, v50
    v_rcp_f32 v51, v51
    v_mul_f32 v48, v48, v50
    v_mul_f32 v49, v49, v51
    v_cvt_pk_bf16_f32 v14, v48, v49
    v_lshlrev_b32 v48, 16, v15
    v_and_b32 v49, 0xffff0000, v15
    v_mul_f32 v50, s38, v48
    v_mul_f32 v51, s38, v49
    v_exp_f32 v50, v50
    v_exp_f32 v51, v51
    v_add_f32 v50, 1.0, v50
    v_add_f32 v51, 1.0, v51
    v_rcp_f32 v50, v50
    v_rcp_f32 v51, v51
    v_mul_f32 v48, v48, v50
    v_mul_f32 v49, v49, v51
    v_cvt_pk_bf16_f32 v15, v48, v49
    ds_write_b128 v6, v[8:11] offset:32768
    ds_write_b128 v6, v[12:15] offset:33856
    ds_read_b128 v[8:11], v7 offset:32768
    ds_read_b128 v[12:15], v7 offset:32832
    ds_read_b128 v[16:19], v7 offset:32896
    ds_read_b128 v[20:23], v7 offset:32960
    s_cmp_lg_u32 s33, 0
    s_cbranch_scc1 L_C_nln
    v_lshrrev_b32 v93, 2, v92
    v_lshl_add_u32 v93, v93, 4, v92
    v_lshlrev_b32 v93, 4, v93
    v_and_b32 v94, 3, v1
    v_lshl_add_u32 v93, v94, 2, v93
    v_add_u32 v93, 51200, v93
    v_lshlrev_b32 v92, 4, v92
    v_add_u32 v94, 51712, v92
    v_lshrrev_b32 v96, 5, v1
    v_lshl_add_u32 v92, v96, 7, v92
    v_bfe_u32 v96, v1, 4, 1
    v_lshl_add_u32 v92, v96, 3, v92
    s_lshl_b32 s39, s55, 8
L_w47:
    ds_read_b32 v40, v0 offset:12
    s_sub_u32 s3, s3, 1
    s_cbranch_scc1 L_end
    s_waitcnt lgkmcnt(0)
    v_cmp_gt_u32 vcc, 4, v40
    s_cbranch_vccnz L_w47
    ds_read_b32 v24, v94 offset:0
    ds_read_b32 v28, v93 offset:0
    ds_read_b32 v25, v94 offset:3072
    ds_read_b32 v29, v93 offset:3072
    ds_read_b32 v26, v94 offset:6144
    ds_read_b32 v30, v93 offset:6144
    ds_read_b32 v27, v94 offset:9216
    ds_read_b32 v31, v93 offset:9216
    ds_read_b64 v[6:7], v95 offset:16384
    s_mov_b32 s38, 0x3b000000
    s_waitcnt lgkmcnt(0)
    v_lshlrev_b32 v96, 16, v6
    v_and_b32 v97, 0xffff0000, v6
    v_lshlrev_b32 v98, 16, v7
    v_and_b32 v99, 0xffff0000, v7
    v_add_f32 v24, v24, v25
    v_add_f32 v28, v28, v29
    v_add_f32 v26, v26, v27
    v_add_f32 v30, v30, v31
    v_add_f32 v24, v24, v26
    v_add_f32 v28, v28, v30
    v_mul_f32 v24, s38, v24
    v_mul_f32 v28, s38, v28
    v_fma_f32 v28, -v24, v24, v28
    v_max_f32 v28, 0, v28
    v_add_f32 v28, 0x3727c5ac, v28
    v_rsq_f32 v28, v28
    v_sub_f32 v96, v96, v24
    v_sub_f32 v97, v97, v24
    v_sub_f32 v98, v98, v24
    v_sub_f32 v99, v99, v24
    v_mul_f32 v96, v96, v28
    v_mul_f32 v97, v97, v28
    v_mul_f32 v98, v98, v28
    v_mul_f32 v99, v99, v28
L_C_nln:
L_w48:
    ds_read_b32 v40, v5 offset:4032
    s_sub_u32 s3, s3, 1
    s_cbranch_scc1 L_end
    s_waitcnt lgkmcnt(0)
    v_cmp_gt_u32 vcc, 1, v40
    s_cbranch_vccnz L_w48
    ds_read_b64_tr_b16 v[48:49], v2 offset:0
    ds_read_b64_tr_b16 v[50:51], v2 offset:256
    ds_read_b64_tr_b16 v[52:53], v3 offset:0
    ds_read_b64_tr_b16 v[54:55], v3 offset:256
    ds_read_b64_tr_b16 v[56:57], v2 offset:2048
    ds_read_b64_tr_b16 v[58:59], v2 offset:2304
    ds_read_b64_tr_b16 v[60:61], v3 offset:2048
    ds_read_b64_tr_b16 v[62:63], v3 offset:2304
    s_waitcnt lgkmcnt(4)
    v_mfma_f32_16x16x32_bf16 v[80:83], v[48:51], v[8:11], 0
    v_mfma_f32_16x16x32_bf16 v[84:87], v[52:55], v[8:11], 0
    s_waitcnt lgkmcnt(0)
    v_mfma_f32_16x16x32_bf16 v[80:83], v[56:59], v[12:15], v[80:83]
    v_mfma_f32_16x16x32_bf16 v[84:87], v[60:63], v[12:15], v[84:87]
L_w49:
    ds_read_b32 v40, v5 offset:4032
    s_sub_u32 s3, s3, 1
    s_cbranch_scc1 L_end
    s_waitcnt lgkmcnt(0)
    v_cmp_gt_u32 vcc, 2, v40
    s_cbranch_vccnz L_w49
    ds_read_b64_tr_b16 v[64:65], v2 offset:4096
    ds_read_b64_tr_b16 v[66:67], v2 offset:4352
    ds_read_b64_tr_b16 v[68:69], v3 offset:4096
    ds_read_b64_tr_b16 v[70:71], v3 offset:4352
    ds_read_b64_tr_b16 v[72:73], v2 offset:6144
    ds_read_b64_tr_b16 v[74:75], v2 offset:6400
    ds_read_b64_tr_b16 v[76:77], v3 offset:6144
    ds_read_b64_tr_b16 v[78:79], v3 offset:6400
    s_waitcnt lgkmcnt(4)
    v_mfma_f32_16x16x32_bf16 v[80:83], v[64:67], v[16:19], v[80:83]
    v_mfma_f32_16x16x32_bf16 v[84:87], v[68:71], v[16:19], v[84:87]
    s_waitcnt lgkmcnt(0)
    v_mfma_f32_16x16x32_bf16 v[80:83], v[72:75], v[20:23], v[80:83]
    v_mfma_f32_16x16x32_bf16 v[84:87], v[76:79], v[20:23], v[84:87]
    s_cmp_eq_u32 s33, 0
    s_cbranch_scc1 L_C_red
    s_nop 4
    ds_write_b128 v4, v[80:83] offset:0
    ds_write_b128 v4, v[84:87] offset:1024
    v_mov_b32 v5, 1
    s_mov_b64 exec, 1
    ds_add_u32 v0, v5 offset:8
    s_mov_b64 exec, -1
    s_branch L_C_o
L_C_red:
L_w50:
    ds_read_b32 v5, v0 offset:8
    s_sub_u32 s3, s3, 1
    s_cbranch_scc1 L_end
    s_waitcnt lgkmcnt(0)
    v_cmp_gt_u32 vcc, 3, v5
    s_cbranch_vccnz L_w50
    ds_read_b128 v[48:51], v4 offset:3072
    ds_read_b128 v[52:55], v4 offset:4096
    ds_read_b128 v[56:59], v4 offset:6144
    ds_read_b128 v[60:63], v4 offset:7168
    ds_read_b128 v[64:67], v4 offset:9216
    ds_read_b128 v[68:71], v4 offset:10240
    ds_read_b32 v5, v0 offset:2020
    v_add_f32 v80, v80, v96
    v_add_f32 v81, v81, v97
    v_add_f32 v82, v82, v98
    v_add_f32 v83, v83, v99
    s_waitcnt lgkmcnt(0)
    v_pk_add_f32 v[80:81], v[80:81], v[48:49]
    v_pk_add_f32 v[56:57], v[56:57], v[64:65]
    v_pk_add_f32 v[82:83], v[82:83], v[50:51]
    v_pk_add_f32 v[58:59], v[58:59], v[66:67]
    v_pk_add_f32 v[84:85], v[84:85], v[52:53]
    v_pk_add_f32 v[60:61], v[60:61], v[68:69]
    v_pk_add_f32 v[86:87], v[86:87], v[54:55]
    v_pk_add_f32 v[62:63], v[62:63], v[70:71]
    v_pk_add_f32 v[80:81], v[80:81], v[56:57]
    v_pk_add_f32 v[82:83], v[82:83], v[58:59]
    v_pk_add_f32 v[84:85], v[84:85], v[60:61]
    v_pk_add_f32 v[86:87], v[86:87], v[62:63]
    v_cmp_gt_u32 vcc, 5, v5
    v_fmac_f32 v80, v84, v96
    v_fmac_f32 v81, v85, v97
    v_fmac_f32 v82, v86, v98
    v_fmac_f32 v83, v87, v99
    v_cvt_pk_bf16_f32 v80, v80, v81
    v_cvt_pk_bf16_f32 v81, v82, v83
    s_cbranch_vccz L_C_pub
L_w51:
    ds_read_b32 v5, v0 offset:2020
    s_sub_u32 s3, s3, 1
    s_cbranch_scc1 L_end
    s_waitcnt lgkmcnt(0)
    v_cmp_gt_u32 vcc, 5, v5
    s_cbranch_vccnz L_w51
L_C_pub:
    s_mov_b64 exec, s[56:57]

    buffer_store_dwordx2 v[80:81], v92, s[40:43], s39 offen sc1
    s_mov_b64 exec, -1
    v_mov_b32 v5, 4
    ds_write_b32 v0, v5 offset:5044
    ds_write_b32 v0, v5 offset:4
    s_branch L_C_o
L_Co:
    s_waitcnt lgkmcnt(0)

    s_mov_b32 s3, 0x400000
    v_mov_b32 v0, 156256
    s_and_b32 s62, s34, 3
    s_lshl2_add_u32 s97, s62, s37
    s_lshl4_add_u32 s61, s36, s97
    s_waitcnt lgkmcnt(0)

    s_mov_b32 s40, s30
    s_mov_b32 s41, s31
    s_mov_b32 s42, 16777216
    s_mov_b32 s43, 0x20000
    s_barrier
    s_cmp_lt_u32 s34, 4
    s_cbranch_scc1 L_C_nt
    s_cmp_lg_u32 s33, 0
    s_cbranch_scc1 L_C_nt
    v_lshrrev_b32 v2, 1, v1
    v_and_b32 v3, 1, v1
    s_lshl2_add_u32 s38, s33, s34
    s_sub_u32 s38, s38, 4
    v_lshl_add_u32 v2, v2, 6, v3
    s_lshl_b32 s38, s38, 10
    s_add_u32 s38, s38, s35
    s_lshl_b32 s38, s38, 8
    v_lshl_add_u32 v2, v2, 7, s38
    s_mov_b32 exec_hi, 0
    global_load_dword v166, v2, s[10:11]
    s_not_b64 exec, exec
    s_waitcnt vmcnt(0)
    global_load_dword v166, v2, s[10:11]
    s_mov_b64 exec, -1
    v_mov_b32 v3, 1
    s_mov_b64 exec, 1
    ds_add_u32 v0, v3 offset:4
    s_mov_b64 exec, -1
L_C_nt:
    s_cmp_ge_u32 s34, 4
    s_cbranch_scc1 L_C_at
    s_mul_i32 s63, s34, 3
    s_add_u32 s63, s63, s33
    s_sub_u32 s63, s63, 3
    s_cmp_eq_u32 s33, 3
    s_cbranch_scc1 L_C_qh
    s_cmp_eq_u32 s63, 8
    s_cbranch_scc1 L_C_qs
    s_mov_b32 s44, s10
    s_mov_b32 s45, s11
    s_mov_b32 s46, 4194304
    s_mov_b32 s47, 0x20000

    v_lshrrev_b32 v3, 4, v1
    v_and_b32 v2, 15, v1
    v_xor_b32 v4, v2, v3
    v_lshlrev_b32 v4, 4, v4
    v_lshl_add_u32 v4, v3, 13, v4
    v_xor_b32 v5, 64, v4
    v_xor_b32 v6, 0x80, v4
    v_xor_b32 v7, 0xc0, v4
    s_lshl_b32 s48, s63, 19
    s_lshl_b32 s38, s35, 8
    s_add_u32 s48, s48, s38
    s_lshl_b32 s51, s33, 14
    s_add_u32 s51, s51, 65536
    v_lshlrev_b32 v12, 4, v1
    v_mov_b32 v8, -1
    v_mov_b32 v9, -1
    v_mov_b32 v10, -1
    v_mov_b32 v11, -1
    s_lshl3_add_u32 s38, s35, s63
    s_lshl_b32 s38, s38, 12
    s_add_u32 s52, s38, 1048576
    s_lshr_b32 s53, s38, 4
    s_add_u32 s53, s53, 983040
L_w52:
    s_sleep 1
    ds_read_b32 v13, v0 offset:0
    s_sub_u32 s3, s3, 1
    s_cbranch_scc1 L_end
    s_waitcnt lgkmcnt(0)
    v_cmp_gt_u32 vcc, 4, v13
    s_cbranch_vccnz L_w52
    s_add_u32 m0, s51, 0
    s_add_u32 s38, s48, 0
    buffer_load_dwordx4 v4, s[44:47], s38 offen nt lds
    s_add_u32 m0, s51, 1024
    s_add_u32 s38, s48, 131072
    buffer_load_dwordx4 v5, s[44:47], s38 offen nt lds
    s_add_u32 m0, s51, 2048
    s_add_u32 s38, s48, 262144
    buffer_load_dwordx4 v6, s[44:47], s38 offen nt lds
    s_add_u32 m0, s51, 3072
    s_add_u32 s38, s48, 393216
    buffer_load_dwordx4 v7, s[44:47], s38 offen nt lds
    s_add_u32 m0, s51, 4096
    s_add_u32 s38, s48, 32768
    buffer_load_dwordx4 v4, s[44:47], s38 offen nt lds
    s_add_u32 m0, s51, 5120
    s_add_u32 s38, s48, 163840
    buffer_load_dwordx4 v5, s[44:47], s38 offen nt lds
    s_add_u32 m0, s51, 6144
    s_add_u32 s38, s48, 294912
    buffer_load_dwordx4 v6, s[44:47], s38 offen nt lds
    s_add_u32 m0, s51, 7168
    s_add_u32 s38, s48, 425984
    buffer_load_dwordx4 v7, s[44:47], s38 offen nt lds
    s_add_u32 m0, s51, 8192
    s_add_u32 s38, s48, 65536
    buffer_load_dwordx4 v4, s[44:47], s38 offen nt lds
    s_add_u32 m0, s51, 9216
    s_add_u32 s38, s48, 196608
    buffer_load_dwordx4 v5, s[44:47], s38 offen nt lds
    s_add_u32 m0, s51, 10240
    s_add_u32 s38, s48, 327680
    buffer_load_dwordx4 v6, s[44:47], s38 offen nt lds
    s_add_u32 m0, s51, 11264
    s_add_u32 s38, s48, 458752
    buffer_load_dwordx4 v7, s[44:47], s38 offen nt lds
    s_add_u32 m0, s51, 12288
    s_add_u32 s38, s48, 98304
    buffer_load_dwordx4 v4, s[44:47], s38 offen nt lds
    s_add_u32 m0, s51, 13312
    s_add_u32 s38, s48, 229376
    buffer_load_dwordx4 v5, s[44:47], s38 offen nt lds
    s_add_u32 m0, s51, 14336
    s_add_u32 s38, s48, 360448
    buffer_load_dwordx4 v6, s[44:47], s38 offen nt lds
    s_add_u32 m0, s51, 15360
    s_add_u32 s38, s48, 491520
    buffer_load_dwordx4 v7, s[44:47], s38 offen nt lds
    v_mov_b32 v13, 1
    s_mov_b64 exec, 1
    ds_add_u32 v0, v13 offset:7068
    s_mov_b64 exec, -1

    v_lshlrev_b32 v4, 2, v3
    v_xor_b32 v4, v4, v2
    v_lshlrev_b32 v4, 4, v4
    v_lshl_add_u32 v4, v2, 8, v4
    v_add_u32 v4, s51, v4
    v_xor_b32 v5, 16, v4
    v_xor_b32 v6, 32, v4
    v_xor_b32 v7, 48, v4
    v_add_u32 v12, 131072, v12
    v_and_b32 v13, 1, v1
    v_lshlrev_b32 v14, 4, v13
    v_lshl_add_u32 v15, v3, 5, v14
    v_lshrrev_b32 v2, 1, v2
    v_lshl_add_u32 v15, v2, 15, v15
    s_mov_b32 s38, 0xffff
    v_lshlrev_b32 v14, v14, s38
    v_cmp_eq_u32 s[56:57], 1, v13
    s_lshl_b32 s49, s35, 10
    s_lshl_b32 s38, s63, 7
    s_add_u32 s49, s49, s38
    s_add_u32 s49, s49, 65536
    s_waitcnt vmcnt(0)
    ds_read_b128 v[104:107], v4 offset:0
    ds_read_b128 v[108:111], v5 offset:0
    ds_read_b128 v[112:115], v6 offset:0
    ds_read_b128 v[116:119], v7 offset:0
    s_waitcnt lgkmcnt(0)
    ds_read_b128 v[120:123], v4 offset:4096
    ds_read_b128 v[124:127], v5 offset:4096
    ds_read_b128 v[128:131], v6 offset:4096
    ds_read_b128 v[132:135], v7 offset:4096
    s_waitcnt lgkmcnt(0)
    ds_read_b128 v[136:139], v4 offset:8192
    ds_read_b128 v[140:143], v5 offset:8192
    ds_read_b128 v[144:147], v6 offset:8192
    ds_read_b128 v[148:151], v7 offset:8192
    s_waitcnt lgkmcnt(0)
    ds_read_b128 v[152:155], v4 offset:12288
    ds_read_b128 v[156:159], v5 offset:12288
    ds_read_b128 v[160:163], v6 offset:12288
    ds_read_b128 v[164:167], v7 offset:12288
    s_waitcnt lgkmcnt(0)
    s_setprio 2
    v_mov_b32 v5, 1
    s_mov_b64 exec, 1
    ds_add_u32 v0, v5 offset:3028
    s_mov_b64 exec, -1
L_w53:
    ds_read_b32 v5, v0 offset:4
    s_sub_u32 s3, s3, 1
    s_cbranch_scc1 L_end
    s_waitcnt lgkmcnt(0)
    v_cmp_gt_u32 vcc, 4, v5
    s_cbranch_vccnz L_w53
    v_lshlrev_b32 v32, 4, v1
    s_mov_b64 exec, 0xffff
    buffer_store_dwordx4 v[8:11], v32, s[40:43], s53 offen sc1
    s_mov_b64 exec, -1
    buffer_store_dwordx4 v[8:11], v32, s[40:43], s52 offen offset:0 sc1
    buffer_store_dwordx4 v[8:11], v32, s[40:43], s52 offen offset:1024 sc1
    buffer_store_dwordx4 v[8:11], v32, s[40:43], s52 offen offset:2048 sc1
    buffer_store_dwordx4 v[8:11], v32, s[40:43], s52 offen offset:3072 sc1
L_w54:
    ds_read_b32 v5, v0 offset:5040
    s_sub_u32 s3, s3, 1
    s_cbranch_scc1 L_end
    s_waitcnt lgkmcnt(0)
    v_cmp_gt_u32 vcc, 4, v5
    s_cbranch_vccnz L_w54
    s_xor_b32 s38, s2, 8
    s_or_b32 s38, s38, s33
    s_cbranch_scc1 L_C_f2
    v_mov_b32 v5, 0
    s_mov_b64 exec, 1
    global_store_dword v5, v8, s[28:29] offset:128 sc1
    s_mov_b64 exec, -1
L_C_f2:
    ds_read_b128 v[40:43], v12 offset:0
    ds_read_b128 v[44:47], v12 offset:4096
    ds_read_b128 v[48:51], v12 offset:8192
    ds_read_b128 v[52:55], v12 offset:12288
    ds_read_b128 v[56:59], v12 offset:1024
    ds_read_b128 v[60:63], v12 offset:5120
    ds_read_b128 v[64:67], v12 offset:9216
    ds_read_b128 v[68:71], v12 offset:13312
    ds_read_b128 v[72:75], v12 offset:2048
    ds_read_b128 v[76:79], v12 offset:6144
    ds_read_b128 v[80:83], v12 offset:10240
    ds_read_b128 v[84:87], v12 offset:14336
    s_waitcnt lgkmcnt(8)
    ds_read_b128 v[88:91], v12 offset:3072
    ds_read_b128 v[92:95], v12 offset:7168
    ds_read_b128 v[96:99], v12 offset:11264
    ds_read_b128 v[100:103], v12 offset:15360
    s_waitcnt lgkmcnt(12)
    v_pk_add_f32 v[40:41], v[40:41], v[44:45]
    v_pk_add_f32 v[48:49], v[48:49], v[52:53]
    v_pk_add_f32 v[42:43], v[42:43], v[46:47]
    v_pk_add_f32 v[50:51], v[50:51], v[54:55]
    v_pk_add_f32 v[40:41], v[40:41], v[48:49]
    v_pk_add_f32 v[42:43], v[42:43], v[50:51]
    v_cvt_pk_bf16_f32 v40, v40, v40
    v_cvt_pk_bf16_f32 v41, v41, v41
    v_cvt_pk_bf16_f32 v42, v42, v42
    v_cvt_pk_bf16_f32 v43, v43, v43
    v_and_b32 v16, v40, v14
    v_and_b32 v20, v41, v14
    v_and_b32 v24, v42, v14
    v_and_b32 v28, v43, v14
    s_waitcnt lgkmcnt(8)
    v_pk_add_f32 v[56:57], v[56:57], v[60:61]
    v_pk_add_f32 v[64:65], v[64:65], v[68:69]
    v_pk_add_f32 v[58:59], v[58:59], v[62:63]
    v_pk_add_f32 v[66:67], v[66:67], v[70:71]
    v_pk_add_f32 v[56:57], v[56:57], v[64:65]
    v_pk_add_f32 v[58:59], v[58:59], v[66:67]
    v_cvt_pk_bf16_f32 v56, v56, v56
    v_cvt_pk_bf16_f32 v57, v57, v57
    v_cvt_pk_bf16_f32 v58, v58, v58
    v_cvt_pk_bf16_f32 v59, v59, v59
    v_and_b32 v17, v56, v14
    v_and_b32 v21, v57, v14
    v_and_b32 v25, v58, v14
    v_and_b32 v29, v59, v14
    s_waitcnt lgkmcnt(4)
    v_pk_add_f32 v[72:73], v[72:73], v[76:77]
    v_pk_add_f32 v[80:81], v[80:81], v[84:85]
    v_pk_add_f32 v[74:75], v[74:75], v[78:79]
    v_pk_add_f32 v[82:83], v[82:83], v[86:87]
    v_pk_add_f32 v[72:73], v[72:73], v[80:81]
    v_pk_add_f32 v[74:75], v[74:75], v[82:83]
    v_cvt_pk_bf16_f32 v72, v72, v72
    v_cvt_pk_bf16_f32 v73, v73, v73
    v_cvt_pk_bf16_f32 v74, v74, v74
    v_cvt_pk_bf16_f32 v75, v75, v75
    v_and_b32 v18, v72, v14
    v_and_b32 v22, v73, v14
    v_and_b32 v26, v74, v14
    v_and_b32 v30, v75, v14
    s_waitcnt lgkmcnt(0)
    v_pk_add_f32 v[88:89], v[88:89], v[92:93]
    v_pk_add_f32 v[96:97], v[96:97], v[100:101]
    v_pk_add_f32 v[90:91], v[90:91], v[94:95]
    v_pk_add_f32 v[98:99], v[98:99], v[102:103]
    v_pk_add_f32 v[88:89], v[88:89], v[96:97]
    v_pk_add_f32 v[90:91], v[90:91], v[98:99]
    v_cvt_pk_bf16_f32 v88, v88, v88
    v_cvt_pk_bf16_f32 v89, v89, v89
    v_cvt_pk_bf16_f32 v90, v90, v90
    v_cvt_pk_bf16_f32 v91, v91, v91
    v_and_b32 v19, v88, v14
    v_and_b32 v23, v89, v14
    v_and_b32 v27, v90, v14
    v_and_b32 v31, v91, v14
    v_mfma_f32_16x16x32_bf16 v[40:43], v[104:107], v[16:19], 0
    v_mfma_f32_16x16x32_bf16 v[44:47], v[120:123], v[16:19], 0
    v_mfma_f32_16x16x32_bf16 v[48:51], v[136:139], v[16:19], 0
    v_mfma_f32_16x16x32_bf16 v[52:55], v[152:155], v[16:19], 0
    v_mfma_f32_16x16x32_bf16 v[40:43], v[108:111], v[20:23], v[40:43]
    v_mfma_f32_16x16x32_bf16 v[44:47], v[124:127], v[20:23], v[44:47]
    v_mfma_f32_16x16x32_bf16 v[48:51], v[140:143], v[20:23], v[48:51]
    v_mfma_f32_16x16x32_bf16 v[52:55], v[156:159], v[20:23], v[52:55]
    v_mfma_f32_16x16x32_bf16 v[40:43], v[112:115], v[24:27], v[40:43]
    v_mfma_f32_16x16x32_bf16 v[44:47], v[128:131], v[24:27], v[44:47]
    v_mfma_f32_16x16x32_bf16 v[48:51], v[144:147], v[24:27], v[48:51]
    v_mfma_f32_16x16x32_bf16 v[52:55], v[160:163], v[24:27], v[52:55]
    v_mfma_f32_16x16x32_bf16 v[40:43], v[116:119], v[28:31], v[40:43]
    v_mfma_f32_16x16x32_bf16 v[44:47], v[132:135], v[28:31], v[44:47]
    v_mfma_f32_16x16x32_bf16 v[48:51], v[148:151], v[28:31], v[48:51]
    v_mfma_f32_16x16x32_bf16 v[52:55], v[164:167], v[28:31], v[52:55]
    s_nop 4
    v_add_f32_dpp v40, v40, v40 quad_perm:[1,0,3,2] row_mask:0xf bank_mask:0xf
    v_add_f32_dpp v41, v41, v41 quad_perm:[1,0,3,2] row_mask:0xf bank_mask:0xf
    v_add_f32_dpp v42, v42, v42 quad_perm:[1,0,3,2] row_mask:0xf bank_mask:0xf
    v_add_f32_dpp v43, v43, v43 quad_perm:[1,0,3,2] row_mask:0xf bank_mask:0xf
    v_add_f32_dpp v44, v44, v44 quad_perm:[1,0,3,2] row_mask:0xf bank_mask:0xf
    v_add_f32_dpp v45, v45, v45 quad_perm:[1,0,3,2] row_mask:0xf bank_mask:0xf
    v_add_f32_dpp v46, v46, v46 quad_perm:[1,0,3,2] row_mask:0xf bank_mask:0xf
    v_add_f32_dpp v47, v47, v47 quad_perm:[1,0,3,2] row_mask:0xf bank_mask:0xf
    v_add_f32_dpp v48, v48, v48 quad_perm:[1,0,3,2] row_mask:0xf bank_mask:0xf
    v_add_f32_dpp v49, v49, v49 quad_perm:[1,0,3,2] row_mask:0xf bank_mask:0xf
    v_add_f32_dpp v50, v50, v50 quad_perm:[1,0,3,2] row_mask:0xf bank_mask:0xf
    v_add_f32_dpp v51, v51, v51 quad_perm:[1,0,3,2] row_mask:0xf bank_mask:0xf
    v_add_f32_dpp v52, v52, v52 quad_perm:[1,0,3,2] row_mask:0xf bank_mask:0xf
    v_add_f32_dpp v53, v53, v53 quad_perm:[1,0,3,2] row_mask:0xf bank_mask:0xf
    v_add_f32_dpp v54, v54, v54 quad_perm:[1,0,3,2] row_mask:0xf bank_mask:0xf
    v_add_f32_dpp v55, v55, v55 quad_perm:[1,0,3,2] row_mask:0xf bank_mask:0xf
    v_cndmask_b32 v40, v40, v48, s[56:57]
    v_cndmask_b32 v41, v41, v49, s[56:57]
    v_cndmask_b32 v42, v42, v50, s[56:57]
    v_cndmask_b32 v43, v43, v51, s[56:57]
    v_cndmask_b32 v44, v44, v52, s[56:57]
    v_cndmask_b32 v45, v45, v53, s[56:57]
    v_cndmask_b32 v46, v46, v54, s[56:57]
    v_cndmask_b32 v47, v47, v55, s[56:57]
    v_cvt_pk_bf16_f32 v40, v40, v41
    v_cvt_pk_bf16_f32 v41, v42, v43
    v_cvt_pk_bf16_f32 v42, v44, v45
    v_cvt_pk_bf16_f32 v43, v46, v47
    s_waitcnt vmcnt(0)
    buffer_store_dwordx4 v[40:43], v15, s[40:43], s49 offen sc1
L_C_qs:
    v_mov_b32 v5, 1
    s_mov_b64 exec, 1
    ds_add_u32 v0, v5 offset:5044
    s_mov_b64 exec, -1
    s_branch L_C_o
L_C_qh:
L_C_o:
    s_setprio 0
    v_and_b32 v5, 15, v1
    s_mov_b32 s44, s14
    s_mov_b32 s45, s15
    s_mov_b32 s46, 4194304
    s_mov_b32 s47, 0x20000
    v_and_b32 v16, 1, v1
    v_lshlrev_b32 v16, 4, v16
    s_mov_b32 s38, 0xffff
    v_lshlrev_b32 v16, v16, s38
    v_bfe_u32 v17, v1, 1, 2
    v_cmp_eq_u32 vcc, 0, v17
    s_nop 1
    v_cndmask_b32 v20, 0, v16, vcc
    v_cmp_eq_u32 vcc, 1, v17
    s_nop 1
    v_cndmask_b32 v21, 0, v16, vcc
    v_cmp_eq_u32 vcc, 2, v17
    s_nop 1
    v_cndmask_b32 v22, 0, v16, vcc
    v_cmp_eq_u32 vcc, 3, v17
    s_nop 1
    v_cndmask_b32 v23, 0, v16, vcc

    s_mov_b32 s38, 0x3f803f80
    v_and_b32 v20, s38, v20
    v_and_b32 v21, s38, v21
    v_and_b32 v22, s38, v22
    v_and_b32 v23, s38, v23
    v_lshrrev_b32 v4, 4, v1
    v_lshlrev_b32 v7, 11, v4
    v_lshl_add_u32 v7, v5, 4, v7
    s_and_b32 s52, s35, 23
    s_lshr_b32 s38, s33, 1
    s_lshl3_add_u32 s52, s38, s52
    s_and_b32 s39, s33, 1
    s_lshl3_add_u32 s50, s52, s39
    s_lshl_b32 s50, s50, 10
    s_add_u32 s50, s50, 1835008
    s_lshl1_add_u32 s48, s52, s39
    s_lshl_b32 s48, s48, 16
    s_and_b32 s53, s37, 1
    s_lshl2_add_u32 s53, s53, s62
    s_lshl_b32 s38, s53, 7
    s_add_u32 s48, s48, s38
    s_lshr_b32 s39, s37, 1
    s_lshl3_add_u32 s39, s39, s36
    s_lshl_b32 s49, s39, 10
    s_add_u32 s49, s49, s38
    s_add_u32 s49, s49, 1572864
    s_add_u32 s51, s49, 32768
    s_lshl4_add_u32 s60, s53, s39
    s_lshl_b32 s60, s60, 7
    s_add_u32 s60, s60, 983040
    v_and_b32 v12, 1, v4
    v_lshrrev_b32 v13, 1, v4
    v_lshl_add_u32 v12, v12, 1, v13
    v_mul_u32_u24 v12, 272, v12
    v_lshl_add_u32 v12, v5, 4, v12
    s_mul_i32 s38, s33, 4352
    v_add_u32 v18, s38, v12
    v_lshlrev_b32 v13, 4, v13
    v_mul_u32_u24 v3, 272, v5
    v_lshl_add_u32 v3, v4, 4, v3
    v_add_u32 v3, s38, v3
    s_mov_b32 s38, 0xffff
    v_lshlrev_b32 v19, v13, s38
    v_lshlrev_b32 v2, 12, v4
    v_lshl_add_u32 v2, v5, 3, v2
    v_lshlrev_b32 v4, 16, v4
    v_lshl_add_u32 v4, v5, 3, v4
    s_lshl_b32 s38, s33, 11
    s_add_u32 s38, s38, 32768
    v_lshl_add_u32 v17, v1, 4, s38
L_w55:
    s_sleep 1
    ds_read_b32 v6, v0 offset:5048
    s_sub_u32 s3, s3, 1
    s_cbranch_scc1 L_end
    s_waitcnt lgkmcnt(0)
    v_cmp_gt_u32 vcc, 4, v6
    s_cbranch_vccnz L_w55
    s_add_u32 s39, s48, 0
    buffer_load_dwordx2 v[104:105], v2, s[44:47], s39 offen nt
    s_add_u32 s39, s48, 1024
    buffer_load_dwordx2 v[108:109], v2, s[44:47], s39 offen nt
    s_add_u32 s39, s48, 2048
    buffer_load_dwordx2 v[106:107], v2, s[44:47], s39 offen nt
    s_add_u32 s39, s48, 3072
    buffer_load_dwordx2 v[110:111], v2, s[44:47], s39 offen nt
    s_add_u32 s39, s48, 16384
    buffer_load_dwordx2 v[112:113], v2, s[44:47], s39 offen nt
    s_add_u32 s39, s48, 17408
    buffer_load_dwordx2 v[116:117], v2, s[44:47], s39 offen nt
    s_add_u32 s39, s48, 18432
    buffer_load_dwordx2 v[114:115], v2, s[44:47], s39 offen nt
    s_add_u32 s39, s48, 19456
    buffer_load_dwordx2 v[118:119], v2, s[44:47], s39 offen nt
    s_add_u32 s39, s48, 32768
    buffer_load_dwordx2 v[120:121], v2, s[44:47], s39 offen nt
    s_add_u32 s39, s48, 33792
    buffer_load_dwordx2 v[124:125], v2, s[44:47], s39 offen nt
    s_add_u32 s39, s48, 34816
    buffer_load_dwordx2 v[122:123], v2, s[44:47], s39 offen nt
    s_add_u32 s39, s48, 35840
    buffer_load_dwordx2 v[126:127], v2, s[44:47], s39 offen nt
    s_add_u32 s39, s48, 49152
    buffer_load_dwordx2 v[128:129], v2, s[44:47], s39 offen nt
    s_add_u32 s39, s48, 50176
    buffer_load_dwordx2 v[132:133], v2, s[44:47], s39 offen nt
    s_add_u32 s39, s48, 51200
    buffer_load_dwordx2 v[130:131], v2, s[44:47], s39 offen nt
    s_add_u32 s39, s48, 52224
    buffer_load_dwordx2 v[134:135], v2, s[44:47], s39 offen nt
    s_waitcnt vmcnt(0)
    v_mov_b32 v6, 1
    s_mov_b64 exec, 1
    ds_add_u32 v0, v6 offset:6060
    s_mov_b64 exec, -1
    v_swap_b32 v105, v108
    v_swap_b32 v107, v110
    v_swap_b32 v113, v116
    v_swap_b32 v115, v118
    v_swap_b32 v121, v124
    v_swap_b32 v123, v126
    v_swap_b32 v129, v132
    v_swap_b32 v131, v134
L_w56:
    s_sleep 1
    ds_read_b32 v6, v0 offset:6048
    s_sub_u32 s3, s3, 1
    s_cbranch_scc1 L_end
    s_waitcnt lgkmcnt(0)
    v_cmp_gt_u32 vcc, 4, v6
    s_cbranch_vccnz L_w56
    s_setprio 2
L_w57:
    ds_read_b32 v6, v0 offset:6052
    s_sub_u32 s3, s3, 1
    s_cbranch_scc1 L_end
    s_waitcnt lgkmcnt(0)
    v_cmp_gt_u32 vcc, 2, v6
    s_cbranch_vccnz L_w57
L_C_x:
    buffer_load_dwordx4 v[40:43], v7, s[40:43], s50 offen offset:0 sc1
    buffer_load_dwordx4 v[44:47], v7, s[40:43], s50 offen offset:256 sc1
    buffer_load_dwordx4 v[48:51], v7, s[40:43], s50 offen offset:512 sc1
    buffer_load_dwordx4 v[52:55], v7, s[40:43], s50 offen offset:768 sc1
    s_sub_u32 s3, s3, 1
    s_cbranch_scc1 L_end
    s_mov_b64 exec, -1
    s_waitcnt vmcnt(3)
    v_mfma_f32_16x16x32_bf16 v[56:59], v[20:23], v[40:43], 0
    s_waitcnt vmcnt(2)
    v_mfma_f32_16x16x32_bf16 v[60:63], v[20:23], v[44:47], 0
    s_waitcnt vmcnt(1)
    v_mfma_f32_16x16x32_bf16 v[64:67], v[20:23], v[48:51], 0
    s_waitcnt vmcnt(0)
    v_mfma_f32_16x16x32_bf16 v[68:71], v[20:23], v[52:55], 0
    v_max3_u32 v12, v40, v41, v42
    v_max3_u32 v12, v12, v43, v44
    v_max3_u32 v12, v12, v45, v46
    v_max3_u32 v12, v12, v47, v48
    v_max3_u32 v12, v12, v49, v50
    v_max3_u32 v12, v12, v51, v52
    v_max3_u32 v12, v12, v53, v54
    v_max_u32 v12, v12, v55
    v_cmp_eq_u32 vcc, -1, v12
    s_cbranch_vccz L_C_x1
    s_branch L_C_x
L_C_x1:
    v_cvt_pk_bf16_f32 v56, v56, v56
    v_cvt_pk_bf16_f32 v57, v57, v57
    v_cvt_pk_bf16_f32 v58, v58, v58
    v_cvt_pk_bf16_f32 v59, v59, v59
    v_and_b32 v56, v56, v19
    v_and_b32 v57, v57, v19
    v_and_b32 v58, v58, v19
    v_and_b32 v59, v59, v19
    ds_write_b128 v18, v[56:59] offset:0
    v_cvt_pk_bf16_f32 v60, v60, v60
    v_cvt_pk_bf16_f32 v61, v61, v61
    v_cvt_pk_bf16_f32 v62, v62, v62
    v_cvt_pk_bf16_f32 v63, v63, v63
    v_and_b32 v60, v60, v19
    v_and_b32 v61, v61, v19
    v_and_b32 v62, v62, v19
    v_and_b32 v63, v63, v19
    ds_write_b128 v18, v[60:63] offset:1088
    v_cvt_pk_bf16_f32 v64, v64, v64
    v_cvt_pk_bf16_f32 v65, v65, v65
    v_cvt_pk_bf16_f32 v66, v66, v66
    v_cvt_pk_bf16_f32 v67, v67, v67
    v_and_b32 v64, v64, v19
    v_and_b32 v65, v65, v19
    v_and_b32 v66, v66, v19
    v_and_b32 v67, v67, v19
    ds_write_b128 v18, v[64:67] offset:2176
    v_cvt_pk_bf16_f32 v68, v68, v68
    v_cvt_pk_bf16_f32 v69, v69, v69
    v_cvt_pk_bf16_f32 v70, v70, v70
    v_cvt_pk_bf16_f32 v71, v71, v71
    v_and_b32 v68, v68, v19
    v_and_b32 v69, v69, v19
    v_and_b32 v70, v70, v19
    v_and_b32 v71, v71, v19
    ds_write_b128 v18, v[68:71] offset:3264
    ds_read_b128 v[40:43], v3 offset:0
    ds_read_b128 v[44:47], v3 offset:64
    ds_read_b128 v[48:51], v3 offset:128
    ds_read_b128 v[52:55], v3 offset:192
    s_waitcnt lgkmcnt(3)
    v_mfma_f32_16x16x32_bf16 v[24:27], v[40:43], v[104:107], 0
    v_mfma_f32_16x16x32_bf16 v[28:31], v[40:43], v[108:111], 0
    s_waitcnt lgkmcnt(2)
    v_mfma_f32_16x16x32_bf16 v[24:27], v[44:47], v[112:115], v[24:27]
    v_mfma_f32_16x16x32_bf16 v[28:31], v[44:47], v[116:119], v[28:31]
    s_waitcnt lgkmcnt(1)
    v_mfma_f32_16x16x32_bf16 v[24:27], v[48:51], v[120:123], v[24:27]
    v_mfma_f32_16x16x32_bf16 v[28:31], v[48:51], v[124:127], v[28:31]
    s_waitcnt lgkmcnt(0)
    v_mfma_f32_16x16x32_bf16 v[24:27], v[52:55], v[128:131], v[24:27]
    v_mfma_f32_16x16x32_bf16 v[28:31], v[52:55], v[132:135], v[28:31]
    s_cmp_eq_u32 s33, 0
    s_cbranch_scc1 L_C_o2
    s_nop 4
    ds_write_b128 v17, v[24:27]
    ds_write_b128 v17, v[28:31] offset:1024
    v_mov_b32 v6, 1
    s_mov_b64 exec, 1
    ds_add_u32 v0, v6 offset:6056
    s_mov_b64 exec, -1
L_w58:
    ds_read_b32 v6, v0 offset:6056
    s_sub_u32 s3, s3, 1
    s_cbranch_scc1 L_end
    s_waitcnt lgkmcnt(0)
    v_cmp_gt_u32 vcc, 3, v6
    s_cbranch_vccnz L_w58
    s_cmp_lg_u32 s33, 2
    s_cbranch_scc1 L_C_nh
    v_lshlrev_b32 v12, 14, v1
    s_mov_b64 exec, 15
    buffer_store_dword v12, v12, s[40:43], s60 offen sc1
    s_mov_b64 exec, -1
L_C_nh:
    s_branch L_end
L_C_o2:
L_w59:
    ds_read_b32 v6, v0 offset:6056
    s_sub_u32 s3, s3, 1
    s_cbranch_scc1 L_end
    s_waitcnt lgkmcnt(0)
    v_cmp_gt_u32 vcc, 3, v6
    s_cbranch_vccnz L_w59
    ds_read_b128 v[40:43], v17 offset:2048
    ds_read_b128 v[44:47], v17 offset:3072
    ds_read_b128 v[48:51], v17 offset:4096
    ds_read_b128 v[52:55], v17 offset:5120
    ds_read_b128 v[56:59], v17 offset:6144
    ds_read_b128 v[60:63], v17 offset:7168
    s_waitcnt lgkmcnt(4)
    v_pk_add_f32 v[24:25], v[24:25], v[40:41]
    v_pk_add_f32 v[26:27], v[26:27], v[42:43]
    v_pk_add_f32 v[28:29], v[28:29], v[44:45]
    v_pk_add_f32 v[30:31], v[30:31], v[46:47]
    s_waitcnt lgkmcnt(2)
    v_pk_add_f32 v[24:25], v[24:25], v[48:49]
    v_pk_add_f32 v[26:27], v[26:27], v[50:51]
    v_pk_add_f32 v[28:29], v[28:29], v[52:53]
    v_pk_add_f32 v[30:31], v[30:31], v[54:55]
    s_waitcnt lgkmcnt(0)
    v_pk_add_f32 v[24:25], v[24:25], v[56:57]
    v_pk_add_f32 v[26:27], v[26:27], v[58:59]
    v_pk_add_f32 v[28:29], v[28:29], v[60:61]
    v_pk_add_f32 v[30:31], v[30:31], v[62:63]
    v_cvt_pk_bf16_f32 v8, v24, v25
    v_cvt_pk_bf16_f32 v9, v28, v29
    v_cvt_pk_bf16_f32 v10, v26, v27
    v_cvt_pk_bf16_f32 v11, v30, v31
    buffer_store_dwordx2 v[8:9], v4, s[40:43], s49 offen sc1
    buffer_store_dwordx2 v[10:11], v4, s[40:43], s51 offen sc1
    s_branch L_end
L_C_at:

    v_lshrrev_b32 v7, 5, v1
    v_bfe_u32 v2, v1, 2, 2
    v_lshl_add_u32 v3, v7, 2, v2
    v_lshrrev_b32 v2, 1, v2
    v_lshl_or_b32 v2, v2, 2, v7
    v_bfe_u32 v4, v1, 4, 1
    v_bfe_u32 v5, v1, 1, 1
    v_lshl_or_b32 v4, v4, 1, v5
    v_xor_b32 v2, v2, v4
    v_lshlrev_b32 v2, 4, v2
    v_lshl_add_u32 v2, v3, 7, v2
    v_and_b32 v3, 1, v1
    v_lshl_add_u32 v2, v3, 3, v2
    s_and_b32 s38, s33, 1
    s_lshl_b32 s38, s38, 6
    s_lshr_b32 s39, s33, 1
    s_lshl_b32 s39, s39, 14
    s_or_b32 s38, s38, s39
    v_xor_b32 v2, s38, v2
    v_xor_b32 v3, 1056, v2
    v_lshlrev_b32 v4, 4, v1
    v_add_u32 v4, 131072, v4
    s_waitcnt vmcnt(0)
L_w460:
    s_sleep 1
    ds_read_b128 v[8:11], v0 offset:4032
    s_sub_u32 s3, s3, 1
    s_cbranch_scc1 L_end
    s_waitcnt lgkmcnt(0)
    v_min3_u32 v8, v8, v9, v10
    v_min_u32 v8, v8, v11
    v_cmp_gt_u32 vcc, 2, v8
    s_cbranch_vccnz L_w460
    ds_read_b64_tr_b16 v[40:41], v2 offset:0
    ds_read_b64_tr_b16 v[42:43], v3 offset:0
    ds_read_b64_tr_b16 v[44:45], v2 offset:2048
    ds_read_b64_tr_b16 v[46:47], v3 offset:2048
    ds_read_b64_tr_b16 v[48:49], v2 offset:4096
    ds_read_b64_tr_b16 v[50:51], v3 offset:4096
    ds_read_b64_tr_b16 v[52:53], v2 offset:6144
    ds_read_b64_tr_b16 v[54:55], v3 offset:6144
    ds_read_b64_tr_b16 v[56:57], v2 offset:8192
    ds_read_b64_tr_b16 v[58:59], v3 offset:8192
    ds_read_b64_tr_b16 v[60:61], v2 offset:10240
    ds_read_b64_tr_b16 v[62:63], v3 offset:10240
    s_waitcnt lgkmcnt(6)
    ds_read_b64_tr_b16 v[64:65], v2 offset:12288
    ds_read_b64_tr_b16 v[66:67], v3 offset:12288
    ds_read_b64_tr_b16 v[68:69], v2 offset:14336
    ds_read_b64_tr_b16 v[70:71], v3 offset:14336
    v_mov_b32 v5, 1
    s_mov_b64 exec, 1
    ds_add_u32 v0, v5 offset:3024
    s_mov_b64 exec, -1
L_w461:
    s_sleep 1
    ds_read_b128 v[8:11], v0 offset:4032
    s_sub_u32 s3, s3, 1
    s_cbranch_scc1 L_end
    s_waitcnt lgkmcnt(0)
    v_min3_u32 v8, v8, v9, v10
    v_min_u32 v8, v8, v11
    v_cmp_gt_u32 vcc, 4, v8
    s_cbranch_vccnz L_w461
    ds_read_b64_tr_b16 v[72:73], v2 offset:32768
    ds_read_b64_tr_b16 v[74:75], v3 offset:32768
    ds_read_b64_tr_b16 v[76:77], v2 offset:34816
    ds_read_b64_tr_b16 v[78:79], v3 offset:34816
    ds_read_b64_tr_b16 v[80:81], v2 offset:36864
    ds_read_b64_tr_b16 v[82:83], v3 offset:36864
    ds_read_b64_tr_b16 v[84:85], v2 offset:38912
    ds_read_b64_tr_b16 v[86:87], v3 offset:38912
    ds_read_b64_tr_b16 v[88:89], v2 offset:40960
    ds_read_b64_tr_b16 v[90:91], v3 offset:40960
    ds_read_b64_tr_b16 v[92:93], v2 offset:43008
    ds_read_b64_tr_b16 v[94:95], v3 offset:43008
    s_waitcnt lgkmcnt(6)
    ds_read_b64_tr_b16 v[96:97], v2 offset:45056
    ds_read_b64_tr_b16 v[98:99], v3 offset:45056
    ds_read_b64_tr_b16 v[100:101], v2 offset:47104
    ds_read_b64_tr_b16 v[102:103], v3 offset:47104
    v_mov_b32 v5, 1
    s_mov_b64 exec, 1
    ds_add_u32 v0, v5 offset:3028
    s_mov_b64 exec, -1
L_w462:
    s_sleep 1
    ds_read_b128 v[8:11], v0 offset:4032
    s_sub_u32 s3, s3, 1
    s_cbranch_scc1 L_end
    s_waitcnt lgkmcnt(0)
    v_min3_u32 v8, v8, v9, v10
    v_min_u32 v8, v8, v11
    v_cmp_gt_u32 vcc, 6, v8
    s_cbranch_vccnz L_w462
    v_add_u32 v2, 0x10000, v2
    v_add_u32 v3, 0x10000, v3
    ds_read_b64_tr_b16 v[104:105], v2 offset:0
    ds_read_b64_tr_b16 v[106:107], v3 offset:0
    ds_read_b64_tr_b16 v[108:109], v2 offset:2048
    ds_read_b64_tr_b16 v[110:111], v3 offset:2048
    ds_read_b64_tr_b16 v[112:113], v2 offset:4096
    ds_read_b64_tr_b16 v[114:115], v3 offset:4096
    ds_read_b64_tr_b16 v[116:117], v2 offset:6144
    ds_read_b64_tr_b16 v[118:119], v3 offset:6144
    ds_read_b64_tr_b16 v[120:121], v2 offset:8192
    ds_read_b64_tr_b16 v[122:123], v3 offset:8192
    ds_read_b64_tr_b16 v[124:125], v2 offset:10240
    ds_read_b64_tr_b16 v[126:127], v3 offset:10240
    s_waitcnt lgkmcnt(6)
    ds_read_b64_tr_b16 v[128:129], v2 offset:12288
    ds_read_b64_tr_b16 v[130:131], v3 offset:12288
    ds_read_b64_tr_b16 v[132:133], v2 offset:14336
    ds_read_b64_tr_b16 v[134:135], v3 offset:14336
    v_mov_b32 v5, 1
    s_mov_b64 exec, 1
    ds_add_u32 v0, v5 offset:3032
    s_mov_b64 exec, -1
L_w463:
    s_sleep 1
    ds_read_b128 v[8:11], v0 offset:4032
    s_sub_u32 s3, s3, 1
    s_cbranch_scc1 L_end
    s_waitcnt lgkmcnt(0)
    v_min3_u32 v8, v8, v9, v10
    v_min_u32 v8, v8, v11
    v_cmp_gt_u32 vcc, 8, v8
    s_cbranch_vccnz L_w463
    ds_read_b64_tr_b16 v[136:137], v2 offset:32768
    ds_read_b64_tr_b16 v[138:139], v3 offset:32768
    ds_read_b64_tr_b16 v[140:141], v2 offset:34816
    ds_read_b64_tr_b16 v[142:143], v3 offset:34816
    ds_read_b64_tr_b16 v[144:145], v2 offset:36864
    ds_read_b64_tr_b16 v[146:147], v3 offset:36864
    ds_read_b64_tr_b16 v[148:149], v2 offset:38912
    ds_read_b64_tr_b16 v[150:151], v3 offset:38912
    ds_read_b64_tr_b16 v[152:153], v2 offset:40960
    ds_read_b64_tr_b16 v[154:155], v3 offset:40960
    ds_read_b64_tr_b16 v[156:157], v2 offset:43008
    ds_read_b64_tr_b16 v[158:159], v3 offset:43008
    s_waitcnt lgkmcnt(6)
    ds_read_b64_tr_b16 v[160:161], v2 offset:45056
    ds_read_b64_tr_b16 v[162:163], v3 offset:45056
    ds_read_b64_tr_b16 v[164:165], v2 offset:47104
    ds_read_b64_tr_b16 v[166:167], v3 offset:47104
    v_mov_b32 v5, 1
    s_mov_b64 exec, 1
    ds_add_u32 v0, v5 offset:3036
    s_mov_b64 exec, -1
    v_subrev_u32 v2, 0x10000, v2
    v_subrev_u32 v3, 0x10000, v3
L_w64:
    s_sleep 2
    ds_read_b32 v5, v0 offset:1008
    s_sub_u32 s3, s3, 1
    s_cbranch_scc1 L_end
    s_waitcnt lgkmcnt(0)
    v_cmp_gt_u32 vcc, 4, v5
    s_cbranch_vccnz L_w64
    s_setprio 1
L_w65:
    s_sleep 1
    ds_read_b32 v5, v0 offset:1016
    s_sub_u32 s3, s3, 1
    s_cbranch_scc1 L_end
    s_waitcnt lgkmcnt(0)
    v_cmp_gt_u32 vcc, 1, v5
    s_cbranch_vccnz L_w65
L_w66:
    ds_read_b32 v5, v0 offset:1016
    s_sub_u32 s3, s3, 1
    s_cbranch_scc1 L_end
    s_waitcnt lgkmcnt(0)
    v_cmp_gt_u32 vcc, 4, v5
    s_cbranch_vccnz L_w66
    ds_read_b128 v[24:27], v4 offset:0
    ds_read_b128 v[28:31], v4 offset:1024
    ds_read_b128 v[32:35], v4 offset:2048
    ds_read_b128 v[36:39], v4 offset:3072
    s_waitcnt lgkmcnt(3)
    v_mfma_f32_32x32x16_bf16 v[8:23], v[24:27], v[40:43], 0
    ds_read_b128 v[24:27], v4 offset:4096
    s_waitcnt lgkmcnt(3)
    v_mfma_f32_32x32x16_bf16 v[8:23], v[28:31], v[44:47], v[8:23]
    ds_read_b128 v[28:31], v4 offset:5120
    s_waitcnt lgkmcnt(3)
    v_mfma_f32_32x32x16_bf16 v[8:23], v[32:35], v[48:51], v[8:23]
    ds_read_b128 v[32:35], v4 offset:6144
    s_waitcnt lgkmcnt(3)
    v_mfma_f32_32x32x16_bf16 v[8:23], v[36:39], v[52:55], v[8:23]
    ds_read_b128 v[36:39], v4 offset:7168
    s_waitcnt lgkmcnt(3)
    v_mfma_f32_32x32x16_bf16 v[8:23], v[24:27], v[56:59], v[8:23]
    ds_read_b128 v[24:27], v4 offset:0
    s_waitcnt lgkmcnt(3)
    v_mfma_f32_32x32x16_bf16 v[8:23], v[28:31], v[60:63], v[8:23]
    ds_read_b128 v[28:31], v4 offset:1024
    s_waitcnt lgkmcnt(3)
    v_mfma_f32_32x32x16_bf16 v[8:23], v[32:35], v[64:67], v[8:23]
    ds_read_b128 v[32:35], v4 offset:2048
    s_waitcnt lgkmcnt(3)
    v_mfma_f32_32x32x16_bf16 v[8:23], v[36:39], v[68:71], v[8:23]
    ds_read_b128 v[36:39], v4 offset:3072
    s_waitcnt lgkmcnt(3)
    v_mfma_f32_32x32x16_bf16 v[40:55], v[24:27], v[72:75], 0
    ds_read_b128 v[24:27], v4 offset:4096
    s_waitcnt lgkmcnt(3)
    v_mfma_f32_32x32x16_bf16 v[40:55], v[28:31], v[76:79], v[40:55]
    ds_read_b128 v[28:31], v4 offset:5120
    s_waitcnt lgkmcnt(3)
    v_mfma_f32_32x32x16_bf16 v[40:55], v[32:35], v[80:83], v[40:55]
    ds_read_b128 v[32:35], v4 offset:6144
    s_waitcnt lgkmcnt(3)
    v_mfma_f32_32x32x16_bf16 v[40:55], v[36:39], v[84:87], v[40:55]
    ds_read_b128 v[36:39], v4 offset:7168
    s_waitcnt lgkmcnt(3)
    v_mfma_f32_32x32x16_bf16 v[40:55], v[24:27], v[88:91], v[40:55]
    ds_read_b128 v[24:27], v4 offset:0
    s_waitcnt lgkmcnt(3)
    v_mfma_f32_32x32x16_bf16 v[40:55], v[28:31], v[92:95], v[40:55]
    ds_read_b128 v[28:31], v4 offset:1024
    s_waitcnt lgkmcnt(3)
    v_mfma_f32_32x32x16_bf16 v[40:55], v[32:35], v[96:99], v[40:55]
    ds_read_b128 v[32:35], v4 offset:2048
    s_waitcnt lgkmcnt(3)
    v_mfma_f32_32x32x16_bf16 v[40:55], v[36:39], v[100:103], v[40:55]
    ds_read_b128 v[36:39], v4 offset:3072
    s_waitcnt lgkmcnt(3)
    v_mfma_f32_32x32x16_bf16 v[56:71], v[24:27], v[104:107], 0
    ds_read_b128 v[24:27], v4 offset:4096
    s_waitcnt lgkmcnt(3)
    v_mfma_f32_32x32x16_bf16 v[56:71], v[28:31], v[108:111], v[56:71]
    ds_read_b128 v[28:31], v4 offset:5120
    s_waitcnt lgkmcnt(3)
    v_mfma_f32_32x32x16_bf16 v[56:71], v[32:35], v[112:115], v[56:71]
    ds_read_b128 v[32:35], v4 offset:6144
    s_waitcnt lgkmcnt(3)
    v_mfma_f32_32x32x16_bf16 v[56:71], v[36:39], v[116:119], v[56:71]
    ds_read_b128 v[36:39], v4 offset:7168
    s_waitcnt lgkmcnt(3)
    v_mfma_f32_32x32x16_bf16 v[56:71], v[24:27], v[120:123], v[56:71]
    ds_read_b128 v[24:27], v4 offset:0
    s_waitcnt lgkmcnt(3)
    v_mfma_f32_32x32x16_bf16 v[56:71], v[28:31], v[124:127], v[56:71]
    ds_read_b128 v[28:31], v4 offset:1024
    s_waitcnt lgkmcnt(3)
    v_mfma_f32_32x32x16_bf16 v[56:71], v[32:35], v[128:131], v[56:71]
    ds_read_b128 v[32:35], v4 offset:2048
    s_waitcnt lgkmcnt(3)
    v_mfma_f32_32x32x16_bf16 v[56:71], v[36:39], v[132:135], v[56:71]
    ds_read_b128 v[36:39], v4 offset:3072
    s_waitcnt lgkmcnt(3)
    v_mfma_f32_32x32x16_bf16 v[72:87], v[24:27], v[136:139], 0
    ds_read_b128 v[24:27], v4 offset:4096
    s_waitcnt lgkmcnt(3)
    v_mfma_f32_32x32x16_bf16 v[72:87], v[28:31], v[140:143], v[72:87]
    ds_read_b128 v[28:31], v4 offset:5120
    s_waitcnt lgkmcnt(3)
    v_mfma_f32_32x32x16_bf16 v[72:87], v[32:35], v[144:147], v[72:87]
    ds_read_b128 v[32:35], v4 offset:6144
    s_waitcnt lgkmcnt(3)
    v_mfma_f32_32x32x16_bf16 v[72:87], v[36:39], v[148:151], v[72:87]
    ds_read_b128 v[36:39], v4 offset:7168
    s_waitcnt lgkmcnt(3)
    v_mfma_f32_32x32x16_bf16 v[72:87], v[24:27], v[152:155], v[72:87]
    s_waitcnt lgkmcnt(2)
    v_mfma_f32_32x32x16_bf16 v[72:87], v[28:31], v[156:159], v[72:87]
    s_waitcnt lgkmcnt(1)
    v_mfma_f32_32x32x16_bf16 v[72:87], v[32:35], v[160:163], v[72:87]
    s_waitcnt lgkmcnt(0)
    v_mfma_f32_32x32x16_bf16 v[72:87], v[36:39], v[164:167], v[72:87]

    v_lshlrev_b32 v32, 4, v7
    v_add_u32 v32, 147968, v32
    v_bfe_u32 v36, v1, 4, 1
    v_lshrrev_b32 v37, 5, v1
    v_lshl_add_u32 v36, v37, 2, v36
    v_lshlrev_b32 v36, 14, v36
    v_and_b32 v37, 15, v1
    v_lshl_add_u32 v36, v37, 3, v36
    s_lshl_b32 s55, s36, 19
    s_lshl2_add_u32 s38, s97, s33
    s_lshl_b32 s38, s38, 8
    s_add_u32 s55, s55, s38
    s_add_u32 s55, s55, 2097152
    v_lshlrev_b32 v37, 2, v37
    v_add_u32 v37, 149504, v37
    v_mov_b32 v38, -1
    ds_write_b32 v37, v38
L_w467:
    s_sleep 1
    ds_read_b128 v[24:27], v0 offset:4032
    s_sub_u32 s3, s3, 1
    s_cbranch_scc1 L_end
    s_waitcnt lgkmcnt(0)
    v_min3_u32 v24, v24, v25, v26
    v_min_u32 v24, v24, v27
    v_cmp_gt_u32 vcc, 16, v24
    s_cbranch_vccnz L_w467
    ds_read_b64_tr_b16 v[136:137], v2 offset:0
    ds_read_b64_tr_b16 v[138:139], v3 offset:0
    ds_read_b64_tr_b16 v[140:141], v2 offset:2048
    ds_read_b64_tr_b16 v[142:143], v3 offset:2048
    ds_read_b64_tr_b16 v[144:145], v2 offset:4096
    ds_read_b64_tr_b16 v[146:147], v3 offset:4096
    ds_read_b64_tr_b16 v[148:149], v2 offset:6144
    ds_read_b64_tr_b16 v[150:151], v3 offset:6144
L_w68:
    ds_read_b32 v5, v0 offset:1020
    s_sub_u32 s3, s3, 1
    s_cbranch_scc1 L_end
    s_waitcnt lgkmcnt(0)
    v_cmp_gt_u32 vcc, 1, v5
    s_cbranch_vccnz L_w68
    ds_read_b128 v[88:91], v32 offset:0
    ds_read_b128 v[92:95], v32 offset:32
    ds_read_b128 v[96:99], v32 offset:64
    ds_read_b128 v[100:103], v32 offset:96
    s_waitcnt lgkmcnt(0)
    v_pk_mul_f32 v[8:9], v[8:9], v[88:89]
    v_pk_mul_f32 v[10:11], v[10:11], v[90:91]
    v_pk_mul_f32 v[12:13], v[12:13], v[92:93]
    v_pk_mul_f32 v[14:15], v[14:15], v[94:95]
    v_pk_mul_f32 v[16:17], v[16:17], v[96:97]
    v_pk_mul_f32 v[18:19], v[18:19], v[98:99]
    v_pk_mul_f32 v[20:21], v[20:21], v[100:101]
    v_pk_mul_f32 v[22:23], v[22:23], v[102:103]
    v_pk_mul_f32 v[40:41], v[40:41], v[88:89]
    v_pk_mul_f32 v[42:43], v[42:43], v[90:91]
    v_pk_mul_f32 v[44:45], v[44:45], v[92:93]
    v_pk_mul_f32 v[46:47], v[46:47], v[94:95]
    v_pk_mul_f32 v[48:49], v[48:49], v[96:97]
    v_pk_mul_f32 v[50:51], v[50:51], v[98:99]
    v_pk_mul_f32 v[52:53], v[52:53], v[100:101]
    v_pk_mul_f32 v[54:55], v[54:55], v[102:103]
    v_pk_mul_f32 v[56:57], v[56:57], v[88:89]
    v_pk_mul_f32 v[58:59], v[58:59], v[90:91]
    v_pk_mul_f32 v[60:61], v[60:61], v[92:93]
    v_pk_mul_f32 v[62:63], v[62:63], v[94:95]
    v_pk_mul_f32 v[64:65], v[64:65], v[96:97]
    v_pk_mul_f32 v[66:67], v[66:67], v[98:99]
    v_pk_mul_f32 v[68:69], v[68:69], v[100:101]
    v_pk_mul_f32 v[70:71], v[70:71], v[102:103]
    v_pk_mul_f32 v[72:73], v[72:73], v[88:89]
    v_pk_mul_f32 v[74:75], v[74:75], v[90:91]
    v_pk_mul_f32 v[76:77], v[76:77], v[92:93]
    v_pk_mul_f32 v[78:79], v[78:79], v[94:95]
    v_pk_mul_f32 v[80:81], v[80:81], v[96:97]
    v_pk_mul_f32 v[82:83], v[82:83], v[98:99]
    v_pk_mul_f32 v[84:85], v[84:85], v[100:101]
    v_pk_mul_f32 v[86:87], v[86:87], v[102:103]
L_w69:
    ds_read_b32 v5, v0 offset:1016
    s_sub_u32 s3, s3, 1
    s_cbranch_scc1 L_end
    s_waitcnt lgkmcnt(0)
    v_cmp_gt_u32 vcc, 8, v5
    s_cbranch_vccnz L_w69
    s_setprio 3
    ds_read_b128 v[104:107], v4 offset:8192
    ds_read_b128 v[108:111], v4 offset:9216
    ds_read_b128 v[112:115], v4 offset:10240
    ds_read_b128 v[116:119], v4 offset:11264
    ds_read_b128 v[120:123], v4 offset:12288
    ds_read_b128 v[124:127], v4 offset:13312
    ds_read_b128 v[128:131], v4 offset:14336
    ds_read_b128 v[132:135], v4 offset:15360
    ds_read_b64_tr_b16 v[152:153], v2 offset:8192
    ds_read_b64_tr_b16 v[154:155], v3 offset:8192
    s_waitcnt lgkmcnt(9)
    v_mfma_f32_32x32x16_bf16 v[8:23], v[104:107], v[136:139], v[8:23]
    ds_read_b64_tr_b16 v[156:157], v2 offset:10240
    ds_read_b64_tr_b16 v[158:159], v3 offset:10240
    s_waitcnt lgkmcnt(10)
    v_mfma_f32_32x32x16_bf16 v[8:23], v[108:111], v[140:143], v[8:23]
    ds_read_b64_tr_b16 v[160:161], v2 offset:12288
    ds_read_b64_tr_b16 v[162:163], v3 offset:12288
    s_waitcnt lgkmcnt(11)
    v_mfma_f32_32x32x16_bf16 v[8:23], v[112:115], v[144:147], v[8:23]
    ds_read_b64_tr_b16 v[136:137], v2 offset:14336
    ds_read_b64_tr_b16 v[138:139], v3 offset:14336
    s_waitcnt lgkmcnt(12)
    v_mfma_f32_32x32x16_bf16 v[8:23], v[116:119], v[148:151], v[8:23]
    s_waitcnt lgkmcnt(11)
    ds_read_b64_tr_b16 v[140:141], v2 offset:32768
    ds_read_b64_tr_b16 v[142:143], v3 offset:32768
    s_waitcnt lgkmcnt(8)
    v_mfma_f32_32x32x16_bf16 v[8:23], v[120:123], v[152:155], v[8:23]
    ds_read_b64_tr_b16 v[144:145], v2 offset:34816
    ds_read_b64_tr_b16 v[146:147], v3 offset:34816
    s_waitcnt lgkmcnt(8)
    v_mfma_f32_32x32x16_bf16 v[8:23], v[124:127], v[156:159], v[8:23]
    ds_read_b64_tr_b16 v[148:149], v2 offset:36864
    ds_read_b64_tr_b16 v[150:151], v3 offset:36864
    s_waitcnt lgkmcnt(8)
    v_mfma_f32_32x32x16_bf16 v[8:23], v[128:131], v[160:163], v[8:23]
    ds_read_b64_tr_b16 v[152:153], v2 offset:38912
    ds_read_b64_tr_b16 v[154:155], v3 offset:38912
    s_waitcnt lgkmcnt(8)
    v_mfma_f32_32x32x16_bf16 v[8:23], v[132:135], v[136:139], v[8:23]
    ds_read_b64_tr_b16 v[156:157], v2 offset:40960
    ds_read_b64_tr_b16 v[158:159], v3 offset:40960
    s_waitcnt lgkmcnt(8)
    v_mfma_f32_32x32x16_bf16 v[40:55], v[104:107], v[140:143], v[40:55]
    ds_read_b64_tr_b16 v[160:161], v2 offset:43008
    ds_read_b64_tr_b16 v[162:163], v3 offset:43008
    s_waitcnt lgkmcnt(8)
    v_mfma_f32_32x32x16_bf16 v[40:55], v[108:111], v[144:147], v[40:55]
    ds_read_b64_tr_b16 v[136:137], v2 offset:45056
    ds_read_b64_tr_b16 v[138:139], v3 offset:45056
    s_waitcnt lgkmcnt(8)
    v_mfma_f32_32x32x16_bf16 v[40:55], v[112:115], v[148:151], v[40:55]
    ds_read_b64_tr_b16 v[140:141], v2 offset:47104
    ds_read_b64_tr_b16 v[142:143], v3 offset:47104
    s_waitcnt lgkmcnt(8)
    v_mfma_f32_32x32x16_bf16 v[40:55], v[116:119], v[152:155], v[40:55]
    v_add_u32 v2, 0x10000, v2
    v_add_u32 v3, 0x10000, v3
    ds_read_b64_tr_b16 v[144:145], v2 offset:0
    ds_read_b64_tr_b16 v[146:147], v3 offset:0
    s_waitcnt lgkmcnt(8)
    v_mfma_f32_32x32x16_bf16 v[40:55], v[120:123], v[156:159], v[40:55]
    ds_write_b32 v0, v38 offset:7060
    ds_read_b64_tr_b16 v[148:149], v2 offset:2048
    ds_read_b64_tr_b16 v[150:151], v3 offset:2048
    s_waitcnt lgkmcnt(9)
    v_mfma_f32_32x32x16_bf16 v[40:55], v[124:127], v[160:163], v[40:55]
    ds_read_b64_tr_b16 v[152:153], v2 offset:4096
    ds_read_b64_tr_b16 v[154:155], v3 offset:4096
    s_waitcnt lgkmcnt(9)
    v_mfma_f32_32x32x16_bf16 v[40:55], v[128:131], v[136:139], v[40:55]
    ds_read_b64_tr_b16 v[156:157], v2 offset:6144
    ds_read_b64_tr_b16 v[158:159], v3 offset:6144
    s_waitcnt lgkmcnt(9)
    v_mfma_f32_32x32x16_bf16 v[40:55], v[132:135], v[140:143], v[40:55]
    ds_read_b64_tr_b16 v[160:161], v2 offset:8192
    ds_read_b64_tr_b16 v[162:163], v3 offset:8192
    s_waitcnt lgkmcnt(9)
    v_mfma_f32_32x32x16_bf16 v[56:71], v[104:107], v[144:147], v[56:71]
L_w70:
    ds_read_b32 v5, v0 offset:2024
    s_sub_u32 s3, s3, 1
    s_cbranch_scc1 L_end
    s_waitcnt lgkmcnt(0)
    v_cmp_gt_u32 vcc, 4, v5
    s_cbranch_vccnz L_w70
    ds_read_b64_tr_b16 v[136:137], v2 offset:10240
    ds_read_b64_tr_b16 v[138:139], v3 offset:10240
    s_waitcnt lgkmcnt(8)
    v_mfma_f32_32x32x16_bf16 v[56:71], v[108:111], v[148:151], v[56:71]
    ds_read_b64_tr_b16 v[140:141], v2 offset:12288
    ds_read_b64_tr_b16 v[142:143], v3 offset:12288
    s_waitcnt lgkmcnt(8)
    v_mfma_f32_32x32x16_bf16 v[56:71], v[112:115], v[152:155], v[56:71]
    ds_read_b64_tr_b16 v[144:145], v2 offset:14336
    ds_read_b64_tr_b16 v[146:147], v3 offset:14336
    v_cvt_pk_bf16_f32 v88, v8, v40
    v_cvt_pk_bf16_f32 v89, v9, v41
    s_waitcnt lgkmcnt(8)
    v_mfma_f32_32x32x16_bf16 v[56:71], v[116:119], v[156:159], v[56:71]
    s_add_u32 s38, s55, 0
    v_permlane16_swap_b32 v88, v89
    buffer_store_dwordx2 v[88:89], v36, s[40:43], s38 offen offset:0 sc1
    ds_read_b64_tr_b16 v[148:149], v2 offset:32768
    ds_read_b64_tr_b16 v[150:151], v3 offset:32768
    v_cvt_pk_bf16_f32 v90, v10, v42
    v_cvt_pk_bf16_f32 v91, v11, v43
    s_waitcnt lgkmcnt(8)
    v_mfma_f32_32x32x16_bf16 v[56:71], v[120:123], v[160:163], v[56:71]
    s_add_u32 s38, s55, 32768
    v_permlane16_swap_b32 v90, v91
    buffer_store_dwordx2 v[90:91], v36, s[40:43], s38 offen offset:0 sc1
    ds_read_b64_tr_b16 v[152:153], v2 offset:34816
    ds_read_b64_tr_b16 v[154:155], v3 offset:34816
    v_cvt_pk_bf16_f32 v92, v12, v44
    v_cvt_pk_bf16_f32 v93, v13, v45
    s_waitcnt lgkmcnt(8)
    v_mfma_f32_32x32x16_bf16 v[56:71], v[124:127], v[136:139], v[56:71]
    s_add_u32 s38, s55, 131072
    v_permlane16_swap_b32 v92, v93
    buffer_store_dwordx2 v[92:93], v36, s[40:43], s38 offen offset:0 sc1
    ds_read_b64_tr_b16 v[156:157], v2 offset:36864
    ds_read_b64_tr_b16 v[158:159], v3 offset:36864
    v_cvt_pk_bf16_f32 v94, v14, v46
    v_cvt_pk_bf16_f32 v95, v15, v47
    s_waitcnt lgkmcnt(8)
    v_mfma_f32_32x32x16_bf16 v[56:71], v[128:131], v[140:143], v[56:71]
    s_add_u32 s38, s55, 163840
    v_permlane16_swap_b32 v94, v95
    buffer_store_dwordx2 v[94:95], v36, s[40:43], s38 offen offset:0 sc1
    ds_read_b64_tr_b16 v[160:161], v2 offset:38912
    ds_read_b64_tr_b16 v[162:163], v3 offset:38912
    v_cvt_pk_bf16_f32 v96, v16, v48
    v_cvt_pk_bf16_f32 v97, v17, v49
    s_waitcnt lgkmcnt(8)
    v_mfma_f32_32x32x16_bf16 v[56:71], v[132:135], v[144:147], v[56:71]
    s_add_u32 s38, s55, 262144
    v_permlane16_swap_b32 v96, v97
    buffer_store_dwordx2 v[96:97], v36, s[40:43], s38 offen offset:0 sc1
    ds_read_b64_tr_b16 v[136:137], v2 offset:40960
    ds_read_b64_tr_b16 v[138:139], v3 offset:40960
    v_cvt_pk_bf16_f32 v98, v18, v50
    v_cvt_pk_bf16_f32 v99, v19, v51
    s_waitcnt lgkmcnt(8)
    v_mfma_f32_32x32x16_bf16 v[72:87], v[104:107], v[148:151], v[72:87]
    s_add_u32 s38, s55, 294912
    v_permlane16_swap_b32 v98, v99
    buffer_store_dwordx2 v[98:99], v36, s[40:43], s38 offen offset:0 sc1
    ds_read_b64_tr_b16 v[140:141], v2 offset:43008
    ds_read_b64_tr_b16 v[142:143], v3 offset:43008
    v_cvt_pk_bf16_f32 v100, v20, v52
    v_cvt_pk_bf16_f32 v101, v21, v53
    s_waitcnt lgkmcnt(8)
    v_mfma_f32_32x32x16_bf16 v[72:87], v[108:111], v[152:155], v[72:87]
    s_add_u32 s38, s55, 393216
    v_permlane16_swap_b32 v100, v101
    buffer_store_dwordx2 v[100:101], v36, s[40:43], s38 offen offset:0 sc1
    ds_read_b64_tr_b16 v[144:145], v2 offset:45056
    ds_read_b64_tr_b16 v[146:147], v3 offset:45056
    v_cvt_pk_bf16_f32 v102, v22, v54
    v_cvt_pk_bf16_f32 v103, v23, v55
    s_waitcnt lgkmcnt(8)
    v_mfma_f32_32x32x16_bf16 v[72:87], v[112:115], v[156:159], v[72:87]
    s_add_u32 s38, s55, 425984
    v_permlane16_swap_b32 v102, v103
    buffer_store_dwordx2 v[102:103], v36, s[40:43], s38 offen offset:0 sc1
    ds_read_b64_tr_b16 v[148:149], v2 offset:47104
    ds_read_b64_tr_b16 v[150:151], v3 offset:47104
    s_waitcnt lgkmcnt(8)
    v_mfma_f32_32x32x16_bf16 v[72:87], v[116:119], v[160:163], v[72:87]
    s_waitcnt lgkmcnt(6)
    v_mfma_f32_32x32x16_bf16 v[72:87], v[120:123], v[136:139], v[72:87]
    s_waitcnt lgkmcnt(4)
    v_mfma_f32_32x32x16_bf16 v[72:87], v[124:127], v[140:143], v[72:87]
    s_waitcnt lgkmcnt(2)
    v_mfma_f32_32x32x16_bf16 v[72:87], v[128:131], v[144:147], v[72:87]
    s_waitcnt lgkmcnt(0)
    v_mfma_f32_32x32x16_bf16 v[72:87], v[132:135], v[148:151], v[72:87]
    s_nop 11
    v_cvt_pk_bf16_f32 v136, v56, v72
    v_cvt_pk_bf16_f32 v137, v57, v73
    v_cvt_pk_bf16_f32 v138, v58, v74
    v_cvt_pk_bf16_f32 v139, v59, v75
    s_add_u32 s38, s55, 0
    v_permlane16_swap_b32 v136, v137
    buffer_store_dwordx2 v[136:137], v36, s[40:43], s38 offen offset:128 sc1
    v_cvt_pk_bf16_f32 v140, v60, v76
    v_cvt_pk_bf16_f32 v141, v61, v77
    s_add_u32 s38, s55, 32768
    v_permlane16_swap_b32 v138, v139
    buffer_store_dwordx2 v[138:139], v36, s[40:43], s38 offen offset:128 sc1
    v_cvt_pk_bf16_f32 v142, v62, v78
    v_cvt_pk_bf16_f32 v143, v63, v79
    s_add_u32 s38, s55, 131072
    v_permlane16_swap_b32 v140, v141
    buffer_store_dwordx2 v[140:141], v36, s[40:43], s38 offen offset:128 sc1
    v_cvt_pk_bf16_f32 v144, v64, v80
    v_cvt_pk_bf16_f32 v145, v65, v81
    s_add_u32 s38, s55, 163840
    v_permlane16_swap_b32 v142, v143
    buffer_store_dwordx2 v[142:143], v36, s[40:43], s38 offen offset:128 sc1
    v_cvt_pk_bf16_f32 v146, v66, v82
    v_cvt_pk_bf16_f32 v147, v67, v83
    s_add_u32 s38, s55, 262144
    v_permlane16_swap_b32 v144, v145
    buffer_store_dwordx2 v[144:145], v36, s[40:43], s38 offen offset:128 sc1
    v_cvt_pk_bf16_f32 v148, v68, v84
    v_cvt_pk_bf16_f32 v149, v69, v85
    s_add_u32 s38, s55, 294912
    v_permlane16_swap_b32 v146, v147
    buffer_store_dwordx2 v[146:147], v36, s[40:43], s38 offen offset:128 sc1
    v_cvt_pk_bf16_f32 v150, v70, v86
    v_cvt_pk_bf16_f32 v151, v71, v87
    s_add_u32 s38, s55, 393216
    v_permlane16_swap_b32 v148, v149
    buffer_store_dwordx2 v[148:149], v36, s[40:43], s38 offen offset:128 sc1
    s_add_u32 s38, s55, 425984
    v_permlane16_swap_b32 v150, v151
    buffer_store_dwordx2 v[150:151], v36, s[40:43], s38 offen offset:128 sc1
    v_mov_b32 v5, 1
    s_mov_b64 exec, 1
    ds_add_u32 v0, v5 offset:1012
    s_mov_b64 exec, -1
    s_setprio 0
    s_cmp_ge_u32 s35, 28
    s_cbranch_scc1 L_end
    v_lshrrev_b32 v6, 4, v1
    v_and_b32 v3, 15, v1
    v_bfe_u32 v8, v1, 2, 2
    v_lshl_add_u32 v9, v6, 3, v8
    v_and_b32 v10, 1, v6
    v_lshl_or_b32 v8, v10, 2, v8
    v_lshlrev_b32 v8, 5, v8
    v_lshl_add_u32 v8, v9, 8, v8
    v_and_b32 v9, 3, v1
    v_lshl_add_u32 v8, v9, 3, v8
    s_lshl_b32 s38, s33, 14
    s_add_u32 s38, s38, 65536
    v_add_u32 v2, s38, v8
    v_bfe_u32 v8, v1, 3, 1
    v_mul_u32_u24 v8, 144, v8
    v_lshl_add_u32 v8, v6, 4, v8
    v_add_u32 v4, 143552, v8
    v_lshlrev_b32 v7, 17, v7
    v_lshl_add_u32 v7, v3, 4, v7
    s_lshl_b32 s49, s62, 5
    s_add_u32 s49, s49, s35
    s_lshl2_add_u32 s49, s49, s33
    s_lshl_b32 s49, s49, 8
    s_add_u32 s49, s49, 1310720
    s_mov_b32 s44, s20
    s_mov_b32 s45, s21
    s_mov_b32 s46, 1835008
    s_mov_b32 s47, 0x20000
L_w71:
    s_sleep 1
    ds_read_b32 v5, v0 offset:1012
    s_sub_u32 s3, s3, 1
    s_cbranch_scc1 L_end
    s_waitcnt lgkmcnt(0)
    v_cmp_gt_u32 vcc, 5, v5
    s_cbranch_vccnz L_w71

    v_lshlrev_b32 v12, 1, v6
    v_xor_b32 v12, v12, v3
    v_lshlrev_b32 v12, 4, v12
    v_lshl_add_u32 v12, v6, 10, v12
    v_xor_b32 v13, 0x80, v12
    s_lshl_b32 s58, s35, 16
    s_lshl_b32 s38, s33, 8
    s_add_u32 s58, s58, s38
    s_lshl_b32 s57, s33, 14
    s_add_u32 s57, s57, 65536
    s_mov_b32 s56, s62
    s_mov_b32 s59, 0
L_A_f2:
    s_xor_b32 s38, s59, s56
    s_lshl_b32 s39, s38, 12
    s_add_u32 s39, s39, s57
    s_lshl_b32 s38, s38, 14
    s_add_u32 s38, s38, s58
    s_add_u32 m0, s39, 0
    s_add_u32 s60, s38, 0
    buffer_load_dwordx4 v12, s[44:47], s60 offen lds
    s_waitcnt vmcnt(3)
    s_add_u32 m0, s39, 1024
    s_add_u32 s60, s38, 4096
    buffer_load_dwordx4 v12, s[44:47], s60 offen lds
    s_waitcnt vmcnt(3)
    s_add_u32 m0, s39, 2048
    s_add_u32 s60, s38, 8192
    buffer_load_dwordx4 v13, s[44:47], s60 offen lds
    s_waitcnt vmcnt(3)
    s_add_u32 m0, s39, 3072
    s_add_u32 s60, s38, 12288
    buffer_load_dwordx4 v13, s[44:47], s60 offen lds
    s_waitcnt vmcnt(3)
    s_add_u32 s59, s59, 1
    s_cmp_lt_u32 s59, 4
    s_cbranch_scc1 L_A_f2
    v_mov_b32 v5, 1
    s_mov_b64 exec, 1
    ds_add_u32 v0, v5 offset:5044
    s_mov_b64 exec, -1
    s_waitcnt vmcnt(0)
    v_xor_b32 v5, 0, v2
    ds_read_b64_tr_b16 v[64:65], v5 offset:0
    ds_read_b64_tr_b16 v[66:67], v5 offset:1024
    ds_read_b64_tr_b16 v[96:97], v5 offset:8192
    ds_read_b64_tr_b16 v[98:99], v5 offset:9216
    v_xor_b32 v5, 32, v2
    ds_read_b64_tr_b16 v[68:69], v5 offset:0
    ds_read_b64_tr_b16 v[70:71], v5 offset:1024
    ds_read_b64_tr_b16 v[100:101], v5 offset:8192
    ds_read_b64_tr_b16 v[102:103], v5 offset:9216
    s_waitcnt lgkmcnt(4)
    v_xor_b32 v5, 64, v2
    ds_read_b64_tr_b16 v[72:73], v5 offset:0
    ds_read_b64_tr_b16 v[74:75], v5 offset:1024
    ds_read_b64_tr_b16 v[104:105], v5 offset:8192
    ds_read_b64_tr_b16 v[106:107], v5 offset:9216
    v_xor_b32 v5, 96, v2
    ds_read_b64_tr_b16 v[76:77], v5 offset:0
    ds_read_b64_tr_b16 v[78:79], v5 offset:1024
    ds_read_b64_tr_b16 v[108:109], v5 offset:8192
    ds_read_b64_tr_b16 v[110:111], v5 offset:9216
    s_waitcnt lgkmcnt(4)
    v_xor_b32 v5, 128, v2
    ds_read_b64_tr_b16 v[80:81], v5 offset:0
    ds_read_b64_tr_b16 v[82:83], v5 offset:1024
    ds_read_b64_tr_b16 v[112:113], v5 offset:8192
    ds_read_b64_tr_b16 v[114:115], v5 offset:9216
    v_xor_b32 v5, 160, v2
    ds_read_b64_tr_b16 v[84:85], v5 offset:0
    ds_read_b64_tr_b16 v[86:87], v5 offset:1024
    ds_read_b64_tr_b16 v[116:117], v5 offset:8192
    ds_read_b64_tr_b16 v[118:119], v5 offset:9216
    s_waitcnt lgkmcnt(4)
    v_xor_b32 v5, 192, v2
    ds_read_b64_tr_b16 v[88:89], v5 offset:0
    ds_read_b64_tr_b16 v[90:91], v5 offset:1024
    ds_read_b64_tr_b16 v[120:121], v5 offset:8192
    ds_read_b64_tr_b16 v[122:123], v5 offset:9216
    v_xor_b32 v5, 224, v2
    ds_read_b64_tr_b16 v[92:93], v5 offset:0
    ds_read_b64_tr_b16 v[94:95], v5 offset:1024
    ds_read_b64_tr_b16 v[124:125], v5 offset:8192
    ds_read_b64_tr_b16 v[126:127], v5 offset:9216
    s_waitcnt lgkmcnt(4)
L_w72:
    s_sleep 2
    ds_read_b32 v5, v0 offset:5052
    s_sub_u32 s3, s3, 1
    s_cbranch_scc1 L_end
    s_waitcnt lgkmcnt(0)
    v_cmp_gt_u32 vcc, 4, v5
    s_cbranch_vccnz L_w72
L_w73:
    ds_read_b32 v5, v0 offset:2016
    s_sub_u32 s3, s3, 1
    s_cbranch_scc1 L_end
    s_waitcnt lgkmcnt(0)
    v_cmp_gt_u32 vcc, 4, v5
    s_cbranch_vccnz L_w73
    ds_read_b128 v[8:11], v4
    ds_read_b128 v[12:15], v4 offset:64
    s_waitcnt lgkmcnt(0)
    v_mfma_f32_16x16x32_bf16 v[32:35], v[8:11], v[64:67], 0
    v_mfma_f32_16x16x32_bf16 v[36:39], v[8:11], v[68:71], 0
    v_mfma_f32_16x16x32_bf16 v[32:35], v[12:15], v[96:99], v[32:35]
    v_mfma_f32_16x16x32_bf16 v[36:39], v[12:15], v[100:103], v[36:39]
    v_mfma_f32_16x16x32_bf16 v[40:43], v[8:11], v[72:75], 0
    v_mfma_f32_16x16x32_bf16 v[44:47], v[8:11], v[76:79], 0
    v_mfma_f32_16x16x32_bf16 v[40:43], v[12:15], v[104:107], v[40:43]
    v_mfma_f32_16x16x32_bf16 v[44:47], v[12:15], v[108:111], v[44:47]
    v_mfma_f32_16x16x32_bf16 v[48:51], v[8:11], v[80:83], 0
    v_mfma_f32_16x16x32_bf16 v[52:55], v[8:11], v[84:87], 0
    v_mfma_f32_16x16x32_bf16 v[48:51], v[12:15], v[112:115], v[48:51]
    v_mfma_f32_16x16x32_bf16 v[52:55], v[12:15], v[116:119], v[52:55]
    v_mfma_f32_16x16x32_bf16 v[56:59], v[8:11], v[88:91], 0
    v_mfma_f32_16x16x32_bf16 v[60:63], v[8:11], v[92:95], 0
    v_mfma_f32_16x16x32_bf16 v[56:59], v[12:15], v[120:123], v[56:59]
    v_mfma_f32_16x16x32_bf16 v[60:63], v[12:15], v[124:127], v[60:63]
    v_cvt_pk_bf16_f32 v28, v32, v36
    v_cvt_pk_bf16_f32 v29, v40, v44
    s_nop 1
    v_cvt_pk_bf16_f32 v30, v48, v52
    s_nop 2
    v_cvt_pk_bf16_f32 v31, v56, v60
    s_mov_b32 exec_lo, 0xffff
    s_mov_b32 exec_hi, 0xffff
    buffer_store_dwordx4 v[28:31], v7, s[40:43], s49 offen sc1
L_end:
L_exit:
    s_endpgm
L_codeend:
.section .rodata,"a"
.p2align 6
.amdhsa_kernel adaLN_cond__compressed_kv_cla__dense_activation_relu__decode_kernel
.amdhsa_next_free_vgpr 168
.amdhsa_next_free_sgpr 102
.amdhsa_accum_offset 168
.amdhsa_group_segment_fixed_size 0
.amdhsa_kernarg_size 112
.amdhsa_user_sgpr_count 2
.amdhsa_user_sgpr_kernarg_segment_ptr 1
.amdhsa_system_sgpr_workgroup_id_x 1
.amdhsa_float_denorm_mode_32 3
.end_amdhsa_kernel
.text
```

```asm
; @launch grid=(256,1,1) block=(768,1,1) lds=163840
.amdgcn_target "amdgcn-amd-amdhsa--gfx950"
.text
.globl adaLN_cond__compressed_kv_cla__dense_activation_relu__decode_kernel
.p2align 8
.type adaLN_cond__compressed_kv_cla__dense_activation_relu__decode_kernel,@function
adaLN_cond__compressed_kv_cla__dense_activation_relu__decode_kernel:

    s_cmpk_ge_u32 s2, 256
    s_cbranch_scc1 L_exit
    s_load_dwordx16 s[4:19], s[0:1], 0
    s_load_dwordx8 s[20:27], s[0:1], 64
    s_load_dwordx4 s[28:31], s[0:1], 96
    v_lshrrev_b32 v2, 6, v0
    v_and_b32 v1, 63, v0
    v_readfirstlane_b32 s32, v2

    s_lshr_b32 s37, s2, 3
    s_getpc_b64 s[52:53]
L_pc:
    s_mul_i32 s38, s37, 12
    s_add_u32 s38, s38, s32
    s_lshl_b32 s38, s38, 7
    s_min_u32 s38, s38, L_codeend-L_pc-4
    v_mov_b32 v2, s38
    global_load_dword v167, v2, s[52:53]
    s_and_b32 s36, s2, 7
    s_and_b32 s34, s37, 7
    s_lshr_b32 s37, s37, 3
    s_lshl3_add_u32 s35, s37, s36
    s_and_b32 s33, s32, 3
    s_cmp_lt_u32 s32, 4
    s_cbranch_scc1 L_pA
    s_cmp_lt_u32 s32, 8
    s_cbranch_scc1 L_pB
    s_cmp_eq_u32 s34, 0
    s_cbranch_scc1 L_Cs
    s_branch L_Co
L_pB:
    s_cmp_lt_u32 s34, 4
    s_cbranch_scc1 L_Bc
    s_branch L_Be
L_pA:
    s_lshr_b32 s38, s34, 2
    s_or_b32 s38, s38, s32
    s_cbranch_scc0 L_pT
    s_lshl3_add_u32 s38, s32, s34
    s_cmp_lg_u32 s38, 8
    s_cbranch_scc1 L_A
    v_lshlrev_b32 v2, 7, v1
    s_waitcnt lgkmcnt(0)
    global_load_dword v166, v2, s[22:23]
    global_load_dword v166, v2, s[4:5]
    s_branch L_A
L_pT:
    v_and_b32 v3, 1, v1
    v_lshrrev_b32 v2, 1, v1
    s_lshl2_add_u32 s38, s37, s34
    v_lshl_add_u32 v2, s38, 5, v2
    v_mul_u32_u24 v2, 6, v2
    v_add_u32 v2, v2, v3
    s_lshl_b32 s39, s36, 7
    v_lshl_add_u32 v2, v2, 10, s39
    s_waitcnt lgkmcnt(0)
    global_load_dword v166, v2, s[24:25]

L_A:
    v_mov_b32 v8, -1
    v_mov_b32 v9, -1
    v_mov_b32 v10, -1
    v_mov_b32 v11, -1
    v_lshlrev_b32 v14, 4, v1
    s_waitcnt lgkmcnt(0)

    s_mov_b32 s3, 0x400000
    v_mov_b32 v0, 156256
    s_and_b32 s62, s34, 3
    s_lshl2_add_u32 s97, s62, s37
    s_lshl4_add_u32 s61, s36, s97
    s_waitcnt lgkmcnt(0)

    s_mov_b32 s40, s30
    s_mov_b32 s41, s31
    s_mov_b32 s42, 16777216
    s_mov_b32 s43, 0x20000

    s_sub_u32 s98, s2, 40
    s_cmp_ge_u32 s98, 1
    s_cbranch_scc1 L_A_nx
    s_lshl2_add_u32 s38, s98, s33
    s_lshl_b32 s38, s38, 11
    buffer_store_dwordx4 v[8:11], v14, s[40:43], s38 offen offset:0 sc1
    buffer_store_dwordx4 v[8:11], v14, s[40:43], s38 offen offset:1024 sc1
L_A_nx:
    s_cmp_lg_u32 s34, 0
    s_cbranch_scc1 L_A_nc
    s_lshl2_add_u32 s55, s36, s37
    s_lshl2_add_u32 s38, s55, s33
    s_lshl_b32 s38, s38, 11
    s_add_u32 s38, s38, 65536
    buffer_store_dwordx4 v[8:11], v14, s[40:43], s38 offen offset:0 sc1
    buffer_store_dwordx4 v[8:11], v14, s[40:43], s38 offen offset:1024 sc1
L_A_nc:
    s_cmp_lg_u32 s33, 3
    s_cbranch_scc1 L_noinit
    v_mul_u32_u24 v13, 1008, v1
    v_mov_b32 v4, 0
    v_add_u32 v13, v13, v0
    v_mov_b32 v5, v4
    v_mov_b32 v6, v4
    v_mov_b32 v7, v4
    v_add_u32 v12, v14, v0
    s_mov_b64 exec, 0xff
    ds_write_b128 v13, v[4:7]
    s_mov_b32 exec_lo, -1
    ds_write_b128 v12, v[8:11] offset:7072
    s_mov_b64 exec, -1
L_noinit:
    s_cmp_lt_u32 s34, 4
    s_cbranch_scc1 L_AD
    s_mov_b32 s44, s6
    s_mov_b32 s45, s7
    s_mov_b32 s46, 33554432
    s_mov_b32 s47, 0x20000

    v_lshrrev_b32 v4, 3, v1
    v_bfe_u32 v5, v4, 1, 1
    v_lshlrev_b32 v5, 2, v5
    v_bfe_u32 v6, v4, 2, 1
    v_or_b32 v5, v5, v6
    v_and_b32 v6, 7, v1
    v_xor_b32 v5, v5, v6
    v_lshlrev_b32 v5, 4, v5
    v_lshl_add_u32 v2, v4, 10, v5
    v_xor_b32 v3, 32, v2
    s_lshl_b32 s48, s61, 18
    s_lshl_b32 s38, s33, 15
    s_add_u32 s48, s48, s38
    s_lshl_b32 s49, s33, 12
    s_mov_b32 s50, 0
    s_waitcnt lgkmcnt(0)
    s_barrier

    s_cmp_ge_u32 s98, 1
    s_cbranch_scc1 L_A_go
    s_waitcnt vmcnt(0)
    v_mov_b32 v12, 1
    s_mov_b64 exec, 1
    ds_add_u32 v0, v12 offset:8
    s_mov_b64 exec, -1
    s_cmp_lg_u32 s33, 2
    s_cbranch_scc1 L_A_go
    s_lshl_b32 s38, s98, 2
    v_mov_b32 v13, s38
L_w1:
    ds_read_b32 v12, v0 offset:8
    s_sub_u32 s3, s3, 1
    s_cbranch_scc1 L_end
    s_waitcnt lgkmcnt(0)
    v_cmp_gt_u32 vcc, 4, v12
    s_cbranch_vccnz L_w1
    s_mov_b64 exec, 1
    global_store_dword v13, v8, s[28:29] offset:32 sc1
    s_mov_b64 exec, -1
L_A_go:
L_w2:
    s_sleep 1
    ds_read_b32 v8, v0 offset:4
    s_sub_u32 s3, s3, 1
    s_cbranch_scc1 L_end
    s_waitcnt lgkmcnt(0)
    v_cmp_gt_u32 vcc, 4, v8
    s_cbranch_vccnz L_w2
    s_setprio 2
    s_lshl_b32 s38, s33, 2
    v_add_u32 v4, s38, v0
    v_mov_b32 v5, v0
    s_mov_b32 s53, 2
L_A_dma:
    s_and_b32 s38, s50, 9
    s_cmp_lg_u32 s38, 8
    s_cbranch_scc1 L_A_dma1
L_w3:
    ds_read_b32 v8, v5 offset:3024
    s_sub_u32 s3, s3, 1
    s_cbranch_scc1 L_end
    s_waitcnt lgkmcnt(0)
    v_cmp_gt_u32 vcc, 8, v8
    s_cbranch_vccnz L_w3
    v_add_u32 v5, 4, v5
    s_cmp_lg_u32 s50, 8
    s_cbranch_scc1 L_A_dma1
    s_add_u32 s48, s48, 130048
    s_sub_u32 s49, s49, 131072
L_A_dma1:
    s_cmp_lg_u32 s50, 8
    s_cbranch_scc1 L_A_dma2
    v_mov_b32 v8, 7
    s_waitcnt vmcnt(4)
    ds_write_b32 v4, v8 offset:4032
    v_mov_b32 v7, 8
    s_waitcnt vmcnt(0)
    ds_write_b32 v4, v7 offset:4032
L_w4:
    ds_read_b32 v8, v0 offset:2028
    s_sub_u32 s3, s3, 1
    s_cbranch_scc1 L_end
    s_waitcnt lgkmcnt(0)
    v_cmp_gt_u32 vcc, 4, v8
    s_cbranch_vccnz L_w4
    s_mov_b32 s53, 10
L_A_dma2:
    s_cmp_lg_u32 s50, 9
    s_cbranch_scc1 L_A_dma3
L_w5:
    ds_read_b32 v8, v0 offset:1008
    s_sub_u32 s3, s3, 1
    s_cbranch_scc1 L_end
    s_waitcnt lgkmcnt(0)
    v_cmp_gt_u32 vcc, 4, v8
    s_cbranch_vccnz L_w5
L_A_dma3:
    s_add_u32 m0, s49, 0
    s_add_u32 s38, s48, 0
    buffer_load_dwordx4 v2, s[44:47], s38 offen nt lds
    s_waitcnt vmcnt(7)
    s_add_u32 m0, s49, 1024
    s_add_u32 s38, s48, 8192
    buffer_load_dwordx4 v3, s[44:47], s38 offen nt lds
    s_waitcnt vmcnt(7)
    s_add_u32 m0, s49, 2048
    s_add_u32 s38, s48, 16384
    buffer_load_dwordx4 v2, s[44:47], s38 offen nt lds
    s_waitcnt vmcnt(7)
    s_add_u32 m0, s49, 3072
    s_add_u32 s38, s48, 24576
    buffer_load_dwordx4 v3, s[44:47], s38 offen nt lds
    s_waitcnt vmcnt(7)
    s_add_u32 s49, s49, 16384
    s_add_u32 s48, s48, 128
    s_add_u32 s50, s50, 1
    s_max_u32 s38, s50, s53
    s_sub_u32 s38, s38, 2
    v_mov_b32 v6, s38
    ds_write_b32 v4, v6 offset:4032
    s_cmp_lt_u32 s50, 12
    s_cbranch_scc1 L_A_dma
L_w6:
    ds_read_b32 v8, v0 offset:3032
    s_sub_u32 s3, s3, 1
    s_cbranch_scc1 L_end
    s_waitcnt lgkmcnt(0)
    v_cmp_gt_u32_e64 vcc, 8, v8
    s_cbranch_vccnz L_w6
    s_add_u32 m0, s49, 0
    s_add_u32 s38, s48, 0
    buffer_load_dwordx4 v2, s[44:47], s38 offen nt lds
    s_add_u32 m0, s49, 1024
    s_add_u32 s38, s48, 8192
    buffer_load_dwordx4 v3, s[44:47], s38 offen nt lds
    s_add_u32 m0, s49, 2048
    s_add_u32 s38, s48, 16384
    buffer_load_dwordx4 v2, s[44:47], s38 offen nt lds
    v_mov_b32 v6, 12
    s_waitcnt vmcnt(3)
    ds_write_b32 v4, v6 offset:4032
    s_add_u32 m0, s49, 3072
    s_add_u32 s38, s48, 24576
    buffer_load_dwordx4 v3, s[44:47], s38 offen nt lds
    s_add_u32 m0, s49, 16384
    s_add_u32 s38, s48, 128
    buffer_load_dwordx4 v2, s[44:47], s38 offen nt lds
    s_add_u32 m0, s49, 17408
    s_add_u32 s38, s48, 8320
    buffer_load_dwordx4 v3, s[44:47], s38 offen nt lds
    s_add_u32 m0, s49, 18432
    s_add_u32 s38, s48, 16512
    buffer_load_dwordx4 v2, s[44:47], s38 offen nt lds
    v_mov_b32 v6, 13
    s_waitcnt vmcnt(3)
    ds_write_b32 v4, v6 offset:4032
    s_add_u32 m0, s49, 19456
    s_add_u32 s38, s48, 24704
    buffer_load_dwordx4 v3, s[44:47], s38 offen nt lds
L_w7:
    ds_read_b32 v8, v0 offset:3036
    s_sub_u32 s3, s3, 1
    s_cbranch_scc1 L_end
    s_waitcnt lgkmcnt(0)
    v_cmp_gt_u32_e64 vcc, 8, v8
    s_cbranch_vccnz L_w7
    s_add_u32 m0, s49, 32768
    s_add_u32 s38, s48, 256
    buffer_load_dwordx4 v2, s[44:47], s38 offen nt lds
    s_add_u32 m0, s49, 33792
    s_add_u32 s38, s48, 8448
    buffer_load_dwordx4 v3, s[44:47], s38 offen nt lds
    s_add_u32 m0, s49, 34816
    s_add_u32 s38, s48, 16640
    buffer_load_dwordx4 v2, s[44:47], s38 offen nt lds
    v_mov_b32 v6, 14
    s_waitcnt vmcnt(3)
    ds_write_b32 v4, v6 offset:4032
    s_add_u32 m0, s49, 35840
    s_add_u32 s38, s48, 24832
    buffer_load_dwordx4 v3, s[44:47], s38 offen nt lds
    s_add_u32 m0, s49, 49152
    s_add_u32 s38, s48, 384
    buffer_load_dwordx4 v2, s[44:47], s38 offen nt lds
    s_add_u32 m0, s49, 50176
    s_add_u32 s38, s48, 8576
    buffer_load_dwordx4 v3, s[44:47], s38 offen nt lds
    s_add_u32 m0, s49, 51200
    s_add_u32 s38, s48, 16768
    buffer_load_dwordx4 v2, s[44:47], s38 offen nt lds
    v_mov_b32 v6, 15
    s_waitcnt vmcnt(3)
    ds_write_b32 v4, v6 offset:4032
    s_add_u32 m0, s49, 52224
    s_add_u32 s38, s48, 24960
    buffer_load_dwordx4 v3, s[44:47], s38 offen nt lds
    v_mov_b32 v7, 16
    s_waitcnt vmcnt(0)
    ds_write_b32 v4, v7 offset:4032
    v_bfe_u32 v16, v1, 4, 1
    v_lshrrev_b32 v17, 5, v1
    v_lshl_add_u32 v16, v17, 2, v16
    v_lshlrev_b32 v16, 14, v16
    v_and_b32 v17, 15, v1
    v_lshl_add_u32 v16, v17, 4, v16
    s_lshl_b32 s55, s36, 19
    s_lshl2_add_u32 s38, s97, s33
    s_lshl_b32 s38, s38, 8
    s_add_u32 s55, s55, s38
    s_add_u32 s55, s55, 2097152
    v_mov_b32 v20, -1
    v_mov_b32 v21, -1
    v_mov_b32 v22, -1
    v_mov_b32 v23, -1
    s_add_u32 s38, s55, 0
    buffer_store_dwordx4 v[20:23], v16, s[40:43], s38 offen sc1
    s_add_u32 s38, s55, 32768
    buffer_store_dwordx4 v[20:23], v16, s[40:43], s38 offen sc1
    s_add_u32 s38, s55, 131072
    buffer_store_dwordx4 v[20:23], v16, s[40:43], s38 offen sc1
    s_add_u32 s38, s55, 163840
    buffer_store_dwordx4 v[20:23], v16, s[40:43], s38 offen sc1
    s_add_u32 s38, s55, 262144
    buffer_store_dwordx4 v[20:23], v16, s[40:43], s38 offen sc1
    s_add_u32 s38, s55, 294912
    buffer_store_dwordx4 v[20:23], v16, s[40:43], s38 offen sc1
    s_add_u32 s38, s55, 393216
    buffer_store_dwordx4 v[20:23], v16, s[40:43], s38 offen sc1
    s_add_u32 s38, s55, 425984
    buffer_store_dwordx4 v[20:23], v16, s[40:43], s38 offen sc1
    s_waitcnt vmcnt(0)
    v_mov_b32 v12, 1
    s_mov_b64 exec, 1
    ds_add_u32 v0, v12 offset:2024
    s_mov_b64 exec, -1
    s_setprio 0
    s_cmp_ge_u32 s35, 28
    s_cbranch_scc1 L_end

    v_and_b32 v9, 31, v1
    v_lshrrev_b32 v10, 5, v1
    v_and_b32 v3, 15, v1
    v_lshrrev_b32 v6, 4, v1
    v_and_b32 v16, 1, v1
    v_lshlrev_b32 v16, 4, v16
    s_mov_b32 s38, 0xffff
    v_lshlrev_b32 v16, v16, s38
    v_bfe_u32 v17, v1, 1, 2
    v_cmp_eq_u32 vcc, 0, v17
    s_nop 1
    v_cndmask_b32 v20, 0, v16, vcc
    v_cmp_eq_u32 vcc, 1, v17
    s_nop 1
    v_cndmask_b32 v21, 0, v16, vcc
    v_cmp_eq_u32 vcc, 2, v17
    s_nop 1
    v_cndmask_b32 v22, 0, v16, vcc
    v_cmp_eq_u32 vcc, 3, v17
    s_nop 1
    v_cndmask_b32 v23, 0, v16, vcc
L_w8:
    s_sleep 2
    ds_read_b32 v12, v0 offset:5044
    s_sub_u32 s3, s3, 1
    s_cbranch_scc1 L_end
    s_waitcnt lgkmcnt(0)
    v_cmp_gt_u32 vcc, 8, v12
    s_cbranch_vccnz L_w8
    s_branch L_A_F
L_AD:
    s_waitcnt lgkmcnt(0)
    s_barrier
    s_cmp_ge_u32 s98, 1
    s_cbranch_scc1 L_AD_nx
    s_waitcnt vmcnt(0)
    v_mov_b32 v12, 1
    s_mov_b64 exec, 1
    ds_add_u32 v0, v12 offset:8
    s_mov_b64 exec, -1
    s_cmp_lg_u32 s33, 2
    s_cbranch_scc1 L_AD_nx
    s_lshl_b32 s38, s98, 2
    v_mov_b32 v13, s38
L_w9:
    ds_read_b32 v12, v0 offset:8
    s_sub_u32 s3, s3, 1
    s_cbranch_scc1 L_end
    s_waitcnt lgkmcnt(0)
    v_cmp_gt_u32 vcc, 4, v12
    s_cbranch_vccnz L_w9
    s_mov_b64 exec, 1
    global_store_dword v13, v8, s[28:29] offset:32 sc1
    s_mov_b64 exec, -1
L_AD_nx:
    s_cmp_lg_u32 s34, 0
    s_cbranch_scc1 L_AD0
    s_waitcnt vmcnt(0)
    v_mov_b32 v8, 1
    s_mov_b64 exec, 1
    ds_add_u32 v0, v8 offset:2020
    s_mov_b64 exec, -1
    s_cmp_lg_u32 s33, 1
    s_cbranch_scc1 L_AD0
L_w10:
    s_sleep 1
    ds_read_b32 v8, v0 offset:7056
    s_sub_u32 s3, s3, 1
    s_cbranch_scc1 L_end
    s_waitcnt lgkmcnt(0)
    v_cmp_gt_u32 vcc, 4, v8
    s_cbranch_vccnz L_w10
    v_and_b32 v4, 0, v1
    v_lshlrev_b32 v4, 2, v4
L_fl11:
    global_load_dword v5, v4, s[28:29] offset:32 sc1
    s_sub_u32 s3, s3, 1
    s_cbranch_scc1 L_end
    s_waitcnt vmcnt(0)
    v_cmp_eq_u32 vcc, 0, v5
    s_cbranch_vccnz L_fl11
    v_mov_b32 v8, 1
    s_mov_b64 exec, 1
    ds_add_u32 v0, v8 offset:2020
    s_mov_b64 exec, -1
L_AD0:
    s_mov_b32 s44, s6
    s_mov_b32 s45, s7
    s_mov_b32 s46, 33554432
    s_mov_b32 s47, 0x20000
    v_lshlrev_b32 v4, 10, v1
    s_lshl_b32 s51, s61, 18
    s_and_b32 s38, s33, 1
    s_lshl_b32 s38, s38, 16
    s_add_u32 s51, s51, s38
    s_lshr_b32 s38, s33, 1
    s_lshl_b32 s38, s38, 7
    s_add_u32 s51, s51, s38
    s_add_u32 s51, s51, 131072
L_w12:
    s_sleep 1
    ds_read_b32 v8, v0 offset:5044
    s_sub_u32 s3, s3, 1
    s_cbranch_scc1 L_end
    s_waitcnt lgkmcnt(0)
    v_cmp_gt_u32 vcc, 3, v8
    s_cbranch_vccnz L_w12
    s_cmp_lg_u32 s34, 0
    s_cbranch_scc1 L_AD_k1
    s_add_u32 s38, s51, 917504
    buffer_load_dword v166, v4, s[44:47], s38 offen offset:768
    s_waitcnt vmcnt(1)
    s_add_u32 s38, s51, 1966080
    buffer_load_dword v166, v4, s[44:47], s38 offen offset:768
    s_waitcnt vmcnt(1)
    s_branch L_AD_k2
L_AD_k1:
L_AD_k2:
    s_sub_u32 s38, s51, 131072
    buffer_load_dword v166, v4, s[44:47], s38 offen offset:768
    s_waitcnt vmcnt(1)
L_AD_k3:
    buffer_load_dword v166, v4, s[44:47], s51 offen offset:256
    s_waitcnt vmcnt(1)
    buffer_load_dword v166, v4, s[44:47], s51 offen offset:512
    s_waitcnt vmcnt(1)
    buffer_load_dword v166, v4, s[44:47], s51 offen offset:768
    v_mov_b32 v8, 1
    s_mov_b64 exec, 1
    ds_add_u32 v0, v8 offset:5048
    s_mov_b64 exec, -1
L_AD1:
    v_and_b32 v9, 31, v1
    v_lshrrev_b32 v10, 5, v1
    v_and_b32 v3, 15, v1
    v_lshrrev_b32 v6, 4, v1
    v_lshlrev_b32 v7, 12, v6
    v_lshl_add_u32 v7, v3, 4, v7
    v_and_b32 v5, 1, v6
    v_lshlrev_b32 v5, 6, v5
    v_add_lshl_u32 v5, v5, v3, 10
    s_lshl_b32 s38, s62, 8
    s_lshl_b32 s50, s33, 11
    s_lshl4_add_u32 s50, s36, s50
    s_add_u32 s50, s50, s37
    s_lshl_b32 s50, s50, 3
    s_add_u32 s50, s50, 1048576
    s_lshl_b32 s51, s33, 5
    s_add_u32 s51, s51, s35
    s_lshl_b32 s51, s51, 14
    s_add_u32 s51, s51, s38
    s_add_u32 s51, s51, 2097152
    s_add_u32 s52, s51, 2097152
    s_lshl_b32 s38, s33, 8
    s_add_u32 s38, s38, 139776
    v_lshl_add_u32 v24, v1, 2, s38
    v_bfe_u32 v16, v1, 3, 1
    v_lshlrev_b32 v16, 7, v16
    v_lshl_add_u32 v16, v6, 4, v16
    v_add_u32 v25, s38, v16
    v_bfe_u32 v16, v1, 4, 1
    v_lshlrev_b32 v16, 4, v16
    v_lshl_add_u32 v16, v3, 5, v16
    v_lshl_add_u32 v16, v10, 3, v16
    s_mul_i32 s38, s33, 1056
    s_add_u32 s38, s38, 141312
    v_add_u32 v26, s38, v16
    v_add_u32 v27, 4224, v26
    v_and_b32 v16, 1, v1
    v_lshlrev_b32 v16, 4, v16
    s_mov_b32 s38, 0xffff
    v_lshlrev_b32 v16, v16, s38
    v_bfe_u32 v17, v1, 1, 2
    v_cmp_eq_u32 vcc, 0, v17
    s_nop 1
    v_cndmask_b32 v20, 0, v16, vcc
    v_cmp_eq_u32 vcc, 1, v17
    s_nop 1
    v_cndmask_b32 v21, 0, v16, vcc
    v_cmp_eq_u32 vcc, 2, v17
    s_nop 1
    v_cndmask_b32 v22, 0, v16, vcc
    v_cmp_eq_u32 vcc, 3, v17
    s_nop 1
    v_cndmask_b32 v23, 0, v16, vcc
L_w13:
    s_sleep 1
    ds_read_b32 v12, v0 offset:5052
    s_sub_u32 s3, s3, 1
    s_cbranch_scc1 L_end
    s_waitcnt lgkmcnt(0)
    v_cmp_gt_u32 vcc, 1, v12
    s_cbranch_vccnz L_w13
L_w14:
    s_sleep 1
    ds_read_b32 v12, v0 offset:6060
    s_sub_u32 s3, s3, 1
    s_cbranch_scc1 L_end
    s_waitcnt lgkmcnt(0)
    v_cmp_gt_u32 vcc, 7, v12
    s_cbranch_vccnz L_w14
L_A_st1:
    buffer_load_dwordx2 v[12:13], v5, s[40:43], s50 offen sc1
    s_sub_u32 s3, s3, 1
    s_cbranch_scc1 L_end
    s_waitcnt vmcnt(0)
    v_max_u32 v14, v12, v13
    v_cmp_eq_u32_e64 vcc, -1, v14
    s_cbranch_vccz L_A_st3
    s_mov_b64 exec, vcc
    s_sleep 4
    s_branch L_A_st1
L_A_st3:
    s_mov_b64 exec, -1
    buffer_load_dwordx4 v[32:35], v7, s[40:43], s51 offen offset:0 sc1
    buffer_load_dwordx4 v[36:39], v7, s[40:43], s51 offen offset:1024 sc1
    buffer_load_dwordx4 v[40:43], v7, s[40:43], s51 offen offset:2048 sc1
    buffer_load_dwordx4 v[44:47], v7, s[40:43], s51 offen offset:3072 sc1
    buffer_load_dwordx4 v[48:51], v7, s[40:43], s52 offen offset:0 sc1
    buffer_load_dwordx4 v[52:55], v7, s[40:43], s52 offen offset:1024 sc1
    buffer_load_dwordx4 v[56:59], v7, s[40:43], s52 offen offset:2048 sc1
    buffer_load_dwordx4 v[60:63], v7, s[40:43], s52 offen offset:3072 sc1
    v_mov_b32 v14, v12
    s_nop 1
    v_max_f32_dpp v14, v14, v14 quad_perm:[1,0,3,2] row_mask:0xf bank_mask:0xf
    s_nop 1
    v_max_f32_dpp v14, v14, v14 quad_perm:[2,3,0,1] row_mask:0xf bank_mask:0xf
    s_nop 1
    v_max_f32_dpp v14, v14, v14 row_half_mirror row_mask:0xf bank_mask:0xf
    s_nop 1
    v_max_f32_dpp v14, v14, v14 row_mirror row_mask:0xf bank_mask:0xf
    v_sub_f32 v12, v12, v14
    v_exp_f32 v12, v12
    s_nop 0
    v_mul_f32 v14, v12, v13
    s_nop 1
    v_add_f32_dpp v14, v14, v14 quad_perm:[1,0,3,2] row_mask:0xf bank_mask:0xf
    s_nop 1
    v_add_f32_dpp v14, v14, v14 quad_perm:[2,3,0,1] row_mask:0xf bank_mask:0xf
    s_nop 1
    v_add_f32_dpp v14, v14, v14 row_half_mirror row_mask:0xf bank_mask:0xf
    s_nop 1
    v_add_f32_dpp v14, v14, v14 row_mirror row_mask:0xf bank_mask:0xf
    v_rcp_f32 v14, v14
    v_cmp_gt_u32 vcc, 32, v1
    v_mul_f32 v12, v12, v14
    v_cvt_pk_bf16_f32 v13, v12, v12
    v_and_b32 v14, 0xffff0000, v13
    v_sub_f32 v12, v12, v14
    v_cvt_pk_bf16_f32 v12, v12, v12
    v_cndmask_b32 v12, v12, v13, vcc
    ds_write_b32 v24, v12
    ds_read_b128 v[12:15], v25
    ds_read_b128 v[16:19], v25 offset:64
    s_waitcnt lgkmcnt(0)
    v_and_b32 v64, v12, v20
    v_and_b32 v65, v12, v21
    v_and_b32 v66, v12, v22
    v_and_b32 v67, v12, v23
    v_and_b32 v68, v13, v20
    v_and_b32 v69, v13, v21
    v_and_b32 v70, v13, v22
    v_and_b32 v71, v13, v23
    v_and_b32 v72, v14, v20
    v_and_b32 v73, v14, v21
    v_and_b32 v74, v14, v22
    v_and_b32 v75, v14, v23
    v_and_b32 v76, v15, v20
    v_and_b32 v77, v15, v21
    v_and_b32 v78, v15, v22
    v_and_b32 v79, v15, v23
    v_and_b32 v80, v16, v20
    v_and_b32 v81, v16, v21
    v_and_b32 v82, v16, v22
    v_and_b32 v83, v16, v23
    v_and_b32 v84, v17, v20
    v_and_b32 v85, v17, v21
    v_and_b32 v86, v17, v22
    v_and_b32 v87, v17, v23
    v_and_b32 v88, v18, v20
    v_and_b32 v89, v18, v21
    v_and_b32 v90, v18, v22
    v_and_b32 v91, v18, v23
    v_and_b32 v92, v19, v20
    v_and_b32 v93, v19, v21
    v_and_b32 v94, v19, v22
    v_and_b32 v95, v19, v23
    s_waitcnt vmcnt(4)
L_h3_c0:
    v_mfma_f32_16x16x32_bf16 v[28:31], v[64:67], v[32:35], 0
    v_mfma_f32_16x16x32_bf16 v[28:31], v[68:71], v[36:39], v[28:31]
    v_mfma_f32_16x16x32_bf16 v[28:31], v[72:75], v[40:43], v[28:31]
    v_mfma_f32_16x16x32_bf16 v[28:31], v[76:79], v[44:47], v[28:31]
    v_max3_u32 v12, v32, v33, v34
    v_max3_u32 v12, v12, v35, v36
    v_max3_u32 v12, v12, v37, v38
    v_max3_u32 v12, v12, v39, v40
    v_max3_u32 v12, v12, v41, v42
    v_max3_u32 v12, v12, v43, v44
    v_max3_u32 v12, v12, v45, v46
    v_max_u32 v12, v12, v47
    v_cmp_eq_u32 vcc, -1, v12
    s_cbranch_vccnz L_h3_r0
    s_waitcnt vmcnt(0)
L_h3_c1:
    v_mfma_f32_16x16x32_bf16 v[96:99], v[80:83], v[48:51], 0
    v_mfma_f32_16x16x32_bf16 v[96:99], v[84:87], v[52:55], v[96:99]
    v_mfma_f32_16x16x32_bf16 v[96:99], v[88:91], v[56:59], v[96:99]
    v_mfma_f32_16x16x32_bf16 v[96:99], v[92:95], v[60:63], v[96:99]
    v_max3_u32 v12, v48, v49, v50
    v_max3_u32 v12, v12, v51, v52
    v_max3_u32 v12, v12, v53, v54
    v_max3_u32 v12, v12, v55, v56
    v_max3_u32 v12, v12, v57, v58
    v_max3_u32 v12, v12, v59, v60
    v_max3_u32 v12, v12, v61, v62
    v_max_u32 v12, v12, v63
    v_cmp_eq_u32 vcc, -1, v12
    s_cbranch_vccnz L_h3_r1
    v_permlane32_swap_b32 v28, v30
    v_permlane32_swap_b32 v29, v31
    v_add_f32 v28, v28, v30
    v_add_f32_e64 v29, v29, v31
    v_cvt_pk_bf16_f32 v12, v28, 0
    v_cvt_pk_bf16_f32 v13, v29, 0
    v_cvt_pk_bf16_f32 v14, 0, v28
    v_cvt_pk_bf16_f32 v15, 0, v29
    ds_write2_b64 v26, v[12:13], v[14:15] offset0:0 offset1:66
    v_permlane32_swap_b32 v96, v98
    v_permlane32_swap_b32 v97, v99
    v_add_f32 v96, v96, v98
    v_add_f32 v97, v97, v99
    v_cvt_pk_bf16_f32 v16, v96, 0
    v_cvt_pk_bf16_f32 v17, v97, 0
    v_cvt_pk_bf16_f32 v18, 0, v96
    v_cvt_pk_bf16_f32 v19, 0, v97
    ds_write2_b64 v27, v[16:17], v[18:19] offset0:0 offset1:66
    v_mov_b32 v28, 1
    s_mov_b64 exec, 1
    ds_add_u32 v0, v28 offset:6048
    s_mov_b64 exec, -1
    s_and_b32 s38, s35, 27
    s_cmp_lg_u32 s38, s33
    s_cbranch_scc1 L_end
    s_waitcnt lgkmcnt(0)
L_A_F:
    s_mov_b32 s44, s4
    s_mov_b32 s45, s5
    s_mov_b32 s46, 8192
    s_mov_b32 s47, 0x20000

    v_bfe_u32 v17, v1, 3, 1
    v_cmp_eq_u32 vcc, v17, v10
    v_mov_b32 v12, 0x3f803f80
    s_nop 0
    v_cndmask_b32 v12, 0, v12, vcc
    v_and_b32 v20, v12, v20
    v_and_b32 v21, v12, v21
    v_and_b32 v22, v12, v22
    v_and_b32 v23, v12, v23
    v_and_b32 v12, 1, v6
    v_lshlrev_b32 v13, 3, v12
    v_lshl_add_u32 v13, v3, 4, v13
    v_lshl_add_u32 v16, v10, 12, v13
    s_lshl_b32 s38, s62, 10
    s_lshl_b32 s39, s33, 8
    s_add_u32 s48, s38, s39
    buffer_load_dwordx2 v[128:129], v16, s[44:47], s48 offen
    s_cmp_lt_u32 s34, 4
    s_cselect_b32 s50, 65536, 0

    s_add_u32 s49, s48, 1179648
    buffer_load_dwordx2 v[96:97], v16, s[40:43], s49 offen sc1
    s_add_u32 s49, s49, 8192
    buffer_load_dwordx2 v[98:99], v16, s[40:43], s49 offen sc1
    s_add_u32 s49, s49, 8192
    buffer_load_dwordx2 v[100:101], v16, s[40:43], s49 offen sc1
    s_add_u32 s49, s49, 8192
    buffer_load_dwordx2 v[102:103], v16, s[40:43], s49 offen sc1
    s_add_u32 s49, s49, 8192
    s_add_u32 s49, s49, s50
    s_nop 0
    buffer_load_dwordx2 v[104:105], v16, s[40:43], s49 offen sc1
    s_add_u32 s49, s49, 8192
    buffer_load_dwordx2 v[106:107], v16, s[40:43], s49 offen sc1
    s_add_u32 s49, s49, 8192
    buffer_load_dwordx2 v[108:109], v16, s[40:43], s49 offen sc1
    s_add_u32 s49, s49, 8192
    buffer_load_dwordx2 v[110:111], v16, s[40:43], s49 offen sc1
    s_add_u32 s49, s49, 8192
    s_sub_u32 s49, s49, s50
    s_nop 0
    buffer_load_dwordx2 v[112:113], v16, s[40:43], s49 offen sc1
    s_add_u32 s49, s49, 8192
    buffer_load_dwordx2 v[114:115], v16, s[40:43], s49 offen sc1
    s_add_u32 s49, s49, 8192
    buffer_load_dwordx2 v[116:117], v16, s[40:43], s49 offen sc1
    s_add_u32 s49, s49, 8192
    buffer_load_dwordx2 v[118:119], v16, s[40:43], s49 offen sc1
    s_add_u32 s49, s49, 8192

    s_lshl_b32 s53, s62, 15
    s_add_u32 s53, s53, s39
    s_add_u32 s56, s53, 1572864
    s_add_u32 s53, s53, 1310720
    s_and_b32 s38, s35, 8
    s_lshl_b32 s38, s38, 9
    s_add_u32 s56, s56, s38
    s_xor_b32 s57, s56, 4096
    s_xor_b32 s58, s56, 8192
    s_xor_b32 s59, s56, 12288
    v_lshlrev_b32 v5, 17, v10
    v_lshl_add_u32 v5, v3, 4, v5
    v_lshl_add_u32 v7, v12, 13, v5
    s_add_u32 s38, s39, 131072
    v_mul_u32_u24 v24, 2176, v10
    v_add3_u32 v25, v24, v13, s38
    s_lshl_b32 s38, s33, 2
    s_add_u32 s38, s38, 149504
    v_lshl_add_u32 v26, v6, 4, s38
    v_add_u32 v24, v24, v25
    v_add_u32 v24, 4352, v24
    v_add_u32 v27, 2176, v24
    s_and_b32 s60, s36, 3
    s_lshl2_add_u32 s60, s60, s33
    s_lshl_b32 s60, s60, 12
    s_add_u32 s60, s60, 983040
    v_and_b32 v13, 3, v1
    v_lshlrev_b32 v13, 10, v13
    s_lshl_b32 s38, s36, 7
    v_add_u32 v13, s38, v13
    s_mov_b32 s51, 15
    buffer_load_dword v18, v13, s[40:43], s60 offen sc1
    s_branch L_A_md1
L_A_md:
    s_sleep 4
    s_add_u32 s49, s48, 1179648
    buffer_load_dwordx2 v[96:97], v16, s[40:43], s49 offen sc1
    s_add_u32 s49, s49, 8192
    buffer_load_dwordx2 v[98:99], v16, s[40:43], s49 offen sc1
    s_add_u32 s49, s49, 8192
    buffer_load_dwordx2 v[100:101], v16, s[40:43], s49 offen sc1
    s_add_u32 s49, s49, 8192
    buffer_load_dwordx2 v[102:103], v16, s[40:43], s49 offen sc1
    s_add_u32 s49, s49, 8192
    s_add_u32 s49, s49, s50
    s_nop 0
    buffer_load_dwordx2 v[104:105], v16, s[40:43], s49 offen sc1
    s_add_u32 s49, s49, 8192
    buffer_load_dwordx2 v[106:107], v16, s[40:43], s49 offen sc1
    s_add_u32 s49, s49, 8192
    buffer_load_dwordx2 v[108:109], v16, s[40:43], s49 offen sc1
    s_add_u32 s49, s49, 8192
    buffer_load_dwordx2 v[110:111], v16, s[40:43], s49 offen sc1
    s_add_u32 s49, s49, 8192
    s_sub_u32 s49, s49, s50
    s_nop 0
    buffer_load_dwordx2 v[112:113], v16, s[40:43], s49 offen sc1
    s_add_u32 s49, s49, 8192
    buffer_load_dwordx2 v[114:115], v16, s[40:43], s49 offen sc1
    s_add_u32 s49, s49, 8192
    buffer_load_dwordx2 v[116:117], v16, s[40:43], s49 offen sc1
    s_add_u32 s49, s49, 8192
    buffer_load_dwordx2 v[118:119], v16, s[40:43], s49 offen sc1
    s_add_u32 s49, s49, 8192
    s_sub_u32 s3, s3, 1
    s_cbranch_scc1 L_end
L_A_md1:
    s_waitcnt vmcnt(0)
    s_nop 0
    v_max3_u32 v15, v96, v97, v98
    v_max3_u32 v15, v15, v99, v100
    v_max3_u32 v15, v15, v101, v102
    v_max3_u32 v15, v15, v103, v104
    v_max3_u32 v15, v15, v105, v106
    v_max3_u32 v15, v15, v107, v108
    v_max3_u32 v15, v15, v109, v110
    v_max3_u32 v15, v15, v111, v112
    v_max3_u32 v15, v15, v113, v114
    v_max3_u32 v15, v15, v115, v116
    v_max3_u32 v15, v15, v117, v118
    v_max_u32 v15, v15, v119
    v_cmp_eq_u32 vcc, -1, v15
    s_cbranch_vccnz L_A_md
    s_mov_b32 s52, 1
    v_cmp_eq_u32 vcc, -1, v18
    s_cbranch_vccz L_A_h4s
    s_mov_b32 s52, 0
    v_lshlrev_b32 v140, 16, v128
    v_and_b32 v141, 0xffff0000, v128
    v_lshlrev_b32 v142, 16, v129
    v_and_b32 v143, 0xffff0000, v129
    v_lshlrev_b32 v152, 16, v112
    v_and_b32 v153, 0xffff0000, v112
    v_lshlrev_b32 v154, 16, v113
    v_and_b32 v155, 0xffff0000, v113
    v_lshlrev_b32 v14, 16, v114
    v_and_b32 v15, 0xffff0000, v114
    v_pk_add_f32 v[152:153], v[152:153], v[14:15]
    v_lshlrev_b32 v14, 16, v115
    v_and_b32 v15, 0xffff0000, v115
    v_pk_add_f32 v[154:155], v[154:155], v[14:15]
    v_lshlrev_b32 v14, 16, v116
    v_and_b32 v15, 0xffff0000, v116
    v_pk_add_f32 v[152:153], v[152:153], v[14:15]
    v_lshlrev_b32 v14, 16, v117
    v_and_b32 v15, 0xffff0000, v117
    v_pk_add_f32 v[154:155], v[154:155], v[14:15]
    v_lshlrev_b32 v14, 16, v118
    v_and_b32 v15, 0xffff0000, v118
    v_pk_add_f32 v[152:153], v[152:153], v[14:15]
    v_lshlrev_b32 v14, 16, v119
    v_and_b32 v15, 0xffff0000, v119
    v_pk_add_f32 v[154:155], v[154:155], v[14:15]
    v_lshlrev_b32 v148, 16, v104
    v_and_b32 v149, 0xffff0000, v104
    v_lshlrev_b32 v150, 16, v105
    v_and_b32 v151, 0xffff0000, v105
    v_lshlrev_b32 v14, 16, v106
    v_and_b32 v15, 0xffff0000, v106
    v_pk_add_f32 v[148:149], v[148:149], v[14:15]
    v_lshlrev_b32 v14, 16, v107
    v_and_b32 v15, 0xffff0000, v107
    v_pk_add_f32 v[150:151], v[150:151], v[14:15]
    v_lshlrev_b32 v14, 16, v108
    v_and_b32 v15, 0xffff0000, v108
    v_pk_add_f32 v[148:149], v[148:149], v[14:15]
    v_lshlrev_b32 v14, 16, v109
    v_and_b32 v15, 0xffff0000, v109
    v_pk_add_f32 v[150:151], v[150:151], v[14:15]
    v_lshlrev_b32 v14, 16, v110
    v_and_b32 v15, 0xffff0000, v110
    v_pk_add_f32 v[148:149], v[148:149], v[14:15]
    v_lshlrev_b32 v14, 16, v111
    v_and_b32 v15, 0xffff0000, v111
    v_pk_add_f32 v[150:151], v[150:151], v[14:15]
    v_add_f32 v152, 1.0, v152
    v_add_f32 v153, 1.0, v153
    v_add_f32 v154, 1.0, v154
    v_add_f32 v155, 1.0, v155
    s_cmp_lt_u32 s34, 4
    s_cbranch_scc1 L_nk15
    v_cvt_pk_bf16_f32 v120, v152, v153
    v_cvt_pk_bf16_f32 v121, v154, v155
    v_lshlrev_b32 v124, 16, v120
    v_and_b32 v125, 0xffff0000, v120
    v_lshlrev_b32_e64 v126, 16, v121
    v_and_b32 v127, 0xffff0000, v121
    v_pk_add_f32 v[124:125], v[152:153], v[124:125] neg_lo:[0,1] neg_hi:[0,1]
    v_pk_add_f32 v[126:127], v[154:155], v[126:127] neg_lo:[0,1] neg_hi:[0,1]
    v_cvt_pk_bf16_f32 v122, v124, v125
    v_cvt_pk_bf16_f32 v123, v126, v127
    ds_write2_b64 v24, v[120:121], v[122:123] offset0:0 offset1:136
    v_cvt_pk_bf16_f32 v130, v148, v149
    v_cvt_pk_bf16_f32 v131, v150, v151
    v_lshlrev_b32 v134, 16, v130
    v_and_b32 v135, 0xffff0000, v130
    v_lshlrev_b32 v136, 16, v131
    v_and_b32 v137, 0xffff0000, v131
    v_pk_add_f32 v[134:135], v[148:149], v[134:135] neg_lo:[0,1] neg_hi:[0,1]
    v_pk_add_f32 v[136:137], v[150:151], v[136:137] neg_lo:[0,1] neg_hi:[0,1]
    v_cvt_pk_bf16_f32 v132, v134, v135
    v_cvt_pk_bf16_f32 v133, v136, v137
    ds_write2_b64 v27, v[130:131], v[132:133] offset0:0 offset1:136
    v_mov_b32 v14, 1
    s_mov_b64 exec, 1
    ds_add_u32 v0, v14 offset:5048
    s_mov_b64 exec, -1
L_nk15:
    v_lshlrev_b32 v144, 16, v96
    v_and_b32 v145, 0xffff0000, v96
    v_lshlrev_b32 v146, 16, v97
    v_and_b32 v147, 0xffff0000, v97
    v_lshlrev_b32 v14, 16, v98
    v_and_b32 v15, 0xffff0000, v98
    v_pk_add_f32 v[144:145], v[144:145], v[14:15]
    v_lshlrev_b32 v14, 16, v99
    v_and_b32 v15, 0xffff0000, v99
    v_pk_add_f32 v[146:147], v[146:147], v[14:15]
    v_lshlrev_b32 v14, 16, v100
    v_and_b32 v15, 0xffff0000, v100
    v_pk_add_f32 v[144:145], v[144:145], v[14:15]
    v_lshlrev_b32 v14, 16, v101
    v_and_b32 v15, 0xffff0000, v101
    v_pk_add_f32 v[146:147], v[146:147], v[14:15]
    v_lshlrev_b32 v14, 16, v102
    v_and_b32 v15, 0xffff0000, v102
    v_pk_add_f32 v[144:145], v[144:145], v[14:15]
    v_lshlrev_b32_e64 v14, 16, v103
    v_and_b32 v15, 0xffff0000, v103
    v_pk_add_f32 v[146:147], v[146:147], v[14:15]
    v_pk_mul_f32 v[156:157], v[144:145], v[152:153]
    v_pk_mul_f32 v[152:153], v[140:141], v[152:153]
    v_pk_mul_f32 v[158:159], v[146:147], v[154:155]
    v_pk_mul_f32 v[154:155], v[142:143], v[154:155]
    s_mov_b32 exec_lo, s51
    s_mov_b32 exec_hi, 0
L_A_hint1:
    buffer_load_dword v12, v13, s[40:43], s60 offen sc1
    s_sub_u32 s3, s3, 1
    s_cbranch_scc1 L_end
    s_waitcnt vmcnt(0)
    v_cmp_eq_u32_e64 vcc, -1, v12
    s_mov_b64 exec, vcc
    s_cbranch_vccnz L_A_hint1
    s_mov_b64 exec, -1
L_A_h4s:
    buffer_load_dwordx4 v[32:35], v7, s[40:43], s56 offen offset:0 sc1
    buffer_load_dwordx4 v[36:39], v7, s[40:43], s56 offen offset:1024 sc1
    buffer_load_dwordx4 v[40:43], v7, s[40:43], s56 offen offset:2048 sc1
    buffer_load_dwordx4 v[44:47], v7, s[40:43], s56 offen offset:3072 sc1
    buffer_load_dwordx4 v[48:51], v7, s[40:43], s57 offen offset:0 sc1
    buffer_load_dwordx4 v[52:55], v7, s[40:43], s57 offen offset:1024 sc1
    buffer_load_dwordx4 v[56:59], v7, s[40:43], s57 offen offset:2048 sc1
    buffer_load_dwordx4 v[60:63], v7, s[40:43], s57 offen offset:3072 sc1
    s_cmp_eq_u32 s52, 0
    s_cbranch_scc1 L_A_mu
    v_lshlrev_b32 v140, 16, v128
    v_and_b32 v141, 0xffff0000, v128
    v_lshlrev_b32 v142, 16, v129
    v_and_b32 v143, 0xffff0000, v129
    v_lshlrev_b32 v152, 16, v112
    v_and_b32 v153, 0xffff0000, v112
    v_lshlrev_b32 v154, 16, v113
    v_and_b32 v155, 0xffff0000, v113
    v_lshlrev_b32 v14, 16, v114
    v_and_b32 v15, 0xffff0000, v114
    v_pk_add_f32 v[152:153], v[152:153], v[14:15]
    v_lshlrev_b32 v14, 16, v115
    v_and_b32 v15, 0xffff0000, v115
    v_pk_add_f32 v[154:155], v[154:155], v[14:15]
    v_lshlrev_b32 v14, 16, v116
    v_and_b32 v15, 0xffff0000, v116
    v_pk_add_f32 v[152:153], v[152:153], v[14:15]
    v_lshlrev_b32 v14, 16, v117
    v_and_b32 v15, 0xffff0000, v117
    v_pk_add_f32 v[154:155], v[154:155], v[14:15]
    v_lshlrev_b32 v14, 16, v118
    v_and_b32 v15, 0xffff0000, v118
    v_pk_add_f32 v[152:153], v[152:153], v[14:15]
    v_lshlrev_b32 v14, 16, v119
    v_and_b32 v15, 0xffff0000, v119
    v_pk_add_f32 v[154:155], v[154:155], v[14:15]
    v_lshlrev_b32 v148, 16, v104
    v_and_b32 v149, 0xffff0000, v104
    v_lshlrev_b32 v150, 16, v105
    v_and_b32 v151, 0xffff0000, v105
    v_lshlrev_b32 v14, 16, v106
    v_and_b32 v15, 0xffff0000, v106
    v_pk_add_f32 v[148:149], v[148:149], v[14:15]
    v_lshlrev_b32 v14, 16, v107
    v_and_b32 v15, 0xffff0000, v107
    v_pk_add_f32 v[150:151], v[150:151], v[14:15]
    v_lshlrev_b32 v14, 16, v108
    v_and_b32 v15, 0xffff0000, v108
    v_pk_add_f32 v[148:149], v[148:149], v[14:15]
    v_lshlrev_b32 v14, 16, v109
    v_and_b32 v15, 0xffff0000, v109
    v_pk_add_f32 v[150:151], v[150:151], v[14:15]
    v_lshlrev_b32 v14, 16, v110
    v_and_b32 v15, 0xffff0000, v110
    v_pk_add_f32 v[148:149], v[148:149], v[14:15]
    v_lshlrev_b32 v14, 16, v111
    v_and_b32 v15, 0xffff0000, v111
    v_pk_add_f32 v[150:151], v[150:151], v[14:15]
    v_add_f32 v152, 1.0, v152
    v_add_f32 v153, 1.0, v153
    v_add_f32 v154, 1.0, v154
    v_add_f32 v155, 1.0, v155
    s_cmp_lt_u32 s34, 4
    s_cbranch_scc1 L_nk16
    v_cvt_pk_bf16_f32 v120, v152, v153
    v_cvt_pk_bf16_f32 v121, v154, v155
    v_lshlrev_b32 v124, 16, v120
    v_and_b32 v125, 0xffff0000, v120
    v_lshlrev_b32 v126, 16, v121
    v_and_b32 v127, 0xffff0000, v121
    v_pk_add_f32 v[124:125], v[152:153], v[124:125] neg_lo:[0,1] neg_hi:[0,1]
    v_pk_add_f32 v[126:127], v[154:155], v[126:127] neg_lo:[0,1] neg_hi:[0,1]
    v_cvt_pk_bf16_f32 v122, v124, v125
    v_cvt_pk_bf16_f32 v123, v126, v127
    ds_write2_b64 v24, v[120:121], v[122:123] offset0:0 offset1:136
    v_cvt_pk_bf16_f32 v130, v148, v149
    v_cvt_pk_bf16_f32 v131, v150, v151
    v_lshlrev_b32 v134, 16, v130
    v_and_b32 v135, 0xffff0000, v130
    v_lshlrev_b32 v136, 16, v131
    v_and_b32 v137, 0xffff0000, v131
    v_pk_add_f32 v[134:135], v[148:149], v[134:135] neg_lo:[0,1] neg_hi:[0,1]
    v_pk_add_f32 v[136:137], v[150:151], v[136:137] neg_lo:[0,1] neg_hi:[0,1]
    v_cvt_pk_bf16_f32 v132, v134, v135
    v_cvt_pk_bf16_f32 v133, v136, v137
    ds_write2_b64 v27, v[130:131], v[132:133] offset0:0 offset1:136
    v_mov_b32 v14, 1
    s_mov_b64 exec, 1
    ds_add_u32 v0, v14 offset:5048
    s_mov_b64 exec, -1
L_nk16:
    v_lshlrev_b32 v144, 16, v96
    v_and_b32 v145, 0xffff0000, v96
    v_lshlrev_b32 v146, 16, v97
    v_and_b32 v147, 0xffff0000, v97
    v_lshlrev_b32 v14, 16, v98
    v_and_b32 v15, 0xffff0000, v98
    v_pk_add_f32 v[144:145], v[144:145], v[14:15]
    v_lshlrev_b32 v14, 16, v99
    v_and_b32 v15, 0xffff0000, v99
    v_pk_add_f32 v[146:147], v[146:147], v[14:15]
    v_lshlrev_b32 v14, 16, v100
    v_and_b32 v15, 0xffff0000, v100
    v_pk_add_f32 v[144:145], v[144:145], v[14:15]
    v_lshlrev_b32 v14, 16, v101
    v_and_b32 v15, 0xffff0000, v101
    v_pk_add_f32 v[146:147], v[146:147], v[14:15]
    v_lshlrev_b32 v14, 16, v102
    v_and_b32 v15, 0xffff0000, v102
    v_pk_add_f32 v[144:145], v[144:145], v[14:15]
    v_lshlrev_b32_e64 v14, 16, v103
    v_and_b32 v15, 0xffff0000, v103
    v_pk_add_f32 v[146:147], v[146:147], v[14:15]
    v_pk_mul_f32 v[156:157], v[144:145], v[152:153]
    v_pk_mul_f32 v[152:153], v[140:141], v[152:153]
    v_pk_mul_f32 v[158:159], v[146:147], v[154:155]
    v_pk_mul_f32 v[154:155], v[142:143], v[154:155]
L_A_mu:
    v_mov_b32 v28, 0
    v_mov_b32 v29, 0
    v_mov_b32 v30, 0
    v_mov_b32 v31, 0
    s_mov_b32 s63, 0
    s_waitcnt vmcnt(6)
    v_max3_u32 v12, v32, v33, v34
    v_max3_u32 v12, v12, v35, v36
    v_max3_u32 v12, v12, v37, v38
    v_max_u32 v12, v12, v39
    v_cmp_eq_u32 vcc, -1, v12
    s_cbranch_vccnz L_h4_f0
    v_mfma_f32_16x16x32_bf16 v[28:31], v[20:23], v[32:35], v[28:31]
    v_mfma_f32_16x16x32_bf16 v[28:31], v[20:23], v[36:39], v[28:31]
L_h4_n0:
    s_waitcnt vmcnt(4)
    v_max3_u32 v12, v40, v41, v42
    v_max3_u32 v12, v12, v43, v44
    v_max3_u32 v12, v12, v45, v46
    v_max_u32 v12, v12, v47
    v_cmp_eq_u32 vcc, -1, v12
    s_cbranch_vccnz L_h4_f2
    v_mfma_f32_16x16x32_bf16 v[28:31], v[20:23], v[40:43], v[28:31]
    v_mfma_f32_16x16x32_bf16 v[28:31], v[20:23], v[44:47], v[28:31]
L_h4_n2:
    s_waitcnt vmcnt(2)
    v_max3_u32 v12, v48, v49, v50
    v_max3_u32 v12, v12, v51, v52
    v_max3_u32 v12, v12, v53, v54
    v_max_u32 v12, v12, v55
    v_cmp_eq_u32 vcc, -1, v12
    s_cbranch_vccnz L_h4_f4
    v_mfma_f32_16x16x32_bf16 v[28:31], v[20:23], v[48:51], v[28:31]
    v_mfma_f32_16x16x32_bf16 v[28:31], v[20:23], v[52:55], v[28:31]
L_h4_n4:
    s_waitcnt vmcnt(0)
    v_max3_u32 v12, v56, v57, v58
    v_max3_u32 v12, v12, v59, v60
    v_max3_u32 v12, v12, v61, v62
    v_max_u32 v12, v12, v63
    v_cmp_eq_u32 vcc, -1, v12
    s_cbranch_vccnz L_h4_f6
    v_mfma_f32_16x16x32_bf16 v[28:31], v[20:23], v[56:59], v[28:31]
    v_mfma_f32_16x16x32_bf16 v[28:31], v[20:23], v[60:63], v[28:31]
L_h4_n6:
    s_cmp_lg_u32 s63, 0
    s_cbranch_scc1 L_h4_r
L_h4_d:
    s_cmp_lt_u32 s34, 4
    s_cbranch_scc1 L_A_fin
    v_mov_b32 v14, 1
    s_nop 2
    v_pk_fma_f32 v[152:153], v[28:29], v[156:157], v[152:153]
    v_pk_fma_f32 v[154:155], v[30:31], v[158:159], v[154:155]
    v_cvt_pk_bf16_f32 v32, v152, v153
    v_cvt_pk_bf16_f32 v33, v154, v155
    v_lshlrev_b32 v36, 16, v32
    v_and_b32 v37, 0xffff0000, v32
    v_lshlrev_b32_e64 v38, 16, v33
    v_and_b32 v39, 0xffff0000, v33
    v_pk_add_f32 v[36:37], v[152:153], v[36:37] neg_lo:[0,1] neg_hi:[0,1]
    v_pk_add_f32 v[38:39], v[154:155], v[38:39] neg_lo:[0,1] neg_hi:[0,1]
    v_cvt_pk_bf16_f32 v34, v36, v37
    v_cvt_pk_bf16_f32 v35, v38, v39
    ds_write2_b64 v25, v[32:33], v[34:35] offset0:0 offset1:136
    s_mov_b64 exec, 1
    ds_add_u32 v0, v14 offset:5052
    s_mov_b64 exec, -1
    v_pk_fma_f32 v[28:29], v[28:29], v[144:145], v[140:141]
    v_pk_fma_f32 v[30:31], v[30:31], v[146:147], v[142:143]

    v_add_f32 v12, v28, v29
    v_mul_f32 v13, v28, v28
    v_add_f32 v14, v30, v31
    v_fmac_f32 v13, v29, v29
    v_add_f32 v12, v12, v14
    v_fmac_f32 v13, v30, v30
    v_fmac_f32 v13, v31, v31
    s_nop 1
    v_permlane16_swap_b32 v12, v13
    v_add_f32 v12, v12, v13
    s_nop 1
    v_add_f32_dpp v12, v12, v12 quad_perm:[1,0,3,2] row_mask:0xf bank_mask:0xf
    s_nop 1
    v_add_f32_dpp v12, v12, v12 quad_perm:[2,3,0,1] row_mask:0xf bank_mask:0xf
    s_nop 1
    v_add_f32_dpp v12, v12, v12 row_half_mirror row_mask:0xf bank_mask:0xf
    s_nop 1
    v_add_f32_dpp v12, v12, v12 row_mirror row_mask:0xf bank_mask:0xf
    ds_write_b32 v26, v12
    s_branch L_end
L_A_fin:
    s_nop 3
    v_pk_fma_f32 v[28:29], v[28:29], v[144:145], v[140:141]
    v_pk_fma_f32 v[30:31], v[30:31], v[146:147], v[142:143]
    s_mov_b32 s44, s26
    s_mov_b32 s45, s27
    s_mov_b32 s46, 8192
    s_mov_b32 s47, 0x20000

    v_and_b32 v12, 7, v1
    v_lshlrev_b32 v13, 1, v12
    v_lshrrev_b32 v14, 1, v6
    v_add_u32 v13, v13, v14
    v_and_b32 v14, 1, v6
    v_lshl_add_u32 v13, v14, 4, v13

    v_and_b32 v18, 1, v1
    v_lshlrev_b32 v18, 4, v18
    s_mov_b32 s38, 0xffff
    v_lshlrev_b32 v18, v18, s38
    v_bfe_u32 v19, v1, 1, 2
    v_cmp_eq_u32 vcc, 0, v19
    s_nop 1
    v_cndmask_b32 v20, 0, v18, vcc
    v_cmp_eq_u32 vcc, 1, v19
    s_nop 1
    v_cndmask_b32 v21, 0, v18, vcc
    v_cmp_eq_u32 vcc, 2, v19
    s_nop 1
    v_cndmask_b32 v22, 0, v18, vcc
    v_cmp_eq_u32 vcc, 3, v19
    s_nop 1
    v_cndmask_b32 v23, 0, v18, vcc
    s_mov_b32 s38, 0x3f803f80
    v_and_b32 v20, s38, v20
    v_and_b32 v21, s38, v21
    v_and_b32 v22, s38, v22
    v_and_b32 v23, s38, v23
    s_lshr_b32 s38, s35, 2
    v_mov_b32 v17, s38
    v_lshl_add_u32 v13, v17, 5, v13
    v_lshlrev_b32 v13, 2, v13
    ds_bpermute_b32 v140, v13, v28
    ds_bpermute_b32 v144, v13, v148
    ds_bpermute_b32 v141, v13, v29
    ds_bpermute_b32 v145, v13, v149
    ds_bpermute_b32 v142, v13, v30
    ds_bpermute_b32 v146, v13, v150
    ds_bpermute_b32 v143, v13, v31
    ds_bpermute_b32 v147, v13, v151

    v_lshlrev_b32_e64 v4, 5, v12
    v_lshl_add_u32 v4, v6, 3, v4
    v_lshl_add_u32 v4, v17, 12, v4
    v_mul_u32_u24 v7, 7168, v6
    v_lshl_add_u32 v7, v3, 4, v7
    v_lshl_add_u32 v7, v17, 17, v7
    s_mov_b32 s56, s53
    s_add_u32 s57, s53, 4096
    s_add_u32 s58, s53, 8192
    s_add_u32 s59, s53, 12288
    s_waitcnt lgkmcnt(0)
L_h5:
    buffer_load_dwordx4 v[32:35], v7, s[40:43], s56 offen offset:0 sc1
    buffer_load_dwordx4 v[36:39], v7, s[40:43], s56 offen offset:1024 sc1
    buffer_load_dwordx4 v[40:43], v7, s[40:43], s56 offen offset:2048 sc1
    buffer_load_dwordx4 v[44:47], v7, s[40:43], s56 offen offset:3072 sc1
    buffer_load_dwordx4 v[48:51], v7, s[40:43], s57 offen offset:0 sc1
    buffer_load_dwordx4 v[52:55], v7, s[40:43], s57 offen offset:1024 sc1
    buffer_load_dwordx4 v[56:59], v7, s[40:43], s57 offen offset:2048 sc1
    s_sub_u32 s3, s3, 1
    s_cbranch_scc1 L_end
    s_waitcnt vmcnt(6)
    v_mfma_f32_16x16x32_bf16 v[28:31], v[32:35], v[20:23], 0
    v_max3_u32 v12, v32, v33, v34
    v_max_u32 v12, v12, v35
    s_waitcnt vmcnt(5)
    v_mfma_f32_16x16x32_bf16 v[28:31], v[36:39], v[20:23], v[28:31]
    v_max3_u32 v12, v12, v36, v37
    v_max3_u32 v12, v12, v38, v39
    s_waitcnt vmcnt(4)
    v_mfma_f32_16x16x32_bf16 v[28:31], v[40:43], v[20:23], v[28:31]
    v_max3_u32 v12, v12, v40, v41
    v_max3_u32 v12, v12, v42, v43
    s_waitcnt vmcnt(3)
    v_mfma_f32_16x16x32_bf16 v[28:31], v[44:47], v[20:23], v[28:31]
    v_max3_u32 v12, v12, v44, v45
    v_max3_u32 v12, v12, v46, v47
    s_waitcnt vmcnt(2)
    v_mfma_f32_16x16x32_bf16 v[28:31], v[48:51], v[20:23], v[28:31]
    v_max3_u32 v12, v12, v48, v49
    v_max3_u32 v12, v12, v50, v51
    s_waitcnt vmcnt(1)
    v_mfma_f32_16x16x32_bf16 v[28:31], v[52:55], v[20:23], v[28:31]
    v_max3_u32 v12, v12, v52, v53
    v_max3_u32 v12, v12, v54, v55
    s_waitcnt vmcnt(0)
    v_mfma_f32_16x16x32_bf16 v[28:31], v[56:59], v[20:23], v[28:31]
    v_max3_u32 v12, v12, v56, v57
    v_max3_u32 v12, v12, v58, v59
    v_cmp_eq_u32_e64 vcc, -1, v12
    s_cbranch_vccnz L_h5
    s_mov_b32 exec_lo, 0x00ff00ff
    s_mov_b32 exec_hi, 0x00ff00ff
    s_nop 1
    v_fma_f32 v28, v28, v144, v140
    v_fma_f32 v29, v29, v145, v141
    v_fma_f32 v30, v30, v146, v142
    v_fma_f32 v31, v31, v147, v143
    v_cvt_pk_bf16_f32 v28, v28, v29
    v_cvt_pk_bf16_f32 v29, v30, v31
    buffer_store_dwordx2 v[28:29], v4, s[44:47], s48 offen
    s_branch L_end
L_h4_f0:
    buffer_load_dwordx4 v[32:35], v7, s[40:43], s56 offen offset:0 sc1
    buffer_load_dwordx4 v[36:39], v7, s[40:43], s56 offen offset:1024 sc1
    s_mov_b64 exec, -1
    s_bitset1_b32 s63, 0
    s_branch L_h4_n0
L_h4_f2:
    buffer_load_dwordx4 v[40:43], v7, s[40:43], s56 offen offset:2048 sc1
    buffer_load_dwordx4 v[44:47], v7, s[40:43], s56 offen offset:3072 sc1
    s_mov_b64 exec, -1
    s_bitset1_b32 s63, 2
    s_branch L_h4_n2
L_h4_f4:
    buffer_load_dwordx4 v[48:51], v7, s[40:43], s57 offen offset:0 sc1
    buffer_load_dwordx4 v[52:55], v7, s[40:43], s57 offen offset:1024 sc1
    s_mov_b64 exec, -1
    s_bitset1_b32 s63, 4
    s_branch L_h4_n4
L_h4_f6:
    buffer_load_dwordx4 v[56:59], v7, s[40:43], s57 offen offset:2048 sc1
    buffer_load_dwordx4 v[60:63], v7, s[40:43], s57 offen offset:3072 sc1
    s_mov_b64 exec, -1
    s_bitset1_b32 s63, 6
    s_branch L_h4_n6
L_h4_r:
    s_sub_u32 s3, s3, 1
    s_cbranch_scc1 L_end
    s_waitcnt vmcnt(0)
    s_bitcmp1_b32 s63, 0
    s_cbranch_scc0 L_h4_s0
    v_max3_u32 v12, v32, v33, v34
    v_max3_u32 v12, v12, v35, v36
    v_max3_u32 v12, v12, v37, v38
    v_max_u32 v12, v12, v39
    v_cmp_eq_u32 vcc, -1, v12
    s_cbranch_vccz L_h4_g0
    buffer_load_dwordx4 v[32:35], v7, s[40:43], s56 offen offset:0 sc1
    buffer_load_dwordx4 v[36:39], v7, s[40:43], s56 offen offset:1024 sc1
    s_mov_b64 exec, -1
    s_branch L_h4_s0
L_h4_g0:
    s_bitset0_b32 s63, 0
    v_mfma_f32_16x16x32_bf16 v[28:31], v[20:23], v[32:35], v[28:31]
    v_mfma_f32_16x16x32_bf16 v[28:31], v[20:23], v[36:39], v[28:31]
L_h4_s0:
    s_bitcmp1_b32 s63, 2
    s_cbranch_scc0 L_h4_s2
    v_max3_u32 v12, v40, v41, v42
    v_max3_u32 v12, v12, v43, v44
    v_max3_u32 v12, v12, v45, v46
    v_max_u32 v12, v12, v47
    v_cmp_eq_u32 vcc, -1, v12
    s_cbranch_vccz L_h4_g2
    buffer_load_dwordx4 v[40:43], v7, s[40:43], s56 offen offset:2048 sc1
    buffer_load_dwordx4 v[44:47], v7, s[40:43], s56 offen offset:3072 sc1
    s_mov_b64 exec, -1
    s_branch L_h4_s2
L_h4_g2:
    s_bitset0_b32 s63, 2
    v_mfma_f32_16x16x32_bf16 v[28:31], v[20:23], v[40:43], v[28:31]
    v_mfma_f32_16x16x32_bf16 v[28:31], v[20:23], v[44:47], v[28:31]
L_h4_s2:
    s_bitcmp1_b32 s63, 4
    s_cbranch_scc0 L_h4_s4
    v_max3_u32 v12, v48, v49, v50
    v_max3_u32 v12, v12, v51, v52
    v_max3_u32 v12, v12, v53, v54
    v_max_u32 v12, v12, v55
    v_cmp_eq_u32 vcc, -1, v12
    s_cbranch_vccz L_h4_g4
    buffer_load_dwordx4 v[48:51], v7, s[40:43], s57 offen offset:0 sc1
    buffer_load_dwordx4 v[52:55], v7, s[40:43], s57 offen offset:1024 sc1
    s_mov_b64 exec, -1
    s_branch L_h4_s4
L_h4_g4:
    s_bitset0_b32 s63, 4
    v_mfma_f32_16x16x32_bf16 v[28:31], v[20:23], v[48:51], v[28:31]
    v_mfma_f32_16x16x32_bf16 v[28:31], v[20:23], v[52:55], v[28:31]
L_h4_s4:
    s_bitcmp1_b32 s63, 6
    s_cbranch_scc0 L_h4_s6
    v_max3_u32 v12, v56, v57, v58
    v_max3_u32 v12, v12, v59, v60
    v_max3_u32 v12, v12, v61, v62
    v_max_u32 v12, v12, v63
    v_cmp_eq_u32_e64 vcc, -1, v12
    s_cbranch_vccz L_h4_g6
    buffer_load_dwordx4 v[56:59], v7, s[40:43], s57 offen offset:2048 sc1
    buffer_load_dwordx4 v[60:63], v7, s[40:43], s57 offen offset:3072 sc1
    s_mov_b64 exec, -1
    s_branch L_h4_s6
L_h4_g6:
    s_bitset0_b32 s63, 6
    v_mfma_f32_16x16x32_bf16 v[28:31], v[20:23], v[56:59], v[28:31]
    v_mfma_f32_16x16x32_bf16 v[28:31], v[20:23], v[60:63], v[28:31]
L_h4_s6:
    s_cmp_lg_u32 s63, 0
    s_cbranch_scc1 L_h4_r
    s_branch L_h4_d
L_h3_r0:
    buffer_load_dwordx4 v[32:35], v7, s[40:43], s51 offen offset:0 sc1
    buffer_load_dwordx4 v[36:39], v7, s[40:43], s51 offen offset:1024 sc1
    buffer_load_dwordx4 v[40:43], v7, s[40:43], s51 offen offset:2048 sc1
    buffer_load_dwordx4 v[44:47], v7, s[40:43], s51 offen offset:3072 sc1
    buffer_load_dwordx4 v[48:51], v7, s[40:43], s52 offen offset:0 sc1
    buffer_load_dwordx4 v[52:55], v7, s[40:43], s52 offen offset:1024 sc1
    buffer_load_dwordx4 v[56:59], v7, s[40:43], s52 offen offset:2048 sc1
    buffer_load_dwordx4 v[60:63], v7, s[40:43], s52 offen offset:3072 sc1
    s_sub_u32 s3, s3, 1
    s_cbranch_scc1 L_end
    s_waitcnt vmcnt(4)
    s_branch L_h3_c0
L_h3_r1:
    buffer_load_dwordx4 v[48:51], v7, s[40:43], s52 offen offset:0 sc1
    buffer_load_dwordx4 v[52:55], v7, s[40:43], s52 offen offset:1024 sc1
    buffer_load_dwordx4 v[56:59], v7, s[40:43], s52 offen offset:2048 sc1
    buffer_load_dwordx4 v[60:63], v7, s[40:43], s52 offen offset:3072 sc1
    s_sub_u32 s3, s3, 1
    s_cbranch_scc1 L_end
    s_waitcnt vmcnt(0)
    s_branch L_h3_c1
L_Bc:
    s_cmp_lg_u32 s34, 0
    s_cbranch_scc1 L_B_go
    s_lshl2_add_u32 s55, s36, s37

    v_lshrrev_b32 v2, 2, v1
    v_mul_u32_u24 v4, 6144, v2
    v_lshrrev_b32 v2, 5, v1
    v_bfe_u32 v5, v1, 1, 1
    v_xor_b32 v2, v2, v5
    v_lshl_add_u32 v4, v2, 10, v4
    v_and_b32 v2, 1, v1
    v_lshl_add_u32 v4, v2, 4, v4
    s_mul_i32 s58, s33, 786432
    s_lshl_b32 s39, s55, 5
    s_add_u32 s58, s58, s39
    s_lshl_b32 s59, s33, 13
    s_add_u32 m0, s59, 65536
    s_waitcnt lgkmcnt(0)
    s_mov_b32 s44, s24
    s_mov_b32 s45, s25
    s_mov_b32 s46, 3145728
    s_mov_b32 s47, 0x20000

    s_mov_b32 s3, 0x400000
    v_mov_b32 v0, 156256
    s_and_b32 s62, s34, 3
    s_lshl2_add_u32 s97, s62, s37
    s_lshl4_add_u32 s61, s36, s97
    s_waitcnt lgkmcnt(0)

    s_mov_b32 s40, s30
    s_mov_b32 s41, s31
    s_mov_b32 s42, 16777216
    s_mov_b32 s43, 0x20000
    s_barrier
    buffer_load_dwordx4 v4, s[44:47], s58 offen lds
    s_add_u32 m0, m0, 1024
    s_add_u32 s58, s58, 98304
    buffer_load_dwordx4 v4, s[44:47], s58 offen lds
    s_add_u32 m0, m0, 1024
    s_add_u32 s58, s58, 98304
    buffer_load_dwordx4 v4, s[44:47], s58 offen lds
    s_add_u32 m0, m0, 1024
    s_add_u32 s58, s58, 98304
    buffer_load_dwordx4 v4, s[44:47], s58 offen lds
    s_add_u32 m0, m0, 1024
    s_add_u32 s58, s58, 98304
    buffer_load_dwordx4 v4, s[44:47], s58 offen lds
    s_add_u32 m0, m0, 1024
    s_add_u32 s58, s58, 98304
    buffer_load_dwordx4 v4, s[44:47], s58 offen lds
    s_add_u32 m0, m0, 1024
    s_add_u32 s58, s58, 98304
    buffer_load_dwordx4 v4, s[44:47], s58 offen lds
    s_add_u32 m0, m0, 1024
    s_add_u32 s58, s58, 98304
    buffer_load_dwordx4 v4, s[44:47], s58 offen lds
    s_add_u32 m0, m0, 1024
    s_add_u32 s58, s58, 98304
    v_mov_b32 v6, 1
    s_mov_b64 exec, 1
    ds_add_u32 v0, v6 offset:7056
    s_mov_b64 exec, -1
    s_lshl_b32 s38, s33, 2
    v_add_u32 v5, s38, v0
    v_mov_b32 v7, 2
    s_waitcnt vmcnt(4)
    ds_write_b32 v5, v6 offset:4032
    s_waitcnt vmcnt(0)
    ds_write_b32 v5, v7 offset:4032
    s_branch L_B_t
L_B_go:
    s_lshl_b32 s48, s33, 20
    s_lshl_b32 s38, s35, 8
    s_add_u32 s48, s48, s38
    s_and_b32 s49, s34, 3
    v_lshrrev_b32 v4, 4, v1
    v_and_b32 v5, 15, v1
    v_lshlrev_b32 v2, 18, v4
    v_lshl_add_u32 v2, v5, 4, v2
    s_waitcnt lgkmcnt(0)
    s_mov_b32 s44, s8
    s_mov_b32 s45, s9
    s_mov_b32 s46, 4194304
    s_mov_b32 s47, 0x20000
    s_xor_b32 s38, s49, 0
    s_lshl_b32 s38, s38, 16
    s_add_u32 s38, s38, s48
    buffer_load_dwordx4 v[40:43], v2, s[44:47], s38 offen
    s_add_u32 s38, s38, 8192
    buffer_load_dwordx4 v[44:47], v2, s[44:47], s38 offen
    s_add_u32 s38, s38, 8192
    buffer_load_dwordx4 v[48:51], v2, s[44:47], s38 offen
    s_add_u32 s38, s38, 8192
    buffer_load_dwordx4 v[52:55], v2, s[44:47], s38 offen
    s_add_u32 s38, s38, 8192
    buffer_load_dwordx4 v[56:59], v2, s[44:47], s38 offen
    s_add_u32 s38, s38, 8192
    buffer_load_dwordx4 v[60:63], v2, s[44:47], s38 offen
    s_add_u32 s38, s38, 8192
    buffer_load_dwordx4 v[64:67], v2, s[44:47], s38 offen
    s_add_u32 s38, s38, 8192
    buffer_load_dwordx4 v[68:71], v2, s[44:47], s38 offen

    s_mov_b32 s3, 0x400000
    v_mov_b32 v0, 156256
    s_and_b32 s62, s34, 3
    s_lshl2_add_u32 s97, s62, s37
    s_lshl4_add_u32 s61, s36, s97
    s_waitcnt lgkmcnt(0)

    s_mov_b32 s40, s30
    s_mov_b32 s41, s31
    s_mov_b32 s42, 16777216
    s_mov_b32 s43, 0x20000
    s_barrier
    s_xor_b32 s38, s49, 1
    s_lshl_b32 s38, s38, 16
    s_add_u32 s38, s38, s48
    buffer_load_dwordx4 v[72:75], v2, s[44:47], s38 offen
    s_add_u32 s38, s38, 8192
    s_waitcnt vmcnt(6)
    buffer_load_dwordx4 v[76:79], v2, s[44:47], s38 offen
    s_add_u32 s38, s38, 8192
    s_waitcnt vmcnt(6)
    buffer_load_dwordx4 v[80:83], v2, s[44:47], s38 offen
    s_add_u32 s38, s38, 8192
    s_waitcnt vmcnt(6)
    buffer_load_dwordx4 v[84:87], v2, s[44:47], s38 offen
    s_add_u32 s38, s38, 8192
    s_waitcnt vmcnt(6)
    buffer_load_dwordx4 v[88:91], v2, s[44:47], s38 offen
    s_add_u32 s38, s38, 8192
    s_waitcnt vmcnt(6)
    buffer_load_dwordx4 v[92:95], v2, s[44:47], s38 offen
    s_add_u32 s38, s38, 8192
    s_waitcnt vmcnt(6)
    buffer_load_dwordx4 v[96:99], v2, s[44:47], s38 offen
    s_add_u32 s38, s38, 8192
    s_waitcnt vmcnt(6)
    buffer_load_dwordx4 v[100:103], v2, s[44:47], s38 offen
    s_waitcnt vmcnt(6)
    s_xor_b32 s38, s49, 2
    s_lshl_b32 s38, s38, 16
    s_add_u32 s38, s38, s48
    buffer_load_dwordx4 v[104:107], v2, s[44:47], s38 offen
    s_add_u32 s38, s38, 8192
    s_waitcnt vmcnt(6)
    buffer_load_dwordx4 v[108:111], v2, s[44:47], s38 offen
    s_add_u32 s38, s38, 8192
    s_waitcnt vmcnt(6)
    buffer_load_dwordx4 v[112:115], v2, s[44:47], s38 offen
    s_add_u32 s38, s38, 8192
    s_waitcnt vmcnt(6)
    buffer_load_dwordx4 v[116:119], v2, s[44:47], s38 offen
    s_add_u32 s38, s38, 8192
    s_waitcnt vmcnt(6)
    buffer_load_dwordx4 v[120:123], v2, s[44:47], s38 offen
    s_add_u32 s38, s38, 8192
    s_waitcnt vmcnt(6)
    buffer_load_dwordx4 v[124:127], v2, s[44:47], s38 offen
    s_add_u32 s38, s38, 8192
    s_waitcnt vmcnt(6)
    buffer_load_dwordx4 v[128:131], v2, s[44:47], s38 offen
    s_add_u32 s38, s38, 8192
    s_waitcnt vmcnt(6)
    buffer_load_dwordx4 v[132:135], v2, s[44:47], s38 offen
    s_waitcnt vmcnt(6)
    s_xor_b32 s38, s49, 3
    s_lshl_b32 s38, s38, 16
    s_add_u32 s38, s38, s48
    buffer_load_dwordx4 v[136:139], v2, s[44:47], s38 offen
    s_add_u32 s38, s38, 8192
    s_waitcnt vmcnt(6)
    buffer_load_dwordx4 v[140:143], v2, s[44:47], s38 offen
    s_add_u32 s38, s38, 8192
    s_waitcnt vmcnt(6)
    buffer_load_dwordx4 v[144:147], v2, s[44:47], s38 offen
    s_add_u32 s38, s38, 8192
    s_waitcnt vmcnt(6)
    buffer_load_dwordx4 v[148:151], v2, s[44:47], s38 offen
    s_add_u32 s38, s38, 8192
    s_waitcnt vmcnt(6)
    buffer_load_dwordx4 v[152:155], v2, s[44:47], s38 offen
    s_add_u32 s38, s38, 8192
    s_waitcnt vmcnt(6)
    buffer_load_dwordx4 v[156:159], v2, s[44:47], s38 offen
    s_add_u32 s38, s38, 8192
    s_waitcnt vmcnt(6)
    buffer_load_dwordx4 v[160:163], v2, s[44:47], s38 offen
    s_add_u32 s38, s38, 8192
    s_waitcnt vmcnt(6)
    buffer_load_dwordx4 v[164:167], v2, s[44:47], s38 offen
    s_waitcnt vmcnt(6)
    v_mov_b32 v6, 1
    s_mov_b64 exec, 1
    ds_add_u32 v0, v6 offset:0
    s_mov_b64 exec, -1

    v_lshrrev_b32 v5, 1, v5
    v_lshlrev_b32 v5, 4, v5
    v_lshl_add_u32 v7, v4, 9, v5
    s_and_b32 s38, s36, 0
    s_lshl2_add_u32 s38, s38, s33
    s_lshl_b32 s38, s38, 11
    s_xor_b32 s50, s49, 0
    s_lshl_b32 s50, s50, 7
    s_add_u32 s50, s50, s38
    s_xor_b32 s51, s49, 1
    s_lshl_b32 s51, s51, 7
    s_add_u32 s51, s51, s38
    s_xor_b32 s52, s49, 2
    s_lshl_b32 s52, s52, 7
    s_add_u32 s52, s52, s38
    s_xor_b32 s53, s49, 3
    s_lshl_b32 s53, s53, 7
    s_add_u32 s53, s53, s38

    v_and_b32 v4, 1, v1
    v_cmp_eq_u32 vcc, 1, v4
    v_mov_b32 v2, 0x0c0c0100
    v_mov_b32 v4, 0x01000c0c
    v_cndmask_b32 v2, v2, v4, vcc
    v_mov_b32 v3, 0x0c0c0302
    v_mov_b32 v4, 0x03020c0c
    v_cndmask_b32 v3, v3, v4, vcc

    v_and_b32 v6, 0, v1
    v_lshlrev_b32 v6, 2, v6
L_fl17:
    global_load_dword v4, v6, s[28:29] offset:32 sc1
    s_sub_u32 s3, s3, 1
    s_cbranch_scc1 L_end
    s_waitcnt vmcnt(0)
    v_cmp_eq_u32 vcc, 0, v4
    s_cbranch_vccnz L_fl17
    v_swap_b32 v41, v44
    v_swap_b32 v42, v48
    v_swap_b32 v43, v52
    v_swap_b32 v46, v49
    v_swap_b32 v47, v53
    v_swap_b32 v51, v54
    v_swap_b32 v57, v60
    v_swap_b32 v58, v64
    v_swap_b32 v59, v68
    v_swap_b32 v62, v65
    v_swap_b32 v63, v69
    v_swap_b32 v67, v70
    v_swap_b32 v73, v76
    v_swap_b32 v74, v80
    v_swap_b32 v75, v84
    v_swap_b32 v78, v81
    v_swap_b32 v79, v85
    v_swap_b32 v83, v86
    v_swap_b32 v89, v92
    v_swap_b32 v90, v96
    v_swap_b32 v91, v100
    v_swap_b32 v94, v97
    v_swap_b32 v95, v101
    v_swap_b32 v99, v102
    v_swap_b32 v105, v108
    v_swap_b32 v106, v112
    v_swap_b32 v107, v116
    v_swap_b32 v110, v113
    v_swap_b32 v111, v117
    v_swap_b32 v115, v118
    v_swap_b32 v121, v124
    v_swap_b32 v122, v128
    v_swap_b32 v123, v132
    v_swap_b32 v126, v129
    v_swap_b32 v127, v133
    v_swap_b32 v131, v134
    v_swap_b32 v137, v140
    v_swap_b32 v138, v144
    v_swap_b32 v139, v148
    v_swap_b32 v142, v145
    v_swap_b32 v143, v149
    v_swap_b32 v147, v150
    v_swap_b32 v153, v156
    v_swap_b32 v154, v160
    v_swap_b32 v155, v164
    v_swap_b32 v158, v161
    v_swap_b32 v159, v165
    v_swap_b32 v163, v166
L_w18:
    ds_read_b32 v24, v0 offset:7068
    s_sub_u32 s3, s3, 1
    s_cbranch_scc1 L_end
    s_waitcnt lgkmcnt(0)
    v_cmp_gt_u32_e64 vcc, 2, v24
    s_cbranch_vccnz L_w18
L_B_h0:
    buffer_load_dwordx4 v[8:11], v7, s[40:43], s50 offen sc1
    buffer_load_dwordx4 v[12:15], v7, s[40:43], s51 offen sc1
    buffer_load_dwordx4 v[16:19], v7, s[40:43], s52 offen sc1
    buffer_load_dwordx4 v[20:23], v7, s[40:43], s53 offen sc1
    s_sub_u32 s3, s3, 1
    s_cbranch_scc1 L_end
L_B_h1:
    s_waitcnt vmcnt(0)
    v_max3_u32 v24, v8, v9, v10
    v_max3_u32 v24, v24, v11, v12
    v_max3_u32 v24, v24, v13, v14
    v_max3_u32 v24, v24, v15, v16
    v_max3_u32 v24, v24, v17, v18
    v_max3_u32 v24, v24, v19, v20
    v_max3_u32 v24, v24, v21, v22
    v_max_u32 v24, v24, v23
    v_cmp_eq_u32 vcc, -1, v24
    s_cbranch_vccnz L_B_h0
    s_setprio 3
    v_mov_b32 v24, 1
    s_mov_b64 exec, 1
    ds_add_u32 v0, v24 offset:4
    s_mov_b64 exec, -1
    v_perm_b32 v4, v8, v8, v2
    v_perm_b32 v5, v8, v8, v3
    v_perm_b32 v6, v9, v9, v2
    v_perm_b32 v7, v9, v9, v3
    s_nop 1
    v_mfma_f32_16x16x32_bf16 v[24:27], v[40:43], v[4:7], 0
    v_perm_b32 v40, v10, v10, v2
    v_perm_b32 v41, v10, v10, v3
    v_mfma_f32_16x16x32_bf16 v[28:31], v[44:47], v[4:7], 0
    v_perm_b32 v42, v11, v11, v2
    v_perm_b32 v43, v11, v11, v3
    v_mfma_f32_16x16x32_bf16 v[32:35], v[48:51], v[4:7], 0
    v_mfma_f32_16x16x32_bf16 v[36:39], v[52:55], v[4:7], 0
    v_mfma_f32_16x16x32_bf16 v[24:27], v[56:59], v[40:43], v[24:27]
    v_perm_b32 v56, v12, v12, v2
    v_perm_b32 v57, v12, v12, v3
    v_mfma_f32_16x16x32_bf16 v[28:31], v[60:63], v[40:43], v[28:31]
    v_perm_b32 v58, v13, v13, v2
    v_perm_b32 v59, v13, v13, v3
    v_mfma_f32_16x16x32_bf16 v[32:35], v[64:67], v[40:43], v[32:35]
    v_mfma_f32_16x16x32_bf16 v[36:39], v[68:71], v[40:43], v[36:39]
    v_mfma_f32_16x16x32_bf16 v[24:27], v[72:75], v[56:59], v[24:27]
    v_perm_b32 v72, v14, v14, v2
    v_perm_b32 v73, v14, v14, v3
    v_mfma_f32_16x16x32_bf16 v[28:31], v[76:79], v[56:59], v[28:31]
    v_perm_b32 v74, v15, v15, v2
    v_perm_b32 v75, v15, v15, v3
    v_mfma_f32_16x16x32_bf16 v[32:35], v[80:83], v[56:59], v[32:35]
    v_mfma_f32_16x16x32_bf16 v[36:39], v[84:87], v[56:59], v[36:39]
    v_mfma_f32_16x16x32_bf16 v[24:27], v[88:91], v[72:75], v[24:27]
    v_perm_b32 v88, v16, v16, v2
    v_perm_b32 v89, v16, v16, v3
    v_mfma_f32_16x16x32_bf16 v[28:31], v[92:95], v[72:75], v[28:31]
    v_perm_b32 v90, v17, v17, v2
    v_perm_b32 v91, v17, v17, v3
    v_mfma_f32_16x16x32_bf16 v[32:35], v[96:99], v[72:75], v[32:35]
    v_mfma_f32_16x16x32_bf16 v[36:39], v[100:103], v[72:75], v[36:39]
    v_mfma_f32_16x16x32_bf16 v[24:27], v[104:107], v[88:91], v[24:27]
    v_perm_b32 v104, v18, v18, v2
    v_perm_b32 v105, v18, v18, v3
    v_mfma_f32_16x16x32_bf16 v[28:31], v[108:111], v[88:91], v[28:31]
    v_perm_b32 v106, v19, v19, v2
    v_perm_b32 v107, v19, v19, v3
    v_mfma_f32_16x16x32_bf16 v[32:35], v[112:115], v[88:91], v[32:35]
    v_mfma_f32_16x16x32_bf16 v[36:39], v[116:119], v[88:91], v[36:39]
    v_mfma_f32_16x16x32_bf16 v[24:27], v[120:123], v[104:107], v[24:27]
    v_perm_b32 v120, v20, v20, v2
    v_perm_b32 v121, v20, v20, v3
    v_mfma_f32_16x16x32_bf16 v[28:31], v[124:127], v[104:107], v[28:31]
    v_perm_b32 v122, v21, v21, v2
    v_perm_b32 v123, v21, v21, v3
    v_mfma_f32_16x16x32_bf16 v[32:35], v[128:131], v[104:107], v[32:35]
    v_mfma_f32_16x16x32_bf16 v[36:39], v[132:135], v[104:107], v[36:39]
    v_mfma_f32_16x16x32_bf16 v[24:27], v[136:139], v[120:123], v[24:27]
    v_perm_b32 v136, v22, v22, v2
    v_perm_b32 v137, v22, v22, v3
    v_mfma_f32_16x16x32_bf16 v[28:31], v[140:143], v[120:123], v[28:31]
    v_perm_b32 v138, v23, v23, v2
    v_perm_b32 v139, v23, v23, v3
    v_mfma_f32_16x16x32_bf16 v[32:35], v[144:147], v[120:123], v[32:35]
    v_mfma_f32_16x16x32_bf16 v[36:39], v[148:151], v[120:123], v[36:39]
    v_mfma_f32_16x16x32_bf16 v[24:27], v[152:155], v[136:139], v[24:27]
    v_mfma_f32_16x16x32_bf16 v[28:31], v[156:159], v[136:139], v[28:31]
    v_mfma_f32_16x16x32_bf16 v[32:35], v[160:163], v[136:139], v[32:35]
    v_mfma_f32_16x16x32_bf16 v[36:39], v[164:167], v[136:139], v[36:39]
    s_lshl_b32 s38, s33, 12
    s_add_u32 s38, s38, 131072
    v_lshl_add_u32 v4, v1, 4, s38
    s_nop 1
    ds_write_b128 v4, v[24:27] offset:0
    ds_write_b128 v4, v[28:31] offset:1024
    ds_write_b128 v4, v[32:35] offset:2048
    ds_write_b128 v4, v[36:39] offset:3072
    v_mov_b32 v5, 1
    s_mov_b64 exec, 1
    ds_add_u32 v0, v5 offset:5040
    s_mov_b64 exec, -1
    s_setprio 0
L_B_t:
    s_cmp_lt_u32 s33, 2
    s_cbranch_scc1 L_B_uv
    s_cmp_eq_u32 s33, 2
    s_cbranch_scc1 L_B_mo
L_w19:
    s_sleep 1
    ds_read_b32 v6, v0 offset:5044
    s_sub_u32 s3, s3, 1
    s_cbranch_scc1 L_end
    s_waitcnt lgkmcnt(0)
    v_cmp_gt_u32 vcc, 3, v6
    s_cbranch_vccnz L_w19
    v_mov_b32 v4, 0
L_fl20:
    s_sleep 8
    global_load_dword v5, v4, s[28:29] offset:4 sc1
    s_sub_u32 s3, s3, 1
    s_cbranch_scc1 L_end
    s_waitcnt vmcnt(0)
    v_cmp_eq_u32 vcc, 0, v5
    s_cbranch_vccnz L_fl20
    v_mov_b32 v6, 1
    s_mov_b64 exec, 1
    ds_add_u32 v0, v6 offset:5052
    s_mov_b64 exec, -1
    s_branch L_end
L_B_mo:
L_w21:
    s_sleep 1
    ds_read_b32 v6, v0 offset:5044
    s_sub_u32 s3, s3, 1
    s_cbranch_scc1 L_end
    s_waitcnt lgkmcnt(0)
    v_cmp_gt_u32 vcc, 3, v6
    s_cbranch_vccnz L_w21
    s_mov_b32 s44, s22
    s_mov_b32 s45, s23
    s_mov_b32 s46, 8192
    s_mov_b32 s47, 0x20000

    v_lshrrev_b32 v4, 4, v1
    v_and_b32 v5, 15, v1
    v_lshrrev_b32 v2, 1, v5
    v_lshlrev_b32 v2, 10, v2
    v_lshl_add_u32 v2, v4, 6, v2
    s_lshl_b32 s38, s62, 8
    buffer_load_dwordx4 v[8:11], v2, s[44:47], s38 offen offset:0
    buffer_load_dwordx4 v[12:15], v2, s[44:47], s38 offen offset:16
    buffer_load_dwordx4 v[16:19], v2, s[44:47], s38 offen offset:32
    buffer_load_dwordx4 v[20:23], v2, s[44:47], s38 offen offset:48
    s_mov_b32 s44, s24
    s_mov_b32 s45, s25
    s_mov_b32 s46, 3145728
    s_mov_b32 s47, 0x20000

    v_mul_u32_u24 v2, 196608, v4
    v_lshl_add_u32 v2, v5, 3, v2
    v_lshlrev_b32 v4, 11, v4
    v_lshl_add_u32 v4, v5, 3, v4
    v_and_b32 v3, 1, v1
    v_lshlrev_b32 v3, 4, v3
    s_mov_b32 s38, 0xffff
    v_lshlrev_b32 v3, v3, s38
    s_mul_i32 s48, s62, 786432
    s_lshl_b32 s38, s35, 7
    s_add_u32 s48, s48, s38
    s_add_u32 s48, s48, 2048
    s_lshl2_add_u32 s49, s37, s62
    s_lshl_b32 s49, s49, 13
    s_lshl_b32 s38, s36, 7
    s_add_u32 s49, s49, s38
    s_add_u32 s49, s49, 1179648
    s_mov_b32 s38, 0xbfb8aa3b
    s_waitcnt vmcnt(0)
    v_lshlrev_b32 v24, 16, v8
    v_and_b32 v25, 0xffff0000, v8
    v_mul_f32 v26, s38, v24
    v_mul_f32 v27, s38, v25
    v_exp_f32 v26, v26
    v_exp_f32 v27, v27
    v_add_f32 v26, 1.0, v26
    v_add_f32 v27, 1.0, v27
    v_rcp_f32 v26, v26
    v_rcp_f32 v27, v27
    v_mul_f32 v24, v24, v26
    v_mul_f32 v25, v25, v27
    v_cvt_pk_bf16_f32 v24, v24, v24
    v_cvt_pk_bf16_f32 v25, v25, v25
    v_and_b32 v40, v24, v3
    v_and_b32 v41, v25, v3
    v_lshlrev_b32 v24, 16, v9
    v_and_b32 v25, 0xffff0000, v9
    v_mul_f32 v26, s38, v24
    v_mul_f32 v27, s38, v25
    v_exp_f32 v26, v26
    v_exp_f32 v27, v27
    v_add_f32 v26, 1.0, v26
    v_add_f32 v27, 1.0, v27
    v_rcp_f32 v26, v26
    v_rcp_f32 v27, v27
    v_mul_f32 v24, v24, v26
    v_mul_f32 v25, v25, v27
    v_cvt_pk_bf16_f32 v24, v24, v24
    v_cvt_pk_bf16_f32 v25, v25, v25
    v_and_b32 v42, v24, v3
    v_and_b32 v43, v25, v3
    v_lshlrev_b32 v24, 16, v10
    v_and_b32 v25, 0xffff0000, v10
    v_mul_f32 v26, s38, v24
    v_mul_f32 v27, s38, v25
    v_exp_f32 v26, v26
    v_exp_f32 v27, v27
    v_add_f32 v26, 1.0, v26
    v_add_f32 v27, 1.0, v27
    v_rcp_f32 v26, v26
    v_rcp_f32 v27, v27
    v_mul_f32 v24, v24, v26
    v_mul_f32 v25, v25, v27
    v_cvt_pk_bf16_f32 v24, v24, v24
    v_cvt_pk_bf16_f32 v25, v25, v25
    v_and_b32 v44, v24, v3
    v_and_b32 v45, v25, v3
    v_lshlrev_b32 v24, 16, v11
    v_and_b32 v25, 0xffff0000, v11
    v_mul_f32 v26, s38, v24
    v_mul_f32 v27, s38, v25
    v_exp_f32 v26, v26
    v_exp_f32 v27, v27
    v_add_f32 v26, 1.0, v26
    v_add_f32 v27, 1.0, v27
    v_rcp_f32 v26, v26
    v_rcp_f32 v27, v27
    v_mul_f32 v24, v24, v26
    v_mul_f32 v25, v25, v27
    v_cvt_pk_bf16_f32 v24, v24, v24
    v_cvt_pk_bf16_f32 v25, v25, v25
    v_and_b32 v46, v24, v3
    v_and_b32 v47, v25, v3
    v_lshlrev_b32 v24, 16, v12
    v_and_b32 v25, 0xffff0000, v12
    v_mul_f32 v26, s38, v24
    v_mul_f32 v27, s38, v25
    v_exp_f32 v26, v26
    v_exp_f32 v27, v27
    v_add_f32 v26, 1.0, v26
    v_add_f32 v27, 1.0, v27
    v_rcp_f32 v26, v26
    v_rcp_f32 v27, v27
    v_mul_f32 v24, v24, v26
    v_mul_f32 v25, v25, v27
    v_cvt_pk_bf16_f32 v24, v24, v24
    v_cvt_pk_bf16_f32 v25, v25, v25
    v_and_b32 v48, v24, v3
    v_and_b32 v49, v25, v3
    v_lshlrev_b32 v24, 16, v13
    v_and_b32 v25, 0xffff0000, v13
    v_mul_f32 v26, s38, v24
    v_mul_f32 v27, s38, v25
    v_exp_f32 v26, v26
    v_exp_f32 v27, v27
    v_add_f32 v26, 1.0, v26
    v_add_f32 v27, 1.0, v27
    v_rcp_f32 v26, v26
    v_rcp_f32 v27, v27
    v_mul_f32 v24, v24, v26
    v_mul_f32 v25, v25, v27
    v_cvt_pk_bf16_f32 v24, v24, v24
    v_cvt_pk_bf16_f32 v25, v25, v25
    v_and_b32 v50, v24, v3
    v_and_b32 v51, v25, v3
    v_lshlrev_b32 v24, 16, v14
    v_and_b32 v25, 0xffff0000, v14
    v_mul_f32 v26, s38, v24
    v_mul_f32 v27, s38, v25
    v_exp_f32 v26, v26
    v_exp_f32 v27, v27
    v_add_f32 v26, 1.0, v26
    v_add_f32 v27, 1.0, v27
    v_rcp_f32 v26, v26
    v_rcp_f32 v27, v27
    v_mul_f32 v24, v24, v26
    v_mul_f32 v25, v25, v27
    v_cvt_pk_bf16_f32 v24, v24, v24
    v_cvt_pk_bf16_f32 v25, v25, v25
    v_and_b32 v52, v24, v3
    v_and_b32 v53, v25, v3
    v_lshlrev_b32 v24, 16, v15
    v_and_b32 v25, 0xffff0000, v15
    v_mul_f32 v26, s38, v24
    v_mul_f32 v27, s38, v25
    v_exp_f32 v26, v26
    v_exp_f32 v27, v27
    v_add_f32 v26, 1.0, v26
    v_add_f32 v27, 1.0, v27
    v_rcp_f32 v26, v26
    v_rcp_f32 v27, v27
    v_mul_f32 v24, v24, v26
    v_mul_f32 v25, v25, v27
    v_cvt_pk_bf16_f32 v24, v24, v24
    v_cvt_pk_bf16_f32 v25, v25, v25
    v_and_b32 v54, v24, v3
    v_and_b32 v55, v25, v3
    v_lshlrev_b32 v24, 16, v16
    v_and_b32 v25, 0xffff0000, v16
    v_mul_f32 v26, s38, v24
    v_mul_f32 v27, s38, v25
    v_exp_f32 v26, v26
    v_exp_f32 v27, v27
    v_add_f32 v26, 1.0, v26
    v_add_f32 v27, 1.0, v27
    v_rcp_f32 v26, v26
    v_rcp_f32 v27, v27
    v_mul_f32 v24, v24, v26
    v_mul_f32 v25, v25, v27
    v_cvt_pk_bf16_f32 v24, v24, v24
    v_cvt_pk_bf16_f32 v25, v25, v25
    v_and_b32 v56, v24, v3
    v_and_b32 v57, v25, v3
    v_lshlrev_b32 v24, 16, v17
    v_and_b32 v25, 0xffff0000, v17
    v_mul_f32 v26, s38, v24
    v_mul_f32 v27, s38, v25
    v_exp_f32 v26, v26
    v_exp_f32 v27, v27
    v_add_f32 v26, 1.0, v26
    v_add_f32 v27, 1.0, v27
    v_rcp_f32 v26, v26
    v_rcp_f32 v27, v27
    v_mul_f32 v24, v24, v26
    v_mul_f32 v25, v25, v27
    v_cvt_pk_bf16_f32 v24, v24, v24
    v_cvt_pk_bf16_f32 v25, v25, v25
    v_and_b32 v58, v24, v3
    v_and_b32 v59, v25, v3
    v_lshlrev_b32 v24, 16, v18
    v_and_b32 v25, 0xffff0000, v18
    v_mul_f32 v26, s38, v24
    v_mul_f32 v27, s38, v25
    v_exp_f32 v26, v26
    v_exp_f32 v27, v27
    v_add_f32 v26, 1.0, v26
    v_add_f32 v27, 1.0, v27
    v_rcp_f32 v26, v26
    v_rcp_f32 v27, v27
    v_mul_f32 v24, v24, v26
    v_mul_f32 v25, v25, v27
    v_cvt_pk_bf16_f32 v24, v24, v24
    v_cvt_pk_bf16_f32 v25, v25, v25
    v_and_b32 v60, v24, v3
    v_and_b32 v61, v25, v3
    v_lshlrev_b32 v24, 16, v19
    v_and_b32 v25, 0xffff0000, v19
    v_mul_f32 v26, s38, v24
    v_mul_f32 v27, s38, v25
    v_exp_f32 v26, v26
    v_exp_f32 v27, v27
    v_add_f32 v26, 1.0, v26
    v_add_f32 v27, 1.0, v27
    v_rcp_f32 v26, v26
    v_rcp_f32 v27, v27
    v_mul_f32 v24, v24, v26
    v_mul_f32 v25, v25, v27
    v_cvt_pk_bf16_f32 v24, v24, v24
    v_cvt_pk_bf16_f32 v25, v25, v25
    v_and_b32 v62, v24, v3
    v_and_b32 v63, v25, v3
    v_lshlrev_b32 v24, 16, v20
    v_and_b32 v25, 0xffff0000, v20
    v_mul_f32 v26, s38, v24
    v_mul_f32 v27, s38, v25
    v_exp_f32 v26, v26
    v_exp_f32 v27, v27
    v_add_f32 v26, 1.0, v26
    v_add_f32 v27, 1.0, v27
    v_rcp_f32 v26, v26
    v_rcp_f32 v27, v27
    v_mul_f32 v24, v24, v26
    v_mul_f32 v25, v25, v27
    v_cvt_pk_bf16_f32 v24, v24, v24
    v_cvt_pk_bf16_f32 v25, v25, v25
    v_and_b32 v64, v24, v3
    v_and_b32 v65, v25, v3
    v_lshlrev_b32 v24, 16, v21
    v_and_b32 v25, 0xffff0000, v21
    v_mul_f32 v26, s38, v24
    v_mul_f32 v27, s38, v25
    v_exp_f32 v26, v26
    v_exp_f32 v27, v27
    v_add_f32 v26, 1.0, v26
    v_add_f32 v27, 1.0, v27
    v_rcp_f32 v26, v26
    v_rcp_f32 v27, v27
    v_mul_f32 v24, v24, v26
    v_mul_f32 v25, v25, v27
    v_cvt_pk_bf16_f32 v24, v24, v24
    v_cvt_pk_bf16_f32 v25, v25, v25
    v_and_b32 v66, v24, v3
    v_and_b32 v67, v25, v3
    v_lshlrev_b32 v24, 16, v22
    v_and_b32 v25, 0xffff0000, v22
    v_mul_f32 v26, s38, v24
    v_mul_f32 v27, s38, v25
    v_exp_f32 v26, v26
    v_exp_f32 v27, v27
    v_add_f32 v26, 1.0, v26
    v_add_f32 v27, 1.0, v27
    v_rcp_f32 v26, v26
    v_rcp_f32 v27, v27
    v_mul_f32 v24, v24, v26
    v_mul_f32 v25, v25, v27
    v_cvt_pk_bf16_f32 v24, v24, v24
    v_cvt_pk_bf16_f32 v25, v25, v25
    v_and_b32 v68, v24, v3
    v_and_b32 v69, v25, v3
    v_lshlrev_b32 v24, 16, v23
    v_and_b32 v25, 0xffff0000, v23
    v_mul_f32 v26, s38, v24
    v_mul_f32 v27, s38, v25
    v_exp_f32 v26, v26
    v_exp_f32 v27, v27
    v_add_f32 v26, 1.0, v26
    v_add_f32 v27, 1.0, v27
    v_rcp_f32 v26, v26
    v_rcp_f32 v27, v27
    v_mul_f32 v24, v24, v26
    v_mul_f32 v25, v25, v27
    v_cvt_pk_bf16_f32 v24, v24, v24
    v_cvt_pk_bf16_f32 v25, v25, v25
    v_and_b32 v70, v24, v3
    v_and_b32 v71, v25, v3
L_w22:
    s_sleep 1
    ds_read_b32 v6, v0 offset:5048
    s_sub_u32 s3, s3, 1
    s_cbranch_scc1 L_end
    s_waitcnt lgkmcnt(0)
    v_cmp_gt_u32_e64 vcc, 4, v6
    s_cbranch_vccnz L_w22
    s_add_u32 s39, s48, 0
    buffer_load_dwordx2 v[104:105], v2, s[44:47], s39 offen nt
    s_add_u32 s39, s48, 6144
    buffer_load_dwordx2 v[108:109], v2, s[44:47], s39 offen nt
    s_add_u32 s39, s48, 12288
    buffer_load_dwordx2 v[106:107], v2, s[44:47], s39 offen nt
    s_add_u32 s39, s48, 18432
    buffer_load_dwordx2 v[110:111], v2, s[44:47], s39 offen nt
    s_add_u32 s39, s48, 24576
    buffer_load_dwordx2 v[112:113], v2, s[44:47], s39 offen nt
    s_add_u32 s39, s48, 30720
    buffer_load_dwordx2 v[116:117], v2, s[44:47], s39 offen nt
    s_add_u32 s39, s48, 36864
    buffer_load_dwordx2 v[114:115], v2, s[44:47], s39 offen nt
    s_add_u32 s39, s48, 43008
    buffer_load_dwordx2 v[118:119], v2, s[44:47], s39 offen nt
    s_add_u32 s39, s48, 49152
    buffer_load_dwordx2 v[120:121], v2, s[44:47], s39 offen nt
    s_add_u32 s39, s48, 55296
    buffer_load_dwordx2 v[124:125], v2, s[44:47], s39 offen nt
    s_add_u32 s39, s48, 61440
    buffer_load_dwordx2 v[122:123], v2, s[44:47], s39 offen nt
    s_add_u32 s39, s48, 67584
    buffer_load_dwordx2 v[126:127], v2, s[44:47], s39 offen nt
    s_add_u32 s39, s48, 73728
    buffer_load_dwordx2 v[128:129], v2, s[44:47], s39 offen nt
    s_add_u32 s39, s48, 79872
    buffer_load_dwordx2 v[132:133], v2, s[44:47], s39 offen nt
    s_add_u32 s39, s48, 86016
    buffer_load_dwordx2 v[130:131], v2, s[44:47], s39 offen nt
    s_add_u32 s39, s48, 92160
    buffer_load_dwordx2 v[134:135], v2, s[44:47], s39 offen nt
    s_add_u32 s39, s48, 98304
    buffer_load_dwordx2 v[136:137], v2, s[44:47], s39 offen nt
    s_add_u32 s39, s48, 104448
    buffer_load_dwordx2 v[140:141], v2, s[44:47], s39 offen nt
    s_add_u32 s39, s48, 110592
    buffer_load_dwordx2 v[138:139], v2, s[44:47], s39 offen nt
    s_add_u32 s39, s48, 116736
    buffer_load_dwordx2 v[142:143], v2, s[44:47], s39 offen nt
    s_add_u32 s39, s48, 122880
    buffer_load_dwordx2 v[144:145], v2, s[44:47], s39 offen nt
    s_add_u32 s39, s48, 129024
    buffer_load_dwordx2 v[148:149], v2, s[44:47], s39 offen nt
    s_add_u32 s39, s48, 135168
    buffer_load_dwordx2 v[146:147], v2, s[44:47], s39 offen nt
    s_add_u32 s39, s48, 141312
    buffer_load_dwordx2 v[150:151], v2, s[44:47], s39 offen nt
    s_add_u32 s39, s48, 147456
    buffer_load_dwordx2 v[152:153], v2, s[44:47], s39 offen nt
    s_add_u32 s39, s48, 153600
    buffer_load_dwordx2 v[156:157], v2, s[44:47], s39 offen nt
    s_add_u32 s39, s48, 159744
    buffer_load_dwordx2 v[154:155], v2, s[44:47], s39 offen nt
    s_add_u32 s39, s48, 165888
    buffer_load_dwordx2 v[158:159], v2, s[44:47], s39 offen nt
    s_add_u32 s39, s48, 172032
    buffer_load_dwordx2 v[160:161], v2, s[44:47], s39 offen nt
    s_add_u32 s39, s48, 178176
    buffer_load_dwordx2 v[164:165], v2, s[44:47], s39 offen nt
    s_add_u32 s39, s48, 184320
    buffer_load_dwordx2 v[162:163], v2, s[44:47], s39 offen nt
    s_add_u32 s39, s48, 190464
    buffer_load_dwordx2 v[166:167], v2, s[44:47], s39 offen nt
    s_waitcnt vmcnt(31)
    s_waitcnt vmcnt(0)
    v_mov_b32_e64 v6, 1
    s_mov_b64 exec, 1
    ds_add_u32 v0, v6 offset:6060
    s_mov_b64 exec, -1
    v_swap_b32 v105, v108
    v_swap_b32 v107, v110
    v_swap_b32 v113, v116
    v_swap_b32 v115, v118
    v_swap_b32 v121, v124
    v_swap_b32 v123, v126
    v_swap_b32 v129, v132
    v_swap_b32 v131, v134
    v_swap_b32 v137, v140
    v_swap_b32 v139, v142
    v_swap_b32 v145, v148
    v_swap_b32 v147, v150
    v_swap_b32 v153, v156
    v_swap_b32 v155, v158
    v_swap_b32 v161, v164
    v_swap_b32 v163, v166
    v_mfma_f32_16x16x32_bf16 v[24:27], v[40:43], v[104:107], 0
    v_mfma_f32_16x16x32_bf16 v[28:31], v[40:43], v[108:111], 0
    v_mfma_f32_16x16x32_bf16 v[24:27], v[44:47], v[112:115], v[24:27]
    v_mfma_f32_16x16x32_bf16 v[28:31], v[44:47], v[116:119], v[28:31]
    v_mfma_f32_16x16x32_bf16 v[24:27], v[48:51], v[120:123], v[24:27]
    v_mfma_f32_16x16x32_bf16 v[28:31], v[48:51], v[124:127], v[28:31]
    v_mfma_f32_16x16x32_bf16 v[24:27], v[52:55], v[128:131], v[24:27]
    v_mfma_f32_16x16x32_bf16 v[28:31], v[52:55], v[132:135], v[28:31]
    v_mfma_f32_16x16x32_bf16 v[24:27], v[56:59], v[136:139], v[24:27]
    v_mfma_f32_16x16x32_bf16 v[28:31], v[56:59], v[140:143], v[28:31]
    v_mfma_f32_16x16x32_bf16 v[24:27], v[60:63], v[144:147], v[24:27]
    v_mfma_f32_16x16x32_bf16 v[28:31], v[60:63], v[148:151], v[28:31]
    v_mfma_f32_16x16x32_bf16 v[24:27], v[64:67], v[152:155], v[24:27]
    v_mfma_f32_16x16x32_bf16 v[28:31], v[64:67], v[156:159], v[28:31]
    v_mfma_f32_16x16x32_bf16 v[24:27], v[68:71], v[160:163], v[24:27]
    v_mfma_f32_16x16x32_bf16 v[28:31], v[68:71], v[164:167], v[28:31]
    s_nop 6
    v_cvt_pk_bf16_f32 v8, v24, v25
    v_cvt_pk_bf16_f32 v10, v26, v27
    v_cvt_pk_bf16_f32 v9, v28, v29
    v_cvt_pk_bf16_f32 v11, v30, v31
L_w23:
    s_sleep 1
    ds_read_b32 v6, v0 offset:5052
    s_sub_u32 s3, s3, 1
    s_cbranch_scc1 L_end
    s_waitcnt lgkmcnt(0)
    v_cmp_gt_u32 vcc, 1, v6
    s_cbranch_vccnz L_w23
    buffer_store_dwordx2 v[8:9], v4, s[40:43], s49 offen sc1
    buffer_store_dwordx2 v[10:11], v4, s[40:43], s49 offen offset:1024 sc1
    s_branch L_end
L_B_uv:
    s_mov_b32 s44, s12
    s_mov_b32 s45, s13
    s_mov_b32 s46, 4194304
    s_mov_b32 s47, 0x20000

    v_lshrrev_b32 v4, 4, v1
    v_and_b32 v5, 15, v1
    v_lshlrev_b32 v2, 14, v4
    v_lshl_add_u32 v2, v5, 3, v2
    s_lshl_b32 s48, s62, 18
    s_lshl1_add_u32 s38, s35, s33
    s_lshl_b32 s38, s38, 7
    s_add_u32 s48, s48, s38
    v_mul_u32_u24 v3, 528, v5
    v_lshl_add_u32 v3, v4, 5, v3
    v_add_u32 v3, 141312, v3
    v_lshlrev_b32 v4, 4, v1
    s_lshl2_add_u32 s49, s35, s62
    s_lshl1_add_u32 s49, s49, s33
    s_lshl_b32 s49, s49, 10
    s_add_u32 s49, s49, 1835008
L_w24:
    s_sleep 1
    ds_read_b32 v6, v0 offset:5048
    s_sub_u32 s3, s3, 1
    s_cbranch_scc1 L_end
    s_waitcnt lgkmcnt(0)
    v_cmp_gt_u32 vcc, 4, v6
    s_cbranch_vccnz L_w24
    s_add_u32 s39, s48, 0
    buffer_load_dwordx2 v[104:105], v2, s[44:47], s39 offen nt
    s_add_u32 s39, s48, 1048576
    buffer_load_dwordx2 v[108:109], v2, s[44:47], s39 offen nt
    s_add_u32 s39, s48, 131072
    buffer_load_dwordx2 v[106:107], v2, s[44:47], s39 offen nt
    s_add_u32 s39, s48, 1179648
    buffer_load_dwordx2 v[110:111], v2, s[44:47], s39 offen nt
    s_add_u32 s39, s48, 8192
    buffer_load_dwordx2 v[112:113], v2, s[44:47], s39 offen nt
    s_add_u32 s39, s48, 1056768
    buffer_load_dwordx2 v[116:117], v2, s[44:47], s39 offen nt
    s_add_u32 s39, s48, 139264
    buffer_load_dwordx2 v[114:115], v2, s[44:47], s39 offen nt
    s_add_u32 s39, s48, 1187840
    buffer_load_dwordx2 v[118:119], v2, s[44:47], s39 offen nt
    s_add_u32 s39, s48, 65536
    buffer_load_dwordx2 v[120:121], v2, s[44:47], s39 offen nt
    s_add_u32 s39, s48, 1114112
    buffer_load_dwordx2 v[124:125], v2, s[44:47], s39 offen nt
    s_add_u32 s39, s48, 196608
    buffer_load_dwordx2 v[122:123], v2, s[44:47], s39 offen nt
    s_add_u32 s39, s48, 1245184
    buffer_load_dwordx2 v[126:127], v2, s[44:47], s39 offen nt
    s_add_u32 s39, s48, 73728
    buffer_load_dwordx2 v[128:129], v2, s[44:47], s39 offen nt
    s_add_u32 s39, s48, 1122304
    buffer_load_dwordx2 v[132:133], v2, s[44:47], s39 offen nt
    s_add_u32 s39, s48, 204800
    buffer_load_dwordx2 v[130:131], v2, s[44:47], s39 offen nt
    s_add_u32 s39, s48, 1253376
    buffer_load_dwordx2 v[134:135], v2, s[44:47], s39 offen nt
    s_add_u32 s39, s48, 2097152
    buffer_load_dwordx2 v[136:137], v2, s[44:47], s39 offen nt
    s_add_u32 s39, s48, 3145728
    buffer_load_dwordx2 v[140:141], v2, s[44:47], s39 offen nt
    s_add_u32 s39, s48, 2228224
    buffer_load_dwordx2 v[138:139], v2, s[44:47], s39 offen nt
    s_add_u32 s39, s48, 3276800
    buffer_load_dwordx2 v[142:143], v2, s[44:47], s39 offen nt
    s_add_u32 s39, s48, 2105344
    buffer_load_dwordx2 v[144:145], v2, s[44:47], s39 offen nt
    s_add_u32 s39, s48, 3153920
    buffer_load_dwordx2 v[148:149], v2, s[44:47], s39 offen nt
    s_add_u32 s39, s48, 2236416
    buffer_load_dwordx2 v[146:147], v2, s[44:47], s39 offen nt
    s_add_u32 s39, s48, 3284992
    buffer_load_dwordx2 v[150:151], v2, s[44:47], s39 offen nt
    s_add_u32 s39, s48, 2162688
    buffer_load_dwordx2 v[152:153], v2, s[44:47], s39 offen nt
    s_add_u32 s39, s48, 3211264
    buffer_load_dwordx2 v[156:157], v2, s[44:47], s39 offen nt
    s_add_u32 s39, s48, 2293760
    buffer_load_dwordx2 v[154:155], v2, s[44:47], s39 offen nt
    s_add_u32 s39, s48, 3342336
    buffer_load_dwordx2 v[158:159], v2, s[44:47], s39 offen nt
    s_add_u32 s39, s48, 2170880
    buffer_load_dwordx2 v[160:161], v2, s[44:47], s39 offen nt
    s_add_u32 s39, s48, 3219456
    buffer_load_dwordx2 v[164:165], v2, s[44:47], s39 offen nt
    s_add_u32 s39, s48, 2301952
    buffer_load_dwordx2 v[162:163], v2, s[44:47], s39 offen nt
    s_add_u32 s39, s48, 3350528
    buffer_load_dwordx2 v[166:167], v2, s[44:47], s39 offen nt
    s_waitcnt vmcnt(31)
    s_waitcnt vmcnt(0)
    v_mov_b32 v6, 1
    s_mov_b64 exec, 1
    ds_add_u32 v0, v6 offset:6060
    s_mov_b64 exec, -1
    v_swap_b32 v105, v108
    v_swap_b32 v107, v110
    v_swap_b32 v113, v116
    v_swap_b32 v115, v118
    v_swap_b32 v121, v124
    v_swap_b32 v123, v126
    v_swap_b32 v129, v132
    v_swap_b32 v131, v134
    v_swap_b32 v137, v140
    v_swap_b32 v139, v142
    v_swap_b32 v145, v148
    v_swap_b32 v147, v150
    v_swap_b32 v153, v156
    v_swap_b32 v155, v158
    v_swap_b32 v161, v164
    v_swap_b32 v163, v166
L_w25:
    s_sleep 1
    ds_read_b32 v6, v0 offset:6048
    s_sub_u32 s3, s3, 1
    s_cbranch_scc1 L_end
    s_waitcnt lgkmcnt(0)
    v_cmp_gt_u32 vcc, 1, v6
    s_cbranch_vccnz L_w25
    s_setprio 2
L_w26:
    ds_read_b32 v6, v0 offset:6048
    s_sub_u32 s3, s3, 1
    s_cbranch_scc1 L_end
    s_waitcnt lgkmcnt(0)
    v_cmp_gt_u32_e64 vcc, 4, v6
    s_cbranch_vccnz L_w26
    ds_read_b128 v[40:43], v3 offset:0
    ds_read_b128 v[44:47], v3 offset:16
    ds_read_b128 v[48:51], v3 offset:128
    ds_read_b128 v[52:55], v3 offset:144
    ds_read_b128 v[56:59], v3 offset:256
    ds_read_b128 v[60:63], v3 offset:272
    ds_read_b128 v[64:67], v3 offset:384
    ds_read_b128 v[68:71], v3 offset:400
    s_waitcnt lgkmcnt(7)
    v_mfma_f32_16x16x32_bf16 v[24:27], v[40:43], v[104:107], 0
    v_mfma_f32_16x16x32_bf16 v[28:31], v[40:43], v[108:111], 0
    s_waitcnt lgkmcnt(6)
    v_mfma_f32_16x16x32_bf16 v[24:27], v[44:47], v[112:115], v[24:27]
    v_mfma_f32_16x16x32_bf16 v[28:31], v[44:47], v[116:119], v[28:31]
    s_waitcnt lgkmcnt(5)
    v_mfma_f32_16x16x32_bf16 v[24:27], v[48:51], v[120:123], v[24:27]
    v_mfma_f32_16x16x32_bf16 v[28:31], v[48:51], v[124:127], v[28:31]
    s_waitcnt lgkmcnt(4)
    v_mfma_f32_16x16x32_bf16 v[24:27], v[52:55], v[128:131], v[24:27]
    v_mfma_f32_16x16x32_bf16 v[28:31], v[52:55], v[132:135], v[28:31]
    s_waitcnt lgkmcnt(3)
    v_mfma_f32_16x16x32_bf16 v[24:27], v[56:59], v[136:139], v[24:27]
    v_mfma_f32_16x16x32_bf16 v[28:31], v[56:59], v[140:143], v[28:31]
    s_waitcnt lgkmcnt(2)
    v_mfma_f32_16x16x32_bf16 v[24:27], v[60:63], v[144:147], v[24:27]
    v_mfma_f32_16x16x32_bf16 v[28:31], v[60:63], v[148:151], v[28:31]
    s_waitcnt lgkmcnt(1)
    v_mfma_f32_16x16x32_bf16 v[24:27], v[64:67], v[152:155], v[24:27]
    v_mfma_f32_16x16x32_bf16 v[28:31], v[64:67], v[156:159], v[28:31]
    s_waitcnt lgkmcnt(0)
    v_mfma_f32_16x16x32_bf16 v[24:27], v[68:71], v[160:163], v[24:27]
    v_mfma_f32_16x16x32_bf16 v[28:31], v[68:71], v[164:167], v[28:31]
    s_nop 6
    v_cvt_pk_bf16_f32 v8, v24, v25
    v_cvt_pk_bf16_f32 v10, v26, v27
    v_cvt_pk_bf16_f32 v9, v28, v29
    v_cvt_pk_bf16_f32 v11, v30, v31
    buffer_store_dwordx4 v[8:11], v4, s[40:43], s49 offen sc1
    s_waitcnt vmcnt(0)
    v_mov_b32 v6, 1
    s_mov_b64 exec, 1
    ds_add_u32 v0, v6 offset:6052
    s_mov_b64 exec, -1
    s_branch L_end
L_Be:
    s_waitcnt lgkmcnt(0)
    s_cmp_lg_u32 s33, 0
    s_cbranch_scc1 L_B_t1
    v_lshrrev_b32 v2, 1, v1
    v_and_b32 v3, 1, v1
    v_and_b32 v4, 24, v2
    v_and_b32 v2, 7, v2
    v_lshl_add_u32 v2, v4, 2, v2
    v_lshl_add_u32 v2, v2, 6, v3
    s_and_b32 s38, s34, 3
    s_lshl_b32 s38, s38, 12
    s_add_u32 s38, s38, s35
    s_lshl_b32 s38, s38, 8
    v_lshl_add_u32 v2, v2, 7, s38
    global_load_dword v166, v2, s[8:9]
L_B_t1:

    s_mov_b32 s3, 0x400000
    v_mov_b32 v0, 156256
    s_and_b32 s62, s34, 3
    s_lshl2_add_u32 s97, s62, s37
    s_lshl4_add_u32 s61, s36, s97
    s_waitcnt lgkmcnt(0)

    s_mov_b32 s40, s30
    s_mov_b32 s41, s31
    s_mov_b32 s42, 16777216
    s_mov_b32 s43, 0x20000
    s_barrier
    s_cmp_eq_u32 s33, 0
    s_cbranch_scc1 L_B_nt
    v_lshrrev_b32 v2, 1, v1
    v_and_b32 v3, 1, v1
    s_lshl2_add_u32 s38, s33, s34
    s_sub_u32 s38, s38, 4
    v_lshl_add_u32 v2, v2, 6, v3
    s_lshl_b32 s38, s38, 10
    s_add_u32 s38, s38, s35
    s_lshl_b32 s38, s38, 8
    v_lshl_add_u32 v2, v2, 7, s38
    s_mov_b32 exec_hi, 0
    global_load_dword v166, v2, s[10:11]
    s_not_b64 exec, exec
    s_waitcnt vmcnt(0)
    global_load_dword v166, v2, s[10:11]
    s_mov_b64 exec, -1
    v_mov_b32 v3, 1
    s_mov_b64 exec, 1
    ds_add_u32 v0, v3 offset:4
    s_mov_b64 exec, -1
L_B_nt:

    v_and_b32 v5, 31, v1
    v_lshrrev_b32 v7, 5, v1
    v_bfe_u32 v2, v5, 1, 1
    v_lshlrev_b32 v2, 2, v2
    v_bfe_u32 v3, v5, 2, 2
    v_or_b32 v2, v2, v3
    v_xor_b32 v2, v2, v7
    v_lshlrev_b32 v2, 4, v2
    v_lshl_add_u32 v2, v5, 7, v2
    s_lshl_b32 s38, s33, 12
    v_add_u32 v2, s38, v2
    v_mov_b32 v8, v2
    v_xor_b32 v9, 32, v2
    v_xor_b32 v10, 64, v2
    v_xor_b32 v11, 0x60, v2
    v_mul_u32_u24 v4, 1008, v5
    v_lshl_add_u32 v4, v7, 4, v4
    v_add_u32 v4, 131072, v4
    v_lshlrev_b32 v12, 10, v5
    v_lshl_add_u32 v7, v7, 4, v12
    v_lshl_add_u32 v5, v5, 4, v0
    s_lshl_b32 s53, s33, 2
    v_add_u32 v6, s53, v0
    s_lshl_b32 s50, s36, 15
    s_add_u32 s50, s50, 65536
    s_lshl_b32 s51, s33, 13
    s_add_u32 s51, s51, s50
    s_mul_i32 s49, s33, 8064
    s_add_u32 s49, s49, 131072
    s_mov_b32 s52, 0x3e0293ee
    s_mov_b32 s56, -1
    s_mov_b32 s57, 0x3fffffff
    s_mov_b64 exec, 0
    s_branch L_pad_b_0
L_pad_b_r:
    s_mov_b64 exec, -1
L_w27:
    s_sleep 1
    ds_read_b32 v3, v6 offset:4032
    s_sub_u32 s3, s3, 1
    s_cbranch_scc1 L_end
    s_waitcnt lgkmcnt(0)
    v_cmp_gt_u32_e64 vcc, 2, v3
    s_cbranch_vccnz L_w27
    ds_read_b128 v[40:43], v8 offset:0
    ds_read_b128 v[44:47], v9 offset:0
    ds_read_b128 v[48:51], v10 offset:0
    ds_read_b128 v[52:55], v11 offset:0
    ds_read_b128 v[56:59], v8 offset:16384
    ds_read_b128 v[60:63], v9 offset:16384
    ds_read_b128 v[64:67], v10 offset:16384
    ds_read_b128 v[68:71], v11 offset:16384
    v_mov_b32 v3, 1
    s_mov_b64 exec, 1
    ds_add_u32 v0, v3 offset:3024
    s_mov_b64 exec, -1
L_w28:
    s_sleep 1
    ds_read_b32 v3, v6 offset:4032
    s_sub_u32 s3, s3, 1
    s_cbranch_scc1 L_end
    s_waitcnt lgkmcnt(0)
    v_cmp_gt_u32_e64 vcc, 4, v3
    s_cbranch_vccnz L_w28
    ds_read_b128 v[72:75], v8 offset:32768
    ds_read_b128 v[76:79], v9 offset:32768
    ds_read_b128 v[80:83], v10 offset:32768
    ds_read_b128 v[84:87], v11 offset:32768
    ds_read_b128 v[88:91], v8 offset:49152
    ds_read_b128 v[92:95], v9 offset:49152
    ds_read_b128 v[96:99], v10 offset:49152
    ds_read_b128 v[100:103], v11 offset:49152
    v_mov_b32 v3, 1
    s_mov_b64 exec, 1
    ds_add_u32 v0, v3 offset:3028
    s_mov_b64 exec, -1
    v_mov_b32 v3, 0
    v_mov_b32 v13, 0
    v_mov_b32 v14, 0
    s_waitcnt vmcnt(0)
L_B_f2:
    global_load_dword v12, v3, s[28:29] offset:128 sc1
    s_sub_u32 s3, s3, 1
    s_cbranch_scc1 L_end
    s_sleep 4
    s_waitcnt vmcnt(2)
    v_cmp_eq_u32 vcc, 0, v13
    s_cbranch_vccz L_B_f2d
    global_load_dword v13, v3, s[28:29] offset:128 sc1
    s_sub_u32 s3, s3, 1
    s_cbranch_scc1 L_end
    s_sleep 4
    s_waitcnt vmcnt(2)
    v_cmp_eq_u32 vcc, 0, v14
    s_cbranch_vccz L_B_f2d
    global_load_dword v14, v3, s[28:29] offset:128 sc1
    s_sub_u32 s3, s3, 1
    s_cbranch_scc1 L_end
    s_sleep 4
    s_waitcnt vmcnt(2)
    v_cmp_eq_u32 vcc, 0, v12
    s_cbranch_vccz L_B_f2d
    s_branch L_B_f2
L_B_f2d:
    s_setprio 3
    v_lshlrev_b32_e64 v3, 4, v1
    s_mov_b32 m0, s49
    s_mov_b32 s38, s51
    s_mov_b64 exec, s[56:57]
    buffer_load_dwordx4 v3, s[40:43], s38 offen sc1 lds
    s_add_u32 m0, m0, 1008
    s_add_u32 s38, s38, 1024
    buffer_load_dwordx4 v3, s[40:43], s38 offen sc1 lds
    s_add_u32 m0, m0, 1008
    s_add_u32 s38, s38, 1024
    buffer_load_dwordx4 v3, s[40:43], s38 offen sc1 lds
    s_add_u32 m0, m0, 1008
    s_add_u32 s38, s38, 1024
    buffer_load_dwordx4 v3, s[40:43], s38 offen sc1 lds
    s_add_u32 m0, m0, 1008
    s_add_u32 s38, s38, 1024
    buffer_load_dwordx4 v3, s[40:43], s38 offen sc1 lds
    s_add_u32 m0, m0, 1008
    s_add_u32 s38, s38, 1024
    buffer_load_dwordx4 v3, s[40:43], s38 offen sc1 lds
    s_add_u32 m0, m0, 1008
    s_add_u32 s38, s38, 1024
    buffer_load_dwordx4 v3, s[40:43], s38 offen sc1 lds
    s_add_u32 m0, m0, 1008
    s_add_u32 s38, s38, 1024
    buffer_load_dwordx4 v3, s[40:43], s38 offen sc1 lds
    s_mov_b64 exec, -1
    buffer_load_dwordx4 v[24:27], v7, s[40:43], s50 offen offset:992 sc1
    v_mov_b32 v3, 1
    s_mov_b64 exec, 1
    ds_add_u32 v0, v3 offset:2028
    s_mov_b64 exec, -1
L_w29:
    s_sleep 1
    ds_read_b32 v3, v6 offset:4032
    s_sub_u32 s3, s3, 1
    s_cbranch_scc1 L_end
    s_waitcnt lgkmcnt(0)
    v_cmp_gt_u32 vcc, 6, v3
    s_cbranch_vccnz L_w29
    v_add_u32 v8, 0x10000, v8
    v_add_u32 v9, 0x10000, v9
    v_add_u32 v10, 0x10000, v10
    v_add_u32 v11, 0x10000, v11
    ds_read_b128 v[104:107], v8 offset:0
    ds_read_b128 v[108:111], v9 offset:0
    ds_read_b128 v[112:115], v10 offset:0
    ds_read_b128 v[116:119], v11 offset:0
    ds_read_b128 v[120:123], v8 offset:16384
    ds_read_b128 v[124:127], v9 offset:16384
    ds_read_b128 v[128:131], v10 offset:16384
    ds_read_b128 v[132:135], v11 offset:16384
    v_mov_b32 v3, 1
    s_mov_b64 exec, 1
    ds_add_u32 v0, v3 offset:3032
    s_mov_b64 exec, -1
L_w30:
    s_sleep 1
    ds_read_b32 v3, v6 offset:4032
    s_sub_u32 s3, s3, 1
    s_cbranch_scc1 L_end
    s_waitcnt lgkmcnt(0)
    v_cmp_gt_u32_e64 vcc, 8, v3
    s_cbranch_vccnz L_w30
    ds_read_b128 v[136:139], v8 offset:32768
    ds_read_b128 v[140:143], v9 offset:32768
    ds_read_b128 v[144:147], v10 offset:32768
    ds_read_b128 v[148:151], v11 offset:32768
    ds_read_b128 v[152:155], v8 offset:49152
    ds_read_b128 v[156:159], v9 offset:49152
    ds_read_b128 v[160:163], v10 offset:49152
    ds_read_b128 v[164:167], v11 offset:49152
    v_mov_b32 v3, 1
    s_mov_b64 exec, 1
    ds_add_u32 v0, v3 offset:3036
    s_mov_b64 exec, -1
L_pad_b_0:
    s_cbranch_execz L_pad_b_1
    v_lshl_add_u32 v3, v1, 4, s49
    s_waitcnt vmcnt(0) lgkmcnt(0)
    s_mov_b64 exec, s[56:57]
    ds_read_b128 v[8:11], v3 offset:0
    ds_read_b128 v[12:15], v3 offset:1008
    ds_read_b128 v[16:19], v3 offset:2016
    ds_read_b128 v[20:23], v3 offset:3024
    ds_read_b128 v[28:31], v3 offset:4032
    ds_read_b128 v[32:35], v3 offset:5040
    ds_read_b128 v[36:39], v3 offset:6048
    s_mov_b64 exec, -1
    v_max3_u32 v6, v24, v25, v26
    v_max_u32 v6, v6, v27
    s_mov_b64 exec, s[56:57]
    s_waitcnt lgkmcnt(6)
    v_max3_u32 v6, v6, v8, v9
    v_max3_u32 v6, v6, v10, v11
    ds_read_b128 v[8:11], v3 offset:7056
    s_waitcnt lgkmcnt(6)
    v_max3_u32 v6, v6, v12, v13
    v_max3_u32 v6, v6, v14, v15
    s_waitcnt lgkmcnt(5)
    v_max3_u32 v6, v6, v16, v17
    v_max3_u32 v6, v6, v18, v19
    s_waitcnt lgkmcnt(4)
    v_max3_u32 v6, v6, v20, v21
    v_max3_u32 v6, v6, v22, v23
    s_waitcnt lgkmcnt(3)
    v_max3_u32 v6, v6, v28, v29
    v_max3_u32 v6, v6, v30, v31
    s_waitcnt lgkmcnt(2)
    v_max3_u32 v6, v6, v32, v33
    v_max3_u32 v6, v6, v34, v35
    s_waitcnt lgkmcnt(1)
    v_max3_u32 v6, v6, v36, v37
    v_max3_u32 v6, v6, v38, v39
    s_waitcnt lgkmcnt(0)
    v_max3_u32 v6, v6, v8, v9
    v_max3_u32 v6, v6, v10, v11
    s_mov_b64 exec, -1
    v_cmp_eq_u32 vcc, -1, v6
    s_cbranch_vccnz L_B_qv
L_B_qok:
    v_mov_b32 v3, 1
    s_mov_b64 exec, 1
    ds_add_u32 v0, v3 offset:1008
    s_mov_b64 exec, -1
    s_setprio 2
L_w31:
    ds_read_b32 v3, v0 offset:1008
    s_sub_u32 s3, s3, 1
    s_cbranch_scc1 L_end
    s_waitcnt lgkmcnt(0)
    v_cmp_gt_u32 vcc, 4, v3
    s_cbranch_vccnz L_w31
    s_xor_b32 s38, s2, 40
    s_or_b32 s38, s38, s33
    s_cbranch_scc1 L_B_n3
    v_mov_b32 v3, 4
    s_mov_b64 exec, 1
    global_store_dword v3, v3, s[28:29] sc1
    s_mov_b64 exec, -1
L_B_n3:
    ds_read_b128 v[28:31], v4 offset:0
    ds_read_b128 v[32:35], v4 offset:32
    ds_read_b128 v[36:39], v4 offset:64
    s_waitcnt lgkmcnt(2)
    v_mfma_f32_32x32x16_bf16 v[8:23], v[40:43], v[28:31], 0
    ds_read_b128 v[40:43], v4 offset:96
    s_waitcnt lgkmcnt(2)
    v_mfma_f32_32x32x16_bf16 v[8:23], v[44:47], v[32:35], v[8:23]
    ds_read_b128 v[44:47], v4 offset:128
    s_waitcnt lgkmcnt(2)
    v_mfma_f32_32x32x16_bf16 v[8:23], v[48:51], v[36:39], v[8:23]
    ds_read_b128 v[48:51], v4 offset:160
    s_waitcnt lgkmcnt(2)
    v_mfma_f32_32x32x16_bf16 v[8:23], v[52:55], v[40:43], v[8:23]
    ds_read_b128 v[52:55], v4 offset:192
    s_waitcnt lgkmcnt(2)
    v_mfma_f32_32x32x16_bf16 v[8:23], v[56:59], v[44:47], v[8:23]
    ds_read_b128 v[56:59], v4 offset:224
    s_waitcnt lgkmcnt(2)
    v_mfma_f32_32x32x16_bf16 v[8:23], v[60:63], v[48:51], v[8:23]
    ds_read_b128 v[60:63], v4 offset:256
    s_waitcnt lgkmcnt(2)
    v_mfma_f32_32x32x16_bf16 v[8:23], v[64:67], v[52:55], v[8:23]
    ds_read_b128 v[64:67], v4 offset:288
    s_waitcnt lgkmcnt(2)
    v_mfma_f32_32x32x16_bf16 v[8:23], v[68:71], v[56:59], v[8:23]
    ds_read_b128 v[68:71], v4 offset:320
    s_waitcnt lgkmcnt(2)
    v_mfma_f32_32x32x16_bf16 v[8:23], v[72:75], v[60:63], v[8:23]
    ds_read_b128 v[72:75], v4 offset:352
    s_waitcnt lgkmcnt(2)
    v_mfma_f32_32x32x16_bf16 v[8:23], v[76:79], v[64:67], v[8:23]
    ds_read_b128 v[76:79], v4 offset:384
    s_waitcnt lgkmcnt(2)
    v_mfma_f32_32x32x16_bf16 v[8:23], v[80:83], v[68:71], v[8:23]
    ds_read_b128 v[80:83], v4 offset:416
    s_waitcnt lgkmcnt(2)
    v_mfma_f32_32x32x16_bf16 v[8:23], v[84:87], v[72:75], v[8:23]
    ds_read_b128 v[84:87], v4 offset:448
    s_waitcnt lgkmcnt(2)
    v_mfma_f32_32x32x16_bf16 v[8:23], v[88:91], v[76:79], v[8:23]
    ds_read_b128 v[88:91], v4 offset:480
    s_waitcnt lgkmcnt(2)
    v_mfma_f32_32x32x16_bf16 v[8:23], v[92:95], v[80:83], v[8:23]
    ds_read_b128 v[92:95], v4 offset:512
    s_waitcnt lgkmcnt(2)
    v_mfma_f32_32x32x16_bf16 v[8:23], v[96:99], v[84:87], v[8:23]
    ds_read_b128 v[96:99], v4 offset:544
    s_waitcnt lgkmcnt(2)
    v_mfma_f32_32x32x16_bf16 v[8:23], v[100:103], v[88:91], v[8:23]
    ds_read_b128 v[100:103], v4 offset:576
    s_waitcnt lgkmcnt(2)
    v_mfma_f32_32x32x16_bf16 v[8:23], v[104:107], v[92:95], v[8:23]
    ds_read_b128 v[104:107], v4 offset:608
    s_waitcnt lgkmcnt(2)
    v_mfma_f32_32x32x16_bf16 v[8:23], v[108:111], v[96:99], v[8:23]
    ds_read_b128 v[108:111], v4 offset:640
    s_waitcnt lgkmcnt(2)
    v_mfma_f32_32x32x16_bf16 v[8:23], v[112:115], v[100:103], v[8:23]
    ds_read_b128 v[112:115], v4 offset:672
    s_waitcnt lgkmcnt(2)
    v_mfma_f32_32x32x16_bf16 v[8:23], v[116:119], v[104:107], v[8:23]
L_pad_b_1:
    s_cbranch_execz L_pad_b_2
    ds_read_b128 v[116:119], v4 offset:704
    s_waitcnt lgkmcnt(2)
    v_mfma_f32_32x32x16_bf16 v[8:23], v[120:123], v[108:111], v[8:23]
    ds_read_b128 v[120:123], v4 offset:736
    s_waitcnt lgkmcnt(2)
    v_mfma_f32_32x32x16_bf16 v[8:23], v[124:127], v[112:115], v[8:23]
    ds_read_b128 v[124:127], v4 offset:768
    s_waitcnt lgkmcnt(2)
    v_mfma_f32_32x32x16_bf16 v[8:23], v[128:131], v[116:119], v[8:23]
    ds_read_b128 v[128:131], v4 offset:800
    s_waitcnt lgkmcnt(2)
    v_mfma_f32_32x32x16_bf16 v[8:23], v[132:135], v[120:123], v[8:23]
    ds_read_b128 v[132:135], v4 offset:832
    s_waitcnt lgkmcnt(2)
    v_mfma_f32_32x32x16_bf16 v[8:23], v[136:139], v[124:127], v[8:23]
    ds_read_b128 v[136:139], v4 offset:864
    s_waitcnt lgkmcnt(2)
    v_mfma_f32_32x32x16_bf16 v[8:23], v[140:143], v[128:131], v[8:23]
    ds_read_b128 v[140:143], v4 offset:896
    s_waitcnt lgkmcnt(2)
    v_mfma_f32_32x32x16_bf16 v[8:23], v[144:147], v[132:135], v[8:23]
    ds_read_b128 v[144:147], v4 offset:928
    s_waitcnt lgkmcnt(2)
    v_mfma_f32_32x32x16_bf16 v[8:23], v[148:151], v[136:139], v[8:23]
    ds_read_b128 v[148:151], v4 offset:960
    s_waitcnt lgkmcnt(2)
    v_mfma_f32_32x32x16_bf16 v[8:23], v[152:155], v[140:143], v[8:23]
    s_waitcnt lgkmcnt(1)
    v_mfma_f32_32x32x16_bf16 v[8:23], v[156:159], v[144:147], v[8:23]
    s_waitcnt lgkmcnt(0)
    v_mfma_f32_32x32x16_bf16 v[8:23], v[160:163], v[148:151], v[8:23]
    v_mfma_f32_32x32x16_bf16 v[8:23], v[164:167], v[24:27], v[8:23]
    v_add_u32 v4, s53, v0
    v_add_u32_e64 v166, s53, v5
    s_lshl_b32 s38, s33, 11
    s_add_u32 s38, s38, 131072
    v_lshl_add_u32 v167, v1, 4, s38
    s_nop 6
    v_max3_f32 v164, v8, v9, v10
    v_max3_f32 v165, v11, v12, v13
    v_max3_f32 v164, v164, v14, v15
    v_max3_f32 v165, v165, v16, v17
    v_max3_f32 v164, v164, v18, v19
    v_max3_f32 v165, v165, v20, v21
    v_max3_f32 v164, v164, v22, v23
    v_max_f32 v164, v164, v165
    v_mov_b32 v165, v164
    s_nop 1
    v_permlane32_swap_b32 v164, v165
    v_max_f32 v164, v164, v165
    ds_write_b32 v166, v164 offset:7072
    v_mul_f32 v164, s52, v164
    v_pk_fma_f32 v[8:9], v[8:9], s[52:53], v[164:165] op_sel_hi:[1,0,0] neg_lo:[0,0,1] neg_hi:[0,0,1]
    v_pk_fma_f32 v[10:11], v[10:11], s[52:53], v[164:165] op_sel_hi:[1,0,0] neg_lo:[0,0,1] neg_hi:[0,0,1]
    v_pk_fma_f32 v[12:13], v[12:13], s[52:53], v[164:165] op_sel_hi:[1,0,0] neg_lo:[0,0,1] neg_hi:[0,0,1]
    v_pk_fma_f32 v[14:15], v[14:15], s[52:53], v[164:165] op_sel_hi:[1,0,0] neg_lo:[0,0,1] neg_hi:[0,0,1]
    v_pk_fma_f32 v[16:17], v[16:17], s[52:53], v[164:165] op_sel_hi:[1,0,0] neg_lo:[0,0,1] neg_hi:[0,0,1]
    v_pk_fma_f32 v[18:19], v[18:19], s[52:53], v[164:165] op_sel_hi:[1,0,0] neg_lo:[0,0,1] neg_hi:[0,0,1]
    v_pk_fma_f32 v[20:21], v[20:21], s[52:53], v[164:165] op_sel_hi:[1,0,0] neg_lo:[0,0,1] neg_hi:[0,0,1]
    v_pk_fma_f32 v[22:23], v[22:23], s[52:53], v[164:165] op_sel_hi:[1,0,0] neg_lo:[0,0,1] neg_hi:[0,0,1]
    v_exp_f32 v8, v8
    v_exp_f32 v9, v9
    v_exp_f32 v10, v10
    v_exp_f32 v11, v11
    v_exp_f32 v12, v12
    v_exp_f32 v13, v13
    v_exp_f32 v14, v14
    v_exp_f32 v15, v15
    ds_read_b128 v[160:163], v5 offset:7072
    v_exp_f32 v16, v16
    v_exp_f32 v17, v17
    v_exp_f32 v18, v18
    v_exp_f32 v19, v19
    v_exp_f32 v20, v20
    v_exp_f32 v21, v21
    v_exp_f32 v22, v22
    v_exp_f32 v23, v23
    s_waitcnt lgkmcnt(0)
L_B_mx0:
    v_max3_u32 v152, v160, v161, v162
    v_max_u32 v152, v152, v163
    v_cmp_eq_u32 vcc, -1, v152
    v_max3_f32 v153, v160, v161, v162
    v_max_f32 v153, v153, v163
    s_cbranch_vccnz L_B_my0
    v_mul_f32 v6, s52, v153
    v_sub_f32 v164, v164, v6
    v_exp_f32 v164, v164
    v_mov_b32_e64 v161, 1
    v_pk_mul_f32 v[8:9], v[8:9], v[164:165] op_sel_hi:[1,0]
    v_pk_mul_f32 v[10:11], v[10:11], v[164:165] op_sel_hi:[1,0]
    v_pk_mul_f32 v[12:13], v[12:13], v[164:165] op_sel_hi:[1,0]
    v_pk_mul_f32 v[14:15], v[14:15], v[164:165] op_sel_hi:[1,0]
    v_cvt_pk_bf16_f32 v152, v8, v9
    v_cvt_pk_bf16_f32 v153, v10, v11
    v_cvt_pk_bf16_f32 v154, v12, v13
    v_cvt_pk_bf16_f32 v155, v14, v15
    ds_write_b128 v167, v[152:155] offset:0
    v_pk_mul_f32 v[16:17], v[16:17], v[164:165] op_sel_hi:[1,0]
    v_pk_mul_f32 v[18:19], v[18:19], v[164:165] op_sel_hi:[1,0]
    v_pk_mul_f32 v[20:21], v[20:21], v[164:165] op_sel_hi:[1,0]
    v_pk_mul_f32 v[22:23], v[22:23], v[164:165] op_sel_hi:[1,0]
    v_cvt_pk_bf16_f32 v156, v16, v17
    v_cvt_pk_bf16_f32 v157, v18, v19
    v_cvt_pk_bf16_f32 v158, v20, v21
    v_cvt_pk_bf16_f32 v159, v22, v23
    ds_write_b128 v167, v[156:159] offset:1024
    v_add_u32 v5, -8800, v5
    v_add_u32 v166, s53, v5
    v_mov_b32 v165, -1
    ds_write_b32 v166, v165
    s_mov_b64 exec, 1
    ds_add_u32 v0, v161 offset:1016
    s_mov_b64 exec, -1
    v_pk_add_f32 v[8:9], v[8:9], v[16:17]
    v_pk_add_f32 v[10:11], v[10:11], v[18:19]
    v_pk_add_f32 v[12:13], v[12:13], v[20:21]
    v_pk_add_f32 v[14:15], v[14:15], v[22:23]
    v_pk_add_f32 v[8:9], v[8:9], v[12:13]
    v_pk_add_f32 v[10:11], v[10:11], v[14:15]
    v_pk_add_f32 v[8:9], v[8:9], v[10:11]
    v_add_f32 v7, v8, v9
L_w32:
    ds_read_b32 v3, v0 offset:1016
L_pad_b_2:
    s_cbranch_execz L_pad_b_3
    s_sub_u32 s3, s3, 1
    s_cbranch_scc1 L_end
    s_waitcnt lgkmcnt(0)
    v_cmp_gt_u32 vcc, 4, v3
    s_cbranch_vccnz L_w32
L_w33:
    ds_read_b32 v3, v4 offset:4032
    s_sub_u32 s3, s3, 1
    s_cbranch_scc1 L_end
    s_waitcnt lgkmcnt(0)
    v_cmp_gt_u32 vcc, 10, v3
    s_cbranch_vccnz L_w33
    ds_read_b128 v[152:155], v2 offset:0
    v_xor_b32 v3, 32, v2
    ds_read_b128 v[156:159], v3 offset:0
    v_xor_b32 v3, 64, v2
    ds_read_b128 v[160:163], v3 offset:0
    v_xor_b32 v3, 96, v2
    ds_read_b128 v[164:167], v3 offset:0
    s_waitcnt lgkmcnt(3)
    v_mfma_f32_32x32x16_bf16 v[8:23], v[152:155], v[28:31], 0
    ds_read_b128 v[152:155], v2 offset:16384
    s_waitcnt lgkmcnt(3)
    v_mfma_f32_32x32x16_bf16 v[8:23], v[156:159], v[32:35], v[8:23]
    v_xor_b32 v3, 32, v2
    ds_read_b128 v[156:159], v3 offset:16384
    s_waitcnt lgkmcnt(3)
    v_mfma_f32_32x32x16_bf16 v[8:23], v[160:163], v[36:39], v[8:23]
    v_xor_b32 v3, 64, v2
    ds_read_b128 v[160:163], v3 offset:16384
    s_waitcnt lgkmcnt(3)
    v_mfma_f32_32x32x16_bf16 v[8:23], v[164:167], v[40:43], v[8:23]
    v_xor_b32 v3, 96, v2
    ds_read_b128 v[164:167], v3 offset:16384
    s_waitcnt lgkmcnt(3)
    v_mfma_f32_32x32x16_bf16 v[8:23], v[152:155], v[44:47], v[8:23]
L_w34:
    ds_read_b32 v3, v4 offset:4032
    s_sub_u32 s3, s3, 1
    s_cbranch_scc1 L_end
    s_waitcnt lgkmcnt(0)
    v_cmp_gt_u32 vcc, 12, v3
    s_cbranch_vccnz L_w34
    ds_read_b128 v[152:155], v2 offset:32768
    s_waitcnt lgkmcnt(3)
    v_mfma_f32_32x32x16_bf16 v[8:23], v[156:159], v[48:51], v[8:23]
    v_xor_b32 v3, 32, v2
    ds_read_b128 v[156:159], v3 offset:32768
    s_waitcnt lgkmcnt(3)
    v_mfma_f32_32x32x16_bf16 v[8:23], v[160:163], v[52:55], v[8:23]
    v_xor_b32 v3, 64, v2
    ds_read_b128 v[160:163], v3 offset:32768
    s_waitcnt lgkmcnt(3)
    v_mfma_f32_32x32x16_bf16 v[8:23], v[164:167], v[56:59], v[8:23]
    v_xor_b32 v3, 96, v2
    ds_read_b128 v[164:167], v3 offset:32768
    s_waitcnt lgkmcnt(3)
    v_mfma_f32_32x32x16_bf16 v[8:23], v[152:155], v[60:63], v[8:23]
    ds_read_b128 v[152:155], v2 offset:49152
    s_waitcnt lgkmcnt(3)
    v_mfma_f32_32x32x16_bf16 v[8:23], v[156:159], v[64:67], v[8:23]
    v_xor_b32 v3, 32, v2
    ds_read_b128 v[156:159], v3 offset:49152
    s_waitcnt lgkmcnt(3)
    v_mfma_f32_32x32x16_bf16 v[8:23], v[160:163], v[68:71], v[8:23]
    v_xor_b32 v3, 64, v2
    ds_read_b128 v[160:163], v3 offset:49152
    s_waitcnt lgkmcnt(3)
    v_mfma_f32_32x32x16_bf16 v[8:23], v[164:167], v[72:75], v[8:23]
    v_xor_b32 v3, 96, v2
    ds_read_b128 v[164:167], v3 offset:49152
    s_waitcnt lgkmcnt(3)
    v_mfma_f32_32x32x16_bf16 v[8:23], v[152:155], v[76:79], v[8:23]
    v_add_u32 v2, 0x10000, v2
L_w35:
    ds_read_b32 v3, v4 offset:4032
    s_sub_u32 s3, s3, 1
    s_cbranch_scc1 L_end
    s_waitcnt lgkmcnt(0)
    v_cmp_gt_u32 vcc, 13, v3
    s_cbranch_vccnz L_w35
    ds_read_b128 v[152:155], v2 offset:0
    s_waitcnt lgkmcnt(3)
    v_mfma_f32_32x32x16_bf16 v[8:23], v[156:159], v[80:83], v[8:23]
    v_xor_b32 v3, 32, v2
    ds_read_b128 v[156:159], v3 offset:0
    s_waitcnt lgkmcnt(3)
    v_mfma_f32_32x32x16_bf16 v[8:23], v[160:163], v[84:87], v[8:23]
    v_xor_b32 v3, 64, v2
    ds_read_b128 v[160:163], v3 offset:0
    s_waitcnt lgkmcnt(3)
    v_mfma_f32_32x32x16_bf16 v[8:23], v[164:167], v[88:91], v[8:23]
    v_xor_b32 v3, 96, v2
    ds_read_b128 v[164:167], v3 offset:0
    s_waitcnt lgkmcnt(3)
    v_mfma_f32_32x32x16_bf16 v[8:23], v[152:155], v[92:95], v[8:23]
L_w36:
    ds_read_b32 v3, v4 offset:4032
    s_sub_u32 s3, s3, 1
    s_cbranch_scc1 L_end
    s_waitcnt lgkmcnt(0)
    v_cmp_gt_u32 vcc, 14, v3
    s_cbranch_vccnz L_w36
    ds_read_b128 v[152:155], v2 offset:16384
    s_waitcnt lgkmcnt(3)
    v_mfma_f32_32x32x16_bf16 v[8:23], v[156:159], v[96:99], v[8:23]
    v_xor_b32 v3, 32, v2
    ds_read_b128 v[156:159], v3 offset:16384
    s_waitcnt lgkmcnt(3)
    v_mfma_f32_32x32x16_bf16 v[8:23], v[160:163], v[100:103], v[8:23]
    v_xor_b32 v3, 64, v2
    ds_read_b128 v[160:163], v3 offset:16384
    s_waitcnt lgkmcnt(3)
    v_mfma_f32_32x32x16_bf16 v[8:23], v[164:167], v[104:107], v[8:23]
    v_xor_b32 v3, 96, v2
    ds_read_b128 v[164:167], v3 offset:16384
    s_waitcnt lgkmcnt(3)
    v_mfma_f32_32x32x16_bf16 v[8:23], v[152:155], v[108:111], v[8:23]
L_w37:
    ds_read_b32 v3, v4 offset:4032
    s_sub_u32 s3, s3, 1
    s_cbranch_scc1 L_end
    s_waitcnt lgkmcnt(0)
    v_cmp_gt_u32 vcc, 15, v3
    s_cbranch_vccnz L_w37
    ds_read_b128 v[152:155], v2 offset:32768
    s_waitcnt lgkmcnt(3)
    v_mfma_f32_32x32x16_bf16 v[8:23], v[156:159], v[112:115], v[8:23]
    v_xor_b32 v3, 32, v2
    ds_read_b128 v[156:159], v3 offset:32768
    s_waitcnt lgkmcnt(3)
    v_mfma_f32_32x32x16_bf16 v[8:23], v[160:163], v[116:119], v[8:23]
    v_xor_b32 v3, 64, v2
    ds_read_b128 v[160:163], v3 offset:32768
    s_waitcnt lgkmcnt(3)
L_pad_b_3:
    s_cbranch_execz L_pad_b_4
    v_mfma_f32_32x32x16_bf16 v[8:23], v[164:167], v[120:123], v[8:23]
    v_xor_b32 v3, 96, v2
    ds_read_b128 v[164:167], v3 offset:32768
    s_waitcnt lgkmcnt(3)
    v_mfma_f32_32x32x16_bf16 v[8:23], v[152:155], v[124:127], v[8:23]
L_w38:
    ds_read_b32 v3, v4 offset:4032
    s_sub_u32 s3, s3, 1
    s_cbranch_scc1 L_end
    s_waitcnt lgkmcnt(0)
    v_cmp_gt_u32 vcc, 16, v3
    s_cbranch_vccnz L_w38
    ds_read_b128 v[152:155], v2 offset:49152
    s_waitcnt lgkmcnt(3)
    v_mfma_f32_32x32x16_bf16 v[8:23], v[156:159], v[128:131], v[8:23]
    v_xor_b32 v3, 32, v2
    ds_read_b128 v[156:159], v3 offset:49152
    s_waitcnt lgkmcnt(3)
    v_mfma_f32_32x32x16_bf16 v[8:23], v[160:163], v[132:135], v[8:23]
    v_xor_b32 v3, 64, v2
    ds_read_b128 v[160:163], v3 offset:49152
    s_waitcnt lgkmcnt(3)
    v_mfma_f32_32x32x16_bf16 v[8:23], v[164:167], v[136:139], v[8:23]
    v_xor_b32 v3, 96, v2
    ds_read_b128 v[164:167], v3 offset:49152
    s_waitcnt lgkmcnt(3)
    v_mfma_f32_32x32x16_bf16 v[8:23], v[152:155], v[140:143], v[8:23]
    s_waitcnt lgkmcnt(2)
    v_mfma_f32_32x32x16_bf16 v[8:23], v[156:159], v[144:147], v[8:23]
    s_waitcnt lgkmcnt(1)
    v_mfma_f32_32x32x16_bf16 v[8:23], v[160:163], v[148:151], v[8:23]
    s_waitcnt lgkmcnt(0)
    v_mfma_f32_32x32x16_bf16 v[8:23], v[164:167], v[24:27], v[8:23]
    v_add_u32_e64 v166, s53, v5
    s_lshl_b32 s38, s33, 11
    s_add_u32 s38, s38, 139264
    v_lshl_add_u32 v167, v1, 4, s38
    s_nop 7
    v_max3_f32 v164, v8, v9, v10
    v_max3_f32 v165, v11, v12, v13
    v_max3_f32 v164, v164, v14, v15
    v_max3_f32 v165, v165, v16, v17
    v_max3_f32 v164, v164, v18, v19
    v_max3_f32 v165, v165, v20, v21
    v_max3_f32 v164, v164, v22, v23
    v_max_f32 v164, v164, v165
    v_mov_b32 v165, v164
    s_nop 1
    v_permlane32_swap_b32 v164, v165
    v_max_f32 v164, v164, v165
    ds_write_b32 v166, v164 offset:0
    v_mul_f32 v164, s52, v164
    v_pk_fma_f32 v[8:9], v[8:9], s[52:53], v[164:165] op_sel_hi:[1,0,0] neg_lo:[0,0,1] neg_hi:[0,0,1]
    v_pk_fma_f32 v[10:11], v[10:11], s[52:53], v[164:165] op_sel_hi:[1,0,0] neg_lo:[0,0,1] neg_hi:[0,0,1]
    v_pk_fma_f32 v[12:13], v[12:13], s[52:53], v[164:165] op_sel_hi:[1,0,0] neg_lo:[0,0,1] neg_hi:[0,0,1]
    v_pk_fma_f32 v[14:15], v[14:15], s[52:53], v[164:165] op_sel_hi:[1,0,0] neg_lo:[0,0,1] neg_hi:[0,0,1]
    v_pk_fma_f32 v[16:17], v[16:17], s[52:53], v[164:165] op_sel_hi:[1,0,0] neg_lo:[0,0,1] neg_hi:[0,0,1]
    v_pk_fma_f32 v[18:19], v[18:19], s[52:53], v[164:165] op_sel_hi:[1,0,0] neg_lo:[0,0,1] neg_hi:[0,0,1]
    v_pk_fma_f32 v[20:21], v[20:21], s[52:53], v[164:165] op_sel_hi:[1,0,0] neg_lo:[0,0,1] neg_hi:[0,0,1]
    v_pk_fma_f32 v[22:23], v[22:23], s[52:53], v[164:165] op_sel_hi:[1,0,0] neg_lo:[0,0,1] neg_hi:[0,0,1]
    v_exp_f32 v8, v8
    v_exp_f32 v9, v9
    v_exp_f32 v10, v10
    v_exp_f32 v11, v11
    v_exp_f32 v12, v12
    v_exp_f32 v13, v13
    v_exp_f32 v14, v14
    v_exp_f32 v15, v15
    ds_read_b128 v[160:163], v5 offset:0
    v_exp_f32 v16, v16
    v_exp_f32 v17, v17
    v_exp_f32 v18, v18
    v_exp_f32 v19, v19
    v_exp_f32 v20, v20
    v_exp_f32 v21, v21
    v_exp_f32 v22, v22
    v_exp_f32 v23, v23
    s_waitcnt lgkmcnt(0)
L_B_mx1:
    v_max3_u32 v152, v160, v161, v162
    v_max_u32 v152, v152, v163
    v_cmp_eq_u32 vcc, -1, v152
    v_max3_f32 v153, v160, v161, v162
    v_max_f32 v153, v153, v163
    s_cbranch_vccnz L_B_my1
    v_mul_f32 v153, s52, v153
    v_max_f32 v160, v153, v6
    v_sub_f32 v164, v164, v160
    v_exp_f32 v164, v164
    v_mov_b32 v161, 1
    v_pk_mul_f32 v[8:9], v[8:9], v[164:165] op_sel_hi:[1,0]
    v_pk_mul_f32 v[10:11], v[10:11], v[164:165] op_sel_hi:[1,0]
    v_pk_mul_f32 v[12:13], v[12:13], v[164:165] op_sel_hi:[1,0]
    v_pk_mul_f32 v[14:15], v[14:15], v[164:165] op_sel_hi:[1,0]
    v_cvt_pk_bf16_f32 v152, v8, v9
    v_cvt_pk_bf16_f32 v153, v10, v11
    v_cvt_pk_bf16_f32 v154, v12, v13
    v_cvt_pk_bf16_f32 v155, v14, v15
    ds_write_b128 v167, v[152:155] offset:0
    v_pk_mul_f32 v[16:17], v[16:17], v[164:165] op_sel_hi:[1,0]
    v_pk_mul_f32 v[18:19], v[18:19], v[164:165] op_sel_hi:[1,0]
    v_pk_mul_f32 v[20:21], v[20:21], v[164:165] op_sel_hi:[1,0]
    v_pk_mul_f32 v[22:23], v[22:23], v[164:165] op_sel_hi:[1,0]
    v_cvt_pk_bf16_f32 v156, v16, v17
    v_cvt_pk_bf16_f32 v157, v18, v19
    v_cvt_pk_bf16_f32 v158, v20, v21
    v_cvt_pk_bf16_f32 v159, v22, v23
    ds_write_b128 v167, v[156:159] offset:1024
    s_mov_b64 exec, 1
    ds_add_u32 v0, v161 offset:1016
    s_mov_b64 exec, -1
    v_sub_f32 v165, v6, v160
    v_exp_f32 v165, v165
    v_mov_b32_e64 v6, v160
    v_pk_add_f32 v[8:9], v[8:9], v[16:17]
    v_pk_add_f32 v[10:11], v[10:11], v[18:19]
    v_pk_add_f32 v[12:13], v[12:13], v[20:21]
    v_pk_add_f32 v[14:15], v[14:15], v[22:23]
    v_pk_add_f32 v[8:9], v[8:9], v[12:13]
    v_pk_add_f32 v[10:11], v[10:11], v[14:15]
    v_pk_add_f32 v[8:9], v[8:9], v[10:11]
    v_add_f32 v8, v8, v9
    v_fmac_f32 v8, v7, v165
    v_mov_b32 v9, v8
    s_nop 1
    v_permlane32_swap_b32 v8, v9
    v_add_f32 v8, v8, v9
    ds_write_b32 v166, v8 offset:1024
    v_mov_b32 v164, 1
L_pad_b_4:
    s_cbranch_execz L_pad_b_5
    s_mov_b64 exec, 1
    ds_add_u32 v0, v164 offset:1020
    s_mov_b64 exec, -1
    s_cmp_lg_u32 s33, 0
    s_cbranch_scc1 L_B_F
    v_and_b32 v2, 7, v1
    v_lshlrev_b32 v2, 7, v2
    v_and_or_b32 v2, v1, 24, v2
    s_lshl_b32 s49, s61, 10
    s_add_u32 s49, s49, 1048576
L_w39:
    ds_read_b32 v3, v0 offset:1020
    s_sub_u32 s3, s3, 1
    s_cbranch_scc1 L_end
    s_waitcnt lgkmcnt(0)
    v_cmp_gt_u32 vcc, 4, v3
    s_cbranch_vccnz L_w39
    ds_read_b128 v[8:11], v5 offset:1024
    s_waitcnt lgkmcnt(0)
    v_add_f32 v8, v8, v9
    v_add_f32 v10, v10, v11
    v_add_f32 v7, v8, v10
L_w40:
    ds_read_b32 v3, v0 offset:2024
    s_sub_u32 s3, s3, 1
    s_cbranch_scc1 L_end
    s_waitcnt lgkmcnt(0)
    v_cmp_gt_u32 vcc, 4, v3
    s_cbranch_vccnz L_w40
L_w41:
    s_sleep 1
    ds_read_b32 v3, v0 offset:7060
    s_sub_u32 s3, s3, 1
    s_cbranch_scc1 L_end
    s_waitcnt lgkmcnt(0)
    v_cmp_gt_u32 vcc, 1, v3
    s_cbranch_vccnz L_w41
    s_mov_b32 exec_hi, 0
    buffer_store_dwordx2 v[6:7], v2, s[40:43], s49 offen sc1
    s_mov_b64 exec, -1
    v_mov_b32 v3, 1
    s_mov_b64 exec, 1
    ds_add_u32 v0, v3 offset:1012
    s_mov_b64 exec, -1
L_B_F:
    s_setprio 0
    s_cmp_ge_u32 s35, 28
    s_cbranch_scc1 L_end
    v_bfe_u32 v12, v1, 4, 1
    v_lshlrev_b32 v12, 1, v12
    v_and_b32 v13, 7, v1
    v_xor_b32 v12, v12, v13
    v_lshlrev_b32 v164, 4, v12
    v_lshrrev_b32 v165, 3, v1
    v_lshrrev_b32 v6, 4, v1
    v_bfe_u32 v8, v1, 2, 2
    v_lshl_add_u32 v9, v6, 3, v8
    v_lshrrev_b32 v8, 1, v8
    v_and_b32 v10, 1, v6
    v_lshl_or_b32 v8, v10, 1, v8
    v_xor_b32 v8, s33, v8
    v_lshlrev_b32 v8, 5, v8
    v_lshl_add_u32 v8, v9, 7, v8
    v_and_b32 v9, 3, v1
    v_lshl_add_u32 v2, v9, 3, v8
    v_bfe_u32 v7, v1, 3, 1
    v_lshl_add_u32 v8, v7, 2, v9
    v_mul_u32_u24 v8, 1088, v8
    v_lshl_add_u32 v8, v6, 4, v8
    v_add_u32 v4, 135424, v8
    v_and_b32_e64 v9, 1, v1
    v_lshl_add_u32 v8, v7, 1, v9
    v_mul_u32_u24 v8, 1088, v8
    v_lshl_add_u32 v8, v6, 4, v8
    v_add_u32 v5, 131072, v8
    v_mul_u32_u24 v8, 144, v7
    v_lshl_add_u32 v8, v6, 3, v8
    s_lshl_b32 s38, s33, 5
    s_add_u32 s38, s38, 144128
    v_add_u32 v6, s38, v8
    v_lshlrev_b32 v7, 5, v7
    v_add_u32 v7, 149504, v7
    s_mov_b32 s44, s18
    s_mov_b32 s45, s19
    s_mov_b32 s46, 1835008
    s_mov_b32 s47, 0x20000
    s_lshl_b32 s58, s35, 7
L_w42:
    s_sleep 2
    ds_read_b32 v3, v0 offset:1012
    s_sub_u32 s3, s3, 1
    s_cbranch_scc1 L_end
    s_waitcnt lgkmcnt(0)
    v_cmp_gt_u32 vcc, 5, v3
    s_cbranch_vccnz L_w42

    v_mul_u32_u24 v12, 3584, v165
    v_add_u32 v12, v12, v164
    v_xor_b32 v13, 64, v12
    s_mul_i32 s38, s33, 458752
    s_add_u32 s58, s58, s38
    s_lshl_b32 s57, s33, 14
    s_add_u32 s57, s57, 0
    s_and_b32 s56, s34, 3
    s_mov_b32 s59, 0
L_A_f1:
    s_xor_b32 s38, s59, s56
    s_lshl_b32 s39, s38, 12
    s_add_u32 s39, s39, s57
    s_mul_i32 s38, s38, 114688
    s_add_u32 s38, s38, s58
    s_add_u32 m0, s39, 0
    s_add_u32 s60, s38, 0
    buffer_load_dwordx4 v12, s[44:47], s60 offen lds
    s_waitcnt vmcnt(3)
    s_add_u32 m0, s39, 1024
    s_add_u32 s60, s38, 28672
    buffer_load_dwordx4 v13, s[44:47], s60 offen lds
    s_waitcnt vmcnt(3)
    s_add_u32 m0, s39, 2048
    s_add_u32 s60, s38, 57344
    buffer_load_dwordx4 v12, s[44:47], s60 offen lds
    s_waitcnt vmcnt(3)
    s_add_u32 m0, s39, 3072
    s_add_u32 s60, s38, 86016
    buffer_load_dwordx4 v13, s[44:47], s60 offen lds
    s_waitcnt vmcnt(3)
    s_add_u32 s59, s59, 1
    s_cmp_lt_u32 s59, 4
    s_cbranch_scc1 L_A_f1
    v_mov_b32 v3, 1
    s_mov_b64 exec, 1
    ds_add_u32 v0, v3 offset:5044
    s_mov_b64 exec, -1
    s_waitcnt vmcnt(0)
    v_mov_b32 v3, 1
    s_mov_b64 exec, 1
    ds_add_u32 v0, v3 offset:5040
    s_mov_b64 exec, -1
L_w43:
    s_sleep 1
    ds_read_b32 v3, v0 offset:5040
    s_sub_u32 s3, s3, 1
    s_cbranch_scc1 L_end
    s_waitcnt lgkmcnt(0)
    v_cmp_gt_u32 vcc, 4, v3
    s_cbranch_vccnz L_w43
    ds_read_b64_tr_b16 v[104:105], v2 offset:0
    ds_read_b64_tr_b16 v[106:107], v2 offset:512
    ds_read_b64_tr_b16 v[108:109], v2 offset:4096
L_pad_b_5:
    s_cbranch_execz L_pad_b_6
    ds_read_b64_tr_b16 v[110:111], v2 offset:4608
    ds_read_b64_tr_b16 v[112:113], v2 offset:8192
    ds_read_b64_tr_b16 v[114:115], v2 offset:8704
    ds_read_b64_tr_b16 v[116:117], v2 offset:12288
    ds_read_b64_tr_b16 v[118:119], v2 offset:12800
    s_waitcnt lgkmcnt(4)
    s_nop 0
    ds_read_b64_tr_b16 v[120:121], v2 offset:16384
    ds_read_b64_tr_b16 v[122:123], v2 offset:16896
    ds_read_b64_tr_b16 v[124:125], v2 offset:20480
    ds_read_b64_tr_b16 v[126:127], v2 offset:20992
    ds_read_b64_tr_b16 v[128:129], v2 offset:24576
    ds_read_b64_tr_b16 v[130:131], v2 offset:25088
    ds_read_b64_tr_b16 v[132:133], v2 offset:28672
    ds_read_b64_tr_b16 v[134:135], v2 offset:29184
    s_waitcnt lgkmcnt(4)
    s_nop 0
    ds_read_b64_tr_b16 v[136:137], v2 offset:32768
    ds_read_b64_tr_b16 v[138:139], v2 offset:33280
    ds_read_b64_tr_b16 v[140:141], v2 offset:36864
    ds_read_b64_tr_b16 v[142:143], v2 offset:37376
    ds_read_b64_tr_b16 v[144:145], v2 offset:40960
    ds_read_b64_tr_b16 v[146:147], v2 offset:41472
    ds_read_b64_tr_b16 v[148:149], v2 offset:45056
    ds_read_b64_tr_b16 v[150:151], v2 offset:45568
    s_waitcnt lgkmcnt(4)
    s_nop 0
    ds_read_b64_tr_b16 v[152:153], v2 offset:49152
    ds_read_b64_tr_b16 v[154:155], v2 offset:49664
    ds_read_b64_tr_b16 v[156:157], v2 offset:53248
    ds_read_b64_tr_b16 v[158:159], v2 offset:53760
    ds_read_b64_tr_b16 v[160:161], v2 offset:57344
    ds_read_b64_tr_b16 v[162:163], v2 offset:57856
    ds_read_b64_tr_b16 v[164:165], v2 offset:61440
    ds_read_b64_tr_b16 v[166:167], v2 offset:61952
    s_waitcnt lgkmcnt(4)
L_w44:
    s_sleep 1
    ds_read_b32 v3, v0 offset:5048
    s_sub_u32 s3, s3, 1
    s_cbranch_scc1 L_end
    s_waitcnt lgkmcnt(0)
    v_cmp_gt_u32_e64 vcc, 4, v3
    s_cbranch_vccnz L_w44
    ds_read_b128 v[40:43], v4 offset:0
    ds_read_b128 v[44:47], v4 offset:64
    ds_read_b128 v[48:51], v4 offset:128
    ds_read_b128 v[52:55], v4 offset:192
    ds_read_b128 v[56:59], v4 offset:256
    ds_read_b128 v[60:63], v4 offset:320
    ds_read_b128 v[64:67], v4 offset:384
    ds_read_b128 v[68:71], v4 offset:448
    ds_read_b128 v[72:75], v4 offset:512
    ds_read_b128 v[76:79], v4 offset:576
    ds_read_b128 v[80:83], v4 offset:640
    ds_read_b128 v[84:87], v4 offset:704
    s_waitcnt lgkmcnt(11)
    v_mfma_f32_16x16x32_bf16 v[8:11], v[104:107], v[40:43], 0
    ds_read_b128 v[88:91], v4 offset:768
    s_waitcnt lgkmcnt(11)
    v_mfma_f32_16x16x32_bf16 v[12:15], v[108:111], v[44:47], 0
    ds_read_b128 v[92:95], v4 offset:832
    s_waitcnt lgkmcnt(11)
    v_mfma_f32_16x16x32_bf16 v[8:11], v[112:115], v[48:51], v[8:11]
    ds_read_b128 v[96:99], v4 offset:896
    s_waitcnt lgkmcnt(11)
    v_mfma_f32_16x16x32_bf16 v[12:15], v[116:119], v[52:55], v[12:15]
    ds_read_b128 v[100:103], v4 offset:960
    s_waitcnt lgkmcnt(11)
    v_mfma_f32_16x16x32_bf16 v[8:11], v[120:123], v[56:59], v[8:11]
    s_waitcnt lgkmcnt(10)
    v_mfma_f32_16x16x32_bf16 v[12:15], v[124:127], v[60:63], v[12:15]
    s_waitcnt lgkmcnt(9)
    v_mfma_f32_16x16x32_bf16 v[8:11], v[128:131], v[64:67], v[8:11]
    s_waitcnt lgkmcnt(8)
    v_mfma_f32_16x16x32_bf16 v[12:15], v[132:135], v[68:71], v[12:15]
    s_waitcnt lgkmcnt(7)
    v_mfma_f32_16x16x32_bf16 v[8:11], v[136:139], v[72:75], v[8:11]
    s_waitcnt lgkmcnt(6)
    v_mfma_f32_16x16x32_bf16 v[12:15], v[140:143], v[76:79], v[12:15]
    s_waitcnt lgkmcnt(5)
    v_mfma_f32_16x16x32_bf16 v[8:11], v[144:147], v[80:83], v[8:11]
    s_waitcnt lgkmcnt(4)
    v_mfma_f32_16x16x32_bf16 v[12:15], v[148:151], v[84:87], v[12:15]
    s_waitcnt lgkmcnt(3)
    v_mfma_f32_16x16x32_bf16 v[8:11], v[152:155], v[88:91], v[8:11]
    s_waitcnt lgkmcnt(2)
    v_mfma_f32_16x16x32_bf16 v[12:15], v[156:159], v[92:95], v[12:15]
    s_waitcnt lgkmcnt(1)
    v_mfma_f32_16x16x32_bf16 v[8:11], v[160:163], v[96:99], v[8:11]
    s_waitcnt lgkmcnt(0)
    v_mfma_f32_16x16x32_bf16 v[12:15], v[164:167], v[100:103], v[12:15]
    s_nop 7
    v_pk_add_f32 v[8:9], v[8:9], v[12:13]
    v_pk_add_f32 v[10:11], v[10:11], v[14:15]
    s_nop 0
    v_add_f32_dpp v8, v8, v8 quad_perm:[1,0,3,2] row_mask:0xf bank_mask:0xf
    v_add_f32_dpp v9, v9, v9 quad_perm:[1,0,3,2] row_mask:0xf bank_mask:0xf
    v_add_f32_dpp v10, v10, v10 quad_perm:[1,0,3,2] row_mask:0xf bank_mask:0xf
    v_add_f32_dpp v11, v11, v11 quad_perm:[1,0,3,2] row_mask:0xf bank_mask:0xf
    v_mov_b32_dpp v16, v8 quad_perm:[0,0,0,0] row_mask:0xf bank_mask:0xf
    v_mov_b32_dpp v20, v8 quad_perm:[2,2,2,2] row_mask:0xf bank_mask:0xf
    v_mov_b32_dpp v17, v9 quad_perm:[0,0,0,0] row_mask:0xf bank_mask:0xf
    v_mov_b32_dpp v21, v9 quad_perm:[2,2,2,2] row_mask:0xf bank_mask:0xf
    v_mov_b32_dpp v18, v10 quad_perm:[0,0,0,0] row_mask:0xf bank_mask:0xf
    v_mov_b32_dpp v22, v10 quad_perm:[2,2,2,2] row_mask:0xf bank_mask:0xf
    v_mov_b32_dpp v19, v11 quad_perm:[0,0,0,0] row_mask:0xf bank_mask:0xf
    v_mov_b32_dpp v23, v11 quad_perm:[2,2,2,2] row_mask:0xf bank_mask:0xf
    s_mov_b32 s38, 0x3b000000
    s_setprio 2
L_w45:
    s_sleep 1
    ds_read_b32 v3, v0 offset:5052
    s_sub_u32 s3, s3, 1
    s_cbranch_scc1 L_end
    s_waitcnt lgkmcnt(0)
    v_cmp_gt_u32 vcc, 1, v3
    s_cbranch_vccnz L_w45
L_w46:
    ds_read_b32 v3, v0 offset:5052
L_pad_b_6:
    s_cbranch_execz L_pad_b_r
    s_sub_u32 s3, s3, 1
    s_cbranch_scc1 L_end
    s_waitcnt lgkmcnt(0)
    v_cmp_gt_u32_e64 vcc, 4, v3
    s_cbranch_vccnz L_w46
    ds_read_b128 v[40:43], v5 offset:0
    ds_read_b128 v[44:47], v5 offset:64
    ds_read_b128 v[48:51], v5 offset:128
    ds_read_b128 v[52:55], v5 offset:192
    ds_read_b128 v[56:59], v5 offset:256
    ds_read_b128 v[60:63], v5 offset:320
    ds_read_b128 v[64:67], v5 offset:384
    ds_read_b128 v[68:71], v5 offset:448
    ds_read_b128 v[72:75], v5 offset:512
    ds_read_b128 v[76:79], v5 offset:576
    ds_read_b128 v[80:83], v5 offset:640
    ds_read_b128 v[84:87], v5 offset:704
    s_waitcnt lgkmcnt(11)
    v_mfma_f32_16x16x32_bf16 v[8:11], v[104:107], v[40:43], 0
    ds_read_b128 v[88:91], v5 offset:768
    s_waitcnt lgkmcnt(11)
    v_mfma_f32_16x16x32_bf16 v[12:15], v[108:111], v[44:47], 0
    ds_read_b128 v[92:95], v5 offset:832
    s_waitcnt lgkmcnt(11)
    v_mfma_f32_16x16x32_bf16 v[8:11], v[112:115], v[48:51], v[8:11]
    ds_read_b128 v[96:99], v5 offset:896
    s_waitcnt lgkmcnt(11)
    v_mfma_f32_16x16x32_bf16 v[12:15], v[116:119], v[52:55], v[12:15]
    ds_read_b128 v[100:103], v5 offset:960
    s_waitcnt lgkmcnt(11)
    v_mfma_f32_16x16x32_bf16 v[8:11], v[120:123], v[56:59], v[8:11]
    s_waitcnt lgkmcnt(10)
    v_mfma_f32_16x16x32_bf16 v[12:15], v[124:127], v[60:63], v[12:15]
    s_waitcnt lgkmcnt(9)
    v_mfma_f32_16x16x32_bf16 v[8:11], v[128:131], v[64:67], v[8:11]
    s_waitcnt lgkmcnt(8)
    v_mfma_f32_16x16x32_bf16 v[12:15], v[132:135], v[68:71], v[12:15]
    s_waitcnt lgkmcnt(7)
    v_mfma_f32_16x16x32_bf16 v[8:11], v[136:139], v[72:75], v[8:11]
    ds_read_b128 v[24:27], v7
    ds_read_b128 v[28:31], v7 offset:16
    s_waitcnt lgkmcnt(8)
    v_mfma_f32_16x16x32_bf16 v[12:15], v[140:143], v[76:79], v[12:15]
    s_waitcnt lgkmcnt(7)
    v_mfma_f32_16x16x32_bf16 v[8:11], v[144:147], v[80:83], v[8:11]
    s_waitcnt lgkmcnt(0)
    v_mfma_f32_16x16x32_bf16 v[12:15], v[148:151], v[84:87], v[12:15]
    v_max3_u32 v32, v24, v25, v26
    v_max3_u32 v33, v27, v28, v29
    v_mfma_f32_16x16x32_bf16 v[8:11], v[152:155], v[88:91], v[8:11]
    v_max3_u32 v32, v32, v30, v31
    v_max_u32 v32, v32, v33
    v_mfma_f32_16x16x32_bf16 v[12:15], v[156:159], v[92:95], v[12:15]
    v_cmp_eq_u32 vcc, -1, v32
    s_cbranch_vccnz L_B_ln
L_B_ln1:
    v_mfma_f32_16x16x32_bf16 v[8:11], v[160:163], v[96:99], v[8:11]
    v_pk_add_f32 v[24:25], v[24:25], v[26:27]
    v_pk_add_f32 v[28:29], v[28:29], v[30:31]
    v_mfma_f32_16x16x32_bf16 v[12:15], v[164:167], v[100:103], v[12:15]
    v_add_f32 v24, v24, v25
    v_add_f32 v28, v28, v29
    v_mul_f32 v24, s38, v24
    v_mul_f32 v28, s38, v28
    v_fma_f32 v28, -v24, v24, v28
    v_max_f32 v28, 0, v28
    v_add_f32 v28, 0x3727c5ac, v28
    v_rsq_f32 v28, v28
    v_pk_add_f32 v[8:9], v[8:9], v[12:13]
    v_pk_add_f32 v[10:11], v[10:11], v[14:15]
    s_nop 0
    v_add_f32_dpp v8, v8, v8 quad_perm:[1,0,3,2] row_mask:0xf bank_mask:0xf
    v_add_f32_dpp v9, v9, v9 quad_perm:[1,0,3,2] row_mask:0xf bank_mask:0xf
    v_add_f32_dpp v10, v10, v10 quad_perm:[1,0,3,2] row_mask:0xf bank_mask:0xf
    v_add_f32_dpp v11, v11, v11 quad_perm:[1,0,3,2] row_mask:0xf bank_mask:0xf
    v_fma_f32 v8, -v24, v16, v8
    v_fma_f32 v9, -v24, v17, v9
    v_fma_f32 v10, -v24, v18, v10
    v_fma_f32 v11, -v24, v19, v11
    v_fma_f32 v8, v8, v28, v20
    v_fma_f32 v9, v9, v28, v21
    v_fma_f32 v10, v10, v28, v22
    v_fma_f32 v11, v11, v28, v23
    v_max_f32 v8, 0, v8
    v_max_f32 v9, 0, v9
    v_max_f32 v10, 0, v10
    v_max_f32 v11, 0, v11
    v_cvt_pk_bf16_f32 v8, v8, v9
    v_cvt_pk_bf16_f32 v9, v10, v11
    ds_write_b64 v6, v[8:9]
    v_mov_b32_e64 v3, 1
    s_mov_b64 exec, 1
    ds_add_u32 v0, v3 offset:2016
    s_mov_b64 exec, -1
    s_branch L_end
L_B_qv:
    v_lshl_add_u32 v3, v1, 4, s49
    s_mov_b32 s63, 0
    s_waitcnt vmcnt(0) lgkmcnt(0)
    s_mov_b64 exec, s[56:57]
    ds_read_b128 v[8:11], v3 offset:0
    ds_read_b128 v[12:15], v3 offset:1008
    ds_read_b128 v[16:19], v3 offset:2016
    ds_read_b128 v[20:23], v3 offset:3024
    ds_read_b128 v[28:31], v3 offset:4032
    ds_read_b128 v[32:35], v3 offset:5040
    ds_read_b128 v[36:39], v3 offset:6048
    s_mov_b64 exec, -1
    v_max3_u32 v6, v24, v25, v26
    v_max_u32 v6, v6, v27
    v_cmp_eq_u32 vcc, -1, v6
    s_cbranch_vccnz L_B_qf8
L_B_qn8:
    s_mov_b64 exec, s[56:57]
    s_waitcnt lgkmcnt(6)
    v_max3_u32 v6, v8, v9, v10
    v_max_u32 v6, v6, v11
    v_cmp_eq_u32 vcc, -1, v6
    ds_read_b128 v[8:11], v3 offset:7056
    s_cbranch_vccnz L_B_qf0
L_B_qn0:
    s_waitcnt lgkmcnt(6)
    v_max3_u32 v6, v12, v13, v14
    v_max_u32 v6, v6, v15
    v_cmp_eq_u32 vcc, -1, v6
    s_cbranch_vccnz L_B_qf1
L_B_qn1:
    s_waitcnt lgkmcnt(5)
    v_max3_u32 v6, v16, v17, v18
    v_max_u32 v6, v6, v19
    v_cmp_eq_u32 vcc, -1, v6
    s_cbranch_vccnz L_B_qf2
L_B_qn2:
    s_waitcnt lgkmcnt(4)
    v_max3_u32 v6, v20, v21, v22
    v_max_u32 v6, v6, v23
    v_cmp_eq_u32 vcc, -1, v6
    s_cbranch_vccnz L_B_qf3
L_B_qn3:
    s_waitcnt lgkmcnt(3)
    v_max3_u32 v6, v28, v29, v30
    v_max_u32 v6, v6, v31
    v_cmp_eq_u32 vcc, -1, v6
    s_cbranch_vccnz L_B_qf4
L_B_qn4:
    s_waitcnt lgkmcnt(2)
    v_max3_u32 v6, v32, v33, v34
    v_max_u32 v6, v6, v35
    v_cmp_eq_u32 vcc, -1, v6
    s_cbranch_vccnz L_B_qf5
L_B_qn5:
    s_waitcnt lgkmcnt(1)
    v_max3_u32 v6, v36, v37, v38
    v_max_u32 v6, v6, v39
    v_cmp_eq_u32 vcc, -1, v6
    s_cbranch_vccnz L_B_qf6
L_B_qn6:
    s_waitcnt lgkmcnt(0)
    v_max3_u32 v6, v8, v9, v10
    v_max_u32 v6, v6, v11
    v_cmp_eq_u32 vcc, -1, v6
    s_cbranch_vccnz L_B_qf7
L_B_qn7:
    s_mov_b64 exec, -1
    s_cmp_lg_u32 s63, 0
    s_cbranch_scc1 L_B_qv
    s_branch L_B_qok
L_B_qf0:
    s_mov_b32 s63, 1
    s_sub_u32 s3, s3, 1
    s_cbranch_scc1 L_end
    s_add_u32 m0, s49, 0
    s_add_u32 s38, s51, 0
    v_lshlrev_b32 v6, 4, v1
    buffer_load_dwordx4 v6, s[40:43], s38 offen sc1 lds
    s_branch L_B_qn0
L_B_qf1:
    s_mov_b32 s63, 1
    s_sub_u32 s3, s3, 1
    s_cbranch_scc1 L_end
    s_add_u32 m0, s49, 1008
    s_add_u32 s38, s51, 1024
    v_lshlrev_b32 v6, 4, v1
    buffer_load_dwordx4 v6, s[40:43], s38 offen sc1 lds
    s_branch L_B_qn1
L_B_qf2:
    s_mov_b32 s63, 1
    s_sub_u32 s3, s3, 1
    s_cbranch_scc1 L_end
    s_add_u32 m0, s49, 2016
    s_add_u32 s38, s51, 2048
    v_lshlrev_b32 v6, 4, v1
    buffer_load_dwordx4 v6, s[40:43], s38 offen sc1 lds
    s_branch L_B_qn2
L_B_qf3:
    s_mov_b32 s63, 1
    s_sub_u32 s3, s3, 1
    s_cbranch_scc1 L_end
    s_add_u32 m0, s49, 3024
    s_add_u32 s38, s51, 3072
    v_lshlrev_b32 v6, 4, v1
    buffer_load_dwordx4 v6, s[40:43], s38 offen sc1 lds
    s_branch L_B_qn3
L_B_qf4:
    s_mov_b32 s63, 1
    s_sub_u32 s3, s3, 1
    s_cbranch_scc1 L_end
    s_add_u32 m0, s49, 4032
    s_add_u32 s38, s51, 4096
    v_lshlrev_b32 v6, 4, v1
    buffer_load_dwordx4 v6, s[40:43], s38 offen sc1 lds
    s_branch L_B_qn4
L_B_qf5:
    s_mov_b32 s63, 1
    s_sub_u32 s3, s3, 1
    s_cbranch_scc1 L_end
    s_add_u32 m0, s49, 5040
    s_add_u32 s38, s51, 5120
    v_lshlrev_b32 v6, 4, v1
    buffer_load_dwordx4 v6, s[40:43], s38 offen sc1 lds
    s_branch L_B_qn5
L_B_qf6:
    s_mov_b32 s63, 1
    s_sub_u32 s3, s3, 1
    s_cbranch_scc1 L_end
    s_add_u32 m0, s49, 6048
    s_add_u32 s38, s51, 6144
    v_lshlrev_b32 v6, 4, v1
    buffer_load_dwordx4 v6, s[40:43], s38 offen sc1 lds
    s_branch L_B_qn6
L_B_qf7:
    s_mov_b32 s63, 1
    s_sub_u32 s3, s3, 1
    s_cbranch_scc1 L_end
    s_add_u32 m0, s49, 7056
    s_add_u32 s38, s51, 7168
    v_lshlrev_b32 v6, 4, v1
    buffer_load_dwordx4 v6, s[40:43], s38 offen sc1 lds
    s_branch L_B_qn7
L_B_qf8:
    s_mov_b32 s63, 1
    s_sub_u32 s3, s3, 1
    s_cbranch_scc1 L_end
    buffer_load_dwordx4 v[24:27], v7, s[40:43], s50 offen offset:992 sc1
    s_branch L_B_qn8
L_B_my0:
    ds_read_b128 v[160:163], v5 offset:7072
    s_sub_u32 s3, s3, 1
    s_cbranch_scc1 L_end
    s_waitcnt lgkmcnt(0)
    s_branch L_B_mx0
L_B_my1:
    ds_read_b128 v[160:163], v5 offset:0
    s_sub_u32 s3, s3, 1
    s_cbranch_scc1 L_end
    s_waitcnt lgkmcnt(0)
    s_branch L_B_mx1
L_B_ln:
    ds_read_b128 v[24:27], v7
    ds_read_b128 v[28:31], v7 offset:16
    s_sub_u32 s3, s3, 1
    s_cbranch_scc1 L_end
    s_waitcnt lgkmcnt(0)
    v_max3_u32 v32, v24, v25, v26
    v_max3_u32 v32, v32, v27, v28
    v_max3_u32 v32, v32, v29, v30
    v_max_u32 v32, v32, v31
    v_cmp_eq_u32 vcc, -1, v32
    s_cbranch_vccnz L_B_ln
    s_branch L_B_ln1
L_Cs:
    s_setprio 2

    v_lshrrev_b32 v3, 4, v1
    v_and_b32 v5, 15, v1
    v_lshlrev_b32 v2, 10, v3
    v_lshl_add_u32 v2, v5, 4, v2
    s_lshl_b32 s38, s33, 8
    v_add_u32 v2, s38, v2
    v_add_u32 v4, 0x1000, v2
    s_waitcnt lgkmcnt(0)
    global_load_dwordx4 v[24:27], v2, s[4:5]
    global_load_dwordx4 v[28:31], v4, s[4:5]
    global_load_dwordx4 v[8:11], v2, s[22:23]
    global_load_dwordx4 v[12:15], v4, s[22:23]
    s_barrier

    s_mov_b32 s3, 0x400000
    v_mov_b32 v0, 156256
    s_and_b32 s62, s34, 3
    s_lshl2_add_u32 s97, s62, s37
    s_lshl4_add_u32 s61, s36, s97
    s_waitcnt lgkmcnt(0)

    s_mov_b32 s40, s30
    s_mov_b32 s41, s31
    s_mov_b32 s42, 16777216
    s_mov_b32 s43, 0x20000
    s_lshl2_add_u32 s55, s36, s37
    v_mov_b32 v32, 0x3f803f80
    v_mov_b32 v33, v32
    v_mov_b32 v34, v32
    v_mov_b32 v35, v32
    v_mov_b32 v36, v32
    v_mov_b32 v37, v32
    v_mov_b32 v38, v32
    v_mov_b32 v39, v32
    v_mov_b32 v40, v32
    v_mov_b32 v41, v32
    v_mov_b32 v42, v32
    v_mov_b32 v43, v32
    v_mov_b32 v44, v32
    v_mov_b32 v45, v32
    v_mov_b32 v46, v32
    v_mov_b32 v47, v32

    s_mov_b32 s56, 0x00ff00ff
    s_mov_b32 s57, 0x00ff00ff
    s_mul_i32 s38, s33, 2176
    v_mul_u32_u24 v6, 272, v3
    v_lshl_add_u32 v6, v5, 4, v6
    v_add_u32 v6, s38, v6
    v_and_b32 v92, 7, v1
    v_mul_u32_u24 v95, 272, v92
    v_lshl_add_u32 v7, v3, 4, v95
    v_add_u32 v7, s38, v7
    v_lshl_add_u32 v95, v3, 3, v95
    s_lshr_b32 s38, s55, 3
    s_mul_i32 s38, s38, 2176
    s_and_b32 s39, s55, 7
    s_lshl_b32 s39, s39, 5
    s_add_u32 s38, s38, s39
    v_add_u32 v95, s38, v95
    s_lshl_b32 s59, s33, 13
    s_add_u32 s59, s59, 65536
    v_bfe_u32 v2, v1, 2, 2
    v_lshl_add_u32 v2, v3, 3, v2
    v_lshlrev_b32 v2, 6, v2
    v_and_b32 v4, 1, v3
    v_lshl_add_u32 v2, v4, 5, v2
    v_and_b32 v4, 3, v1
    v_lshl_add_u32 v2, v4, 3, v2
    v_add_u32 v2, s59, v2
    v_xor_b32 v3, 32, v2
    s_mul_i32 s38, s33, 3072
    s_add_u32 s38, s38, 49152
    v_lshl_add_u32 v4, v1, 4, s38
    s_lshl_b32 s38, s33, 2
    v_add_u32 v5, s38, v0
    s_mov_b32 s38, 0xbfb8aa3b
    s_waitcnt vmcnt(2)
    ds_write_b128 v6, v[24:27] offset:16384
    ds_write_b128 v6, v[28:31] offset:17472
    s_mov_b64 exec, s[56:57]
    ds_read_b128 v[32:35], v7 offset:16384
    ds_read_b128 v[36:39], v7 offset:16448
    ds_read_b128 v[40:43], v7 offset:16512
    ds_read_b128 v[44:47], v7 offset:16576
    s_mov_b64 exec, -1
    s_waitcnt vmcnt(0)
    v_lshlrev_b32 v48, 16, v8
    v_and_b32 v49, 0xffff0000, v8
    v_mul_f32 v50, s38, v48
    v_mul_f32 v51, s38, v49
    v_exp_f32 v50, v50
    v_exp_f32 v51, v51
    v_add_f32 v50, 1.0, v50
    v_add_f32 v51, 1.0, v51
    v_rcp_f32 v50, v50
    v_rcp_f32 v51, v51
    v_mul_f32 v48, v48, v50
    v_mul_f32 v49, v49, v51
    v_cvt_pk_bf16_f32 v8, v48, v49
    s_waitcnt lgkmcnt(0)
    v_mfma_f32_16x16x32_bf16 v[88:91], v[32:35], v[32:35], 0
    v_mfma_f32_16x16x32_bf16 v[88:91], v[36:39], v[36:39], v[88:91]
    v_mfma_f32_16x16x32_bf16 v[88:91], v[40:43], v[40:43], v[88:91]
    v_mfma_f32_16x16x32_bf16 v[88:91], v[44:47], v[44:47], v[88:91]
    v_lshlrev_b32 v48, 16, v9
    v_and_b32 v49, 0xffff0000, v9
    v_mul_f32 v50, s38, v48
    v_mul_f32 v51, s38, v49
    v_exp_f32 v50, v50
    v_exp_f32 v51, v51
    v_add_f32 v50, 1.0, v50
    v_add_f32 v51, 1.0, v51
    v_rcp_f32 v50, v50
    v_rcp_f32 v51, v51
    v_mul_f32 v48, v48, v50
    v_mul_f32 v49, v49, v51
    v_cvt_pk_bf16_f32 v9, v48, v49
    ds_write_b128 v4, v[88:91] offset:2048
    v_mov_b32 v52, 1
    s_mov_b64 exec, 1
    ds_add_u32 v0, v52 offset:12
    s_mov_b64 exec, -1
    v_lshlrev_b32 v48, 16, v10
    v_and_b32 v49, 0xffff0000, v10
    v_mul_f32 v50, s38, v48
    v_mul_f32 v51, s38, v49
    v_exp_f32 v50, v50
    v_exp_f32 v51, v51
    v_add_f32 v50, 1.0, v50
    v_add_f32 v51, 1.0, v51
    v_rcp_f32 v50, v50
    v_rcp_f32 v51, v51
    v_mul_f32 v48, v48, v50
    v_mul_f32 v49, v49, v51
    v_cvt_pk_bf16_f32 v10, v48, v49
    v_lshlrev_b32 v48, 16, v11
    v_and_b32 v49, 0xffff0000, v11
    v_mul_f32 v50, s38, v48
    v_mul_f32 v51, s38, v49
    v_exp_f32 v50, v50
    v_exp_f32 v51, v51
    v_add_f32 v50, 1.0, v50
    v_add_f32 v51, 1.0, v51
    v_rcp_f32 v50, v50
    v_rcp_f32 v51, v51
    v_mul_f32 v48, v48, v50
    v_mul_f32 v49, v49, v51
    v_cvt_pk_bf16_f32 v11, v48, v49
    v_lshlrev_b32 v48, 16, v12
    v_and_b32 v49, 0xffff0000, v12
    v_mul_f32 v50, s38, v48
    v_mul_f32 v51, s38, v49
    v_exp_f32 v50, v50
    v_exp_f32 v51, v51
    v_add_f32 v50, 1.0, v50
    v_add_f32 v51, 1.0, v51
    v_rcp_f32 v50, v50
    v_rcp_f32 v51, v51
    v_mul_f32 v48, v48, v50
    v_mul_f32 v49, v49, v51
    v_cvt_pk_bf16_f32 v12, v48, v49
    v_lshlrev_b32 v48, 16, v13
    v_and_b32 v49, 0xffff0000, v13
    v_mul_f32 v50, s38, v48
    v_mul_f32 v51, s38, v49
    v_exp_f32 v50, v50
    v_exp_f32 v51, v51
    v_add_f32 v50, 1.0, v50
    v_add_f32 v51, 1.0, v51
    v_rcp_f32 v50, v50
    v_rcp_f32 v51, v51
    v_mul_f32 v48, v48, v50
    v_mul_f32 v49, v49, v51
    v_cvt_pk_bf16_f32 v13, v48, v49
    v_lshlrev_b32 v48, 16, v14
    v_and_b32 v49, 0xffff0000, v14
    v_mul_f32 v50, s38, v48
    v_mul_f32 v51, s38, v49
    v_exp_f32 v50, v50
    v_exp_f32 v51, v51
    v_add_f32 v50, 1.0, v50
    v_add_f32 v51, 1.0, v51
    v_rcp_f32 v50, v50
    v_rcp_f32 v51, v51
    v_mul_f32 v48, v48, v50
    v_mul_f32 v49, v49, v51
    v_cvt_pk_bf16_f32 v14, v48, v49
    v_lshlrev_b32 v48, 16, v15
    v_and_b32 v49, 0xffff0000, v15
    v_mul_f32 v50, s38, v48
    v_mul_f32 v51, s38, v49
    v_exp_f32 v50, v50
    v_exp_f32 v51, v51
    v_add_f32 v50, 1.0, v50
    v_add_f32 v51, 1.0, v51
    v_rcp_f32 v50, v50
    v_rcp_f32 v51, v51
    v_mul_f32 v48, v48, v50
    v_mul_f32 v49, v49, v51
    v_cvt_pk_bf16_f32 v15, v48, v49
    ds_write_b128 v6, v[8:11] offset:32768
    ds_write_b128 v6, v[12:15] offset:33856
    ds_read_b128 v[8:11], v7 offset:32768
    ds_read_b128 v[12:15], v7 offset:32832
    ds_read_b128 v[16:19], v7 offset:32896
    ds_read_b128 v[20:23], v7 offset:32960
    s_cmp_lg_u32 s33, 0
    s_cbranch_scc1 L_C_nln
    v_lshrrev_b32 v93, 2, v92
    v_lshl_add_u32 v93, v93, 4, v92
    v_lshlrev_b32 v93, 4, v93
    v_and_b32 v94, 3, v1
    v_lshl_add_u32 v93, v94, 2, v93
    v_add_u32 v93, 51200, v93
    v_lshlrev_b32 v92, 4, v92
    v_add_u32 v94, 51712, v92
    v_lshrrev_b32 v96, 5, v1
    v_lshl_add_u32 v92, v96, 7, v92
    v_bfe_u32 v96, v1, 4, 1
    v_lshl_add_u32 v92, v96, 3, v92
    s_lshl_b32 s39, s55, 8
L_w47:
    ds_read_b32 v40, v0 offset:12
    s_sub_u32 s3, s3, 1
    s_cbranch_scc1 L_end
    s_waitcnt lgkmcnt(0)
    v_cmp_gt_u32_e64 vcc, 4, v40
    s_cbranch_vccnz L_w47
    ds_read_b32 v24, v94 offset:0
    ds_read_b32 v28, v93 offset:0
    ds_read_b32 v25, v94 offset:3072
    ds_read_b32 v29, v93 offset:3072
    ds_read_b32 v26, v94 offset:6144
    ds_read_b32 v30, v93 offset:6144
    ds_read_b32 v27, v94 offset:9216
    ds_read_b32 v31, v93 offset:9216
    ds_read_b64 v[6:7], v95 offset:16384
    s_mov_b32 s38, 0x3b000000
    s_waitcnt lgkmcnt(0)
    v_lshlrev_b32 v96, 16, v6
    v_and_b32 v97, 0xffff0000, v6
    v_lshlrev_b32 v98, 16, v7
    v_and_b32 v99, 0xffff0000, v7
    v_add_f32 v24, v24, v25
    v_add_f32 v28, v28, v29
    v_add_f32 v26, v26, v27
    v_add_f32 v30, v30, v31
    v_add_f32 v24, v24, v26
    v_add_f32 v28, v28, v30
    v_mul_f32 v24, s38, v24
    v_mul_f32 v28, s38, v28
    v_fma_f32 v28, -v24, v24, v28
    v_max_f32 v28, 0, v28
    v_add_f32 v28, 0x3727c5ac, v28
    v_rsq_f32 v28, v28
    v_sub_f32 v96, v96, v24
    v_sub_f32 v97, v97, v24
    v_sub_f32 v98, v98, v24
    v_sub_f32 v99, v99, v24
    v_mul_f32 v96, v96, v28
    v_mul_f32 v97, v97, v28
    v_mul_f32 v98, v98, v28
    v_mul_f32 v99, v99, v28
L_C_nln:
L_w48:
    ds_read_b32 v40, v5 offset:4032
    s_sub_u32 s3, s3, 1
    s_cbranch_scc1 L_end
    s_waitcnt lgkmcnt(0)
    v_cmp_gt_u32 vcc, 1, v40
    s_cbranch_vccnz L_w48
    ds_read_b64_tr_b16 v[48:49], v2 offset:0
    ds_read_b64_tr_b16 v[50:51], v2 offset:256
    ds_read_b64_tr_b16 v[52:53], v3 offset:0
    ds_read_b64_tr_b16 v[54:55], v3 offset:256
    ds_read_b64_tr_b16 v[56:57], v2 offset:2048
    ds_read_b64_tr_b16 v[58:59], v2 offset:2304
    ds_read_b64_tr_b16 v[60:61], v3 offset:2048
    ds_read_b64_tr_b16 v[62:63], v3 offset:2304
    s_waitcnt lgkmcnt(4)
    v_mfma_f32_16x16x32_bf16 v[80:83], v[48:51], v[8:11], 0
    v_mfma_f32_16x16x32_bf16 v[84:87], v[52:55], v[8:11], 0
    s_waitcnt lgkmcnt(0)
    v_mfma_f32_16x16x32_bf16 v[80:83], v[56:59], v[12:15], v[80:83]
    v_mfma_f32_16x16x32_bf16 v[84:87], v[60:63], v[12:15], v[84:87]
L_w49:
    ds_read_b32 v40, v5 offset:4032
    s_sub_u32 s3, s3, 1
    s_cbranch_scc1 L_end
    s_waitcnt lgkmcnt(0)
    v_cmp_gt_u32_e64 vcc, 2, v40
    s_cbranch_vccnz L_w49
    ds_read_b64_tr_b16 v[64:65], v2 offset:4096
    ds_read_b64_tr_b16 v[66:67], v2 offset:4352
    ds_read_b64_tr_b16 v[68:69], v3 offset:4096
    ds_read_b64_tr_b16 v[70:71], v3 offset:4352
    ds_read_b64_tr_b16 v[72:73], v2 offset:6144
    ds_read_b64_tr_b16 v[74:75], v2 offset:6400
    ds_read_b64_tr_b16 v[76:77], v3 offset:6144
    ds_read_b64_tr_b16 v[78:79], v3 offset:6400
    s_waitcnt lgkmcnt(4)
    v_mfma_f32_16x16x32_bf16 v[80:83], v[64:67], v[16:19], v[80:83]
    v_mfma_f32_16x16x32_bf16 v[84:87], v[68:71], v[16:19], v[84:87]
    s_waitcnt lgkmcnt(0)
    v_mfma_f32_16x16x32_bf16 v[80:83], v[72:75], v[20:23], v[80:83]
    v_mfma_f32_16x16x32_bf16 v[84:87], v[76:79], v[20:23], v[84:87]
    s_cmp_eq_u32 s33, 0
    s_cbranch_scc1 L_C_red
    s_nop 4
    ds_write_b128 v4, v[80:83] offset:0
    ds_write_b128 v4, v[84:87] offset:1024
    v_mov_b32 v5, 1
    s_mov_b64 exec, 1
    ds_add_u32 v0, v5 offset:8
    s_mov_b64 exec, -1
    s_branch L_C_o
L_C_red:
L_w50:
    ds_read_b32 v5, v0 offset:8
    s_sub_u32 s3, s3, 1
    s_cbranch_scc1 L_end
    s_waitcnt lgkmcnt(0)
    v_cmp_gt_u32 vcc, 3, v5
    s_cbranch_vccnz L_w50
    ds_read_b128 v[48:51], v4 offset:3072
    ds_read_b128 v[52:55], v4 offset:4096
    ds_read_b128 v[56:59], v4 offset:6144
    ds_read_b128 v[60:63], v4 offset:7168
    ds_read_b128 v[64:67], v4 offset:9216
    ds_read_b128 v[68:71], v4 offset:10240
    ds_read_b32 v5, v0 offset:2020
    v_add_f32 v80, v80, v96
    v_add_f32 v81, v81, v97
    v_add_f32 v82, v82, v98
    v_add_f32_e64 v83, v83, v99
    s_waitcnt lgkmcnt(0)
    v_pk_add_f32 v[80:81], v[80:81], v[48:49]
    v_pk_add_f32 v[56:57], v[56:57], v[64:65]
    v_pk_add_f32 v[82:83], v[82:83], v[50:51]
    v_pk_add_f32 v[58:59], v[58:59], v[66:67]
    v_pk_add_f32 v[84:85], v[84:85], v[52:53]
    v_pk_add_f32 v[60:61], v[60:61], v[68:69]
    v_pk_add_f32 v[86:87], v[86:87], v[54:55]
    v_pk_add_f32 v[62:63], v[62:63], v[70:71]
    v_pk_add_f32 v[80:81], v[80:81], v[56:57]
    v_pk_add_f32 v[82:83], v[82:83], v[58:59]
    v_pk_add_f32 v[84:85], v[84:85], v[60:61]
    v_pk_add_f32 v[86:87], v[86:87], v[62:63]
    v_cmp_gt_u32 vcc, 5, v5
    v_fmac_f32 v80, v84, v96
    v_fmac_f32 v81, v85, v97
    v_fmac_f32 v82, v86, v98
    v_fmac_f32 v83, v87, v99
    v_cvt_pk_bf16_f32 v80, v80, v81
    v_cvt_pk_bf16_f32 v81, v82, v83
    s_cbranch_vccz L_C_pub
L_w51:
    ds_read_b32 v5, v0 offset:2020
    s_sub_u32 s3, s3, 1
    s_cbranch_scc1 L_end
    s_waitcnt lgkmcnt(0)
    v_cmp_gt_u32 vcc, 5, v5
    s_cbranch_vccnz L_w51
L_C_pub:
    s_mov_b64 exec, s[56:57]

    buffer_store_dwordx2 v[80:81], v92, s[40:43], s39 offen sc1
    s_mov_b64 exec, -1
    v_mov_b32 v5, 4
    ds_write_b32 v0, v5 offset:5044
    ds_write_b32 v0, v5 offset:4
    s_branch L_C_o
L_Co:
    s_waitcnt lgkmcnt(0)

    s_mov_b32 s3, 0x400000
    v_mov_b32 v0, 156256
    s_and_b32 s62, s34, 3
    s_lshl2_add_u32 s97, s62, s37
    s_lshl4_add_u32 s61, s36, s97
    s_waitcnt lgkmcnt(0)

    s_mov_b32 s40, s30
    s_mov_b32 s41, s31
    s_mov_b32 s42, 16777216
    s_mov_b32 s43, 0x20000
    s_barrier
    s_cmp_lt_u32 s34, 4
    s_cbranch_scc1 L_C_nt
    s_cmp_lg_u32 s33, 0
    s_cbranch_scc1 L_C_nt
    v_lshrrev_b32 v2, 1, v1
    v_and_b32 v3, 1, v1
    s_lshl2_add_u32 s38, s33, s34
    s_sub_u32 s38, s38, 4
    v_lshl_add_u32 v2, v2, 6, v3
    s_lshl_b32 s38, s38, 10
    s_add_u32 s38, s38, s35
    s_lshl_b32 s38, s38, 8
    v_lshl_add_u32 v2, v2, 7, s38
    s_mov_b32 exec_hi, 0
    global_load_dword v166, v2, s[10:11]
    s_not_b64 exec, exec
    s_waitcnt vmcnt(0)
    global_load_dword v166, v2, s[10:11]
    s_mov_b64 exec, -1
    v_mov_b32 v3, 1
    s_mov_b64 exec, 1
    ds_add_u32 v0, v3 offset:4
    s_mov_b64 exec, -1
L_C_nt:
    s_cmp_ge_u32 s34, 4
    s_cbranch_scc1 L_C_at
    s_mul_i32 s63, s34, 3
    s_add_u32 s63, s63, s33
    s_sub_u32 s63, s63, 3
    s_cmp_eq_u32 s33, 3
    s_cbranch_scc1 L_C_qh
    s_cmp_eq_u32 s63, 8
    s_cbranch_scc1 L_C_qs
    s_mov_b32 s44, s10
    s_mov_b32 s45, s11
    s_mov_b32 s46, 4194304
    s_mov_b32 s47, 0x20000

    v_lshrrev_b32 v3, 4, v1
    v_and_b32 v2, 15, v1
    v_xor_b32 v4, v2, v3
    v_lshlrev_b32 v4, 4, v4
    v_lshl_add_u32 v4, v3, 13, v4
    v_xor_b32 v5, 64, v4
    v_xor_b32 v6, 0x80, v4
    v_xor_b32 v7, 0xc0, v4
    s_lshl_b32 s48, s63, 19
    s_lshl_b32 s38, s35, 8
    s_add_u32 s48, s48, s38
    s_lshl_b32 s51, s33, 14
    s_add_u32 s51, s51, 65536
    v_lshlrev_b32 v12, 4, v1
    v_mov_b32 v8, -1
    v_mov_b32 v9, -1
    v_mov_b32 v10, -1
    v_mov_b32 v11, -1
    s_lshl3_add_u32 s38, s35, s63
    s_lshl_b32 s38, s38, 12
    s_add_u32 s52, s38, 1048576
    s_lshr_b32 s53, s38, 4
    s_add_u32 s53, s53, 983040
L_w52:
    s_sleep 1
    ds_read_b32 v13, v0 offset:0
    s_sub_u32 s3, s3, 1
    s_cbranch_scc1 L_end
    s_waitcnt lgkmcnt(0)
    v_cmp_gt_u32_e64 vcc, 4, v13
    s_cbranch_vccnz L_w52
    s_add_u32 m0, s51, 0
    s_add_u32 s38, s48, 0
    buffer_load_dwordx4 v4, s[44:47], s38 offen nt lds
    s_add_u32 m0, s51, 1024
    s_add_u32 s38, s48, 131072
    buffer_load_dwordx4 v5, s[44:47], s38 offen nt lds
    s_add_u32 m0, s51, 2048
    s_add_u32 s38, s48, 262144
    buffer_load_dwordx4 v6, s[44:47], s38 offen nt lds
    s_add_u32 m0, s51, 3072
    s_add_u32 s38, s48, 393216
    buffer_load_dwordx4 v7, s[44:47], s38 offen nt lds
    s_add_u32 m0, s51, 4096
    s_add_u32 s38, s48, 32768
    buffer_load_dwordx4 v4, s[44:47], s38 offen nt lds
    s_add_u32 m0, s51, 5120
    s_add_u32 s38, s48, 163840
    buffer_load_dwordx4 v5, s[44:47], s38 offen nt lds
    s_add_u32 m0, s51, 6144
    s_add_u32 s38, s48, 294912
    buffer_load_dwordx4 v6, s[44:47], s38 offen nt lds
    s_add_u32 m0, s51, 7168
    s_add_u32 s38, s48, 425984
    buffer_load_dwordx4 v7, s[44:47], s38 offen nt lds
    s_add_u32 m0, s51, 8192
    s_add_u32 s38, s48, 65536
    buffer_load_dwordx4 v4, s[44:47], s38 offen nt lds
    s_add_u32 m0, s51, 9216
    s_add_u32 s38, s48, 196608
    buffer_load_dwordx4 v5, s[44:47], s38 offen nt lds
    s_add_u32 m0, s51, 10240
    s_add_u32 s38, s48, 327680
    buffer_load_dwordx4 v6, s[44:47], s38 offen nt lds
    s_add_u32 m0, s51, 11264
    s_add_u32 s38, s48, 458752
    buffer_load_dwordx4 v7, s[44:47], s38 offen nt lds
    s_add_u32 m0, s51, 12288
    s_add_u32 s38, s48, 98304
    buffer_load_dwordx4 v4, s[44:47], s38 offen nt lds
    s_add_u32 m0, s51, 13312
    s_add_u32 s38, s48, 229376
    buffer_load_dwordx4 v5, s[44:47], s38 offen nt lds
    s_add_u32 m0, s51, 14336
    s_add_u32 s38, s48, 360448
    buffer_load_dwordx4 v6, s[44:47], s38 offen nt lds
    s_add_u32 m0, s51, 15360
    s_add_u32 s38, s48, 491520
    buffer_load_dwordx4 v7, s[44:47], s38 offen nt lds
    v_mov_b32 v13, 1
    s_mov_b64 exec, 1
    ds_add_u32 v0, v13 offset:7068
    s_mov_b64 exec, -1

    v_lshlrev_b32 v4, 2, v3
    v_xor_b32 v4, v4, v2
    v_lshlrev_b32 v4, 4, v4
    v_lshl_add_u32 v4, v2, 8, v4
    v_add_u32 v4, s51, v4
    v_xor_b32 v5, 16, v4
    v_xor_b32 v6, 32, v4
    v_xor_b32 v7, 48, v4
    v_add_u32 v12, 131072, v12
    v_and_b32 v13, 1, v1
    v_lshlrev_b32 v14, 4, v13
    v_lshl_add_u32 v15, v3, 5, v14
    v_lshrrev_b32 v2, 1, v2
    v_lshl_add_u32 v15, v2, 15, v15
    s_mov_b32 s38, 0xffff
    v_lshlrev_b32 v14, v14, s38
    v_cmp_eq_u32 s[56:57], 1, v13
    s_lshl_b32 s49, s35, 10
    s_lshl_b32 s38, s63, 7
    s_add_u32 s49, s49, s38
    s_add_u32 s49, s49, 65536
    s_waitcnt vmcnt(0)
    ds_read_b128 v[104:107], v4 offset:0
    ds_read_b128 v[108:111], v5 offset:0
    ds_read_b128 v[112:115], v6 offset:0
    ds_read_b128 v[116:119], v7 offset:0
    s_waitcnt lgkmcnt(0)
    ds_read_b128 v[120:123], v4 offset:4096
    ds_read_b128 v[124:127], v5 offset:4096
    ds_read_b128 v[128:131], v6 offset:4096
    ds_read_b128 v[132:135], v7 offset:4096
    s_waitcnt lgkmcnt(0)
    ds_read_b128 v[136:139], v4 offset:8192
    ds_read_b128 v[140:143], v5 offset:8192
    ds_read_b128 v[144:147], v6 offset:8192
    ds_read_b128 v[148:151], v7 offset:8192
    s_waitcnt lgkmcnt(0)
    ds_read_b128 v[152:155], v4 offset:12288
    ds_read_b128 v[156:159], v5 offset:12288
    ds_read_b128 v[160:163], v6 offset:12288
    ds_read_b128 v[164:167], v7 offset:12288
    s_waitcnt lgkmcnt(0)
    s_setprio 2
    v_mov_b32 v5, 1
    s_mov_b64 exec, 1
    ds_add_u32 v0, v5 offset:3028
    s_mov_b64 exec, -1
L_w53:
    ds_read_b32 v5, v0 offset:4
    s_sub_u32 s3, s3, 1
    s_cbranch_scc1 L_end
    s_waitcnt lgkmcnt(0)
    v_cmp_gt_u32 vcc, 4, v5
    s_cbranch_vccnz L_w53
    s_xor_b32 s38, s2, 8
    s_or_b32 s38, s38, s33
    s_cbranch_scc1 L_C_f2
    v_mov_b32 v5, 0
    s_mov_b64 exec, 1
    global_store_dword v5, v8, s[28:29] offset:128 sc1
    s_mov_b64 exec, -1
L_C_f2:
    v_lshlrev_b32 v32, 4, v1
    s_mov_b64 exec, 0xffff
    buffer_store_dwordx4 v[8:11], v32, s[40:43], s53 offen sc1
    s_mov_b64 exec, -1
    buffer_store_dwordx4 v[8:11], v32, s[40:43], s52 offen offset:0 sc1
    buffer_store_dwordx4 v[8:11], v32, s[40:43], s52 offen offset:1024 sc1
    buffer_store_dwordx4 v[8:11], v32, s[40:43], s52 offen offset:2048 sc1
    buffer_store_dwordx4 v[8:11], v32, s[40:43], s52 offen offset:3072 sc1
L_w54:
    ds_read_b32 v5, v0 offset:5040
    s_sub_u32 s3, s3, 1
    s_cbranch_scc1 L_end
    s_waitcnt lgkmcnt(0)
    v_cmp_gt_u32_e64 vcc, 4, v5
    s_cbranch_vccnz L_w54
    ds_read_b128 v[40:43], v12 offset:0
    ds_read_b128 v[44:47], v12 offset:4096
    ds_read_b128 v[48:51], v12 offset:8192
    ds_read_b128 v[52:55], v12 offset:12288
    ds_read_b128 v[56:59], v12 offset:1024
    ds_read_b128 v[60:63], v12 offset:5120
    ds_read_b128 v[64:67], v12 offset:9216
    ds_read_b128 v[68:71], v12 offset:13312
    ds_read_b128 v[72:75], v12 offset:2048
    ds_read_b128 v[76:79], v12 offset:6144
    ds_read_b128 v[80:83], v12 offset:10240
    ds_read_b128 v[84:87], v12 offset:14336
    s_waitcnt lgkmcnt(8)
    ds_read_b128 v[88:91], v12 offset:3072
    ds_read_b128 v[92:95], v12 offset:7168
    ds_read_b128 v[96:99], v12 offset:11264
    ds_read_b128 v[100:103], v12 offset:15360
    s_waitcnt lgkmcnt(12)
    v_pk_add_f32 v[40:41], v[40:41], v[44:45]
    v_pk_add_f32 v[48:49], v[48:49], v[52:53]
    v_pk_add_f32 v[42:43], v[42:43], v[46:47]
    v_pk_add_f32 v[50:51], v[50:51], v[54:55]
    v_pk_add_f32 v[40:41], v[40:41], v[48:49]
    v_pk_add_f32 v[42:43], v[42:43], v[50:51]
    v_cvt_pk_bf16_f32 v40, v40, v40
    v_cvt_pk_bf16_f32 v41, v41, v41
    v_cvt_pk_bf16_f32 v42, v42, v42
    v_cvt_pk_bf16_f32 v43, v43, v43
    v_and_b32 v16, v40, v14
    v_and_b32 v20, v41, v14
    v_and_b32 v24, v42, v14
    v_and_b32_e64 v28, v43, v14
    s_waitcnt lgkmcnt(8)
    v_pk_add_f32 v[56:57], v[56:57], v[60:61]
    v_pk_add_f32 v[64:65], v[64:65], v[68:69]
    v_pk_add_f32 v[58:59], v[58:59], v[62:63]
    v_pk_add_f32 v[66:67], v[66:67], v[70:71]
    v_pk_add_f32 v[56:57], v[56:57], v[64:65]
    v_pk_add_f32 v[58:59], v[58:59], v[66:67]
    v_cvt_pk_bf16_f32 v56, v56, v56
    v_cvt_pk_bf16_f32 v57, v57, v57
    v_cvt_pk_bf16_f32 v58, v58, v58
    v_cvt_pk_bf16_f32 v59, v59, v59
    v_and_b32 v17, v56, v14
    v_and_b32 v21, v57, v14
    v_and_b32 v25, v58, v14
    v_and_b32_e64 v29, v59, v14
    s_waitcnt lgkmcnt(4)
    v_pk_add_f32 v[72:73], v[72:73], v[76:77]
    v_pk_add_f32 v[80:81], v[80:81], v[84:85]
    v_pk_add_f32 v[74:75], v[74:75], v[78:79]
    v_pk_add_f32 v[82:83], v[82:83], v[86:87]
    v_pk_add_f32 v[72:73], v[72:73], v[80:81]
    v_pk_add_f32 v[74:75], v[74:75], v[82:83]
    v_cvt_pk_bf16_f32 v72, v72, v72
    v_cvt_pk_bf16_f32 v73, v73, v73
    v_cvt_pk_bf16_f32 v74, v74, v74
    v_cvt_pk_bf16_f32 v75, v75, v75
    v_and_b32 v18, v72, v14
    v_and_b32 v22, v73, v14
    v_and_b32 v26, v74, v14
    v_and_b32_e64 v30, v75, v14
    s_waitcnt lgkmcnt(0)
    v_pk_add_f32 v[88:89], v[88:89], v[92:93]
    v_pk_add_f32 v[96:97], v[96:97], v[100:101]
    v_pk_add_f32 v[90:91], v[90:91], v[94:95]
    v_pk_add_f32 v[98:99], v[98:99], v[102:103]
    v_pk_add_f32 v[88:89], v[88:89], v[96:97]
    v_pk_add_f32 v[90:91], v[90:91], v[98:99]
    v_cvt_pk_bf16_f32 v88, v88, v88
    v_cvt_pk_bf16_f32 v89, v89, v89
    v_cvt_pk_bf16_f32 v90, v90, v90
    v_cvt_pk_bf16_f32 v91, v91, v91
    v_and_b32 v19, v88, v14
    v_and_b32 v23, v89, v14
    v_and_b32 v27, v90, v14
    v_and_b32 v31, v91, v14
    v_mfma_f32_16x16x32_bf16 v[40:43], v[104:107], v[16:19], 0
    v_mfma_f32_16x16x32_bf16 v[44:47], v[120:123], v[16:19], 0
    v_mfma_f32_16x16x32_bf16 v[48:51], v[136:139], v[16:19], 0
    v_mfma_f32_16x16x32_bf16 v[52:55], v[152:155], v[16:19], 0
    v_mfma_f32_16x16x32_bf16 v[40:43], v[108:111], v[20:23], v[40:43]
    v_mfma_f32_16x16x32_bf16 v[44:47], v[124:127], v[20:23], v[44:47]
    v_mfma_f32_16x16x32_bf16 v[48:51], v[140:143], v[20:23], v[48:51]
    v_mfma_f32_16x16x32_bf16 v[52:55], v[156:159], v[20:23], v[52:55]
    v_mfma_f32_16x16x32_bf16 v[40:43], v[112:115], v[24:27], v[40:43]
    v_mfma_f32_16x16x32_bf16 v[44:47], v[128:131], v[24:27], v[44:47]
    v_mfma_f32_16x16x32_bf16 v[48:51], v[144:147], v[24:27], v[48:51]
    v_mfma_f32_16x16x32_bf16 v[52:55], v[160:163], v[24:27], v[52:55]
    v_mfma_f32_16x16x32_bf16 v[40:43], v[116:119], v[28:31], v[40:43]
    v_mfma_f32_16x16x32_bf16 v[44:47], v[132:135], v[28:31], v[44:47]
    v_mfma_f32_16x16x32_bf16 v[48:51], v[148:151], v[28:31], v[48:51]
    v_mfma_f32_16x16x32_bf16 v[52:55], v[164:167], v[28:31], v[52:55]
    s_nop 4
    s_nop 0
    v_add_f32_dpp v40, v40, v40 quad_perm:[1,0,3,2] row_mask:0xf bank_mask:0xf
    v_add_f32_dpp v41, v41, v41 quad_perm:[1,0,3,2] row_mask:0xf bank_mask:0xf
    v_add_f32_dpp v42, v42, v42 quad_perm:[1,0,3,2] row_mask:0xf bank_mask:0xf
    v_add_f32_dpp v43, v43, v43 quad_perm:[1,0,3,2] row_mask:0xf bank_mask:0xf
    v_add_f32_dpp v44, v44, v44 quad_perm:[1,0,3,2] row_mask:0xf bank_mask:0xf
    v_add_f32_dpp v45, v45, v45 quad_perm:[1,0,3,2] row_mask:0xf bank_mask:0xf
    v_add_f32_dpp v46, v46, v46 quad_perm:[1,0,3,2] row_mask:0xf bank_mask:0xf
    v_add_f32_dpp v47, v47, v47 quad_perm:[1,0,3,2] row_mask:0xf bank_mask:0xf
    v_add_f32_dpp v48, v48, v48 quad_perm:[1,0,3,2] row_mask:0xf bank_mask:0xf
    v_add_f32_dpp v49, v49, v49 quad_perm:[1,0,3,2] row_mask:0xf bank_mask:0xf
    v_add_f32_dpp v50, v50, v50 quad_perm:[1,0,3,2] row_mask:0xf bank_mask:0xf
    v_add_f32_dpp v51, v51, v51 quad_perm:[1,0,3,2] row_mask:0xf bank_mask:0xf
    v_add_f32_dpp v52, v52, v52 quad_perm:[1,0,3,2] row_mask:0xf bank_mask:0xf
    v_add_f32_dpp v53, v53, v53 quad_perm:[1,0,3,2] row_mask:0xf bank_mask:0xf
    v_add_f32_dpp v54, v54, v54 quad_perm:[1,0,3,2] row_mask:0xf bank_mask:0xf
    v_add_f32_dpp v55, v55, v55 quad_perm:[1,0,3,2] row_mask:0xf bank_mask:0xf
    v_cndmask_b32 v40, v40, v48, s[56:57]
    v_cndmask_b32 v41, v41, v49, s[56:57]
    v_cndmask_b32 v42, v42, v50, s[56:57]
    v_cndmask_b32 v43, v43, v51, s[56:57]
    v_cndmask_b32 v44, v44, v52, s[56:57]
    v_cndmask_b32 v45, v45, v53, s[56:57]
    v_cndmask_b32 v46, v46, v54, s[56:57]
    v_cndmask_b32 v47, v47, v55, s[56:57]
    v_cvt_pk_bf16_f32 v40, v40, v41
    v_cvt_pk_bf16_f32 v41, v42, v43
    v_cvt_pk_bf16_f32 v42, v44, v45
    v_cvt_pk_bf16_f32 v43, v46, v47
    s_waitcnt vmcnt(0)
    buffer_store_dwordx4 v[40:43], v15, s[40:43], s49 offen sc1
L_C_qs:
    v_mov_b32 v5, 1
    s_mov_b64 exec, 1
    ds_add_u32 v0, v5 offset:5044
    s_mov_b64 exec, -1
    s_branch L_C_o
L_C_qh:
L_C_o:
    s_setprio 0
    v_and_b32 v5, 15, v1
    s_mov_b32 s44, s14
    s_mov_b32 s45, s15
    s_mov_b32 s46, 4194304
    s_mov_b32 s47, 0x20000
    v_and_b32 v16, 1, v1
    v_lshlrev_b32 v16, 4, v16
    s_mov_b32 s38, 0xffff
    v_lshlrev_b32 v16, v16, s38
    v_bfe_u32 v17, v1, 1, 2
    v_cmp_eq_u32 vcc, 0, v17
    s_nop 1
    v_cndmask_b32 v20, 0, v16, vcc
    v_cmp_eq_u32 vcc, 1, v17
    s_nop 1
    v_cndmask_b32 v21, 0, v16, vcc
    v_cmp_eq_u32 vcc, 2, v17
    s_nop 1
    v_cndmask_b32 v22, 0, v16, vcc
    v_cmp_eq_u32 vcc, 3, v17
    s_nop 1
    v_cndmask_b32 v23, 0, v16, vcc

    s_mov_b32 s38, 0x3f803f80
    v_and_b32 v20, s38, v20
    v_and_b32 v21, s38, v21
    v_and_b32 v22, s38, v22
    v_and_b32 v23, s38, v23
    v_lshrrev_b32 v4, 4, v1
    v_lshlrev_b32 v7, 11, v4
    v_lshl_add_u32 v7, v5, 4, v7
    s_and_b32 s52, s35, 23
    s_lshr_b32 s38, s33, 1
    s_lshl3_add_u32 s52, s38, s52
    s_and_b32 s39, s33, 1
    s_lshl3_add_u32 s50, s52, s39
    s_lshl_b32 s50, s50, 10
    s_add_u32 s50, s50, 1835008
    s_lshl1_add_u32 s48, s52, s39
    s_lshl_b32 s48, s48, 16
    s_and_b32 s53, s37, 1
    s_lshl2_add_u32 s53, s53, s62
    s_lshl_b32 s38, s53, 7
    s_add_u32 s48, s48, s38
    s_lshr_b32 s39, s37, 1
    s_lshl3_add_u32 s39, s39, s36
    s_lshl_b32 s49, s39, 10
    s_add_u32 s49, s49, s38
    s_add_u32 s49, s49, 1572864
    s_add_u32 s51, s49, 32768
    s_lshl4_add_u32 s60, s53, s39
    s_lshl_b32 s60, s60, 7
    s_add_u32 s60, s60, 983040
    v_and_b32 v12, 1, v4
    v_lshrrev_b32 v13, 1, v4
    v_lshl_add_u32 v12, v12, 1, v13
    v_mul_u32_u24 v12, 272, v12
    v_lshl_add_u32 v12, v5, 4, v12
    s_mul_i32 s38, s33, 4352
    v_add_u32 v18, s38, v12
    v_lshlrev_b32 v13, 4, v13
    v_mul_u32_u24 v3, 272, v5
    v_lshl_add_u32 v3, v4, 4, v3
    v_add_u32 v3, s38, v3
    s_mov_b32 s38, 0xffff
    v_lshlrev_b32 v19, v13, s38
    v_lshlrev_b32 v2, 12, v4
    v_lshl_add_u32 v2, v5, 3, v2
    v_lshlrev_b32 v4, 16, v4
    v_lshl_add_u32 v4, v5, 3, v4
    s_lshl_b32 s38, s33, 11
    s_add_u32 s38, s38, 32768
    v_lshl_add_u32 v17, v1, 4, s38
L_w55:
    s_sleep 1
    ds_read_b32 v6, v0 offset:5048
    s_sub_u32 s3, s3, 1
    s_cbranch_scc1 L_end
    s_waitcnt lgkmcnt(0)
    v_cmp_gt_u32 vcc, 4, v6
    s_cbranch_vccnz L_w55
    s_add_u32 s39, s48, 0
    buffer_load_dwordx2 v[104:105], v2, s[44:47], s39 offen nt
    s_add_u32 s39, s48, 1024
    buffer_load_dwordx2 v[108:109], v2, s[44:47], s39 offen nt
    s_add_u32 s39, s48, 2048
    buffer_load_dwordx2 v[106:107], v2, s[44:47], s39 offen nt
    s_add_u32 s39, s48, 3072
    buffer_load_dwordx2 v[110:111], v2, s[44:47], s39 offen nt
    s_add_u32 s39, s48, 16384
    buffer_load_dwordx2 v[112:113], v2, s[44:47], s39 offen nt
    s_add_u32 s39, s48, 17408
    buffer_load_dwordx2 v[116:117], v2, s[44:47], s39 offen nt
    s_add_u32 s39, s48, 18432
    buffer_load_dwordx2 v[114:115], v2, s[44:47], s39 offen nt
    s_add_u32 s39, s48, 19456
    buffer_load_dwordx2 v[118:119], v2, s[44:47], s39 offen nt
    s_add_u32 s39, s48, 32768
    buffer_load_dwordx2 v[120:121], v2, s[44:47], s39 offen nt
    s_add_u32 s39, s48, 33792
    buffer_load_dwordx2 v[124:125], v2, s[44:47], s39 offen nt
    s_add_u32 s39, s48, 34816
    buffer_load_dwordx2 v[122:123], v2, s[44:47], s39 offen nt
    s_add_u32 s39, s48, 35840
    buffer_load_dwordx2 v[126:127], v2, s[44:47], s39 offen nt
    s_add_u32 s39, s48, 49152
    buffer_load_dwordx2 v[128:129], v2, s[44:47], s39 offen nt
    s_add_u32 s39, s48, 50176
    buffer_load_dwordx2 v[132:133], v2, s[44:47], s39 offen nt
    s_add_u32 s39, s48, 51200
    buffer_load_dwordx2 v[130:131], v2, s[44:47], s39 offen nt
    s_add_u32 s39, s48, 52224
    buffer_load_dwordx2 v[134:135], v2, s[44:47], s39 offen nt
    s_waitcnt vmcnt(0)
    v_mov_b32 v6, 1
    s_mov_b64 exec, 1
    ds_add_u32 v0, v6 offset:6060
    s_mov_b64 exec, -1
    v_swap_b32 v105, v108
    v_swap_b32 v107, v110
    v_swap_b32 v113, v116
    v_swap_b32 v115, v118
    v_swap_b32 v121, v124
    v_swap_b32 v123, v126
    v_swap_b32 v129, v132
    v_swap_b32 v131, v134
L_w56:
    s_sleep 1
    ds_read_b32 v6, v0 offset:6048
    s_sub_u32 s3, s3, 1
    s_cbranch_scc1 L_end
    s_waitcnt lgkmcnt(0)
    v_cmp_gt_u32 vcc, 4, v6
    s_cbranch_vccnz L_w56
    s_setprio 2
L_w57:
    ds_read_b32 v6, v0 offset:6052
    s_sub_u32 s3, s3, 1
    s_cbranch_scc1 L_end
    s_waitcnt lgkmcnt(0)
    v_cmp_gt_u32_e64 vcc, 2, v6
    s_cbranch_vccnz L_w57
L_C_x:
    buffer_load_dwordx4 v[40:43], v7, s[40:43], s50 offen offset:0 sc1
    buffer_load_dwordx4 v[44:47], v7, s[40:43], s50 offen offset:256 sc1
    buffer_load_dwordx4 v[48:51], v7, s[40:43], s50 offen offset:512 sc1
    buffer_load_dwordx4 v[52:55], v7, s[40:43], s50 offen offset:768 sc1
    s_sub_u32 s3, s3, 1
    s_cbranch_scc1 L_end
    s_mov_b64 exec, -1
    s_waitcnt vmcnt(3)
    v_mfma_f32_16x16x32_bf16 v[56:59], v[20:23], v[40:43], 0
    s_waitcnt vmcnt(2)
    v_mfma_f32_16x16x32_bf16 v[60:63], v[20:23], v[44:47], 0
    s_waitcnt vmcnt(1)
    v_mfma_f32_16x16x32_bf16 v[64:67], v[20:23], v[48:51], 0
    s_waitcnt vmcnt(0)
    v_mfma_f32_16x16x32_bf16 v[68:71], v[20:23], v[52:55], 0
    v_max3_u32 v12, v40, v41, v42
    v_max3_u32 v12, v12, v43, v44
    v_max3_u32 v12, v12, v45, v46
    v_max3_u32 v12, v12, v47, v48
    v_max3_u32 v12, v12, v49, v50
    v_max3_u32 v12, v12, v51, v52
    v_max3_u32 v12, v12, v53, v54
    v_max_u32 v12, v12, v55
    v_cmp_eq_u32 vcc, -1, v12
    s_cbranch_vccz L_C_x1
    s_branch L_C_x
L_C_x1:
    v_cvt_pk_bf16_f32 v56, v56, v56
    v_cvt_pk_bf16_f32 v57, v57, v57
    v_cvt_pk_bf16_f32 v58, v58, v58
    v_cvt_pk_bf16_f32 v59, v59, v59
    v_and_b32 v56, v56, v19
    v_and_b32 v57, v57, v19
    v_and_b32 v58, v58, v19
    v_and_b32 v59, v59, v19
    ds_write_b128 v18, v[56:59] offset:0
    v_cvt_pk_bf16_f32 v60, v60, v60
    v_cvt_pk_bf16_f32 v61, v61, v61
    v_cvt_pk_bf16_f32 v62, v62, v62
    v_cvt_pk_bf16_f32 v63, v63, v63
    v_and_b32 v60, v60, v19
    v_and_b32 v61, v61, v19
    v_and_b32 v62, v62, v19
    v_and_b32 v63, v63, v19
    ds_write_b128 v18, v[60:63] offset:1088
    v_cvt_pk_bf16_f32 v64, v64, v64
    v_cvt_pk_bf16_f32 v65, v65, v65
    v_cvt_pk_bf16_f32 v66, v66, v66
    v_cvt_pk_bf16_f32 v67, v67, v67
    v_and_b32 v64, v64, v19
    v_and_b32 v65, v65, v19
    v_and_b32 v66, v66, v19
    v_and_b32 v67, v67, v19
    ds_write_b128 v18, v[64:67] offset:2176
    v_cvt_pk_bf16_f32 v68, v68, v68
    v_cvt_pk_bf16_f32 v69, v69, v69
    v_cvt_pk_bf16_f32 v70, v70, v70
    v_cvt_pk_bf16_f32 v71, v71, v71
    v_and_b32 v68, v68, v19
    v_and_b32 v69, v69, v19
    v_and_b32 v70, v70, v19
    v_and_b32 v71, v71, v19
    ds_write_b128 v18, v[68:71] offset:3264
    ds_read_b128 v[40:43], v3 offset:0
    ds_read_b128 v[44:47], v3 offset:64
    ds_read_b128 v[48:51], v3 offset:128
    ds_read_b128 v[52:55], v3 offset:192
    s_waitcnt lgkmcnt(3)
    v_mfma_f32_16x16x32_bf16 v[24:27], v[40:43], v[104:107], 0
    v_mfma_f32_16x16x32_bf16 v[28:31], v[40:43], v[108:111], 0
    s_waitcnt lgkmcnt(2)
    v_mfma_f32_16x16x32_bf16 v[24:27], v[44:47], v[112:115], v[24:27]
    v_mfma_f32_16x16x32_bf16 v[28:31], v[44:47], v[116:119], v[28:31]
    s_waitcnt lgkmcnt(1)
    v_mfma_f32_16x16x32_bf16 v[24:27], v[48:51], v[120:123], v[24:27]
    v_mfma_f32_16x16x32_bf16 v[28:31], v[48:51], v[124:127], v[28:31]
    s_waitcnt lgkmcnt(0)
    v_mfma_f32_16x16x32_bf16 v[24:27], v[52:55], v[128:131], v[24:27]
    v_mfma_f32_16x16x32_bf16 v[28:31], v[52:55], v[132:135], v[28:31]
    s_cmp_eq_u32 s33, 0
    s_cbranch_scc1 L_C_o2
    s_nop 4
    ds_write_b128 v17, v[24:27]
    ds_write_b128 v17, v[28:31] offset:1024
    v_mov_b32 v6, 1
    s_mov_b64 exec, 1
    ds_add_u32 v0, v6 offset:6056
    s_mov_b64 exec, -1
L_w58:
    ds_read_b32 v6, v0 offset:6056
    s_sub_u32 s3, s3, 1
    s_cbranch_scc1 L_end
    s_waitcnt lgkmcnt(0)
    v_cmp_gt_u32 vcc, 3, v6
    s_cbranch_vccnz L_w58
    s_cmp_lg_u32 s33, 2
    s_cbranch_scc1 L_C_nh
    v_lshlrev_b32 v12, 14, v1
    s_mov_b64 exec, 15
    buffer_store_dword v12, v12, s[40:43], s60 offen sc1
    s_mov_b64 exec, -1
L_C_nh:
    s_branch L_end
L_C_o2:
L_w59:
    ds_read_b32 v6, v0 offset:6056
    s_sub_u32 s3, s3, 1
    s_cbranch_scc1 L_end
    s_waitcnt lgkmcnt(0)
    v_cmp_gt_u32 vcc, 3, v6
    s_cbranch_vccnz L_w59
    ds_read_b128 v[40:43], v17 offset:2048
    ds_read_b128 v[44:47], v17 offset:3072
    ds_read_b128 v[48:51], v17 offset:4096
    ds_read_b128 v[52:55], v17 offset:5120
    ds_read_b128 v[56:59], v17 offset:6144
    ds_read_b128 v[60:63], v17 offset:7168
    s_waitcnt lgkmcnt(4)
    v_pk_add_f32 v[24:25], v[24:25], v[40:41]
    v_pk_add_f32 v[26:27], v[26:27], v[42:43]
    v_pk_add_f32 v[28:29], v[28:29], v[44:45]
    v_pk_add_f32 v[30:31], v[30:31], v[46:47]
    s_waitcnt lgkmcnt(2)
    v_pk_add_f32 v[24:25], v[24:25], v[48:49]
    v_pk_add_f32 v[26:27], v[26:27], v[50:51]
    v_pk_add_f32 v[28:29], v[28:29], v[52:53]
    v_pk_add_f32 v[30:31], v[30:31], v[54:55]
    s_waitcnt lgkmcnt(0)
    s_nop 0
    v_pk_add_f32 v[24:25], v[24:25], v[56:57]
    v_pk_add_f32 v[26:27], v[26:27], v[58:59]
    v_pk_add_f32 v[28:29], v[28:29], v[60:61]
    v_pk_add_f32 v[30:31], v[30:31], v[62:63]
    v_cvt_pk_bf16_f32 v8, v24, v25
    v_cvt_pk_bf16_f32 v9, v28, v29
    v_cvt_pk_bf16_f32 v10, v26, v27
    v_cvt_pk_bf16_f32 v11, v30, v31
    buffer_store_dwordx2 v[8:9], v4, s[40:43], s49 offen sc1
    buffer_store_dwordx2 v[10:11], v4, s[40:43], s51 offen sc1
    s_branch L_end
L_C_at:

    v_lshrrev_b32 v7, 5, v1
    v_bfe_u32 v2, v1, 2, 2
    v_lshl_add_u32 v3, v7, 2, v2
    v_lshrrev_b32 v2, 1, v2
    v_lshl_or_b32 v2, v2, 2, v7
    v_bfe_u32 v4, v1, 4, 1
    v_bfe_u32 v5, v1, 1, 1
    v_lshl_or_b32 v4, v4, 1, v5
    v_xor_b32 v2, v2, v4
    v_lshlrev_b32 v2, 4, v2
    v_lshl_add_u32 v2, v3, 7, v2
    v_and_b32 v3, 1, v1
    v_lshl_add_u32 v2, v3, 3, v2
    s_and_b32 s38, s33, 1
    s_lshl_b32 s38, s38, 6
    s_lshr_b32 s39, s33, 1
    s_lshl_b32 s39, s39, 14
    s_or_b32 s38, s38, s39
    v_xor_b32 v2, s38, v2
    v_xor_b32 v3, 1056, v2
    v_lshlrev_b32 v4, 4, v1
    v_add_u32 v4, 131072, v4
    s_waitcnt vmcnt(0)
    s_mov_b64 exec, 0
    s_branch L_pad_c_0
L_pad_c_r:
    s_mov_b64 exec, -1
L_w460:
    s_sleep 1
    ds_read_b128 v[8:11], v0 offset:4032
    s_sub_u32 s3, s3, 1
    s_cbranch_scc1 L_end
    s_waitcnt lgkmcnt(0)
    v_min3_u32 v8, v8, v9, v10
    v_min_u32 v8, v8, v11
    v_cmp_gt_u32 vcc, 2, v8
    s_cbranch_vccnz L_w460
    ds_read_b64_tr_b16 v[40:41], v2 offset:0
    ds_read_b64_tr_b16 v[42:43], v3 offset:0
    ds_read_b64_tr_b16 v[44:45], v2 offset:2048
    ds_read_b64_tr_b16 v[46:47], v3 offset:2048
    ds_read_b64_tr_b16 v[48:49], v2 offset:4096
    ds_read_b64_tr_b16 v[50:51], v3 offset:4096
    ds_read_b64_tr_b16 v[52:53], v2 offset:6144
    ds_read_b64_tr_b16 v[54:55], v3 offset:6144
    ds_read_b64_tr_b16 v[56:57], v2 offset:8192
    ds_read_b64_tr_b16 v[58:59], v3 offset:8192
    ds_read_b64_tr_b16 v[60:61], v2 offset:10240
    ds_read_b64_tr_b16 v[62:63], v3 offset:10240
    s_waitcnt lgkmcnt(6)
    ds_read_b64_tr_b16 v[64:65], v2 offset:12288
    ds_read_b64_tr_b16 v[66:67], v3 offset:12288
    ds_read_b64_tr_b16 v[68:69], v2 offset:14336
    ds_read_b64_tr_b16 v[70:71], v3 offset:14336
    v_mov_b32 v5, 1
    s_mov_b64 exec, 1
    ds_add_u32 v0, v5 offset:3024
    s_mov_b64 exec, -1
L_w461:
    s_sleep 1
    ds_read_b128 v[8:11], v0 offset:4032
    s_sub_u32 s3, s3, 1
    s_cbranch_scc1 L_end
    s_waitcnt lgkmcnt(0)
    v_min3_u32 v8, v8, v9, v10
    v_min_u32 v8, v8, v11
    v_cmp_gt_u32_e64 vcc, 4, v8
    s_cbranch_vccnz L_w461
    ds_read_b64_tr_b16 v[72:73], v2 offset:32768
    ds_read_b64_tr_b16 v[74:75], v3 offset:32768
    ds_read_b64_tr_b16 v[76:77], v2 offset:34816
    ds_read_b64_tr_b16 v[78:79], v3 offset:34816
    ds_read_b64_tr_b16 v[80:81], v2 offset:36864
    ds_read_b64_tr_b16 v[82:83], v3 offset:36864
    ds_read_b64_tr_b16 v[84:85], v2 offset:38912
    ds_read_b64_tr_b16 v[86:87], v3 offset:38912
    ds_read_b64_tr_b16 v[88:89], v2 offset:40960
    ds_read_b64_tr_b16 v[90:91], v3 offset:40960
    ds_read_b64_tr_b16 v[92:93], v2 offset:43008
    ds_read_b64_tr_b16 v[94:95], v3 offset:43008
    s_waitcnt lgkmcnt(6)
    ds_read_b64_tr_b16 v[96:97], v2 offset:45056
    ds_read_b64_tr_b16 v[98:99], v3 offset:45056
    ds_read_b64_tr_b16 v[100:101], v2 offset:47104
    ds_read_b64_tr_b16 v[102:103], v3 offset:47104
    v_mov_b32 v5, 1
    s_mov_b64 exec, 1
    ds_add_u32 v0, v5 offset:3028
    s_mov_b64 exec, -1
L_w462:
    s_sleep 1
    ds_read_b128 v[8:11], v0 offset:4032
    s_sub_u32 s3, s3, 1
    s_cbranch_scc1 L_end
    s_waitcnt lgkmcnt(0)
    v_min3_u32 v8, v8, v9, v10
    v_min_u32 v8, v8, v11
    v_cmp_gt_u32_e64 vcc, 6, v8
    s_cbranch_vccnz L_w462
    v_add_u32 v2, 0x10000, v2
    v_add_u32 v3, 0x10000, v3
    ds_read_b64_tr_b16 v[104:105], v2 offset:0
    ds_read_b64_tr_b16 v[106:107], v3 offset:0
    ds_read_b64_tr_b16 v[108:109], v2 offset:2048
    ds_read_b64_tr_b16 v[110:111], v3 offset:2048
    ds_read_b64_tr_b16 v[112:113], v2 offset:4096
    ds_read_b64_tr_b16 v[114:115], v3 offset:4096
    ds_read_b64_tr_b16 v[116:117], v2 offset:6144
    ds_read_b64_tr_b16 v[118:119], v3 offset:6144
    ds_read_b64_tr_b16 v[120:121], v2 offset:8192
    ds_read_b64_tr_b16 v[122:123], v3 offset:8192
    ds_read_b64_tr_b16 v[124:125], v2 offset:10240
    ds_read_b64_tr_b16 v[126:127], v3 offset:10240
    s_waitcnt lgkmcnt(6)
    ds_read_b64_tr_b16 v[128:129], v2 offset:12288
    ds_read_b64_tr_b16 v[130:131], v3 offset:12288
    ds_read_b64_tr_b16 v[132:133], v2 offset:14336
    ds_read_b64_tr_b16 v[134:135], v3 offset:14336
    v_mov_b32 v5, 1
    s_mov_b64 exec, 1
    ds_add_u32 v0, v5 offset:3032
    s_mov_b64 exec, -1
L_w463:
    s_sleep 1
    ds_read_b128 v[8:11], v0 offset:4032
    s_sub_u32 s3, s3, 1
    s_cbranch_scc1 L_end
    s_waitcnt lgkmcnt(0)
    v_min3_u32 v8, v8, v9, v10
    v_min_u32 v8, v8, v11
    v_cmp_gt_u32_e64 vcc, 8, v8
    s_cbranch_vccnz L_w463
    ds_read_b64_tr_b16 v[136:137], v2 offset:32768
    ds_read_b64_tr_b16 v[138:139], v3 offset:32768
    ds_read_b64_tr_b16 v[140:141], v2 offset:34816
    ds_read_b64_tr_b16 v[142:143], v3 offset:34816
    ds_read_b64_tr_b16 v[144:145], v2 offset:36864
    ds_read_b64_tr_b16 v[146:147], v3 offset:36864
    ds_read_b64_tr_b16 v[148:149], v2 offset:38912
    ds_read_b64_tr_b16 v[150:151], v3 offset:38912
    ds_read_b64_tr_b16 v[152:153], v2 offset:40960
    ds_read_b64_tr_b16 v[154:155], v3 offset:40960
    ds_read_b64_tr_b16 v[156:157], v2 offset:43008
    ds_read_b64_tr_b16 v[158:159], v3 offset:43008
    s_waitcnt lgkmcnt(6)
    ds_read_b64_tr_b16 v[160:161], v2 offset:45056
    ds_read_b64_tr_b16 v[162:163], v3 offset:45056
    ds_read_b64_tr_b16 v[164:165], v2 offset:47104
    ds_read_b64_tr_b16 v[166:167], v3 offset:47104
    v_mov_b32 v5, 1
    s_mov_b64 exec, 1
    ds_add_u32 v0, v5 offset:3036
    s_mov_b64 exec, -1
    v_subrev_u32 v2, 0x10000, v2
    v_subrev_u32 v3, 0x10000, v3
L_w64:
    s_sleep 2
    ds_read_b32 v5, v0 offset:1008
    s_sub_u32 s3, s3, 1
    s_cbranch_scc1 L_end
    s_waitcnt lgkmcnt(0)
    v_cmp_gt_u32 vcc, 4, v5
    s_cbranch_vccnz L_w64
    s_setprio 1
L_w65:
    s_sleep 1
    ds_read_b32 v5, v0 offset:1016
    s_sub_u32 s3, s3, 1
    s_cbranch_scc1 L_end
    s_waitcnt lgkmcnt(0)
    v_cmp_gt_u32 vcc, 1, v5
    s_cbranch_vccnz L_w65
L_w66:
    ds_read_b32 v5, v0 offset:1016
    s_sub_u32 s3, s3, 1
    s_cbranch_scc1 L_end
    s_waitcnt lgkmcnt(0)
    v_cmp_gt_u32 vcc, 4, v5
    s_cbranch_vccnz L_w66
L_pad_c_0:
    s_cbranch_execz L_pad_c_1
    ds_read_b128 v[24:27], v4 offset:0
    ds_read_b128 v[28:31], v4 offset:1024
    ds_read_b128 v[32:35], v4 offset:2048
    ds_read_b128 v[36:39], v4 offset:3072
    s_waitcnt lgkmcnt(3)
    v_mfma_f32_32x32x16_bf16 v[8:23], v[24:27], v[40:43], 0
    ds_read_b128 v[24:27], v4 offset:4096
    s_waitcnt lgkmcnt(3)
    v_mfma_f32_32x32x16_bf16 v[8:23], v[28:31], v[44:47], v[8:23]
    ds_read_b128 v[28:31], v4 offset:5120
    s_waitcnt lgkmcnt(3)
    v_mfma_f32_32x32x16_bf16 v[8:23], v[32:35], v[48:51], v[8:23]
    ds_read_b128 v[32:35], v4 offset:6144
    s_waitcnt lgkmcnt(3)
    v_mfma_f32_32x32x16_bf16 v[8:23], v[36:39], v[52:55], v[8:23]
    ds_read_b128 v[36:39], v4 offset:7168
    s_waitcnt lgkmcnt(3)
    v_mfma_f32_32x32x16_bf16 v[8:23], v[24:27], v[56:59], v[8:23]
    ds_read_b128 v[24:27], v4 offset:0
    s_waitcnt lgkmcnt(3)
    v_mfma_f32_32x32x16_bf16 v[8:23], v[28:31], v[60:63], v[8:23]
    ds_read_b128 v[28:31], v4 offset:1024
    s_waitcnt lgkmcnt(3)
    v_mfma_f32_32x32x16_bf16 v[8:23], v[32:35], v[64:67], v[8:23]
    ds_read_b128 v[32:35], v4 offset:2048
    s_waitcnt lgkmcnt(3)
    v_mfma_f32_32x32x16_bf16 v[8:23], v[36:39], v[68:71], v[8:23]
    ds_read_b128 v[36:39], v4 offset:3072
    s_waitcnt lgkmcnt(3)
    v_mfma_f32_32x32x16_bf16 v[40:55], v[24:27], v[72:75], 0
    ds_read_b128 v[24:27], v4 offset:4096
    s_waitcnt lgkmcnt(3)
    v_mfma_f32_32x32x16_bf16 v[40:55], v[28:31], v[76:79], v[40:55]
    ds_read_b128 v[28:31], v4 offset:5120
    s_waitcnt lgkmcnt(3)
    v_mfma_f32_32x32x16_bf16 v[40:55], v[32:35], v[80:83], v[40:55]
    ds_read_b128 v[32:35], v4 offset:6144
    s_waitcnt lgkmcnt(3)
    v_mfma_f32_32x32x16_bf16 v[40:55], v[36:39], v[84:87], v[40:55]
    ds_read_b128 v[36:39], v4 offset:7168
    s_waitcnt lgkmcnt(3)
    v_mfma_f32_32x32x16_bf16 v[40:55], v[24:27], v[88:91], v[40:55]
    ds_read_b128 v[24:27], v4 offset:0
    s_waitcnt lgkmcnt(3)
    v_mfma_f32_32x32x16_bf16 v[40:55], v[28:31], v[92:95], v[40:55]
    ds_read_b128 v[28:31], v4 offset:1024
    s_waitcnt lgkmcnt(3)
    v_mfma_f32_32x32x16_bf16 v[40:55], v[32:35], v[96:99], v[40:55]
    ds_read_b128 v[32:35], v4 offset:2048
    s_waitcnt lgkmcnt(3)
    v_mfma_f32_32x32x16_bf16 v[40:55], v[36:39], v[100:103], v[40:55]
    ds_read_b128 v[36:39], v4 offset:3072
    s_waitcnt lgkmcnt(3)
    v_mfma_f32_32x32x16_bf16 v[56:71], v[24:27], v[104:107], 0
    ds_read_b128 v[24:27], v4 offset:4096
    s_waitcnt lgkmcnt(3)
    v_mfma_f32_32x32x16_bf16 v[56:71], v[28:31], v[108:111], v[56:71]
    ds_read_b128 v[28:31], v4 offset:5120
    s_waitcnt lgkmcnt(3)
    v_mfma_f32_32x32x16_bf16 v[56:71], v[32:35], v[112:115], v[56:71]
    ds_read_b128 v[32:35], v4 offset:6144
    s_waitcnt lgkmcnt(3)
    v_mfma_f32_32x32x16_bf16 v[56:71], v[36:39], v[116:119], v[56:71]
    ds_read_b128 v[36:39], v4 offset:7168
    s_waitcnt lgkmcnt(3)
    v_mfma_f32_32x32x16_bf16 v[56:71], v[24:27], v[120:123], v[56:71]
    ds_read_b128 v[24:27], v4 offset:0
    s_waitcnt lgkmcnt(3)
    v_mfma_f32_32x32x16_bf16 v[56:71], v[28:31], v[124:127], v[56:71]
    ds_read_b128 v[28:31], v4 offset:1024
    s_waitcnt lgkmcnt(3)
    v_mfma_f32_32x32x16_bf16 v[56:71], v[32:35], v[128:131], v[56:71]
    ds_read_b128 v[32:35], v4 offset:2048
    s_waitcnt lgkmcnt(3)
    v_mfma_f32_32x32x16_bf16 v[56:71], v[36:39], v[132:135], v[56:71]
    ds_read_b128 v[36:39], v4 offset:3072
    s_waitcnt lgkmcnt(3)
    v_mfma_f32_32x32x16_bf16 v[72:87], v[24:27], v[136:139], 0
    ds_read_b128 v[24:27], v4 offset:4096
    s_waitcnt lgkmcnt(3)
    v_mfma_f32_32x32x16_bf16 v[72:87], v[28:31], v[140:143], v[72:87]
    ds_read_b128 v[28:31], v4 offset:5120
    s_waitcnt lgkmcnt(3)
    v_mfma_f32_32x32x16_bf16 v[72:87], v[32:35], v[144:147], v[72:87]
    ds_read_b128 v[32:35], v4 offset:6144
    s_waitcnt lgkmcnt(3)
    v_mfma_f32_32x32x16_bf16 v[72:87], v[36:39], v[148:151], v[72:87]
    ds_read_b128 v[36:39], v4 offset:7168
    s_waitcnt lgkmcnt(3)
    v_mfma_f32_32x32x16_bf16 v[72:87], v[24:27], v[152:155], v[72:87]
    s_waitcnt lgkmcnt(2)
    v_mfma_f32_32x32x16_bf16 v[72:87], v[28:31], v[156:159], v[72:87]
    s_waitcnt lgkmcnt(1)
    v_mfma_f32_32x32x16_bf16 v[72:87], v[32:35], v[160:163], v[72:87]
    s_waitcnt lgkmcnt(0)
    v_mfma_f32_32x32x16_bf16 v[72:87], v[36:39], v[164:167], v[72:87]

    s_lshl_b32 s38, s33, 7
    s_add_u32 s38, s38, 147968
    v_lshl_add_u32 v32, v7, 4, s38
    v_and_b32_e64 v6, 31, v1
    v_lshl_add_u32 v33, v6, 2, s38
    v_lshl_add_u32 v34, v6, 4, v0
    ds_read_b128 v[28:31], v34 offset:7072
    v_add_u32 v34, -8800, v34
    s_mov_b32 s52, 0x3e0293ee
    s_waitcnt lgkmcnt(0)
    v_max3_f32 v35, v28, v29, v30
    v_max_f32 v35, v35, v31
    v_mul_f32 v35, s52, v35
    v_bfe_u32 v36, v1, 4, 1
    v_lshrrev_b32 v37, 5, v1
    v_lshl_add_u32 v36, v37, 2, v36
    v_lshlrev_b32 v36, 14, v36
    v_and_b32 v37, 15, v1
    v_lshl_add_u32 v36, v37, 3, v36
    s_lshl_b32 s55, s36, 19
    s_lshl2_add_u32 s38, s97, s33
L_pad_c_1:
    s_cbranch_execz L_pad_c_2
    s_lshl_b32 s38, s38, 8
    s_add_u32 s55, s55, s38
    s_add_u32 s55, s55, 2097152
    s_add_u32 s44, s55, 0
    s_add_u32 s45, s55, 32768
    s_add_u32 s46, s55, 131072
    s_add_u32 s47, s55, 163840
    s_add_u32 s48, s55, 262144
    s_add_u32 s49, s55, 294912
    s_add_u32 s50, s55, 393216
    s_add_u32 s51, s55, 425984
    v_lshlrev_b32 v37, 2, v37
    v_add_u32 v37, 149504, v37
    v_mov_b32 v38, -1
    ds_write_b32 v37, v38
L_w467:
    s_sleep 1
    ds_read_b128 v[24:27], v0 offset:4032
    s_sub_u32 s3, s3, 1
    s_cbranch_scc1 L_end
    s_waitcnt lgkmcnt(0)
    v_min3_u32 v24, v24, v25, v26
    v_min_u32 v24, v24, v27
    v_cmp_gt_u32_e64 vcc, 16, v24
    s_cbranch_vccnz L_w467
    ds_read_b64_tr_b16 v[136:137], v2 offset:0
    ds_read_b64_tr_b16 v[138:139], v3 offset:0
    ds_read_b64_tr_b16 v[140:141], v2 offset:2048
    ds_read_b64_tr_b16 v[142:143], v3 offset:2048
    ds_read_b64_tr_b16 v[144:145], v2 offset:4096
    ds_read_b64_tr_b16 v[146:147], v3 offset:4096
    ds_read_b64_tr_b16 v[148:149], v2 offset:6144
    ds_read_b64_tr_b16 v[150:151], v3 offset:6144
    ds_read_b64_tr_b16 v[152:153], v2 offset:8192
    ds_read_b64_tr_b16 v[154:155], v3 offset:8192
    ds_read_b64_tr_b16 v[156:157], v2 offset:10240
    ds_read_b64_tr_b16 v[158:159], v3 offset:10240
    s_waitcnt lgkmcnt(4)
    ds_read_b64_tr_b16 v[160:161], v2 offset:12288
    ds_read_b64_tr_b16 v[162:163], v3 offset:12288
    ds_read_b64_tr_b16 v[164:165], v2 offset:14336
    ds_read_b64_tr_b16 v[166:167], v3 offset:14336
    ds_read_b64_tr_b16 v[24:25], v2 offset:32768
    ds_read_b64_tr_b16 v[26:27], v3 offset:32768
L_C_mx:
    ds_read_b128 v[28:31], v34
    s_sub_u32 s3, s3, 1
    s_cbranch_scc1 L_end
    s_waitcnt lgkmcnt(0)
    v_max3_u32 v5, v28, v29, v30
    v_max_u32 v5, v5, v31
    v_cmp_eq_u32 vcc, -1, v5
    s_cbranch_vccnz L_C_mx
    v_max3_f32 v28, v28, v29, v30
    v_max_f32 v28, v28, v31
    v_mul_f32 v28, s52, v28
    v_max_f32 v28, v28, v35
    v_sub_f32 v28, v35, v28
    v_exp_f32_e64 v28, v28
    s_nop 0
    ds_write_b32 v33, v28
    ds_read_b128 v[88:91], v32 offset:0
    ds_read_b128 v[92:95], v32 offset:32
    ds_read_b128 v[96:99], v32 offset:64
    ds_read_b128 v[100:103], v32 offset:96
    s_waitcnt lgkmcnt(0)
    s_nop 0
    v_pk_mul_f32 v[8:9], v[8:9], v[88:89]
    v_pk_mul_f32 v[10:11], v[10:11], v[90:91]
    v_pk_mul_f32 v[12:13], v[12:13], v[92:93]
    v_pk_mul_f32 v[14:15], v[14:15], v[94:95]
    v_pk_mul_f32 v[16:17], v[16:17], v[96:97]
    v_pk_mul_f32 v[18:19], v[18:19], v[98:99]
    v_pk_mul_f32 v[20:21], v[20:21], v[100:101]
    v_pk_mul_f32 v[22:23], v[22:23], v[102:103]
    v_pk_mul_f32 v[40:41], v[40:41], v[88:89]
    v_pk_mul_f32 v[42:43], v[42:43], v[90:91]
    v_pk_mul_f32 v[44:45], v[44:45], v[92:93]
    v_pk_mul_f32 v[46:47], v[46:47], v[94:95]
    v_pk_mul_f32 v[48:49], v[48:49], v[96:97]
    v_pk_mul_f32 v[50:51], v[50:51], v[98:99]
    v_pk_mul_f32 v[52:53], v[52:53], v[100:101]
    v_pk_mul_f32 v[54:55], v[54:55], v[102:103]
    v_pk_mul_f32 v[56:57], v[56:57], v[88:89]
    v_pk_mul_f32 v[58:59], v[58:59], v[90:91]
    v_pk_mul_f32 v[60:61], v[60:61], v[92:93]
    v_pk_mul_f32 v[62:63], v[62:63], v[94:95]
    v_pk_mul_f32 v[64:65], v[64:65], v[96:97]
    v_pk_mul_f32 v[66:67], v[66:67], v[98:99]
    v_pk_mul_f32 v[68:69], v[68:69], v[100:101]
    v_pk_mul_f32 v[70:71], v[70:71], v[102:103]
    v_pk_mul_f32 v[72:73], v[72:73], v[88:89]
    v_pk_mul_f32 v[74:75], v[74:75], v[90:91]
    v_pk_mul_f32 v[76:77], v[76:77], v[92:93]
    v_pk_mul_f32 v[78:79], v[78:79], v[94:95]
    v_pk_mul_f32 v[80:81], v[80:81], v[96:97]
    v_pk_mul_f32 v[82:83], v[82:83], v[98:99]
    v_pk_mul_f32 v[84:85], v[84:85], v[100:101]
    v_pk_mul_f32 v[86:87], v[86:87], v[102:103]
L_w68:
    ds_read_b32 v5, v0 offset:1016
    s_sub_u32 s3, s3, 1
    s_cbranch_scc1 L_end
    s_waitcnt lgkmcnt(0)
    v_cmp_gt_u32 vcc, 8, v5
    s_cbranch_vccnz L_w68
    s_setprio 3
    ds_read_b128 v[104:107], v4 offset:8192
    ds_read_b128 v[108:111], v4 offset:9216
    ds_read_b128 v[112:115], v4 offset:10240
    ds_read_b128 v[116:119], v4 offset:11264
    ds_read_b128 v[120:123], v4 offset:12288
    ds_read_b128 v[124:127], v4 offset:13312
    ds_read_b128 v[128:131], v4 offset:14336
    ds_read_b128 v[132:135], v4 offset:15360
    ds_read_b64_tr_b16 v[28:29], v2 offset:34816
L_pad_c_2:
    s_cbranch_execz L_pad_c_3
    ds_read_b64_tr_b16 v[30:31], v3 offset:34816
    s_waitcnt lgkmcnt(9)
    v_mfma_f32_32x32x16_bf16 v[8:23], v[104:107], v[136:139], v[8:23]
    ds_read_b64_tr_b16 v[136:137], v2 offset:36864
    ds_read_b64_tr_b16 v[138:139], v3 offset:36864
    s_waitcnt lgkmcnt(10)
    v_mfma_f32_32x32x16_bf16 v[8:23], v[108:111], v[140:143], v[8:23]
    ds_read_b64_tr_b16 v[140:141], v2 offset:38912
    ds_read_b64_tr_b16 v[142:143], v3 offset:38912
    s_waitcnt lgkmcnt(11)
    v_mfma_f32_32x32x16_bf16 v[8:23], v[112:115], v[144:147], v[8:23]
    ds_read_b64_tr_b16 v[144:145], v2 offset:40960
    ds_read_b64_tr_b16 v[146:147], v3 offset:40960
    s_waitcnt lgkmcnt(4)
    s_nop 0
    v_mfma_f32_32x32x16_bf16 v[8:23], v[116:119], v[148:151], v[8:23]
    ds_read_b64_tr_b16 v[148:149], v2 offset:43008
    ds_read_b64_tr_b16 v[150:151], v3 offset:43008
    v_mfma_f32_32x32x16_bf16 v[8:23], v[120:123], v[152:155], v[8:23]
    ds_read_b64_tr_b16 v[152:153], v2 offset:45056
    ds_read_b64_tr_b16 v[154:155], v3 offset:45056
    v_mfma_f32_32x32x16_bf16 v[8:23], v[124:127], v[156:159], v[8:23]
    ds_read_b64_tr_b16 v[156:157], v2 offset:47104
    ds_read_b64_tr_b16 v[158:159], v3 offset:47104
    v_mfma_f32_32x32x16_bf16 v[8:23], v[128:131], v[160:163], v[8:23]
    v_add_u32 v2, 0x10000, v2
    v_add_u32 v3, 0x10000, v3
    ds_read_b64_tr_b16 v[160:161], v2 offset:0
    ds_read_b64_tr_b16 v[162:163], v3 offset:0
    v_mfma_f32_32x32x16_bf16 v[8:23], v[132:135], v[164:167], v[8:23]
    ds_read_b64_tr_b16 v[164:165], v2 offset:2048
    ds_read_b64_tr_b16 v[166:167], v3 offset:2048
    v_mfma_f32_32x32x16_bf16 v[40:55], v[104:107], v[24:27], v[40:55]
    s_waitcnt lgkmcnt(4)
    s_nop 0
    ds_read_b64_tr_b16 v[24:25], v2 offset:4096
    ds_read_b64_tr_b16 v[26:27], v3 offset:4096
    v_mfma_f32_32x32x16_bf16 v[40:55], v[108:111], v[28:31], v[40:55]
    ds_read_b64_tr_b16 v[28:29], v2 offset:6144
    ds_read_b64_tr_b16 v[30:31], v3 offset:6144
    v_mfma_f32_32x32x16_bf16 v[40:55], v[112:115], v[136:139], v[40:55]
    ds_read_b64_tr_b16 v[136:137], v2 offset:8192
    ds_read_b64_tr_b16 v[138:139], v3 offset:8192
    v_mfma_f32_32x32x16_bf16 v[40:55], v[116:119], v[140:143], v[40:55]
    ds_read_b32 v5, v0 offset:2024
    ds_read_b64_tr_b16 v[140:141], v2 offset:10240
    ds_read_b64_tr_b16 v[142:143], v3 offset:10240
    v_mfma_f32_32x32x16_bf16 v[40:55], v[120:123], v[144:147], v[40:55]
    ds_write_b32 v0, v38 offset:7060
    s_waitcnt lgkmcnt(4)
    s_nop 0
    ds_read_b64_tr_b16 v[144:145], v2 offset:12288
    ds_read_b64_tr_b16 v[146:147], v3 offset:12288
    v_mfma_f32_32x32x16_bf16 v[40:55], v[124:127], v[148:151], v[40:55]
    ds_read_b64_tr_b16 v[148:149], v2 offset:14336
    ds_read_b64_tr_b16 v[150:151], v3 offset:14336
    v_mfma_f32_32x32x16_bf16 v[40:55], v[128:131], v[152:155], v[40:55]
    ds_read_b64_tr_b16 v[152:153], v2 offset:32768
    ds_read_b64_tr_b16 v[154:155], v3 offset:32768
    v_mfma_f32_32x32x16_bf16 v[40:55], v[132:135], v[156:159], v[40:55]
    ds_read_b64_tr_b16 v[156:157], v2 offset:34816
    ds_read_b64_tr_b16 v[158:159], v3 offset:34816
    s_waitcnt lgkmcnt(4)
    v_mfma_f32_32x32x16_bf16 v[56:71], v[104:107], v[160:163], v[56:71]
    v_cmp_gt_u32_e64 vcc, 4, v5
    s_cbranch_vccnz L_C_pc
L_C_pc1:
    ds_read_b64_tr_b16 v[160:161], v2 offset:36864
    ds_read_b64_tr_b16 v[162:163], v3 offset:36864
    v_mfma_f32_32x32x16_bf16 v[56:71], v[108:111], v[164:167], v[56:71]
    ds_read_b64_tr_b16 v[164:165], v2 offset:38912
    ds_read_b64_tr_b16 v[166:167], v3 offset:38912
    v_mfma_f32_32x32x16_bf16 v[56:71], v[112:115], v[24:27], v[56:71]
    v_cvt_pk_bf16_f32 v88, v8, v40
    v_cvt_pk_bf16_f32 v89, v9, v41
    ds_read_b64_tr_b16 v[24:25], v2 offset:40960
    ds_read_b64_tr_b16 v[26:27], v3 offset:40960
    v_mfma_f32_32x32x16_bf16 v[56:71], v[116:119], v[28:31], v[56:71]
    v_cvt_pk_bf16_f32 v90, v10, v42
    v_cvt_pk_bf16_f32 v91, v11, v43
    ds_read_b64_tr_b16 v[28:29], v2 offset:43008
    ds_read_b64_tr_b16 v[30:31], v3 offset:43008
    v_mfma_f32_32x32x16_bf16 v[56:71], v[120:123], v[136:139], v[56:71]
    v_permlane16_swap_b32 v88, v89
    buffer_store_dwordx2 v[88:89], v36, s[40:43], s44 offen offset:0 sc1
    ds_read_b64_tr_b16 v[136:137], v2 offset:45056
    ds_read_b64_tr_b16 v[138:139], v3 offset:45056
    v_mfma_f32_32x32x16_bf16 v[56:71], v[124:127], v[140:143], v[56:71]
    v_cvt_pk_bf16_f32 v92, v12, v44
    v_cvt_pk_bf16_f32 v93, v13, v45
    s_waitcnt lgkmcnt(4)
    ds_read_b64_tr_b16 v[140:141], v2 offset:47104
    ds_read_b64_tr_b16 v[142:143], v3 offset:47104
    v_mfma_f32_32x32x16_bf16 v[56:71], v[128:131], v[144:147], v[56:71]
    v_permlane16_swap_b32 v90, v91
    buffer_store_dwordx2 v[90:91], v36, s[40:43], s45 offen offset:0 sc1
    v_mfma_f32_32x32x16_bf16 v[56:71], v[132:135], v[148:151], v[56:71]
    v_cvt_pk_bf16_f32 v94, v14, v46
    v_cvt_pk_bf16_f32 v95, v15, v47
    v_permlane16_swap_b32 v92, v93
    buffer_store_dwordx2 v[92:93], v36, s[40:43], s46 offen offset:0 sc1
    v_mfma_f32_32x32x16_bf16 v[72:87], v[104:107], v[152:155], v[72:87]
    v_cvt_pk_bf16_f32 v96, v16, v48
    v_cvt_pk_bf16_f32 v97, v17, v49
    v_permlane16_swap_b32 v94, v95
    buffer_store_dwordx2 v[94:95], v36, s[40:43], s47 offen offset:0 sc1
    v_mfma_f32_32x32x16_bf16 v[72:87], v[108:111], v[156:159], v[72:87]
L_pad_c_3:
    s_cbranch_execz L_pad_c_4
    v_cvt_pk_bf16_f32 v98, v18, v50
    v_cvt_pk_bf16_f32 v99, v19, v51
    v_permlane16_swap_b32 v96, v97
    buffer_store_dwordx2 v[96:97], v36, s[40:43], s48 offen offset:0 sc1
    v_mfma_f32_32x32x16_bf16 v[72:87], v[112:115], v[160:163], v[72:87]
    v_cvt_pk_bf16_f32 v100, v20, v52
    v_cvt_pk_bf16_f32 v101, v21, v53
    v_permlane16_swap_b32 v98, v99
    buffer_store_dwordx2 v[98:99], v36, s[40:43], s49 offen offset:0 sc1
    v_mfma_f32_32x32x16_bf16 v[72:87], v[116:119], v[164:167], v[72:87]
    v_cvt_pk_bf16_f32 v102, v22, v54
    v_cvt_pk_bf16_f32 v103, v23, v55
    v_permlane16_swap_b32 v100, v101
    buffer_store_dwordx2 v[100:101], v36, s[40:43], s50 offen offset:0 sc1
    v_mfma_f32_32x32x16_bf16 v[72:87], v[120:123], v[24:27], v[72:87]
    v_permlane16_swap_b32 v102, v103
    buffer_store_dwordx2 v[102:103], v36, s[40:43], s51 offen offset:0 sc1
    s_waitcnt lgkmcnt(4)
    v_mfma_f32_32x32x16_bf16 v[72:87], v[124:127], v[28:31], v[72:87]
    s_waitcnt lgkmcnt(2)
    v_mfma_f32_32x32x16_bf16 v[72:87], v[128:131], v[136:139], v[72:87]
    s_waitcnt lgkmcnt(0)
    v_mfma_f32_32x32x16_bf16 v[72:87], v[132:135], v[140:143], v[72:87]
    s_nop 11
    v_cvt_pk_bf16_f32 v104, v56, v72
    v_cvt_pk_bf16_f32 v105, v57, v73
    v_cvt_pk_bf16_f32 v106, v58, v74
    v_cvt_pk_bf16_f32 v107, v59, v75
    v_permlane16_swap_b32 v104, v105
    buffer_store_dwordx2 v[104:105], v36, s[40:43], s44 offen offset:128 sc1
    v_cvt_pk_bf16_f32 v108, v60, v76
    v_cvt_pk_bf16_f32 v109, v61, v77
    v_permlane16_swap_b32 v106, v107
    buffer_store_dwordx2 v[106:107], v36, s[40:43], s45 offen offset:128 sc1
    v_cvt_pk_bf16_f32 v110, v62, v78
    v_cvt_pk_bf16_f32 v111, v63, v79
    v_permlane16_swap_b32 v108, v109
    buffer_store_dwordx2 v[108:109], v36, s[40:43], s46 offen offset:128 sc1
    v_cvt_pk_bf16_f32 v112, v64, v80
    v_cvt_pk_bf16_f32 v113, v65, v81
    v_permlane16_swap_b32 v110, v111
    buffer_store_dwordx2 v[110:111], v36, s[40:43], s47 offen offset:128 sc1
    v_cvt_pk_bf16_f32 v114, v66, v82
    v_cvt_pk_bf16_f32 v115, v67, v83
    v_permlane16_swap_b32 v112, v113
    buffer_store_dwordx2 v[112:113], v36, s[40:43], s48 offen offset:128 sc1
    v_cvt_pk_bf16_f32 v116, v68, v84
    v_cvt_pk_bf16_f32 v117, v69, v85
    v_permlane16_swap_b32 v114, v115
    buffer_store_dwordx2 v[114:115], v36, s[40:43], s49 offen offset:128 sc1
    v_cvt_pk_bf16_f32 v118, v70, v86
    v_cvt_pk_bf16_f32 v119, v71, v87
    v_permlane16_swap_b32 v116, v117
    buffer_store_dwordx2 v[116:117], v36, s[40:43], s50 offen offset:128 sc1
    v_permlane16_swap_b32 v118, v119
    buffer_store_dwordx2 v[118:119], v36, s[40:43], s51 offen offset:128 sc1
    v_mov_b32 v5, 1
    s_mov_b64 exec, 1
    ds_add_u32 v0, v5 offset:1012
    s_mov_b64 exec, -1
    s_setprio 0
    s_cmp_ge_u32 s35, 28
    s_cbranch_scc1 L_end
    v_lshrrev_b32 v6, 4, v1
    v_and_b32 v3, 15, v1
    v_bfe_u32 v8, v1, 2, 2
    v_lshl_add_u32 v9, v6, 3, v8
    v_and_b32 v10, 1, v6
    v_lshl_or_b32 v8, v10, 2, v8
    v_lshlrev_b32 v8, 5, v8
    v_lshl_add_u32 v8, v9, 8, v8
    v_and_b32 v9, 3, v1
    v_lshl_add_u32 v8, v9, 3, v8
    s_lshl_b32 s38, s33, 14
    s_add_u32 s38, s38, 65536
    v_add_u32 v2, s38, v8
    v_bfe_u32 v8, v1, 3, 1
    v_mul_u32_u24 v8, 144, v8
    v_lshl_add_u32 v8, v6, 4, v8
    v_add_u32 v4, 144128, v8
    v_lshlrev_b32 v7, 17, v7
    v_lshl_add_u32 v7, v3, 4, v7
    s_lshl_b32 s49, s62, 5
    s_add_u32 s49, s49, s35
    s_lshl2_add_u32 s49, s49, s33
    s_lshl_b32 s49, s49, 8
    s_add_u32 s49, s49, 1310720
    s_mov_b32 s44, s20
    s_mov_b32 s45, s21
    s_mov_b32 s46, 1835008
    s_mov_b32 s47, 0x20000
L_w69:
    s_sleep 1
    ds_read_b32 v5, v0 offset:1012
    s_sub_u32 s3, s3, 1
    s_cbranch_scc1 L_end
    s_waitcnt lgkmcnt(0)
    v_cmp_gt_u32 vcc, 5, v5
    s_cbranch_vccnz L_w69

    v_lshlrev_b32 v12, 1, v6
    v_xor_b32 v12, v12, v3
    v_lshlrev_b32 v12, 4, v12
    v_lshl_add_u32 v12, v6, 10, v12
    v_xor_b32 v13, 0x80, v12
    s_lshl_b32 s58, s35, 16
    s_lshl_b32 s38, s33, 8
    s_add_u32 s58, s58, s38
    s_lshl_b32 s57, s33, 14
    s_add_u32 s57, s57, 65536
    s_mov_b32 s56, s62
    s_mov_b32 s59, 0
L_A_f2:
    s_xor_b32 s38, s59, s56
    s_lshl_b32 s39, s38, 12
    s_add_u32 s39, s39, s57
    s_lshl_b32 s38, s38, 14
    s_add_u32 s38, s38, s58
    s_add_u32 m0, s39, 0
    s_add_u32 s60, s38, 0
    buffer_load_dwordx4 v12, s[44:47], s60 offen lds
    s_waitcnt vmcnt(3)
    s_add_u32 m0, s39, 1024
    s_add_u32 s60, s38, 4096
    buffer_load_dwordx4 v12, s[44:47], s60 offen lds
    s_waitcnt vmcnt(3)
    s_add_u32 m0, s39, 2048
    s_add_u32 s60, s38, 8192
    buffer_load_dwordx4 v13, s[44:47], s60 offen lds
L_pad_c_4:
    s_cbranch_execz L_pad_c_r
    s_waitcnt vmcnt(3)
    s_add_u32 m0, s39, 3072
    s_add_u32 s60, s38, 12288
    buffer_load_dwordx4 v13, s[44:47], s60 offen lds
    s_waitcnt vmcnt(3)
    s_add_u32 s59, s59, 1
    s_cmp_lt_u32 s59, 4
    s_cbranch_scc1 L_A_f2
    v_mov_b32 v5, 1
    s_mov_b64 exec, 1
    ds_add_u32 v0, v5 offset:5044
    s_mov_b64 exec, -1
    s_waitcnt vmcnt(0)
    v_xor_b32 v5, 0, v2
    ds_read_b64_tr_b16 v[64:65], v5 offset:0
    ds_read_b64_tr_b16 v[66:67], v5 offset:1024
    ds_read_b64_tr_b16 v[96:97], v5 offset:8192
    ds_read_b64_tr_b16 v[98:99], v5 offset:9216
    v_xor_b32 v5, 32, v2
    ds_read_b64_tr_b16 v[68:69], v5 offset:0
    ds_read_b64_tr_b16 v[70:71], v5 offset:1024
    ds_read_b64_tr_b16 v[100:101], v5 offset:8192
    ds_read_b64_tr_b16 v[102:103], v5 offset:9216
    s_waitcnt lgkmcnt(4)
    v_xor_b32 v5, 64, v2
    ds_read_b64_tr_b16 v[72:73], v5 offset:0
    ds_read_b64_tr_b16 v[74:75], v5 offset:1024
    ds_read_b64_tr_b16 v[104:105], v5 offset:8192
    ds_read_b64_tr_b16 v[106:107], v5 offset:9216
    v_xor_b32 v5, 96, v2
    ds_read_b64_tr_b16 v[76:77], v5 offset:0
    ds_read_b64_tr_b16 v[78:79], v5 offset:1024
    ds_read_b64_tr_b16 v[108:109], v5 offset:8192
    ds_read_b64_tr_b16 v[110:111], v5 offset:9216
    s_waitcnt lgkmcnt(4)
    s_nop 0
    v_xor_b32 v5, 128, v2
    ds_read_b64_tr_b16 v[80:81], v5 offset:0
    ds_read_b64_tr_b16 v[82:83], v5 offset:1024
    ds_read_b64_tr_b16 v[112:113], v5 offset:8192
    ds_read_b64_tr_b16 v[114:115], v5 offset:9216
    v_xor_b32 v5, 160, v2
    ds_read_b64_tr_b16 v[84:85], v5 offset:0
    ds_read_b64_tr_b16 v[86:87], v5 offset:1024
    ds_read_b64_tr_b16 v[116:117], v5 offset:8192
    ds_read_b64_tr_b16 v[118:119], v5 offset:9216
    s_waitcnt lgkmcnt(4)
    s_nop 0
    v_xor_b32 v5, 192, v2
    ds_read_b64_tr_b16 v[88:89], v5 offset:0
    ds_read_b64_tr_b16 v[90:91], v5 offset:1024
    ds_read_b64_tr_b16 v[120:121], v5 offset:8192
    ds_read_b64_tr_b16 v[122:123], v5 offset:9216
    v_xor_b32 v5, 224, v2
    ds_read_b64_tr_b16 v[92:93], v5 offset:0
    ds_read_b64_tr_b16 v[94:95], v5 offset:1024
    ds_read_b64_tr_b16 v[124:125], v5 offset:8192
    ds_read_b64_tr_b16 v[126:127], v5 offset:9216
    s_waitcnt lgkmcnt(4)
L_w70:
    s_sleep 2
    ds_read_b32 v5, v0 offset:5052
    s_sub_u32 s3, s3, 1
    s_cbranch_scc1 L_end
    s_waitcnt lgkmcnt(0)
    v_cmp_gt_u32 vcc, 4, v5
    s_cbranch_vccnz L_w70
L_w71:
    ds_read_b32 v5, v0 offset:2016
    s_sub_u32 s3, s3, 1
    s_cbranch_scc1 L_end
    s_waitcnt lgkmcnt(0)
    v_cmp_gt_u32_e64 vcc, 4, v5
    s_cbranch_vccnz L_w71
    ds_read_b128 v[8:11], v4
    ds_read_b128 v[12:15], v4 offset:64
    s_waitcnt lgkmcnt(0)
    v_mfma_f32_16x16x32_bf16 v[32:35], v[8:11], v[64:67], 0
    v_mfma_f32_16x16x32_bf16 v[36:39], v[8:11], v[68:71], 0
    v_mfma_f32_16x16x32_bf16 v[32:35], v[12:15], v[96:99], v[32:35]
    v_mfma_f32_16x16x32_bf16 v[36:39], v[12:15], v[100:103], v[36:39]
    v_mfma_f32_16x16x32_bf16 v[40:43], v[8:11], v[72:75], 0
    v_mfma_f32_16x16x32_bf16 v[44:47], v[8:11], v[76:79], 0
    v_mfma_f32_16x16x32_bf16 v[40:43], v[12:15], v[104:107], v[40:43]
    v_mfma_f32_16x16x32_bf16 v[44:47], v[12:15], v[108:111], v[44:47]
    v_mfma_f32_16x16x32_bf16 v[48:51], v[8:11], v[80:83], 0
    v_mfma_f32_16x16x32_bf16 v[52:55], v[8:11], v[84:87], 0
    v_mfma_f32_16x16x32_bf16 v[48:51], v[12:15], v[112:115], v[48:51]
    v_mfma_f32_16x16x32_bf16 v[52:55], v[12:15], v[116:119], v[52:55]
    v_mfma_f32_16x16x32_bf16 v[56:59], v[8:11], v[88:91], 0
    v_mfma_f32_16x16x32_bf16 v[60:63], v[8:11], v[92:95], 0
    v_mfma_f32_16x16x32_bf16 v[56:59], v[12:15], v[120:123], v[56:59]
    v_mfma_f32_16x16x32_bf16 v[60:63], v[12:15], v[124:127], v[60:63]
    v_cvt_pk_bf16_f32 v28, v32, v36
    v_cvt_pk_bf16_f32 v29, v40, v44
    s_nop 1
    v_cvt_pk_bf16_f32 v30, v48, v52
    s_nop 2
    v_cvt_pk_bf16_f32 v31, v56, v60
    s_mov_b32 exec_lo, 0xffff
    s_mov_b32 exec_hi, 0xffff
    buffer_store_dwordx4 v[28:31], v7, s[40:43], s49 offen sc1
    s_branch L_end
L_C_pc:
L_w72:
    ds_read_b32 v5, v0 offset:2024
    s_sub_u32 s3, s3, 1
    s_cbranch_scc1 L_end
    s_waitcnt lgkmcnt(0)
    v_cmp_gt_u32 vcc, 4, v5
    s_cbranch_vccnz L_w72
    s_branch L_C_pc1
L_end:
L_exit:
    s_endpgm
L_codeend:
.section .rodata,"a"
.p2align 6
.amdhsa_kernel adaLN_cond__compressed_kv_cla__dense_activation_relu__decode_kernel
.amdhsa_next_free_vgpr 168
.amdhsa_next_free_sgpr 102
.amdhsa_accum_offset 168
.amdhsa_group_segment_fixed_size 0
.amdhsa_kernarg_size 112
.amdhsa_user_sgpr_count 2
.amdhsa_user_sgpr_kernarg_segment_ptr 1
.amdhsa_system_sgpr_workgroup_id_x 1
.amdhsa_float_denorm_mode_32 3
.end_amdhsa_kernel
.text
```

```asm
; @launch grid=(256,1,1) block=(768,1,1) lds=163840
.amdgcn_target "amdgcn-amd-amdhsa--gfx950"
.text
.globl adaLN_cond__compressed_kv_cla__dense_activation_relu__decode_kernel
.p2align 8
.type adaLN_cond__compressed_kv_cla__dense_activation_relu__decode_kernel,@function
adaLN_cond__compressed_kv_cla__dense_activation_relu__decode_kernel:

    s_cmpk_ge_u32 s2, 256
    s_cbranch_scc1 L_exit
    s_load_dwordx16 s[4:19], s[0:1], 0
    s_load_dwordx8 s[20:27], s[0:1], 64
    s_load_dwordx4 s[28:31], s[0:1], 96
    v_lshrrev_b32 v2, 6, v0
    v_and_b32 v1, 63, v0
    v_readfirstlane_b32 s32, v2

    s_lshr_b32 s37, s2, 3
    s_getpc_b64 s[52:53]
L_pc:
    s_mul_i32 s38, s37, 12
    s_add_u32 s38, s38, s32
    s_lshl_b32 s38, s38, 7
    s_min_u32 s38, s38, L_codeend-L_pc-4
    v_mov_b32 v2, s38
    global_load_dword v167, v2, s[52:53]
    s_and_b32 s36, s2, 7
    s_and_b32 s34, s37, 7
    s_lshr_b32 s37, s37, 3
    s_lshl3_add_u32 s35, s37, s36
    s_and_b32 s33, s32, 3
    s_cmp_lt_u32 s32, 4
    s_cbranch_scc1 L_pA
    s_cmp_lt_u32 s32, 8
    s_cbranch_scc1 L_pB
    s_cmp_eq_u32 s34, 0
    s_cbranch_scc1 L_Cs
    s_branch L_Co
L_pB:
    s_cmp_lt_u32 s34, 4
    s_cbranch_scc1 L_Bc
    s_branch L_Be
L_pA:
    s_lshr_b32 s38, s34, 2
    s_or_b32 s38, s38, s32
    s_cbranch_scc0 L_pT
    s_lshl3_add_u32 s38, s32, s34
    s_cmp_lg_u32 s38, 8
    s_cbranch_scc1 L_A
    v_lshlrev_b32 v2, 7, v1
    s_waitcnt lgkmcnt(0)
    global_load_dword v166, v2, s[22:23]
    global_load_dword v166, v2, s[4:5]
    s_branch L_A
L_pT:
    v_and_b32 v3, 1, v1
    v_lshrrev_b32 v2, 1, v1
    s_lshl2_add_u32 s38, s37, s34
    v_lshl_add_u32 v2, s38, 5, v2
    v_mul_u32_u24 v2, 6, v2
    v_add_u32 v2, v2, v3
    s_lshl_b32 s39, s36, 7
    v_lshl_add_u32 v2, v2, 10, s39
    s_waitcnt lgkmcnt(0)
    global_load_dword v166, v2, s[24:25]

L_A:
    v_mov_b32 v8, -1
    v_mov_b32 v9, -1
    v_mov_b32 v10, -1
    v_mov_b32 v11, -1
    v_lshlrev_b32 v14, 4, v1
    s_waitcnt lgkmcnt(0)

    s_mov_b32 s3, 0x400000
    v_mov_b32 v0, 156256
    s_and_b32 s62, s34, 3
    s_lshl2_add_u32 s97, s62, s37
    s_lshl4_add_u32 s61, s36, s97
    s_waitcnt lgkmcnt(0)

    s_mov_b32 s40, s30
    s_mov_b32 s41, s31
    s_mov_b32 s42, 16777216
    s_mov_b32 s43, 0x20000

    s_sub_u32 s98, s2, 40
    s_cmp_ge_u32 s98, 1
    s_cbranch_scc1 L_A_nx
    s_lshl2_add_u32 s38, s98, s33
    s_lshl_b32 s38, s38, 11
    buffer_store_dwordx4 v[8:11], v14, s[40:43], s38 offen offset:0 sc1
    buffer_store_dwordx4 v[8:11], v14, s[40:43], s38 offen offset:1024 sc1
L_A_nx:
    s_cmp_lg_u32 s34, 0
    s_cbranch_scc1 L_A_nc
    s_lshl2_add_u32 s55, s36, s37
    s_lshl2_add_u32 s38, s55, s33
    s_lshl_b32 s38, s38, 11
    s_add_u32 s38, s38, 65536
    buffer_store_dwordx4 v[8:11], v14, s[40:43], s38 offen offset:0 sc1
    buffer_store_dwordx4 v[8:11], v14, s[40:43], s38 offen offset:1024 sc1
L_A_nc:
    s_cmp_lg_u32 s33, 3
    s_cbranch_scc1 L_noinit
    v_mul_u32_u24 v13, 1008, v1
    v_mov_b32 v4, 0
    v_add_u32 v13, v13, v0
    v_mov_b32 v5, v4
    v_mov_b32 v6, v4
    v_mov_b32 v7, v4
    v_add_u32 v12, v14, v0
    s_mov_b64 exec, 0xff
    ds_write_b128 v13, v[4:7]
    s_mov_b32 exec_lo, -1
    ds_write_b128 v12, v[8:11] offset:7072
    s_mov_b64 exec, -1
L_noinit:
    s_cmp_lt_u32 s34, 4
    s_cbranch_scc1 L_AD
    s_mov_b32 s44, s6
    s_mov_b32 s45, s7
    s_mov_b32 s46, 33554432
    s_mov_b32 s47, 0x20000

    v_lshrrev_b32 v4, 3, v1
    v_bfe_u32 v5, v4, 1, 1
    v_lshlrev_b32 v5, 2, v5
    v_bfe_u32 v6, v4, 2, 1
    v_or_b32 v5, v5, v6
    v_and_b32 v6, 7, v1
    v_xor_b32 v5, v5, v6
    v_lshlrev_b32 v5, 4, v5
    v_lshl_add_u32 v2, v4, 10, v5
    v_xor_b32 v3, 32, v2
    s_lshl_b32 s48, s61, 18
    s_lshl_b32 s38, s33, 15
    s_add_u32 s48, s48, s38
    s_lshl_b32 s49, s33, 12
    s_mov_b32 s50, 0
    s_waitcnt lgkmcnt(0)
    s_barrier

    s_cmp_ge_u32 s98, 1
    s_cbranch_scc1 L_A_go
    s_waitcnt vmcnt(0)
    v_mov_b32 v12, 1
    s_mov_b64 exec, 1
    ds_add_u32 v0, v12 offset:8
    s_mov_b64 exec, -1
    s_cmp_lg_u32 s33, 2
    s_cbranch_scc1 L_A_go
    s_lshl_b32 s38, s98, 2
    v_mov_b32 v13, s38
L_w1:
    ds_read_b32 v12, v0 offset:8
    s_sub_u32 s3, s3, 1
    s_cbranch_scc1 L_end
    s_waitcnt lgkmcnt(0)
    v_cmp_gt_u32 vcc, 4, v12
    s_cbranch_vccnz L_w1
    s_mov_b64 exec, 1
    global_store_dword v13, v8, s[28:29] offset:32 sc1
    s_mov_b64 exec, -1
L_A_go:
L_w2:
    s_sleep 1
    ds_read_b32 v8, v0 offset:4
    s_sub_u32 s3, s3, 1
    s_cbranch_scc1 L_end
    s_waitcnt lgkmcnt(0)
    v_cmp_gt_u32 vcc, 4, v8
    s_cbranch_vccnz L_w2
    s_setprio 2
    s_lshl_b32 s38, s33, 2
    v_add_u32 v4, s38, v0
    v_mov_b32 v5, v0
    s_mov_b32 s53, 2
L_A_dma:
    s_and_b32 s38, s50, 9
    s_cmp_lg_u32 s38, 8
    s_cbranch_scc1 L_A_dma1
L_w3:
    ds_read_b32 v8, v5 offset:3024
    s_sub_u32 s3, s3, 1
    s_cbranch_scc1 L_end
    s_waitcnt lgkmcnt(0)
    v_cmp_gt_u32 vcc, 8, v8
    s_cbranch_vccnz L_w3
    v_add_u32 v5, 4, v5
    s_cmp_lg_u32 s50, 8
    s_cbranch_scc1 L_A_dma1
    s_add_u32 s48, s48, 130048
    s_sub_u32 s49, s49, 131072
L_A_dma1:
    s_cmp_lg_u32 s50, 8
    s_cbranch_scc1 L_A_dma2
    v_mov_b32 v8, 7
    s_waitcnt vmcnt(4)
    ds_write_b32 v4, v8 offset:4032
    v_mov_b32 v7, 8
    s_waitcnt vmcnt(0)
    ds_write_b32 v4, v7 offset:4032
L_w4:
    ds_read_b32 v8, v0 offset:2028
    s_sub_u32 s3, s3, 1
    s_cbranch_scc1 L_end
    s_waitcnt lgkmcnt(0)
    v_cmp_gt_u32 vcc, 4, v8
    s_cbranch_vccnz L_w4
    s_mov_b32 s53, 10
L_A_dma2:
    s_cmp_lg_u32 s50, 9
    s_cbranch_scc1 L_A_dma3
L_w5:
    ds_read_b32 v8, v0 offset:1008
    s_sub_u32 s3, s3, 1
    s_cbranch_scc1 L_end
    s_waitcnt lgkmcnt(0)
    v_cmp_gt_u32 vcc, 4, v8
    s_cbranch_vccnz L_w5
L_A_dma3:
    s_add_u32 m0, s49, 0
    s_add_u32 s38, s48, 0
    buffer_load_dwordx4 v2, s[44:47], s38 offen nt lds
    s_waitcnt vmcnt(7)
    s_add_u32 m0, s49, 1024
    s_add_u32 s38, s48, 8192
    buffer_load_dwordx4 v3, s[44:47], s38 offen nt lds
    s_waitcnt vmcnt(7)
    s_add_u32 m0, s49, 2048
    s_add_u32 s38, s48, 16384
    buffer_load_dwordx4 v2, s[44:47], s38 offen nt lds
    s_waitcnt vmcnt(7)
    s_add_u32 m0, s49, 3072
    s_add_u32 s38, s48, 24576
    buffer_load_dwordx4 v3, s[44:47], s38 offen nt lds
    s_waitcnt vmcnt(7)
    s_add_u32 s49, s49, 16384
    s_add_u32 s48, s48, 128
    s_add_u32 s50, s50, 1
    s_max_u32 s38, s50, s53
    s_sub_u32 s38, s38, 2
    v_mov_b32 v6, s38
    ds_write_b32 v4, v6 offset:4032
    s_cmp_lt_u32 s50, 12
    s_cbranch_scc1 L_A_dma
L_w6:
    ds_read_b32 v8, v0 offset:3032
    s_sub_u32 s3, s3, 1
    s_cbranch_scc1 L_end
    s_waitcnt lgkmcnt(0)
    v_cmp_gt_u32_e64 vcc, 8, v8
    s_cbranch_vccnz L_w6
    s_add_u32 m0, s49, 0
    s_add_u32 s38, s48, 0
    buffer_load_dwordx4 v2, s[44:47], s38 offen nt lds
    s_add_u32 m0, s49, 1024
    s_add_u32 s38, s48, 8192
    buffer_load_dwordx4 v3, s[44:47], s38 offen nt lds
    s_add_u32 m0, s49, 2048
    s_add_u32 s38, s48, 16384
    buffer_load_dwordx4 v2, s[44:47], s38 offen nt lds
    v_mov_b32 v6, 12
    s_waitcnt vmcnt(3)
    ds_write_b32 v4, v6 offset:4032
    s_add_u32 m0, s49, 3072
    s_add_u32 s38, s48, 24576
    buffer_load_dwordx4 v3, s[44:47], s38 offen nt lds
    s_add_u32 m0, s49, 16384
    s_add_u32 s38, s48, 128
    buffer_load_dwordx4 v2, s[44:47], s38 offen nt lds
    s_add_u32 m0, s49, 17408
    s_add_u32 s38, s48, 8320
    buffer_load_dwordx4 v3, s[44:47], s38 offen nt lds
    s_add_u32 m0, s49, 18432
    s_add_u32 s38, s48, 16512
    buffer_load_dwordx4 v2, s[44:47], s38 offen nt lds
    v_mov_b32 v6, 13
    s_waitcnt vmcnt(3)
    ds_write_b32 v4, v6 offset:4032
    s_add_u32 m0, s49, 19456
    s_add_u32 s38, s48, 24704
    buffer_load_dwordx4 v3, s[44:47], s38 offen nt lds
L_w7:
    ds_read_b32 v8, v0 offset:3036
    s_sub_u32 s3, s3, 1
    s_cbranch_scc1 L_end
    s_waitcnt lgkmcnt(0)
    v_cmp_gt_u32_e64 vcc, 8, v8
    s_cbranch_vccnz L_w7
    s_add_u32 m0, s49, 32768
    s_add_u32 s38, s48, 256
    buffer_load_dwordx4 v2, s[44:47], s38 offen nt lds
    s_add_u32 m0, s49, 33792
    s_add_u32 s38, s48, 8448
    buffer_load_dwordx4 v3, s[44:47], s38 offen nt lds
    s_add_u32 m0, s49, 34816
    s_add_u32 s38, s48, 16640
    buffer_load_dwordx4 v2, s[44:47], s38 offen nt lds
    v_mov_b32 v6, 14
    s_waitcnt vmcnt(3)
    ds_write_b32 v4, v6 offset:4032
    s_add_u32 m0, s49, 35840
    s_add_u32 s38, s48, 24832
    buffer_load_dwordx4 v3, s[44:47], s38 offen nt lds
    s_add_u32 m0, s49, 49152
    s_add_u32 s38, s48, 384
    buffer_load_dwordx4 v2, s[44:47], s38 offen nt lds
    s_add_u32 m0, s49, 50176
    s_add_u32 s38, s48, 8576
    buffer_load_dwordx4 v3, s[44:47], s38 offen nt lds
    s_add_u32 m0, s49, 51200
    s_add_u32 s38, s48, 16768
    buffer_load_dwordx4 v2, s[44:47], s38 offen nt lds
    v_mov_b32 v6, 15
    s_waitcnt vmcnt(3)
    ds_write_b32 v4, v6 offset:4032
    s_add_u32 m0, s49, 52224
    s_add_u32 s38, s48, 24960
    buffer_load_dwordx4 v3, s[44:47], s38 offen nt lds
    v_mov_b32 v7, 16
    s_waitcnt vmcnt(0)
    ds_write_b32 v4, v7 offset:4032
    v_bfe_u32 v16, v1, 4, 1
    v_lshrrev_b32 v17, 5, v1
    v_lshl_add_u32 v16, v17, 2, v16
    v_lshlrev_b32 v16, 14, v16
    v_and_b32 v17, 15, v1
    v_lshl_add_u32 v16, v17, 4, v16
    s_lshl_b32 s55, s36, 19
    s_lshl2_add_u32 s38, s97, s33
    s_lshl_b32 s38, s38, 8
    s_add_u32 s55, s55, s38
    s_add_u32 s55, s55, 2097152
    v_mov_b32 v20, -1
    v_mov_b32 v21, -1
    v_mov_b32 v22, -1
    v_mov_b32 v23, -1
    s_add_u32 s38, s55, 0
    buffer_store_dwordx4 v[20:23], v16, s[40:43], s38 offen sc1
    s_add_u32 s38, s55, 32768
    buffer_store_dwordx4 v[20:23], v16, s[40:43], s38 offen sc1
    s_add_u32 s38, s55, 131072
    buffer_store_dwordx4 v[20:23], v16, s[40:43], s38 offen sc1
    s_add_u32 s38, s55, 163840
    buffer_store_dwordx4 v[20:23], v16, s[40:43], s38 offen sc1
    s_add_u32 s38, s55, 262144
    buffer_store_dwordx4 v[20:23], v16, s[40:43], s38 offen sc1
    s_add_u32 s38, s55, 294912
    buffer_store_dwordx4 v[20:23], v16, s[40:43], s38 offen sc1
    s_add_u32 s38, s55, 393216
    buffer_store_dwordx4 v[20:23], v16, s[40:43], s38 offen sc1
    s_add_u32 s38, s55, 425984
    buffer_store_dwordx4 v[20:23], v16, s[40:43], s38 offen sc1
    s_waitcnt vmcnt(0)
    v_mov_b32 v12, 1
    s_mov_b64 exec, 1
    ds_add_u32 v0, v12 offset:2024
    s_mov_b64 exec, -1
    s_setprio 0
    s_cmp_ge_u32 s35, 28
    s_cbranch_scc1 L_end

    v_and_b32 v9, 31, v1
    v_lshrrev_b32 v10, 5, v1
    v_and_b32 v3, 15, v1
    v_lshrrev_b32 v6, 4, v1
    v_and_b32 v16, 1, v1
    v_lshlrev_b32 v16, 4, v16
    s_mov_b32 s38, 0xffff
    v_lshlrev_b32 v16, v16, s38
    v_bfe_u32 v17, v1, 1, 2
    v_cmp_eq_u32 vcc, 0, v17
    s_nop 1
    v_cndmask_b32 v20, 0, v16, vcc
    v_cmp_eq_u32 vcc, 1, v17
    s_nop 1
    v_cndmask_b32 v21, 0, v16, vcc
    v_cmp_eq_u32 vcc, 2, v17
    s_nop 1
    v_cndmask_b32 v22, 0, v16, vcc
    v_cmp_eq_u32 vcc, 3, v17
    s_nop 1
    v_cndmask_b32 v23, 0, v16, vcc
L_w8:
    s_sleep 2
    ds_read_b32 v12, v0 offset:5044
    s_sub_u32 s3, s3, 1
    s_cbranch_scc1 L_end
    s_waitcnt lgkmcnt(0)
    v_cmp_gt_u32 vcc, 8, v12
    s_cbranch_vccnz L_w8
    s_branch L_A_F
L_AD:
    s_waitcnt lgkmcnt(0)
    s_barrier
    s_cmp_ge_u32 s98, 1
    s_cbranch_scc1 L_AD_nx
    s_waitcnt vmcnt(0)
    v_mov_b32 v12, 1
    s_mov_b64 exec, 1
    ds_add_u32 v0, v12 offset:8
    s_mov_b64 exec, -1
    s_cmp_lg_u32 s33, 2
    s_cbranch_scc1 L_AD_nx
    s_lshl_b32 s38, s98, 2
    v_mov_b32 v13, s38
L_w9:
    ds_read_b32 v12, v0 offset:8
    s_sub_u32 s3, s3, 1
    s_cbranch_scc1 L_end
    s_waitcnt lgkmcnt(0)
    v_cmp_gt_u32 vcc, 4, v12
    s_cbranch_vccnz L_w9
    s_mov_b64 exec, 1
    global_store_dword v13, v8, s[28:29] offset:32 sc1
    s_mov_b64 exec, -1
L_AD_nx:
    s_cmp_lg_u32 s34, 0
    s_cbranch_scc1 L_AD0
    s_waitcnt vmcnt(0)
    v_mov_b32 v8, 1
    s_mov_b64 exec, 1
    ds_add_u32 v0, v8 offset:2020
    s_mov_b64 exec, -1
    s_cmp_lg_u32 s33, 1
    s_cbranch_scc1 L_AD0
L_w10:
    s_sleep 1
    ds_read_b32 v8, v0 offset:7056
    s_sub_u32 s3, s3, 1
    s_cbranch_scc1 L_end
    s_waitcnt lgkmcnt(0)
    v_cmp_gt_u32 vcc, 4, v8
    s_cbranch_vccnz L_w10
    v_and_b32 v4, 0, v1
    v_lshlrev_b32 v4, 2, v4
L_fl11:
    global_load_dword v5, v4, s[28:29] offset:32 sc1
    s_sub_u32 s3, s3, 1
    s_cbranch_scc1 L_end
    s_waitcnt vmcnt(0)
    v_cmp_eq_u32 vcc, 0, v5
    s_cbranch_vccnz L_fl11
    v_mov_b32 v8, 1
    s_mov_b64 exec, 1
    ds_add_u32 v0, v8 offset:2020
    s_mov_b64 exec, -1
L_AD0:
    s_mov_b32 s44, s6
    s_mov_b32 s45, s7
    s_mov_b32 s46, 33554432
    s_mov_b32 s47, 0x20000
    v_lshlrev_b32 v4, 10, v1
    s_lshl_b32 s51, s61, 18
    s_and_b32 s38, s33, 1
    s_lshl_b32 s38, s38, 16
    s_add_u32 s51, s51, s38
    s_lshr_b32 s38, s33, 1
    s_lshl_b32 s38, s38, 7
    s_add_u32 s51, s51, s38
    s_add_u32 s51, s51, 131072
L_w12:
    s_sleep 1
    ds_read_b32 v8, v0 offset:5044
    s_sub_u32 s3, s3, 1
    s_cbranch_scc1 L_end
    s_waitcnt lgkmcnt(0)
    v_cmp_gt_u32 vcc, 3, v8
    s_cbranch_vccnz L_w12
    s_cmp_lg_u32 s34, 0
    s_cbranch_scc1 L_AD_k1
    s_add_u32 s38, s51, 917504
    buffer_load_dword v166, v4, s[44:47], s38 offen offset:768
    s_waitcnt vmcnt(1)
    s_add_u32 s38, s51, 1966080
    buffer_load_dword v166, v4, s[44:47], s38 offen offset:768
    s_waitcnt vmcnt(1)
    s_branch L_AD_k2
L_AD_k1:
L_AD_k2:
    s_sub_u32 s38, s51, 131072
    buffer_load_dword v166, v4, s[44:47], s38 offen offset:768
    s_waitcnt vmcnt(1)
L_AD_k3:
    buffer_load_dword v166, v4, s[44:47], s51 offen offset:256
    s_waitcnt vmcnt(1)
    buffer_load_dword v166, v4, s[44:47], s51 offen offset:512
    s_waitcnt vmcnt(1)
    buffer_load_dword v166, v4, s[44:47], s51 offen offset:768
    v_mov_b32 v8, 1
    s_mov_b64 exec, 1
    ds_add_u32 v0, v8 offset:5048
    s_mov_b64 exec, -1
L_AD1:
    v_and_b32 v9, 31, v1
    v_lshrrev_b32 v10, 5, v1
    v_and_b32 v3, 15, v1
    v_lshrrev_b32 v6, 4, v1
    v_lshlrev_b32 v7, 12, v6
    v_lshl_add_u32 v7, v3, 4, v7
    v_and_b32 v5, 1, v6
    v_lshlrev_b32 v5, 6, v5
    v_add_lshl_u32 v5, v5, v3, 10
    s_lshl_b32 s38, s62, 8
    s_lshl_b32 s50, s33, 11
    s_lshl4_add_u32 s50, s36, s50
    s_add_u32 s50, s50, s37
    s_lshl_b32 s50, s50, 3
    s_add_u32 s50, s50, 1048576
    s_lshl_b32 s51, s33, 5
    s_add_u32 s51, s51, s35
    s_lshl_b32 s51, s51, 14
    s_add_u32 s51, s51, s38
    s_add_u32 s51, s51, 2097152
    s_add_u32 s52, s51, 2097152
    s_lshl_b32 s38, s33, 8
    s_add_u32 s38, s38, 139776
    v_lshl_add_u32 v24, v1, 2, s38
    v_bfe_u32 v16, v1, 3, 1
    v_lshlrev_b32 v16, 7, v16
    v_lshl_add_u32 v16, v6, 4, v16
    v_add_u32 v25, s38, v16
    v_bfe_u32 v16, v1, 4, 1
    v_lshlrev_b32 v16, 4, v16
    v_lshl_add_u32 v16, v3, 5, v16
    v_lshl_add_u32 v16, v10, 3, v16
    s_mul_i32 s38, s33, 1056
    s_add_u32 s38, s38, 141312
    v_add_u32 v26, s38, v16
    v_add_u32 v27, 4224, v26
    v_and_b32 v16, 1, v1
    v_lshlrev_b32 v16, 4, v16
    s_mov_b32 s38, 0xffff
    v_lshlrev_b32 v16, v16, s38
    v_bfe_u32 v17, v1, 1, 2
    v_cmp_eq_u32 vcc, 0, v17
    s_nop 1
    v_cndmask_b32 v20, 0, v16, vcc
    v_cmp_eq_u32 vcc, 1, v17
    s_nop 1
    v_cndmask_b32 v21, 0, v16, vcc
    v_cmp_eq_u32 vcc, 2, v17
    s_nop 1
    v_cndmask_b32 v22, 0, v16, vcc
    v_cmp_eq_u32 vcc, 3, v17
    s_nop 1
    v_cndmask_b32 v23, 0, v16, vcc
L_w13:
    s_sleep 1
    ds_read_b32 v12, v0 offset:5052
    s_sub_u32 s3, s3, 1
    s_cbranch_scc1 L_end
    s_waitcnt lgkmcnt(0)
    v_cmp_gt_u32 vcc, 1, v12
    s_cbranch_vccnz L_w13
L_w14:
    s_sleep 1
    ds_read_b32 v12, v0 offset:6060
    s_sub_u32 s3, s3, 1
    s_cbranch_scc1 L_end
    s_waitcnt lgkmcnt(0)
    v_cmp_gt_u32 vcc, 7, v12
    s_cbranch_vccnz L_w14
L_A_st1:
    buffer_load_dwordx2 v[12:13], v5, s[40:43], s50 offen sc1
    s_sub_u32 s3, s3, 1
    s_cbranch_scc1 L_end
    s_waitcnt vmcnt(0)
    v_max_u32 v14, v12, v13
    v_cmp_eq_u32_e64 vcc, -1, v14
    s_cbranch_vccz L_A_st3
    s_mov_b64 exec, vcc
    s_sleep 4
    s_branch L_A_st1
L_A_st3:
    s_mov_b64 exec, -1
    buffer_load_dwordx4 v[32:35], v7, s[40:43], s51 offen offset:0 sc1
    buffer_load_dwordx4 v[36:39], v7, s[40:43], s51 offen offset:1024 sc1
    buffer_load_dwordx4 v[40:43], v7, s[40:43], s51 offen offset:2048 sc1
    buffer_load_dwordx4 v[44:47], v7, s[40:43], s51 offen offset:3072 sc1
    buffer_load_dwordx4 v[48:51], v7, s[40:43], s52 offen offset:0 sc1
    buffer_load_dwordx4 v[52:55], v7, s[40:43], s52 offen offset:1024 sc1
    buffer_load_dwordx4 v[56:59], v7, s[40:43], s52 offen offset:2048 sc1
    buffer_load_dwordx4 v[60:63], v7, s[40:43], s52 offen offset:3072 sc1
    v_mov_b32 v14, v12
    s_nop 1
    v_max_f32_dpp v14, v14, v14 quad_perm:[1,0,3,2] row_mask:0xf bank_mask:0xf
    s_nop 1
    v_max_f32_dpp v14, v14, v14 quad_perm:[2,3,0,1] row_mask:0xf bank_mask:0xf
    s_nop 1
    v_max_f32_dpp v14, v14, v14 row_half_mirror row_mask:0xf bank_mask:0xf
    s_nop 1
    v_max_f32_dpp v14, v14, v14 row_mirror row_mask:0xf bank_mask:0xf
    v_sub_f32 v12, v12, v14
    v_exp_f32 v12, v12
    s_nop 0
    v_mul_f32 v14, v12, v13
    s_nop 1
    v_add_f32_dpp v14, v14, v14 quad_perm:[1,0,3,2] row_mask:0xf bank_mask:0xf
    s_nop 1
    v_add_f32_dpp v14, v14, v14 quad_perm:[2,3,0,1] row_mask:0xf bank_mask:0xf
    s_nop 1
    v_add_f32_dpp v14, v14, v14 row_half_mirror row_mask:0xf bank_mask:0xf
    s_nop 1
    v_add_f32_dpp v14, v14, v14 row_mirror row_mask:0xf bank_mask:0xf
    v_rcp_f32 v14, v14
    v_cmp_gt_u32 vcc, 32, v1
    v_mul_f32 v12, v12, v14
    v_cvt_pk_bf16_f32 v13, v12, v12
    v_and_b32 v14, 0xffff0000, v13
    v_sub_f32 v12, v12, v14
    v_cvt_pk_bf16_f32 v12, v12, v12
    v_cndmask_b32 v12, v12, v13, vcc
    ds_write_b32 v24, v12
    ds_read_b128 v[12:15], v25
    ds_read_b128 v[16:19], v25 offset:64
    s_waitcnt lgkmcnt(0)
    v_and_b32 v64, v12, v20
    v_and_b32 v65, v12, v21
    v_and_b32 v66, v12, v22
    v_and_b32 v67, v12, v23
    v_and_b32 v68, v13, v20
    v_and_b32 v69, v13, v21
    v_and_b32 v70, v13, v22
    v_and_b32 v71, v13, v23
    v_and_b32 v72, v14, v20
    v_and_b32 v73, v14, v21
    v_and_b32 v74, v14, v22
    v_and_b32 v75, v14, v23
    v_and_b32 v76, v15, v20
    v_and_b32 v77, v15, v21
    v_and_b32 v78, v15, v22
    v_and_b32 v79, v15, v23
    v_and_b32 v80, v16, v20
    v_and_b32 v81, v16, v21
    v_and_b32 v82, v16, v22
    v_and_b32 v83, v16, v23
    v_and_b32 v84, v17, v20
    v_and_b32 v85, v17, v21
    v_and_b32 v86, v17, v22
    v_and_b32 v87, v17, v23
    v_and_b32 v88, v18, v20
    v_and_b32 v89, v18, v21
    v_and_b32 v90, v18, v22
    v_and_b32 v91, v18, v23
    v_and_b32 v92, v19, v20
    v_and_b32 v93, v19, v21
    v_and_b32 v94, v19, v22
    v_and_b32 v95, v19, v23
    s_waitcnt vmcnt(4)
L_h3_c0:
    v_mfma_f32_16x16x32_bf16 v[28:31], v[64:67], v[32:35], 0
    v_mfma_f32_16x16x32_bf16 v[28:31], v[68:71], v[36:39], v[28:31]
    v_mfma_f32_16x16x32_bf16 v[28:31], v[72:75], v[40:43], v[28:31]
    v_mfma_f32_16x16x32_bf16 v[28:31], v[76:79], v[44:47], v[28:31]
    v_max3_u32 v12, v32, v33, v34
    v_max3_u32 v12, v12, v35, v36
    v_max3_u32 v12, v12, v37, v38
    v_max3_u32 v12, v12, v39, v40
    v_max3_u32 v12, v12, v41, v42
    v_max3_u32 v12, v12, v43, v44
    v_max3_u32 v12, v12, v45, v46
    v_max_u32 v12, v12, v47
    v_cmp_eq_u32 vcc, -1, v12
    s_cbranch_vccnz L_h3_r0
    s_waitcnt vmcnt(0)
L_h3_c1:
    v_mfma_f32_16x16x32_bf16 v[96:99], v[80:83], v[48:51], 0
    v_mfma_f32_16x16x32_bf16 v[96:99], v[84:87], v[52:55], v[96:99]
    v_mfma_f32_16x16x32_bf16 v[96:99], v[88:91], v[56:59], v[96:99]
    v_mfma_f32_16x16x32_bf16 v[96:99], v[92:95], v[60:63], v[96:99]
    v_max3_u32 v12, v48, v49, v50
    v_max3_u32 v12, v12, v51, v52
    v_max3_u32 v12, v12, v53, v54
    v_max3_u32 v12, v12, v55, v56
    v_max3_u32 v12, v12, v57, v58
    v_max3_u32 v12, v12, v59, v60
    v_max3_u32 v12, v12, v61, v62
    v_max_u32 v12, v12, v63
    v_cmp_eq_u32 vcc, -1, v12
    s_cbranch_vccnz L_h3_r1
    v_permlane32_swap_b32 v28, v30
    v_permlane32_swap_b32 v29, v31
    v_add_f32 v28, v28, v30
    v_add_f32_e64 v29, v29, v31
    v_cvt_pk_bf16_f32 v12, v28, 0
    v_cvt_pk_bf16_f32 v13, v29, 0
    v_cvt_pk_bf16_f32 v14, 0, v28
    v_cvt_pk_bf16_f32 v15, 0, v29
    ds_write2_b64 v26, v[12:13], v[14:15] offset0:0 offset1:66
    v_permlane32_swap_b32 v96, v98
    v_permlane32_swap_b32 v97, v99
    v_add_f32 v96, v96, v98
    v_add_f32 v97, v97, v99
    v_cvt_pk_bf16_f32 v16, v96, 0
    v_cvt_pk_bf16_f32 v17, v97, 0
    v_cvt_pk_bf16_f32 v18, 0, v96
    v_cvt_pk_bf16_f32 v19, 0, v97
    ds_write2_b64 v27, v[16:17], v[18:19] offset0:0 offset1:66
    v_mov_b32 v28, 1
    s_mov_b64 exec, 1
    ds_add_u32 v0, v28 offset:6048
    s_mov_b64 exec, -1
    s_and_b32 s38, s35, 27
    s_cmp_lg_u32 s38, s33
    s_cbranch_scc1 L_end
    s_waitcnt lgkmcnt(0)
L_A_F:
    s_mov_b32 s44, s4
    s_mov_b32 s45, s5
    s_mov_b32 s46, 8192
    s_mov_b32 s47, 0x20000

    v_bfe_u32 v17, v1, 3, 1
    v_cmp_eq_u32 vcc, v17, v10
    v_mov_b32 v12, 0x3f803f80
    s_nop 0
    v_cndmask_b32 v12, 0, v12, vcc
    v_and_b32 v20, v12, v20
    v_and_b32 v21, v12, v21
    v_and_b32 v22, v12, v22
    v_and_b32 v23, v12, v23
    v_and_b32 v12, 1, v6
    v_lshlrev_b32 v13, 3, v12
    v_lshl_add_u32 v13, v3, 4, v13
    v_lshl_add_u32 v16, v10, 12, v13
    s_lshl_b32 s38, s62, 10
    s_lshl_b32 s39, s33, 8
    s_add_u32 s48, s38, s39
    buffer_load_dwordx2 v[128:129], v16, s[44:47], s48 offen
    s_cmp_lt_u32 s34, 4
    s_cselect_b32 s50, 65536, 0

    s_add_u32 s49, s48, 1179648
    buffer_load_dwordx2 v[96:97], v16, s[40:43], s49 offen sc1
    s_add_u32 s49, s49, 8192
    buffer_load_dwordx2 v[98:99], v16, s[40:43], s49 offen sc1
    s_add_u32 s49, s49, 8192
    buffer_load_dwordx2 v[100:101], v16, s[40:43], s49 offen sc1
    s_add_u32 s49, s49, 8192
    buffer_load_dwordx2 v[102:103], v16, s[40:43], s49 offen sc1
    s_add_u32 s49, s49, 8192
    s_add_u32 s49, s49, s50
    s_nop 0
    buffer_load_dwordx2 v[104:105], v16, s[40:43], s49 offen sc1
    s_add_u32 s49, s49, 8192
    buffer_load_dwordx2 v[106:107], v16, s[40:43], s49 offen sc1
    s_add_u32 s49, s49, 8192
    buffer_load_dwordx2 v[108:109], v16, s[40:43], s49 offen sc1
    s_add_u32 s49, s49, 8192
    buffer_load_dwordx2 v[110:111], v16, s[40:43], s49 offen sc1
    s_add_u32 s49, s49, 8192
    s_sub_u32 s49, s49, s50
    s_nop 0
    buffer_load_dwordx2 v[112:113], v16, s[40:43], s49 offen sc1
    s_add_u32 s49, s49, 8192
    buffer_load_dwordx2 v[114:115], v16, s[40:43], s49 offen sc1
    s_add_u32 s49, s49, 8192
    buffer_load_dwordx2 v[116:117], v16, s[40:43], s49 offen sc1
    s_add_u32 s49, s49, 8192
    buffer_load_dwordx2 v[118:119], v16, s[40:43], s49 offen sc1
    s_add_u32 s49, s49, 8192

    s_lshl_b32 s53, s62, 15
    s_add_u32 s53, s53, s39
    s_add_u32 s56, s53, 1572864
    s_add_u32 s53, s53, 1310720
    s_and_b32 s38, s35, 8
    s_lshl_b32 s38, s38, 9
    s_add_u32 s56, s56, s38
    s_xor_b32 s57, s56, 4096
    s_xor_b32 s58, s56, 8192
    s_xor_b32 s59, s56, 12288
    v_lshlrev_b32 v5, 17, v10
    v_lshl_add_u32 v5, v3, 4, v5
    v_lshl_add_u32 v7, v12, 13, v5
    s_add_u32 s38, s39, 131072
    v_mul_u32_u24 v24, 2176, v10
    v_add3_u32 v25, v24, v13, s38
    s_lshl_b32 s38, s33, 2
    s_add_u32 s38, s38, 149504
    v_lshl_add_u32 v26, v6, 4, s38
    v_add_u32 v24, v24, v25
    v_add_u32 v24, 4352, v24
    v_add_u32 v27, 2176, v24
    s_and_b32 s60, s36, 0
    s_lshl2_add_u32 s60, s60, s33
    s_lshl_b32 s60, s60, 12
    s_add_u32 s60, s60, 983040
    v_and_b32 v13, 3, v1
    v_lshlrev_b32 v13, 10, v13
    s_xor_b32 s38, s36, 0
    s_lshl_b32 s38, s38, 7
    v_add_u32_e64 v13, s38, v13
    s_mov_b32 s51, 15
    buffer_load_dword v18, v13, s[40:43], s60 offen sc1
    s_branch L_A_md1
L_A_md:
    s_sleep 4
    s_add_u32 s49, s48, 1179648
    buffer_load_dwordx2 v[96:97], v16, s[40:43], s49 offen sc1
    s_add_u32 s49, s49, 8192
    buffer_load_dwordx2 v[98:99], v16, s[40:43], s49 offen sc1
    s_add_u32 s49, s49, 8192
    buffer_load_dwordx2 v[100:101], v16, s[40:43], s49 offen sc1
    s_add_u32 s49, s49, 8192
    buffer_load_dwordx2 v[102:103], v16, s[40:43], s49 offen sc1
    s_add_u32 s49, s49, 8192
    s_add_u32 s49, s49, s50
    s_nop 0
    buffer_load_dwordx2 v[104:105], v16, s[40:43], s49 offen sc1
    s_add_u32 s49, s49, 8192
    buffer_load_dwordx2 v[106:107], v16, s[40:43], s49 offen sc1
    s_add_u32 s49, s49, 8192
    buffer_load_dwordx2 v[108:109], v16, s[40:43], s49 offen sc1
    s_add_u32 s49, s49, 8192
    buffer_load_dwordx2 v[110:111], v16, s[40:43], s49 offen sc1
    s_add_u32 s49, s49, 8192
    s_sub_u32 s49, s49, s50
    s_nop 0
    buffer_load_dwordx2 v[112:113], v16, s[40:43], s49 offen sc1
    s_add_u32 s49, s49, 8192
    buffer_load_dwordx2 v[114:115], v16, s[40:43], s49 offen sc1
    s_add_u32 s49, s49, 8192
    buffer_load_dwordx2 v[116:117], v16, s[40:43], s49 offen sc1
    s_add_u32 s49, s49, 8192
    buffer_load_dwordx2 v[118:119], v16, s[40:43], s49 offen sc1
    s_add_u32 s49, s49, 8192
    s_sub_u32 s3, s3, 1
    s_cbranch_scc1 L_end
L_A_md1:
    s_waitcnt vmcnt(0)
    s_nop 0
    v_max3_u32 v15, v96, v97, v98
    v_max3_u32 v15, v15, v99, v100
    v_max3_u32 v15, v15, v101, v102
    v_max3_u32 v15, v15, v103, v104
    v_max3_u32 v15, v15, v105, v106
    v_max3_u32 v15, v15, v107, v108
    v_max3_u32 v15, v15, v109, v110
    v_max3_u32 v15, v15, v111, v112
    v_max3_u32 v15, v15, v113, v114
    v_max3_u32 v15, v15, v115, v116
    v_max3_u32 v15, v15, v117, v118
    v_max_u32 v15, v15, v119
    v_cmp_eq_u32 vcc, -1, v15
    s_cbranch_vccnz L_A_md
    s_mov_b32 s52, 1
    v_cmp_eq_u32 vcc, -1, v18
    s_cbranch_vccz L_A_h4s
    s_mov_b32 s52, 0
    v_lshlrev_b32 v140, 16, v128
    v_and_b32 v141, 0xffff0000, v128
    v_lshlrev_b32 v142, 16, v129
    v_and_b32 v143, 0xffff0000, v129
    v_lshlrev_b32 v152, 16, v112
    v_and_b32 v153, 0xffff0000, v112
    v_lshlrev_b32 v154, 16, v113
    v_and_b32 v155, 0xffff0000, v113
    v_lshlrev_b32 v14, 16, v114
    v_and_b32 v15, 0xffff0000, v114
    v_pk_add_f32 v[152:153], v[152:153], v[14:15]
    v_lshlrev_b32 v14, 16, v115
    v_and_b32 v15, 0xffff0000, v115
    v_pk_add_f32 v[154:155], v[154:155], v[14:15]
    v_lshlrev_b32 v14, 16, v116
    v_and_b32 v15, 0xffff0000, v116
    v_pk_add_f32 v[152:153], v[152:153], v[14:15]
    v_lshlrev_b32 v14, 16, v117
    v_and_b32 v15, 0xffff0000, v117
    v_pk_add_f32 v[154:155], v[154:155], v[14:15]
    v_lshlrev_b32 v14, 16, v118
    v_and_b32 v15, 0xffff0000, v118
    v_pk_add_f32 v[152:153], v[152:153], v[14:15]
    v_lshlrev_b32 v14, 16, v119
    v_and_b32 v15, 0xffff0000, v119
    v_pk_add_f32 v[154:155], v[154:155], v[14:15]
    v_lshlrev_b32 v148, 16, v104
    v_and_b32 v149, 0xffff0000, v104
    v_lshlrev_b32 v150, 16, v105
    v_and_b32 v151, 0xffff0000, v105
    v_lshlrev_b32 v14, 16, v106
    v_and_b32 v15, 0xffff0000, v106
    v_pk_add_f32 v[148:149], v[148:149], v[14:15]
    v_lshlrev_b32 v14, 16, v107
    v_and_b32 v15, 0xffff0000, v107
    v_pk_add_f32 v[150:151], v[150:151], v[14:15]
    v_lshlrev_b32 v14, 16, v108
    v_and_b32 v15, 0xffff0000, v108
    v_pk_add_f32 v[148:149], v[148:149], v[14:15]
    v_lshlrev_b32 v14, 16, v109
    v_and_b32 v15, 0xffff0000, v109
    v_pk_add_f32 v[150:151], v[150:151], v[14:15]
    v_lshlrev_b32 v14, 16, v110
    v_and_b32 v15, 0xffff0000, v110
    v_pk_add_f32 v[148:149], v[148:149], v[14:15]
    v_lshlrev_b32 v14, 16, v111
    v_and_b32 v15, 0xffff0000, v111
    v_pk_add_f32 v[150:151], v[150:151], v[14:15]
    v_add_f32 v152, 1.0, v152
    v_add_f32 v153, 1.0, v153
    v_add_f32 v154, 1.0, v154
    v_add_f32 v155, 1.0, v155
    s_cmp_lt_u32 s34, 4
    s_cbranch_scc1 L_nk15
    v_cvt_pk_bf16_f32 v120, v152, v153
    v_cvt_pk_bf16_f32 v121, v154, v155
    v_lshlrev_b32 v124, 16, v120
    v_and_b32 v125, 0xffff0000, v120
    v_lshlrev_b32_e64 v126, 16, v121
    v_and_b32 v127, 0xffff0000, v121
    v_pk_add_f32 v[124:125], v[152:153], v[124:125] neg_lo:[0,1] neg_hi:[0,1]
    v_pk_add_f32 v[126:127], v[154:155], v[126:127] neg_lo:[0,1] neg_hi:[0,1]
    v_cvt_pk_bf16_f32 v122, v124, v125
    v_cvt_pk_bf16_f32 v123, v126, v127
    ds_write2_b64 v24, v[120:121], v[122:123] offset0:0 offset1:136
    v_cvt_pk_bf16_f32 v130, v148, v149
    v_cvt_pk_bf16_f32 v131, v150, v151
    v_lshlrev_b32 v134, 16, v130
    v_and_b32 v135, 0xffff0000, v130
    v_lshlrev_b32 v136, 16, v131
    v_and_b32 v137, 0xffff0000, v131
    v_pk_add_f32 v[134:135], v[148:149], v[134:135] neg_lo:[0,1] neg_hi:[0,1]
    v_pk_add_f32 v[136:137], v[150:151], v[136:137] neg_lo:[0,1] neg_hi:[0,1]
    v_cvt_pk_bf16_f32 v132, v134, v135
    v_cvt_pk_bf16_f32 v133, v136, v137
    ds_write2_b64 v27, v[130:131], v[132:133] offset0:0 offset1:136
    v_mov_b32 v14, 1
    s_mov_b64 exec, 1
    ds_add_u32 v0, v14 offset:5048
    s_mov_b64 exec, -1
L_nk15:
    v_lshlrev_b32 v144, 16, v96
    v_and_b32 v145, 0xffff0000, v96
    v_lshlrev_b32 v146, 16, v97
    v_and_b32 v147, 0xffff0000, v97
    v_lshlrev_b32 v14, 16, v98
    v_and_b32 v15, 0xffff0000, v98
    v_pk_add_f32 v[144:145], v[144:145], v[14:15]
    v_lshlrev_b32 v14, 16, v99
    v_and_b32 v15, 0xffff0000, v99
    v_pk_add_f32 v[146:147], v[146:147], v[14:15]
    v_lshlrev_b32 v14, 16, v100
    v_and_b32 v15, 0xffff0000, v100
    v_pk_add_f32 v[144:145], v[144:145], v[14:15]
    v_lshlrev_b32 v14, 16, v101
    v_and_b32 v15, 0xffff0000, v101
    v_pk_add_f32 v[146:147], v[146:147], v[14:15]
    v_lshlrev_b32 v14, 16, v102
    v_and_b32 v15, 0xffff0000, v102
    v_pk_add_f32 v[144:145], v[144:145], v[14:15]
    v_lshlrev_b32_e64 v14, 16, v103
    v_and_b32 v15, 0xffff0000, v103
    v_pk_add_f32 v[146:147], v[146:147], v[14:15]
    v_pk_mul_f32 v[156:157], v[144:145], v[152:153]
    v_pk_mul_f32 v[152:153], v[140:141], v[152:153]
    v_pk_mul_f32 v[158:159], v[146:147], v[154:155]
    v_pk_mul_f32 v[154:155], v[142:143], v[154:155]
    s_mov_b32 exec_lo, s51
    s_mov_b32 exec_hi, 0
L_A_hint1:
    buffer_load_dword v12, v13, s[40:43], s60 offen sc1
    s_sub_u32 s3, s3, 1
    s_cbranch_scc1 L_end
    s_waitcnt vmcnt(0)
    v_cmp_eq_u32_e64 vcc, -1, v12
    s_mov_b64 exec, vcc
    s_cbranch_vccnz L_A_hint1
    s_mov_b64 exec, -1
L_A_h4s:
    buffer_load_dwordx4 v[32:35], v7, s[40:43], s56 offen offset:0 sc1
    buffer_load_dwordx4 v[36:39], v7, s[40:43], s56 offen offset:1024 sc1
    buffer_load_dwordx4 v[40:43], v7, s[40:43], s56 offen offset:2048 sc1
    buffer_load_dwordx4 v[44:47], v7, s[40:43], s56 offen offset:3072 sc1
    buffer_load_dwordx4 v[48:51], v7, s[40:43], s57 offen offset:0 sc1
    buffer_load_dwordx4 v[52:55], v7, s[40:43], s57 offen offset:1024 sc1
    buffer_load_dwordx4 v[56:59], v7, s[40:43], s57 offen offset:2048 sc1
    buffer_load_dwordx4 v[60:63], v7, s[40:43], s57 offen offset:3072 sc1
    s_cmp_eq_u32 s52, 0
    s_cbranch_scc1 L_A_mu
    v_lshlrev_b32 v140, 16, v128
    v_and_b32 v141, 0xffff0000, v128
    v_lshlrev_b32 v142, 16, v129
    v_and_b32 v143, 0xffff0000, v129
    v_lshlrev_b32 v152, 16, v112
    v_and_b32 v153, 0xffff0000, v112
    v_lshlrev_b32 v154, 16, v113
    v_and_b32 v155, 0xffff0000, v113
    v_lshlrev_b32 v14, 16, v114
    v_and_b32 v15, 0xffff0000, v114
    v_pk_add_f32 v[152:153], v[152:153], v[14:15]
    v_lshlrev_b32 v14, 16, v115
    v_and_b32 v15, 0xffff0000, v115
    v_pk_add_f32 v[154:155], v[154:155], v[14:15]
    v_lshlrev_b32 v14, 16, v116
    v_and_b32 v15, 0xffff0000, v116
    v_pk_add_f32 v[152:153], v[152:153], v[14:15]
    v_lshlrev_b32 v14, 16, v117
    v_and_b32 v15, 0xffff0000, v117
    v_pk_add_f32 v[154:155], v[154:155], v[14:15]
    v_lshlrev_b32 v14, 16, v118
    v_and_b32 v15, 0xffff0000, v118
    v_pk_add_f32 v[152:153], v[152:153], v[14:15]
    v_lshlrev_b32 v14, 16, v119
    v_and_b32 v15, 0xffff0000, v119
    v_pk_add_f32 v[154:155], v[154:155], v[14:15]
    v_lshlrev_b32 v148, 16, v104
    v_and_b32 v149, 0xffff0000, v104
    v_lshlrev_b32 v150, 16, v105
    v_and_b32 v151, 0xffff0000, v105
    v_lshlrev_b32 v14, 16, v106
    v_and_b32 v15, 0xffff0000, v106
    v_pk_add_f32 v[148:149], v[148:149], v[14:15]
    v_lshlrev_b32 v14, 16, v107
    v_and_b32 v15, 0xffff0000, v107
    v_pk_add_f32 v[150:151], v[150:151], v[14:15]
    v_lshlrev_b32 v14, 16, v108
    v_and_b32 v15, 0xffff0000, v108
    v_pk_add_f32 v[148:149], v[148:149], v[14:15]
    v_lshlrev_b32 v14, 16, v109
    v_and_b32 v15, 0xffff0000, v109
    v_pk_add_f32 v[150:151], v[150:151], v[14:15]
    v_lshlrev_b32 v14, 16, v110
    v_and_b32 v15, 0xffff0000, v110
    v_pk_add_f32 v[148:149], v[148:149], v[14:15]
    v_lshlrev_b32 v14, 16, v111
    v_and_b32 v15, 0xffff0000, v111
    v_pk_add_f32 v[150:151], v[150:151], v[14:15]
    v_add_f32 v152, 1.0, v152
    v_add_f32 v153, 1.0, v153
    v_add_f32 v154, 1.0, v154
    v_add_f32 v155, 1.0, v155
    s_cmp_lt_u32 s34, 4
    s_cbranch_scc1 L_nk16
    v_cvt_pk_bf16_f32 v120, v152, v153
    v_cvt_pk_bf16_f32 v121, v154, v155
    v_lshlrev_b32 v124, 16, v120
    v_and_b32 v125, 0xffff0000, v120
    v_lshlrev_b32 v126, 16, v121
    v_and_b32 v127, 0xffff0000, v121
    v_pk_add_f32 v[124:125], v[152:153], v[124:125] neg_lo:[0,1] neg_hi:[0,1]
    v_pk_add_f32 v[126:127], v[154:155], v[126:127] neg_lo:[0,1] neg_hi:[0,1]
    v_cvt_pk_bf16_f32 v122, v124, v125
    v_cvt_pk_bf16_f32 v123, v126, v127
    ds_write2_b64 v24, v[120:121], v[122:123] offset0:0 offset1:136
    v_cvt_pk_bf16_f32 v130, v148, v149
    v_cvt_pk_bf16_f32 v131, v150, v151
    v_lshlrev_b32 v134, 16, v130
    v_and_b32 v135, 0xffff0000, v130
    v_lshlrev_b32 v136, 16, v131
    v_and_b32 v137, 0xffff0000, v131
    v_pk_add_f32 v[134:135], v[148:149], v[134:135] neg_lo:[0,1] neg_hi:[0,1]
    v_pk_add_f32 v[136:137], v[150:151], v[136:137] neg_lo:[0,1] neg_hi:[0,1]
    v_cvt_pk_bf16_f32 v132, v134, v135
    v_cvt_pk_bf16_f32 v133, v136, v137
    ds_write2_b64 v27, v[130:131], v[132:133] offset0:0 offset1:136
    v_mov_b32 v14, 1
    s_mov_b64 exec, 1
    ds_add_u32 v0, v14 offset:5048
    s_mov_b64 exec, -1
L_nk16:
    v_lshlrev_b32 v144, 16, v96
    v_and_b32 v145, 0xffff0000, v96
    v_lshlrev_b32 v146, 16, v97
    v_and_b32 v147, 0xffff0000, v97
    v_lshlrev_b32 v14, 16, v98
    v_and_b32 v15, 0xffff0000, v98
    v_pk_add_f32 v[144:145], v[144:145], v[14:15]
    v_lshlrev_b32 v14, 16, v99
    v_and_b32 v15, 0xffff0000, v99
    v_pk_add_f32 v[146:147], v[146:147], v[14:15]
    v_lshlrev_b32 v14, 16, v100
    v_and_b32 v15, 0xffff0000, v100
    v_pk_add_f32 v[144:145], v[144:145], v[14:15]
    v_lshlrev_b32 v14, 16, v101
    v_and_b32 v15, 0xffff0000, v101
    v_pk_add_f32 v[146:147], v[146:147], v[14:15]
    v_lshlrev_b32 v14, 16, v102
    v_and_b32 v15, 0xffff0000, v102
    v_pk_add_f32 v[144:145], v[144:145], v[14:15]
    v_lshlrev_b32_e64 v14, 16, v103
    v_and_b32 v15, 0xffff0000, v103
    v_pk_add_f32 v[146:147], v[146:147], v[14:15]
    v_pk_mul_f32 v[156:157], v[144:145], v[152:153]
    v_pk_mul_f32 v[152:153], v[140:141], v[152:153]
    v_pk_mul_f32 v[158:159], v[146:147], v[154:155]
    v_pk_mul_f32 v[154:155], v[142:143], v[154:155]
L_A_mu:
    v_mov_b32 v28, 0
    v_mov_b32 v29, 0
    v_mov_b32 v30, 0
    v_mov_b32 v31, 0
    s_mov_b32 s63, 0
    s_waitcnt vmcnt(6)
    v_max3_u32 v12, v32, v33, v34
    v_max3_u32 v12, v12, v35, v36
    v_max3_u32 v12, v12, v37, v38
    v_max_u32 v12, v12, v39
    v_cmp_eq_u32 vcc, -1, v12
    s_cbranch_vccnz L_h4_f0
    v_mfma_f32_16x16x32_bf16 v[28:31], v[20:23], v[32:35], v[28:31]
    v_mfma_f32_16x16x32_bf16 v[28:31], v[20:23], v[36:39], v[28:31]
L_h4_n0:
    s_waitcnt vmcnt(4)
    v_max3_u32 v12, v40, v41, v42
    v_max3_u32 v12, v12, v43, v44
    v_max3_u32 v12, v12, v45, v46
    v_max_u32 v12, v12, v47
    v_cmp_eq_u32 vcc, -1, v12
    s_cbranch_vccnz L_h4_f2
    v_mfma_f32_16x16x32_bf16 v[28:31], v[20:23], v[40:43], v[28:31]
    v_mfma_f32_16x16x32_bf16 v[28:31], v[20:23], v[44:47], v[28:31]
L_h4_n2:
    s_waitcnt vmcnt(2)
    v_max3_u32 v12, v48, v49, v50
    v_max3_u32 v12, v12, v51, v52
    v_max3_u32 v12, v12, v53, v54
    v_max_u32 v12, v12, v55
    v_cmp_eq_u32 vcc, -1, v12
    s_cbranch_vccnz L_h4_f4
    v_mfma_f32_16x16x32_bf16 v[28:31], v[20:23], v[48:51], v[28:31]
    v_mfma_f32_16x16x32_bf16 v[28:31], v[20:23], v[52:55], v[28:31]
L_h4_n4:
    s_waitcnt vmcnt(0)
    v_max3_u32 v12, v56, v57, v58
    v_max3_u32 v12, v12, v59, v60
    v_max3_u32 v12, v12, v61, v62
    v_max_u32 v12, v12, v63
    v_cmp_eq_u32 vcc, -1, v12
    s_cbranch_vccnz L_h4_f6
    v_mfma_f32_16x16x32_bf16 v[28:31], v[20:23], v[56:59], v[28:31]
    v_mfma_f32_16x16x32_bf16 v[28:31], v[20:23], v[60:63], v[28:31]
L_h4_n6:
    s_cmp_lg_u32 s63, 0
    s_cbranch_scc1 L_h4_r
L_h4_d:
    s_cmp_lt_u32 s34, 4
    s_cbranch_scc1 L_A_fin
    v_mov_b32 v14, 1
    s_nop 2
    v_pk_fma_f32 v[152:153], v[28:29], v[156:157], v[152:153]
    v_pk_fma_f32 v[154:155], v[30:31], v[158:159], v[154:155]
    v_cvt_pk_bf16_f32 v32, v152, v153
    v_cvt_pk_bf16_f32 v33, v154, v155
    v_lshlrev_b32 v36, 16, v32
    v_and_b32 v37, 0xffff0000, v32
    v_lshlrev_b32_e64 v38, 16, v33
    v_and_b32 v39, 0xffff0000, v33
    v_pk_add_f32 v[36:37], v[152:153], v[36:37] neg_lo:[0,1] neg_hi:[0,1]
    v_pk_add_f32 v[38:39], v[154:155], v[38:39] neg_lo:[0,1] neg_hi:[0,1]
    v_cvt_pk_bf16_f32 v34, v36, v37
    v_cvt_pk_bf16_f32 v35, v38, v39
    ds_write2_b64 v25, v[32:33], v[34:35] offset0:0 offset1:136
    s_mov_b64 exec, 1
    ds_add_u32 v0, v14 offset:5052
    s_mov_b64 exec, -1
    v_pk_fma_f32 v[28:29], v[28:29], v[144:145], v[140:141]
    v_pk_fma_f32 v[30:31], v[30:31], v[146:147], v[142:143]

    v_add_f32 v12, v28, v29
    v_mul_f32 v13, v28, v28
    v_add_f32 v14, v30, v31
    v_fmac_f32 v13, v29, v29
    v_add_f32 v12, v12, v14
    v_fmac_f32 v13, v30, v30
    v_fmac_f32 v13, v31, v31
    s_nop 1
    v_permlane16_swap_b32 v12, v13
    v_add_f32 v12, v12, v13
    s_nop 1
    v_add_f32_dpp v12, v12, v12 quad_perm:[1,0,3,2] row_mask:0xf bank_mask:0xf
    s_nop 1
    v_add_f32_dpp v12, v12, v12 quad_perm:[2,3,0,1] row_mask:0xf bank_mask:0xf
    s_nop 1
    v_add_f32_dpp v12, v12, v12 row_half_mirror row_mask:0xf bank_mask:0xf
    s_nop 1
    v_add_f32_dpp v12, v12, v12 row_mirror row_mask:0xf bank_mask:0xf
    ds_write_b32 v26, v12
    s_branch L_end
L_A_fin:
    s_nop 3
    v_pk_fma_f32 v[28:29], v[28:29], v[144:145], v[140:141]
    v_pk_fma_f32 v[30:31], v[30:31], v[146:147], v[142:143]
    s_mov_b32 s44, s26
    s_mov_b32 s45, s27
    s_mov_b32 s46, 8192
    s_mov_b32 s47, 0x20000

    v_and_b32 v12, 7, v1
    v_lshlrev_b32 v13, 1, v12
    v_lshrrev_b32 v14, 1, v6
    v_add_u32 v13, v13, v14
    v_and_b32 v14, 1, v6
    v_lshl_add_u32 v13, v14, 4, v13

    v_and_b32 v18, 1, v1
    v_lshlrev_b32 v18, 4, v18
    s_mov_b32 s38, 0xffff
    v_lshlrev_b32 v18, v18, s38
    v_bfe_u32 v19, v1, 1, 2
    v_cmp_eq_u32 vcc, 0, v19
    s_nop 1
    v_cndmask_b32 v20, 0, v18, vcc
    v_cmp_eq_u32 vcc, 1, v19
    s_nop 1
    v_cndmask_b32 v21, 0, v18, vcc
    v_cmp_eq_u32 vcc, 2, v19
    s_nop 1
    v_cndmask_b32 v22, 0, v18, vcc
    v_cmp_eq_u32 vcc, 3, v19
    s_nop 1
    v_cndmask_b32 v23, 0, v18, vcc
    s_mov_b32 s38, 0x3f803f80
    v_and_b32 v20, s38, v20
    v_and_b32 v21, s38, v21
    v_and_b32 v22, s38, v22
    v_and_b32 v23, s38, v23
    s_lshr_b32 s38, s35, 2
    v_mov_b32 v17, s38
    v_lshl_add_u32 v13, v17, 5, v13
    v_lshlrev_b32 v13, 2, v13
    ds_bpermute_b32 v140, v13, v28
    ds_bpermute_b32 v144, v13, v148
    ds_bpermute_b32 v141, v13, v29
    ds_bpermute_b32 v145, v13, v149
    ds_bpermute_b32 v142, v13, v30
    ds_bpermute_b32 v146, v13, v150
    ds_bpermute_b32 v143, v13, v31
    ds_bpermute_b32 v147, v13, v151

    v_lshlrev_b32_e64 v4, 5, v12
    v_lshl_add_u32 v4, v6, 3, v4
    v_lshl_add_u32 v4, v17, 12, v4
    v_mul_u32_u24 v7, 7168, v6
    v_lshl_add_u32 v7, v3, 4, v7
    v_lshl_add_u32 v7, v17, 17, v7
    s_mov_b32 s56, s53
    s_add_u32 s57, s53, 4096
    s_add_u32 s58, s53, 8192
    s_add_u32 s59, s53, 12288
    s_waitcnt lgkmcnt(0)
L_h5:
    buffer_load_dwordx4 v[32:35], v7, s[40:43], s56 offen offset:0 sc1
    buffer_load_dwordx4 v[36:39], v7, s[40:43], s56 offen offset:1024 sc1
    buffer_load_dwordx4 v[40:43], v7, s[40:43], s56 offen offset:2048 sc1
    buffer_load_dwordx4 v[44:47], v7, s[40:43], s56 offen offset:3072 sc1
    buffer_load_dwordx4 v[48:51], v7, s[40:43], s57 offen offset:0 sc1
    buffer_load_dwordx4 v[52:55], v7, s[40:43], s57 offen offset:1024 sc1
    buffer_load_dwordx4 v[56:59], v7, s[40:43], s57 offen offset:2048 sc1
    s_sub_u32 s3, s3, 1
    s_cbranch_scc1 L_end
    s_waitcnt vmcnt(6)
    v_mfma_f32_16x16x32_bf16 v[28:31], v[32:35], v[20:23], 0
    v_max3_u32 v12, v32, v33, v34
    v_max_u32 v12, v12, v35
    s_waitcnt vmcnt(5)
    v_mfma_f32_16x16x32_bf16 v[28:31], v[36:39], v[20:23], v[28:31]
    v_max3_u32 v12, v12, v36, v37
    v_max3_u32 v12, v12, v38, v39
    s_waitcnt vmcnt(4)
    v_mfma_f32_16x16x32_bf16 v[28:31], v[40:43], v[20:23], v[28:31]
    v_max3_u32 v12, v12, v40, v41
    v_max3_u32 v12, v12, v42, v43
    s_waitcnt vmcnt(3)
    v_mfma_f32_16x16x32_bf16 v[28:31], v[44:47], v[20:23], v[28:31]
    v_max3_u32 v12, v12, v44, v45
    v_max3_u32 v12, v12, v46, v47
    s_waitcnt vmcnt(2)
    v_mfma_f32_16x16x32_bf16 v[28:31], v[48:51], v[20:23], v[28:31]
    v_max3_u32 v12, v12, v48, v49
    v_max3_u32 v12, v12, v50, v51
    s_waitcnt vmcnt(1)
    v_mfma_f32_16x16x32_bf16 v[28:31], v[52:55], v[20:23], v[28:31]
    v_max3_u32 v12, v12, v52, v53
    v_max3_u32 v12, v12, v54, v55
    s_waitcnt vmcnt(0)
    v_mfma_f32_16x16x32_bf16 v[28:31], v[56:59], v[20:23], v[28:31]
    v_max3_u32 v12, v12, v56, v57
    v_max3_u32 v12, v12, v58, v59
    v_cmp_eq_u32_e64 vcc, -1, v12
    s_cbranch_vccnz L_h5
    s_mov_b32 exec_lo, 0x00ff00ff
    s_mov_b32 exec_hi, 0x00ff00ff
    s_nop 1
    v_fma_f32 v28, v28, v144, v140
    v_fma_f32 v29, v29, v145, v141
    v_fma_f32 v30, v30, v146, v142
    v_fma_f32 v31, v31, v147, v143
    v_cvt_pk_bf16_f32 v28, v28, v29
    v_cvt_pk_bf16_f32 v29, v30, v31
    buffer_store_dwordx2 v[28:29], v4, s[44:47], s48 offen
    s_branch L_end
L_h4_f0:
    buffer_load_dwordx4 v[32:35], v7, s[40:43], s56 offen offset:0 sc1
    buffer_load_dwordx4 v[36:39], v7, s[40:43], s56 offen offset:1024 sc1
    s_mov_b64 exec, -1
    s_bitset1_b32 s63, 0
    s_branch L_h4_n0
L_h4_f2:
    buffer_load_dwordx4 v[40:43], v7, s[40:43], s56 offen offset:2048 sc1
    buffer_load_dwordx4 v[44:47], v7, s[40:43], s56 offen offset:3072 sc1
    s_mov_b64 exec, -1
    s_bitset1_b32 s63, 2
    s_branch L_h4_n2
L_h4_f4:
    buffer_load_dwordx4 v[48:51], v7, s[40:43], s57 offen offset:0 sc1
    buffer_load_dwordx4 v[52:55], v7, s[40:43], s57 offen offset:1024 sc1
    s_mov_b64 exec, -1
    s_bitset1_b32 s63, 4
    s_branch L_h4_n4
L_h4_f6:
    buffer_load_dwordx4 v[56:59], v7, s[40:43], s57 offen offset:2048 sc1
    buffer_load_dwordx4 v[60:63], v7, s[40:43], s57 offen offset:3072 sc1
    s_mov_b64 exec, -1
    s_bitset1_b32 s63, 6
    s_branch L_h4_n6
L_h4_r:
    s_sub_u32 s3, s3, 1
    s_cbranch_scc1 L_end
    s_waitcnt vmcnt(0)
    s_bitcmp1_b32 s63, 0
    s_cbranch_scc0 L_h4_s0
    v_max3_u32 v12, v32, v33, v34
    v_max3_u32 v12, v12, v35, v36
    v_max3_u32 v12, v12, v37, v38
    v_max_u32 v12, v12, v39
    v_cmp_eq_u32 vcc, -1, v12
    s_cbranch_vccz L_h4_g0
    buffer_load_dwordx4 v[32:35], v7, s[40:43], s56 offen offset:0 sc1
    buffer_load_dwordx4 v[36:39], v7, s[40:43], s56 offen offset:1024 sc1
    s_mov_b64 exec, -1
    s_branch L_h4_s0
L_h4_g0:
    s_bitset0_b32 s63, 0
    v_mfma_f32_16x16x32_bf16 v[28:31], v[20:23], v[32:35], v[28:31]
    v_mfma_f32_16x16x32_bf16 v[28:31], v[20:23], v[36:39], v[28:31]
L_h4_s0:
    s_bitcmp1_b32 s63, 2
    s_cbranch_scc0 L_h4_s2
    v_max3_u32 v12, v40, v41, v42
    v_max3_u32 v12, v12, v43, v44
    v_max3_u32 v12, v12, v45, v46
    v_max_u32 v12, v12, v47
    v_cmp_eq_u32 vcc, -1, v12
    s_cbranch_vccz L_h4_g2
    buffer_load_dwordx4 v[40:43], v7, s[40:43], s56 offen offset:2048 sc1
    buffer_load_dwordx4 v[44:47], v7, s[40:43], s56 offen offset:3072 sc1
    s_mov_b64 exec, -1
    s_branch L_h4_s2
L_h4_g2:
    s_bitset0_b32 s63, 2
    v_mfma_f32_16x16x32_bf16 v[28:31], v[20:23], v[40:43], v[28:31]
    v_mfma_f32_16x16x32_bf16 v[28:31], v[20:23], v[44:47], v[28:31]
L_h4_s2:
    s_bitcmp1_b32 s63, 4
    s_cbranch_scc0 L_h4_s4
    v_max3_u32 v12, v48, v49, v50
    v_max3_u32 v12, v12, v51, v52
    v_max3_u32 v12, v12, v53, v54
    v_max_u32 v12, v12, v55
    v_cmp_eq_u32 vcc, -1, v12
    s_cbranch_vccz L_h4_g4
    buffer_load_dwordx4 v[48:51], v7, s[40:43], s57 offen offset:0 sc1
    buffer_load_dwordx4 v[52:55], v7, s[40:43], s57 offen offset:1024 sc1
    s_mov_b64 exec, -1
    s_branch L_h4_s4
L_h4_g4:
    s_bitset0_b32 s63, 4
    v_mfma_f32_16x16x32_bf16 v[28:31], v[20:23], v[48:51], v[28:31]
    v_mfma_f32_16x16x32_bf16 v[28:31], v[20:23], v[52:55], v[28:31]
L_h4_s4:
    s_bitcmp1_b32 s63, 6
    s_cbranch_scc0 L_h4_s6
    v_max3_u32 v12, v56, v57, v58
    v_max3_u32 v12, v12, v59, v60
    v_max3_u32 v12, v12, v61, v62
    v_max_u32 v12, v12, v63
    v_cmp_eq_u32_e64 vcc, -1, v12
    s_cbranch_vccz L_h4_g6
    buffer_load_dwordx4 v[56:59], v7, s[40:43], s57 offen offset:2048 sc1
    buffer_load_dwordx4 v[60:63], v7, s[40:43], s57 offen offset:3072 sc1
    s_mov_b64 exec, -1
    s_branch L_h4_s6
L_h4_g6:
    s_bitset0_b32 s63, 6
    v_mfma_f32_16x16x32_bf16 v[28:31], v[20:23], v[56:59], v[28:31]
    v_mfma_f32_16x16x32_bf16 v[28:31], v[20:23], v[60:63], v[28:31]
L_h4_s6:
    s_cmp_lg_u32 s63, 0
    s_cbranch_scc1 L_h4_r
    s_branch L_h4_d
L_h3_r0:
    buffer_load_dwordx4 v[32:35], v7, s[40:43], s51 offen offset:0 sc1
    buffer_load_dwordx4 v[36:39], v7, s[40:43], s51 offen offset:1024 sc1
    buffer_load_dwordx4 v[40:43], v7, s[40:43], s51 offen offset:2048 sc1
    buffer_load_dwordx4 v[44:47], v7, s[40:43], s51 offen offset:3072 sc1
    buffer_load_dwordx4 v[48:51], v7, s[40:43], s52 offen offset:0 sc1
    buffer_load_dwordx4 v[52:55], v7, s[40:43], s52 offen offset:1024 sc1
    buffer_load_dwordx4 v[56:59], v7, s[40:43], s52 offen offset:2048 sc1
    buffer_load_dwordx4 v[60:63], v7, s[40:43], s52 offen offset:3072 sc1
    s_sub_u32 s3, s3, 1
    s_cbranch_scc1 L_end
    s_waitcnt vmcnt(4)
    s_branch L_h3_c0
L_h3_r1:
    buffer_load_dwordx4 v[48:51], v7, s[40:43], s52 offen offset:0 sc1
    buffer_load_dwordx4 v[52:55], v7, s[40:43], s52 offen offset:1024 sc1
    buffer_load_dwordx4 v[56:59], v7, s[40:43], s52 offen offset:2048 sc1
    buffer_load_dwordx4 v[60:63], v7, s[40:43], s52 offen offset:3072 sc1
    s_sub_u32 s3, s3, 1
    s_cbranch_scc1 L_end
    s_waitcnt vmcnt(0)
    s_branch L_h3_c1
L_Bc:
    s_cmp_lg_u32 s34, 0
    s_cbranch_scc1 L_B_go
    s_lshl2_add_u32 s55, s36, s37

    v_lshrrev_b32 v2, 2, v1
    v_mul_u32_u24 v4, 6144, v2
    v_lshrrev_b32 v2, 5, v1
    v_bfe_u32 v5, v1, 1, 1
    v_xor_b32 v2, v2, v5
    v_lshl_add_u32 v4, v2, 10, v4
    v_and_b32 v2, 1, v1
    v_lshl_add_u32 v4, v2, 4, v4
    s_mul_i32 s58, s33, 786432
    s_lshl_b32 s39, s55, 5
    s_add_u32 s58, s58, s39
    s_lshl_b32 s59, s33, 13
    s_add_u32 m0, s59, 65536
    s_waitcnt lgkmcnt(0)
    s_mov_b32 s44, s24
    s_mov_b32 s45, s25
    s_mov_b32 s46, 3145728
    s_mov_b32 s47, 0x20000

    s_mov_b32 s3, 0x400000
    v_mov_b32 v0, 156256
    s_and_b32 s62, s34, 3
    s_lshl2_add_u32 s97, s62, s37
    s_lshl4_add_u32 s61, s36, s97
    s_waitcnt lgkmcnt(0)

    s_mov_b32 s40, s30
    s_mov_b32 s41, s31
    s_mov_b32 s42, 16777216
    s_mov_b32 s43, 0x20000
    s_barrier
    buffer_load_dwordx4 v4, s[44:47], s58 offen lds
    s_add_u32 m0, m0, 1024
    s_add_u32 s58, s58, 98304
    buffer_load_dwordx4 v4, s[44:47], s58 offen lds
    s_add_u32 m0, m0, 1024
    s_add_u32 s58, s58, 98304
    buffer_load_dwordx4 v4, s[44:47], s58 offen lds
    s_add_u32 m0, m0, 1024
    s_add_u32 s58, s58, 98304
    buffer_load_dwordx4 v4, s[44:47], s58 offen lds
    s_add_u32 m0, m0, 1024
    s_add_u32 s58, s58, 98304
    buffer_load_dwordx4 v4, s[44:47], s58 offen lds
    s_add_u32 m0, m0, 1024
    s_add_u32 s58, s58, 98304
    buffer_load_dwordx4 v4, s[44:47], s58 offen lds
    s_add_u32 m0, m0, 1024
    s_add_u32 s58, s58, 98304
    buffer_load_dwordx4 v4, s[44:47], s58 offen lds
    s_add_u32 m0, m0, 1024
    s_add_u32 s58, s58, 98304
    buffer_load_dwordx4 v4, s[44:47], s58 offen lds
    s_add_u32 m0, m0, 1024
    s_add_u32 s58, s58, 98304
    v_mov_b32 v6, 1
    s_mov_b64 exec, 1
    ds_add_u32 v0, v6 offset:7056
    s_mov_b64 exec, -1
    s_lshl_b32 s38, s33, 2
    v_add_u32 v5, s38, v0
    v_mov_b32 v7, 2
    s_waitcnt vmcnt(4)
    ds_write_b32 v5, v6 offset:4032
    s_waitcnt vmcnt(0)
    ds_write_b32 v5, v7 offset:4032
    s_branch L_B_t
L_B_go:
    s_lshl_b32 s48, s33, 20
    s_lshl_b32 s38, s35, 8
    s_add_u32 s48, s48, s38
    s_and_b32 s49, s34, 3
    v_lshrrev_b32 v4, 4, v1
    v_and_b32 v5, 15, v1
    v_lshlrev_b32 v2, 18, v4
    v_lshl_add_u32 v2, v5, 4, v2
    s_waitcnt lgkmcnt(0)
    s_mov_b32 s44, s8
    s_mov_b32 s45, s9
    s_mov_b32 s46, 4194304
    s_mov_b32 s47, 0x20000
    s_xor_b32 s38, s49, 0
    s_lshl_b32 s38, s38, 16
    s_add_u32 s38, s38, s48
    buffer_load_dwordx4 v[40:43], v2, s[44:47], s38 offen
    s_add_u32 s38, s38, 8192
    buffer_load_dwordx4 v[44:47], v2, s[44:47], s38 offen
    s_add_u32 s38, s38, 8192
    buffer_load_dwordx4 v[48:51], v2, s[44:47], s38 offen
    s_add_u32 s38, s38, 8192
    buffer_load_dwordx4 v[52:55], v2, s[44:47], s38 offen
    s_add_u32 s38, s38, 8192
    buffer_load_dwordx4 v[56:59], v2, s[44:47], s38 offen
    s_add_u32 s38, s38, 8192
    buffer_load_dwordx4 v[60:63], v2, s[44:47], s38 offen
    s_add_u32 s38, s38, 8192
    buffer_load_dwordx4 v[64:67], v2, s[44:47], s38 offen
    s_add_u32 s38, s38, 8192
    buffer_load_dwordx4 v[68:71], v2, s[44:47], s38 offen

    s_mov_b32 s3, 0x400000
    v_mov_b32 v0, 156256
    s_and_b32 s62, s34, 3
    s_lshl2_add_u32 s97, s62, s37
    s_lshl4_add_u32 s61, s36, s97
    s_waitcnt lgkmcnt(0)

    s_mov_b32 s40, s30
    s_mov_b32 s41, s31
    s_mov_b32 s42, 16777216
    s_mov_b32 s43, 0x20000
    s_barrier
    s_xor_b32 s38, s49, 1
    s_lshl_b32 s38, s38, 16
    s_add_u32 s38, s38, s48
    buffer_load_dwordx4 v[72:75], v2, s[44:47], s38 offen
    s_add_u32 s38, s38, 8192
    s_waitcnt vmcnt(6)
    buffer_load_dwordx4 v[76:79], v2, s[44:47], s38 offen
    s_add_u32 s38, s38, 8192
    s_waitcnt vmcnt(6)
    buffer_load_dwordx4 v[80:83], v2, s[44:47], s38 offen
    s_add_u32 s38, s38, 8192
    s_waitcnt vmcnt(6)
    buffer_load_dwordx4 v[84:87], v2, s[44:47], s38 offen
    s_add_u32 s38, s38, 8192
    s_waitcnt vmcnt(6)
    buffer_load_dwordx4 v[88:91], v2, s[44:47], s38 offen
    s_add_u32 s38, s38, 8192
    s_waitcnt vmcnt(6)
    buffer_load_dwordx4 v[92:95], v2, s[44:47], s38 offen
    s_add_u32 s38, s38, 8192
    s_waitcnt vmcnt(6)
    buffer_load_dwordx4 v[96:99], v2, s[44:47], s38 offen
    s_add_u32 s38, s38, 8192
    s_waitcnt vmcnt(6)
    buffer_load_dwordx4 v[100:103], v2, s[44:47], s38 offen
    s_waitcnt vmcnt(6)
    s_xor_b32 s38, s49, 2
    s_lshl_b32 s38, s38, 16
    s_add_u32 s38, s38, s48
    buffer_load_dwordx4 v[104:107], v2, s[44:47], s38 offen
    s_add_u32 s38, s38, 8192
    s_waitcnt vmcnt(6)
    buffer_load_dwordx4 v[108:111], v2, s[44:47], s38 offen
    s_add_u32 s38, s38, 8192
    s_waitcnt vmcnt(6)
    buffer_load_dwordx4 v[112:115], v2, s[44:47], s38 offen
    s_add_u32 s38, s38, 8192
    s_waitcnt vmcnt(6)
    buffer_load_dwordx4 v[116:119], v2, s[44:47], s38 offen
    s_add_u32 s38, s38, 8192
    s_waitcnt vmcnt(6)
    buffer_load_dwordx4 v[120:123], v2, s[44:47], s38 offen
    s_add_u32 s38, s38, 8192
    s_waitcnt vmcnt(6)
    buffer_load_dwordx4 v[124:127], v2, s[44:47], s38 offen
    s_add_u32 s38, s38, 8192
    s_waitcnt vmcnt(6)
    buffer_load_dwordx4 v[128:131], v2, s[44:47], s38 offen
    s_add_u32 s38, s38, 8192
    s_waitcnt vmcnt(6)
    buffer_load_dwordx4 v[132:135], v2, s[44:47], s38 offen
    s_waitcnt vmcnt(6)
    s_xor_b32 s38, s49, 3
    s_lshl_b32 s38, s38, 16
    s_add_u32 s38, s38, s48
    buffer_load_dwordx4 v[136:139], v2, s[44:47], s38 offen
    s_add_u32 s38, s38, 8192
    s_waitcnt vmcnt(6)
    buffer_load_dwordx4 v[140:143], v2, s[44:47], s38 offen
    s_add_u32 s38, s38, 8192
    s_waitcnt vmcnt(6)
    buffer_load_dwordx4 v[144:147], v2, s[44:47], s38 offen
    s_add_u32 s38, s38, 8192
    s_waitcnt vmcnt(6)
    buffer_load_dwordx4 v[148:151], v2, s[44:47], s38 offen
    s_add_u32 s38, s38, 8192
    s_waitcnt vmcnt(6)
    buffer_load_dwordx4 v[152:155], v2, s[44:47], s38 offen
    s_add_u32 s38, s38, 8192
    s_waitcnt vmcnt(6)
    buffer_load_dwordx4 v[156:159], v2, s[44:47], s38 offen
    s_add_u32 s38, s38, 8192
    s_waitcnt vmcnt(6)
    buffer_load_dwordx4 v[160:163], v2, s[44:47], s38 offen
    s_add_u32 s38, s38, 8192
    s_waitcnt vmcnt(6)
    buffer_load_dwordx4 v[164:167], v2, s[44:47], s38 offen
    s_waitcnt vmcnt(6)
    v_mov_b32 v6, 1
    s_mov_b64 exec, 1
    ds_add_u32 v0, v6 offset:0
    s_mov_b64 exec, -1

    v_lshrrev_b32 v5, 1, v5
    v_lshlrev_b32 v5, 4, v5
    v_lshl_add_u32 v7, v4, 9, v5
    s_and_b32 s38, s36, 0
    s_lshl2_add_u32 s38, s38, s33
    s_lshl_b32 s38, s38, 11
    s_xor_b32 s50, s49, 0
    s_lshl_b32 s50, s50, 7
    s_add_u32 s50, s50, s38
    s_xor_b32 s51, s49, 1
    s_lshl_b32 s51, s51, 7
    s_add_u32 s51, s51, s38
    s_xor_b32 s52, s49, 2
    s_lshl_b32 s52, s52, 7
    s_add_u32 s52, s52, s38
    s_xor_b32 s53, s49, 3
    s_lshl_b32 s53, s53, 7
    s_add_u32 s53, s53, s38

    v_and_b32 v4, 1, v1
    v_cmp_eq_u32 vcc, 1, v4
    v_mov_b32 v2, 0x0c0c0100
    v_mov_b32 v4, 0x01000c0c
    v_cndmask_b32 v2, v2, v4, vcc
    v_mov_b32 v3, 0x0c0c0302
    v_mov_b32 v4, 0x03020c0c
    v_cndmask_b32 v3, v3, v4, vcc

    v_and_b32 v6, 0, v1
    v_lshlrev_b32 v6, 2, v6
L_fl17:
    global_load_dword v4, v6, s[28:29] offset:32 sc1
    s_sub_u32 s3, s3, 1
    s_cbranch_scc1 L_end
    s_waitcnt vmcnt(0)
    v_cmp_eq_u32 vcc, 0, v4
    s_cbranch_vccnz L_fl17
    v_swap_b32 v41, v44
    v_swap_b32 v42, v48
    v_swap_b32 v43, v52
    v_swap_b32 v46, v49
    v_swap_b32 v47, v53
    v_swap_b32 v51, v54
    v_swap_b32 v57, v60
    v_swap_b32 v58, v64
    v_swap_b32 v59, v68
    v_swap_b32 v62, v65
    v_swap_b32 v63, v69
    v_swap_b32 v67, v70
    v_swap_b32 v73, v76
    v_swap_b32 v74, v80
    v_swap_b32 v75, v84
    v_swap_b32 v78, v81
    v_swap_b32 v79, v85
    v_swap_b32 v83, v86
    v_swap_b32 v89, v92
    v_swap_b32 v90, v96
    v_swap_b32 v91, v100
    v_swap_b32 v94, v97
    v_swap_b32 v95, v101
    v_swap_b32 v99, v102
    v_swap_b32 v105, v108
    v_swap_b32 v106, v112
    v_swap_b32 v107, v116
    v_swap_b32 v110, v113
    v_swap_b32 v111, v117
    v_swap_b32 v115, v118
    v_swap_b32 v121, v124
    v_swap_b32 v122, v128
    v_swap_b32 v123, v132
    v_swap_b32 v126, v129
    v_swap_b32 v127, v133
    v_swap_b32 v131, v134
    v_swap_b32 v137, v140
    v_swap_b32 v138, v144
    v_swap_b32 v139, v148
    v_swap_b32 v142, v145
    v_swap_b32 v143, v149
    v_swap_b32 v147, v150
    v_swap_b32 v153, v156
    v_swap_b32 v154, v160
    v_swap_b32 v155, v164
    v_swap_b32 v158, v161
    v_swap_b32 v159, v165
    v_swap_b32 v163, v166
L_w18:
    ds_read_b32 v24, v0 offset:7068
    s_sub_u32 s3, s3, 1
    s_cbranch_scc1 L_end
    s_waitcnt lgkmcnt(0)
    v_cmp_gt_u32_e64 vcc, 2, v24
    s_cbranch_vccnz L_w18
L_B_h0:
    buffer_load_dwordx4 v[8:11], v7, s[40:43], s50 offen sc1
    buffer_load_dwordx4 v[12:15], v7, s[40:43], s51 offen sc1
    buffer_load_dwordx4 v[16:19], v7, s[40:43], s52 offen sc1
    buffer_load_dwordx4 v[20:23], v7, s[40:43], s53 offen sc1
    s_sub_u32 s3, s3, 1
    s_cbranch_scc1 L_end
L_B_h1:
    s_waitcnt vmcnt(0)
    v_max3_u32 v24, v8, v9, v10
    v_max3_u32 v24, v24, v11, v12
    v_max3_u32 v24, v24, v13, v14
    v_max3_u32 v24, v24, v15, v16
    v_max3_u32 v24, v24, v17, v18
    v_max3_u32 v24, v24, v19, v20
    v_max3_u32 v24, v24, v21, v22
    v_max_u32 v24, v24, v23
    v_cmp_eq_u32 vcc, -1, v24
    s_cbranch_vccnz L_B_h0
    s_setprio 3
    v_mov_b32 v24, 1
    s_mov_b64 exec, 1
    ds_add_u32 v0, v24 offset:4
    s_mov_b64 exec, -1
    v_perm_b32 v4, v8, v8, v2
    v_perm_b32 v5, v8, v8, v3
    v_perm_b32 v6, v9, v9, v2
    v_perm_b32 v7, v9, v9, v3
    s_nop 1
    v_mfma_f32_16x16x32_bf16 v[24:27], v[40:43], v[4:7], 0
    v_perm_b32 v40, v10, v10, v2
    v_perm_b32 v41, v10, v10, v3
    v_mfma_f32_16x16x32_bf16 v[28:31], v[44:47], v[4:7], 0
    v_perm_b32 v42, v11, v11, v2
    v_perm_b32 v43, v11, v11, v3
    v_mfma_f32_16x16x32_bf16 v[32:35], v[48:51], v[4:7], 0
    v_mfma_f32_16x16x32_bf16 v[36:39], v[52:55], v[4:7], 0
    v_mfma_f32_16x16x32_bf16 v[24:27], v[56:59], v[40:43], v[24:27]
    v_perm_b32 v56, v12, v12, v2
    v_perm_b32 v57, v12, v12, v3
    v_mfma_f32_16x16x32_bf16 v[28:31], v[60:63], v[40:43], v[28:31]
    v_perm_b32 v58, v13, v13, v2
    v_perm_b32 v59, v13, v13, v3
    v_mfma_f32_16x16x32_bf16 v[32:35], v[64:67], v[40:43], v[32:35]
    v_mfma_f32_16x16x32_bf16 v[36:39], v[68:71], v[40:43], v[36:39]
    v_mfma_f32_16x16x32_bf16 v[24:27], v[72:75], v[56:59], v[24:27]
    v_perm_b32 v72, v14, v14, v2
    v_perm_b32 v73, v14, v14, v3
    v_mfma_f32_16x16x32_bf16 v[28:31], v[76:79], v[56:59], v[28:31]
    v_perm_b32 v74, v15, v15, v2
    v_perm_b32 v75, v15, v15, v3
    v_mfma_f32_16x16x32_bf16 v[32:35], v[80:83], v[56:59], v[32:35]
    v_mfma_f32_16x16x32_bf16 v[36:39], v[84:87], v[56:59], v[36:39]
    v_mfma_f32_16x16x32_bf16 v[24:27], v[88:91], v[72:75], v[24:27]
    v_perm_b32 v88, v16, v16, v2
    v_perm_b32 v89, v16, v16, v3
    v_mfma_f32_16x16x32_bf16 v[28:31], v[92:95], v[72:75], v[28:31]
    v_perm_b32 v90, v17, v17, v2
    v_perm_b32 v91, v17, v17, v3
    v_mfma_f32_16x16x32_bf16 v[32:35], v[96:99], v[72:75], v[32:35]
    v_mfma_f32_16x16x32_bf16 v[36:39], v[100:103], v[72:75], v[36:39]
    v_mfma_f32_16x16x32_bf16 v[24:27], v[104:107], v[88:91], v[24:27]
    v_perm_b32 v104, v18, v18, v2
    v_perm_b32 v105, v18, v18, v3
    v_mfma_f32_16x16x32_bf16 v[28:31], v[108:111], v[88:91], v[28:31]
    v_perm_b32 v106, v19, v19, v2
    v_perm_b32 v107, v19, v19, v3
    v_mfma_f32_16x16x32_bf16 v[32:35], v[112:115], v[88:91], v[32:35]
    v_mfma_f32_16x16x32_bf16 v[36:39], v[116:119], v[88:91], v[36:39]
    v_mfma_f32_16x16x32_bf16 v[24:27], v[120:123], v[104:107], v[24:27]
    v_perm_b32 v120, v20, v20, v2
    v_perm_b32 v121, v20, v20, v3
    v_mfma_f32_16x16x32_bf16 v[28:31], v[124:127], v[104:107], v[28:31]
    v_perm_b32 v122, v21, v21, v2
    v_perm_b32 v123, v21, v21, v3
    v_mfma_f32_16x16x32_bf16 v[32:35], v[128:131], v[104:107], v[32:35]
    v_mfma_f32_16x16x32_bf16 v[36:39], v[132:135], v[104:107], v[36:39]
    v_mfma_f32_16x16x32_bf16 v[24:27], v[136:139], v[120:123], v[24:27]
    v_perm_b32 v136, v22, v22, v2
    v_perm_b32 v137, v22, v22, v3
    v_mfma_f32_16x16x32_bf16 v[28:31], v[140:143], v[120:123], v[28:31]
    v_perm_b32 v138, v23, v23, v2
    v_perm_b32 v139, v23, v23, v3
    v_mfma_f32_16x16x32_bf16 v[32:35], v[144:147], v[120:123], v[32:35]
    v_mfma_f32_16x16x32_bf16 v[36:39], v[148:151], v[120:123], v[36:39]
    v_mfma_f32_16x16x32_bf16 v[24:27], v[152:155], v[136:139], v[24:27]
    v_mfma_f32_16x16x32_bf16 v[28:31], v[156:159], v[136:139], v[28:31]
    v_mfma_f32_16x16x32_bf16 v[32:35], v[160:163], v[136:139], v[32:35]
    v_mfma_f32_16x16x32_bf16 v[36:39], v[164:167], v[136:139], v[36:39]
    s_lshl_b32 s38, s33, 12
    s_add_u32 s38, s38, 131072
    v_lshl_add_u32 v4, v1, 4, s38
    s_nop 1
    ds_write_b128 v4, v[24:27] offset:0
    ds_write_b128 v4, v[28:31] offset:1024
    ds_write_b128 v4, v[32:35] offset:2048
    ds_write_b128 v4, v[36:39] offset:3072
    v_mov_b32 v5, 1
    s_mov_b64 exec, 1
    ds_add_u32 v0, v5 offset:5040
    s_mov_b64 exec, -1
    s_setprio 0
L_B_t:
    s_cmp_lt_u32 s33, 2
    s_cbranch_scc1 L_B_uv
    s_cmp_eq_u32 s33, 2
    s_cbranch_scc1 L_B_mo
L_w19:
    s_sleep 1
    ds_read_b32 v6, v0 offset:5044
    s_sub_u32 s3, s3, 1
    s_cbranch_scc1 L_end
    s_waitcnt lgkmcnt(0)
    v_cmp_gt_u32 vcc, 3, v6
    s_cbranch_vccnz L_w19
    v_mov_b32 v4, 0
L_fl20:
    s_sleep 8
    global_load_dword v5, v4, s[28:29] offset:4 sc1
    s_sub_u32 s3, s3, 1
    s_cbranch_scc1 L_end
    s_waitcnt vmcnt(0)
    v_cmp_eq_u32 vcc, 0, v5
    s_cbranch_vccnz L_fl20
    v_mov_b32 v6, 1
    s_mov_b64 exec, 1
    ds_add_u32 v0, v6 offset:5052
    s_mov_b64 exec, -1
    s_branch L_end
L_B_mo:
L_w21:
    s_sleep 1
    ds_read_b32 v6, v0 offset:5044
    s_sub_u32 s3, s3, 1
    s_cbranch_scc1 L_end
    s_waitcnt lgkmcnt(0)
    v_cmp_gt_u32 vcc, 3, v6
    s_cbranch_vccnz L_w21
    s_mov_b32 s44, s22
    s_mov_b32 s45, s23
    s_mov_b32 s46, 8192
    s_mov_b32 s47, 0x20000

    v_lshrrev_b32 v4, 4, v1
    v_and_b32 v5, 15, v1
    v_lshrrev_b32 v2, 1, v5
    v_lshlrev_b32 v2, 10, v2
    v_lshl_add_u32 v2, v4, 6, v2
    s_lshl_b32 s38, s62, 8
    buffer_load_dwordx4 v[8:11], v2, s[44:47], s38 offen offset:0
    buffer_load_dwordx4 v[12:15], v2, s[44:47], s38 offen offset:16
    buffer_load_dwordx4 v[16:19], v2, s[44:47], s38 offen offset:32
    buffer_load_dwordx4 v[20:23], v2, s[44:47], s38 offen offset:48
    s_mov_b32 s44, s24
    s_mov_b32 s45, s25
    s_mov_b32 s46, 3145728
    s_mov_b32 s47, 0x20000

    v_mul_u32_u24 v2, 196608, v4
    v_lshl_add_u32 v2, v5, 3, v2
    v_lshlrev_b32 v4, 11, v4
    v_lshl_add_u32 v4, v5, 3, v4
    v_and_b32 v3, 1, v1
    v_lshlrev_b32 v3, 4, v3
    s_mov_b32 s38, 0xffff
    v_lshlrev_b32 v3, v3, s38
    s_mul_i32 s48, s62, 786432
    s_lshl_b32 s38, s35, 7
    s_add_u32 s48, s48, s38
    s_add_u32 s48, s48, 2048
    s_lshl2_add_u32 s49, s37, s62
    s_lshl_b32 s49, s49, 13
    s_lshl_b32 s38, s36, 7
    s_add_u32 s49, s49, s38
    s_add_u32 s49, s49, 1179648
    s_mov_b32 s38, 0xbfb8aa3b
    s_waitcnt vmcnt(0)
    v_lshlrev_b32 v24, 16, v8
    v_and_b32 v25, 0xffff0000, v8
    v_mul_f32 v26, s38, v24
    v_mul_f32 v27, s38, v25
    v_exp_f32 v26, v26
    v_exp_f32 v27, v27
    v_add_f32 v26, 1.0, v26
    v_add_f32 v27, 1.0, v27
    v_rcp_f32 v26, v26
    v_rcp_f32 v27, v27
    v_mul_f32 v24, v24, v26
    v_mul_f32 v25, v25, v27
    v_cvt_pk_bf16_f32 v24, v24, v24
    v_cvt_pk_bf16_f32 v25, v25, v25
    v_and_b32 v40, v24, v3
    v_and_b32 v41, v25, v3
    v_lshlrev_b32 v24, 16, v9
    v_and_b32 v25, 0xffff0000, v9
    v_mul_f32 v26, s38, v24
    v_mul_f32 v27, s38, v25
    v_exp_f32 v26, v26
    v_exp_f32 v27, v27
    v_add_f32 v26, 1.0, v26
    v_add_f32 v27, 1.0, v27
    v_rcp_f32 v26, v26
    v_rcp_f32 v27, v27
    v_mul_f32 v24, v24, v26
    v_mul_f32 v25, v25, v27
    v_cvt_pk_bf16_f32 v24, v24, v24
    v_cvt_pk_bf16_f32 v25, v25, v25
    v_and_b32 v42, v24, v3
    v_and_b32 v43, v25, v3
    v_lshlrev_b32 v24, 16, v10
    v_and_b32 v25, 0xffff0000, v10
    v_mul_f32 v26, s38, v24
    v_mul_f32 v27, s38, v25
    v_exp_f32 v26, v26
    v_exp_f32 v27, v27
    v_add_f32 v26, 1.0, v26
    v_add_f32 v27, 1.0, v27
    v_rcp_f32 v26, v26
    v_rcp_f32 v27, v27
    v_mul_f32 v24, v24, v26
    v_mul_f32 v25, v25, v27
    v_cvt_pk_bf16_f32 v24, v24, v24
    v_cvt_pk_bf16_f32 v25, v25, v25
    v_and_b32 v44, v24, v3
    v_and_b32 v45, v25, v3
    v_lshlrev_b32 v24, 16, v11
    v_and_b32 v25, 0xffff0000, v11
    v_mul_f32 v26, s38, v24
    v_mul_f32 v27, s38, v25
    v_exp_f32 v26, v26
    v_exp_f32 v27, v27
    v_add_f32 v26, 1.0, v26
    v_add_f32 v27, 1.0, v27
    v_rcp_f32 v26, v26
    v_rcp_f32 v27, v27
    v_mul_f32 v24, v24, v26
    v_mul_f32 v25, v25, v27
    v_cvt_pk_bf16_f32 v24, v24, v24
    v_cvt_pk_bf16_f32 v25, v25, v25
    v_and_b32 v46, v24, v3
    v_and_b32 v47, v25, v3
    v_lshlrev_b32 v24, 16, v12
    v_and_b32 v25, 0xffff0000, v12
    v_mul_f32 v26, s38, v24
    v_mul_f32 v27, s38, v25
    v_exp_f32 v26, v26
    v_exp_f32 v27, v27
    v_add_f32 v26, 1.0, v26
    v_add_f32 v27, 1.0, v27
    v_rcp_f32 v26, v26
    v_rcp_f32 v27, v27
    v_mul_f32 v24, v24, v26
    v_mul_f32 v25, v25, v27
    v_cvt_pk_bf16_f32 v24, v24, v24
    v_cvt_pk_bf16_f32 v25, v25, v25
    v_and_b32 v48, v24, v3
    v_and_b32 v49, v25, v3
    v_lshlrev_b32 v24, 16, v13
    v_and_b32 v25, 0xffff0000, v13
    v_mul_f32 v26, s38, v24
    v_mul_f32 v27, s38, v25
    v_exp_f32 v26, v26
    v_exp_f32 v27, v27
    v_add_f32 v26, 1.0, v26
    v_add_f32 v27, 1.0, v27
    v_rcp_f32 v26, v26
    v_rcp_f32 v27, v27
    v_mul_f32 v24, v24, v26
    v_mul_f32 v25, v25, v27
    v_cvt_pk_bf16_f32 v24, v24, v24
    v_cvt_pk_bf16_f32 v25, v25, v25
    v_and_b32 v50, v24, v3
    v_and_b32 v51, v25, v3
    v_lshlrev_b32 v24, 16, v14
    v_and_b32 v25, 0xffff0000, v14
    v_mul_f32 v26, s38, v24
    v_mul_f32 v27, s38, v25
    v_exp_f32 v26, v26
    v_exp_f32 v27, v27
    v_add_f32 v26, 1.0, v26
    v_add_f32 v27, 1.0, v27
    v_rcp_f32 v26, v26
    v_rcp_f32 v27, v27
    v_mul_f32 v24, v24, v26
    v_mul_f32 v25, v25, v27
    v_cvt_pk_bf16_f32 v24, v24, v24
    v_cvt_pk_bf16_f32 v25, v25, v25
    v_and_b32 v52, v24, v3
    v_and_b32 v53, v25, v3
    v_lshlrev_b32 v24, 16, v15
    v_and_b32 v25, 0xffff0000, v15
    v_mul_f32 v26, s38, v24
    v_mul_f32 v27, s38, v25
    v_exp_f32 v26, v26
    v_exp_f32 v27, v27
    v_add_f32 v26, 1.0, v26
    v_add_f32 v27, 1.0, v27
    v_rcp_f32 v26, v26
    v_rcp_f32 v27, v27
    v_mul_f32 v24, v24, v26
    v_mul_f32 v25, v25, v27
    v_cvt_pk_bf16_f32 v24, v24, v24
    v_cvt_pk_bf16_f32 v25, v25, v25
    v_and_b32 v54, v24, v3
    v_and_b32 v55, v25, v3
    v_lshlrev_b32 v24, 16, v16
    v_and_b32 v25, 0xffff0000, v16
    v_mul_f32 v26, s38, v24
    v_mul_f32 v27, s38, v25
    v_exp_f32 v26, v26
    v_exp_f32 v27, v27
    v_add_f32 v26, 1.0, v26
    v_add_f32 v27, 1.0, v27
    v_rcp_f32 v26, v26
    v_rcp_f32 v27, v27
    v_mul_f32 v24, v24, v26
    v_mul_f32 v25, v25, v27
    v_cvt_pk_bf16_f32 v24, v24, v24
    v_cvt_pk_bf16_f32 v25, v25, v25
    v_and_b32 v56, v24, v3
    v_and_b32 v57, v25, v3
    v_lshlrev_b32 v24, 16, v17
    v_and_b32 v25, 0xffff0000, v17
    v_mul_f32 v26, s38, v24
    v_mul_f32 v27, s38, v25
    v_exp_f32 v26, v26
    v_exp_f32 v27, v27
    v_add_f32 v26, 1.0, v26
    v_add_f32 v27, 1.0, v27
    v_rcp_f32 v26, v26
    v_rcp_f32 v27, v27
    v_mul_f32 v24, v24, v26
    v_mul_f32 v25, v25, v27
    v_cvt_pk_bf16_f32 v24, v24, v24
    v_cvt_pk_bf16_f32 v25, v25, v25
    v_and_b32 v58, v24, v3
    v_and_b32 v59, v25, v3
    v_lshlrev_b32 v24, 16, v18
    v_and_b32 v25, 0xffff0000, v18
    v_mul_f32 v26, s38, v24
    v_mul_f32 v27, s38, v25
    v_exp_f32 v26, v26
    v_exp_f32 v27, v27
    v_add_f32 v26, 1.0, v26
    v_add_f32 v27, 1.0, v27
    v_rcp_f32 v26, v26
    v_rcp_f32 v27, v27
    v_mul_f32 v24, v24, v26
    v_mul_f32 v25, v25, v27
    v_cvt_pk_bf16_f32 v24, v24, v24
    v_cvt_pk_bf16_f32 v25, v25, v25
    v_and_b32 v60, v24, v3
    v_and_b32 v61, v25, v3
    v_lshlrev_b32 v24, 16, v19
    v_and_b32 v25, 0xffff0000, v19
    v_mul_f32 v26, s38, v24
    v_mul_f32 v27, s38, v25
    v_exp_f32 v26, v26
    v_exp_f32 v27, v27
    v_add_f32 v26, 1.0, v26
    v_add_f32 v27, 1.0, v27
    v_rcp_f32 v26, v26
    v_rcp_f32 v27, v27
    v_mul_f32 v24, v24, v26
    v_mul_f32 v25, v25, v27
    v_cvt_pk_bf16_f32 v24, v24, v24
    v_cvt_pk_bf16_f32 v25, v25, v25
    v_and_b32 v62, v24, v3
    v_and_b32 v63, v25, v3
    v_lshlrev_b32 v24, 16, v20
    v_and_b32 v25, 0xffff0000, v20
    v_mul_f32 v26, s38, v24
    v_mul_f32 v27, s38, v25
    v_exp_f32 v26, v26
    v_exp_f32 v27, v27
    v_add_f32 v26, 1.0, v26
    v_add_f32 v27, 1.0, v27
    v_rcp_f32 v26, v26
    v_rcp_f32 v27, v27
    v_mul_f32 v24, v24, v26
    v_mul_f32 v25, v25, v27
    v_cvt_pk_bf16_f32 v24, v24, v24
    v_cvt_pk_bf16_f32 v25, v25, v25
    v_and_b32 v64, v24, v3
    v_and_b32 v65, v25, v3
    v_lshlrev_b32 v24, 16, v21
    v_and_b32 v25, 0xffff0000, v21
    v_mul_f32 v26, s38, v24
    v_mul_f32 v27, s38, v25
    v_exp_f32 v26, v26
    v_exp_f32 v27, v27
    v_add_f32 v26, 1.0, v26
    v_add_f32 v27, 1.0, v27
    v_rcp_f32 v26, v26
    v_rcp_f32 v27, v27
    v_mul_f32 v24, v24, v26
    v_mul_f32 v25, v25, v27
    v_cvt_pk_bf16_f32 v24, v24, v24
    v_cvt_pk_bf16_f32 v25, v25, v25
    v_and_b32 v66, v24, v3
    v_and_b32 v67, v25, v3
    v_lshlrev_b32 v24, 16, v22
    v_and_b32 v25, 0xffff0000, v22
    v_mul_f32 v26, s38, v24
    v_mul_f32 v27, s38, v25
    v_exp_f32 v26, v26
    v_exp_f32 v27, v27
    v_add_f32 v26, 1.0, v26
    v_add_f32 v27, 1.0, v27
    v_rcp_f32 v26, v26
    v_rcp_f32 v27, v27
    v_mul_f32 v24, v24, v26
    v_mul_f32 v25, v25, v27
    v_cvt_pk_bf16_f32 v24, v24, v24
    v_cvt_pk_bf16_f32 v25, v25, v25
    v_and_b32 v68, v24, v3
    v_and_b32 v69, v25, v3
    v_lshlrev_b32 v24, 16, v23
    v_and_b32 v25, 0xffff0000, v23
    v_mul_f32 v26, s38, v24
    v_mul_f32 v27, s38, v25
    v_exp_f32 v26, v26
    v_exp_f32 v27, v27
    v_add_f32 v26, 1.0, v26
    v_add_f32 v27, 1.0, v27
    v_rcp_f32 v26, v26
    v_rcp_f32 v27, v27
    v_mul_f32 v24, v24, v26
    v_mul_f32 v25, v25, v27
    v_cvt_pk_bf16_f32 v24, v24, v24
    v_cvt_pk_bf16_f32 v25, v25, v25
    v_and_b32 v70, v24, v3
    v_and_b32 v71, v25, v3
L_w22:
    s_sleep 1
    ds_read_b32 v6, v0 offset:5048
    s_sub_u32 s3, s3, 1
    s_cbranch_scc1 L_end
    s_waitcnt lgkmcnt(0)
    v_cmp_gt_u32_e64 vcc, 4, v6
    s_cbranch_vccnz L_w22
    s_add_u32 s39, s48, 0
    buffer_load_dwordx2 v[104:105], v2, s[44:47], s39 offen nt
    s_add_u32 s39, s48, 6144
    buffer_load_dwordx2 v[108:109], v2, s[44:47], s39 offen nt
    s_add_u32 s39, s48, 12288
    buffer_load_dwordx2 v[106:107], v2, s[44:47], s39 offen nt
    s_add_u32 s39, s48, 18432
    buffer_load_dwordx2 v[110:111], v2, s[44:47], s39 offen nt
    s_add_u32 s39, s48, 24576
    buffer_load_dwordx2 v[112:113], v2, s[44:47], s39 offen nt
    s_add_u32 s39, s48, 30720
    buffer_load_dwordx2 v[116:117], v2, s[44:47], s39 offen nt
    s_add_u32 s39, s48, 36864
    buffer_load_dwordx2 v[114:115], v2, s[44:47], s39 offen nt
    s_add_u32 s39, s48, 43008
    buffer_load_dwordx2 v[118:119], v2, s[44:47], s39 offen nt
    s_add_u32 s39, s48, 49152
    buffer_load_dwordx2 v[120:121], v2, s[44:47], s39 offen nt
    s_add_u32 s39, s48, 55296
    buffer_load_dwordx2 v[124:125], v2, s[44:47], s39 offen nt
    s_add_u32 s39, s48, 61440
    buffer_load_dwordx2 v[122:123], v2, s[44:47], s39 offen nt
    s_add_u32 s39, s48, 67584
    buffer_load_dwordx2 v[126:127], v2, s[44:47], s39 offen nt
    s_add_u32 s39, s48, 73728
    buffer_load_dwordx2 v[128:129], v2, s[44:47], s39 offen nt
    s_add_u32 s39, s48, 79872
    buffer_load_dwordx2 v[132:133], v2, s[44:47], s39 offen nt
    s_add_u32 s39, s48, 86016
    buffer_load_dwordx2 v[130:131], v2, s[44:47], s39 offen nt
    s_add_u32 s39, s48, 92160
    buffer_load_dwordx2 v[134:135], v2, s[44:47], s39 offen nt
    s_add_u32 s39, s48, 98304
    buffer_load_dwordx2 v[136:137], v2, s[44:47], s39 offen nt
    s_add_u32 s39, s48, 104448
    buffer_load_dwordx2 v[140:141], v2, s[44:47], s39 offen nt
    s_add_u32 s39, s48, 110592
    buffer_load_dwordx2 v[138:139], v2, s[44:47], s39 offen nt
    s_add_u32 s39, s48, 116736
    buffer_load_dwordx2 v[142:143], v2, s[44:47], s39 offen nt
    s_add_u32 s39, s48, 122880
    buffer_load_dwordx2 v[144:145], v2, s[44:47], s39 offen nt
    s_add_u32 s39, s48, 129024
    buffer_load_dwordx2 v[148:149], v2, s[44:47], s39 offen nt
    s_add_u32 s39, s48, 135168
    buffer_load_dwordx2 v[146:147], v2, s[44:47], s39 offen nt
    s_add_u32 s39, s48, 141312
    buffer_load_dwordx2 v[150:151], v2, s[44:47], s39 offen nt
    s_add_u32 s39, s48, 147456
    buffer_load_dwordx2 v[152:153], v2, s[44:47], s39 offen nt
    s_add_u32 s39, s48, 153600
    buffer_load_dwordx2 v[156:157], v2, s[44:47], s39 offen nt
    s_add_u32 s39, s48, 159744
    buffer_load_dwordx2 v[154:155], v2, s[44:47], s39 offen nt
    s_add_u32 s39, s48, 165888
    buffer_load_dwordx2 v[158:159], v2, s[44:47], s39 offen nt
    s_add_u32 s39, s48, 172032
    buffer_load_dwordx2 v[160:161], v2, s[44:47], s39 offen nt
    s_add_u32 s39, s48, 178176
    buffer_load_dwordx2 v[164:165], v2, s[44:47], s39 offen nt
    s_add_u32 s39, s48, 184320
    buffer_load_dwordx2 v[162:163], v2, s[44:47], s39 offen nt
    s_add_u32 s39, s48, 190464
    buffer_load_dwordx2 v[166:167], v2, s[44:47], s39 offen nt
    s_waitcnt vmcnt(31)
    s_waitcnt vmcnt(0)
    v_mov_b32_e64 v6, 1
    s_mov_b64 exec, 1
    ds_add_u32 v0, v6 offset:6060
    s_mov_b64 exec, -1
    v_swap_b32 v105, v108
    v_swap_b32 v107, v110
    v_swap_b32 v113, v116
    v_swap_b32 v115, v118
    v_swap_b32 v121, v124
    v_swap_b32 v123, v126
    v_swap_b32 v129, v132
    v_swap_b32 v131, v134
    v_swap_b32 v137, v140
    v_swap_b32 v139, v142
    v_swap_b32 v145, v148
    v_swap_b32 v147, v150
    v_swap_b32 v153, v156
    v_swap_b32 v155, v158
    v_swap_b32 v161, v164
    v_swap_b32 v163, v166
    v_mfma_f32_16x16x32_bf16 v[24:27], v[40:43], v[104:107], 0
    v_mfma_f32_16x16x32_bf16 v[28:31], v[40:43], v[108:111], 0
    v_mfma_f32_16x16x32_bf16 v[24:27], v[44:47], v[112:115], v[24:27]
    v_mfma_f32_16x16x32_bf16 v[28:31], v[44:47], v[116:119], v[28:31]
    v_mfma_f32_16x16x32_bf16 v[24:27], v[48:51], v[120:123], v[24:27]
    v_mfma_f32_16x16x32_bf16 v[28:31], v[48:51], v[124:127], v[28:31]
    v_mfma_f32_16x16x32_bf16 v[24:27], v[52:55], v[128:131], v[24:27]
    v_mfma_f32_16x16x32_bf16 v[28:31], v[52:55], v[132:135], v[28:31]
    v_mfma_f32_16x16x32_bf16 v[24:27], v[56:59], v[136:139], v[24:27]
    v_mfma_f32_16x16x32_bf16 v[28:31], v[56:59], v[140:143], v[28:31]
    v_mfma_f32_16x16x32_bf16 v[24:27], v[60:63], v[144:147], v[24:27]
    v_mfma_f32_16x16x32_bf16 v[28:31], v[60:63], v[148:151], v[28:31]
    v_mfma_f32_16x16x32_bf16 v[24:27], v[64:67], v[152:155], v[24:27]
    v_mfma_f32_16x16x32_bf16 v[28:31], v[64:67], v[156:159], v[28:31]
    v_mfma_f32_16x16x32_bf16 v[24:27], v[68:71], v[160:163], v[24:27]
    v_mfma_f32_16x16x32_bf16 v[28:31], v[68:71], v[164:167], v[28:31]
    s_nop 6
    v_cvt_pk_bf16_f32 v8, v24, v25
    v_cvt_pk_bf16_f32 v10, v26, v27
    v_cvt_pk_bf16_f32 v9, v28, v29
    v_cvt_pk_bf16_f32 v11, v30, v31
L_w23:
    s_sleep 1
    ds_read_b32 v6, v0 offset:5052
    s_sub_u32 s3, s3, 1
    s_cbranch_scc1 L_end
    s_waitcnt lgkmcnt(0)
    v_cmp_gt_u32 vcc, 1, v6
    s_cbranch_vccnz L_w23
    buffer_store_dwordx2 v[8:9], v4, s[40:43], s49 offen sc1
    buffer_store_dwordx2 v[10:11], v4, s[40:43], s49 offen offset:1024 sc1
    s_branch L_end
L_B_uv:
    s_mov_b32 s44, s12
    s_mov_b32 s45, s13
    s_mov_b32 s46, 4194304
    s_mov_b32 s47, 0x20000

    v_lshrrev_b32 v4, 4, v1
    v_and_b32 v5, 15, v1
    v_lshlrev_b32 v2, 14, v4
    v_lshl_add_u32 v2, v5, 3, v2
    s_lshl_b32 s48, s62, 18
    s_lshl1_add_u32 s38, s35, s33
    s_lshl_b32 s38, s38, 7
    s_add_u32 s48, s48, s38
    v_mul_u32_u24 v3, 528, v5
    v_lshl_add_u32 v3, v4, 5, v3
    v_add_u32 v3, 141312, v3
    v_lshlrev_b32 v4, 4, v1
    s_lshl2_add_u32 s49, s35, s62
    s_lshl1_add_u32 s49, s49, s33
    s_lshl_b32 s49, s49, 10
    s_add_u32 s49, s49, 1835008
L_w24:
    s_sleep 1
    ds_read_b32 v6, v0 offset:5048
    s_sub_u32 s3, s3, 1
    s_cbranch_scc1 L_end
    s_waitcnt lgkmcnt(0)
    v_cmp_gt_u32 vcc, 4, v6
    s_cbranch_vccnz L_w24
    s_add_u32 s39, s48, 0
    buffer_load_dwordx2 v[104:105], v2, s[44:47], s39 offen nt
    s_add_u32 s39, s48, 1048576
    buffer_load_dwordx2 v[108:109], v2, s[44:47], s39 offen nt
    s_add_u32 s39, s48, 131072
    buffer_load_dwordx2 v[106:107], v2, s[44:47], s39 offen nt
    s_add_u32 s39, s48, 1179648
    buffer_load_dwordx2 v[110:111], v2, s[44:47], s39 offen nt
    s_add_u32 s39, s48, 8192
    buffer_load_dwordx2 v[112:113], v2, s[44:47], s39 offen nt
    s_add_u32 s39, s48, 1056768
    buffer_load_dwordx2 v[116:117], v2, s[44:47], s39 offen nt
    s_add_u32 s39, s48, 139264
    buffer_load_dwordx2 v[114:115], v2, s[44:47], s39 offen nt
    s_add_u32 s39, s48, 1187840
    buffer_load_dwordx2 v[118:119], v2, s[44:47], s39 offen nt
    s_add_u32 s39, s48, 65536
    buffer_load_dwordx2 v[120:121], v2, s[44:47], s39 offen nt
    s_add_u32 s39, s48, 1114112
    buffer_load_dwordx2 v[124:125], v2, s[44:47], s39 offen nt
    s_add_u32 s39, s48, 196608
    buffer_load_dwordx2 v[122:123], v2, s[44:47], s39 offen nt
    s_add_u32 s39, s48, 1245184
    buffer_load_dwordx2 v[126:127], v2, s[44:47], s39 offen nt
    s_add_u32 s39, s48, 73728
    buffer_load_dwordx2 v[128:129], v2, s[44:47], s39 offen nt
    s_add_u32 s39, s48, 1122304
    buffer_load_dwordx2 v[132:133], v2, s[44:47], s39 offen nt
    s_add_u32 s39, s48, 204800
    buffer_load_dwordx2 v[130:131], v2, s[44:47], s39 offen nt
    s_add_u32 s39, s48, 1253376
    buffer_load_dwordx2 v[134:135], v2, s[44:47], s39 offen nt
    s_add_u32 s39, s48, 2097152
    buffer_load_dwordx2 v[136:137], v2, s[44:47], s39 offen nt
    s_add_u32 s39, s48, 3145728
    buffer_load_dwordx2 v[140:141], v2, s[44:47], s39 offen nt
    s_add_u32 s39, s48, 2228224
    buffer_load_dwordx2 v[138:139], v2, s[44:47], s39 offen nt
    s_add_u32 s39, s48, 3276800
    buffer_load_dwordx2 v[142:143], v2, s[44:47], s39 offen nt
    s_add_u32 s39, s48, 2105344
    buffer_load_dwordx2 v[144:145], v2, s[44:47], s39 offen nt
    s_add_u32 s39, s48, 3153920
    buffer_load_dwordx2 v[148:149], v2, s[44:47], s39 offen nt
    s_add_u32 s39, s48, 2236416
    buffer_load_dwordx2 v[146:147], v2, s[44:47], s39 offen nt
    s_add_u32 s39, s48, 3284992
    buffer_load_dwordx2 v[150:151], v2, s[44:47], s39 offen nt
    s_add_u32 s39, s48, 2162688
    buffer_load_dwordx2 v[152:153], v2, s[44:47], s39 offen nt
    s_add_u32 s39, s48, 3211264
    buffer_load_dwordx2 v[156:157], v2, s[44:47], s39 offen nt
    s_add_u32 s39, s48, 2293760
    buffer_load_dwordx2 v[154:155], v2, s[44:47], s39 offen nt
    s_add_u32 s39, s48, 3342336
    buffer_load_dwordx2 v[158:159], v2, s[44:47], s39 offen nt
    s_add_u32 s39, s48, 2170880
    buffer_load_dwordx2 v[160:161], v2, s[44:47], s39 offen nt
    s_add_u32 s39, s48, 3219456
    buffer_load_dwordx2 v[164:165], v2, s[44:47], s39 offen nt
    s_add_u32 s39, s48, 2301952
    buffer_load_dwordx2 v[162:163], v2, s[44:47], s39 offen nt
    s_add_u32 s39, s48, 3350528
    buffer_load_dwordx2 v[166:167], v2, s[44:47], s39 offen nt
    s_waitcnt vmcnt(31)
    s_waitcnt vmcnt(0)
    v_mov_b32 v6, 1
    s_mov_b64 exec, 1
    ds_add_u32 v0, v6 offset:6060
    s_mov_b64 exec, -1
    v_swap_b32 v105, v108
    v_swap_b32 v107, v110
    v_swap_b32 v113, v116
    v_swap_b32 v115, v118
    v_swap_b32 v121, v124
    v_swap_b32 v123, v126
    v_swap_b32 v129, v132
    v_swap_b32 v131, v134
    v_swap_b32 v137, v140
    v_swap_b32 v139, v142
    v_swap_b32 v145, v148
    v_swap_b32 v147, v150
    v_swap_b32 v153, v156
    v_swap_b32 v155, v158
    v_swap_b32 v161, v164
    v_swap_b32 v163, v166
L_w25:
    s_sleep 1
    ds_read_b32 v6, v0 offset:6048
    s_sub_u32 s3, s3, 1
    s_cbranch_scc1 L_end
    s_waitcnt lgkmcnt(0)
    v_cmp_gt_u32 vcc, 1, v6
    s_cbranch_vccnz L_w25
    s_setprio 2
L_w26:
    ds_read_b32 v6, v0 offset:6048
    s_sub_u32 s3, s3, 1
    s_cbranch_scc1 L_end
    s_waitcnt lgkmcnt(0)
    v_cmp_gt_u32_e64 vcc, 4, v6
    s_cbranch_vccnz L_w26
    ds_read_b128 v[40:43], v3 offset:0
    ds_read_b128 v[44:47], v3 offset:16
    ds_read_b128 v[48:51], v3 offset:128
    ds_read_b128 v[52:55], v3 offset:144
    ds_read_b128 v[56:59], v3 offset:256
    ds_read_b128 v[60:63], v3 offset:272
    ds_read_b128 v[64:67], v3 offset:384
    ds_read_b128 v[68:71], v3 offset:400
    s_waitcnt lgkmcnt(7)
    v_mfma_f32_16x16x32_bf16 v[24:27], v[40:43], v[104:107], 0
    v_mfma_f32_16x16x32_bf16 v[28:31], v[40:43], v[108:111], 0
    s_waitcnt lgkmcnt(6)
    v_mfma_f32_16x16x32_bf16 v[24:27], v[44:47], v[112:115], v[24:27]
    v_mfma_f32_16x16x32_bf16 v[28:31], v[44:47], v[116:119], v[28:31]
    s_waitcnt lgkmcnt(5)
    v_mfma_f32_16x16x32_bf16 v[24:27], v[48:51], v[120:123], v[24:27]
    v_mfma_f32_16x16x32_bf16 v[28:31], v[48:51], v[124:127], v[28:31]
    s_waitcnt lgkmcnt(4)
    v_mfma_f32_16x16x32_bf16 v[24:27], v[52:55], v[128:131], v[24:27]
    v_mfma_f32_16x16x32_bf16 v[28:31], v[52:55], v[132:135], v[28:31]
    s_waitcnt lgkmcnt(3)
    v_mfma_f32_16x16x32_bf16 v[24:27], v[56:59], v[136:139], v[24:27]
    v_mfma_f32_16x16x32_bf16 v[28:31], v[56:59], v[140:143], v[28:31]
    s_waitcnt lgkmcnt(2)
    v_mfma_f32_16x16x32_bf16 v[24:27], v[60:63], v[144:147], v[24:27]
    v_mfma_f32_16x16x32_bf16 v[28:31], v[60:63], v[148:151], v[28:31]
    s_waitcnt lgkmcnt(1)
    v_mfma_f32_16x16x32_bf16 v[24:27], v[64:67], v[152:155], v[24:27]
    v_mfma_f32_16x16x32_bf16 v[28:31], v[64:67], v[156:159], v[28:31]
    s_waitcnt lgkmcnt(0)
    v_mfma_f32_16x16x32_bf16 v[24:27], v[68:71], v[160:163], v[24:27]
    v_mfma_f32_16x16x32_bf16 v[28:31], v[68:71], v[164:167], v[28:31]
    s_nop 6
    v_cvt_pk_bf16_f32 v8, v24, v25
    v_cvt_pk_bf16_f32 v10, v26, v27
    v_cvt_pk_bf16_f32 v9, v28, v29
    v_cvt_pk_bf16_f32 v11, v30, v31
    buffer_store_dwordx4 v[8:11], v4, s[40:43], s49 offen sc1
    s_waitcnt vmcnt(0)
    v_mov_b32 v6, 1
    s_mov_b64 exec, 1
    ds_add_u32 v0, v6 offset:6052
    s_mov_b64 exec, -1
    s_branch L_end
L_Be:
    s_waitcnt lgkmcnt(0)
    v_lshrrev_b32 v2, 1, v1
    v_and_b32 v3, 1, v1
    v_and_b32 v4, 24, v2
    v_and_b32 v2, 7, v2
    v_lshl_add_u32 v2, v4, 2, v2
    v_lshl_add_u32 v2, v2, 6, v3
    s_and_b32 s38, s34, 3
    s_lshl4_add_u32 s38, s38, s33
    s_lshl_b32 s38, s38, 8
    s_add_u32 s38, s38, s35
    s_lshl_b32 s38, s38, 8
    v_lshl_add_u32 v2, v2, 7, s38
    global_load_dword v166, v2, s[8:9]

    s_mov_b32 s3, 0x400000
    v_mov_b32 v0, 156256
    s_and_b32 s62, s34, 3
    s_lshl2_add_u32 s97, s62, s37
    s_lshl4_add_u32 s61, s36, s97
    s_waitcnt lgkmcnt(0)

    s_mov_b32 s40, s30
    s_mov_b32 s41, s31
    s_mov_b32 s42, 16777216
    s_mov_b32 s43, 0x20000
    s_barrier
    s_cmp_eq_u32 s33, 0
    s_cbranch_scc1 L_B_nt
    v_lshrrev_b32 v2, 1, v1
    v_and_b32 v3, 1, v1
    s_lshl2_add_u32 s38, s33, s34
    s_sub_u32 s38, s38, 4
    v_lshl_add_u32 v2, v2, 6, v3
    s_lshl_b32 s38, s38, 10
    s_add_u32 s38, s38, s35
    s_lshl_b32 s38, s38, 8
    v_lshl_add_u32 v2, v2, 7, s38
    s_mov_b64 exec, 1
    global_load_dword v166, v2, s[10:11]
    s_mov_b64 exec, -1
    s_waitcnt vmcnt(0)
    global_load_dword v166, v2, s[10:11]
    s_mov_b64 exec, -1
    v_mov_b32 v3, 1
    s_mov_b64 exec, 1
    ds_add_u32 v0, v3 offset:4
    s_mov_b64 exec, -1
L_B_nt:

    v_and_b32 v5, 31, v1
    v_lshrrev_b32 v7, 5, v1
    v_bfe_u32 v2, v5, 1, 1
    v_lshlrev_b32 v2, 2, v2
    v_bfe_u32 v3, v5, 2, 2
    v_or_b32 v2, v2, v3
    v_xor_b32 v2, v2, v7
    v_lshlrev_b32 v2, 4, v2
    v_lshl_add_u32 v2, v5, 7, v2
    s_lshl_b32 s38, s33, 12
    v_add_u32 v2, s38, v2
    v_mov_b32 v8, v2
    v_xor_b32 v9, 32, v2
    v_xor_b32 v10, 64, v2
    v_xor_b32 v11, 0x60, v2
    v_mul_u32_u24 v4, 1008, v5
    v_lshl_add_u32 v4, v7, 4, v4
    v_add_u32 v4, 131072, v4
    v_lshlrev_b32 v12, 10, v5
    v_lshl_add_u32 v7, v7, 4, v12
    v_lshl_add_u32 v5, v5, 4, v0
    s_lshl_b32 s53, s33, 2
    v_add_u32 v6, s53, v0
    s_lshl_b32 s50, s36, 15
    s_add_u32 s50, s50, 65536
    s_lshl_b32 s51, s33, 13
    s_add_u32 s51, s51, s50
    s_mul_i32 s49, s33, 8064
    s_add_u32 s49, s49, 131072
    s_mov_b32 s52, 0x3e0293ee
    s_mov_b32 s56, -1
    s_mov_b32 s57, 0x3fffffff
    s_mov_b64 exec, 0
    s_branch L_pad_b_0
L_pad_b_r:
    s_mov_b64 exec, -1
L_w27:
    s_sleep 1
    ds_read_b32 v3, v6 offset:4032
    s_sub_u32 s3, s3, 1
    s_cbranch_scc1 L_end
    s_waitcnt lgkmcnt(0)
    v_cmp_gt_u32 vcc, 2, v3
    s_cbranch_vccnz L_w27
    ds_read_b128 v[40:43], v8 offset:0
    ds_read_b128 v[44:47], v9 offset:0
    ds_read_b128 v[48:51], v10 offset:0
    ds_read_b128 v[52:55], v11 offset:0
    ds_read_b128 v[56:59], v8 offset:16384
    ds_read_b128 v[60:63], v9 offset:16384
    ds_read_b128 v[64:67], v10 offset:16384
    ds_read_b128 v[68:71], v11 offset:16384
    v_mov_b32 v3, 1
    s_mov_b64 exec, 1
    ds_add_u32 v0, v3 offset:3024
    s_mov_b64 exec, -1
L_w28:
    s_sleep 1
    ds_read_b32 v3, v6 offset:4032
    s_sub_u32 s3, s3, 1
    s_cbranch_scc1 L_end
    s_waitcnt lgkmcnt(0)
    v_cmp_gt_u32_e64 vcc, 4, v3
    s_cbranch_vccnz L_w28
    ds_read_b128 v[72:75], v8 offset:32768
    ds_read_b128 v[76:79], v9 offset:32768
    ds_read_b128 v[80:83], v10 offset:32768
    ds_read_b128 v[84:87], v11 offset:32768
    ds_read_b128 v[88:91], v8 offset:49152
    ds_read_b128 v[92:95], v9 offset:49152
    ds_read_b128 v[96:99], v10 offset:49152
    ds_read_b128 v[100:103], v11 offset:49152
    v_mov_b32 v3, 1
    s_mov_b64 exec, 1
    ds_add_u32 v0, v3 offset:3028
    s_mov_b64 exec, -1
    s_cmp_lt_u32 s36, 0
    s_movk_i32 s38, 128
    s_cselect_b32 s38, 8, s38
    v_mov_b32 v3, s38
    v_mov_b32 v13, 0
    v_mov_b32 v14, 0
    s_waitcnt vmcnt(0)
L_B_f2:
    global_load_dword v12, v3, s[28:29] sc1
    s_sub_u32 s3, s3, 1
    s_cbranch_scc1 L_end
    s_sleep 4
    s_waitcnt vmcnt(2)
    v_cmp_eq_u32 vcc, 0, v13
    s_cbranch_vccz L_B_f2d
    global_load_dword v13, v3, s[28:29] sc1
    s_sub_u32 s3, s3, 1
    s_cbranch_scc1 L_end
    s_sleep 4
    s_waitcnt vmcnt(2)
    v_cmp_eq_u32 vcc, 0, v14
    s_cbranch_vccz L_B_f2d
    global_load_dword v14, v3, s[28:29] sc1
    s_sub_u32 s3, s3, 1
    s_cbranch_scc1 L_end
    s_sleep 4
    s_waitcnt vmcnt(2)
    v_cmp_eq_u32 vcc, 0, v12
    s_cbranch_vccz L_B_f2d
    s_branch L_B_f2
L_B_f2d:
    s_setprio 3
    v_lshlrev_b32 v3, 4, v1
    s_mov_b32 m0, s49
    s_mov_b32 s38, s51
    s_mov_b64 exec, s[56:57]
    buffer_load_dwordx4 v3, s[40:43], s38 offen sc1 lds
    s_add_u32 m0, m0, 1008
    s_add_u32 s38, s38, 1024
    buffer_load_dwordx4 v3, s[40:43], s38 offen sc1 lds
    s_add_u32 m0, m0, 1008
    s_add_u32 s38, s38, 1024
    buffer_load_dwordx4 v3, s[40:43], s38 offen sc1 lds
    s_add_u32 m0, m0, 1008
    s_add_u32 s38, s38, 1024
    buffer_load_dwordx4 v3, s[40:43], s38 offen sc1 lds
    s_add_u32 m0, m0, 1008
    s_add_u32 s38, s38, 1024
    buffer_load_dwordx4 v3, s[40:43], s38 offen sc1 lds
    s_add_u32 m0, m0, 1008
    s_add_u32 s38, s38, 1024
    buffer_load_dwordx4 v3, s[40:43], s38 offen sc1 lds
    s_add_u32 m0, m0, 1008
    s_add_u32 s38, s38, 1024
    buffer_load_dwordx4 v3, s[40:43], s38 offen sc1 lds
    s_add_u32 m0, m0, 1008
    s_add_u32 s38, s38, 1024
    buffer_load_dwordx4 v3, s[40:43], s38 offen sc1 lds
    s_mov_b64 exec, -1
    buffer_load_dwordx4 v[24:27], v7, s[40:43], s50 offen offset:992 sc1
    v_mov_b32 v3, 1
    s_mov_b64 exec, 1
    ds_add_u32 v0, v3 offset:2028
    s_mov_b64 exec, -1
L_w29:
    s_sleep 1
    ds_read_b32 v3, v6 offset:4032
    s_sub_u32 s3, s3, 1
    s_cbranch_scc1 L_end
    s_waitcnt lgkmcnt(0)
    v_cmp_gt_u32 vcc, 6, v3
    s_cbranch_vccnz L_w29
    v_add_u32 v8, 0x10000, v8
    v_add_u32 v9, 0x10000, v9
    v_add_u32 v10, 0x10000, v10
    v_add_u32 v11, 0x10000, v11
    ds_read_b128 v[104:107], v8 offset:0
    ds_read_b128 v[108:111], v9 offset:0
    ds_read_b128 v[112:115], v10 offset:0
    ds_read_b128 v[116:119], v11 offset:0
    ds_read_b128 v[120:123], v8 offset:16384
    ds_read_b128 v[124:127], v9 offset:16384
    ds_read_b128 v[128:131], v10 offset:16384
    ds_read_b128 v[132:135], v11 offset:16384
    v_mov_b32 v3, 1
    s_mov_b64 exec, 1
    ds_add_u32 v0, v3 offset:3032
    s_mov_b64 exec, -1
L_w30:
    s_sleep 1
    ds_read_b32 v3, v6 offset:4032
    s_sub_u32 s3, s3, 1
    s_cbranch_scc1 L_end
    s_waitcnt lgkmcnt(0)
    v_cmp_gt_u32_e64 vcc, 8, v3
    s_cbranch_vccnz L_w30
    ds_read_b128 v[136:139], v8 offset:32768
    ds_read_b128 v[140:143], v9 offset:32768
    ds_read_b128 v[144:147], v10 offset:32768
    ds_read_b128 v[148:151], v11 offset:32768
    ds_read_b128 v[152:155], v8 offset:49152
    ds_read_b128 v[156:159], v9 offset:49152
    ds_read_b128 v[160:163], v10 offset:49152
    ds_read_b128 v[164:167], v11 offset:49152
    v_mov_b32 v3, 1
    s_mov_b64 exec, 1
    ds_add_u32 v0, v3 offset:3036
    s_mov_b64 exec, -1
L_pad_b_0:
    s_cbranch_execz L_pad_b_1
    v_lshl_add_u32 v3, v1, 4, s49
    s_waitcnt vmcnt(0) lgkmcnt(0)
    s_mov_b64 exec, s[56:57]
    ds_read_b128 v[8:11], v3 offset:0
    ds_read_b128 v[12:15], v3 offset:1008
    ds_read_b128 v[16:19], v3 offset:2016
    ds_read_b128 v[20:23], v3 offset:3024
    ds_read_b128 v[28:31], v3 offset:4032
    ds_read_b128 v[32:35], v3 offset:5040
    ds_read_b128 v[36:39], v3 offset:6048
    s_mov_b64 exec, -1
    v_max3_u32 v6, v24, v25, v26
    v_max_u32 v6, v6, v27
    s_mov_b64 exec, s[56:57]
    s_waitcnt lgkmcnt(6)
    v_max3_u32 v6, v6, v8, v9
    v_max3_u32 v6, v6, v10, v11
    ds_read_b128 v[8:11], v3 offset:7056
    s_waitcnt lgkmcnt(6)
    v_max3_u32 v6, v6, v12, v13
    v_max3_u32 v6, v6, v14, v15
    s_waitcnt lgkmcnt(5)
    v_max3_u32 v6, v6, v16, v17
    v_max3_u32 v6, v6, v18, v19
    s_waitcnt lgkmcnt(4)
    v_max3_u32 v6, v6, v20, v21
    v_max3_u32 v6, v6, v22, v23
    s_waitcnt lgkmcnt(3)
    v_max3_u32 v6, v6, v28, v29
    v_max3_u32 v6, v6, v30, v31
    s_waitcnt lgkmcnt(2)
    v_max3_u32 v6, v6, v32, v33
    v_max3_u32 v6, v6, v34, v35
    s_waitcnt lgkmcnt(1)
    v_max3_u32 v6, v6, v36, v37
    v_max3_u32 v6, v6, v38, v39
    s_waitcnt lgkmcnt(0)
    v_max3_u32 v6, v6, v8, v9
    v_max3_u32 v6, v6, v10, v11
    s_mov_b64 exec, -1
    v_cmp_eq_u32 vcc, -1, v6
    s_cbranch_vccnz L_B_qv
L_B_qok:
    v_mov_b32 v3, 1
    s_mov_b64 exec, 1
    ds_add_u32 v0, v3 offset:1008
    s_mov_b64 exec, -1
    s_setprio 2
L_w31:
    ds_read_b32 v3, v0 offset:1008
    s_sub_u32 s3, s3, 1
    s_cbranch_scc1 L_end
    s_waitcnt lgkmcnt(0)
    v_cmp_gt_u32 vcc, 4, v3
    s_cbranch_vccnz L_w31
    s_xor_b32 s38, s2, 40
    s_or_b32 s38, s38, s33
    s_cbranch_scc1 L_B_n3
    v_mov_b32 v3, 4
    s_mov_b64 exec, 1
    global_store_dword v3, v3, s[28:29] sc1
    s_mov_b64 exec, -1
L_B_n3:
    ds_read_b128 v[28:31], v4 offset:0
    ds_read_b128 v[32:35], v4 offset:32
    ds_read_b128 v[36:39], v4 offset:64
    s_waitcnt lgkmcnt(2)
    v_mfma_f32_32x32x16_bf16 v[8:23], v[40:43], v[28:31], 0
    ds_read_b128 v[40:43], v4 offset:96
    s_waitcnt lgkmcnt(2)
    v_mfma_f32_32x32x16_bf16 v[8:23], v[44:47], v[32:35], v[8:23]
    ds_read_b128 v[44:47], v4 offset:128
    s_waitcnt lgkmcnt(2)
    v_mfma_f32_32x32x16_bf16 v[8:23], v[48:51], v[36:39], v[8:23]
    ds_read_b128 v[48:51], v4 offset:160
    s_waitcnt lgkmcnt(2)
    v_mfma_f32_32x32x16_bf16 v[8:23], v[52:55], v[40:43], v[8:23]
    ds_read_b128 v[52:55], v4 offset:192
    s_waitcnt lgkmcnt(2)
    v_mfma_f32_32x32x16_bf16 v[8:23], v[56:59], v[44:47], v[8:23]
    ds_read_b128 v[56:59], v4 offset:224
    s_waitcnt lgkmcnt(2)
    v_mfma_f32_32x32x16_bf16 v[8:23], v[60:63], v[48:51], v[8:23]
    ds_read_b128 v[60:63], v4 offset:256
    s_waitcnt lgkmcnt(2)
    v_mfma_f32_32x32x16_bf16 v[8:23], v[64:67], v[52:55], v[8:23]
    ds_read_b128 v[64:67], v4 offset:288
    s_waitcnt lgkmcnt(2)
    v_mfma_f32_32x32x16_bf16 v[8:23], v[68:71], v[56:59], v[8:23]
    ds_read_b128 v[68:71], v4 offset:320
    s_waitcnt lgkmcnt(2)
    v_mfma_f32_32x32x16_bf16 v[8:23], v[72:75], v[60:63], v[8:23]
    ds_read_b128 v[72:75], v4 offset:352
    s_waitcnt lgkmcnt(2)
    v_mfma_f32_32x32x16_bf16 v[8:23], v[76:79], v[64:67], v[8:23]
    ds_read_b128 v[76:79], v4 offset:384
    s_waitcnt lgkmcnt(2)
    v_mfma_f32_32x32x16_bf16 v[8:23], v[80:83], v[68:71], v[8:23]
    ds_read_b128 v[80:83], v4 offset:416
    s_waitcnt lgkmcnt(2)
    v_mfma_f32_32x32x16_bf16 v[8:23], v[84:87], v[72:75], v[8:23]
    ds_read_b128 v[84:87], v4 offset:448
    s_waitcnt lgkmcnt(2)
    v_mfma_f32_32x32x16_bf16 v[8:23], v[88:91], v[76:79], v[8:23]
    ds_read_b128 v[88:91], v4 offset:480
    s_waitcnt lgkmcnt(2)
    v_mfma_f32_32x32x16_bf16 v[8:23], v[92:95], v[80:83], v[8:23]
    ds_read_b128 v[92:95], v4 offset:512
    s_waitcnt lgkmcnt(2)
    v_mfma_f32_32x32x16_bf16 v[8:23], v[96:99], v[84:87], v[8:23]
    ds_read_b128 v[96:99], v4 offset:544
    s_waitcnt lgkmcnt(2)
    v_mfma_f32_32x32x16_bf16 v[8:23], v[100:103], v[88:91], v[8:23]
    ds_read_b128 v[100:103], v4 offset:576
    s_waitcnt lgkmcnt(2)
    v_mfma_f32_32x32x16_bf16 v[8:23], v[104:107], v[92:95], v[8:23]
    ds_read_b128 v[104:107], v4 offset:608
    s_waitcnt lgkmcnt(2)
    v_mfma_f32_32x32x16_bf16 v[8:23], v[108:111], v[96:99], v[8:23]
    ds_read_b128 v[108:111], v4 offset:640
    s_waitcnt lgkmcnt(2)
    v_mfma_f32_32x32x16_bf16 v[8:23], v[112:115], v[100:103], v[8:23]
    ds_read_b128 v[112:115], v4 offset:672
    s_waitcnt lgkmcnt(2)
    v_mfma_f32_32x32x16_bf16 v[8:23], v[116:119], v[104:107], v[8:23]
L_pad_b_1:
    s_cbranch_execz L_pad_b_2
    ds_read_b128 v[116:119], v4 offset:704
    s_waitcnt lgkmcnt(2)
    v_mfma_f32_32x32x16_bf16 v[8:23], v[120:123], v[108:111], v[8:23]
    ds_read_b128 v[120:123], v4 offset:736
    s_waitcnt lgkmcnt(2)
    v_mfma_f32_32x32x16_bf16 v[8:23], v[124:127], v[112:115], v[8:23]
    ds_read_b128 v[124:127], v4 offset:768
    s_waitcnt lgkmcnt(2)
    v_mfma_f32_32x32x16_bf16 v[8:23], v[128:131], v[116:119], v[8:23]
    ds_read_b128 v[128:131], v4 offset:800
    s_waitcnt lgkmcnt(2)
    v_mfma_f32_32x32x16_bf16 v[8:23], v[132:135], v[120:123], v[8:23]
    ds_read_b128 v[132:135], v4 offset:832
    s_waitcnt lgkmcnt(2)
    v_mfma_f32_32x32x16_bf16 v[8:23], v[136:139], v[124:127], v[8:23]
    ds_read_b128 v[136:139], v4 offset:864
    s_waitcnt lgkmcnt(2)
    v_mfma_f32_32x32x16_bf16 v[8:23], v[140:143], v[128:131], v[8:23]
    ds_read_b128 v[140:143], v4 offset:896
    s_waitcnt lgkmcnt(2)
    v_mfma_f32_32x32x16_bf16 v[8:23], v[144:147], v[132:135], v[8:23]
    ds_read_b128 v[144:147], v4 offset:928
    s_waitcnt lgkmcnt(2)
    v_mfma_f32_32x32x16_bf16 v[8:23], v[148:151], v[136:139], v[8:23]
    ds_read_b128 v[148:151], v4 offset:960
    s_waitcnt lgkmcnt(2)
    v_mfma_f32_32x32x16_bf16 v[8:23], v[152:155], v[140:143], v[8:23]
    s_waitcnt lgkmcnt(1)
    v_mfma_f32_32x32x16_bf16 v[8:23], v[156:159], v[144:147], v[8:23]
    s_waitcnt lgkmcnt(0)
    v_mfma_f32_32x32x16_bf16 v[8:23], v[160:163], v[148:151], v[8:23]
    v_mfma_f32_32x32x16_bf16 v[8:23], v[164:167], v[24:27], v[8:23]
    v_add_u32 v4, s53, v0
    v_add_u32_e64 v166, s53, v5
    s_lshl_b32 s38, s33, 11
    s_add_u32 s38, s38, 131072
    v_lshl_add_u32 v167, v1, 4, s38
    s_nop 6
    v_max3_f32 v164, v8, v9, v10
    v_max3_f32 v165, v11, v12, v13
    v_max3_f32 v164, v164, v14, v15
    v_max3_f32 v165, v165, v16, v17
    v_max3_f32 v164, v164, v18, v19
    v_max3_f32 v165, v165, v20, v21
    v_max3_f32 v164, v164, v22, v23
    v_max_f32 v164, v164, v165
    v_mov_b32 v165, v164
    s_nop 1
    v_permlane32_swap_b32 v164, v165
    v_max_f32 v164, v164, v165
    ds_write_b32 v166, v164 offset:7072
    v_mul_f32 v164, s52, v164
    v_pk_fma_f32 v[8:9], v[8:9], s[52:53], v[164:165] op_sel_hi:[1,0,0] neg_lo:[0,0,1] neg_hi:[0,0,1]
    v_pk_fma_f32 v[10:11], v[10:11], s[52:53], v[164:165] op_sel_hi:[1,0,0] neg_lo:[0,0,1] neg_hi:[0,0,1]
    v_pk_fma_f32 v[12:13], v[12:13], s[52:53], v[164:165] op_sel_hi:[1,0,0] neg_lo:[0,0,1] neg_hi:[0,0,1]
    v_pk_fma_f32 v[14:15], v[14:15], s[52:53], v[164:165] op_sel_hi:[1,0,0] neg_lo:[0,0,1] neg_hi:[0,0,1]
    v_pk_fma_f32 v[16:17], v[16:17], s[52:53], v[164:165] op_sel_hi:[1,0,0] neg_lo:[0,0,1] neg_hi:[0,0,1]
    v_pk_fma_f32 v[18:19], v[18:19], s[52:53], v[164:165] op_sel_hi:[1,0,0] neg_lo:[0,0,1] neg_hi:[0,0,1]
    v_pk_fma_f32 v[20:21], v[20:21], s[52:53], v[164:165] op_sel_hi:[1,0,0] neg_lo:[0,0,1] neg_hi:[0,0,1]
    v_pk_fma_f32 v[22:23], v[22:23], s[52:53], v[164:165] op_sel_hi:[1,0,0] neg_lo:[0,0,1] neg_hi:[0,0,1]
    v_exp_f32 v8, v8
    v_exp_f32 v9, v9
    v_exp_f32 v10, v10
    v_exp_f32 v11, v11
    v_exp_f32 v12, v12
    v_exp_f32 v13, v13
    v_exp_f32 v14, v14
    v_exp_f32 v15, v15
    ds_read_b128 v[160:163], v5 offset:7072
    v_exp_f32 v16, v16
    v_exp_f32 v17, v17
    v_exp_f32 v18, v18
    v_exp_f32 v19, v19
    v_exp_f32 v20, v20
    v_exp_f32 v21, v21
    v_exp_f32 v22, v22
    v_exp_f32 v23, v23
    s_waitcnt lgkmcnt(0)
L_B_mx0:
    v_max3_u32 v152, v160, v161, v162
    v_max_u32 v152, v152, v163
    v_cmp_eq_u32 vcc, -1, v152
    v_max3_f32 v153, v160, v161, v162
    v_max_f32 v153, v153, v163
    s_cbranch_vccnz L_B_my0
    v_mul_f32 v6, s52, v153
    v_sub_f32 v164, v164, v6
    v_exp_f32 v164, v164
    v_mov_b32_e64 v161, 1
    v_pk_mul_f32 v[8:9], v[8:9], v[164:165] op_sel_hi:[1,0]
    v_pk_mul_f32 v[10:11], v[10:11], v[164:165] op_sel_hi:[1,0]
    v_pk_mul_f32 v[12:13], v[12:13], v[164:165] op_sel_hi:[1,0]
    v_pk_mul_f32 v[14:15], v[14:15], v[164:165] op_sel_hi:[1,0]
    v_cvt_pk_bf16_f32 v152, v8, v9
    v_cvt_pk_bf16_f32 v153, v10, v11
    v_cvt_pk_bf16_f32 v154, v12, v13
    v_cvt_pk_bf16_f32 v155, v14, v15
    ds_write_b128 v167, v[152:155] offset:0
    v_pk_mul_f32 v[16:17], v[16:17], v[164:165] op_sel_hi:[1,0]
    v_pk_mul_f32 v[18:19], v[18:19], v[164:165] op_sel_hi:[1,0]
    v_pk_mul_f32 v[20:21], v[20:21], v[164:165] op_sel_hi:[1,0]
    v_pk_mul_f32 v[22:23], v[22:23], v[164:165] op_sel_hi:[1,0]
    v_cvt_pk_bf16_f32 v156, v16, v17
    v_cvt_pk_bf16_f32 v157, v18, v19
    v_cvt_pk_bf16_f32 v158, v20, v21
    v_cvt_pk_bf16_f32 v159, v22, v23
    ds_write_b128 v167, v[156:159] offset:1024
    v_add_u32 v5, -8800, v5
    v_add_u32 v166, s53, v5
    v_mov_b32 v165, -1
    ds_write_b32 v166, v165
    s_mov_b64 exec, 1
    ds_add_u32 v0, v161 offset:1016
    s_mov_b64 exec, -1
    v_pk_add_f32 v[8:9], v[8:9], v[16:17]
    v_pk_add_f32 v[10:11], v[10:11], v[18:19]
    v_pk_add_f32 v[12:13], v[12:13], v[20:21]
    v_pk_add_f32 v[14:15], v[14:15], v[22:23]
    v_pk_add_f32 v[8:9], v[8:9], v[12:13]
    v_pk_add_f32 v[10:11], v[10:11], v[14:15]
    v_pk_add_f32 v[8:9], v[8:9], v[10:11]
    v_add_f32 v7, v8, v9
L_w32:
    ds_read_b32 v3, v0 offset:1016
L_pad_b_2:
    s_cbranch_execz L_pad_b_3
    s_sub_u32 s3, s3, 1
    s_cbranch_scc1 L_end
    s_waitcnt lgkmcnt(0)
    v_cmp_gt_u32 vcc, 4, v3
    s_cbranch_vccnz L_w32
L_w33:
    ds_read_b32 v3, v4 offset:4032
    s_sub_u32 s3, s3, 1
    s_cbranch_scc1 L_end
    s_waitcnt lgkmcnt(0)
    v_cmp_gt_u32 vcc, 10, v3
    s_cbranch_vccnz L_w33
    ds_read_b128 v[152:155], v2 offset:0
    v_xor_b32 v3, 32, v2
    ds_read_b128 v[156:159], v3 offset:0
    v_xor_b32 v3, 64, v2
    ds_read_b128 v[160:163], v3 offset:0
    v_xor_b32 v3, 96, v2
    ds_read_b128 v[164:167], v3 offset:0
    s_waitcnt lgkmcnt(3)
    v_mfma_f32_32x32x16_bf16 v[8:23], v[152:155], v[28:31], 0
    ds_read_b128 v[152:155], v2 offset:16384
    s_waitcnt lgkmcnt(3)
    v_mfma_f32_32x32x16_bf16 v[8:23], v[156:159], v[32:35], v[8:23]
    v_xor_b32 v3, 32, v2
    ds_read_b128 v[156:159], v3 offset:16384
    s_waitcnt lgkmcnt(3)
    v_mfma_f32_32x32x16_bf16 v[8:23], v[160:163], v[36:39], v[8:23]
    v_xor_b32 v3, 64, v2
    ds_read_b128 v[160:163], v3 offset:16384
    s_waitcnt lgkmcnt(3)
    v_mfma_f32_32x32x16_bf16 v[8:23], v[164:167], v[40:43], v[8:23]
    v_xor_b32 v3, 96, v2
    ds_read_b128 v[164:167], v3 offset:16384
    s_waitcnt lgkmcnt(3)
    v_mfma_f32_32x32x16_bf16 v[8:23], v[152:155], v[44:47], v[8:23]
L_w34:
    ds_read_b32 v3, v4 offset:4032
    s_sub_u32 s3, s3, 1
    s_cbranch_scc1 L_end
    s_waitcnt lgkmcnt(0)
    v_cmp_gt_u32 vcc, 12, v3
    s_cbranch_vccnz L_w34
    ds_read_b128 v[152:155], v2 offset:32768
    s_waitcnt lgkmcnt(3)
    v_mfma_f32_32x32x16_bf16 v[8:23], v[156:159], v[48:51], v[8:23]
    v_xor_b32 v3, 32, v2
    ds_read_b128 v[156:159], v3 offset:32768
    s_waitcnt lgkmcnt(3)
    v_mfma_f32_32x32x16_bf16 v[8:23], v[160:163], v[52:55], v[8:23]
    v_xor_b32 v3, 64, v2
    ds_read_b128 v[160:163], v3 offset:32768
    s_waitcnt lgkmcnt(3)
    v_mfma_f32_32x32x16_bf16 v[8:23], v[164:167], v[56:59], v[8:23]
    v_xor_b32 v3, 96, v2
    ds_read_b128 v[164:167], v3 offset:32768
    s_waitcnt lgkmcnt(3)
    v_mfma_f32_32x32x16_bf16 v[8:23], v[152:155], v[60:63], v[8:23]
    ds_read_b128 v[152:155], v2 offset:49152
    s_waitcnt lgkmcnt(3)
    v_mfma_f32_32x32x16_bf16 v[8:23], v[156:159], v[64:67], v[8:23]
    v_xor_b32 v3, 32, v2
    ds_read_b128 v[156:159], v3 offset:49152
    s_waitcnt lgkmcnt(3)
    v_mfma_f32_32x32x16_bf16 v[8:23], v[160:163], v[68:71], v[8:23]
    v_xor_b32 v3, 64, v2
    ds_read_b128 v[160:163], v3 offset:49152
    s_waitcnt lgkmcnt(3)
    v_mfma_f32_32x32x16_bf16 v[8:23], v[164:167], v[72:75], v[8:23]
    v_xor_b32 v3, 96, v2
    ds_read_b128 v[164:167], v3 offset:49152
    s_waitcnt lgkmcnt(3)
    v_mfma_f32_32x32x16_bf16 v[8:23], v[152:155], v[76:79], v[8:23]
    v_add_u32 v2, 0x10000, v2
L_w35:
    ds_read_b32 v3, v4 offset:4032
    s_sub_u32 s3, s3, 1
    s_cbranch_scc1 L_end
    s_waitcnt lgkmcnt(0)
    v_cmp_gt_u32 vcc, 13, v3
    s_cbranch_vccnz L_w35
    ds_read_b128 v[152:155], v2 offset:0
    s_waitcnt lgkmcnt(3)
    v_mfma_f32_32x32x16_bf16 v[8:23], v[156:159], v[80:83], v[8:23]
    v_xor_b32 v3, 32, v2
    ds_read_b128 v[156:159], v3 offset:0
    s_waitcnt lgkmcnt(3)
    v_mfma_f32_32x32x16_bf16 v[8:23], v[160:163], v[84:87], v[8:23]
    v_xor_b32 v3, 64, v2
    ds_read_b128 v[160:163], v3 offset:0
    s_waitcnt lgkmcnt(3)
    v_mfma_f32_32x32x16_bf16 v[8:23], v[164:167], v[88:91], v[8:23]
    v_xor_b32 v3, 96, v2
    ds_read_b128 v[164:167], v3 offset:0
    s_waitcnt lgkmcnt(3)
    v_mfma_f32_32x32x16_bf16 v[8:23], v[152:155], v[92:95], v[8:23]
L_w36:
    ds_read_b32 v3, v4 offset:4032
    s_sub_u32 s3, s3, 1
    s_cbranch_scc1 L_end
    s_waitcnt lgkmcnt(0)
    v_cmp_gt_u32 vcc, 14, v3
    s_cbranch_vccnz L_w36
    ds_read_b128 v[152:155], v2 offset:16384
    s_waitcnt lgkmcnt(3)
    v_mfma_f32_32x32x16_bf16 v[8:23], v[156:159], v[96:99], v[8:23]
    v_xor_b32 v3, 32, v2
    ds_read_b128 v[156:159], v3 offset:16384
    s_waitcnt lgkmcnt(3)
    v_mfma_f32_32x32x16_bf16 v[8:23], v[160:163], v[100:103], v[8:23]
    v_xor_b32 v3, 64, v2
    ds_read_b128 v[160:163], v3 offset:16384
    s_waitcnt lgkmcnt(3)
    v_mfma_f32_32x32x16_bf16 v[8:23], v[164:167], v[104:107], v[8:23]
    v_xor_b32 v3, 96, v2
    ds_read_b128 v[164:167], v3 offset:16384
    s_waitcnt lgkmcnt(3)
    v_mfma_f32_32x32x16_bf16 v[8:23], v[152:155], v[108:111], v[8:23]
L_w37:
    ds_read_b32 v3, v4 offset:4032
    s_sub_u32 s3, s3, 1
    s_cbranch_scc1 L_end
    s_waitcnt lgkmcnt(0)
    v_cmp_gt_u32 vcc, 15, v3
    s_cbranch_vccnz L_w37
    ds_read_b128 v[152:155], v2 offset:32768
    s_waitcnt lgkmcnt(3)
    v_mfma_f32_32x32x16_bf16 v[8:23], v[156:159], v[112:115], v[8:23]
    v_xor_b32 v3, 32, v2
    ds_read_b128 v[156:159], v3 offset:32768
    s_waitcnt lgkmcnt(3)
    v_mfma_f32_32x32x16_bf16 v[8:23], v[160:163], v[116:119], v[8:23]
    v_xor_b32 v3, 64, v2
    ds_read_b128 v[160:163], v3 offset:32768
    s_waitcnt lgkmcnt(3)
L_pad_b_3:
    s_cbranch_execz L_pad_b_4
    v_mfma_f32_32x32x16_bf16 v[8:23], v[164:167], v[120:123], v[8:23]
    v_xor_b32 v3, 96, v2
    ds_read_b128 v[164:167], v3 offset:32768
    s_waitcnt lgkmcnt(3)
    v_mfma_f32_32x32x16_bf16 v[8:23], v[152:155], v[124:127], v[8:23]
L_w38:
    ds_read_b32 v3, v4 offset:4032
    s_sub_u32 s3, s3, 1
    s_cbranch_scc1 L_end
    s_waitcnt lgkmcnt(0)
    v_cmp_gt_u32 vcc, 16, v3
    s_cbranch_vccnz L_w38
    ds_read_b128 v[152:155], v2 offset:49152
    s_waitcnt lgkmcnt(3)
    v_mfma_f32_32x32x16_bf16 v[8:23], v[156:159], v[128:131], v[8:23]
    v_xor_b32 v3, 32, v2
    ds_read_b128 v[156:159], v3 offset:49152
    s_waitcnt lgkmcnt(3)
    v_mfma_f32_32x32x16_bf16 v[8:23], v[160:163], v[132:135], v[8:23]
    v_xor_b32 v3, 64, v2
    ds_read_b128 v[160:163], v3 offset:49152
    s_waitcnt lgkmcnt(3)
    v_mfma_f32_32x32x16_bf16 v[8:23], v[164:167], v[136:139], v[8:23]
    v_xor_b32 v3, 96, v2
    ds_read_b128 v[164:167], v3 offset:49152
    s_waitcnt lgkmcnt(3)
    v_mfma_f32_32x32x16_bf16 v[8:23], v[152:155], v[140:143], v[8:23]
    s_waitcnt lgkmcnt(2)
    v_mfma_f32_32x32x16_bf16 v[8:23], v[156:159], v[144:147], v[8:23]
    s_waitcnt lgkmcnt(1)
    v_mfma_f32_32x32x16_bf16 v[8:23], v[160:163], v[148:151], v[8:23]
    s_waitcnt lgkmcnt(0)
    v_mfma_f32_32x32x16_bf16 v[8:23], v[164:167], v[24:27], v[8:23]
    v_add_u32_e64 v166, s53, v5
    s_lshl_b32 s38, s33, 11
    s_add_u32 s38, s38, 139264
    v_lshl_add_u32 v167, v1, 4, s38
    s_nop 7
    v_max3_f32 v164, v8, v9, v10
    v_max3_f32 v165, v11, v12, v13
    v_max3_f32 v164, v164, v14, v15
    v_max3_f32 v165, v165, v16, v17
    v_max3_f32 v164, v164, v18, v19
    v_max3_f32 v165, v165, v20, v21
    v_max3_f32 v164, v164, v22, v23
    v_max_f32 v164, v164, v165
    v_mov_b32 v165, v164
    s_nop 1
    v_permlane32_swap_b32 v164, v165
    v_max_f32 v164, v164, v165
    ds_write_b32 v166, v164 offset:0
    v_mul_f32 v164, s52, v164
    v_pk_fma_f32 v[8:9], v[8:9], s[52:53], v[164:165] op_sel_hi:[1,0,0] neg_lo:[0,0,1] neg_hi:[0,0,1]
    v_pk_fma_f32 v[10:11], v[10:11], s[52:53], v[164:165] op_sel_hi:[1,0,0] neg_lo:[0,0,1] neg_hi:[0,0,1]
    v_pk_fma_f32 v[12:13], v[12:13], s[52:53], v[164:165] op_sel_hi:[1,0,0] neg_lo:[0,0,1] neg_hi:[0,0,1]
    v_pk_fma_f32 v[14:15], v[14:15], s[52:53], v[164:165] op_sel_hi:[1,0,0] neg_lo:[0,0,1] neg_hi:[0,0,1]
    v_pk_fma_f32 v[16:17], v[16:17], s[52:53], v[164:165] op_sel_hi:[1,0,0] neg_lo:[0,0,1] neg_hi:[0,0,1]
    v_pk_fma_f32 v[18:19], v[18:19], s[52:53], v[164:165] op_sel_hi:[1,0,0] neg_lo:[0,0,1] neg_hi:[0,0,1]
    v_pk_fma_f32 v[20:21], v[20:21], s[52:53], v[164:165] op_sel_hi:[1,0,0] neg_lo:[0,0,1] neg_hi:[0,0,1]
    v_pk_fma_f32 v[22:23], v[22:23], s[52:53], v[164:165] op_sel_hi:[1,0,0] neg_lo:[0,0,1] neg_hi:[0,0,1]
    v_exp_f32 v8, v8
    v_exp_f32 v9, v9
    v_exp_f32 v10, v10
    v_exp_f32 v11, v11
    v_exp_f32 v12, v12
    v_exp_f32 v13, v13
    v_exp_f32 v14, v14
    v_exp_f32 v15, v15
    ds_read_b128 v[160:163], v5 offset:0
    v_exp_f32 v16, v16
    v_exp_f32 v17, v17
    v_exp_f32 v18, v18
    v_exp_f32 v19, v19
    v_exp_f32 v20, v20
    v_exp_f32 v21, v21
    v_exp_f32 v22, v22
    v_exp_f32 v23, v23
    s_waitcnt lgkmcnt(0)
L_B_mx1:
    v_max3_u32 v152, v160, v161, v162
    v_max_u32 v152, v152, v163
    v_cmp_eq_u32 vcc, -1, v152
    v_max3_f32 v153, v160, v161, v162
    v_max_f32 v153, v153, v163
    s_cbranch_vccnz L_B_my1
    v_mul_f32 v153, s52, v153
    v_max_f32 v160, v153, v6
    v_sub_f32 v164, v164, v160
    v_exp_f32 v164, v164
    v_mov_b32 v161, 1
    v_pk_mul_f32 v[8:9], v[8:9], v[164:165] op_sel_hi:[1,0]
    v_pk_mul_f32 v[10:11], v[10:11], v[164:165] op_sel_hi:[1,0]
    v_pk_mul_f32 v[12:13], v[12:13], v[164:165] op_sel_hi:[1,0]
    v_pk_mul_f32 v[14:15], v[14:15], v[164:165] op_sel_hi:[1,0]
    v_cvt_pk_bf16_f32 v152, v8, v9
    v_cvt_pk_bf16_f32 v153, v10, v11
    v_cvt_pk_bf16_f32 v154, v12, v13
    v_cvt_pk_bf16_f32 v155, v14, v15
    ds_write_b128 v167, v[152:155] offset:0
    v_pk_mul_f32 v[16:17], v[16:17], v[164:165] op_sel_hi:[1,0]
    v_pk_mul_f32 v[18:19], v[18:19], v[164:165] op_sel_hi:[1,0]
    v_pk_mul_f32 v[20:21], v[20:21], v[164:165] op_sel_hi:[1,0]
    v_pk_mul_f32 v[22:23], v[22:23], v[164:165] op_sel_hi:[1,0]
    v_cvt_pk_bf16_f32 v156, v16, v17
    v_cvt_pk_bf16_f32 v157, v18, v19
    v_cvt_pk_bf16_f32 v158, v20, v21
    v_cvt_pk_bf16_f32 v159, v22, v23
    ds_write_b128 v167, v[156:159] offset:1024
    s_mov_b64 exec, 1
    ds_add_u32 v0, v161 offset:1016
    s_mov_b64 exec, -1
    v_sub_f32 v165, v6, v160
    v_exp_f32 v165, v165
    v_mov_b32_e64 v6, v160
    v_pk_add_f32 v[8:9], v[8:9], v[16:17]
    v_pk_add_f32 v[10:11], v[10:11], v[18:19]
    v_pk_add_f32 v[12:13], v[12:13], v[20:21]
    v_pk_add_f32 v[14:15], v[14:15], v[22:23]
    v_pk_add_f32 v[8:9], v[8:9], v[12:13]
    v_pk_add_f32 v[10:11], v[10:11], v[14:15]
    v_pk_add_f32 v[8:9], v[8:9], v[10:11]
    v_add_f32 v8, v8, v9
    v_fmac_f32 v8, v7, v165
    v_mov_b32 v9, v8
    s_nop 1
    v_permlane32_swap_b32 v8, v9
    v_add_f32 v8, v8, v9
    ds_write_b32 v166, v8 offset:1024
    v_mov_b32 v164, 1
L_pad_b_4:
    s_cbranch_execz L_pad_b_5
    s_mov_b64 exec, 1
    ds_add_u32 v0, v164 offset:1020
    s_mov_b64 exec, -1
    s_cmp_lg_u32 s33, 0
    s_cbranch_scc1 L_B_F
    v_and_b32 v2, 7, v1
    v_lshlrev_b32 v2, 7, v2
    v_and_or_b32 v2, v1, 24, v2
    s_lshl_b32 s49, s61, 10
    s_add_u32 s49, s49, 1048576
L_w39:
    ds_read_b32 v3, v0 offset:1020
    s_sub_u32 s3, s3, 1
    s_cbranch_scc1 L_end
    s_waitcnt lgkmcnt(0)
    v_cmp_gt_u32 vcc, 4, v3
    s_cbranch_vccnz L_w39
    ds_read_b128 v[8:11], v5 offset:1024
    s_waitcnt lgkmcnt(0)
    v_add_f32 v8, v8, v9
    v_add_f32 v10, v10, v11
    v_add_f32 v7, v8, v10
L_w40:
    ds_read_b32 v3, v0 offset:2024
    s_sub_u32 s3, s3, 1
    s_cbranch_scc1 L_end
    s_waitcnt lgkmcnt(0)
    v_cmp_gt_u32 vcc, 4, v3
    s_cbranch_vccnz L_w40
L_w41:
    s_sleep 1
    ds_read_b32 v3, v0 offset:7060
    s_sub_u32 s3, s3, 1
    s_cbranch_scc1 L_end
    s_waitcnt lgkmcnt(0)
    v_cmp_gt_u32 vcc, 1, v3
    s_cbranch_vccnz L_w41
    s_mov_b32 exec_hi, 0
    buffer_store_dwordx2 v[6:7], v2, s[40:43], s49 offen sc1
    s_mov_b64 exec, -1
    v_mov_b32 v3, 1
    s_mov_b64 exec, 1
    ds_add_u32 v0, v3 offset:1012
    s_mov_b64 exec, -1
L_B_F:
    s_setprio 0
    s_cmp_ge_u32 s35, 28
    s_cbranch_scc1 L_end
    v_bfe_u32 v12, v1, 4, 1
    v_lshlrev_b32 v12, 1, v12
    v_and_b32 v13, 7, v1
    v_xor_b32 v12, v12, v13
    v_lshlrev_b32 v164, 4, v12
    v_lshrrev_b32 v165, 3, v1
    v_lshrrev_b32 v6, 4, v1
    v_bfe_u32 v8, v1, 2, 2
    v_lshl_add_u32 v9, v6, 3, v8
    v_lshrrev_b32 v8, 1, v8
    v_and_b32 v10, 1, v6
    v_lshl_or_b32 v8, v10, 1, v8
    v_xor_b32 v8, s33, v8
    v_lshlrev_b32 v8, 5, v8
    v_lshl_add_u32 v8, v9, 7, v8
    v_and_b32 v9, 3, v1
    v_lshl_add_u32 v2, v9, 3, v8
    v_bfe_u32 v7, v1, 3, 1
    v_lshl_add_u32 v8, v7, 2, v9
    v_mul_u32_u24 v8, 1088, v8
    v_lshl_add_u32 v8, v6, 4, v8
    v_add_u32 v4, 135424, v8
    v_and_b32_e64 v9, 1, v1
    v_lshl_add_u32 v8, v7, 1, v9
    v_mul_u32_u24 v8, 1088, v8
    v_lshl_add_u32 v8, v6, 4, v8
    v_add_u32 v5, 131072, v8
    v_mul_u32_u24 v8, 144, v7
    v_lshl_add_u32 v8, v6, 3, v8
    s_lshl_b32 s38, s33, 5
    s_add_u32 s38, s38, 144128
    v_add_u32 v6, s38, v8
    v_lshlrev_b32 v7, 5, v7
    v_add_u32 v7, 149504, v7
    s_mov_b32 s44, s18
    s_mov_b32 s45, s19
    s_mov_b32 s46, 1835008
    s_mov_b32 s47, 0x20000
    s_lshl_b32 s58, s35, 7
L_w42:
    s_sleep 2
    ds_read_b32 v3, v0 offset:1012
    s_sub_u32 s3, s3, 1
    s_cbranch_scc1 L_end
    s_waitcnt lgkmcnt(0)
    v_cmp_gt_u32 vcc, 5, v3
    s_cbranch_vccnz L_w42

    v_mul_u32_u24 v12, 3584, v165
    v_add_u32 v12, v12, v164
    v_xor_b32 v13, 64, v12
    s_mul_i32 s38, s33, 458752
    s_add_u32 s58, s58, s38
    s_lshl_b32 s57, s33, 14
    s_add_u32 s57, s57, 0
    s_and_b32 s56, s34, 3
    s_mov_b32 s59, 0
L_A_f1:
    s_xor_b32 s38, s59, s56
    s_lshl_b32 s39, s38, 12
    s_add_u32 s39, s39, s57
    s_mul_i32 s38, s38, 114688
    s_add_u32 s38, s38, s58
    s_add_u32 m0, s39, 0
    s_add_u32 s60, s38, 0
    buffer_load_dwordx4 v12, s[44:47], s60 offen lds
    s_waitcnt vmcnt(3)
    s_add_u32 m0, s39, 1024
    s_add_u32 s60, s38, 28672
    buffer_load_dwordx4 v13, s[44:47], s60 offen lds
    s_waitcnt vmcnt(3)
    s_add_u32 m0, s39, 2048
    s_add_u32 s60, s38, 57344
    buffer_load_dwordx4 v12, s[44:47], s60 offen lds
    s_waitcnt vmcnt(3)
    s_add_u32 m0, s39, 3072
    s_add_u32 s60, s38, 86016
    buffer_load_dwordx4 v13, s[44:47], s60 offen lds
    s_waitcnt vmcnt(3)
    s_add_u32 s59, s59, 1
    s_cmp_lt_u32 s59, 4
    s_cbranch_scc1 L_A_f1
    v_mov_b32 v3, 1
    s_mov_b64 exec, 1
    ds_add_u32 v0, v3 offset:5044
    s_mov_b64 exec, -1
    s_waitcnt vmcnt(0)
    v_mov_b32 v3, 1
    s_mov_b64 exec, 1
    ds_add_u32 v0, v3 offset:5040
    s_mov_b64 exec, -1
L_w43:
    s_sleep 1
    ds_read_b32 v3, v0 offset:5040
    s_sub_u32 s3, s3, 1
    s_cbranch_scc1 L_end
    s_waitcnt lgkmcnt(0)
    v_cmp_gt_u32 vcc, 4, v3
    s_cbranch_vccnz L_w43
    ds_read_b64_tr_b16 v[104:105], v2 offset:0
    ds_read_b64_tr_b16 v[106:107], v2 offset:512
    ds_read_b64_tr_b16 v[108:109], v2 offset:4096
L_pad_b_5:
    s_cbranch_execz L_pad_b_6
    ds_read_b64_tr_b16 v[110:111], v2 offset:4608
    ds_read_b64_tr_b16 v[112:113], v2 offset:8192
    ds_read_b64_tr_b16 v[114:115], v2 offset:8704
    ds_read_b64_tr_b16 v[116:117], v2 offset:12288
    ds_read_b64_tr_b16 v[118:119], v2 offset:12800
    s_waitcnt lgkmcnt(4)
    s_nop 0
    ds_read_b64_tr_b16 v[120:121], v2 offset:16384
    ds_read_b64_tr_b16 v[122:123], v2 offset:16896
    ds_read_b64_tr_b16 v[124:125], v2 offset:20480
    ds_read_b64_tr_b16 v[126:127], v2 offset:20992
    ds_read_b64_tr_b16 v[128:129], v2 offset:24576
    ds_read_b64_tr_b16 v[130:131], v2 offset:25088
    ds_read_b64_tr_b16 v[132:133], v2 offset:28672
    ds_read_b64_tr_b16 v[134:135], v2 offset:29184
    s_waitcnt lgkmcnt(4)
    s_nop 0
    ds_read_b64_tr_b16 v[136:137], v2 offset:32768
    ds_read_b64_tr_b16 v[138:139], v2 offset:33280
    ds_read_b64_tr_b16 v[140:141], v2 offset:36864
    ds_read_b64_tr_b16 v[142:143], v2 offset:37376
    ds_read_b64_tr_b16 v[144:145], v2 offset:40960
    ds_read_b64_tr_b16 v[146:147], v2 offset:41472
    ds_read_b64_tr_b16 v[148:149], v2 offset:45056
    ds_read_b64_tr_b16 v[150:151], v2 offset:45568
    s_waitcnt lgkmcnt(4)
    s_nop 0
    ds_read_b64_tr_b16 v[152:153], v2 offset:49152
    ds_read_b64_tr_b16 v[154:155], v2 offset:49664
    ds_read_b64_tr_b16 v[156:157], v2 offset:53248
    ds_read_b64_tr_b16 v[158:159], v2 offset:53760
    ds_read_b64_tr_b16 v[160:161], v2 offset:57344
    ds_read_b64_tr_b16 v[162:163], v2 offset:57856
    ds_read_b64_tr_b16 v[164:165], v2 offset:61440
    ds_read_b64_tr_b16 v[166:167], v2 offset:61952
    s_waitcnt lgkmcnt(4)
L_w44:
    s_sleep 1
    ds_read_b32 v3, v0 offset:5048
    s_sub_u32 s3, s3, 1
    s_cbranch_scc1 L_end
    s_waitcnt lgkmcnt(0)
    v_cmp_gt_u32_e64 vcc, 4, v3
    s_cbranch_vccnz L_w44
    ds_read_b128 v[40:43], v4 offset:0
    ds_read_b128 v[44:47], v4 offset:64
    ds_read_b128 v[48:51], v4 offset:128
    ds_read_b128 v[52:55], v4 offset:192
    ds_read_b128 v[56:59], v4 offset:256
    ds_read_b128 v[60:63], v4 offset:320
    ds_read_b128 v[64:67], v4 offset:384
    ds_read_b128 v[68:71], v4 offset:448
    ds_read_b128 v[72:75], v4 offset:512
    ds_read_b128 v[76:79], v4 offset:576
    ds_read_b128 v[80:83], v4 offset:640
    ds_read_b128 v[84:87], v4 offset:704
    s_waitcnt lgkmcnt(11)
    v_mfma_f32_16x16x32_bf16 v[8:11], v[104:107], v[40:43], 0
    ds_read_b128 v[88:91], v4 offset:768
    s_waitcnt lgkmcnt(11)
    v_mfma_f32_16x16x32_bf16 v[12:15], v[108:111], v[44:47], 0
    ds_read_b128 v[92:95], v4 offset:832
    s_waitcnt lgkmcnt(11)
    v_mfma_f32_16x16x32_bf16 v[8:11], v[112:115], v[48:51], v[8:11]
    ds_read_b128 v[96:99], v4 offset:896
    s_waitcnt lgkmcnt(11)
    v_mfma_f32_16x16x32_bf16 v[12:15], v[116:119], v[52:55], v[12:15]
    ds_read_b128 v[100:103], v4 offset:960
    s_waitcnt lgkmcnt(11)
    v_mfma_f32_16x16x32_bf16 v[8:11], v[120:123], v[56:59], v[8:11]
    s_waitcnt lgkmcnt(10)
    v_mfma_f32_16x16x32_bf16 v[12:15], v[124:127], v[60:63], v[12:15]
    s_waitcnt lgkmcnt(9)
    v_mfma_f32_16x16x32_bf16 v[8:11], v[128:131], v[64:67], v[8:11]
    s_waitcnt lgkmcnt(8)
    v_mfma_f32_16x16x32_bf16 v[12:15], v[132:135], v[68:71], v[12:15]
    s_waitcnt lgkmcnt(7)
    v_mfma_f32_16x16x32_bf16 v[8:11], v[136:139], v[72:75], v[8:11]
    s_waitcnt lgkmcnt(6)
    v_mfma_f32_16x16x32_bf16 v[12:15], v[140:143], v[76:79], v[12:15]
    s_waitcnt lgkmcnt(5)
    v_mfma_f32_16x16x32_bf16 v[8:11], v[144:147], v[80:83], v[8:11]
    s_waitcnt lgkmcnt(4)
    v_mfma_f32_16x16x32_bf16 v[12:15], v[148:151], v[84:87], v[12:15]
    s_waitcnt lgkmcnt(3)
    v_mfma_f32_16x16x32_bf16 v[8:11], v[152:155], v[88:91], v[8:11]
    s_waitcnt lgkmcnt(2)
    v_mfma_f32_16x16x32_bf16 v[12:15], v[156:159], v[92:95], v[12:15]
    s_waitcnt lgkmcnt(1)
    v_mfma_f32_16x16x32_bf16 v[8:11], v[160:163], v[96:99], v[8:11]
    s_waitcnt lgkmcnt(0)
    v_mfma_f32_16x16x32_bf16 v[12:15], v[164:167], v[100:103], v[12:15]
    s_nop 7
    v_pk_add_f32 v[8:9], v[8:9], v[12:13]
    v_pk_add_f32 v[10:11], v[10:11], v[14:15]
    s_nop 0
    v_add_f32_dpp v8, v8, v8 quad_perm:[1,0,3,2] row_mask:0xf bank_mask:0xf
    v_add_f32_dpp v9, v9, v9 quad_perm:[1,0,3,2] row_mask:0xf bank_mask:0xf
    v_add_f32_dpp v10, v10, v10 quad_perm:[1,0,3,2] row_mask:0xf bank_mask:0xf
    v_add_f32_dpp v11, v11, v11 quad_perm:[1,0,3,2] row_mask:0xf bank_mask:0xf
    v_mov_b32_dpp v16, v8 quad_perm:[0,0,0,0] row_mask:0xf bank_mask:0xf
    v_mov_b32_dpp v20, v8 quad_perm:[2,2,2,2] row_mask:0xf bank_mask:0xf
    v_mov_b32_dpp v17, v9 quad_perm:[0,0,0,0] row_mask:0xf bank_mask:0xf
    v_mov_b32_dpp v21, v9 quad_perm:[2,2,2,2] row_mask:0xf bank_mask:0xf
    v_mov_b32_dpp v18, v10 quad_perm:[0,0,0,0] row_mask:0xf bank_mask:0xf
    v_mov_b32_dpp v22, v10 quad_perm:[2,2,2,2] row_mask:0xf bank_mask:0xf
    v_mov_b32_dpp v19, v11 quad_perm:[0,0,0,0] row_mask:0xf bank_mask:0xf
    v_mov_b32_dpp v23, v11 quad_perm:[2,2,2,2] row_mask:0xf bank_mask:0xf
    s_mov_b32 s38, 0x3b000000
    s_setprio 2
L_w45:
    s_sleep 1
    ds_read_b32 v3, v0 offset:5052
    s_sub_u32 s3, s3, 1
    s_cbranch_scc1 L_end
    s_waitcnt lgkmcnt(0)
    v_cmp_gt_u32 vcc, 1, v3
    s_cbranch_vccnz L_w45
L_w46:
    ds_read_b32 v3, v0 offset:5052
L_pad_b_6:
    s_cbranch_execz L_pad_b_r
    s_sub_u32 s3, s3, 1
    s_cbranch_scc1 L_end
    s_waitcnt lgkmcnt(0)
    v_cmp_gt_u32_e64 vcc, 4, v3
    s_cbranch_vccnz L_w46
    ds_read_b128 v[40:43], v5 offset:0
    ds_read_b128 v[44:47], v5 offset:64
    ds_read_b128 v[48:51], v5 offset:128
    ds_read_b128 v[52:55], v5 offset:192
    ds_read_b128 v[56:59], v5 offset:256
    ds_read_b128 v[60:63], v5 offset:320
    ds_read_b128 v[64:67], v5 offset:384
    ds_read_b128 v[68:71], v5 offset:448
    ds_read_b128 v[72:75], v5 offset:512
    ds_read_b128 v[76:79], v5 offset:576
    ds_read_b128 v[80:83], v5 offset:640
    ds_read_b128 v[84:87], v5 offset:704
    s_waitcnt lgkmcnt(11)
    v_mfma_f32_16x16x32_bf16 v[8:11], v[104:107], v[40:43], 0
    ds_read_b128 v[88:91], v5 offset:768
    s_waitcnt lgkmcnt(11)
    v_mfma_f32_16x16x32_bf16 v[12:15], v[108:111], v[44:47], 0
    ds_read_b128 v[92:95], v5 offset:832
    s_waitcnt lgkmcnt(11)
    v_mfma_f32_16x16x32_bf16 v[8:11], v[112:115], v[48:51], v[8:11]
    ds_read_b128 v[96:99], v5 offset:896
    s_waitcnt lgkmcnt(11)
    v_mfma_f32_16x16x32_bf16 v[12:15], v[116:119], v[52:55], v[12:15]
    ds_read_b128 v[100:103], v5 offset:960
    s_waitcnt lgkmcnt(11)
    v_mfma_f32_16x16x32_bf16 v[8:11], v[120:123], v[56:59], v[8:11]
    s_waitcnt lgkmcnt(10)
    v_mfma_f32_16x16x32_bf16 v[12:15], v[124:127], v[60:63], v[12:15]
    s_waitcnt lgkmcnt(9)
    v_mfma_f32_16x16x32_bf16 v[8:11], v[128:131], v[64:67], v[8:11]
    s_waitcnt lgkmcnt(8)
    v_mfma_f32_16x16x32_bf16 v[12:15], v[132:135], v[68:71], v[12:15]
    s_waitcnt lgkmcnt(7)
    v_mfma_f32_16x16x32_bf16 v[8:11], v[136:139], v[72:75], v[8:11]
    ds_read_b128 v[24:27], v7
    ds_read_b128 v[28:31], v7 offset:16
    s_waitcnt lgkmcnt(8)
    v_mfma_f32_16x16x32_bf16 v[12:15], v[140:143], v[76:79], v[12:15]
    s_waitcnt lgkmcnt(7)
    v_mfma_f32_16x16x32_bf16 v[8:11], v[144:147], v[80:83], v[8:11]
    s_waitcnt lgkmcnt(0)
    v_mfma_f32_16x16x32_bf16 v[12:15], v[148:151], v[84:87], v[12:15]
    v_max3_u32 v32, v24, v25, v26
    v_max3_u32 v33, v27, v28, v29
    v_mfma_f32_16x16x32_bf16 v[8:11], v[152:155], v[88:91], v[8:11]
    v_max3_u32 v32, v32, v30, v31
    v_max_u32 v32, v32, v33
    v_mfma_f32_16x16x32_bf16 v[12:15], v[156:159], v[92:95], v[12:15]
    v_cmp_eq_u32 vcc, -1, v32
    s_cbranch_vccnz L_B_ln
L_B_ln1:
    v_mfma_f32_16x16x32_bf16 v[8:11], v[160:163], v[96:99], v[8:11]
    v_pk_add_f32 v[24:25], v[24:25], v[26:27]
    v_pk_add_f32 v[28:29], v[28:29], v[30:31]
    v_mfma_f32_16x16x32_bf16 v[12:15], v[164:167], v[100:103], v[12:15]
    v_add_f32 v24, v24, v25
    v_add_f32 v28, v28, v29
    v_mul_f32 v24, s38, v24
    v_mul_f32 v28, s38, v28
    v_fma_f32 v28, -v24, v24, v28
    v_max_f32 v28, 0, v28
    v_add_f32 v28, 0x3727c5ac, v28
    v_rsq_f32 v28, v28
    v_pk_add_f32 v[8:9], v[8:9], v[12:13]
    v_pk_add_f32 v[10:11], v[10:11], v[14:15]
    s_nop 0
    v_add_f32_dpp v8, v8, v8 quad_perm:[1,0,3,2] row_mask:0xf bank_mask:0xf
    v_add_f32_dpp v9, v9, v9 quad_perm:[1,0,3,2] row_mask:0xf bank_mask:0xf
    v_add_f32_dpp v10, v10, v10 quad_perm:[1,0,3,2] row_mask:0xf bank_mask:0xf
    v_add_f32_dpp v11, v11, v11 quad_perm:[1,0,3,2] row_mask:0xf bank_mask:0xf
    v_fma_f32 v8, -v24, v16, v8
    v_fma_f32 v9, -v24, v17, v9
    v_fma_f32 v10, -v24, v18, v10
    v_fma_f32 v11, -v24, v19, v11
    v_fma_f32 v8, v8, v28, v20
    v_fma_f32 v9, v9, v28, v21
    v_fma_f32 v10, v10, v28, v22
    v_fma_f32 v11, v11, v28, v23
    v_max_f32 v8, 0, v8
    v_max_f32 v9, 0, v9
    v_max_f32 v10, 0, v10
    v_max_f32 v11, 0, v11
    v_cvt_pk_bf16_f32 v8, v8, v9
    v_cvt_pk_bf16_f32 v9, v10, v11
    ds_write_b64 v6, v[8:9]
    v_mov_b32_e64 v3, 1
    s_mov_b64 exec, 1
    ds_add_u32 v0, v3 offset:2016
    s_mov_b64 exec, -1
    s_branch L_end
L_B_qv:
    v_lshl_add_u32 v3, v1, 4, s49
    s_mov_b32 s63, 0
    s_waitcnt vmcnt(0) lgkmcnt(0)

    s_mov_b64 exec, s[56:57]
    ds_read_b128 v[8:11], v3 offset:0
    ds_read_b128 v[12:15], v3 offset:1008
    ds_read_b128 v[16:19], v3 offset:2016
    ds_read_b128 v[20:23], v3 offset:3024
    ds_read_b128 v[28:31], v3 offset:4032
    ds_read_b128 v[32:35], v3 offset:5040
    ds_read_b128 v[36:39], v3 offset:6048
    s_mov_b64 exec, -1
    v_max3_u32 v6, v24, v25, v26
    v_max_u32 v6, v6, v27
    v_cmp_eq_u32 vcc, -1, v6
    s_cbranch_vccnz L_B_qf8
L_B_qn8:
    s_mov_b64 exec, s[56:57]
    s_waitcnt lgkmcnt(6)
    v_max3_u32 v6, v8, v9, v10
    v_max_u32 v6, v6, v11
    v_cmp_eq_u32 vcc, -1, v6
    ds_read_b128 v[8:11], v3 offset:7056
    s_cbranch_vccnz L_B_qf0
L_B_qn0:
    s_waitcnt lgkmcnt(6)
    v_max3_u32 v6, v12, v13, v14
    v_max_u32 v6, v6, v15
    v_cmp_eq_u32 vcc, -1, v6
    s_cbranch_vccnz L_B_qf1
L_B_qn1:
    s_waitcnt lgkmcnt(5)
    v_max3_u32 v6, v16, v17, v18
    v_max_u32 v6, v6, v19
    v_cmp_eq_u32 vcc, -1, v6
    s_cbranch_vccnz L_B_qf2
L_B_qn2:
    s_waitcnt lgkmcnt(4)
    v_max3_u32 v6, v20, v21, v22
    v_max_u32 v6, v6, v23
    v_cmp_eq_u32 vcc, -1, v6
    s_cbranch_vccnz L_B_qf3
L_B_qn3:
    s_waitcnt lgkmcnt(3)
    v_max3_u32 v6, v28, v29, v30
    v_max_u32 v6, v6, v31
    v_cmp_eq_u32 vcc, -1, v6
    s_cbranch_vccnz L_B_qf4
L_B_qn4:
    s_waitcnt lgkmcnt(2)
    v_max3_u32 v6, v32, v33, v34
    v_max_u32 v6, v6, v35
    v_cmp_eq_u32 vcc, -1, v6
    s_cbranch_vccnz L_B_qf5
L_B_qn5:
    s_waitcnt lgkmcnt(1)
    v_max3_u32 v6, v36, v37, v38
    v_max_u32 v6, v6, v39
    v_cmp_eq_u32 vcc, -1, v6
    s_cbranch_vccnz L_B_qf6
L_B_qn6:
    s_waitcnt lgkmcnt(0)
    v_max3_u32 v6, v8, v9, v10
    v_max_u32 v6, v6, v11
    v_cmp_eq_u32 vcc, -1, v6
    s_cbranch_vccnz L_B_qf7
L_B_qn7:
    s_mov_b64 exec, -1
    s_cmp_lg_u32 s63, 0
    s_cbranch_scc1 L_B_qv
    s_branch L_B_qok
L_B_qf0:
    s_mov_b32 s63, 1
    s_sub_u32 s3, s3, 1
    s_cbranch_scc1 L_end
    s_mov_b64 exec, vcc
    s_add_u32 m0, s49, 0
    s_add_u32 s38, s51, 0
    v_lshlrev_b32 v6, 4, v1
    buffer_load_dwordx4 v6, s[40:43], s38 offen sc1 lds
    s_mov_b64 exec, s[56:57]
    s_branch L_B_qn0
L_B_qf1:
    s_mov_b32 s63, 1
    s_sub_u32 s3, s3, 1
    s_cbranch_scc1 L_end
    s_mov_b64 exec, vcc
    s_add_u32 m0, s49, 1008
    s_add_u32 s38, s51, 1024
    v_lshlrev_b32 v6, 4, v1
    buffer_load_dwordx4 v6, s[40:43], s38 offen sc1 lds
    s_mov_b64 exec, s[56:57]
    s_branch L_B_qn1
L_B_qf2:
    s_mov_b32 s63, 1
    s_sub_u32 s3, s3, 1
    s_cbranch_scc1 L_end
    s_mov_b64 exec, vcc
    s_add_u32 m0, s49, 2016
    s_add_u32 s38, s51, 2048
    v_lshlrev_b32 v6, 4, v1
    buffer_load_dwordx4 v6, s[40:43], s38 offen sc1 lds
    s_mov_b64 exec, s[56:57]
    s_branch L_B_qn2
L_B_qf3:
    s_mov_b32 s63, 1
    s_sub_u32 s3, s3, 1
    s_cbranch_scc1 L_end
    s_mov_b64 exec, vcc
    s_add_u32 m0, s49, 3024
    s_add_u32 s38, s51, 3072
    v_lshlrev_b32 v6, 4, v1
    buffer_load_dwordx4 v6, s[40:43], s38 offen sc1 lds
    s_mov_b64 exec, s[56:57]
    s_branch L_B_qn3
L_B_qf4:
    s_mov_b32 s63, 1
    s_sub_u32 s3, s3, 1
    s_cbranch_scc1 L_end
    s_mov_b64 exec, vcc
    s_add_u32 m0, s49, 4032
    s_add_u32 s38, s51, 4096
    v_lshlrev_b32 v6, 4, v1
    buffer_load_dwordx4 v6, s[40:43], s38 offen sc1 lds
    s_mov_b64 exec, s[56:57]
    s_branch L_B_qn4
L_B_qf5:
    s_mov_b32 s63, 1
    s_sub_u32 s3, s3, 1
    s_cbranch_scc1 L_end
    s_mov_b64 exec, vcc
    s_add_u32 m0, s49, 5040
    s_add_u32 s38, s51, 5120
    v_lshlrev_b32 v6, 4, v1
    buffer_load_dwordx4 v6, s[40:43], s38 offen sc1 lds
    s_mov_b64 exec, s[56:57]
    s_branch L_B_qn5
L_B_qf6:
    s_mov_b32 s63, 1
    s_sub_u32 s3, s3, 1
    s_cbranch_scc1 L_end
    s_mov_b64 exec, vcc
    s_add_u32 m0, s49, 6048
    s_add_u32 s38, s51, 6144
    v_lshlrev_b32 v6, 4, v1
    buffer_load_dwordx4 v6, s[40:43], s38 offen sc1 lds
    s_mov_b64 exec, s[56:57]
    s_branch L_B_qn6
L_B_qf7:
    s_mov_b32 s63, 1
    s_sub_u32 s3, s3, 1
    s_cbranch_scc1 L_end
    s_mov_b64 exec, vcc
    s_add_u32 m0, s49, 7056
    s_add_u32 s38, s51, 7168
    v_lshlrev_b32 v6, 4, v1
    buffer_load_dwordx4 v6, s[40:43], s38 offen sc1 lds
    s_mov_b64 exec, s[56:57]
    s_branch L_B_qn7
L_B_qf8:
    s_mov_b32 s63, 1
    s_sub_u32 s3, s3, 1
    s_cbranch_scc1 L_end
    s_mov_b64 exec, vcc
    buffer_load_dwordx4 v[24:27], v7, s[40:43], s50 offen offset:992 sc1
    s_branch L_B_qn8
L_B_my0:
    ds_read_b128 v[160:163], v5 offset:7072
    s_sub_u32 s3, s3, 1
    s_cbranch_scc1 L_end
    s_waitcnt lgkmcnt(0)
    s_branch L_B_mx0
L_B_my1:
    ds_read_b128 v[160:163], v5 offset:0
    s_sub_u32 s3, s3, 1
    s_cbranch_scc1 L_end
    s_waitcnt lgkmcnt(0)
    s_branch L_B_mx1
L_B_ln:
    ds_read_b128 v[24:27], v7
    ds_read_b128 v[28:31], v7 offset:16
    s_sub_u32 s3, s3, 1
    s_cbranch_scc1 L_end
    s_waitcnt lgkmcnt(0)
    v_max3_u32 v32, v24, v25, v26
    v_max3_u32 v32, v32, v27, v28
    v_max3_u32 v32, v32, v29, v30
    v_max_u32 v32, v32, v31
    v_cmp_eq_u32 vcc, -1, v32
    s_cbranch_vccnz L_B_ln
    s_branch L_B_ln1
L_Cs:
    s_setprio 2

    v_lshrrev_b32 v3, 4, v1
    v_and_b32 v5, 15, v1
    v_lshlrev_b32 v2, 10, v3
    v_lshl_add_u32 v2, v5, 4, v2
    s_lshl_b32 s38, s33, 8
    v_add_u32 v2, s38, v2
    v_add_u32 v4, 0x1000, v2
    s_waitcnt lgkmcnt(0)
    global_load_dwordx4 v[24:27], v2, s[4:5]
    global_load_dwordx4 v[28:31], v4, s[4:5]
    global_load_dwordx4 v[8:11], v2, s[22:23]
    global_load_dwordx4 v[12:15], v4, s[22:23]
    s_barrier

    s_mov_b32 s3, 0x400000
    v_mov_b32 v0, 156256
    s_and_b32 s62, s34, 3
    s_lshl2_add_u32 s97, s62, s37
    s_lshl4_add_u32 s61, s36, s97
    s_waitcnt lgkmcnt(0)

    s_mov_b32 s40, s30
    s_mov_b32 s41, s31
    s_mov_b32 s42, 16777216
    s_mov_b32 s43, 0x20000
    s_lshl2_add_u32 s55, s36, s37
    v_mov_b32 v32, 0x3f803f80
    v_mov_b32 v33, v32
    v_mov_b32 v34, v32
    v_mov_b32 v35, v32
    v_mov_b32 v36, v32
    v_mov_b32 v37, v32
    v_mov_b32 v38, v32
    v_mov_b32 v39, v32
    v_mov_b32 v40, v32
    v_mov_b32 v41, v32
    v_mov_b32 v42, v32
    v_mov_b32 v43, v32
    v_mov_b32 v44, v32
    v_mov_b32 v45, v32
    v_mov_b32 v46, v32
    v_mov_b32_e64 v47, v32

    s_mov_b32 s56, 0x00ff00ff
    s_mov_b32 s57, 0x00ff00ff
    s_mul_i32 s38, s33, 2176
    v_mul_u32_u24 v6, 272, v3
    v_lshl_add_u32 v6, v5, 4, v6
    v_add_u32 v6, s38, v6
    v_and_b32 v92, 7, v1
    v_mul_u32_u24 v95, 272, v92
    v_lshl_add_u32 v7, v3, 4, v95
    v_add_u32 v7, s38, v7
    v_lshl_add_u32 v95, v3, 3, v95
    s_lshr_b32 s38, s55, 3
    s_mul_i32 s38, s38, 2176
    s_and_b32 s39, s55, 7
    s_lshl_b32 s39, s39, 5
    s_add_u32 s38, s38, s39
    v_add_u32 v95, s38, v95
    s_lshl_b32 s59, s33, 13
    s_add_u32 s59, s59, 65536
    v_bfe_u32 v2, v1, 2, 2
    v_lshl_add_u32 v2, v3, 3, v2
    v_lshlrev_b32 v2, 6, v2
    v_and_b32 v4, 1, v3
    v_lshl_add_u32 v2, v4, 5, v2
    v_and_b32 v4, 3, v1
    v_lshl_add_u32 v2, v4, 3, v2
    v_add_u32 v2, s59, v2
    v_xor_b32 v3, 32, v2
    s_mul_i32 s38, s33, 3072
    s_add_u32 s38, s38, 49152
    v_lshl_add_u32 v4, v1, 4, s38
    s_lshl_b32 s38, s33, 2
    v_add_u32 v5, s38, v0
    s_mov_b32 s38, 0xbfb8aa3b
    s_waitcnt vmcnt(2)
    ds_write_b128 v6, v[24:27] offset:16384
    ds_write_b128 v6, v[28:31] offset:17472
    s_mov_b64 exec, s[56:57]
    ds_read_b128 v[32:35], v7 offset:16384
    ds_read_b128 v[36:39], v7 offset:16448
    ds_read_b128 v[40:43], v7 offset:16512
    ds_read_b128 v[44:47], v7 offset:16576
    s_mov_b64 exec, -1
    s_waitcnt vmcnt(0)
    v_lshlrev_b32 v48, 16, v8
    v_and_b32 v49, 0xffff0000, v8
    v_mul_f32 v50, s38, v48
    v_mul_f32 v51, s38, v49
    v_exp_f32 v50, v50
    v_exp_f32 v51, v51
    v_add_f32 v50, 1.0, v50
    v_add_f32 v51, 1.0, v51
    v_rcp_f32 v50, v50
    v_rcp_f32 v51, v51
    v_mul_f32 v48, v48, v50
    v_mul_f32 v49, v49, v51
    v_cvt_pk_bf16_f32 v8, v48, v49
    s_waitcnt lgkmcnt(0)
    v_mfma_f32_16x16x32_bf16 v[88:91], v[32:35], v[32:35], 0
    v_mfma_f32_16x16x32_bf16 v[88:91], v[36:39], v[36:39], v[88:91]
    v_mfma_f32_16x16x32_bf16 v[88:91], v[40:43], v[40:43], v[88:91]
    v_mfma_f32_16x16x32_bf16 v[88:91], v[44:47], v[44:47], v[88:91]
    v_lshlrev_b32 v48, 16, v9
    v_and_b32 v49, 0xffff0000, v9
    v_mul_f32 v50, s38, v48
    v_mul_f32 v51, s38, v49
    v_exp_f32 v50, v50
    v_exp_f32 v51, v51
    v_add_f32 v50, 1.0, v50
    v_add_f32 v51, 1.0, v51
    v_rcp_f32 v50, v50
    v_rcp_f32 v51, v51
    v_mul_f32 v48, v48, v50
    v_mul_f32 v49, v49, v51
    v_cvt_pk_bf16_f32 v9, v48, v49
    ds_write_b128 v4, v[88:91] offset:2048
    v_mov_b32 v52, 1
    s_mov_b64 exec, 1
    ds_add_u32 v0, v52 offset:12
    s_mov_b64 exec, -1
    v_lshlrev_b32 v48, 16, v10
    v_and_b32 v49, 0xffff0000, v10
    v_mul_f32 v50, s38, v48
    v_mul_f32 v51, s38, v49
    v_exp_f32 v50, v50
    v_exp_f32 v51, v51
    v_add_f32 v50, 1.0, v50
    v_add_f32 v51, 1.0, v51
    v_rcp_f32 v50, v50
    v_rcp_f32 v51, v51
    v_mul_f32 v48, v48, v50
    v_mul_f32 v49, v49, v51
    v_cvt_pk_bf16_f32 v10, v48, v49
    v_lshlrev_b32 v48, 16, v11
    v_and_b32 v49, 0xffff0000, v11
    v_mul_f32 v50, s38, v48
    v_mul_f32 v51, s38, v49
    v_exp_f32 v50, v50
    v_exp_f32 v51, v51
    v_add_f32 v50, 1.0, v50
    v_add_f32 v51, 1.0, v51
    v_rcp_f32 v50, v50
    v_rcp_f32 v51, v51
    v_mul_f32 v48, v48, v50
    v_mul_f32 v49, v49, v51
    v_cvt_pk_bf16_f32 v11, v48, v49
    v_lshlrev_b32 v48, 16, v12
    v_and_b32 v49, 0xffff0000, v12
    v_mul_f32 v50, s38, v48
    v_mul_f32 v51, s38, v49
    v_exp_f32 v50, v50
    v_exp_f32 v51, v51
    v_add_f32 v50, 1.0, v50
    v_add_f32 v51, 1.0, v51
    v_rcp_f32 v50, v50
    v_rcp_f32 v51, v51
    v_mul_f32 v48, v48, v50
    v_mul_f32 v49, v49, v51
    v_cvt_pk_bf16_f32 v12, v48, v49
    v_lshlrev_b32 v48, 16, v13
    v_and_b32 v49, 0xffff0000, v13
    v_mul_f32 v50, s38, v48
    v_mul_f32 v51, s38, v49
    v_exp_f32 v50, v50
    v_exp_f32 v51, v51
    v_add_f32 v50, 1.0, v50
    v_add_f32 v51, 1.0, v51
    v_rcp_f32 v50, v50
    v_rcp_f32 v51, v51
    v_mul_f32 v48, v48, v50
    v_mul_f32 v49, v49, v51
    v_cvt_pk_bf16_f32 v13, v48, v49
    v_lshlrev_b32 v48, 16, v14
    v_and_b32 v49, 0xffff0000, v14
    v_mul_f32 v50, s38, v48
    v_mul_f32 v51, s38, v49
    v_exp_f32 v50, v50
    v_exp_f32 v51, v51
    v_add_f32 v50, 1.0, v50
    v_add_f32 v51, 1.0, v51
    v_rcp_f32 v50, v50
    v_rcp_f32 v51, v51
    v_mul_f32 v48, v48, v50
    v_mul_f32 v49, v49, v51
    v_cvt_pk_bf16_f32 v14, v48, v49
    v_lshlrev_b32 v48, 16, v15
    v_and_b32 v49, 0xffff0000, v15
    v_mul_f32 v50, s38, v48
    v_mul_f32 v51, s38, v49
    v_exp_f32 v50, v50
    v_exp_f32 v51, v51
    v_add_f32 v50, 1.0, v50
    v_add_f32 v51, 1.0, v51
    v_rcp_f32 v50, v50
    v_rcp_f32 v51, v51
    v_mul_f32 v48, v48, v50
    v_mul_f32 v49, v49, v51
    v_cvt_pk_bf16_f32 v15, v48, v49
    ds_write_b128 v6, v[8:11] offset:32768
    ds_write_b128 v6, v[12:15] offset:33856
    ds_read_b128 v[8:11], v7 offset:32768
    ds_read_b128 v[12:15], v7 offset:32832
    ds_read_b128 v[16:19], v7 offset:32896
    ds_read_b128 v[20:23], v7 offset:32960
    s_cmp_lg_u32 s33, 0
    s_cbranch_scc1 L_C_nln
    v_lshrrev_b32 v93, 2, v92
    v_lshl_add_u32 v93, v93, 4, v92
    v_lshlrev_b32 v93, 4, v93
    v_and_b32 v94, 3, v1
    v_lshl_add_u32 v93, v94, 2, v93
    v_add_u32 v93, 51200, v93
    v_lshlrev_b32 v92, 4, v92
    v_add_u32 v94, 51712, v92
    v_lshrrev_b32 v96, 5, v1
    v_lshl_add_u32 v92, v96, 7, v92
    v_bfe_u32 v96, v1, 4, 1
    v_lshl_add_u32 v92, v96, 3, v92
    s_lshl_b32 s39, s55, 8
L_w47:
    ds_read_b32 v40, v0 offset:12
    s_sub_u32 s3, s3, 1
    s_cbranch_scc1 L_end
    s_waitcnt lgkmcnt(0)
    v_cmp_gt_u32_e64 vcc, 4, v40
    s_cbranch_vccnz L_w47
    ds_read_b32 v24, v94 offset:0
    ds_read_b32 v28, v93 offset:0
    ds_read_b32 v25, v94 offset:3072
    ds_read_b32 v29, v93 offset:3072
    ds_read_b32 v26, v94 offset:6144
    ds_read_b32 v30, v93 offset:6144
    ds_read_b32 v27, v94 offset:9216
    ds_read_b32 v31, v93 offset:9216
    ds_read_b64 v[6:7], v95 offset:16384
    s_mov_b32 s38, 0x3b000000
    s_waitcnt lgkmcnt(0)
    v_lshlrev_b32 v96, 16, v6
    v_and_b32 v97, 0xffff0000, v6
    v_lshlrev_b32 v98, 16, v7
    v_and_b32 v99, 0xffff0000, v7
    v_add_f32 v24, v24, v25
    v_add_f32 v28, v28, v29
    v_add_f32 v26, v26, v27
    v_add_f32 v30, v30, v31
    v_add_f32 v24, v24, v26
    v_add_f32 v28, v28, v30
    v_mul_f32 v24, s38, v24
    v_mul_f32 v28, s38, v28
    v_fma_f32 v28, -v24, v24, v28
    v_max_f32 v28, 0, v28
    v_add_f32 v28, 0x3727c5ac, v28
    v_rsq_f32 v28, v28
    v_sub_f32 v96, v96, v24
    v_sub_f32 v97, v97, v24
    v_sub_f32 v98, v98, v24
    v_sub_f32 v99, v99, v24
    v_mul_f32 v96, v96, v28
    v_mul_f32 v97, v97, v28
    v_mul_f32 v98, v98, v28
    v_mul_f32 v99, v99, v28
L_C_nln:
L_w48:
    ds_read_b32 v40, v5 offset:4032
    s_sub_u32 s3, s3, 1
    s_cbranch_scc1 L_end
    s_waitcnt lgkmcnt(0)
    v_cmp_gt_u32 vcc, 1, v40
    s_cbranch_vccnz L_w48
    ds_read_b64_tr_b16 v[48:49], v2 offset:0
    ds_read_b64_tr_b16 v[50:51], v2 offset:256
    ds_read_b64_tr_b16 v[52:53], v3 offset:0
    ds_read_b64_tr_b16 v[54:55], v3 offset:256
    ds_read_b64_tr_b16 v[56:57], v2 offset:2048
    ds_read_b64_tr_b16 v[58:59], v2 offset:2304
    ds_read_b64_tr_b16 v[60:61], v3 offset:2048
    ds_read_b64_tr_b16 v[62:63], v3 offset:2304
    s_waitcnt lgkmcnt(4)
    v_mfma_f32_16x16x32_bf16 v[80:83], v[48:51], v[8:11], 0
    v_mfma_f32_16x16x32_bf16 v[84:87], v[52:55], v[8:11], 0
    s_waitcnt lgkmcnt(0)
    v_mfma_f32_16x16x32_bf16 v[80:83], v[56:59], v[12:15], v[80:83]
    v_mfma_f32_16x16x32_bf16 v[84:87], v[60:63], v[12:15], v[84:87]
L_w49:
    ds_read_b32 v40, v5 offset:4032
    s_sub_u32 s3, s3, 1
    s_cbranch_scc1 L_end
    s_waitcnt lgkmcnt(0)
    v_cmp_gt_u32_e64 vcc, 2, v40
    s_cbranch_vccnz L_w49
    ds_read_b64_tr_b16 v[64:65], v2 offset:4096
    ds_read_b64_tr_b16 v[66:67], v2 offset:4352
    ds_read_b64_tr_b16 v[68:69], v3 offset:4096
    ds_read_b64_tr_b16 v[70:71], v3 offset:4352
    ds_read_b64_tr_b16 v[72:73], v2 offset:6144
    ds_read_b64_tr_b16 v[74:75], v2 offset:6400
    ds_read_b64_tr_b16 v[76:77], v3 offset:6144
    ds_read_b64_tr_b16 v[78:79], v3 offset:6400
    s_waitcnt lgkmcnt(4)
    v_mfma_f32_16x16x32_bf16 v[80:83], v[64:67], v[16:19], v[80:83]
    v_mfma_f32_16x16x32_bf16 v[84:87], v[68:71], v[16:19], v[84:87]
    s_waitcnt lgkmcnt(0)
    v_mfma_f32_16x16x32_bf16 v[80:83], v[72:75], v[20:23], v[80:83]
    v_mfma_f32_16x16x32_bf16 v[84:87], v[76:79], v[20:23], v[84:87]
    s_cmp_eq_u32 s33, 0
    s_cbranch_scc1 L_C_red
    s_nop 4
    ds_write_b128 v4, v[80:83] offset:0
    ds_write_b128 v4, v[84:87] offset:1024
    v_mov_b32 v5, 1
    s_mov_b64 exec, 1
    ds_add_u32 v0, v5 offset:8
    s_mov_b64 exec, -1
    s_branch L_C_o
L_C_red:
L_w50:
    ds_read_b32 v5, v0 offset:8
    s_sub_u32 s3, s3, 1
    s_cbranch_scc1 L_end
    s_waitcnt lgkmcnt(0)
    v_cmp_gt_u32 vcc, 3, v5
    s_cbranch_vccnz L_w50
    ds_read_b128 v[48:51], v4 offset:3072
    ds_read_b128 v[52:55], v4 offset:4096
    ds_read_b128 v[56:59], v4 offset:6144
    ds_read_b128 v[60:63], v4 offset:7168
    ds_read_b128 v[64:67], v4 offset:9216
    ds_read_b128 v[68:71], v4 offset:10240
    ds_read_b32 v5, v0 offset:2020
    v_add_f32 v80, v80, v96
    v_add_f32 v81, v81, v97
    v_add_f32 v82, v82, v98
    v_add_f32_e64 v83, v83, v99
    s_waitcnt lgkmcnt(0)
    v_pk_add_f32 v[80:81], v[80:81], v[48:49]
    v_pk_add_f32 v[56:57], v[56:57], v[64:65]
    v_pk_add_f32 v[82:83], v[82:83], v[50:51]
    v_pk_add_f32 v[58:59], v[58:59], v[66:67]
    v_pk_add_f32 v[84:85], v[84:85], v[52:53]
    v_pk_add_f32 v[60:61], v[60:61], v[68:69]
    v_pk_add_f32 v[86:87], v[86:87], v[54:55]
    v_pk_add_f32 v[62:63], v[62:63], v[70:71]
    v_pk_add_f32 v[80:81], v[80:81], v[56:57]
    v_pk_add_f32 v[82:83], v[82:83], v[58:59]
    v_pk_add_f32 v[84:85], v[84:85], v[60:61]
    v_pk_add_f32 v[86:87], v[86:87], v[62:63]
    v_cmp_gt_u32 vcc, 5, v5
    v_fmac_f32 v80, v84, v96
    v_fmac_f32 v81, v85, v97
    v_fmac_f32 v82, v86, v98
    v_fmac_f32 v83, v87, v99
    v_cvt_pk_bf16_f32 v80, v80, v81
    v_cvt_pk_bf16_f32 v81, v82, v83
    s_cbranch_vccz L_C_pub
L_w51:
    ds_read_b32 v5, v0 offset:2020
    s_sub_u32 s3, s3, 1
    s_cbranch_scc1 L_end
    s_waitcnt lgkmcnt(0)
    v_cmp_gt_u32 vcc, 5, v5
    s_cbranch_vccnz L_w51
L_C_pub:
    s_mov_b64 exec, s[56:57]

    buffer_store_dwordx2 v[80:81], v92, s[40:43], s39 offen sc1
    s_mov_b64 exec, -1
    v_mov_b32 v5, 4
    ds_write_b32 v0, v5 offset:5044
    ds_write_b32 v0, v5 offset:4
    s_branch L_C_o
L_Co:
    s_waitcnt lgkmcnt(0)

    s_mov_b32 s3, 0x400000
    v_mov_b32 v0, 156256
    s_and_b32 s62, s34, 3
    s_lshl2_add_u32 s97, s62, s37
    s_lshl4_add_u32 s61, s36, s97
    s_waitcnt lgkmcnt(0)

    s_mov_b32 s40, s30
    s_mov_b32 s41, s31
    s_mov_b32 s42, 16777216
    s_mov_b32 s43, 0x20000
    s_barrier
    s_cmp_lt_u32 s34, 4
    s_cbranch_scc1 L_C_nt
    s_cmp_lg_u32 s33, 0
    s_cbranch_scc1 L_C_nt
    v_lshrrev_b32 v2, 1, v1
    v_and_b32 v3, 1, v1
    s_lshl2_add_u32 s38, s33, s34
    s_sub_u32 s38, s38, 4
    v_lshl_add_u32 v2, v2, 6, v3
    s_lshl_b32 s38, s38, 10
    s_add_u32 s38, s38, s35
    s_lshl_b32 s38, s38, 8
    v_lshl_add_u32 v2, v2, 7, s38
    s_mov_b64 exec, 1
    global_load_dword v166, v2, s[10:11]
    s_mov_b64 exec, -1
    s_waitcnt vmcnt(0)
    global_load_dword v166, v2, s[10:11]
    s_mov_b64 exec, -1
    v_mov_b32 v3, 1
    s_mov_b64 exec, 1
    ds_add_u32 v0, v3 offset:4
    s_mov_b64 exec, -1
L_C_nt:
    s_cmp_ge_u32 s34, 4
    s_cbranch_scc1 L_C_at
    s_mul_i32 s63, s34, 3
    s_add_u32 s63, s63, s33
    s_sub_u32 s63, s63, 3
    s_cmp_eq_u32 s33, 3
    s_cbranch_scc1 L_C_qh
    s_cmp_eq_u32 s63, 8
    s_cbranch_scc1 L_C_qs
    s_mov_b32 s44, s10
    s_mov_b32 s45, s11
    s_mov_b32 s46, 4194304
    s_mov_b32 s47, 0x20000

    v_lshrrev_b32 v3, 4, v1
    v_and_b32 v2, 15, v1
    v_xor_b32 v4, v2, v3
    v_lshlrev_b32 v4, 4, v4
    v_lshl_add_u32 v4, v3, 13, v4
    v_xor_b32 v5, 64, v4
    v_xor_b32 v6, 0x80, v4
    v_xor_b32 v7, 0xc0, v4
    s_lshl_b32 s48, s63, 19
    s_lshl_b32 s38, s35, 8
    s_add_u32 s48, s48, s38
    s_lshl_b32 s51, s33, 14
    s_add_u32 s51, s51, 65536
    v_lshlrev_b32 v12, 4, v1
    v_mov_b32 v8, -1
    v_mov_b32 v9, -1
    v_mov_b32 v10, -1
    v_mov_b32 v11, -1
    s_lshl3_add_u32 s38, s35, s63
    s_lshl_b32 s38, s38, 12
    s_add_u32 s52, s38, 1048576
    s_lshr_b32 s53, s38, 4
    s_add_u32 s53, s53, 983040
L_w52:
    s_sleep 1
    ds_read_b32 v13, v0 offset:0
    s_sub_u32 s3, s3, 1
    s_cbranch_scc1 L_end
    s_waitcnt lgkmcnt(0)
    v_cmp_gt_u32_e64 vcc, 4, v13
    s_cbranch_vccnz L_w52
    s_add_u32 m0, s51, 0
    s_add_u32 s38, s48, 0
    buffer_load_dwordx4 v4, s[44:47], s38 offen nt lds
    s_add_u32 m0, s51, 1024
    s_add_u32 s38, s48, 131072
    buffer_load_dwordx4 v5, s[44:47], s38 offen nt lds
    s_add_u32 m0, s51, 2048
    s_add_u32 s38, s48, 262144
    buffer_load_dwordx4 v6, s[44:47], s38 offen nt lds
    s_add_u32 m0, s51, 3072
    s_add_u32 s38, s48, 393216
    buffer_load_dwordx4 v7, s[44:47], s38 offen nt lds
    s_add_u32 m0, s51, 4096
    s_add_u32 s38, s48, 32768
    buffer_load_dwordx4 v4, s[44:47], s38 offen nt lds
    s_add_u32 m0, s51, 5120
    s_add_u32 s38, s48, 163840
    buffer_load_dwordx4 v5, s[44:47], s38 offen nt lds
    s_add_u32 m0, s51, 6144
    s_add_u32 s38, s48, 294912
    buffer_load_dwordx4 v6, s[44:47], s38 offen nt lds
    s_add_u32 m0, s51, 7168
    s_add_u32 s38, s48, 425984
    buffer_load_dwordx4 v7, s[44:47], s38 offen nt lds
    s_add_u32 m0, s51, 8192
    s_add_u32 s38, s48, 65536
    buffer_load_dwordx4 v4, s[44:47], s38 offen nt lds
    s_add_u32 m0, s51, 9216
    s_add_u32 s38, s48, 196608
    buffer_load_dwordx4 v5, s[44:47], s38 offen nt lds
    s_add_u32 m0, s51, 10240
    s_add_u32 s38, s48, 327680
    buffer_load_dwordx4 v6, s[44:47], s38 offen nt lds
    s_add_u32 m0, s51, 11264
    s_add_u32 s38, s48, 458752
    buffer_load_dwordx4 v7, s[44:47], s38 offen nt lds
    s_add_u32 m0, s51, 12288
    s_add_u32 s38, s48, 98304
    buffer_load_dwordx4 v4, s[44:47], s38 offen nt lds
    s_add_u32 m0, s51, 13312
    s_add_u32 s38, s48, 229376
    buffer_load_dwordx4 v5, s[44:47], s38 offen nt lds
    s_add_u32 m0, s51, 14336
    s_add_u32 s38, s48, 360448
    buffer_load_dwordx4 v6, s[44:47], s38 offen nt lds
    s_add_u32 m0, s51, 15360
    s_add_u32 s38, s48, 491520
    buffer_load_dwordx4 v7, s[44:47], s38 offen nt lds
    v_mov_b32 v13, 1
    s_mov_b64 exec, 1
    ds_add_u32 v0, v13 offset:7068
    s_mov_b64 exec, -1

    v_lshlrev_b32 v4, 2, v3
    v_xor_b32 v4, v4, v2
    v_lshlrev_b32 v4, 4, v4
    v_lshl_add_u32 v4, v2, 8, v4
    v_add_u32 v4, s51, v4
    v_xor_b32 v5, 16, v4
    v_xor_b32 v6, 32, v4
    v_xor_b32 v7, 48, v4
    v_add_u32 v12, 131072, v12
    v_and_b32 v13, 1, v1
    v_lshlrev_b32 v14, 4, v13
    v_lshl_add_u32 v15, v3, 5, v14
    v_lshrrev_b32 v2, 1, v2
    v_lshl_add_u32 v15, v2, 15, v15
    s_mov_b32 s38, 0xffff
    v_lshlrev_b32 v14, v14, s38
    v_cmp_eq_u32 s[56:57], 1, v13
    s_lshl_b32 s49, s35, 10
    s_lshl_b32 s38, s63, 7
    s_add_u32 s49, s49, s38
    s_add_u32 s49, s49, 65536
    s_waitcnt vmcnt(0)
    ds_read_b128 v[104:107], v4 offset:0
    ds_read_b128 v[108:111], v5 offset:0
    ds_read_b128 v[112:115], v6 offset:0
    ds_read_b128 v[116:119], v7 offset:0
    s_waitcnt lgkmcnt(0)
    ds_read_b128 v[120:123], v4 offset:4096
    ds_read_b128 v[124:127], v5 offset:4096
    ds_read_b128 v[128:131], v6 offset:4096
    ds_read_b128 v[132:135], v7 offset:4096
    s_waitcnt lgkmcnt(0)
    ds_read_b128 v[136:139], v4 offset:8192
    ds_read_b128 v[140:143], v5 offset:8192
    ds_read_b128 v[144:147], v6 offset:8192
    ds_read_b128 v[148:151], v7 offset:8192
    s_waitcnt lgkmcnt(0)
    ds_read_b128 v[152:155], v4 offset:12288
    ds_read_b128 v[156:159], v5 offset:12288
    ds_read_b128 v[160:163], v6 offset:12288
    ds_read_b128 v[164:167], v7 offset:12288
    s_waitcnt lgkmcnt(0)
    s_setprio 2
    v_mov_b32 v5, 1
    s_mov_b64 exec, 1
    ds_add_u32 v0, v5 offset:3028
    s_mov_b64 exec, -1
L_w53:
    ds_read_b32 v5, v0 offset:4
    s_sub_u32 s3, s3, 1
    s_cbranch_scc1 L_end
    s_waitcnt lgkmcnt(0)
    v_cmp_gt_u32 vcc, 4, v5
    s_cbranch_vccnz L_w53
    s_andn2_b32 s38, s2, 0
    s_xor_b32 s38, s38, 8
    s_or_b32 s38, s38, s33
    s_cbranch_scc1 L_C_f2
    s_mul_i32 s38, s36, -30
    s_add_u32 s38, s38, 128
    v_mov_b32 v5, s38
    s_mov_b64 exec, 1
    global_store_dword v5, v8, s[28:29] sc1
    s_mov_b64 exec, -1
L_C_f2:
    v_lshlrev_b32_e64 v32, 4, v1
    s_mov_b64 exec, 0xffff
    buffer_store_dwordx4 v[8:11], v32, s[40:43], s53 offen sc1
    s_mov_b64 exec, -1
    buffer_store_dwordx4 v[8:11], v32, s[40:43], s52 offen offset:0 sc1
    buffer_store_dwordx4 v[8:11], v32, s[40:43], s52 offen offset:1024 sc1
    buffer_store_dwordx4 v[8:11], v32, s[40:43], s52 offen offset:2048 sc1
    buffer_store_dwordx4 v[8:11], v32, s[40:43], s52 offen offset:3072 sc1
L_w54:
    ds_read_b32 v5, v0 offset:5040
    s_sub_u32 s3, s3, 1
    s_cbranch_scc1 L_end
    s_waitcnt lgkmcnt(0)
    v_cmp_gt_u32_e64 vcc, 4, v5
    s_cbranch_vccnz L_w54
    ds_read_b128 v[40:43], v12 offset:0
    ds_read_b128 v[44:47], v12 offset:4096
    ds_read_b128 v[48:51], v12 offset:8192
    ds_read_b128 v[52:55], v12 offset:12288
    ds_read_b128 v[56:59], v12 offset:1024
    ds_read_b128 v[60:63], v12 offset:5120
    ds_read_b128 v[64:67], v12 offset:9216
    ds_read_b128 v[68:71], v12 offset:13312
    ds_read_b128 v[72:75], v12 offset:2048
    ds_read_b128 v[76:79], v12 offset:6144
    ds_read_b128 v[80:83], v12 offset:10240
    ds_read_b128 v[84:87], v12 offset:14336
    s_waitcnt lgkmcnt(8)
    ds_read_b128 v[88:91], v12 offset:3072
    ds_read_b128 v[92:95], v12 offset:7168
    ds_read_b128 v[96:99], v12 offset:11264
    ds_read_b128 v[100:103], v12 offset:15360
    s_waitcnt lgkmcnt(12)
    v_pk_add_f32 v[40:41], v[40:41], v[44:45]
    v_pk_add_f32 v[48:49], v[48:49], v[52:53]
    v_pk_add_f32 v[42:43], v[42:43], v[46:47]
    v_pk_add_f32 v[50:51], v[50:51], v[54:55]
    v_pk_add_f32 v[40:41], v[40:41], v[48:49]
    v_pk_add_f32 v[42:43], v[42:43], v[50:51]
    v_cvt_pk_bf16_f32 v40, v40, v40
    v_cvt_pk_bf16_f32 v41, v41, v41
    v_cvt_pk_bf16_f32 v42, v42, v42
    v_cvt_pk_bf16_f32 v43, v43, v43
    v_and_b32 v16, v40, v14
    v_and_b32 v20, v41, v14
    v_and_b32 v24, v42, v14
    v_and_b32_e64 v28, v43, v14
    s_waitcnt lgkmcnt(8)
    v_pk_add_f32 v[56:57], v[56:57], v[60:61]
    v_pk_add_f32 v[64:65], v[64:65], v[68:69]
    v_pk_add_f32 v[58:59], v[58:59], v[62:63]
    v_pk_add_f32 v[66:67], v[66:67], v[70:71]
    v_pk_add_f32 v[56:57], v[56:57], v[64:65]
    v_pk_add_f32 v[58:59], v[58:59], v[66:67]
    v_cvt_pk_bf16_f32 v56, v56, v56
    v_cvt_pk_bf16_f32 v57, v57, v57
    v_cvt_pk_bf16_f32 v58, v58, v58
    v_cvt_pk_bf16_f32 v59, v59, v59
    v_and_b32 v17, v56, v14
    v_and_b32 v21, v57, v14
    v_and_b32 v25, v58, v14
    v_and_b32_e64 v29, v59, v14
    s_waitcnt lgkmcnt(4)
    v_pk_add_f32 v[72:73], v[72:73], v[76:77]
    v_pk_add_f32 v[80:81], v[80:81], v[84:85]
    v_pk_add_f32 v[74:75], v[74:75], v[78:79]
    v_pk_add_f32 v[82:83], v[82:83], v[86:87]
    v_pk_add_f32 v[72:73], v[72:73], v[80:81]
    v_pk_add_f32 v[74:75], v[74:75], v[82:83]
    v_cvt_pk_bf16_f32 v72, v72, v72
    v_cvt_pk_bf16_f32 v73, v73, v73
    v_cvt_pk_bf16_f32 v74, v74, v74
    v_cvt_pk_bf16_f32 v75, v75, v75
    v_and_b32 v18, v72, v14
    v_and_b32 v22, v73, v14
    v_and_b32 v26, v74, v14
    v_and_b32_e64 v30, v75, v14
    s_waitcnt lgkmcnt(0)
    v_pk_add_f32 v[88:89], v[88:89], v[92:93]
    v_pk_add_f32 v[96:97], v[96:97], v[100:101]
    v_pk_add_f32 v[90:91], v[90:91], v[94:95]
    v_pk_add_f32 v[98:99], v[98:99], v[102:103]
    v_pk_add_f32 v[88:89], v[88:89], v[96:97]
    v_pk_add_f32 v[90:91], v[90:91], v[98:99]
    v_cvt_pk_bf16_f32 v88, v88, v88
    v_cvt_pk_bf16_f32 v89, v89, v89
    v_cvt_pk_bf16_f32 v90, v90, v90
    v_cvt_pk_bf16_f32 v91, v91, v91
    v_and_b32 v19, v88, v14
    v_and_b32 v23, v89, v14
    v_and_b32 v27, v90, v14
    v_and_b32 v31, v91, v14
    v_mfma_f32_16x16x32_bf16 v[40:43], v[104:107], v[16:19], 0
    v_mfma_f32_16x16x32_bf16 v[44:47], v[120:123], v[16:19], 0
    v_mfma_f32_16x16x32_bf16 v[48:51], v[136:139], v[16:19], 0
    v_mfma_f32_16x16x32_bf16 v[52:55], v[152:155], v[16:19], 0
    v_mfma_f32_16x16x32_bf16 v[40:43], v[108:111], v[20:23], v[40:43]
    v_mfma_f32_16x16x32_bf16 v[44:47], v[124:127], v[20:23], v[44:47]
    v_mfma_f32_16x16x32_bf16 v[48:51], v[140:143], v[20:23], v[48:51]
    v_mfma_f32_16x16x32_bf16 v[52:55], v[156:159], v[20:23], v[52:55]
    v_mfma_f32_16x16x32_bf16 v[40:43], v[112:115], v[24:27], v[40:43]
    v_mfma_f32_16x16x32_bf16 v[44:47], v[128:131], v[24:27], v[44:47]
    v_mfma_f32_16x16x32_bf16 v[48:51], v[144:147], v[24:27], v[48:51]
    v_mfma_f32_16x16x32_bf16 v[52:55], v[160:163], v[24:27], v[52:55]
    v_mfma_f32_16x16x32_bf16 v[40:43], v[116:119], v[28:31], v[40:43]
    v_mfma_f32_16x16x32_bf16 v[44:47], v[132:135], v[28:31], v[44:47]
    v_mfma_f32_16x16x32_bf16 v[48:51], v[148:151], v[28:31], v[48:51]
    v_mfma_f32_16x16x32_bf16 v[52:55], v[164:167], v[28:31], v[52:55]
    s_nop 4
    s_nop 0
    v_add_f32_dpp v40, v40, v40 quad_perm:[1,0,3,2] row_mask:0xf bank_mask:0xf
    v_add_f32_dpp v41, v41, v41 quad_perm:[1,0,3,2] row_mask:0xf bank_mask:0xf
    v_add_f32_dpp v42, v42, v42 quad_perm:[1,0,3,2] row_mask:0xf bank_mask:0xf
    v_add_f32_dpp v43, v43, v43 quad_perm:[1,0,3,2] row_mask:0xf bank_mask:0xf
    v_add_f32_dpp v44, v44, v44 quad_perm:[1,0,3,2] row_mask:0xf bank_mask:0xf
    v_add_f32_dpp v45, v45, v45 quad_perm:[1,0,3,2] row_mask:0xf bank_mask:0xf
    v_add_f32_dpp v46, v46, v46 quad_perm:[1,0,3,2] row_mask:0xf bank_mask:0xf
    v_add_f32_dpp v47, v47, v47 quad_perm:[1,0,3,2] row_mask:0xf bank_mask:0xf
    v_add_f32_dpp v48, v48, v48 quad_perm:[1,0,3,2] row_mask:0xf bank_mask:0xf
    v_add_f32_dpp v49, v49, v49 quad_perm:[1,0,3,2] row_mask:0xf bank_mask:0xf
    v_add_f32_dpp v50, v50, v50 quad_perm:[1,0,3,2] row_mask:0xf bank_mask:0xf
    v_add_f32_dpp v51, v51, v51 quad_perm:[1,0,3,2] row_mask:0xf bank_mask:0xf
    v_add_f32_dpp v52, v52, v52 quad_perm:[1,0,3,2] row_mask:0xf bank_mask:0xf
    v_add_f32_dpp v53, v53, v53 quad_perm:[1,0,3,2] row_mask:0xf bank_mask:0xf
    v_add_f32_dpp v54, v54, v54 quad_perm:[1,0,3,2] row_mask:0xf bank_mask:0xf
    v_add_f32_dpp v55, v55, v55 quad_perm:[1,0,3,2] row_mask:0xf bank_mask:0xf
    v_cndmask_b32 v40, v40, v48, s[56:57]
    v_cndmask_b32 v41, v41, v49, s[56:57]
    v_cndmask_b32 v42, v42, v50, s[56:57]
    v_cndmask_b32 v43, v43, v51, s[56:57]
    v_cndmask_b32 v44, v44, v52, s[56:57]
    v_cndmask_b32 v45, v45, v53, s[56:57]
    v_cndmask_b32 v46, v46, v54, s[56:57]
    v_cndmask_b32 v47, v47, v55, s[56:57]
    v_cvt_pk_bf16_f32 v40, v40, v41
    v_cvt_pk_bf16_f32 v41, v42, v43
    v_cvt_pk_bf16_f32 v42, v44, v45
    v_cvt_pk_bf16_f32 v43, v46, v47
    s_waitcnt vmcnt(0)
    buffer_store_dwordx4 v[40:43], v15, s[40:43], s49 offen sc1
L_C_qs:
    v_mov_b32 v5, 1
    s_mov_b64 exec, 1
    ds_add_u32 v0, v5 offset:5044
    s_mov_b64 exec, -1
    s_branch L_C_o
L_C_qh:
L_C_o:
    s_setprio 0
    v_and_b32 v5, 15, v1
    s_mov_b32 s44, s14
    s_mov_b32 s45, s15
    s_mov_b32 s46, 4194304
    s_mov_b32 s47, 0x20000
    v_and_b32 v16, 1, v1
    v_lshlrev_b32 v16, 4, v16
    s_mov_b32 s38, 0xffff
    v_lshlrev_b32 v16, v16, s38
    v_bfe_u32 v17, v1, 1, 2
    v_cmp_eq_u32 vcc, 0, v17
    s_nop 1
    v_cndmask_b32 v20, 0, v16, vcc
    v_cmp_eq_u32 vcc, 1, v17
    s_nop 1
    v_cndmask_b32 v21, 0, v16, vcc
    v_cmp_eq_u32 vcc, 2, v17
    s_nop 1
    v_cndmask_b32 v22, 0, v16, vcc
    v_cmp_eq_u32 vcc, 3, v17
    s_nop 1
    v_cndmask_b32 v23, 0, v16, vcc

    s_mov_b32 s38, 0x3f803f80
    v_and_b32 v20, s38, v20
    v_and_b32 v21, s38, v21
    v_and_b32 v22, s38, v22
    v_and_b32 v23, s38, v23
    v_lshrrev_b32 v4, 4, v1
    v_lshlrev_b32 v7, 11, v4
    v_lshl_add_u32 v7, v5, 4, v7
    s_and_b32 s52, s35, 23
    s_xor_b32 s52, s52, 4
    s_lshr_b32 s38, s33, 1
    s_lshl3_add_u32 s52, s38, s52
    s_and_b32 s39, s33, 1
    s_lshl3_add_u32 s50, s52, s39
    s_lshl_b32 s50, s50, 10
    s_add_u32 s50, s50, 1835008
    s_lshl1_add_u32 s48, s52, s39
    s_lshl_b32 s48, s48, 16
    s_and_b32 s53, s37, 1
    s_lshl2_add_u32 s53, s53, s62
    s_lshl_b32 s38, s53, 7
    s_add_u32 s48, s48, s38
    s_lshr_b32 s39, s37, 1
    s_lshl3_add_u32 s39, s39, s36
    s_xor_b32 s39, s39, 4
    s_lshl_b32 s49, s39, 10
    s_add_u32 s49, s49, s38
    s_add_u32 s49, s49, 1572864
    s_add_u32 s51, s49, 32768
    s_lshl4_add_u32 s60, s53, s39
    s_lshl_b32 s60, s60, 7
    s_add_u32 s60, s60, 983040
    v_and_b32 v12, 1, v4
    v_lshrrev_b32 v13, 1, v4
    v_lshl_add_u32 v12, v12, 1, v13
    v_mul_u32_u24 v12, 272, v12
    v_lshl_add_u32 v12, v5, 4, v12
    s_mul_i32 s38, s33, 4352
    v_add_u32 v18, s38, v12
    v_lshlrev_b32 v13, 4, v13
    v_mul_u32_u24 v3, 272, v5
    v_lshl_add_u32 v3, v4, 4, v3
    v_add_u32 v3, s38, v3
    s_mov_b32 s38, 0xffff
    v_lshlrev_b32 v19, v13, s38
    v_lshlrev_b32 v2, 12, v4
    v_lshl_add_u32 v2, v5, 3, v2
    v_lshlrev_b32 v4, 16, v4
    v_lshl_add_u32 v4, v5, 3, v4
    s_lshl_b32 s38, s33, 11
    s_add_u32 s38, s38, 32768
    v_lshl_add_u32 v17, v1, 4, s38
L_w55:
    s_sleep 1
    ds_read_b32 v6, v0 offset:5048
    s_sub_u32 s3, s3, 1
    s_cbranch_scc1 L_end
    s_waitcnt lgkmcnt(0)
    v_cmp_gt_u32 vcc, 4, v6
    s_cbranch_vccnz L_w55
    s_add_u32 s39, s48, 0
    buffer_load_dwordx2 v[104:105], v2, s[44:47], s39 offen nt
    s_add_u32 s39, s48, 1024
    buffer_load_dwordx2 v[108:109], v2, s[44:47], s39 offen nt
    s_add_u32 s39, s48, 2048
    buffer_load_dwordx2 v[106:107], v2, s[44:47], s39 offen nt
    s_add_u32 s39, s48, 3072
    buffer_load_dwordx2 v[110:111], v2, s[44:47], s39 offen nt
    s_add_u32 s39, s48, 16384
    buffer_load_dwordx2 v[112:113], v2, s[44:47], s39 offen nt
    s_add_u32 s39, s48, 17408
    buffer_load_dwordx2 v[116:117], v2, s[44:47], s39 offen nt
    s_add_u32 s39, s48, 18432
    buffer_load_dwordx2 v[114:115], v2, s[44:47], s39 offen nt
    s_add_u32 s39, s48, 19456
    buffer_load_dwordx2 v[118:119], v2, s[44:47], s39 offen nt
    s_add_u32 s39, s48, 32768
    buffer_load_dwordx2 v[120:121], v2, s[44:47], s39 offen nt
    s_add_u32 s39, s48, 33792
    buffer_load_dwordx2 v[124:125], v2, s[44:47], s39 offen nt
    s_add_u32 s39, s48, 34816
    buffer_load_dwordx2 v[122:123], v2, s[44:47], s39 offen nt
    s_add_u32 s39, s48, 35840
    buffer_load_dwordx2 v[126:127], v2, s[44:47], s39 offen nt
    s_add_u32 s39, s48, 49152
    buffer_load_dwordx2 v[128:129], v2, s[44:47], s39 offen nt
    s_add_u32 s39, s48, 50176
    buffer_load_dwordx2 v[132:133], v2, s[44:47], s39 offen nt
    s_add_u32 s39, s48, 51200
    buffer_load_dwordx2 v[130:131], v2, s[44:47], s39 offen nt
    s_add_u32 s39, s48, 52224
    buffer_load_dwordx2 v[134:135], v2, s[44:47], s39 offen nt
    s_waitcnt vmcnt(0)
    v_mov_b32 v6, 1
    s_mov_b64 exec, 1
    ds_add_u32 v0, v6 offset:6060
    s_mov_b64 exec, -1
    v_swap_b32 v105, v108
    v_swap_b32 v107, v110
    v_swap_b32 v113, v116
    v_swap_b32 v115, v118
    v_swap_b32 v121, v124
    v_swap_b32 v123, v126
    v_swap_b32 v129, v132
    v_swap_b32 v131, v134
L_w56:
    s_sleep 1
    ds_read_b32 v6, v0 offset:6048
    s_sub_u32 s3, s3, 1
    s_cbranch_scc1 L_end
    s_waitcnt lgkmcnt(0)
    v_cmp_gt_u32 vcc, 4, v6
    s_cbranch_vccnz L_w56
    s_setprio 2
L_w57:
    ds_read_b32 v6, v0 offset:6052
    s_sub_u32 s3, s3, 1
    s_cbranch_scc1 L_end
    s_waitcnt lgkmcnt(0)
    v_cmp_gt_u32_e64 vcc, 2, v6
    s_cbranch_vccnz L_w57
L_C_x:
    buffer_load_dwordx4 v[40:43], v7, s[40:43], s50 offen offset:0 sc1
    buffer_load_dwordx4 v[44:47], v7, s[40:43], s50 offen offset:256 sc1
    buffer_load_dwordx4 v[48:51], v7, s[40:43], s50 offen offset:512 sc1
    buffer_load_dwordx4 v[52:55], v7, s[40:43], s50 offen offset:768 sc1
    s_sub_u32 s3, s3, 1
    s_cbranch_scc1 L_end
    s_mov_b64 exec, -1
    s_waitcnt vmcnt(3)
    v_mfma_f32_16x16x32_bf16 v[56:59], v[20:23], v[40:43], 0
    s_waitcnt vmcnt(2)
    v_mfma_f32_16x16x32_bf16 v[60:63], v[20:23], v[44:47], 0
    s_waitcnt vmcnt(1)
    v_mfma_f32_16x16x32_bf16 v[64:67], v[20:23], v[48:51], 0
    s_waitcnt vmcnt(0)
    v_mfma_f32_16x16x32_bf16 v[68:71], v[20:23], v[52:55], 0
    v_max3_u32 v12, v40, v41, v42
    v_max3_u32 v12, v12, v43, v44
    v_max3_u32 v12, v12, v45, v46
    v_max3_u32 v12, v12, v47, v48
    v_max3_u32 v12, v12, v49, v50
    v_max3_u32 v12, v12, v51, v52
    v_max3_u32 v12, v12, v53, v54
    v_max_u32 v12, v12, v55
    v_cmp_eq_u32 vcc, -1, v12
    s_cbranch_vccz L_C_x1
    s_branch L_C_x
L_C_x1:
    v_cvt_pk_bf16_f32 v56, v56, v56
    v_cvt_pk_bf16_f32 v57, v57, v57
    v_cvt_pk_bf16_f32 v58, v58, v58
    v_cvt_pk_bf16_f32 v59, v59, v59
    v_and_b32 v56, v56, v19
    v_and_b32 v57, v57, v19
    v_and_b32 v58, v58, v19
    v_and_b32 v59, v59, v19
    ds_write_b128 v18, v[56:59] offset:0
    v_cvt_pk_bf16_f32 v60, v60, v60
    v_cvt_pk_bf16_f32 v61, v61, v61
    v_cvt_pk_bf16_f32 v62, v62, v62
    v_cvt_pk_bf16_f32 v63, v63, v63
    v_and_b32 v60, v60, v19
    v_and_b32 v61, v61, v19
    v_and_b32 v62, v62, v19
    v_and_b32 v63, v63, v19
    ds_write_b128 v18, v[60:63] offset:1088
    v_cvt_pk_bf16_f32 v64, v64, v64
    v_cvt_pk_bf16_f32 v65, v65, v65
    v_cvt_pk_bf16_f32 v66, v66, v66
    v_cvt_pk_bf16_f32 v67, v67, v67
    v_and_b32 v64, v64, v19
    v_and_b32 v65, v65, v19
    v_and_b32 v66, v66, v19
    v_and_b32 v67, v67, v19
    ds_write_b128 v18, v[64:67] offset:2176
    v_cvt_pk_bf16_f32 v68, v68, v68
    v_cvt_pk_bf16_f32 v69, v69, v69
    v_cvt_pk_bf16_f32 v70, v70, v70
    v_cvt_pk_bf16_f32 v71, v71, v71
    v_and_b32 v68, v68, v19
    v_and_b32 v69, v69, v19
    v_and_b32 v70, v70, v19
    v_and_b32 v71, v71, v19
    ds_write_b128 v18, v[68:71] offset:3264
    ds_read_b128 v[40:43], v3 offset:0
    ds_read_b128 v[44:47], v3 offset:64
    ds_read_b128 v[48:51], v3 offset:128
    ds_read_b128 v[52:55], v3 offset:192
    s_waitcnt lgkmcnt(3)
    v_mfma_f32_16x16x32_bf16 v[24:27], v[40:43], v[104:107], 0
    v_mfma_f32_16x16x32_bf16 v[28:31], v[40:43], v[108:111], 0
    s_waitcnt lgkmcnt(2)
    v_mfma_f32_16x16x32_bf16 v[24:27], v[44:47], v[112:115], v[24:27]
    v_mfma_f32_16x16x32_bf16 v[28:31], v[44:47], v[116:119], v[28:31]
    s_waitcnt lgkmcnt(1)
    v_mfma_f32_16x16x32_bf16 v[24:27], v[48:51], v[120:123], v[24:27]
    v_mfma_f32_16x16x32_bf16 v[28:31], v[48:51], v[124:127], v[28:31]
    s_waitcnt lgkmcnt(0)
    v_mfma_f32_16x16x32_bf16 v[24:27], v[52:55], v[128:131], v[24:27]
    v_mfma_f32_16x16x32_bf16 v[28:31], v[52:55], v[132:135], v[28:31]
    s_cmp_eq_u32 s33, 0
    s_cbranch_scc1 L_C_o2
    s_nop 4
    ds_write_b128 v17, v[24:27]
    ds_write_b128 v17, v[28:31] offset:1024
    v_mov_b32 v6, 1
    s_mov_b64 exec, 1
    ds_add_u32 v0, v6 offset:6056
    s_mov_b64 exec, -1
L_w58:
    ds_read_b32 v6, v0 offset:6056
    s_sub_u32 s3, s3, 1
    s_cbranch_scc1 L_end
    s_waitcnt lgkmcnt(0)
    v_cmp_gt_u32 vcc, 3, v6
    s_cbranch_vccnz L_w58
    s_cmp_lg_u32 s33, 2
    s_cbranch_scc1 L_C_nh
    v_lshlrev_b32 v12, 14, v1
    s_mov_b64 exec, 1
    buffer_store_dword v12, v12, s[40:43], s60 offen sc1
    s_mov_b64 exec, -1
L_C_nh:
    s_branch L_end
L_C_o2:
L_w59:
    ds_read_b32 v6, v0 offset:6056
    s_sub_u32 s3, s3, 1
    s_cbranch_scc1 L_end
    s_waitcnt lgkmcnt(0)
    v_cmp_gt_u32 vcc, 3, v6
    s_cbranch_vccnz L_w59
    ds_read_b128 v[40:43], v17 offset:2048
    ds_read_b128 v[44:47], v17 offset:3072
    ds_read_b128 v[48:51], v17 offset:4096
    ds_read_b128 v[52:55], v17 offset:5120
    ds_read_b128 v[56:59], v17 offset:6144
    ds_read_b128 v[60:63], v17 offset:7168
    s_waitcnt lgkmcnt(4)
    v_pk_add_f32 v[24:25], v[24:25], v[40:41]
    v_pk_add_f32 v[26:27], v[26:27], v[42:43]
    v_pk_add_f32 v[28:29], v[28:29], v[44:45]
    v_pk_add_f32 v[30:31], v[30:31], v[46:47]
    s_waitcnt lgkmcnt(2)
    v_pk_add_f32 v[24:25], v[24:25], v[48:49]
    v_pk_add_f32 v[26:27], v[26:27], v[50:51]
    v_pk_add_f32 v[28:29], v[28:29], v[52:53]
    v_pk_add_f32 v[30:31], v[30:31], v[54:55]
    s_waitcnt lgkmcnt(0)
    s_nop 0
    v_pk_add_f32 v[24:25], v[24:25], v[56:57]
    v_pk_add_f32 v[26:27], v[26:27], v[58:59]
    v_pk_add_f32 v[28:29], v[28:29], v[60:61]
    v_pk_add_f32 v[30:31], v[30:31], v[62:63]
    v_cvt_pk_bf16_f32 v8, v24, v25
    v_cvt_pk_bf16_f32 v9, v28, v29
    v_cvt_pk_bf16_f32 v10, v26, v27
    v_cvt_pk_bf16_f32 v11, v30, v31
    buffer_store_dwordx2 v[8:9], v4, s[40:43], s49 offen sc1
    buffer_store_dwordx2 v[10:11], v4, s[40:43], s51 offen sc1
    s_branch L_end
L_C_at:

    v_lshrrev_b32 v7, 5, v1
    v_bfe_u32 v2, v1, 2, 2
    v_lshl_add_u32 v3, v7, 2, v2
    v_lshrrev_b32 v2, 1, v2
    v_lshl_or_b32 v2, v2, 2, v7
    v_bfe_u32 v4, v1, 4, 1
    v_bfe_u32 v5, v1, 1, 1
    v_lshl_or_b32 v4, v4, 1, v5
    v_xor_b32 v2, v2, v4
    v_lshlrev_b32 v2, 4, v2
    v_lshl_add_u32 v2, v3, 7, v2
    v_and_b32 v3, 1, v1
    v_lshl_add_u32 v2, v3, 3, v2
    s_and_b32 s38, s33, 1
    s_lshl_b32 s38, s38, 6
    s_lshr_b32 s39, s33, 1
    s_lshl_b32 s39, s39, 14
    s_or_b32 s38, s38, s39
    v_xor_b32 v2, s38, v2
    v_xor_b32 v3, 1056, v2
    v_lshlrev_b32 v4, 4, v1
    v_add_u32 v4, 131072, v4
    s_waitcnt vmcnt(0)
    s_mov_b64 exec, 0
    s_branch L_pad_c_0
L_pad_c_r:
    s_mov_b64 exec, -1
L_w460:
    s_sleep 1
    ds_read_b128 v[8:11], v0 offset:4032
    s_sub_u32 s3, s3, 1
    s_cbranch_scc1 L_end
    s_waitcnt lgkmcnt(0)
    v_min3_u32 v8, v8, v9, v10
    v_min_u32 v8, v8, v11
    v_cmp_gt_u32 vcc, 2, v8
    s_cbranch_vccnz L_w460
    ds_read_b64_tr_b16 v[40:41], v2 offset:0
    ds_read_b64_tr_b16 v[42:43], v3 offset:0
    ds_read_b64_tr_b16 v[44:45], v2 offset:2048
    ds_read_b64_tr_b16 v[46:47], v3 offset:2048
    ds_read_b64_tr_b16 v[48:49], v2 offset:4096
    ds_read_b64_tr_b16 v[50:51], v3 offset:4096
    ds_read_b64_tr_b16 v[52:53], v2 offset:6144
    ds_read_b64_tr_b16 v[54:55], v3 offset:6144
    ds_read_b64_tr_b16 v[56:57], v2 offset:8192
    ds_read_b64_tr_b16 v[58:59], v3 offset:8192
    ds_read_b64_tr_b16 v[60:61], v2 offset:10240
    ds_read_b64_tr_b16 v[62:63], v3 offset:10240
    s_waitcnt lgkmcnt(6)
    ds_read_b64_tr_b16 v[64:65], v2 offset:12288
    ds_read_b64_tr_b16 v[66:67], v3 offset:12288
    ds_read_b64_tr_b16 v[68:69], v2 offset:14336
    ds_read_b64_tr_b16 v[70:71], v3 offset:14336
    v_mov_b32 v5, 1
    s_mov_b64 exec, 1
    ds_add_u32 v0, v5 offset:3024
    s_mov_b64 exec, -1
L_w461:
    s_sleep 1
    ds_read_b128 v[8:11], v0 offset:4032
    s_sub_u32 s3, s3, 1
    s_cbranch_scc1 L_end
    s_waitcnt lgkmcnt(0)
    v_min3_u32 v8, v8, v9, v10
    v_min_u32 v8, v8, v11
    v_cmp_gt_u32_e64 vcc, 4, v8
    s_cbranch_vccnz L_w461
    ds_read_b64_tr_b16 v[72:73], v2 offset:32768
    ds_read_b64_tr_b16 v[74:75], v3 offset:32768
    ds_read_b64_tr_b16 v[76:77], v2 offset:34816
    ds_read_b64_tr_b16 v[78:79], v3 offset:34816
    ds_read_b64_tr_b16 v[80:81], v2 offset:36864
    ds_read_b64_tr_b16 v[82:83], v3 offset:36864
    ds_read_b64_tr_b16 v[84:85], v2 offset:38912
    ds_read_b64_tr_b16 v[86:87], v3 offset:38912
    ds_read_b64_tr_b16 v[88:89], v2 offset:40960
    ds_read_b64_tr_b16 v[90:91], v3 offset:40960
    ds_read_b64_tr_b16 v[92:93], v2 offset:43008
    ds_read_b64_tr_b16 v[94:95], v3 offset:43008
    s_waitcnt lgkmcnt(6)
    ds_read_b64_tr_b16 v[96:97], v2 offset:45056
    ds_read_b64_tr_b16 v[98:99], v3 offset:45056
    ds_read_b64_tr_b16 v[100:101], v2 offset:47104
    ds_read_b64_tr_b16 v[102:103], v3 offset:47104
    v_mov_b32 v5, 1
    s_mov_b64 exec, 1
    ds_add_u32 v0, v5 offset:3028
    s_mov_b64 exec, -1
L_w462:
    s_sleep 1
    ds_read_b128 v[8:11], v0 offset:4032
    s_sub_u32 s3, s3, 1
    s_cbranch_scc1 L_end
    s_waitcnt lgkmcnt(0)
    v_min3_u32 v8, v8, v9, v10
    v_min_u32 v8, v8, v11
    v_cmp_gt_u32_e64 vcc, 6, v8
    s_cbranch_vccnz L_w462
    v_add_u32 v2, 0x10000, v2
    v_add_u32 v3, 0x10000, v3
    ds_read_b64_tr_b16 v[104:105], v2 offset:0
    ds_read_b64_tr_b16 v[106:107], v3 offset:0
    ds_read_b64_tr_b16 v[108:109], v2 offset:2048
    ds_read_b64_tr_b16 v[110:111], v3 offset:2048
    ds_read_b64_tr_b16 v[112:113], v2 offset:4096
    ds_read_b64_tr_b16 v[114:115], v3 offset:4096
    ds_read_b64_tr_b16 v[116:117], v2 offset:6144
    ds_read_b64_tr_b16 v[118:119], v3 offset:6144
    ds_read_b64_tr_b16 v[120:121], v2 offset:8192
    ds_read_b64_tr_b16 v[122:123], v3 offset:8192
    ds_read_b64_tr_b16 v[124:125], v2 offset:10240
    ds_read_b64_tr_b16 v[126:127], v3 offset:10240
    s_waitcnt lgkmcnt(6)
    ds_read_b64_tr_b16 v[128:129], v2 offset:12288
    ds_read_b64_tr_b16 v[130:131], v3 offset:12288
    ds_read_b64_tr_b16 v[132:133], v2 offset:14336
    ds_read_b64_tr_b16 v[134:135], v3 offset:14336
    v_mov_b32 v5, 1
    s_mov_b64 exec, 1
    ds_add_u32 v0, v5 offset:3032
    s_mov_b64 exec, -1
L_w463:
    s_sleep 1
    ds_read_b128 v[8:11], v0 offset:4032
    s_sub_u32 s3, s3, 1
    s_cbranch_scc1 L_end
    s_waitcnt lgkmcnt(0)
    v_min3_u32 v8, v8, v9, v10
    v_min_u32 v8, v8, v11
    v_cmp_gt_u32_e64 vcc, 8, v8
    s_cbranch_vccnz L_w463
    ds_read_b64_tr_b16 v[136:137], v2 offset:32768
    ds_read_b64_tr_b16 v[138:139], v3 offset:32768
    ds_read_b64_tr_b16 v[140:141], v2 offset:34816
    ds_read_b64_tr_b16 v[142:143], v3 offset:34816
    ds_read_b64_tr_b16 v[144:145], v2 offset:36864
    ds_read_b64_tr_b16 v[146:147], v3 offset:36864
    ds_read_b64_tr_b16 v[148:149], v2 offset:38912
    ds_read_b64_tr_b16 v[150:151], v3 offset:38912
    ds_read_b64_tr_b16 v[152:153], v2 offset:40960
    ds_read_b64_tr_b16 v[154:155], v3 offset:40960
    ds_read_b64_tr_b16 v[156:157], v2 offset:43008
    ds_read_b64_tr_b16 v[158:159], v3 offset:43008
    s_waitcnt lgkmcnt(6)
    ds_read_b64_tr_b16 v[160:161], v2 offset:45056
    ds_read_b64_tr_b16 v[162:163], v3 offset:45056
    ds_read_b64_tr_b16 v[164:165], v2 offset:47104
    ds_read_b64_tr_b16 v[166:167], v3 offset:47104
    v_mov_b32 v5, 1
    s_mov_b64 exec, 1
    ds_add_u32 v0, v5 offset:3036
    s_mov_b64 exec, -1
    v_subrev_u32 v2, 0x10000, v2
    v_subrev_u32 v3, 0x10000, v3
L_w64:
    s_sleep 2
    ds_read_b32 v5, v0 offset:1008
    s_sub_u32 s3, s3, 1
    s_cbranch_scc1 L_end
    s_waitcnt lgkmcnt(0)
    v_cmp_gt_u32 vcc, 4, v5
    s_cbranch_vccnz L_w64
    s_setprio 1
L_w65:
    s_sleep 1
    ds_read_b32 v5, v0 offset:1016
    s_sub_u32 s3, s3, 1
    s_cbranch_scc1 L_end
    s_waitcnt lgkmcnt(0)
    v_cmp_gt_u32 vcc, 1, v5
    s_cbranch_vccnz L_w65
L_w66:
    ds_read_b32 v5, v0 offset:1016
    s_sub_u32 s3, s3, 1
    s_cbranch_scc1 L_end
    s_waitcnt lgkmcnt(0)
    v_cmp_gt_u32 vcc, 4, v5
    s_cbranch_vccnz L_w66
L_pad_c_0:
    s_cbranch_execz L_pad_c_1
    ds_read_b128 v[24:27], v4 offset:0
    ds_read_b128 v[28:31], v4 offset:1024
    ds_read_b128 v[32:35], v4 offset:2048
    ds_read_b128 v[36:39], v4 offset:3072
    s_waitcnt lgkmcnt(3)
    v_mfma_f32_32x32x16_bf16 v[8:23], v[24:27], v[40:43], 0
    ds_read_b128 v[24:27], v4 offset:4096
    s_waitcnt lgkmcnt(3)
    v_mfma_f32_32x32x16_bf16 v[8:23], v[28:31], v[44:47], v[8:23]
    ds_read_b128 v[28:31], v4 offset:5120
    s_waitcnt lgkmcnt(3)
    v_mfma_f32_32x32x16_bf16 v[8:23], v[32:35], v[48:51], v[8:23]
    ds_read_b128 v[32:35], v4 offset:6144
    s_waitcnt lgkmcnt(3)
    v_mfma_f32_32x32x16_bf16 v[8:23], v[36:39], v[52:55], v[8:23]
    ds_read_b128 v[36:39], v4 offset:7168
    s_waitcnt lgkmcnt(3)
    v_mfma_f32_32x32x16_bf16 v[8:23], v[24:27], v[56:59], v[8:23]
    ds_read_b128 v[24:27], v4 offset:0
    s_waitcnt lgkmcnt(3)
    v_mfma_f32_32x32x16_bf16 v[8:23], v[28:31], v[60:63], v[8:23]
    ds_read_b128 v[28:31], v4 offset:1024
    s_waitcnt lgkmcnt(3)
    v_mfma_f32_32x32x16_bf16 v[8:23], v[32:35], v[64:67], v[8:23]
    ds_read_b128 v[32:35], v4 offset:2048
    s_waitcnt lgkmcnt(3)
    v_mfma_f32_32x32x16_bf16 v[8:23], v[36:39], v[68:71], v[8:23]
    ds_read_b128 v[36:39], v4 offset:3072
    s_waitcnt lgkmcnt(3)
    v_mfma_f32_32x32x16_bf16 v[40:55], v[24:27], v[72:75], 0
    ds_read_b128 v[24:27], v4 offset:4096
    s_waitcnt lgkmcnt(3)
    v_mfma_f32_32x32x16_bf16 v[40:55], v[28:31], v[76:79], v[40:55]
    ds_read_b128 v[28:31], v4 offset:5120
    s_waitcnt lgkmcnt(3)
    v_mfma_f32_32x32x16_bf16 v[40:55], v[32:35], v[80:83], v[40:55]
    ds_read_b128 v[32:35], v4 offset:6144
    s_waitcnt lgkmcnt(3)
    v_mfma_f32_32x32x16_bf16 v[40:55], v[36:39], v[84:87], v[40:55]
    ds_read_b128 v[36:39], v4 offset:7168
    s_waitcnt lgkmcnt(3)
    v_mfma_f32_32x32x16_bf16 v[40:55], v[24:27], v[88:91], v[40:55]
    ds_read_b128 v[24:27], v4 offset:0
    s_waitcnt lgkmcnt(3)
    v_mfma_f32_32x32x16_bf16 v[40:55], v[28:31], v[92:95], v[40:55]
    ds_read_b128 v[28:31], v4 offset:1024
    s_waitcnt lgkmcnt(3)
    v_mfma_f32_32x32x16_bf16 v[40:55], v[32:35], v[96:99], v[40:55]
    ds_read_b128 v[32:35], v4 offset:2048
    s_waitcnt lgkmcnt(3)
    v_mfma_f32_32x32x16_bf16 v[40:55], v[36:39], v[100:103], v[40:55]
    ds_read_b128 v[36:39], v4 offset:3072
    s_waitcnt lgkmcnt(3)
    v_mfma_f32_32x32x16_bf16 v[56:71], v[24:27], v[104:107], 0
    ds_read_b128 v[24:27], v4 offset:4096
    s_waitcnt lgkmcnt(3)
    v_mfma_f32_32x32x16_bf16 v[56:71], v[28:31], v[108:111], v[56:71]
    ds_read_b128 v[28:31], v4 offset:5120
    s_waitcnt lgkmcnt(3)
    v_mfma_f32_32x32x16_bf16 v[56:71], v[32:35], v[112:115], v[56:71]
    ds_read_b128 v[32:35], v4 offset:6144
    s_waitcnt lgkmcnt(3)
    v_mfma_f32_32x32x16_bf16 v[56:71], v[36:39], v[116:119], v[56:71]
    ds_read_b128 v[36:39], v4 offset:7168
    s_waitcnt lgkmcnt(3)
    v_mfma_f32_32x32x16_bf16 v[56:71], v[24:27], v[120:123], v[56:71]
    ds_read_b128 v[24:27], v4 offset:0
    s_waitcnt lgkmcnt(3)
    v_mfma_f32_32x32x16_bf16 v[56:71], v[28:31], v[124:127], v[56:71]
    ds_read_b128 v[28:31], v4 offset:1024
    s_waitcnt lgkmcnt(3)
    v_mfma_f32_32x32x16_bf16 v[56:71], v[32:35], v[128:131], v[56:71]
    ds_read_b128 v[32:35], v4 offset:2048
    s_waitcnt lgkmcnt(3)
    v_mfma_f32_32x32x16_bf16 v[56:71], v[36:39], v[132:135], v[56:71]
    ds_read_b128 v[36:39], v4 offset:3072
    s_waitcnt lgkmcnt(3)
    v_mfma_f32_32x32x16_bf16 v[72:87], v[24:27], v[136:139], 0
    ds_read_b128 v[24:27], v4 offset:4096
    s_waitcnt lgkmcnt(3)
    v_mfma_f32_32x32x16_bf16 v[72:87], v[28:31], v[140:143], v[72:87]
    ds_read_b128 v[28:31], v4 offset:5120
    s_waitcnt lgkmcnt(3)
    v_mfma_f32_32x32x16_bf16 v[72:87], v[32:35], v[144:147], v[72:87]
    ds_read_b128 v[32:35], v4 offset:6144
    s_waitcnt lgkmcnt(3)
    v_mfma_f32_32x32x16_bf16 v[72:87], v[36:39], v[148:151], v[72:87]
    ds_read_b128 v[36:39], v4 offset:7168
    s_waitcnt lgkmcnt(3)
    v_mfma_f32_32x32x16_bf16 v[72:87], v[24:27], v[152:155], v[72:87]
    s_waitcnt lgkmcnt(2)
    v_mfma_f32_32x32x16_bf16 v[72:87], v[28:31], v[156:159], v[72:87]
    s_waitcnt lgkmcnt(1)
    v_mfma_f32_32x32x16_bf16 v[72:87], v[32:35], v[160:163], v[72:87]
    s_waitcnt lgkmcnt(0)
    v_mfma_f32_32x32x16_bf16 v[72:87], v[36:39], v[164:167], v[72:87]

    s_lshl_b32 s38, s33, 7
    s_add_u32 s38, s38, 147968
    v_lshl_add_u32 v32, v7, 4, s38
    v_and_b32_e64 v6, 31, v1
    v_lshl_add_u32 v33, v6, 2, s38
    v_lshl_add_u32 v34, v6, 4, v0
    ds_read_b128 v[28:31], v34 offset:7072
    v_add_u32 v34, -8800, v34
    s_mov_b32 s52, 0x3e0293ee
    s_waitcnt lgkmcnt(0)
    v_max3_f32 v35, v28, v29, v30
    v_max_f32 v35, v35, v31
    v_mul_f32 v35, s52, v35
    v_bfe_u32 v36, v1, 4, 1
    v_lshrrev_b32 v37, 5, v1
    v_lshl_add_u32 v36, v37, 2, v36
    v_lshlrev_b32 v36, 14, v36
    v_and_b32 v37, 15, v1
    v_lshl_add_u32 v36, v37, 3, v36
    s_lshl_b32 s55, s36, 19
    s_lshl2_add_u32 s38, s97, s33
L_pad_c_1:
    s_cbranch_execz L_pad_c_2
    s_lshl_b32 s38, s38, 8
    s_add_u32 s55, s55, s38
    s_add_u32 s55, s55, 2097152
    s_add_u32 s44, s55, 0
    s_add_u32 s45, s55, 32768
    s_add_u32 s46, s55, 131072
    s_add_u32 s47, s55, 163840
    s_add_u32 s48, s55, 262144
    s_add_u32 s49, s55, 294912
    s_add_u32 s50, s55, 393216
    s_add_u32 s51, s55, 425984
    v_lshlrev_b32 v37, 2, v37
    v_add_u32 v37, 149504, v37
    v_mov_b32 v38, -1
    ds_write_b32 v37, v38
L_w467:
    s_sleep 1
    ds_read_b128 v[24:27], v0 offset:4032
    s_sub_u32 s3, s3, 1
    s_cbranch_scc1 L_end
    s_waitcnt lgkmcnt(0)
    v_min3_u32 v24, v24, v25, v26
    v_min_u32 v24, v24, v27
    v_cmp_gt_u32_e64 vcc, 16, v24
    s_cbranch_vccnz L_w467
    ds_read_b64_tr_b16 v[136:137], v2 offset:0
    ds_read_b64_tr_b16 v[138:139], v3 offset:0
    ds_read_b64_tr_b16 v[140:141], v2 offset:2048
    ds_read_b64_tr_b16 v[142:143], v3 offset:2048
    ds_read_b64_tr_b16 v[144:145], v2 offset:4096
    ds_read_b64_tr_b16 v[146:147], v3 offset:4096
    ds_read_b64_tr_b16 v[148:149], v2 offset:6144
    ds_read_b64_tr_b16 v[150:151], v3 offset:6144
    ds_read_b64_tr_b16 v[152:153], v2 offset:8192
    ds_read_b64_tr_b16 v[154:155], v3 offset:8192
    ds_read_b64_tr_b16 v[156:157], v2 offset:10240
    ds_read_b64_tr_b16 v[158:159], v3 offset:10240
    s_waitcnt lgkmcnt(4)
    ds_read_b64_tr_b16 v[160:161], v2 offset:12288
    ds_read_b64_tr_b16 v[162:163], v3 offset:12288
    ds_read_b64_tr_b16 v[164:165], v2 offset:14336
    ds_read_b64_tr_b16 v[166:167], v3 offset:14336
    ds_read_b64_tr_b16 v[24:25], v2 offset:32768
    ds_read_b64_tr_b16 v[26:27], v3 offset:32768
L_C_mx:
    ds_read_b128 v[28:31], v34
    s_sub_u32 s3, s3, 1
    s_cbranch_scc1 L_end
    s_waitcnt lgkmcnt(0)
    v_max3_u32 v5, v28, v29, v30
    v_max_u32 v5, v5, v31
    v_cmp_eq_u32 vcc, -1, v5
    s_cbranch_vccnz L_C_mx
    v_max3_f32 v28, v28, v29, v30
    v_max_f32 v28, v28, v31
    v_mul_f32 v28, s52, v28
    v_max_f32 v28, v28, v35
    v_sub_f32 v28, v35, v28
    v_exp_f32_e64 v28, v28
    s_nop 0
    ds_write_b32 v33, v28
    ds_read_b128 v[88:91], v32 offset:0
    ds_read_b128 v[92:95], v32 offset:32
    ds_read_b128 v[96:99], v32 offset:64
    ds_read_b128 v[100:103], v32 offset:96
    s_waitcnt lgkmcnt(0)
    s_nop 0
    v_pk_mul_f32 v[8:9], v[8:9], v[88:89]
    v_pk_mul_f32 v[10:11], v[10:11], v[90:91]
    v_pk_mul_f32 v[12:13], v[12:13], v[92:93]
    v_pk_mul_f32 v[14:15], v[14:15], v[94:95]
    v_pk_mul_f32 v[16:17], v[16:17], v[96:97]
    v_pk_mul_f32 v[18:19], v[18:19], v[98:99]
    v_pk_mul_f32 v[20:21], v[20:21], v[100:101]
    v_pk_mul_f32 v[22:23], v[22:23], v[102:103]
    v_pk_mul_f32 v[40:41], v[40:41], v[88:89]
    v_pk_mul_f32 v[42:43], v[42:43], v[90:91]
    v_pk_mul_f32 v[44:45], v[44:45], v[92:93]
    v_pk_mul_f32 v[46:47], v[46:47], v[94:95]
    v_pk_mul_f32 v[48:49], v[48:49], v[96:97]
    v_pk_mul_f32 v[50:51], v[50:51], v[98:99]
    v_pk_mul_f32 v[52:53], v[52:53], v[100:101]
    v_pk_mul_f32 v[54:55], v[54:55], v[102:103]
    v_pk_mul_f32 v[56:57], v[56:57], v[88:89]
    v_pk_mul_f32 v[58:59], v[58:59], v[90:91]
    v_pk_mul_f32 v[60:61], v[60:61], v[92:93]
    v_pk_mul_f32 v[62:63], v[62:63], v[94:95]
    v_pk_mul_f32 v[64:65], v[64:65], v[96:97]
    v_pk_mul_f32 v[66:67], v[66:67], v[98:99]
    v_pk_mul_f32 v[68:69], v[68:69], v[100:101]
    v_pk_mul_f32 v[70:71], v[70:71], v[102:103]
    v_pk_mul_f32 v[72:73], v[72:73], v[88:89]
    v_pk_mul_f32 v[74:75], v[74:75], v[90:91]
    v_pk_mul_f32 v[76:77], v[76:77], v[92:93]
    v_pk_mul_f32 v[78:79], v[78:79], v[94:95]
    v_pk_mul_f32 v[80:81], v[80:81], v[96:97]
    v_pk_mul_f32 v[82:83], v[82:83], v[98:99]
    v_pk_mul_f32 v[84:85], v[84:85], v[100:101]
    v_pk_mul_f32 v[86:87], v[86:87], v[102:103]
L_w68:
    ds_read_b32 v5, v0 offset:1016
    s_sub_u32 s3, s3, 1
    s_cbranch_scc1 L_end
    s_waitcnt lgkmcnt(0)
    v_cmp_gt_u32 vcc, 8, v5
    s_cbranch_vccnz L_w68
    s_setprio 3
    ds_read_b128 v[104:107], v4 offset:8192
    ds_read_b128 v[108:111], v4 offset:9216
    ds_read_b128 v[112:115], v4 offset:10240
    ds_read_b128 v[116:119], v4 offset:11264
    ds_read_b128 v[120:123], v4 offset:12288
    ds_read_b128 v[124:127], v4 offset:13312
    ds_read_b128 v[128:131], v4 offset:14336
    ds_read_b128 v[132:135], v4 offset:15360
    ds_read_b64_tr_b16 v[28:29], v2 offset:34816
L_pad_c_2:
    s_cbranch_execz L_pad_c_3
    ds_read_b64_tr_b16 v[30:31], v3 offset:34816
    s_waitcnt lgkmcnt(9)
    v_mfma_f32_32x32x16_bf16 v[8:23], v[104:107], v[136:139], v[8:23]
    ds_read_b64_tr_b16 v[136:137], v2 offset:36864
    ds_read_b64_tr_b16 v[138:139], v3 offset:36864
    s_waitcnt lgkmcnt(10)
    v_mfma_f32_32x32x16_bf16 v[8:23], v[108:111], v[140:143], v[8:23]
    ds_read_b64_tr_b16 v[140:141], v2 offset:38912
    ds_read_b64_tr_b16 v[142:143], v3 offset:38912
    s_waitcnt lgkmcnt(11)
    v_mfma_f32_32x32x16_bf16 v[8:23], v[112:115], v[144:147], v[8:23]
    ds_read_b64_tr_b16 v[144:145], v2 offset:40960
    ds_read_b64_tr_b16 v[146:147], v3 offset:40960
    s_waitcnt lgkmcnt(4)
    s_nop 0
    v_mfma_f32_32x32x16_bf16 v[8:23], v[116:119], v[148:151], v[8:23]
    ds_read_b64_tr_b16 v[148:149], v2 offset:43008
    ds_read_b64_tr_b16 v[150:151], v3 offset:43008
    v_mfma_f32_32x32x16_bf16 v[8:23], v[120:123], v[152:155], v[8:23]
    ds_read_b64_tr_b16 v[152:153], v2 offset:45056
    ds_read_b64_tr_b16 v[154:155], v3 offset:45056
    v_mfma_f32_32x32x16_bf16 v[8:23], v[124:127], v[156:159], v[8:23]
    ds_read_b64_tr_b16 v[156:157], v2 offset:47104
    ds_read_b64_tr_b16 v[158:159], v3 offset:47104
    v_mfma_f32_32x32x16_bf16 v[8:23], v[128:131], v[160:163], v[8:23]
    v_add_u32 v2, 0x10000, v2
    v_add_u32 v3, 0x10000, v3
    ds_read_b64_tr_b16 v[160:161], v2 offset:0
    ds_read_b64_tr_b16 v[162:163], v3 offset:0
    v_mfma_f32_32x32x16_bf16 v[8:23], v[132:135], v[164:167], v[8:23]
    ds_read_b64_tr_b16 v[164:165], v2 offset:2048
    ds_read_b64_tr_b16 v[166:167], v3 offset:2048
    v_mfma_f32_32x32x16_bf16 v[40:55], v[104:107], v[24:27], v[40:55]
    s_waitcnt lgkmcnt(4)
    s_nop 0
    ds_read_b64_tr_b16 v[24:25], v2 offset:4096
    ds_read_b64_tr_b16 v[26:27], v3 offset:4096
    v_mfma_f32_32x32x16_bf16 v[40:55], v[108:111], v[28:31], v[40:55]
    ds_read_b64_tr_b16 v[28:29], v2 offset:6144
    ds_read_b64_tr_b16 v[30:31], v3 offset:6144
    v_mfma_f32_32x32x16_bf16 v[40:55], v[112:115], v[136:139], v[40:55]
    ds_read_b64_tr_b16 v[136:137], v2 offset:8192
    ds_read_b64_tr_b16 v[138:139], v3 offset:8192
    v_mfma_f32_32x32x16_bf16 v[40:55], v[116:119], v[140:143], v[40:55]
    ds_read_b32 v5, v0 offset:2024
    ds_read_b64_tr_b16 v[140:141], v2 offset:10240
    ds_read_b64_tr_b16 v[142:143], v3 offset:10240
    v_mfma_f32_32x32x16_bf16 v[40:55], v[120:123], v[144:147], v[40:55]
    ds_write_b32 v0, v38 offset:7060
    s_waitcnt lgkmcnt(4)
    s_nop 0
    ds_read_b64_tr_b16 v[144:145], v2 offset:12288
    ds_read_b64_tr_b16 v[146:147], v3 offset:12288
    v_mfma_f32_32x32x16_bf16 v[40:55], v[124:127], v[148:151], v[40:55]
    ds_read_b64_tr_b16 v[148:149], v2 offset:14336
    ds_read_b64_tr_b16 v[150:151], v3 offset:14336
    v_mfma_f32_32x32x16_bf16 v[40:55], v[128:131], v[152:155], v[40:55]
    ds_read_b64_tr_b16 v[152:153], v2 offset:32768
    ds_read_b64_tr_b16 v[154:155], v3 offset:32768
    v_mfma_f32_32x32x16_bf16 v[40:55], v[132:135], v[156:159], v[40:55]
    ds_read_b64_tr_b16 v[156:157], v2 offset:34816
    ds_read_b64_tr_b16 v[158:159], v3 offset:34816
    s_waitcnt lgkmcnt(4)
    v_mfma_f32_32x32x16_bf16 v[56:71], v[104:107], v[160:163], v[56:71]
    v_cmp_gt_u32_e64 vcc, 4, v5
    s_cbranch_vccnz L_C_pc
L_C_pc1:
    ds_read_b64_tr_b16 v[160:161], v2 offset:36864
    ds_read_b64_tr_b16 v[162:163], v3 offset:36864
    v_mfma_f32_32x32x16_bf16 v[56:71], v[108:111], v[164:167], v[56:71]
    ds_read_b64_tr_b16 v[164:165], v2 offset:38912
    ds_read_b64_tr_b16 v[166:167], v3 offset:38912
    v_mfma_f32_32x32x16_bf16 v[56:71], v[112:115], v[24:27], v[56:71]
    v_cvt_pk_bf16_f32 v88, v8, v40
    v_cvt_pk_bf16_f32 v89, v9, v41
    ds_read_b64_tr_b16 v[24:25], v2 offset:40960
    ds_read_b64_tr_b16 v[26:27], v3 offset:40960
    v_mfma_f32_32x32x16_bf16 v[56:71], v[116:119], v[28:31], v[56:71]
    v_cvt_pk_bf16_f32 v90, v10, v42
    v_cvt_pk_bf16_f32 v91, v11, v43
    ds_read_b64_tr_b16 v[28:29], v2 offset:43008
    ds_read_b64_tr_b16 v[30:31], v3 offset:43008
    v_mfma_f32_32x32x16_bf16 v[56:71], v[120:123], v[136:139], v[56:71]
    v_permlane16_swap_b32 v88, v89
    buffer_store_dwordx2 v[88:89], v36, s[40:43], s44 offen offset:0 sc1
    ds_read_b64_tr_b16 v[136:137], v2 offset:45056
    ds_read_b64_tr_b16 v[138:139], v3 offset:45056
    v_mfma_f32_32x32x16_bf16 v[56:71], v[124:127], v[140:143], v[56:71]
    v_cvt_pk_bf16_f32 v92, v12, v44
    v_cvt_pk_bf16_f32 v93, v13, v45
    s_waitcnt lgkmcnt(4)
    ds_read_b64_tr_b16 v[140:141], v2 offset:47104
    ds_read_b64_tr_b16 v[142:143], v3 offset:47104
    v_mfma_f32_32x32x16_bf16 v[56:71], v[128:131], v[144:147], v[56:71]
    v_permlane16_swap_b32 v90, v91
    buffer_store_dwordx2 v[90:91], v36, s[40:43], s45 offen offset:0 sc1
    v_mfma_f32_32x32x16_bf16 v[56:71], v[132:135], v[148:151], v[56:71]
    v_cvt_pk_bf16_f32 v94, v14, v46
    v_cvt_pk_bf16_f32 v95, v15, v47
    v_permlane16_swap_b32 v92, v93
    buffer_store_dwordx2 v[92:93], v36, s[40:43], s46 offen offset:0 sc1
    v_mfma_f32_32x32x16_bf16 v[72:87], v[104:107], v[152:155], v[72:87]
    v_cvt_pk_bf16_f32 v96, v16, v48
    v_cvt_pk_bf16_f32 v97, v17, v49
    v_permlane16_swap_b32 v94, v95
    buffer_store_dwordx2 v[94:95], v36, s[40:43], s47 offen offset:0 sc1
    v_mfma_f32_32x32x16_bf16 v[72:87], v[108:111], v[156:159], v[72:87]
L_pad_c_3:
    s_cbranch_execz L_pad_c_4
    v_cvt_pk_bf16_f32 v98, v18, v50
    v_cvt_pk_bf16_f32 v99, v19, v51
    v_permlane16_swap_b32 v96, v97
    buffer_store_dwordx2 v[96:97], v36, s[40:43], s48 offen offset:0 sc1
    v_mfma_f32_32x32x16_bf16 v[72:87], v[112:115], v[160:163], v[72:87]
    v_cvt_pk_bf16_f32 v100, v20, v52
    v_cvt_pk_bf16_f32 v101, v21, v53
    v_permlane16_swap_b32 v98, v99
    buffer_store_dwordx2 v[98:99], v36, s[40:43], s49 offen offset:0 sc1
    v_mfma_f32_32x32x16_bf16 v[72:87], v[116:119], v[164:167], v[72:87]
    v_cvt_pk_bf16_f32 v102, v22, v54
    v_cvt_pk_bf16_f32 v103, v23, v55
    v_permlane16_swap_b32 v100, v101
    buffer_store_dwordx2 v[100:101], v36, s[40:43], s50 offen offset:0 sc1
    v_mfma_f32_32x32x16_bf16 v[72:87], v[120:123], v[24:27], v[72:87]
    v_permlane16_swap_b32 v102, v103
    buffer_store_dwordx2 v[102:103], v36, s[40:43], s51 offen offset:0 sc1
    s_waitcnt lgkmcnt(4)
    v_mfma_f32_32x32x16_bf16 v[72:87], v[124:127], v[28:31], v[72:87]
    s_waitcnt lgkmcnt(2)
    v_mfma_f32_32x32x16_bf16 v[72:87], v[128:131], v[136:139], v[72:87]
    s_waitcnt lgkmcnt(0)
    v_mfma_f32_32x32x16_bf16 v[72:87], v[132:135], v[140:143], v[72:87]
    s_nop 11
    v_cvt_pk_bf16_f32 v104, v56, v72
    v_cvt_pk_bf16_f32 v105, v57, v73
    v_cvt_pk_bf16_f32 v106, v58, v74
    v_cvt_pk_bf16_f32 v107, v59, v75
    v_permlane16_swap_b32 v104, v105
    buffer_store_dwordx2 v[104:105], v36, s[40:43], s44 offen offset:128 sc1
    v_cvt_pk_bf16_f32 v108, v60, v76
    v_cvt_pk_bf16_f32 v109, v61, v77
    v_permlane16_swap_b32 v106, v107
    buffer_store_dwordx2 v[106:107], v36, s[40:43], s45 offen offset:128 sc1
    v_cvt_pk_bf16_f32 v110, v62, v78
    v_cvt_pk_bf16_f32 v111, v63, v79
    v_permlane16_swap_b32 v108, v109
    buffer_store_dwordx2 v[108:109], v36, s[40:43], s46 offen offset:128 sc1
    v_cvt_pk_bf16_f32 v112, v64, v80
    v_cvt_pk_bf16_f32 v113, v65, v81
    v_permlane16_swap_b32 v110, v111
    buffer_store_dwordx2 v[110:111], v36, s[40:43], s47 offen offset:128 sc1
    v_cvt_pk_bf16_f32 v114, v66, v82
    v_cvt_pk_bf16_f32 v115, v67, v83
    v_permlane16_swap_b32 v112, v113
    buffer_store_dwordx2 v[112:113], v36, s[40:43], s48 offen offset:128 sc1
    v_cvt_pk_bf16_f32 v116, v68, v84
    v_cvt_pk_bf16_f32 v117, v69, v85
    v_permlane16_swap_b32 v114, v115
    buffer_store_dwordx2 v[114:115], v36, s[40:43], s49 offen offset:128 sc1
    v_cvt_pk_bf16_f32 v118, v70, v86
    v_cvt_pk_bf16_f32 v119, v71, v87
    v_permlane16_swap_b32 v116, v117
    buffer_store_dwordx2 v[116:117], v36, s[40:43], s50 offen offset:128 sc1
    v_permlane16_swap_b32 v118, v119
    buffer_store_dwordx2 v[118:119], v36, s[40:43], s51 offen offset:128 sc1
    v_mov_b32 v5, 1
    s_mov_b64 exec, 1
    ds_add_u32 v0, v5 offset:1012
    s_mov_b64 exec, -1
    s_setprio 0
    s_cmp_ge_u32 s35, 28
    s_cbranch_scc1 L_end
    v_lshrrev_b32 v6, 4, v1
    v_and_b32 v3, 15, v1
    v_bfe_u32 v8, v1, 2, 2
    v_lshl_add_u32 v9, v6, 3, v8
    v_and_b32 v10, 1, v6
    v_lshl_or_b32 v8, v10, 2, v8
    v_lshlrev_b32 v8, 5, v8
    v_lshl_add_u32 v8, v9, 8, v8
    v_and_b32 v9, 3, v1
    v_lshl_add_u32 v8, v9, 3, v8
    s_lshl_b32 s38, s33, 14
    s_add_u32 s38, s38, 65536
    v_add_u32 v2, s38, v8
    v_bfe_u32 v8, v1, 3, 1
    v_mul_u32_u24 v8, 144, v8
    v_lshl_add_u32 v8, v6, 4, v8
    v_add_u32 v4, 144128, v8
    v_lshlrev_b32 v7, 17, v7
    v_lshl_add_u32 v7, v3, 4, v7
    s_lshl_b32 s49, s62, 5
    s_add_u32 s49, s49, s35
    s_lshl2_add_u32 s49, s49, s33
    s_lshl_b32 s49, s49, 8
    s_add_u32 s49, s49, 1310720
    s_mov_b32 s44, s20
    s_mov_b32 s45, s21
    s_mov_b32 s46, 1835008
    s_mov_b32 s47, 0x20000
L_w69:
    s_sleep 1
    ds_read_b32 v5, v0 offset:1012
    s_sub_u32 s3, s3, 1
    s_cbranch_scc1 L_end
    s_waitcnt lgkmcnt(0)
    v_cmp_gt_u32 vcc, 5, v5
    s_cbranch_vccnz L_w69

    v_lshlrev_b32 v12, 1, v6
    v_xor_b32 v12, v12, v3
    v_lshlrev_b32 v12, 4, v12
    v_lshl_add_u32 v12, v6, 10, v12
    v_xor_b32 v13, 0x80, v12
    s_lshl_b32 s58, s35, 16
    s_lshl_b32 s38, s33, 8
    s_add_u32 s58, s58, s38
    s_lshl_b32 s57, s33, 14
    s_add_u32 s57, s57, 65536
    s_mov_b32 s56, s62
    s_mov_b32 s59, 0
L_A_f2:
    s_xor_b32 s38, s59, s56
    s_lshl_b32 s39, s38, 12
    s_add_u32 s39, s39, s57
    s_lshl_b32 s38, s38, 14
    s_add_u32 s38, s38, s58
    s_add_u32 m0, s39, 0
    s_add_u32 s60, s38, 0
    buffer_load_dwordx4 v12, s[44:47], s60 offen lds
    s_waitcnt vmcnt(3)
    s_add_u32 m0, s39, 1024
    s_add_u32 s60, s38, 4096
    buffer_load_dwordx4 v12, s[44:47], s60 offen lds
    s_waitcnt vmcnt(3)
    s_add_u32 m0, s39, 2048
    s_add_u32 s60, s38, 8192
    buffer_load_dwordx4 v13, s[44:47], s60 offen lds
L_pad_c_4:
    s_cbranch_execz L_pad_c_r
    s_waitcnt vmcnt(3)
    s_add_u32 m0, s39, 3072
    s_add_u32 s60, s38, 12288
    buffer_load_dwordx4 v13, s[44:47], s60 offen lds
    s_waitcnt vmcnt(3)
    s_add_u32 s59, s59, 1
    s_cmp_lt_u32 s59, 4
    s_cbranch_scc1 L_A_f2
    v_mov_b32 v5, 1
    s_mov_b64 exec, 1
    ds_add_u32 v0, v5 offset:5044
    s_mov_b64 exec, -1
    s_waitcnt vmcnt(0)
    v_xor_b32 v5, 0, v2
    ds_read_b64_tr_b16 v[64:65], v5 offset:0
    ds_read_b64_tr_b16 v[66:67], v5 offset:1024
    ds_read_b64_tr_b16 v[96:97], v5 offset:8192
    ds_read_b64_tr_b16 v[98:99], v5 offset:9216
    v_xor_b32 v5, 32, v2
    ds_read_b64_tr_b16 v[68:69], v5 offset:0
    ds_read_b64_tr_b16 v[70:71], v5 offset:1024
    ds_read_b64_tr_b16 v[100:101], v5 offset:8192
    ds_read_b64_tr_b16 v[102:103], v5 offset:9216
    s_waitcnt lgkmcnt(4)
    v_xor_b32 v5, 64, v2
    ds_read_b64_tr_b16 v[72:73], v5 offset:0
    ds_read_b64_tr_b16 v[74:75], v5 offset:1024
    ds_read_b64_tr_b16 v[104:105], v5 offset:8192
    ds_read_b64_tr_b16 v[106:107], v5 offset:9216
    v_xor_b32 v5, 96, v2
    ds_read_b64_tr_b16 v[76:77], v5 offset:0
    ds_read_b64_tr_b16 v[78:79], v5 offset:1024
    ds_read_b64_tr_b16 v[108:109], v5 offset:8192
    ds_read_b64_tr_b16 v[110:111], v5 offset:9216
    s_waitcnt lgkmcnt(4)
    s_nop 0
    v_xor_b32 v5, 128, v2
    ds_read_b64_tr_b16 v[80:81], v5 offset:0
    ds_read_b64_tr_b16 v[82:83], v5 offset:1024
    ds_read_b64_tr_b16 v[112:113], v5 offset:8192
    ds_read_b64_tr_b16 v[114:115], v5 offset:9216
    v_xor_b32 v5, 160, v2
    ds_read_b64_tr_b16 v[84:85], v5 offset:0
    ds_read_b64_tr_b16 v[86:87], v5 offset:1024
    ds_read_b64_tr_b16 v[116:117], v5 offset:8192
    ds_read_b64_tr_b16 v[118:119], v5 offset:9216
    s_waitcnt lgkmcnt(4)
    s_nop 0
    v_xor_b32 v5, 192, v2
    ds_read_b64_tr_b16 v[88:89], v5 offset:0
    ds_read_b64_tr_b16 v[90:91], v5 offset:1024
    ds_read_b64_tr_b16 v[120:121], v5 offset:8192
    ds_read_b64_tr_b16 v[122:123], v5 offset:9216
    v_xor_b32 v5, 224, v2
    ds_read_b64_tr_b16 v[92:93], v5 offset:0
    ds_read_b64_tr_b16 v[94:95], v5 offset:1024
    ds_read_b64_tr_b16 v[124:125], v5 offset:8192
    ds_read_b64_tr_b16 v[126:127], v5 offset:9216
    s_waitcnt lgkmcnt(4)
L_w70:
    s_sleep 2
    ds_read_b32 v5, v0 offset:5052
    s_sub_u32 s3, s3, 1
    s_cbranch_scc1 L_end
    s_waitcnt lgkmcnt(0)
    v_cmp_gt_u32 vcc, 4, v5
    s_cbranch_vccnz L_w70
L_w71:
    ds_read_b32 v5, v0 offset:2016
    s_sub_u32 s3, s3, 1
    s_cbranch_scc1 L_end
    s_waitcnt lgkmcnt(0)
    v_cmp_gt_u32_e64 vcc, 4, v5
    s_cbranch_vccnz L_w71
    ds_read_b128 v[8:11], v4
    ds_read_b128 v[12:15], v4 offset:64
    s_waitcnt lgkmcnt(0)
    v_mfma_f32_16x16x32_bf16 v[32:35], v[8:11], v[64:67], 0
    v_mfma_f32_16x16x32_bf16 v[36:39], v[8:11], v[68:71], 0
    v_mfma_f32_16x16x32_bf16 v[32:35], v[12:15], v[96:99], v[32:35]
    v_mfma_f32_16x16x32_bf16 v[36:39], v[12:15], v[100:103], v[36:39]
    v_mfma_f32_16x16x32_bf16 v[40:43], v[8:11], v[72:75], 0
    v_mfma_f32_16x16x32_bf16 v[44:47], v[8:11], v[76:79], 0
    v_mfma_f32_16x16x32_bf16 v[40:43], v[12:15], v[104:107], v[40:43]
    v_mfma_f32_16x16x32_bf16 v[44:47], v[12:15], v[108:111], v[44:47]
    v_mfma_f32_16x16x32_bf16 v[48:51], v[8:11], v[80:83], 0
    v_mfma_f32_16x16x32_bf16 v[52:55], v[8:11], v[84:87], 0
    v_mfma_f32_16x16x32_bf16 v[48:51], v[12:15], v[112:115], v[48:51]
    v_mfma_f32_16x16x32_bf16 v[52:55], v[12:15], v[116:119], v[52:55]
    v_mfma_f32_16x16x32_bf16 v[56:59], v[8:11], v[88:91], 0
    v_mfma_f32_16x16x32_bf16 v[60:63], v[8:11], v[92:95], 0
    v_mfma_f32_16x16x32_bf16 v[56:59], v[12:15], v[120:123], v[56:59]
    v_mfma_f32_16x16x32_bf16 v[60:63], v[12:15], v[124:127], v[60:63]
    v_cvt_pk_bf16_f32 v28, v32, v36
    v_cvt_pk_bf16_f32 v29, v40, v44
    s_nop 1
    v_cvt_pk_bf16_f32 v30, v48, v52
    s_nop 2
    v_cvt_pk_bf16_f32 v31, v56, v60
    s_mov_b32 exec_lo, 0xffff
    s_mov_b32 exec_hi, 0xffff
    buffer_store_dwordx4 v[28:31], v7, s[40:43], s49 offen sc1
    s_branch L_end
L_C_pc:
L_w72:
    ds_read_b32 v5, v0 offset:2024
    s_sub_u32 s3, s3, 1
    s_cbranch_scc1 L_end
    s_waitcnt lgkmcnt(0)
    v_cmp_gt_u32 vcc, 4, v5
    s_cbranch_vccnz L_w72
    s_branch L_C_pc1
L_end:
L_exit:
    s_endpgm
L_codeend:
.section .rodata,"a"
.p2align 6
.amdhsa_kernel adaLN_cond__compressed_kv_cla__dense_activation_relu__decode_kernel
.amdhsa_next_free_vgpr 168
.amdhsa_next_free_sgpr 102
.amdhsa_accum_offset 168
.amdhsa_group_segment_fixed_size 0
.amdhsa_kernarg_size 112
.amdhsa_user_sgpr_count 2
.amdhsa_user_sgpr_kernarg_segment_ptr 1
.amdhsa_system_sgpr_workgroup_id_x 1
.amdhsa_float_denorm_mode_32 3
.end_amdhsa_kernel
.text
```
